```python
import torch

def _softmax(x, axis=-1):
    return torch.softmax(x, dim=axis)

def _gelu(x):
    return torch.nn.functional.gelu(x, approximate='tanh')

def _silu(x):
    return torch.nn.functional.silu(x)

def _sigmoid(x):
    return torch.sigmoid(x)

def _layernorm(x, axis=-1, eps=1e-05):
    m = x.mean(dim=axis, keepdim=True)
    v = x.var(dim=axis, keepdim=True, unbiased=False)
    return (x - m) / torch.sqrt(v + eps)

def _scatter_add(tgt, idx, src, axis=0):
    return tgt.clone().index_add_(axis, idx, src)

def _segment_sum(src, seg, n):
    out = torch.zeros((n,) + src.shape[1:], dtype=src.dtype)
    return out.index_add_(0, seg, src)

def _pad(x, pw):
    flat = tuple((v for pair in reversed(pw) for v in pair))
    return torch.nn.functional.pad(x, flat)
kernel_name = 'standalone__tensor_product_equiv_mace__graph'

def setup_inputs():

    _w = lambda a: (lambda t: t.to(torch.bfloat16) if t.is_floating_point() else t)(torch.as_tensor(a))
    N, deg = (10000, 16)
    Lmax, C, De = (1, 256, 16)
    M = (Lmax + 1) ** 2
    E = N * deg
    src = (lambda lo, hi, *s: torch.randint(lo, hi, s))(0, N, E).to(torch.int64)
    dst = (lambda lo, hi, *s: torch.randint(lo, hi, s))(0, N, E).to(torch.int64)
    r = (lambda *s: torch.randn(*s, dtype=torch.bfloat16) * 0.05)(E, 3).to(float)
    r = r / (torch.linalg.norm(r, dim=-1, keepdim=True).to(float) + 1e-06)
    rx, ry, rz = (r[:, 0].clone(), r[:, 1].clone(), r[:, 2].clone())
    x2, y2, z2 = (rx * rx, ry * ry, rz * rz)
    sh_list = [torch.ones_like(rx), rx, ry, rz, rx * ry, ry * rz, 2.0 * z2 - x2 - y2, rx * rz, x2 - y2, ry * (3.0 * x2 - y2), rx * ry * rz, ry * (4.0 * z2 - x2 - y2), rz * (2.0 * z2 - 3.0 * x2 - 3.0 * y2), rx * (4.0 * z2 - x2 - y2), rz * (x2 - y2), rx * (x2 - 3.0 * y2)]
    sh16 = torch.stack(sh_list, dim=-1).to(float)
    pad = max(0, M - 16)
    sh_full = torch.cat([sh16, torch.zeros((E, pad), dtype=float)], dim=-1)[:, :M]
    cg = ((lambda *s: torch.randn(*s, dtype=torch.bfloat16) * 0.05)(M, M, M) * (1.0 / float(M))).to(float)
    return {'x': _w(((lambda *s: torch.randn(*s, dtype=torch.bfloat16) * 0.05)(N, M, C) * 0.3).to(float)), 'src': _w(src), 'dst': _w(dst), 'sh': _w(sh_full.to(float)), 'edge_attr': _w(((lambda *s: torch.randn(*s, dtype=torch.bfloat16) * 0.05)(E, De) * 0.3).to(float)), 'cg': _w(cg), 'w_r': _w(((lambda *s: torch.randn(*s, dtype=torch.bfloat16) * 0.05)(De, C) * (1.0 / float(De) ** 0.5)).to(float)), 'w_out': _w(((lambda *s: torch.randn(*s, dtype=torch.bfloat16) * 0.05)(C, C) * (1.0 / float(C) ** 0.5)).to(float))}

def reference(x, src, dst, sh, edge_attr, cg, w_r, w_out):
    N = x.shape[0]
    M = x.shape[1]
    C = x.shape[2]
    h = x[src]
    tp = torch.einsum('uvw,euc,ev->ewc', cg, h, sh)
    rw = edge_attr @ w_r
    msg = tp * rw[:, None, :]
    msg2 = msg.reshape(-1, M * C)
    agg = _segment_sum(msg2, dst, N).reshape(N, M, C)
    out = torch.einsum('nmc,cd->nmd', agg, w_out)
    return out
```

```asm
; @launch grid=(256,1,1) block=(512,1,1) lds=152320
.amdgcn_target "amdgcn-amd-amdhsa--gfx950"
.text
.globl standalone__tensor_product_equiv_mace__graph_kernel
.p2align 8
.type standalone__tensor_product_equiv_mace__graph_kernel,@function
standalone__tensor_product_equiv_mace__graph_kernel:
    s_cmp_ge_u32 s2, 256
    s_cbranch_scc1 L_end
    s_load_dwordx16 s[64:79], s[0:1], 0
    s_load_dwordx4 s[80:83], s[0:1], 64
    s_load_dwordx2 s[84:85], s[0:1], 80
    v_and_b32 v1, 63, v0
    v_lshrrev_b32 v16, 6, v0
    v_mov_b32 v12, 0
    v_readfirstlane_b32 s3, v16
    s_waitcnt lgkmcnt(0)
    s_mov_b32 s8, s64
    s_mov_b32 s9, s65
    s_mov_b32 s10, 20480000
    s_mov_b32 s11, 0x00020000
    s_mov_b32 s12, s66
    s_mov_b32 s13, s67
    s_mov_b32 s14, 640000
    s_mov_b32 s15, 0x00020000
    s_mov_b32 s16, s68
    s_mov_b32 s17, s69
    s_mov_b32 s18, 640000
    s_mov_b32 s19, 0x00020000
    s_mov_b32 s20, s70
    s_mov_b32 s21, s71
    s_mov_b32 s22, 1280000
    s_mov_b32 s23, 0x00020000
    s_mov_b32 s24, s72
    s_mov_b32 s25, s73
    s_mov_b32 s26, 5120000
    s_mov_b32 s27, 0x00020000
    s_mov_b32 s40, s74
    s_mov_b32 s41, s75
    s_mov_b32 s42, 128
    s_mov_b32 s43, 0x00020000
    s_mov_b32 s36, s76
    s_mov_b32 s37, s77
    s_mov_b32 s38, 8192
    s_mov_b32 s39, 0x00020000
    s_mov_b32 s28, s78
    s_mov_b32 s29, s79
    s_mov_b32 s30, 131072
    s_mov_b32 s31, 0x00020000
    s_mov_b32 s32, s80
    s_mov_b32 s33, s81
    s_mov_b32 s34, 20480000
    s_mov_b32 s35, 0x00020000
    s_mov_b32 s44, s84
    s_mov_b32 s45, s85
    s_mov_b32 s46, 1048576
    s_mov_b32 s47, 0x00020000
    v_bfe_u32 v16, v1, 2, 2
    v_lshlrev_b32 v16, 9, v16
    v_lshrrev_b32 v17, 4, v1
    v_lshl_add_u32 v16, v17, 6, v16
    v_and_b32 v17, 3, v1
    v_lshl_add_u32 v16, v17, 4, v16
    s_lshl_b32 s53, s3, 14
    s_add_u32 m0, s53, 0
    s_add_u32 s54, s53, 0
    buffer_load_dwordx4 v16, s[28:31], s54 offen lds
    s_add_u32 m0, s53, 1024
    s_add_u32 s54, s53, 256
    buffer_load_dwordx4 v16, s[28:31], s54 offen lds
    s_add_u32 m0, s53, 2048
    s_add_u32 s54, s53, 2048
    buffer_load_dwordx4 v16, s[28:31], s54 offen lds
    s_add_u32 m0, s53, 3072
    s_add_u32 s54, s53, 2304
    buffer_load_dwordx4 v16, s[28:31], s54 offen lds
    s_add_u32 m0, s53, 4096
    s_add_u32 s54, s53, 4096
    buffer_load_dwordx4 v16, s[28:31], s54 offen lds
    s_add_u32 m0, s53, 5120
    s_add_u32 s54, s53, 4352
    buffer_load_dwordx4 v16, s[28:31], s54 offen lds
    s_add_u32 m0, s53, 6144
    s_add_u32 s54, s53, 6144
    buffer_load_dwordx4 v16, s[28:31], s54 offen lds
    s_add_u32 m0, s53, 7168
    s_add_u32 s54, s53, 6400
    buffer_load_dwordx4 v16, s[28:31], s54 offen lds
    s_add_u32 m0, s53, 8192
    s_add_u32 s54, s53, 8192
    buffer_load_dwordx4 v16, s[28:31], s54 offen lds
    s_add_u32 m0, s53, 9216
    s_add_u32 s54, s53, 8448
    buffer_load_dwordx4 v16, s[28:31], s54 offen lds
    s_add_u32 m0, s53, 10240
    s_add_u32 s54, s53, 10240
    buffer_load_dwordx4 v16, s[28:31], s54 offen lds
    s_add_u32 m0, s53, 11264
    s_add_u32 s54, s53, 10496
    buffer_load_dwordx4 v16, s[28:31], s54 offen lds
    s_add_u32 m0, s53, 12288
    s_add_u32 s54, s53, 12288
    buffer_load_dwordx4 v16, s[28:31], s54 offen lds
    s_add_u32 m0, s53, 13312
    s_add_u32 s54, s53, 12544
    buffer_load_dwordx4 v16, s[28:31], s54 offen lds
    s_add_u32 m0, s53, 14336
    s_add_u32 s54, s53, 14336
    buffer_load_dwordx4 v16, s[28:31], s54 offen lds
    s_add_u32 m0, s53, 15360
    s_add_u32 s54, s53, 14592
    buffer_load_dwordx4 v16, s[28:31], s54 offen lds
    s_lshl_b32 s53, s3, 10
    s_add_u32 m0, s53, 131072
    v_lshlrev_b32 v17, 4, v1
    buffer_load_dwordx4 v17, s[36:39], s53 offen lds
    v_mov_b32 v18, 0
    v_mov_b32 v19, 0
    v_lshlrev_b32 v20, 3, v0
    v_add_u32 v20, 143616, v20
    ds_write_b64 v20, v[18:19]
    v_and_b32 v20, 3, v1
    v_lshlrev_b32 v20, 3, v20
    v_add_u32 v20, 151808, v20
    ds_write_b64 v20, v[18:19]
    v_mov_b32 v80, 0
    v_mov_b32 v81, 0
    v_mov_b32 v82, 0
    v_mov_b32 v83, 0
    v_mov_b32 v84, 0
    v_mov_b32 v85, 0
    v_mov_b32 v86, 0
    v_mov_b32 v87, 0
    v_mov_b32 v88, 0
    v_mov_b32 v89, 0
    v_mov_b32 v90, 0
    v_mov_b32 v91, 0
    v_mov_b32 v92, 0
    v_mov_b32 v93, 0
    v_mov_b32 v94, 0
    v_mov_b32 v95, 0
    v_mov_b32 v96, 0
    v_mov_b32 v97, 0
    v_mov_b32 v98, 0
    v_mov_b32 v99, 0
    v_mov_b32 v100, 0
    v_mov_b32 v101, 0
    v_mov_b32 v102, 0
    v_mov_b32 v103, 0
    v_mov_b32 v104, 0
    v_mov_b32 v105, 0
    v_mov_b32 v106, 0
    v_mov_b32 v107, 0
    v_mov_b32 v108, 0
    v_mov_b32 v109, 0
    v_mov_b32 v110, 0
    v_mov_b32 v111, 0
    v_mov_b32 v112, 0
    v_mov_b32 v113, 0
    v_mov_b32 v114, 0
    v_mov_b32 v115, 0
    v_mov_b32 v116, 0
    v_mov_b32 v117, 0
    v_mov_b32 v118, 0
    v_mov_b32 v119, 0
    v_mov_b32 v120, 0
    v_mov_b32 v121, 0
    v_mov_b32 v122, 0
    v_mov_b32 v123, 0
    v_mov_b32 v124, 0
    v_mov_b32 v125, 0
    v_mov_b32 v126, 0
    v_mov_b32 v127, 0
    v_mov_b32 v128, 0
    v_mov_b32 v129, 0
    v_mov_b32 v130, 0
    v_mov_b32 v131, 0
    v_mov_b32 v132, 0
    v_mov_b32 v133, 0
    v_mov_b32 v134, 0
    v_mov_b32 v135, 0
    v_mov_b32 v136, 0
    v_mov_b32 v137, 0
    v_mov_b32 v138, 0
    v_mov_b32 v139, 0
    v_mov_b32 v140, 0
    v_mov_b32 v141, 0
    v_mov_b32 v142, 0
    v_mov_b32 v143, 0
    v_mov_b32 v144, 0
    v_mov_b32 v145, 0
    v_mov_b32 v146, 0
    v_mov_b32 v147, 0
    v_mov_b32 v148, 0
    v_mov_b32 v149, 0
    v_mov_b32 v150, 0
    v_mov_b32 v151, 0
    v_mov_b32 v152, 0
    v_mov_b32 v153, 0
    v_mov_b32 v154, 0
    v_mov_b32 v155, 0
    v_mov_b32 v156, 0
    v_mov_b32 v157, 0
    v_mov_b32 v158, 0
    v_mov_b32 v159, 0
    v_lshrrev_b32 v16, 4, v1
    v_and_b32 v17, 7, v1
    v_bfe_u32 v18, v1, 3, 1
    v_lshlrev_b32 v18, 9, v18
    v_lshl_add_u32 v18, v16, 7, v18
    v_lshl_add_u32 v2, v17, 4, v18
    v_xor_b32 v17, 4, v17
    v_lshl_add_u32 v3, v17, 4, v18
    s_lshl_b32 s63, s3, 13
    v_bfe_u32 v20, v1, 2, 2
    v_lshrrev_b32 v21, 4, v1
    v_bfe_u32 v22, v1, 1, 1
    v_lshl_add_u32 v22, v21, 1, v22
    v_lshrrev_b32 v23, 1, v20
    v_lshlrev_b32 v24, 2, v23
    v_xor_b32 v22, v22, v24
    v_and_b32 v24, 1, v20
    v_lshl_add_u32 v22, v24, 3, v22
    v_lshlrev_b32 v22, 4, v22
    v_lshl_add_u32 v22, v23, 10, v22
    v_and_b32 v24, 1, v1
    v_lshl_add_u32 v22, v24, 3, v22
    v_add_u32 v4, s63, v22
    v_lshrrev_b32 v21, 5, v1
    v_mov_b32 v23, 256
    v_cmp_eq_u32 vcc, v20, v21
    v_add_u32 v21, 2, v21
    s_nop 0
    v_cndmask_b32 v8, 0, v23, vcc
    v_cmp_eq_u32 vcc, v20, v21
    s_nop 1
    v_cndmask_b32 v9, 0, v23, vcc
    v_lshlrev_b32 v14, 16, v1
    s_mov_b32 s82, 0x05040100
    s_mov_b32 s83, 0x07060302
    s_mul_i32 s76, s3, 78
    s_add_u32 s77, s76, 79
    s_cmp_lg_u32 s3, 0
    s_addc_u32 s76, s76, 0
    s_mov_b32 s52, 0
    s_mov_b32 s73, 0
    s_lshl_b32 s100, s3, 9
    s_add_u32 s100, s100, 139520
    s_add_u32 s51, s100, 512
    v_lshrrev_b32 v16, 5, v1
    v_lshlrev_b32 v16, 12, v16
    v_lshl_add_u32 v16, v20, 6, v16
    v_bfe_u32 v17, v1, 4, 1
    v_lshl_add_u32 v16, v17, 5, v16
    v_and_b32 v18, 3, v1
    v_lshl_add_u32 v16, v18, 3, v16
    s_lshl_b32 s53, s3, 8
    v_add_u32 v16, s53, v16
    v_add_u32 v19, 0x10000, v16
    v_lshlrev_b32 v21, 12, v17
    v_lshl_add_u32 v21, v20, 9, v21
    v_lshrrev_b32 v22, 5, v1
    v_lshl_add_u32 v21, v22, 5, v21
    v_lshl_add_u32 v21, v18, 3, v21
    v_add_u32 v21, 131072, v21
    s_waitcnt vmcnt(0) lgkmcnt(0)
    s_barrier
    ds_read_b64_tr_b16 a[0:1], v16 offset:0
    ds_read_b64_tr_b16 a[2:3], v16 offset:2048
    ds_read_b64_tr_b16 a[4:5], v16 offset:8192
    ds_read_b64_tr_b16 a[6:7], v16 offset:10240
    ds_read_b64_tr_b16 a[8:9], v16 offset:16384
    ds_read_b64_tr_b16 a[10:11], v16 offset:18432
    ds_read_b64_tr_b16 a[12:13], v16 offset:24576
    ds_read_b64_tr_b16 a[14:15], v16 offset:26624
    s_waitcnt lgkmcnt(0)
    ds_read_b64_tr_b16 a[16:17], v16 offset:32768
    ds_read_b64_tr_b16 a[18:19], v16 offset:34816
    ds_read_b64_tr_b16 a[20:21], v16 offset:40960
    ds_read_b64_tr_b16 a[22:23], v16 offset:43008
    ds_read_b64_tr_b16 a[24:25], v16 offset:49152
    ds_read_b64_tr_b16 a[26:27], v16 offset:51200
    ds_read_b64_tr_b16 a[28:29], v16 offset:57344
    ds_read_b64_tr_b16 a[30:31], v16 offset:59392
    s_waitcnt lgkmcnt(0)
    ds_read_b64_tr_b16 a[32:33], v19 offset:0
    ds_read_b64_tr_b16 a[34:35], v19 offset:2048
    ds_read_b64_tr_b16 a[36:37], v19 offset:8192
    ds_read_b64_tr_b16 a[38:39], v19 offset:10240
    ds_read_b64_tr_b16 a[40:41], v19 offset:16384
    ds_read_b64_tr_b16 a[42:43], v19 offset:18432
    ds_read_b64_tr_b16 a[44:45], v19 offset:24576
    ds_read_b64_tr_b16 a[46:47], v19 offset:26624
    s_waitcnt lgkmcnt(0)
    ds_read_b64_tr_b16 a[48:49], v19 offset:32768
    ds_read_b64_tr_b16 a[50:51], v19 offset:34816
    ds_read_b64_tr_b16 a[52:53], v19 offset:40960
    ds_read_b64_tr_b16 a[54:55], v19 offset:43008
    ds_read_b64_tr_b16 a[56:57], v19 offset:49152
    ds_read_b64_tr_b16 a[58:59], v19 offset:51200
    ds_read_b64_tr_b16 a[60:61], v19 offset:57344
    ds_read_b64_tr_b16 a[62:63], v19 offset:59392
    s_waitcnt lgkmcnt(0)
    ds_read_b64_tr_b16 a[64:65], v21 offset:0
    ds_read_b64_tr_b16 a[66:67], v21 offset:2048
    ds_read_b64_tr_b16 a[68:69], v21 offset:64
    ds_read_b64_tr_b16 a[70:71], v21 offset:2112
    ds_read_b64_tr_b16 a[72:73], v21 offset:128
    ds_read_b64_tr_b16 a[74:75], v21 offset:2176
    ds_read_b64_tr_b16 a[76:77], v21 offset:192
    ds_read_b64_tr_b16 a[78:79], v21 offset:2240
    s_waitcnt lgkmcnt(0)
    ds_read_b64_tr_b16 a[80:81], v21 offset:256
    ds_read_b64_tr_b16 a[82:83], v21 offset:2304
    ds_read_b64_tr_b16 a[84:85], v21 offset:320
    ds_read_b64_tr_b16 a[86:87], v21 offset:2368
    ds_read_b64_tr_b16 a[88:89], v21 offset:384
    ds_read_b64_tr_b16 a[90:91], v21 offset:2432
    ds_read_b64_tr_b16 a[92:93], v21 offset:448
    ds_read_b64_tr_b16 a[94:95], v21 offset:2496
    s_waitcnt lgkmcnt(0)
L_round:
    s_mov_b32 s50, s100
    s_sub_u32 s48, s77, s76
    s_cmp_eq_u32 s48, 0
    s_cbranch_scc1 L_scan_done
    s_lshl_b32 s49, s76, 22
    s_lshl_b32 s53, s76, 10
    v_lshlrev_b32 v13, 4, v1
    v_add_u32 v13, s53, v13
    v_add_u32 v15, 4096, v13
    buffer_load_dwordx4 v[16:19], v13, s[16:19], 0 offen offset:0
    buffer_load_dwordx4 v[20:23], v13, s[16:19], 0 offen offset:1024
    buffer_load_dwordx4 v[24:27], v13, s[16:19], 0 offen offset:2048
    buffer_load_dwordx4 v[28:31], v13, s[16:19], 0 offen offset:3072
    buffer_load_dwordx4 v[32:35], v15, s[16:19], 0 offen offset:0
    buffer_load_dwordx4 v[36:39], v15, s[16:19], 0 offen offset:1024
    buffer_load_dwordx4 v[40:43], v15, s[16:19], 0 offen offset:2048
    buffer_load_dwordx4 v[44:47], v15, s[16:19], 0 offen offset:3072
    v_add_u32 v13, 0x2000, v13
    v_add_u32 v15, 0x2000, v15
    s_cmp_eq_u32 s52, 0
    s_cbranch_scc1 L_scanA
    s_waitcnt vmcnt(7)
    s_xor_b32 s53, s2, 1
    v_mov_b32 v16, s53
    s_cmp_lt_u32 s52, 2
    s_cbranch_scc1 L_scanA
    v_mov_b32 v17, s53
    s_cmp_lt_u32 s52, 3
    s_cbranch_scc1 L_scanA
    v_mov_b32 v18, s53
L_scanA:
    s_cmp_lt_u32 s48, 16
    s_cbranch_scc1 L_scanB
    s_waitcnt vmcnt(7)
    v_cmp_eq_u32_sdwa vcc, v16, s2 src0_sel:BYTE_0 src1_sel:DWORD
    s_cbranch_vccnz L_hA_0_0
L_rA_0_0:
    v_cmp_eq_u32_sdwa vcc, v17, s2 src0_sel:BYTE_0 src1_sel:DWORD
    s_cbranch_vccnz L_hA_0_1
L_rA_0_1:
    v_cmp_eq_u32_sdwa vcc, v18, s2 src0_sel:BYTE_0 src1_sel:DWORD
    s_cbranch_vccnz L_hA_0_2
L_rA_0_2:
    v_cmp_eq_u32_sdwa vcc, v19, s2 src0_sel:BYTE_0 src1_sel:DWORD
    s_cbranch_vccnz L_hA_0_3
L_rA_0_3:
    buffer_load_dwordx4 v[16:19], v13, s[16:19], 0 offen offset:0
    s_waitcnt vmcnt(7)
    v_cmp_eq_u32_sdwa vcc, v20, s2 src0_sel:BYTE_0 src1_sel:DWORD
    s_cbranch_vccnz L_hA_1_0
L_rA_1_0:
    v_cmp_eq_u32_sdwa vcc, v21, s2 src0_sel:BYTE_0 src1_sel:DWORD
    s_cbranch_vccnz L_hA_1_1
L_rA_1_1:
    v_cmp_eq_u32_sdwa vcc, v22, s2 src0_sel:BYTE_0 src1_sel:DWORD
    s_cbranch_vccnz L_hA_1_2
L_rA_1_2:
    v_cmp_eq_u32_sdwa vcc, v23, s2 src0_sel:BYTE_0 src1_sel:DWORD
    s_cbranch_vccnz L_hA_1_3
L_rA_1_3:
    buffer_load_dwordx4 v[20:23], v13, s[16:19], 0 offen offset:1024
    s_waitcnt vmcnt(7)
    v_cmp_eq_u32_sdwa vcc, v24, s2 src0_sel:BYTE_0 src1_sel:DWORD
    s_cbranch_vccnz L_hA_2_0
L_rA_2_0:
    v_cmp_eq_u32_sdwa vcc, v25, s2 src0_sel:BYTE_0 src1_sel:DWORD
    s_cbranch_vccnz L_hA_2_1
L_rA_2_1:
    v_cmp_eq_u32_sdwa vcc, v26, s2 src0_sel:BYTE_0 src1_sel:DWORD
    s_cbranch_vccnz L_hA_2_2
L_rA_2_2:
    v_cmp_eq_u32_sdwa vcc, v27, s2 src0_sel:BYTE_0 src1_sel:DWORD
    s_cbranch_vccnz L_hA_2_3
L_rA_2_3:
    buffer_load_dwordx4 v[24:27], v13, s[16:19], 0 offen offset:2048
    s_waitcnt vmcnt(7)
    v_cmp_eq_u32_sdwa vcc, v28, s2 src0_sel:BYTE_0 src1_sel:DWORD
    s_cbranch_vccnz L_hA_3_0
L_rA_3_0:
    v_cmp_eq_u32_sdwa vcc, v29, s2 src0_sel:BYTE_0 src1_sel:DWORD
    s_cbranch_vccnz L_hA_3_1
L_rA_3_1:
    v_cmp_eq_u32_sdwa vcc, v30, s2 src0_sel:BYTE_0 src1_sel:DWORD
    s_cbranch_vccnz L_hA_3_2
L_rA_3_2:
    v_cmp_eq_u32_sdwa vcc, v31, s2 src0_sel:BYTE_0 src1_sel:DWORD
    s_cbranch_vccnz L_hA_3_3
L_rA_3_3:
    buffer_load_dwordx4 v[28:31], v13, s[16:19], 0 offen offset:3072
    s_waitcnt vmcnt(7)
    v_cmp_eq_u32_sdwa vcc, v32, s2 src0_sel:BYTE_0 src1_sel:DWORD
    s_cbranch_vccnz L_hA_4_0
L_rA_4_0:
    v_cmp_eq_u32_sdwa vcc, v33, s2 src0_sel:BYTE_0 src1_sel:DWORD
    s_cbranch_vccnz L_hA_4_1
L_rA_4_1:
    v_cmp_eq_u32_sdwa vcc, v34, s2 src0_sel:BYTE_0 src1_sel:DWORD
    s_cbranch_vccnz L_hA_4_2
L_rA_4_2:
    v_cmp_eq_u32_sdwa vcc, v35, s2 src0_sel:BYTE_0 src1_sel:DWORD
    s_cbranch_vccnz L_hA_4_3
L_rA_4_3:
    buffer_load_dwordx4 v[32:35], v15, s[16:19], 0 offen offset:0
    s_waitcnt vmcnt(7)
    v_cmp_eq_u32_sdwa vcc, v36, s2 src0_sel:BYTE_0 src1_sel:DWORD
    s_cbranch_vccnz L_hA_5_0
L_rA_5_0:
    v_cmp_eq_u32_sdwa vcc, v37, s2 src0_sel:BYTE_0 src1_sel:DWORD
    s_cbranch_vccnz L_hA_5_1
L_rA_5_1:
    v_cmp_eq_u32_sdwa vcc, v38, s2 src0_sel:BYTE_0 src1_sel:DWORD
    s_cbranch_vccnz L_hA_5_2
L_rA_5_2:
    v_cmp_eq_u32_sdwa vcc, v39, s2 src0_sel:BYTE_0 src1_sel:DWORD
    s_cbranch_vccnz L_hA_5_3
L_rA_5_3:
    buffer_load_dwordx4 v[36:39], v15, s[16:19], 0 offen offset:1024
    s_waitcnt vmcnt(7)
    v_cmp_eq_u32_sdwa vcc, v40, s2 src0_sel:BYTE_0 src1_sel:DWORD
    s_cbranch_vccnz L_hA_6_0
L_rA_6_0:
    v_cmp_eq_u32_sdwa vcc, v41, s2 src0_sel:BYTE_0 src1_sel:DWORD
    s_cbranch_vccnz L_hA_6_1
L_rA_6_1:
    v_cmp_eq_u32_sdwa vcc, v42, s2 src0_sel:BYTE_0 src1_sel:DWORD
    s_cbranch_vccnz L_hA_6_2
L_rA_6_2:
    v_cmp_eq_u32_sdwa vcc, v43, s2 src0_sel:BYTE_0 src1_sel:DWORD
    s_cbranch_vccnz L_hA_6_3
L_rA_6_3:
    buffer_load_dwordx4 v[40:43], v15, s[16:19], 0 offen offset:2048
    s_waitcnt vmcnt(7)
    v_cmp_eq_u32_sdwa vcc, v44, s2 src0_sel:BYTE_0 src1_sel:DWORD
    s_cbranch_vccnz L_hA_7_0
L_rA_7_0:
    v_cmp_eq_u32_sdwa vcc, v45, s2 src0_sel:BYTE_0 src1_sel:DWORD
    s_cbranch_vccnz L_hA_7_1
L_rA_7_1:
    v_cmp_eq_u32_sdwa vcc, v46, s2 src0_sel:BYTE_0 src1_sel:DWORD
    s_cbranch_vccnz L_hA_7_2
L_rA_7_2:
    v_cmp_eq_u32_sdwa vcc, v47, s2 src0_sel:BYTE_0 src1_sel:DWORD
    s_cbranch_vccnz L_hA_7_3
L_rA_7_3:
    buffer_load_dwordx4 v[44:47], v15, s[16:19], 0 offen offset:3072
    v_add_u32 v13, 0x2000, v13
    v_add_u32 v15, 0x2000, v15
    s_add_u32 s49, s49, 33554432
    s_sub_u32 s48, s48, 8
    s_branch L_scanA
L_scanB:
    s_cmp_eq_u32 s48, 0
    s_cbranch_scc1 L_scan_fin
    s_cmp_ge_u32 s48, 8
    s_cbranch_scc1 L_1
    s_waitcnt vmcnt(0)
L_1:
    s_waitcnt vmcnt(7)
    v_cmp_eq_u32_sdwa vcc, v16, s2 src0_sel:BYTE_0 src1_sel:DWORD
    s_cbranch_vccnz L_hB_0_0
L_rB_0_0:
    v_cmp_eq_u32_sdwa vcc, v17, s2 src0_sel:BYTE_0 src1_sel:DWORD
    s_cbranch_vccnz L_hB_0_1
L_rB_0_1:
    v_cmp_eq_u32_sdwa vcc, v18, s2 src0_sel:BYTE_0 src1_sel:DWORD
    s_cbranch_vccnz L_hB_0_2
L_rB_0_2:
    v_cmp_eq_u32_sdwa vcc, v19, s2 src0_sel:BYTE_0 src1_sel:DWORD
    s_cbranch_vccnz L_hB_0_3
L_rB_0_3:
    s_cmp_le_u32 s48, 8
    s_cbranch_scc1 L_2
    buffer_load_dwordx4 v[16:19], v13, s[16:19], 0 offen offset:0
L_2:
    s_sub_u32 s48, s48, 1
    s_cmp_eq_u32 s48, 0
    s_cbranch_scc1 L_scan_fin
    s_cmp_ge_u32 s48, 8
    s_cbranch_scc1 L_3
    s_waitcnt vmcnt(0)
L_3:
    s_waitcnt vmcnt(7)
    v_cmp_eq_u32_sdwa vcc, v20, s2 src0_sel:BYTE_0 src1_sel:DWORD
    s_cbranch_vccnz L_hB_1_0
L_rB_1_0:
    v_cmp_eq_u32_sdwa vcc, v21, s2 src0_sel:BYTE_0 src1_sel:DWORD
    s_cbranch_vccnz L_hB_1_1
L_rB_1_1:
    v_cmp_eq_u32_sdwa vcc, v22, s2 src0_sel:BYTE_0 src1_sel:DWORD
    s_cbranch_vccnz L_hB_1_2
L_rB_1_2:
    v_cmp_eq_u32_sdwa vcc, v23, s2 src0_sel:BYTE_0 src1_sel:DWORD
    s_cbranch_vccnz L_hB_1_3
L_rB_1_3:
    s_cmp_le_u32 s48, 8
    s_cbranch_scc1 L_4
    buffer_load_dwordx4 v[20:23], v13, s[16:19], 0 offen offset:1024
L_4:
    s_sub_u32 s48, s48, 1
    s_cmp_eq_u32 s48, 0
    s_cbranch_scc1 L_scan_fin
    s_cmp_ge_u32 s48, 8
    s_cbranch_scc1 L_5
    s_waitcnt vmcnt(0)
L_5:
    s_waitcnt vmcnt(7)
    v_cmp_eq_u32_sdwa vcc, v24, s2 src0_sel:BYTE_0 src1_sel:DWORD
    s_cbranch_vccnz L_hB_2_0
L_rB_2_0:
    v_cmp_eq_u32_sdwa vcc, v25, s2 src0_sel:BYTE_0 src1_sel:DWORD
    s_cbranch_vccnz L_hB_2_1
L_rB_2_1:
    v_cmp_eq_u32_sdwa vcc, v26, s2 src0_sel:BYTE_0 src1_sel:DWORD
    s_cbranch_vccnz L_hB_2_2
L_rB_2_2:
    v_cmp_eq_u32_sdwa vcc, v27, s2 src0_sel:BYTE_0 src1_sel:DWORD
    s_cbranch_vccnz L_hB_2_3
L_rB_2_3:
    s_cmp_le_u32 s48, 8
    s_cbranch_scc1 L_6
    buffer_load_dwordx4 v[24:27], v13, s[16:19], 0 offen offset:2048
L_6:
    s_sub_u32 s48, s48, 1
    s_cmp_eq_u32 s48, 0
    s_cbranch_scc1 L_scan_fin
    s_cmp_ge_u32 s48, 8
    s_cbranch_scc1 L_7
    s_waitcnt vmcnt(0)
L_7:
    s_waitcnt vmcnt(7)
    v_cmp_eq_u32_sdwa vcc, v28, s2 src0_sel:BYTE_0 src1_sel:DWORD
    s_cbranch_vccnz L_hB_3_0
L_rB_3_0:
    v_cmp_eq_u32_sdwa vcc, v29, s2 src0_sel:BYTE_0 src1_sel:DWORD
    s_cbranch_vccnz L_hB_3_1
L_rB_3_1:
    v_cmp_eq_u32_sdwa vcc, v30, s2 src0_sel:BYTE_0 src1_sel:DWORD
    s_cbranch_vccnz L_hB_3_2
L_rB_3_2:
    v_cmp_eq_u32_sdwa vcc, v31, s2 src0_sel:BYTE_0 src1_sel:DWORD
    s_cbranch_vccnz L_hB_3_3
L_rB_3_3:
    s_cmp_le_u32 s48, 8
    s_cbranch_scc1 L_8
    buffer_load_dwordx4 v[28:31], v13, s[16:19], 0 offen offset:3072
L_8:
    s_sub_u32 s48, s48, 1
    s_cmp_eq_u32 s48, 0
    s_cbranch_scc1 L_scan_fin
    s_cmp_ge_u32 s48, 8
    s_cbranch_scc1 L_9
    s_waitcnt vmcnt(0)
L_9:
    s_waitcnt vmcnt(7)
    v_cmp_eq_u32_sdwa vcc, v32, s2 src0_sel:BYTE_0 src1_sel:DWORD
    s_cbranch_vccnz L_hB_4_0
L_rB_4_0:
    v_cmp_eq_u32_sdwa vcc, v33, s2 src0_sel:BYTE_0 src1_sel:DWORD
    s_cbranch_vccnz L_hB_4_1
L_rB_4_1:
    v_cmp_eq_u32_sdwa vcc, v34, s2 src0_sel:BYTE_0 src1_sel:DWORD
    s_cbranch_vccnz L_hB_4_2
L_rB_4_2:
    v_cmp_eq_u32_sdwa vcc, v35, s2 src0_sel:BYTE_0 src1_sel:DWORD
    s_cbranch_vccnz L_hB_4_3
L_rB_4_3:
    s_cmp_le_u32 s48, 8
    s_cbranch_scc1 L_10
    buffer_load_dwordx4 v[32:35], v15, s[16:19], 0 offen offset:0
L_10:
    s_sub_u32 s48, s48, 1
    s_cmp_eq_u32 s48, 0
    s_cbranch_scc1 L_scan_fin
    s_cmp_ge_u32 s48, 8
    s_cbranch_scc1 L_11
    s_waitcnt vmcnt(0)
L_11:
    s_waitcnt vmcnt(7)
    v_cmp_eq_u32_sdwa vcc, v36, s2 src0_sel:BYTE_0 src1_sel:DWORD
    s_cbranch_vccnz L_hB_5_0
L_rB_5_0:
    v_cmp_eq_u32_sdwa vcc, v37, s2 src0_sel:BYTE_0 src1_sel:DWORD
    s_cbranch_vccnz L_hB_5_1
L_rB_5_1:
    v_cmp_eq_u32_sdwa vcc, v38, s2 src0_sel:BYTE_0 src1_sel:DWORD
    s_cbranch_vccnz L_hB_5_2
L_rB_5_2:
    v_cmp_eq_u32_sdwa vcc, v39, s2 src0_sel:BYTE_0 src1_sel:DWORD
    s_cbranch_vccnz L_hB_5_3
L_rB_5_3:
    s_cmp_le_u32 s48, 8
    s_cbranch_scc1 L_12
    buffer_load_dwordx4 v[36:39], v15, s[16:19], 0 offen offset:1024
L_12:
    s_sub_u32 s48, s48, 1
    s_cmp_eq_u32 s48, 0
    s_cbranch_scc1 L_scan_fin
    s_cmp_ge_u32 s48, 8
    s_cbranch_scc1 L_13
    s_waitcnt vmcnt(0)
L_13:
    s_waitcnt vmcnt(7)
    v_cmp_eq_u32_sdwa vcc, v40, s2 src0_sel:BYTE_0 src1_sel:DWORD
    s_cbranch_vccnz L_hB_6_0
L_rB_6_0:
    v_cmp_eq_u32_sdwa vcc, v41, s2 src0_sel:BYTE_0 src1_sel:DWORD
    s_cbranch_vccnz L_hB_6_1
L_rB_6_1:
    v_cmp_eq_u32_sdwa vcc, v42, s2 src0_sel:BYTE_0 src1_sel:DWORD
    s_cbranch_vccnz L_hB_6_2
L_rB_6_2:
    v_cmp_eq_u32_sdwa vcc, v43, s2 src0_sel:BYTE_0 src1_sel:DWORD
    s_cbranch_vccnz L_hB_6_3
L_rB_6_3:
    s_cmp_le_u32 s48, 8
    s_cbranch_scc1 L_14
    buffer_load_dwordx4 v[40:43], v15, s[16:19], 0 offen offset:2048
L_14:
    s_sub_u32 s48, s48, 1
    s_cmp_eq_u32 s48, 0
    s_cbranch_scc1 L_scan_fin
    s_cmp_ge_u32 s48, 8
    s_cbranch_scc1 L_15
    s_waitcnt vmcnt(0)
L_15:
    s_waitcnt vmcnt(7)
    v_cmp_eq_u32_sdwa vcc, v44, s2 src0_sel:BYTE_0 src1_sel:DWORD
    s_cbranch_vccnz L_hB_7_0
L_rB_7_0:
    v_cmp_eq_u32_sdwa vcc, v45, s2 src0_sel:BYTE_0 src1_sel:DWORD
    s_cbranch_vccnz L_hB_7_1
L_rB_7_1:
    v_cmp_eq_u32_sdwa vcc, v46, s2 src0_sel:BYTE_0 src1_sel:DWORD
    s_cbranch_vccnz L_hB_7_2
L_rB_7_2:
    v_cmp_eq_u32_sdwa vcc, v47, s2 src0_sel:BYTE_0 src1_sel:DWORD
    s_cbranch_vccnz L_hB_7_3
L_rB_7_3:
    s_cmp_le_u32 s48, 8
    s_cbranch_scc1 L_16
    buffer_load_dwordx4 v[44:47], v15, s[16:19], 0 offen offset:3072
L_16:
    s_sub_u32 s48, s48, 1
    s_add_u32 s49, s49, 33554432
    s_branch L_scanB
L_hA_0_0:
    s_bcnt1_i32_b64 s53, vcc
    s_lshl2_add_u32 s54, s53, s50
    s_cmp_gt_u32 s54, s51
    s_cbranch_scc1 L_ovf_0_0
    v_mbcnt_lo_u32_b32 v48, vcc_lo, 0
    v_mbcnt_hi_u32_b32 v48, vcc_hi, v48
    s_add_u32 s55, s49, 0
    v_lshl_add_u32 v48, v48, 2, s50
    v_add3_u32 v49, v16, v14, s55
    s_mov_b64 exec, vcc
    ds_write_b32 v48, v49
    s_mov_b64 exec, -1
    s_mov_b32 s50, s54
    s_branch L_rA_0_0
L_hA_0_1:
    s_bcnt1_i32_b64 s53, vcc
    s_lshl2_add_u32 s54, s53, s50
    s_cmp_gt_u32 s54, s51
    s_cbranch_scc1 L_ovf_0_1
    v_mbcnt_lo_u32_b32 v48, vcc_lo, 0
    v_mbcnt_hi_u32_b32 v48, vcc_hi, v48
    s_add_u32 s55, s49, 16384
    v_lshl_add_u32 v48, v48, 2, s50
    v_add3_u32 v49, v17, v14, s55
    s_mov_b64 exec, vcc
    ds_write_b32 v48, v49
    s_mov_b64 exec, -1
    s_mov_b32 s50, s54
    s_branch L_rA_0_1
L_hA_0_2:
    s_bcnt1_i32_b64 s53, vcc
    s_lshl2_add_u32 s54, s53, s50
    s_cmp_gt_u32 s54, s51
    s_cbranch_scc1 L_ovf_0_2
    v_mbcnt_lo_u32_b32 v48, vcc_lo, 0
    v_mbcnt_hi_u32_b32 v48, vcc_hi, v48
    s_add_u32 s55, s49, 32768
    v_lshl_add_u32 v48, v48, 2, s50
    v_add3_u32 v49, v18, v14, s55
    s_mov_b64 exec, vcc
    ds_write_b32 v48, v49
    s_mov_b64 exec, -1
    s_mov_b32 s50, s54
    s_branch L_rA_0_2
L_hA_0_3:
    s_bcnt1_i32_b64 s53, vcc
    s_lshl2_add_u32 s54, s53, s50
    s_cmp_gt_u32 s54, s51
    s_cbranch_scc1 L_ovf_0_3
    v_mbcnt_lo_u32_b32 v48, vcc_lo, 0
    v_mbcnt_hi_u32_b32 v48, vcc_hi, v48
    s_add_u32 s55, s49, 49152
    v_lshl_add_u32 v48, v48, 2, s50
    v_add3_u32 v49, v19, v14, s55
    s_mov_b64 exec, vcc
    ds_write_b32 v48, v49
    s_mov_b64 exec, -1
    s_mov_b32 s50, s54
    s_branch L_rA_0_3
L_hA_1_0:
    s_bcnt1_i32_b64 s53, vcc
    s_lshl2_add_u32 s54, s53, s50
    s_cmp_gt_u32 s54, s51
    s_cbranch_scc1 L_ovf_1_0
    v_mbcnt_lo_u32_b32 v48, vcc_lo, 0
    v_mbcnt_hi_u32_b32 v48, vcc_hi, v48
    s_add_u32 s55, s49, 4194304
    v_lshl_add_u32 v48, v48, 2, s50
    v_add3_u32 v49, v20, v14, s55
    s_mov_b64 exec, vcc
    ds_write_b32 v48, v49
    s_mov_b64 exec, -1
    s_mov_b32 s50, s54
    s_branch L_rA_1_0
L_hA_1_1:
    s_bcnt1_i32_b64 s53, vcc
    s_lshl2_add_u32 s54, s53, s50
    s_cmp_gt_u32 s54, s51
    s_cbranch_scc1 L_ovf_1_1
    v_mbcnt_lo_u32_b32 v48, vcc_lo, 0
    v_mbcnt_hi_u32_b32 v48, vcc_hi, v48
    s_add_u32 s55, s49, 4210688
    v_lshl_add_u32 v48, v48, 2, s50
    v_add3_u32 v49, v21, v14, s55
    s_mov_b64 exec, vcc
    ds_write_b32 v48, v49
    s_mov_b64 exec, -1
    s_mov_b32 s50, s54
    s_branch L_rA_1_1
L_hA_1_2:
    s_bcnt1_i32_b64 s53, vcc
    s_lshl2_add_u32 s54, s53, s50
    s_cmp_gt_u32 s54, s51
    s_cbranch_scc1 L_ovf_1_2
    v_mbcnt_lo_u32_b32 v48, vcc_lo, 0
    v_mbcnt_hi_u32_b32 v48, vcc_hi, v48
    s_add_u32 s55, s49, 4227072
    v_lshl_add_u32 v48, v48, 2, s50
    v_add3_u32 v49, v22, v14, s55
    s_mov_b64 exec, vcc
    ds_write_b32 v48, v49
    s_mov_b64 exec, -1
    s_mov_b32 s50, s54
    s_branch L_rA_1_2
L_hA_1_3:
    s_bcnt1_i32_b64 s53, vcc
    s_lshl2_add_u32 s54, s53, s50
    s_cmp_gt_u32 s54, s51
    s_cbranch_scc1 L_ovf_1_3
    v_mbcnt_lo_u32_b32 v48, vcc_lo, 0
    v_mbcnt_hi_u32_b32 v48, vcc_hi, v48
    s_add_u32 s55, s49, 4243456
    v_lshl_add_u32 v48, v48, 2, s50
    v_add3_u32 v49, v23, v14, s55
    s_mov_b64 exec, vcc
    ds_write_b32 v48, v49
    s_mov_b64 exec, -1
    s_mov_b32 s50, s54
    s_branch L_rA_1_3
L_hA_2_0:
    s_bcnt1_i32_b64 s53, vcc
    s_lshl2_add_u32 s54, s53, s50
    s_cmp_gt_u32 s54, s51
    s_cbranch_scc1 L_ovf_2_0
    v_mbcnt_lo_u32_b32 v48, vcc_lo, 0
    v_mbcnt_hi_u32_b32 v48, vcc_hi, v48
    s_add_u32 s55, s49, 8388608
    v_lshl_add_u32 v48, v48, 2, s50
    v_add3_u32 v49, v24, v14, s55
    s_mov_b64 exec, vcc
    ds_write_b32 v48, v49
    s_mov_b64 exec, -1
    s_mov_b32 s50, s54
    s_branch L_rA_2_0
L_hA_2_1:
    s_bcnt1_i32_b64 s53, vcc
    s_lshl2_add_u32 s54, s53, s50
    s_cmp_gt_u32 s54, s51
    s_cbranch_scc1 L_ovf_2_1
    v_mbcnt_lo_u32_b32 v48, vcc_lo, 0
    v_mbcnt_hi_u32_b32 v48, vcc_hi, v48
    s_add_u32 s55, s49, 8404992
    v_lshl_add_u32 v48, v48, 2, s50
    v_add3_u32 v49, v25, v14, s55
    s_mov_b64 exec, vcc
    ds_write_b32 v48, v49
    s_mov_b64 exec, -1
    s_mov_b32 s50, s54
    s_branch L_rA_2_1
L_hA_2_2:
    s_bcnt1_i32_b64 s53, vcc
    s_lshl2_add_u32 s54, s53, s50
    s_cmp_gt_u32 s54, s51
    s_cbranch_scc1 L_ovf_2_2
    v_mbcnt_lo_u32_b32 v48, vcc_lo, 0
    v_mbcnt_hi_u32_b32 v48, vcc_hi, v48
    s_add_u32 s55, s49, 8421376
    v_lshl_add_u32 v48, v48, 2, s50
    v_add3_u32 v49, v26, v14, s55
    s_mov_b64 exec, vcc
    ds_write_b32 v48, v49
    s_mov_b64 exec, -1
    s_mov_b32 s50, s54
    s_branch L_rA_2_2
L_hA_2_3:
    s_bcnt1_i32_b64 s53, vcc
    s_lshl2_add_u32 s54, s53, s50
    s_cmp_gt_u32 s54, s51
    s_cbranch_scc1 L_ovf_2_3
    v_mbcnt_lo_u32_b32 v48, vcc_lo, 0
    v_mbcnt_hi_u32_b32 v48, vcc_hi, v48
    s_add_u32 s55, s49, 8437760
    v_lshl_add_u32 v48, v48, 2, s50
    v_add3_u32 v49, v27, v14, s55
    s_mov_b64 exec, vcc
    ds_write_b32 v48, v49
    s_mov_b64 exec, -1
    s_mov_b32 s50, s54
    s_branch L_rA_2_3
L_hA_3_0:
    s_bcnt1_i32_b64 s53, vcc
    s_lshl2_add_u32 s54, s53, s50
    s_cmp_gt_u32 s54, s51
    s_cbranch_scc1 L_ovf_3_0
    v_mbcnt_lo_u32_b32 v48, vcc_lo, 0
    v_mbcnt_hi_u32_b32 v48, vcc_hi, v48
    s_add_u32 s55, s49, 12582912
    v_lshl_add_u32 v48, v48, 2, s50
    v_add3_u32 v49, v28, v14, s55
    s_mov_b64 exec, vcc
    ds_write_b32 v48, v49
    s_mov_b64 exec, -1
    s_mov_b32 s50, s54
    s_branch L_rA_3_0
L_hA_3_1:
    s_bcnt1_i32_b64 s53, vcc
    s_lshl2_add_u32 s54, s53, s50
    s_cmp_gt_u32 s54, s51
    s_cbranch_scc1 L_ovf_3_1
    v_mbcnt_lo_u32_b32 v48, vcc_lo, 0
    v_mbcnt_hi_u32_b32 v48, vcc_hi, v48
    s_add_u32 s55, s49, 12599296
    v_lshl_add_u32 v48, v48, 2, s50
    v_add3_u32 v49, v29, v14, s55
    s_mov_b64 exec, vcc
    ds_write_b32 v48, v49
    s_mov_b64 exec, -1
    s_mov_b32 s50, s54
    s_branch L_rA_3_1
L_hA_3_2:
    s_bcnt1_i32_b64 s53, vcc
    s_lshl2_add_u32 s54, s53, s50
    s_cmp_gt_u32 s54, s51
    s_cbranch_scc1 L_ovf_3_2
    v_mbcnt_lo_u32_b32 v48, vcc_lo, 0
    v_mbcnt_hi_u32_b32 v48, vcc_hi, v48
    s_add_u32 s55, s49, 12615680
    v_lshl_add_u32 v48, v48, 2, s50
    v_add3_u32 v49, v30, v14, s55
    s_mov_b64 exec, vcc
    ds_write_b32 v48, v49
    s_mov_b64 exec, -1
    s_mov_b32 s50, s54
    s_branch L_rA_3_2
L_hA_3_3:
    s_bcnt1_i32_b64 s53, vcc
    s_lshl2_add_u32 s54, s53, s50
    s_cmp_gt_u32 s54, s51
    s_cbranch_scc1 L_ovf_3_3
    v_mbcnt_lo_u32_b32 v48, vcc_lo, 0
    v_mbcnt_hi_u32_b32 v48, vcc_hi, v48
    s_add_u32 s55, s49, 12632064
    v_lshl_add_u32 v48, v48, 2, s50
    v_add3_u32 v49, v31, v14, s55
    s_mov_b64 exec, vcc
    ds_write_b32 v48, v49
    s_mov_b64 exec, -1
    s_mov_b32 s50, s54
    s_branch L_rA_3_3
L_hA_4_0:
    s_bcnt1_i32_b64 s53, vcc
    s_lshl2_add_u32 s54, s53, s50
    s_cmp_gt_u32 s54, s51
    s_cbranch_scc1 L_ovf_4_0
    v_mbcnt_lo_u32_b32 v48, vcc_lo, 0
    v_mbcnt_hi_u32_b32 v48, vcc_hi, v48
    s_add_u32 s55, s49, 16777216
    v_lshl_add_u32 v48, v48, 2, s50
    v_add3_u32 v49, v32, v14, s55
    s_mov_b64 exec, vcc
    ds_write_b32 v48, v49
    s_mov_b64 exec, -1
    s_mov_b32 s50, s54
    s_branch L_rA_4_0
L_hA_4_1:
    s_bcnt1_i32_b64 s53, vcc
    s_lshl2_add_u32 s54, s53, s50
    s_cmp_gt_u32 s54, s51
    s_cbranch_scc1 L_ovf_4_1
    v_mbcnt_lo_u32_b32 v48, vcc_lo, 0
    v_mbcnt_hi_u32_b32 v48, vcc_hi, v48
    s_add_u32 s55, s49, 16793600
    v_lshl_add_u32 v48, v48, 2, s50
    v_add3_u32 v49, v33, v14, s55
    s_mov_b64 exec, vcc
    ds_write_b32 v48, v49
    s_mov_b64 exec, -1
    s_mov_b32 s50, s54
    s_branch L_rA_4_1
L_hA_4_2:
    s_bcnt1_i32_b64 s53, vcc
    s_lshl2_add_u32 s54, s53, s50
    s_cmp_gt_u32 s54, s51
    s_cbranch_scc1 L_ovf_4_2
    v_mbcnt_lo_u32_b32 v48, vcc_lo, 0
    v_mbcnt_hi_u32_b32 v48, vcc_hi, v48
    s_add_u32 s55, s49, 16809984
    v_lshl_add_u32 v48, v48, 2, s50
    v_add3_u32 v49, v34, v14, s55
    s_mov_b64 exec, vcc
    ds_write_b32 v48, v49
    s_mov_b64 exec, -1
    s_mov_b32 s50, s54
    s_branch L_rA_4_2
L_hA_4_3:
    s_bcnt1_i32_b64 s53, vcc
    s_lshl2_add_u32 s54, s53, s50
    s_cmp_gt_u32 s54, s51
    s_cbranch_scc1 L_ovf_4_3
    v_mbcnt_lo_u32_b32 v48, vcc_lo, 0
    v_mbcnt_hi_u32_b32 v48, vcc_hi, v48
    s_add_u32 s55, s49, 16826368
    v_lshl_add_u32 v48, v48, 2, s50
    v_add3_u32 v49, v35, v14, s55
    s_mov_b64 exec, vcc
    ds_write_b32 v48, v49
    s_mov_b64 exec, -1
    s_mov_b32 s50, s54
    s_branch L_rA_4_3
L_hA_5_0:
    s_bcnt1_i32_b64 s53, vcc
    s_lshl2_add_u32 s54, s53, s50
    s_cmp_gt_u32 s54, s51
    s_cbranch_scc1 L_ovf_5_0
    v_mbcnt_lo_u32_b32 v48, vcc_lo, 0
    v_mbcnt_hi_u32_b32 v48, vcc_hi, v48
    s_add_u32 s55, s49, 20971520
    v_lshl_add_u32 v48, v48, 2, s50
    v_add3_u32 v49, v36, v14, s55
    s_mov_b64 exec, vcc
    ds_write_b32 v48, v49
    s_mov_b64 exec, -1
    s_mov_b32 s50, s54
    s_branch L_rA_5_0
L_hA_5_1:
    s_bcnt1_i32_b64 s53, vcc
    s_lshl2_add_u32 s54, s53, s50
    s_cmp_gt_u32 s54, s51
    s_cbranch_scc1 L_ovf_5_1
    v_mbcnt_lo_u32_b32 v48, vcc_lo, 0
    v_mbcnt_hi_u32_b32 v48, vcc_hi, v48
    s_add_u32 s55, s49, 20987904
    v_lshl_add_u32 v48, v48, 2, s50
    v_add3_u32 v49, v37, v14, s55
    s_mov_b64 exec, vcc
    ds_write_b32 v48, v49
    s_mov_b64 exec, -1
    s_mov_b32 s50, s54
    s_branch L_rA_5_1
L_hA_5_2:
    s_bcnt1_i32_b64 s53, vcc
    s_lshl2_add_u32 s54, s53, s50
    s_cmp_gt_u32 s54, s51
    s_cbranch_scc1 L_ovf_5_2
    v_mbcnt_lo_u32_b32 v48, vcc_lo, 0
    v_mbcnt_hi_u32_b32 v48, vcc_hi, v48
    s_add_u32 s55, s49, 21004288
    v_lshl_add_u32 v48, v48, 2, s50
    v_add3_u32 v49, v38, v14, s55
    s_mov_b64 exec, vcc
    ds_write_b32 v48, v49
    s_mov_b64 exec, -1
    s_mov_b32 s50, s54
    s_branch L_rA_5_2
L_hA_5_3:
    s_bcnt1_i32_b64 s53, vcc
    s_lshl2_add_u32 s54, s53, s50
    s_cmp_gt_u32 s54, s51
    s_cbranch_scc1 L_ovf_5_3
    v_mbcnt_lo_u32_b32 v48, vcc_lo, 0
    v_mbcnt_hi_u32_b32 v48, vcc_hi, v48
    s_add_u32 s55, s49, 21020672
    v_lshl_add_u32 v48, v48, 2, s50
    v_add3_u32 v49, v39, v14, s55
    s_mov_b64 exec, vcc
    ds_write_b32 v48, v49
    s_mov_b64 exec, -1
    s_mov_b32 s50, s54
    s_branch L_rA_5_3
L_hA_6_0:
    s_bcnt1_i32_b64 s53, vcc
    s_lshl2_add_u32 s54, s53, s50
    s_cmp_gt_u32 s54, s51
    s_cbranch_scc1 L_ovf_6_0
    v_mbcnt_lo_u32_b32 v48, vcc_lo, 0
    v_mbcnt_hi_u32_b32 v48, vcc_hi, v48
    s_add_u32 s55, s49, 25165824
    v_lshl_add_u32 v48, v48, 2, s50
    v_add3_u32 v49, v40, v14, s55
    s_mov_b64 exec, vcc
    ds_write_b32 v48, v49
    s_mov_b64 exec, -1
    s_mov_b32 s50, s54
    s_branch L_rA_6_0
L_hA_6_1:
    s_bcnt1_i32_b64 s53, vcc
    s_lshl2_add_u32 s54, s53, s50
    s_cmp_gt_u32 s54, s51
    s_cbranch_scc1 L_ovf_6_1
    v_mbcnt_lo_u32_b32 v48, vcc_lo, 0
    v_mbcnt_hi_u32_b32 v48, vcc_hi, v48
    s_add_u32 s55, s49, 25182208
    v_lshl_add_u32 v48, v48, 2, s50
    v_add3_u32 v49, v41, v14, s55
    s_mov_b64 exec, vcc
    ds_write_b32 v48, v49
    s_mov_b64 exec, -1
    s_mov_b32 s50, s54
    s_branch L_rA_6_1
L_hA_6_2:
    s_bcnt1_i32_b64 s53, vcc
    s_lshl2_add_u32 s54, s53, s50
    s_cmp_gt_u32 s54, s51
    s_cbranch_scc1 L_ovf_6_2
    v_mbcnt_lo_u32_b32 v48, vcc_lo, 0
    v_mbcnt_hi_u32_b32 v48, vcc_hi, v48
    s_add_u32 s55, s49, 25198592
    v_lshl_add_u32 v48, v48, 2, s50
    v_add3_u32 v49, v42, v14, s55
    s_mov_b64 exec, vcc
    ds_write_b32 v48, v49
    s_mov_b64 exec, -1
    s_mov_b32 s50, s54
    s_branch L_rA_6_2
L_hA_6_3:
    s_bcnt1_i32_b64 s53, vcc
    s_lshl2_add_u32 s54, s53, s50
    s_cmp_gt_u32 s54, s51
    s_cbranch_scc1 L_ovf_6_3
    v_mbcnt_lo_u32_b32 v48, vcc_lo, 0
    v_mbcnt_hi_u32_b32 v48, vcc_hi, v48
    s_add_u32 s55, s49, 25214976
    v_lshl_add_u32 v48, v48, 2, s50
    v_add3_u32 v49, v43, v14, s55
    s_mov_b64 exec, vcc
    ds_write_b32 v48, v49
    s_mov_b64 exec, -1
    s_mov_b32 s50, s54
    s_branch L_rA_6_3
L_hA_7_0:
    s_bcnt1_i32_b64 s53, vcc
    s_lshl2_add_u32 s54, s53, s50
    s_cmp_gt_u32 s54, s51
    s_cbranch_scc1 L_ovf_7_0
    v_mbcnt_lo_u32_b32 v48, vcc_lo, 0
    v_mbcnt_hi_u32_b32 v48, vcc_hi, v48
    s_add_u32 s55, s49, 29360128
    v_lshl_add_u32 v48, v48, 2, s50
    v_add3_u32 v49, v44, v14, s55
    s_mov_b64 exec, vcc
    ds_write_b32 v48, v49
    s_mov_b64 exec, -1
    s_mov_b32 s50, s54
    s_branch L_rA_7_0
L_hA_7_1:
    s_bcnt1_i32_b64 s53, vcc
    s_lshl2_add_u32 s54, s53, s50
    s_cmp_gt_u32 s54, s51
    s_cbranch_scc1 L_ovf_7_1
    v_mbcnt_lo_u32_b32 v48, vcc_lo, 0
    v_mbcnt_hi_u32_b32 v48, vcc_hi, v48
    s_add_u32 s55, s49, 29376512
    v_lshl_add_u32 v48, v48, 2, s50
    v_add3_u32 v49, v45, v14, s55
    s_mov_b64 exec, vcc
    ds_write_b32 v48, v49
    s_mov_b64 exec, -1
    s_mov_b32 s50, s54
    s_branch L_rA_7_1
L_hA_7_2:
    s_bcnt1_i32_b64 s53, vcc
    s_lshl2_add_u32 s54, s53, s50
    s_cmp_gt_u32 s54, s51
    s_cbranch_scc1 L_ovf_7_2
    v_mbcnt_lo_u32_b32 v48, vcc_lo, 0
    v_mbcnt_hi_u32_b32 v48, vcc_hi, v48
    s_add_u32 s55, s49, 29392896
    v_lshl_add_u32 v48, v48, 2, s50
    v_add3_u32 v49, v46, v14, s55
    s_mov_b64 exec, vcc
    ds_write_b32 v48, v49
    s_mov_b64 exec, -1
    s_mov_b32 s50, s54
    s_branch L_rA_7_2
L_hA_7_3:
    s_bcnt1_i32_b64 s53, vcc
    s_lshl2_add_u32 s54, s53, s50
    s_cmp_gt_u32 s54, s51
    s_cbranch_scc1 L_ovf_7_3
    v_mbcnt_lo_u32_b32 v48, vcc_lo, 0
    v_mbcnt_hi_u32_b32 v48, vcc_hi, v48
    s_add_u32 s55, s49, 29409280
    v_lshl_add_u32 v48, v48, 2, s50
    v_add3_u32 v49, v47, v14, s55
    s_mov_b64 exec, vcc
    ds_write_b32 v48, v49
    s_mov_b64 exec, -1
    s_mov_b32 s50, s54
    s_branch L_rA_7_3
L_hB_0_0:
    s_bcnt1_i32_b64 s53, vcc
    s_lshl2_add_u32 s54, s53, s50
    s_cmp_gt_u32 s54, s51
    s_cbranch_scc1 L_ovf_0_0
    v_mbcnt_lo_u32_b32 v48, vcc_lo, 0
    v_mbcnt_hi_u32_b32 v48, vcc_hi, v48
    s_add_u32 s55, s49, 0
    v_lshl_add_u32 v48, v48, 2, s50
    v_add3_u32 v49, v16, v14, s55
    s_mov_b64 exec, vcc
    ds_write_b32 v48, v49
    s_mov_b64 exec, -1
    s_mov_b32 s50, s54
    s_branch L_rB_0_0
L_hB_0_1:
    s_bcnt1_i32_b64 s53, vcc
    s_lshl2_add_u32 s54, s53, s50
    s_cmp_gt_u32 s54, s51
    s_cbranch_scc1 L_ovf_0_1
    v_mbcnt_lo_u32_b32 v48, vcc_lo, 0
    v_mbcnt_hi_u32_b32 v48, vcc_hi, v48
    s_add_u32 s55, s49, 16384
    v_lshl_add_u32 v48, v48, 2, s50
    v_add3_u32 v49, v17, v14, s55
    s_mov_b64 exec, vcc
    ds_write_b32 v48, v49
    s_mov_b64 exec, -1
    s_mov_b32 s50, s54
    s_branch L_rB_0_1
L_hB_0_2:
    s_bcnt1_i32_b64 s53, vcc
    s_lshl2_add_u32 s54, s53, s50
    s_cmp_gt_u32 s54, s51
    s_cbranch_scc1 L_ovf_0_2
    v_mbcnt_lo_u32_b32 v48, vcc_lo, 0
    v_mbcnt_hi_u32_b32 v48, vcc_hi, v48
    s_add_u32 s55, s49, 32768
    v_lshl_add_u32 v48, v48, 2, s50
    v_add3_u32 v49, v18, v14, s55
    s_mov_b64 exec, vcc
    ds_write_b32 v48, v49
    s_mov_b64 exec, -1
    s_mov_b32 s50, s54
    s_branch L_rB_0_2
L_hB_0_3:
    s_bcnt1_i32_b64 s53, vcc
    s_lshl2_add_u32 s54, s53, s50
    s_cmp_gt_u32 s54, s51
    s_cbranch_scc1 L_ovf_0_3
    v_mbcnt_lo_u32_b32 v48, vcc_lo, 0
    v_mbcnt_hi_u32_b32 v48, vcc_hi, v48
    s_add_u32 s55, s49, 49152
    v_lshl_add_u32 v48, v48, 2, s50
    v_add3_u32 v49, v19, v14, s55
    s_mov_b64 exec, vcc
    ds_write_b32 v48, v49
    s_mov_b64 exec, -1
    s_mov_b32 s50, s54
    s_branch L_rB_0_3
L_hB_1_0:
    s_bcnt1_i32_b64 s53, vcc
    s_lshl2_add_u32 s54, s53, s50
    s_cmp_gt_u32 s54, s51
    s_cbranch_scc1 L_ovf_1_0
    v_mbcnt_lo_u32_b32 v48, vcc_lo, 0
    v_mbcnt_hi_u32_b32 v48, vcc_hi, v48
    s_add_u32 s55, s49, 4194304
    v_lshl_add_u32 v48, v48, 2, s50
    v_add3_u32 v49, v20, v14, s55
    s_mov_b64 exec, vcc
    ds_write_b32 v48, v49
    s_mov_b64 exec, -1
    s_mov_b32 s50, s54
    s_branch L_rB_1_0
L_hB_1_1:
    s_bcnt1_i32_b64 s53, vcc
    s_lshl2_add_u32 s54, s53, s50
    s_cmp_gt_u32 s54, s51
    s_cbranch_scc1 L_ovf_1_1
    v_mbcnt_lo_u32_b32 v48, vcc_lo, 0
    v_mbcnt_hi_u32_b32 v48, vcc_hi, v48
    s_add_u32 s55, s49, 4210688
    v_lshl_add_u32 v48, v48, 2, s50
    v_add3_u32 v49, v21, v14, s55
    s_mov_b64 exec, vcc
    ds_write_b32 v48, v49
    s_mov_b64 exec, -1
    s_mov_b32 s50, s54
    s_branch L_rB_1_1
L_hB_1_2:
    s_bcnt1_i32_b64 s53, vcc
    s_lshl2_add_u32 s54, s53, s50
    s_cmp_gt_u32 s54, s51
    s_cbranch_scc1 L_ovf_1_2
    v_mbcnt_lo_u32_b32 v48, vcc_lo, 0
    v_mbcnt_hi_u32_b32 v48, vcc_hi, v48
    s_add_u32 s55, s49, 4227072
    v_lshl_add_u32 v48, v48, 2, s50
    v_add3_u32 v49, v22, v14, s55
    s_mov_b64 exec, vcc
    ds_write_b32 v48, v49
    s_mov_b64 exec, -1
    s_mov_b32 s50, s54
    s_branch L_rB_1_2
L_hB_1_3:
    s_bcnt1_i32_b64 s53, vcc
    s_lshl2_add_u32 s54, s53, s50
    s_cmp_gt_u32 s54, s51
    s_cbranch_scc1 L_ovf_1_3
    v_mbcnt_lo_u32_b32 v48, vcc_lo, 0
    v_mbcnt_hi_u32_b32 v48, vcc_hi, v48
    s_add_u32 s55, s49, 4243456
    v_lshl_add_u32 v48, v48, 2, s50
    v_add3_u32 v49, v23, v14, s55
    s_mov_b64 exec, vcc
    ds_write_b32 v48, v49
    s_mov_b64 exec, -1
    s_mov_b32 s50, s54
    s_branch L_rB_1_3
L_hB_2_0:
    s_bcnt1_i32_b64 s53, vcc
    s_lshl2_add_u32 s54, s53, s50
    s_cmp_gt_u32 s54, s51
    s_cbranch_scc1 L_ovf_2_0
    v_mbcnt_lo_u32_b32 v48, vcc_lo, 0
    v_mbcnt_hi_u32_b32 v48, vcc_hi, v48
    s_add_u32 s55, s49, 8388608
    v_lshl_add_u32 v48, v48, 2, s50
    v_add3_u32 v49, v24, v14, s55
    s_mov_b64 exec, vcc
    ds_write_b32 v48, v49
    s_mov_b64 exec, -1
    s_mov_b32 s50, s54
    s_branch L_rB_2_0
L_hB_2_1:
    s_bcnt1_i32_b64 s53, vcc
    s_lshl2_add_u32 s54, s53, s50
    s_cmp_gt_u32 s54, s51
    s_cbranch_scc1 L_ovf_2_1
    v_mbcnt_lo_u32_b32 v48, vcc_lo, 0
    v_mbcnt_hi_u32_b32 v48, vcc_hi, v48
    s_add_u32 s55, s49, 8404992
    v_lshl_add_u32 v48, v48, 2, s50
    v_add3_u32 v49, v25, v14, s55
    s_mov_b64 exec, vcc
    ds_write_b32 v48, v49
    s_mov_b64 exec, -1
    s_mov_b32 s50, s54
    s_branch L_rB_2_1
L_hB_2_2:
    s_bcnt1_i32_b64 s53, vcc
    s_lshl2_add_u32 s54, s53, s50
    s_cmp_gt_u32 s54, s51
    s_cbranch_scc1 L_ovf_2_2
    v_mbcnt_lo_u32_b32 v48, vcc_lo, 0
    v_mbcnt_hi_u32_b32 v48, vcc_hi, v48
    s_add_u32 s55, s49, 8421376
    v_lshl_add_u32 v48, v48, 2, s50
    v_add3_u32 v49, v26, v14, s55
    s_mov_b64 exec, vcc
    ds_write_b32 v48, v49
    s_mov_b64 exec, -1
    s_mov_b32 s50, s54
    s_branch L_rB_2_2
L_hB_2_3:
    s_bcnt1_i32_b64 s53, vcc
    s_lshl2_add_u32 s54, s53, s50
    s_cmp_gt_u32 s54, s51
    s_cbranch_scc1 L_ovf_2_3
    v_mbcnt_lo_u32_b32 v48, vcc_lo, 0
    v_mbcnt_hi_u32_b32 v48, vcc_hi, v48
    s_add_u32 s55, s49, 8437760
    v_lshl_add_u32 v48, v48, 2, s50
    v_add3_u32 v49, v27, v14, s55
    s_mov_b64 exec, vcc
    ds_write_b32 v48, v49
    s_mov_b64 exec, -1
    s_mov_b32 s50, s54
    s_branch L_rB_2_3
L_hB_3_0:
    s_bcnt1_i32_b64 s53, vcc
    s_lshl2_add_u32 s54, s53, s50
    s_cmp_gt_u32 s54, s51
    s_cbranch_scc1 L_ovf_3_0
    v_mbcnt_lo_u32_b32 v48, vcc_lo, 0
    v_mbcnt_hi_u32_b32 v48, vcc_hi, v48
    s_add_u32 s55, s49, 12582912
    v_lshl_add_u32 v48, v48, 2, s50
    v_add3_u32 v49, v28, v14, s55
    s_mov_b64 exec, vcc
    ds_write_b32 v48, v49
    s_mov_b64 exec, -1
    s_mov_b32 s50, s54
    s_branch L_rB_3_0
L_hB_3_1:
    s_bcnt1_i32_b64 s53, vcc
    s_lshl2_add_u32 s54, s53, s50
    s_cmp_gt_u32 s54, s51
    s_cbranch_scc1 L_ovf_3_1
    v_mbcnt_lo_u32_b32 v48, vcc_lo, 0
    v_mbcnt_hi_u32_b32 v48, vcc_hi, v48
    s_add_u32 s55, s49, 12599296
    v_lshl_add_u32 v48, v48, 2, s50
    v_add3_u32 v49, v29, v14, s55
    s_mov_b64 exec, vcc
    ds_write_b32 v48, v49
    s_mov_b64 exec, -1
    s_mov_b32 s50, s54
    s_branch L_rB_3_1
L_hB_3_2:
    s_bcnt1_i32_b64 s53, vcc
    s_lshl2_add_u32 s54, s53, s50
    s_cmp_gt_u32 s54, s51
    s_cbranch_scc1 L_ovf_3_2
    v_mbcnt_lo_u32_b32 v48, vcc_lo, 0
    v_mbcnt_hi_u32_b32 v48, vcc_hi, v48
    s_add_u32 s55, s49, 12615680
    v_lshl_add_u32 v48, v48, 2, s50
    v_add3_u32 v49, v30, v14, s55
    s_mov_b64 exec, vcc
    ds_write_b32 v48, v49
    s_mov_b64 exec, -1
    s_mov_b32 s50, s54
    s_branch L_rB_3_2
L_hB_3_3:
    s_bcnt1_i32_b64 s53, vcc
    s_lshl2_add_u32 s54, s53, s50
    s_cmp_gt_u32 s54, s51
    s_cbranch_scc1 L_ovf_3_3
    v_mbcnt_lo_u32_b32 v48, vcc_lo, 0
    v_mbcnt_hi_u32_b32 v48, vcc_hi, v48
    s_add_u32 s55, s49, 12632064
    v_lshl_add_u32 v48, v48, 2, s50
    v_add3_u32 v49, v31, v14, s55
    s_mov_b64 exec, vcc
    ds_write_b32 v48, v49
    s_mov_b64 exec, -1
    s_mov_b32 s50, s54
    s_branch L_rB_3_3
L_hB_4_0:
    s_bcnt1_i32_b64 s53, vcc
    s_lshl2_add_u32 s54, s53, s50
    s_cmp_gt_u32 s54, s51
    s_cbranch_scc1 L_ovf_4_0
    v_mbcnt_lo_u32_b32 v48, vcc_lo, 0
    v_mbcnt_hi_u32_b32 v48, vcc_hi, v48
    s_add_u32 s55, s49, 16777216
    v_lshl_add_u32 v48, v48, 2, s50
    v_add3_u32 v49, v32, v14, s55
    s_mov_b64 exec, vcc
    ds_write_b32 v48, v49
    s_mov_b64 exec, -1
    s_mov_b32 s50, s54
    s_branch L_rB_4_0
L_hB_4_1:
    s_bcnt1_i32_b64 s53, vcc
    s_lshl2_add_u32 s54, s53, s50
    s_cmp_gt_u32 s54, s51
    s_cbranch_scc1 L_ovf_4_1
    v_mbcnt_lo_u32_b32 v48, vcc_lo, 0
    v_mbcnt_hi_u32_b32 v48, vcc_hi, v48
    s_add_u32 s55, s49, 16793600
    v_lshl_add_u32 v48, v48, 2, s50
    v_add3_u32 v49, v33, v14, s55
    s_mov_b64 exec, vcc
    ds_write_b32 v48, v49
    s_mov_b64 exec, -1
    s_mov_b32 s50, s54
    s_branch L_rB_4_1
L_hB_4_2:
    s_bcnt1_i32_b64 s53, vcc
    s_lshl2_add_u32 s54, s53, s50
    s_cmp_gt_u32 s54, s51
    s_cbranch_scc1 L_ovf_4_2
    v_mbcnt_lo_u32_b32 v48, vcc_lo, 0
    v_mbcnt_hi_u32_b32 v48, vcc_hi, v48
    s_add_u32 s55, s49, 16809984
    v_lshl_add_u32 v48, v48, 2, s50
    v_add3_u32 v49, v34, v14, s55
    s_mov_b64 exec, vcc
    ds_write_b32 v48, v49
    s_mov_b64 exec, -1
    s_mov_b32 s50, s54
    s_branch L_rB_4_2
L_hB_4_3:
    s_bcnt1_i32_b64 s53, vcc
    s_lshl2_add_u32 s54, s53, s50
    s_cmp_gt_u32 s54, s51
    s_cbranch_scc1 L_ovf_4_3
    v_mbcnt_lo_u32_b32 v48, vcc_lo, 0
    v_mbcnt_hi_u32_b32 v48, vcc_hi, v48
    s_add_u32 s55, s49, 16826368
    v_lshl_add_u32 v48, v48, 2, s50
    v_add3_u32 v49, v35, v14, s55
    s_mov_b64 exec, vcc
    ds_write_b32 v48, v49
    s_mov_b64 exec, -1
    s_mov_b32 s50, s54
    s_branch L_rB_4_3
L_hB_5_0:
    s_bcnt1_i32_b64 s53, vcc
    s_lshl2_add_u32 s54, s53, s50
    s_cmp_gt_u32 s54, s51
    s_cbranch_scc1 L_ovf_5_0
    v_mbcnt_lo_u32_b32 v48, vcc_lo, 0
    v_mbcnt_hi_u32_b32 v48, vcc_hi, v48
    s_add_u32 s55, s49, 20971520
    v_lshl_add_u32 v48, v48, 2, s50
    v_add3_u32 v49, v36, v14, s55
    s_mov_b64 exec, vcc
    ds_write_b32 v48, v49
    s_mov_b64 exec, -1
    s_mov_b32 s50, s54
    s_branch L_rB_5_0
L_hB_5_1:
    s_bcnt1_i32_b64 s53, vcc
    s_lshl2_add_u32 s54, s53, s50
    s_cmp_gt_u32 s54, s51
    s_cbranch_scc1 L_ovf_5_1
    v_mbcnt_lo_u32_b32 v48, vcc_lo, 0
    v_mbcnt_hi_u32_b32 v48, vcc_hi, v48
    s_add_u32 s55, s49, 20987904
    v_lshl_add_u32 v48, v48, 2, s50
    v_add3_u32 v49, v37, v14, s55
    s_mov_b64 exec, vcc
    ds_write_b32 v48, v49
    s_mov_b64 exec, -1
    s_mov_b32 s50, s54
    s_branch L_rB_5_1
L_hB_5_2:
    s_bcnt1_i32_b64 s53, vcc
    s_lshl2_add_u32 s54, s53, s50
    s_cmp_gt_u32 s54, s51
    s_cbranch_scc1 L_ovf_5_2
    v_mbcnt_lo_u32_b32 v48, vcc_lo, 0
    v_mbcnt_hi_u32_b32 v48, vcc_hi, v48
    s_add_u32 s55, s49, 21004288
    v_lshl_add_u32 v48, v48, 2, s50
    v_add3_u32 v49, v38, v14, s55
    s_mov_b64 exec, vcc
    ds_write_b32 v48, v49
    s_mov_b64 exec, -1
    s_mov_b32 s50, s54
    s_branch L_rB_5_2
L_hB_5_3:
    s_bcnt1_i32_b64 s53, vcc
    s_lshl2_add_u32 s54, s53, s50
    s_cmp_gt_u32 s54, s51
    s_cbranch_scc1 L_ovf_5_3
    v_mbcnt_lo_u32_b32 v48, vcc_lo, 0
    v_mbcnt_hi_u32_b32 v48, vcc_hi, v48
    s_add_u32 s55, s49, 21020672
    v_lshl_add_u32 v48, v48, 2, s50
    v_add3_u32 v49, v39, v14, s55
    s_mov_b64 exec, vcc
    ds_write_b32 v48, v49
    s_mov_b64 exec, -1
    s_mov_b32 s50, s54
    s_branch L_rB_5_3
L_hB_6_0:
    s_bcnt1_i32_b64 s53, vcc
    s_lshl2_add_u32 s54, s53, s50
    s_cmp_gt_u32 s54, s51
    s_cbranch_scc1 L_ovf_6_0
    v_mbcnt_lo_u32_b32 v48, vcc_lo, 0
    v_mbcnt_hi_u32_b32 v48, vcc_hi, v48
    s_add_u32 s55, s49, 25165824
    v_lshl_add_u32 v48, v48, 2, s50
    v_add3_u32 v49, v40, v14, s55
    s_mov_b64 exec, vcc
    ds_write_b32 v48, v49
    s_mov_b64 exec, -1
    s_mov_b32 s50, s54
    s_branch L_rB_6_0
L_hB_6_1:
    s_bcnt1_i32_b64 s53, vcc
    s_lshl2_add_u32 s54, s53, s50
    s_cmp_gt_u32 s54, s51
    s_cbranch_scc1 L_ovf_6_1
    v_mbcnt_lo_u32_b32 v48, vcc_lo, 0
    v_mbcnt_hi_u32_b32 v48, vcc_hi, v48
    s_add_u32 s55, s49, 25182208
    v_lshl_add_u32 v48, v48, 2, s50
    v_add3_u32 v49, v41, v14, s55
    s_mov_b64 exec, vcc
    ds_write_b32 v48, v49
    s_mov_b64 exec, -1
    s_mov_b32 s50, s54
    s_branch L_rB_6_1
L_hB_6_2:
    s_bcnt1_i32_b64 s53, vcc
    s_lshl2_add_u32 s54, s53, s50
    s_cmp_gt_u32 s54, s51
    s_cbranch_scc1 L_ovf_6_2
    v_mbcnt_lo_u32_b32 v48, vcc_lo, 0
    v_mbcnt_hi_u32_b32 v48, vcc_hi, v48
    s_add_u32 s55, s49, 25198592
    v_lshl_add_u32 v48, v48, 2, s50
    v_add3_u32 v49, v42, v14, s55
    s_mov_b64 exec, vcc
    ds_write_b32 v48, v49
    s_mov_b64 exec, -1
    s_mov_b32 s50, s54
    s_branch L_rB_6_2
L_hB_6_3:
    s_bcnt1_i32_b64 s53, vcc
    s_lshl2_add_u32 s54, s53, s50
    s_cmp_gt_u32 s54, s51
    s_cbranch_scc1 L_ovf_6_3
    v_mbcnt_lo_u32_b32 v48, vcc_lo, 0
    v_mbcnt_hi_u32_b32 v48, vcc_hi, v48
    s_add_u32 s55, s49, 25214976
    v_lshl_add_u32 v48, v48, 2, s50
    v_add3_u32 v49, v43, v14, s55
    s_mov_b64 exec, vcc
    ds_write_b32 v48, v49
    s_mov_b64 exec, -1
    s_mov_b32 s50, s54
    s_branch L_rB_6_3
L_hB_7_0:
    s_bcnt1_i32_b64 s53, vcc
    s_lshl2_add_u32 s54, s53, s50
    s_cmp_gt_u32 s54, s51
    s_cbranch_scc1 L_ovf_7_0
    v_mbcnt_lo_u32_b32 v48, vcc_lo, 0
    v_mbcnt_hi_u32_b32 v48, vcc_hi, v48
    s_add_u32 s55, s49, 29360128
    v_lshl_add_u32 v48, v48, 2, s50
    v_add3_u32 v49, v44, v14, s55
    s_mov_b64 exec, vcc
    ds_write_b32 v48, v49
    s_mov_b64 exec, -1
    s_mov_b32 s50, s54
    s_branch L_rB_7_0
L_hB_7_1:
    s_bcnt1_i32_b64 s53, vcc
    s_lshl2_add_u32 s54, s53, s50
    s_cmp_gt_u32 s54, s51
    s_cbranch_scc1 L_ovf_7_1
    v_mbcnt_lo_u32_b32 v48, vcc_lo, 0
    v_mbcnt_hi_u32_b32 v48, vcc_hi, v48
    s_add_u32 s55, s49, 29376512
    v_lshl_add_u32 v48, v48, 2, s50
    v_add3_u32 v49, v45, v14, s55
    s_mov_b64 exec, vcc
    ds_write_b32 v48, v49
    s_mov_b64 exec, -1
    s_mov_b32 s50, s54
    s_branch L_rB_7_1
L_hB_7_2:
    s_bcnt1_i32_b64 s53, vcc
    s_lshl2_add_u32 s54, s53, s50
    s_cmp_gt_u32 s54, s51
    s_cbranch_scc1 L_ovf_7_2
    v_mbcnt_lo_u32_b32 v48, vcc_lo, 0
    v_mbcnt_hi_u32_b32 v48, vcc_hi, v48
    s_add_u32 s55, s49, 29392896
    v_lshl_add_u32 v48, v48, 2, s50
    v_add3_u32 v49, v46, v14, s55
    s_mov_b64 exec, vcc
    ds_write_b32 v48, v49
    s_mov_b64 exec, -1
    s_mov_b32 s50, s54
    s_branch L_rB_7_2
L_hB_7_3:
    s_bcnt1_i32_b64 s53, vcc
    s_lshl2_add_u32 s54, s53, s50
    s_cmp_gt_u32 s54, s51
    s_cbranch_scc1 L_ovf_7_3
    v_mbcnt_lo_u32_b32 v48, vcc_lo, 0
    v_mbcnt_hi_u32_b32 v48, vcc_hi, v48
    s_add_u32 s55, s49, 29409280
    v_lshl_add_u32 v48, v48, 2, s50
    v_add3_u32 v49, v47, v14, s55
    s_mov_b64 exec, vcc
    ds_write_b32 v48, v49
    s_mov_b64 exec, -1
    s_mov_b32 s50, s54
    s_branch L_rB_7_3
L_ovf_0_0:
    s_movk_i32 s53, 0
    s_branch L_ovf
L_ovf_0_1:
    s_movk_i32 s53, 1
    s_branch L_ovf
L_ovf_0_2:
    s_movk_i32 s53, 2
    s_branch L_ovf
L_ovf_0_3:
    s_movk_i32 s53, 3
    s_branch L_ovf
L_ovf_1_0:
    s_movk_i32 s53, 4
    s_branch L_ovf
L_ovf_1_1:
    s_movk_i32 s53, 5
    s_branch L_ovf
L_ovf_1_2:
    s_movk_i32 s53, 6
    s_branch L_ovf
L_ovf_1_3:
    s_movk_i32 s53, 7
    s_branch L_ovf
L_ovf_2_0:
    s_movk_i32 s53, 8
    s_branch L_ovf
L_ovf_2_1:
    s_movk_i32 s53, 9
    s_branch L_ovf
L_ovf_2_2:
    s_movk_i32 s53, 10
    s_branch L_ovf
L_ovf_2_3:
    s_movk_i32 s53, 11
    s_branch L_ovf
L_ovf_3_0:
    s_movk_i32 s53, 12
    s_branch L_ovf
L_ovf_3_1:
    s_movk_i32 s53, 13
    s_branch L_ovf
L_ovf_3_2:
    s_movk_i32 s53, 14
    s_branch L_ovf
L_ovf_3_3:
    s_movk_i32 s53, 15
    s_branch L_ovf
L_ovf_4_0:
    s_movk_i32 s53, 16
    s_branch L_ovf
L_ovf_4_1:
    s_movk_i32 s53, 17
    s_branch L_ovf
L_ovf_4_2:
    s_movk_i32 s53, 18
    s_branch L_ovf
L_ovf_4_3:
    s_movk_i32 s53, 19
    s_branch L_ovf
L_ovf_5_0:
    s_movk_i32 s53, 20
    s_branch L_ovf
L_ovf_5_1:
    s_movk_i32 s53, 21
    s_branch L_ovf
L_ovf_5_2:
    s_movk_i32 s53, 22
    s_branch L_ovf
L_ovf_5_3:
    s_movk_i32 s53, 23
    s_branch L_ovf
L_ovf_6_0:
    s_movk_i32 s53, 24
    s_branch L_ovf
L_ovf_6_1:
    s_movk_i32 s53, 25
    s_branch L_ovf
L_ovf_6_2:
    s_movk_i32 s53, 26
    s_branch L_ovf
L_ovf_6_3:
    s_movk_i32 s53, 27
    s_branch L_ovf
L_ovf_7_0:
    s_movk_i32 s53, 28
    s_branch L_ovf
L_ovf_7_1:
    s_movk_i32 s53, 29
    s_branch L_ovf
L_ovf_7_2:
    s_movk_i32 s53, 30
    s_branch L_ovf
L_ovf_7_3:
    s_movk_i32 s53, 31
    s_branch L_ovf
L_ovf:
    s_lshr_b32 s76, s49, 22
    s_lshr_b32 s54, s53, 2
    s_add_u32 s76, s76, s54
    s_and_b32 s52, s53, 3
    v_mov_b32 v48, 1
    v_mov_b32 v49, 151824
    ds_write_b32 v49, v48
    s_branch L_scan_done
L_scan_fin:
    s_mov_b32 s76, s77
    s_mov_b32 s52, 0
L_scan_done:
    s_waitcnt vmcnt(0) lgkmcnt(0)
    s_sub_u32 s75, s50, s100
    s_lshr_b32 s75, s75, 2
    v_lshlrev_b32 v72, 2, v1
    v_add_u32 v72, s100, v72
    ds_read_b32 v34, v72
    ds_read_b32 v58, v72 offset:256
    v_and_b32 v73, 3, v1
    v_lshlrev_b32 v73, 5, v73
    buffer_load_dwordx4 v[64:67], v73, s[40:43], 0 offen
    buffer_load_dwordx4 v[68:71], v73, s[40:43], 0 offen offset:16
    v_cmp_gt_i32 s[78:79], s75, v1
    s_sub_u32 s53, s75, 64
    v_cmp_gt_i32 s[80:81], s53, v1
    s_waitcnt lgkmcnt(0)
    v_lshrrev_b32 v38, 14, v34
    v_lshlrev_b32 v39, 2, v38
    v_lshlrev_b32 v36, 3, v38
    v_lshlrev_b32 v38, 5, v38
    v_lshrrev_b32 v62, 14, v58
    v_lshlrev_b32 v63, 2, v62
    v_lshlrev_b32 v60, 3, v62
    v_lshlrev_b32 v62, 5, v62
    s_mov_b64 exec, s[78:79]
    s_cbranch_execz L_17
    buffer_load_dword v35, v39, s[12:15], 0 offen
    buffer_load_dwordx2 v[32:33], v36, s[20:23], 0 offen
    buffer_load_dwordx4 v[16:19], v38, s[24:27], 0 offen
    buffer_load_dwordx4 v[20:23], v38, s[24:27], 0 offen offset:16
L_17:
    s_mov_b64 exec, s[80:81]
    s_cbranch_execz L_18
    buffer_load_dword v59, v63, s[12:15], 0 offen
    buffer_load_dwordx2 v[56:57], v60, s[20:23], 0 offen
    buffer_load_dwordx4 v[40:43], v62, s[24:27], 0 offen
    buffer_load_dwordx4 v[44:47], v62, s[24:27], 0 offen offset:16
L_18:
    s_mov_b64 exec, -1
    s_waitcnt vmcnt(0)
    v_mov_b32 v72, 1
    v_mul_u32_u24 v38, 6711, v35
    v_lshrrev_b32 v38, 22, v38
    v_min_u32 v38, 15, v38
    v_bfe_u32 v39, v34, 8, 6
    v_lshlrev_b32 v38, 2, v38
    v_lshl_add_u32 v36, v39, 6, v38
    v_add_u32 v36, 143616, v36
    v_mul_u32_u24 v62, 6711, v59
    v_lshrrev_b32 v62, 22, v62
    v_min_u32 v62, 15, v62
    v_bfe_u32 v63, v58, 8, 6
    v_lshlrev_b32 v62, 2, v62
    v_lshl_add_u32 v60, v63, 6, v62
    v_add_u32 v60, 143616, v60
    s_mov_b64 exec, s[78:79]
    ds_add_rtn_u32 v37, v36, v72
    s_mov_b64 exec, s[80:81]
    ds_add_rtn_u32 v61, v60, v72
    s_mov_b64 exec, -1
    s_waitcnt lgkmcnt(0)
    s_barrier
    v_perm_b32 v72, v66, v64, s82
    v_perm_b32 v73, v70, v68, s82
    v_perm_b32 v74, v66, v64, s83
    v_perm_b32 v75, v70, v68, s83
    v_perm_b32 v76, v67, v65, s82
    v_perm_b32 v77, v71, v69, s82
    v_perm_b32 v78, v67, v65, s83
    v_perm_b32 v79, v71, v69, s83
    s_nop 1
    v_mfma_f32_4x4x4_16b_bf16 v[64:67], v[72:73], v[32:33], 0
    v_mfma_f32_4x4x4_16b_bf16 v[68:71], v[74:75], v[32:33], 0
    s_nop 5
    v_cvt_pk_bf16_f32 v24, v64, v65
    v_cvt_pk_bf16_f32 v25, v66, v67
    v_cvt_pk_bf16_f32 v26, v68, v69
    v_cvt_pk_bf16_f32 v27, v70, v71
    s_nop 1
    v_mfma_f32_4x4x4_16b_bf16 v[64:67], v[76:77], v[32:33], 0
    v_mfma_f32_4x4x4_16b_bf16 v[68:71], v[78:79], v[32:33], 0
    s_nop 5
    v_cvt_pk_bf16_f32 v28, v64, v65
    v_cvt_pk_bf16_f32 v29, v66, v67
    v_cvt_pk_bf16_f32 v30, v68, v69
    v_cvt_pk_bf16_f32 v31, v70, v71
    s_nop 1
    v_mfma_f32_4x4x4_16b_bf16 v[64:67], v[72:73], v[56:57], 0
    v_mfma_f32_4x4x4_16b_bf16 v[68:71], v[74:75], v[56:57], 0
    s_nop 5
    v_cvt_pk_bf16_f32 v48, v64, v65
    v_cvt_pk_bf16_f32 v49, v66, v67
    v_cvt_pk_bf16_f32 v50, v68, v69
    v_cvt_pk_bf16_f32 v51, v70, v71
    s_nop 1
    v_mfma_f32_4x4x4_16b_bf16 v[64:67], v[76:77], v[56:57], 0
    v_mfma_f32_4x4x4_16b_bf16 v[68:71], v[78:79], v[56:57], 0
    s_nop 5
    v_cvt_pk_bf16_f32 v52, v64, v65
    v_cvt_pk_bf16_f32 v53, v66, v67
    v_cvt_pk_bf16_f32 v54, v68, v69
    v_cvt_pk_bf16_f32 v55, v70, v71
    s_nop 1
    v_lshlrev_b32 v38, 6, v1
    v_add_u32 v38, 143616, v38
    v_mov_b32 v39, 151824
    ds_read_b128 v[64:67], v38 offset:0
    ds_read_b128 v[68:71], v38 offset:16
    ds_read_b128 v[72:75], v38 offset:32
    ds_read_b128 v[76:79], v38 offset:48
    ds_read_b32 v39, v39
    s_waitcnt lgkmcnt(0)
    v_readfirstlane_b32 s74, v39
    v_add3_u32 v64, v64, v65, v66
    v_add3_u32 v67, v67, v68, v69
    v_add3_u32 v70, v70, v71, v72
    v_add3_u32 v73, v73, v74, v75
    v_add3_u32 v76, v76, v77, v78
    v_add3_u32 v64, v64, v67, v70
    v_add3_u32 v73, v73, v76, v79
    v_add_u32 v64, v64, v73
    s_cmp_lg_u32 s73, 0
    s_cbranch_scc1 L_assigned
    v_sub_u32 v65, 63, v1
    v_lshl_add_u32 v65, v64, 6, v65
    v_mov_b32 v66, 0
    v_readlane_b32 s84, v65, 0
    v_readlane_b32 s85, v65, 1
    v_readlane_b32 s86, v65, 2
    v_readlane_b32 s87, v65, 3
    v_readlane_b32 s88, v65, 4
    v_readlane_b32 s89, v65, 5
    v_readlane_b32 s90, v65, 6
    v_readlane_b32 s91, v65, 7
    v_readlane_b32 s92, v65, 8
    v_readlane_b32 s93, v65, 9
    v_readlane_b32 s94, v65, 10
    v_readlane_b32 s95, v65, 11
    v_readlane_b32 s96, v65, 12
    v_readlane_b32 s97, v65, 13
    v_readlane_b32 s98, v65, 14
    v_readlane_b32 s99, v65, 15
    s_nop 1
    v_cmp_gt_u32 vcc, s84, v65
    v_cmp_gt_u32 s[4:5], s85, v65
    v_cmp_gt_u32 s[6:7], s86, v65
    v_addc_co_u32 v66, vcc, 0, v66, vcc
    v_addc_co_u32 v66, s[4:5], 0, v66, s[4:5]
    v_addc_co_u32 v66, s[6:7], 0, v66, s[6:7]
    v_cmp_gt_u32 vcc, s87, v65
    v_cmp_gt_u32 s[4:5], s88, v65
    v_cmp_gt_u32 s[6:7], s89, v65
    v_addc_co_u32 v66, vcc, 0, v66, vcc
    v_addc_co_u32 v66, s[4:5], 0, v66, s[4:5]
    v_addc_co_u32 v66, s[6:7], 0, v66, s[6:7]
    v_cmp_gt_u32 vcc, s90, v65
    v_cmp_gt_u32 s[4:5], s91, v65
    v_cmp_gt_u32 s[6:7], s92, v65
    v_addc_co_u32 v66, vcc, 0, v66, vcc
    v_addc_co_u32 v66, s[4:5], 0, v66, s[4:5]
    v_addc_co_u32 v66, s[6:7], 0, v66, s[6:7]
    v_cmp_gt_u32 vcc, s93, v65
    v_cmp_gt_u32 s[4:5], s94, v65
    v_cmp_gt_u32 s[6:7], s95, v65
    v_addc_co_u32 v66, vcc, 0, v66, vcc
    v_addc_co_u32 v66, s[4:5], 0, v66, s[4:5]
    v_addc_co_u32 v66, s[6:7], 0, v66, s[6:7]
    v_cmp_gt_u32 vcc, s96, v65
    v_cmp_gt_u32 s[4:5], s97, v65
    v_cmp_gt_u32 s[6:7], s98, v65
    v_addc_co_u32 v66, vcc, 0, v66, vcc
    v_addc_co_u32 v66, s[4:5], 0, v66, s[4:5]
    v_addc_co_u32 v66, s[6:7], 0, v66, s[6:7]
    v_cmp_gt_u32 vcc, s99, v65
    s_nop 1
    v_addc_co_u32 v66, vcc, 0, v66, vcc
    v_readlane_b32 s84, v65, 16
    v_readlane_b32 s85, v65, 17
    v_readlane_b32 s86, v65, 18
    v_readlane_b32 s87, v65, 19
    v_readlane_b32 s88, v65, 20
    v_readlane_b32 s89, v65, 21
    v_readlane_b32 s90, v65, 22
    v_readlane_b32 s91, v65, 23
    v_readlane_b32 s92, v65, 24
    v_readlane_b32 s93, v65, 25
    v_readlane_b32 s94, v65, 26
    v_readlane_b32 s95, v65, 27
    v_readlane_b32 s96, v65, 28
    v_readlane_b32 s97, v65, 29
    v_readlane_b32 s98, v65, 30
    v_readlane_b32 s99, v65, 31
    s_nop 1
    v_cmp_gt_u32 vcc, s84, v65
    v_cmp_gt_u32 s[4:5], s85, v65
    v_cmp_gt_u32 s[6:7], s86, v65
    v_addc_co_u32 v66, vcc, 0, v66, vcc
    v_addc_co_u32 v66, s[4:5], 0, v66, s[4:5]
    v_addc_co_u32 v66, s[6:7], 0, v66, s[6:7]
    v_cmp_gt_u32 vcc, s87, v65
    v_cmp_gt_u32 s[4:5], s88, v65
    v_cmp_gt_u32 s[6:7], s89, v65
    v_addc_co_u32 v66, vcc, 0, v66, vcc
    v_addc_co_u32 v66, s[4:5], 0, v66, s[4:5]
    v_addc_co_u32 v66, s[6:7], 0, v66, s[6:7]
    v_cmp_gt_u32 vcc, s90, v65
    v_cmp_gt_u32 s[4:5], s91, v65
    v_cmp_gt_u32 s[6:7], s92, v65
    v_addc_co_u32 v66, vcc, 0, v66, vcc
    v_addc_co_u32 v66, s[4:5], 0, v66, s[4:5]
    v_addc_co_u32 v66, s[6:7], 0, v66, s[6:7]
    v_cmp_gt_u32 vcc, s93, v65
    v_cmp_gt_u32 s[4:5], s94, v65
    v_cmp_gt_u32 s[6:7], s95, v65
    v_addc_co_u32 v66, vcc, 0, v66, vcc
    v_addc_co_u32 v66, s[4:5], 0, v66, s[4:5]
    v_addc_co_u32 v66, s[6:7], 0, v66, s[6:7]
    v_cmp_gt_u32 vcc, s96, v65
    v_cmp_gt_u32 s[4:5], s97, v65
    v_cmp_gt_u32 s[6:7], s98, v65
    v_addc_co_u32 v66, vcc, 0, v66, vcc
    v_addc_co_u32 v66, s[4:5], 0, v66, s[4:5]
    v_addc_co_u32 v66, s[6:7], 0, v66, s[6:7]
    v_cmp_gt_u32 vcc, s99, v65
    s_nop 1
    v_addc_co_u32 v66, vcc, 0, v66, vcc
    v_readlane_b32 s84, v65, 32
    v_readlane_b32 s85, v65, 33
    v_readlane_b32 s86, v65, 34
    v_readlane_b32 s87, v65, 35
    v_readlane_b32 s88, v65, 36
    v_readlane_b32 s89, v65, 37
    v_readlane_b32 s90, v65, 38
    v_readlane_b32 s91, v65, 39
    s_nop 1
    v_cmp_gt_u32 vcc, s84, v65
    v_cmp_gt_u32 s[4:5], s85, v65
    v_cmp_gt_u32 s[6:7], s86, v65
    v_addc_co_u32 v66, vcc, 0, v66, vcc
    v_addc_co_u32 v66, s[4:5], 0, v66, s[4:5]
    v_addc_co_u32 v66, s[6:7], 0, v66, s[6:7]
    v_cmp_gt_u32 vcc, s87, v65
    v_cmp_gt_u32 s[4:5], s88, v65
    v_cmp_gt_u32 s[6:7], s89, v65
    v_addc_co_u32 v66, vcc, 0, v66, vcc
    v_addc_co_u32 v66, s[4:5], 0, v66, s[4:5]
    v_addc_co_u32 v66, s[6:7], 0, v66, s[6:7]
    v_cmp_gt_u32 vcc, s90, v65
    v_cmp_gt_u32 s[4:5], s91, v65
    s_nop 0
    v_addc_co_u32 v66, vcc, 0, v66, vcc
    v_addc_co_u32 v66, s[4:5], 0, v66, s[4:5]
    v_bfe_u32 v67, v66, 3, 1
    v_mul_u32_u24 v67, 7, v67
    v_and_b32 v68, 7, v66
    v_xor_b32 v11, v67, v68
    s_sub_u32 s53, 7, s3
    s_add_u32 s54, s3, 0
    v_cmp_eq_u32 vcc, s54, v66
    s_ff1_i32_b64 s56, vcc
    s_add_u32 s54, s53, 8
    v_cmp_eq_u32 vcc, s54, v66
    s_ff1_i32_b64 s57, vcc
    s_add_u32 s54, s3, 16
    v_cmp_eq_u32 vcc, s54, v66
    s_ff1_i32_b64 s58, vcc
    s_add_u32 s54, s53, 24
    v_cmp_eq_u32 vcc, s54, v66
    s_ff1_i32_b64 s59, vcc
    s_add_u32 s54, s3, 32
    v_cmp_eq_u32 vcc, s54, v66
    s_ff1_i32_b64 s60, vcc
L_assigned:
    v_cmp_gt_u32 vcc, s3, v11
    v_and_b32 v68, 15, v1
    v_lshlrev_b32 v68, 2, v68
    v_cndmask_b32 v67, 0, v64, vcc
    v_add_u32 v68, 143616, v68
    s_lshl_b32 s84, s56, 6
    v_add_u32 v70, s84, v68
    ds_read_b32 v75, v70
    s_lshl_b32 s85, s57, 6
    v_add_u32 v71, s85, v68
    ds_read_b32 v76, v71
    s_lshl_b32 s86, s58, 6
    v_add_u32 v72, s86, v68
    ds_read_b32 v77, v72
    s_lshl_b32 s87, s59, 6
    v_add_u32 v73, s87, v68
    ds_read_b32 v78, v73
    s_lshl_b32 s88, s60, 6
    v_add_u32 v74, s88, v68
    ds_read_b32 v79, v74
    s_nop 1
    v_add_u32_dpp v67, v67, v67 row_shr:1 row_mask:0xf bank_mask:0xf bound_ctrl:1
    s_nop 1
    v_add_u32_dpp v67, v67, v67 row_shr:2 row_mask:0xf bank_mask:0xf bound_ctrl:1
    s_nop 1
    v_add_u32_dpp v67, v67, v67 row_shr:4 row_mask:0xf bank_mask:0xf bound_ctrl:1
    s_nop 1
    v_add_u32_dpp v67, v67, v67 row_shr:8 row_mask:0xf bank_mask:0xf bound_ctrl:1
    s_nop 0
    v_readlane_b32 s61, v67, 15
    v_readlane_b32 s53, v67, 31
    v_readlane_b32 s54, v67, 47
    v_readlane_b32 s92, v64, s56
    v_readlane_b32 s93, v64, s57
    v_readlane_b32 s94, v64, s58
    v_readlane_b32 s95, v64, s59
    v_readlane_b32 s96, v64, s60
    s_add_u32 s61, s61, s53
    s_add_u32 s61, s61, s54
    s_add_u32 s61, s61, 3
    s_andn2_b32 s61, s61, 3
    s_lshl2_add_u32 s61, s3, s61
    s_add_u32 s62, s92, s93
    s_add_u32 s62, s62, s94
    s_add_u32 s62, s62, s95
    s_add_u32 s62, s62, s96
    s_waitcnt lgkmcnt(0)
    v_add3_u32 v67, v75, v76, v77
    v_add3_u32 v67, v67, v78, v79
    v_mov_b32 v68, v67
    s_nop 1
    v_add_u32_dpp v68, v68, v68 row_shr:1 row_mask:0xf bank_mask:0xf bound_ctrl:1
    s_nop 1
    v_add_u32_dpp v68, v68, v68 row_shr:2 row_mask:0xf bank_mask:0xf bound_ctrl:1
    s_nop 1
    v_add_u32_dpp v68, v68, v68 row_shr:4 row_mask:0xf bank_mask:0xf bound_ctrl:1
    s_nop 1
    v_add_u32_dpp v68, v68, v68 row_shr:8 row_mask:0xf bank_mask:0xf bound_ctrl:1
    v_sub_u32 v68, v68, v67
    v_add_u32 v68, s61, v68
    v_lshl_add_u32 v69, v68, 3, 0
    ds_write_b32 v70, v69 offset:4096
    v_add_u32 v68, v68, v75
    s_nop 0
    v_lshl_add_u32 v69, v68, 3, 1
    ds_write_b32 v71, v69 offset:4096
    v_add_u32 v68, v68, v76
    s_nop 0
    v_lshl_add_u32 v69, v68, 3, 2
    ds_write_b32 v72, v69 offset:4096
    v_add_u32 v68, v68, v77
    s_nop 0
    v_lshl_add_u32 v69, v68, 3, 3
    ds_write_b32 v73, v69 offset:4096
    v_add_u32 v68, v68, v78
    s_nop 0
    v_lshl_add_u32 v69, v68, 3, 4
    ds_write_b32 v74, v69 offset:4096
    s_waitcnt lgkmcnt(0)
    s_barrier
    ds_read_b32 v38, v36 offset:4096
    ds_read_b32 v62, v60 offset:4096
    v_mov_b32 v64, 0
    v_mov_b32 v65, 0
    v_lshlrev_b32 v66, 3, v0
    v_add_u32 v66, 143616, v66
    ds_write_b64 v66, v[64:65]
    v_mov_b32 v66, 151824
    ds_write_b32 v66, v64
    s_waitcnt lgkmcnt(0)
    v_lshrrev_b32 v39, 3, v38
    v_add_u32 v39, v39, v37
    v_and_b32 v38, 7, v38
    v_lshl_or_b32 v38, v35, 11, v38
    v_lshlrev_b32 v36, 2, v39
    v_add_u32 v36, 135168, v36
    v_lshlrev_b32 v39, 6, v39
    v_add_u32 v39, 65536, v39
    v_lshrrev_b32 v63, 3, v62
    v_add_u32 v63, v63, v61
    v_and_b32 v62, 7, v62
    v_lshl_or_b32 v62, v59, 11, v62
    v_lshlrev_b32 v60, 2, v63
    v_add_u32 v60, 135168, v60
    v_lshlrev_b32 v63, 6, v63
    v_add_u32 v63, 65536, v63
    s_mov_b64 exec, s[78:79]
    ds_write_b32 v36, v38
    ds_write_b128 v39, v[24:27]
    ds_write_b128 v39, v[28:31] offset:16
    ds_write_b128 v39, v[16:19] offset:32
    ds_write_b128 v39, v[20:23] offset:48
    s_mov_b64 exec, s[80:81]
    ds_write_b32 v60, v62
    ds_write_b128 v63, v[48:51]
    ds_write_b128 v63, v[52:55] offset:16
    ds_write_b128 v63, v[40:43] offset:32
    ds_write_b128 v63, v[44:47] offset:48
    s_mov_b64 exec, -1
    s_lshl_b32 s53, s61, 6
    s_add_u32 s53, s53, 65536
    v_and_b32 v64, 3, v1
    v_lshlrev_b32 v65, 3, v64
    v_add_u32 v5, s53, v65
    v_bfe_u32 v65, v1, 4, 1
    v_lshlrev_b32 v65, 4, v65
    v_lshl_add_u32 v65, v64, 6, v65
    v_add3_u32 v65, v65, s53, 32
    v_mov_b32 v66, 151808
    v_cmp_ne_u32 vcc, 0, v8
    v_cmp_ne_u32 s[4:5], 0, v9
    s_nop 0
    v_cndmask_b32 v6, v66, v65, vcc
    v_cndmask_b32 v7, v66, v65, s[4:5]
    s_lshl_b32 s53, s61, 2
    s_add_u32 s53, s53, 135168
    v_mov_b32 v10, s53
    s_waitcnt lgkmcnt(0)
    s_barrier
    s_cmp_eq_u32 s62, 0
    s_cbranch_scc1 L_sweep_done
    ds_read_b128 v[68:71], v10
    s_waitcnt lgkmcnt(0)
    v_readfirstlane_b32 s64, v68
    v_readfirstlane_b32 s65, v69
    v_readfirstlane_b32 s66, v70
    v_readfirstlane_b32 s67, v71
    s_add_u32 m0, s63, 0
    s_andn2_b32 s72, s64, 7
    buffer_load_dwordx4 v2, s[8:11], s72 offen lds
    buffer_load_dwordx4 v3, s[8:11], s72 offen offset:1024 lds
    s_and_b32 s68, s64, 7
    s_cmp_le_u32 s62, 1
    s_cbranch_scc1 L_group
    s_add_u32 m0, s63, 2048
    s_andn2_b32 s72, s65, 7
    buffer_load_dwordx4 v2, s[8:11], s72 offen lds
    buffer_load_dwordx4 v3, s[8:11], s72 offen offset:1024 lds
    s_and_b32 s69, s65, 7
    s_cmp_le_u32 s62, 2
    s_cbranch_scc1 L_group
    s_add_u32 m0, s63, 4096
    s_andn2_b32 s72, s66, 7
    buffer_load_dwordx4 v2, s[8:11], s72 offen lds
    buffer_load_dwordx4 v3, s[8:11], s72 offen offset:1024 lds
    s_and_b32 s70, s66, 7
    s_cmp_le_u32 s62, 3
    s_cbranch_scc1 L_group
    s_add_u32 m0, s63, 6144
    s_andn2_b32 s72, s67, 7
    buffer_load_dwordx4 v2, s[8:11], s72 offen lds
    buffer_load_dwordx4 v3, s[8:11], s72 offen offset:1024 lds
    s_and_b32 s71, s67, 7
L_group:
    ds_read_b128 v[60:63], v6
    ds_read_b128 v[64:67], v7
    ds_read_b128 v[68:71], v10 offset:16
    v_add_u32 v6, v6, v8
    v_add_u32 v7, v7, v9
    v_add_u32 v10, 16, v10
    s_waitcnt lgkmcnt(0)
    v_mfma_f32_16x16x32_bf16 v[16:19], v[60:63], a[64:67], 0
    v_mfma_f32_16x16x32_bf16 v[20:23], v[60:63], a[72:75], 0
    v_mfma_f32_16x16x32_bf16 v[24:27], v[60:63], a[80:83], 0
    v_mfma_f32_16x16x32_bf16 v[28:31], v[60:63], a[88:91], 0
    v_mfma_f32_16x16x32_bf16 v[16:19], v[64:67], a[68:71], v[16:19]
    v_mfma_f32_16x16x32_bf16 v[20:23], v[64:67], a[76:79], v[20:23]
    v_mfma_f32_16x16x32_bf16 v[24:27], v[64:67], a[84:87], v[24:27]
    v_mfma_f32_16x16x32_bf16 v[28:31], v[64:67], a[92:95], v[28:31]
    v_readfirstlane_b32 s64, v68
    v_readfirstlane_b32 s65, v69
    v_readfirstlane_b32 s66, v70
    v_readfirstlane_b32 s67, v71
    ds_read_b64 v[56:57], v5 offset:0
    s_cmp_ge_u32 s62, 4
    s_cbranch_scc1 L_19
    s_waitcnt vmcnt(0)
L_19:
    s_waitcnt vmcnt(6)
    ds_read_b64_tr_b16 v[48:49], v4 offset:0
    ds_read_b64_tr_b16 v[50:51], v4 offset:256
    ds_read_b64_tr_b16 v[52:53], v4 offset:512
    ds_read_b64_tr_b16 v[54:55], v4 offset:768
    s_waitcnt lgkmcnt(0)
    s_cmp_le_u32 s62, 4
    s_cbranch_scc1 L_20
    s_add_u32 m0, s63, 0
    s_andn2_b32 s72, s64, 7
    buffer_load_dwordx4 v2, s[8:11], s72 offen lds
    buffer_load_dwordx4 v3, s[8:11], s72 offen offset:1024 lds
L_20:
    v_mfma_f32_4x4x4_16b_bf16 v[32:35], v[56:57], v[48:49], 0
    v_mfma_f32_4x4x4_16b_bf16 v[36:39], v[56:57], v[50:51], 0
    v_mfma_f32_4x4x4_16b_bf16 v[40:43], v[56:57], v[52:53], 0
    v_mfma_f32_4x4x4_16b_bf16 v[44:47], v[56:57], v[54:55], 0
    s_nop 1
    s_cmp_ge_u32 s68, 2
    s_cbranch_scc1 L_acc_23
    s_cmp_eq_u32 s68, 1
    s_cbranch_scc1 L_acc_22
    v_pk_fma_f32 v[80:81], v[32:33], v[16:17], v[80:81] op_sel:[0,0,0] op_sel_hi:[1,0,1]
    v_pk_fma_f32 v[82:83], v[34:35], v[16:17], v[82:83] op_sel:[0,0,0] op_sel_hi:[1,0,1]
    v_pk_fma_f32 v[84:85], v[36:37], v[20:21], v[84:85] op_sel:[0,0,0] op_sel_hi:[1,0,1]
    v_pk_fma_f32 v[86:87], v[38:39], v[20:21], v[86:87] op_sel:[0,0,0] op_sel_hi:[1,0,1]
    v_pk_fma_f32 v[88:89], v[40:41], v[24:25], v[88:89] op_sel:[0,0,0] op_sel_hi:[1,0,1]
    v_pk_fma_f32 v[90:91], v[42:43], v[24:25], v[90:91] op_sel:[0,0,0] op_sel_hi:[1,0,1]
    v_pk_fma_f32 v[92:93], v[44:45], v[28:29], v[92:93] op_sel:[0,0,0] op_sel_hi:[1,0,1]
    v_pk_fma_f32 v[94:95], v[46:47], v[28:29], v[94:95] op_sel:[0,0,0] op_sel_hi:[1,0,1]
    s_branch L_join_26
L_acc_22:
    v_pk_fma_f32 v[96:97], v[32:33], v[16:17], v[96:97] op_sel:[0,0,0] op_sel_hi:[1,0,1]
    v_pk_fma_f32 v[98:99], v[34:35], v[16:17], v[98:99] op_sel:[0,0,0] op_sel_hi:[1,0,1]
    v_pk_fma_f32 v[100:101], v[36:37], v[20:21], v[100:101] op_sel:[0,0,0] op_sel_hi:[1,0,1]
    v_pk_fma_f32 v[102:103], v[38:39], v[20:21], v[102:103] op_sel:[0,0,0] op_sel_hi:[1,0,1]
    v_pk_fma_f32 v[104:105], v[40:41], v[24:25], v[104:105] op_sel:[0,0,0] op_sel_hi:[1,0,1]
    v_pk_fma_f32 v[106:107], v[42:43], v[24:25], v[106:107] op_sel:[0,0,0] op_sel_hi:[1,0,1]
    v_pk_fma_f32 v[108:109], v[44:45], v[28:29], v[108:109] op_sel:[0,0,0] op_sel_hi:[1,0,1]
    v_pk_fma_f32 v[110:111], v[46:47], v[28:29], v[110:111] op_sel:[0,0,0] op_sel_hi:[1,0,1]
    s_branch L_join_26
L_acc_23:
    s_cmp_eq_u32 s68, 3
    s_cbranch_scc1 L_acc_24
    s_cmp_eq_u32 s68, 4
    s_cbranch_scc1 L_acc_25
    v_pk_fma_f32 v[112:113], v[32:33], v[16:17], v[112:113] op_sel:[0,0,0] op_sel_hi:[1,0,1]
    v_pk_fma_f32 v[114:115], v[34:35], v[16:17], v[114:115] op_sel:[0,0,0] op_sel_hi:[1,0,1]
    v_pk_fma_f32 v[116:117], v[36:37], v[20:21], v[116:117] op_sel:[0,0,0] op_sel_hi:[1,0,1]
    v_pk_fma_f32 v[118:119], v[38:39], v[20:21], v[118:119] op_sel:[0,0,0] op_sel_hi:[1,0,1]
    v_pk_fma_f32 v[120:121], v[40:41], v[24:25], v[120:121] op_sel:[0,0,0] op_sel_hi:[1,0,1]
    v_pk_fma_f32 v[122:123], v[42:43], v[24:25], v[122:123] op_sel:[0,0,0] op_sel_hi:[1,0,1]
    v_pk_fma_f32 v[124:125], v[44:45], v[28:29], v[124:125] op_sel:[0,0,0] op_sel_hi:[1,0,1]
    v_pk_fma_f32 v[126:127], v[46:47], v[28:29], v[126:127] op_sel:[0,0,0] op_sel_hi:[1,0,1]
    s_branch L_join_26
L_acc_24:
    v_pk_fma_f32 v[128:129], v[32:33], v[16:17], v[128:129] op_sel:[0,0,0] op_sel_hi:[1,0,1]
    v_pk_fma_f32 v[130:131], v[34:35], v[16:17], v[130:131] op_sel:[0,0,0] op_sel_hi:[1,0,1]
    v_pk_fma_f32 v[132:133], v[36:37], v[20:21], v[132:133] op_sel:[0,0,0] op_sel_hi:[1,0,1]
    v_pk_fma_f32 v[134:135], v[38:39], v[20:21], v[134:135] op_sel:[0,0,0] op_sel_hi:[1,0,1]
    v_pk_fma_f32 v[136:137], v[40:41], v[24:25], v[136:137] op_sel:[0,0,0] op_sel_hi:[1,0,1]
    v_pk_fma_f32 v[138:139], v[42:43], v[24:25], v[138:139] op_sel:[0,0,0] op_sel_hi:[1,0,1]
    v_pk_fma_f32 v[140:141], v[44:45], v[28:29], v[140:141] op_sel:[0,0,0] op_sel_hi:[1,0,1]
    v_pk_fma_f32 v[142:143], v[46:47], v[28:29], v[142:143] op_sel:[0,0,0] op_sel_hi:[1,0,1]
    s_branch L_join_26
L_acc_25:
    v_pk_fma_f32 v[144:145], v[32:33], v[16:17], v[144:145] op_sel:[0,0,0] op_sel_hi:[1,0,1]
    v_pk_fma_f32 v[146:147], v[34:35], v[16:17], v[146:147] op_sel:[0,0,0] op_sel_hi:[1,0,1]
    v_pk_fma_f32 v[148:149], v[36:37], v[20:21], v[148:149] op_sel:[0,0,0] op_sel_hi:[1,0,1]
    v_pk_fma_f32 v[150:151], v[38:39], v[20:21], v[150:151] op_sel:[0,0,0] op_sel_hi:[1,0,1]
    v_pk_fma_f32 v[152:153], v[40:41], v[24:25], v[152:153] op_sel:[0,0,0] op_sel_hi:[1,0,1]
    v_pk_fma_f32 v[154:155], v[42:43], v[24:25], v[154:155] op_sel:[0,0,0] op_sel_hi:[1,0,1]
    v_pk_fma_f32 v[156:157], v[44:45], v[28:29], v[156:157] op_sel:[0,0,0] op_sel_hi:[1,0,1]
    v_pk_fma_f32 v[158:159], v[46:47], v[28:29], v[158:159] op_sel:[0,0,0] op_sel_hi:[1,0,1]
L_join_26:
    s_and_b32 s68, s64, 7
    s_sub_u32 s62, s62, 1
    s_cmp_eq_u32 s62, 0
    s_cbranch_scc1 L_sweep_done
    ds_read_b64 v[56:57], v5 offset:64
    s_cmp_ge_u32 s62, 4
    s_cbranch_scc1 L_27
    s_waitcnt vmcnt(0)
L_27:
    s_waitcnt vmcnt(6)
    ds_read_b64_tr_b16 v[48:49], v4 offset:2048
    ds_read_b64_tr_b16 v[50:51], v4 offset:2304
    ds_read_b64_tr_b16 v[52:53], v4 offset:2560
    ds_read_b64_tr_b16 v[54:55], v4 offset:2816
    s_waitcnt lgkmcnt(0)
    s_cmp_le_u32 s62, 4
    s_cbranch_scc1 L_28
    s_add_u32 m0, s63, 2048
    s_andn2_b32 s72, s65, 7
    buffer_load_dwordx4 v2, s[8:11], s72 offen lds
    buffer_load_dwordx4 v3, s[8:11], s72 offen offset:1024 lds
L_28:
    v_mfma_f32_4x4x4_16b_bf16 v[32:35], v[56:57], v[48:49], 0
    v_mfma_f32_4x4x4_16b_bf16 v[36:39], v[56:57], v[50:51], 0
    v_mfma_f32_4x4x4_16b_bf16 v[40:43], v[56:57], v[52:53], 0
    v_mfma_f32_4x4x4_16b_bf16 v[44:47], v[56:57], v[54:55], 0
    s_nop 1
    s_cmp_ge_u32 s69, 2
    s_cbranch_scc1 L_acc_31
    s_cmp_eq_u32 s69, 1
    s_cbranch_scc1 L_acc_30
    v_pk_fma_f32 v[80:81], v[32:33], v[16:17], v[80:81] op_sel:[0,1,0] op_sel_hi:[1,1,1]
    v_pk_fma_f32 v[82:83], v[34:35], v[16:17], v[82:83] op_sel:[0,1,0] op_sel_hi:[1,1,1]
    v_pk_fma_f32 v[84:85], v[36:37], v[20:21], v[84:85] op_sel:[0,1,0] op_sel_hi:[1,1,1]
    v_pk_fma_f32 v[86:87], v[38:39], v[20:21], v[86:87] op_sel:[0,1,0] op_sel_hi:[1,1,1]
    v_pk_fma_f32 v[88:89], v[40:41], v[24:25], v[88:89] op_sel:[0,1,0] op_sel_hi:[1,1,1]
    v_pk_fma_f32 v[90:91], v[42:43], v[24:25], v[90:91] op_sel:[0,1,0] op_sel_hi:[1,1,1]
    v_pk_fma_f32 v[92:93], v[44:45], v[28:29], v[92:93] op_sel:[0,1,0] op_sel_hi:[1,1,1]
    v_pk_fma_f32 v[94:95], v[46:47], v[28:29], v[94:95] op_sel:[0,1,0] op_sel_hi:[1,1,1]
    s_branch L_join_34
L_acc_30:
    v_pk_fma_f32 v[96:97], v[32:33], v[16:17], v[96:97] op_sel:[0,1,0] op_sel_hi:[1,1,1]
    v_pk_fma_f32 v[98:99], v[34:35], v[16:17], v[98:99] op_sel:[0,1,0] op_sel_hi:[1,1,1]
    v_pk_fma_f32 v[100:101], v[36:37], v[20:21], v[100:101] op_sel:[0,1,0] op_sel_hi:[1,1,1]
    v_pk_fma_f32 v[102:103], v[38:39], v[20:21], v[102:103] op_sel:[0,1,0] op_sel_hi:[1,1,1]
    v_pk_fma_f32 v[104:105], v[40:41], v[24:25], v[104:105] op_sel:[0,1,0] op_sel_hi:[1,1,1]
    v_pk_fma_f32 v[106:107], v[42:43], v[24:25], v[106:107] op_sel:[0,1,0] op_sel_hi:[1,1,1]
    v_pk_fma_f32 v[108:109], v[44:45], v[28:29], v[108:109] op_sel:[0,1,0] op_sel_hi:[1,1,1]
    v_pk_fma_f32 v[110:111], v[46:47], v[28:29], v[110:111] op_sel:[0,1,0] op_sel_hi:[1,1,1]
    s_branch L_join_34
L_acc_31:
    s_cmp_eq_u32 s69, 3
    s_cbranch_scc1 L_acc_32
    s_cmp_eq_u32 s69, 4
    s_cbranch_scc1 L_acc_33
    v_pk_fma_f32 v[112:113], v[32:33], v[16:17], v[112:113] op_sel:[0,1,0] op_sel_hi:[1,1,1]
    v_pk_fma_f32 v[114:115], v[34:35], v[16:17], v[114:115] op_sel:[0,1,0] op_sel_hi:[1,1,1]
    v_pk_fma_f32 v[116:117], v[36:37], v[20:21], v[116:117] op_sel:[0,1,0] op_sel_hi:[1,1,1]
    v_pk_fma_f32 v[118:119], v[38:39], v[20:21], v[118:119] op_sel:[0,1,0] op_sel_hi:[1,1,1]
    v_pk_fma_f32 v[120:121], v[40:41], v[24:25], v[120:121] op_sel:[0,1,0] op_sel_hi:[1,1,1]
    v_pk_fma_f32 v[122:123], v[42:43], v[24:25], v[122:123] op_sel:[0,1,0] op_sel_hi:[1,1,1]
    v_pk_fma_f32 v[124:125], v[44:45], v[28:29], v[124:125] op_sel:[0,1,0] op_sel_hi:[1,1,1]
    v_pk_fma_f32 v[126:127], v[46:47], v[28:29], v[126:127] op_sel:[0,1,0] op_sel_hi:[1,1,1]
    s_branch L_join_34
L_acc_32:
    v_pk_fma_f32 v[128:129], v[32:33], v[16:17], v[128:129] op_sel:[0,1,0] op_sel_hi:[1,1,1]
    v_pk_fma_f32 v[130:131], v[34:35], v[16:17], v[130:131] op_sel:[0,1,0] op_sel_hi:[1,1,1]
    v_pk_fma_f32 v[132:133], v[36:37], v[20:21], v[132:133] op_sel:[0,1,0] op_sel_hi:[1,1,1]
    v_pk_fma_f32 v[134:135], v[38:39], v[20:21], v[134:135] op_sel:[0,1,0] op_sel_hi:[1,1,1]
    v_pk_fma_f32 v[136:137], v[40:41], v[24:25], v[136:137] op_sel:[0,1,0] op_sel_hi:[1,1,1]
    v_pk_fma_f32 v[138:139], v[42:43], v[24:25], v[138:139] op_sel:[0,1,0] op_sel_hi:[1,1,1]
    v_pk_fma_f32 v[140:141], v[44:45], v[28:29], v[140:141] op_sel:[0,1,0] op_sel_hi:[1,1,1]
    v_pk_fma_f32 v[142:143], v[46:47], v[28:29], v[142:143] op_sel:[0,1,0] op_sel_hi:[1,1,1]
    s_branch L_join_34
L_acc_33:
    v_pk_fma_f32 v[144:145], v[32:33], v[16:17], v[144:145] op_sel:[0,1,0] op_sel_hi:[1,1,1]
    v_pk_fma_f32 v[146:147], v[34:35], v[16:17], v[146:147] op_sel:[0,1,0] op_sel_hi:[1,1,1]
    v_pk_fma_f32 v[148:149], v[36:37], v[20:21], v[148:149] op_sel:[0,1,0] op_sel_hi:[1,1,1]
    v_pk_fma_f32 v[150:151], v[38:39], v[20:21], v[150:151] op_sel:[0,1,0] op_sel_hi:[1,1,1]
    v_pk_fma_f32 v[152:153], v[40:41], v[24:25], v[152:153] op_sel:[0,1,0] op_sel_hi:[1,1,1]
    v_pk_fma_f32 v[154:155], v[42:43], v[24:25], v[154:155] op_sel:[0,1,0] op_sel_hi:[1,1,1]
    v_pk_fma_f32 v[156:157], v[44:45], v[28:29], v[156:157] op_sel:[0,1,0] op_sel_hi:[1,1,1]
    v_pk_fma_f32 v[158:159], v[46:47], v[28:29], v[158:159] op_sel:[0,1,0] op_sel_hi:[1,1,1]
L_join_34:
    s_and_b32 s69, s65, 7
    s_sub_u32 s62, s62, 1
    s_cmp_eq_u32 s62, 0
    s_cbranch_scc1 L_sweep_done
    ds_read_b64 v[56:57], v5 offset:128
    s_cmp_ge_u32 s62, 4
    s_cbranch_scc1 L_35
    s_waitcnt vmcnt(0)
L_35:
    s_waitcnt vmcnt(6)
    ds_read_b64_tr_b16 v[48:49], v4 offset:4096
    ds_read_b64_tr_b16 v[50:51], v4 offset:4352
    ds_read_b64_tr_b16 v[52:53], v4 offset:4608
    ds_read_b64_tr_b16 v[54:55], v4 offset:4864
    s_waitcnt lgkmcnt(0)
    s_cmp_le_u32 s62, 4
    s_cbranch_scc1 L_36
    s_add_u32 m0, s63, 4096
    s_andn2_b32 s72, s66, 7
    buffer_load_dwordx4 v2, s[8:11], s72 offen lds
    buffer_load_dwordx4 v3, s[8:11], s72 offen offset:1024 lds
L_36:
    v_mfma_f32_4x4x4_16b_bf16 v[32:35], v[56:57], v[48:49], 0
    v_mfma_f32_4x4x4_16b_bf16 v[36:39], v[56:57], v[50:51], 0
    v_mfma_f32_4x4x4_16b_bf16 v[40:43], v[56:57], v[52:53], 0
    v_mfma_f32_4x4x4_16b_bf16 v[44:47], v[56:57], v[54:55], 0
    s_nop 1
    s_cmp_ge_u32 s70, 2
    s_cbranch_scc1 L_acc_39
    s_cmp_eq_u32 s70, 1
    s_cbranch_scc1 L_acc_38
    v_pk_fma_f32 v[80:81], v[32:33], v[18:19], v[80:81] op_sel:[0,0,0] op_sel_hi:[1,0,1]
    v_pk_fma_f32 v[82:83], v[34:35], v[18:19], v[82:83] op_sel:[0,0,0] op_sel_hi:[1,0,1]
    v_pk_fma_f32 v[84:85], v[36:37], v[22:23], v[84:85] op_sel:[0,0,0] op_sel_hi:[1,0,1]
    v_pk_fma_f32 v[86:87], v[38:39], v[22:23], v[86:87] op_sel:[0,0,0] op_sel_hi:[1,0,1]
    v_pk_fma_f32 v[88:89], v[40:41], v[26:27], v[88:89] op_sel:[0,0,0] op_sel_hi:[1,0,1]
    v_pk_fma_f32 v[90:91], v[42:43], v[26:27], v[90:91] op_sel:[0,0,0] op_sel_hi:[1,0,1]
    v_pk_fma_f32 v[92:93], v[44:45], v[30:31], v[92:93] op_sel:[0,0,0] op_sel_hi:[1,0,1]
    v_pk_fma_f32 v[94:95], v[46:47], v[30:31], v[94:95] op_sel:[0,0,0] op_sel_hi:[1,0,1]
    s_branch L_join_42
L_acc_38:
    v_pk_fma_f32 v[96:97], v[32:33], v[18:19], v[96:97] op_sel:[0,0,0] op_sel_hi:[1,0,1]
    v_pk_fma_f32 v[98:99], v[34:35], v[18:19], v[98:99] op_sel:[0,0,0] op_sel_hi:[1,0,1]
    v_pk_fma_f32 v[100:101], v[36:37], v[22:23], v[100:101] op_sel:[0,0,0] op_sel_hi:[1,0,1]
    v_pk_fma_f32 v[102:103], v[38:39], v[22:23], v[102:103] op_sel:[0,0,0] op_sel_hi:[1,0,1]
    v_pk_fma_f32 v[104:105], v[40:41], v[26:27], v[104:105] op_sel:[0,0,0] op_sel_hi:[1,0,1]
    v_pk_fma_f32 v[106:107], v[42:43], v[26:27], v[106:107] op_sel:[0,0,0] op_sel_hi:[1,0,1]
    v_pk_fma_f32 v[108:109], v[44:45], v[30:31], v[108:109] op_sel:[0,0,0] op_sel_hi:[1,0,1]
    v_pk_fma_f32 v[110:111], v[46:47], v[30:31], v[110:111] op_sel:[0,0,0] op_sel_hi:[1,0,1]
    s_branch L_join_42
L_acc_39:
    s_cmp_eq_u32 s70, 3
    s_cbranch_scc1 L_acc_40
    s_cmp_eq_u32 s70, 4
    s_cbranch_scc1 L_acc_41
    v_pk_fma_f32 v[112:113], v[32:33], v[18:19], v[112:113] op_sel:[0,0,0] op_sel_hi:[1,0,1]
    v_pk_fma_f32 v[114:115], v[34:35], v[18:19], v[114:115] op_sel:[0,0,0] op_sel_hi:[1,0,1]
    v_pk_fma_f32 v[116:117], v[36:37], v[22:23], v[116:117] op_sel:[0,0,0] op_sel_hi:[1,0,1]
    v_pk_fma_f32 v[118:119], v[38:39], v[22:23], v[118:119] op_sel:[0,0,0] op_sel_hi:[1,0,1]
    v_pk_fma_f32 v[120:121], v[40:41], v[26:27], v[120:121] op_sel:[0,0,0] op_sel_hi:[1,0,1]
    v_pk_fma_f32 v[122:123], v[42:43], v[26:27], v[122:123] op_sel:[0,0,0] op_sel_hi:[1,0,1]
    v_pk_fma_f32 v[124:125], v[44:45], v[30:31], v[124:125] op_sel:[0,0,0] op_sel_hi:[1,0,1]
    v_pk_fma_f32 v[126:127], v[46:47], v[30:31], v[126:127] op_sel:[0,0,0] op_sel_hi:[1,0,1]
    s_branch L_join_42
L_acc_40:
    v_pk_fma_f32 v[128:129], v[32:33], v[18:19], v[128:129] op_sel:[0,0,0] op_sel_hi:[1,0,1]
    v_pk_fma_f32 v[130:131], v[34:35], v[18:19], v[130:131] op_sel:[0,0,0] op_sel_hi:[1,0,1]
    v_pk_fma_f32 v[132:133], v[36:37], v[22:23], v[132:133] op_sel:[0,0,0] op_sel_hi:[1,0,1]
    v_pk_fma_f32 v[134:135], v[38:39], v[22:23], v[134:135] op_sel:[0,0,0] op_sel_hi:[1,0,1]
    v_pk_fma_f32 v[136:137], v[40:41], v[26:27], v[136:137] op_sel:[0,0,0] op_sel_hi:[1,0,1]
    v_pk_fma_f32 v[138:139], v[42:43], v[26:27], v[138:139] op_sel:[0,0,0] op_sel_hi:[1,0,1]
    v_pk_fma_f32 v[140:141], v[44:45], v[30:31], v[140:141] op_sel:[0,0,0] op_sel_hi:[1,0,1]
    v_pk_fma_f32 v[142:143], v[46:47], v[30:31], v[142:143] op_sel:[0,0,0] op_sel_hi:[1,0,1]
    s_branch L_join_42
L_acc_41:
    v_pk_fma_f32 v[144:145], v[32:33], v[18:19], v[144:145] op_sel:[0,0,0] op_sel_hi:[1,0,1]
    v_pk_fma_f32 v[146:147], v[34:35], v[18:19], v[146:147] op_sel:[0,0,0] op_sel_hi:[1,0,1]
    v_pk_fma_f32 v[148:149], v[36:37], v[22:23], v[148:149] op_sel:[0,0,0] op_sel_hi:[1,0,1]
    v_pk_fma_f32 v[150:151], v[38:39], v[22:23], v[150:151] op_sel:[0,0,0] op_sel_hi:[1,0,1]
    v_pk_fma_f32 v[152:153], v[40:41], v[26:27], v[152:153] op_sel:[0,0,0] op_sel_hi:[1,0,1]
    v_pk_fma_f32 v[154:155], v[42:43], v[26:27], v[154:155] op_sel:[0,0,0] op_sel_hi:[1,0,1]
    v_pk_fma_f32 v[156:157], v[44:45], v[30:31], v[156:157] op_sel:[0,0,0] op_sel_hi:[1,0,1]
    v_pk_fma_f32 v[158:159], v[46:47], v[30:31], v[158:159] op_sel:[0,0,0] op_sel_hi:[1,0,1]
L_join_42:
    s_and_b32 s70, s66, 7
    s_sub_u32 s62, s62, 1
    s_cmp_eq_u32 s62, 0
    s_cbranch_scc1 L_sweep_done
    ds_read_b64 v[56:57], v5 offset:192
    s_cmp_ge_u32 s62, 4
    s_cbranch_scc1 L_43
    s_waitcnt vmcnt(0)
L_43:
    s_waitcnt vmcnt(6)
    ds_read_b64_tr_b16 v[48:49], v4 offset:6144
    ds_read_b64_tr_b16 v[50:51], v4 offset:6400
    ds_read_b64_tr_b16 v[52:53], v4 offset:6656
    ds_read_b64_tr_b16 v[54:55], v4 offset:6912
    s_waitcnt lgkmcnt(0)
    s_cmp_le_u32 s62, 4
    s_cbranch_scc1 L_44
    s_add_u32 m0, s63, 6144
    s_andn2_b32 s72, s67, 7
    buffer_load_dwordx4 v2, s[8:11], s72 offen lds
    buffer_load_dwordx4 v3, s[8:11], s72 offen offset:1024 lds
L_44:
    v_mfma_f32_4x4x4_16b_bf16 v[32:35], v[56:57], v[48:49], 0
    v_mfma_f32_4x4x4_16b_bf16 v[36:39], v[56:57], v[50:51], 0
    v_mfma_f32_4x4x4_16b_bf16 v[40:43], v[56:57], v[52:53], 0
    v_mfma_f32_4x4x4_16b_bf16 v[44:47], v[56:57], v[54:55], 0
    s_nop 1
    s_cmp_ge_u32 s71, 2
    s_cbranch_scc1 L_acc_47
    s_cmp_eq_u32 s71, 1
    s_cbranch_scc1 L_acc_46
    v_pk_fma_f32 v[80:81], v[32:33], v[18:19], v[80:81] op_sel:[0,1,0] op_sel_hi:[1,1,1]
    v_pk_fma_f32 v[82:83], v[34:35], v[18:19], v[82:83] op_sel:[0,1,0] op_sel_hi:[1,1,1]
    v_pk_fma_f32 v[84:85], v[36:37], v[22:23], v[84:85] op_sel:[0,1,0] op_sel_hi:[1,1,1]
    v_pk_fma_f32 v[86:87], v[38:39], v[22:23], v[86:87] op_sel:[0,1,0] op_sel_hi:[1,1,1]
    v_pk_fma_f32 v[88:89], v[40:41], v[26:27], v[88:89] op_sel:[0,1,0] op_sel_hi:[1,1,1]
    v_pk_fma_f32 v[90:91], v[42:43], v[26:27], v[90:91] op_sel:[0,1,0] op_sel_hi:[1,1,1]
    v_pk_fma_f32 v[92:93], v[44:45], v[30:31], v[92:93] op_sel:[0,1,0] op_sel_hi:[1,1,1]
    v_pk_fma_f32 v[94:95], v[46:47], v[30:31], v[94:95] op_sel:[0,1,0] op_sel_hi:[1,1,1]
    s_branch L_join_50
L_acc_46:
    v_pk_fma_f32 v[96:97], v[32:33], v[18:19], v[96:97] op_sel:[0,1,0] op_sel_hi:[1,1,1]
    v_pk_fma_f32 v[98:99], v[34:35], v[18:19], v[98:99] op_sel:[0,1,0] op_sel_hi:[1,1,1]
    v_pk_fma_f32 v[100:101], v[36:37], v[22:23], v[100:101] op_sel:[0,1,0] op_sel_hi:[1,1,1]
    v_pk_fma_f32 v[102:103], v[38:39], v[22:23], v[102:103] op_sel:[0,1,0] op_sel_hi:[1,1,1]
    v_pk_fma_f32 v[104:105], v[40:41], v[26:27], v[104:105] op_sel:[0,1,0] op_sel_hi:[1,1,1]
    v_pk_fma_f32 v[106:107], v[42:43], v[26:27], v[106:107] op_sel:[0,1,0] op_sel_hi:[1,1,1]
    v_pk_fma_f32 v[108:109], v[44:45], v[30:31], v[108:109] op_sel:[0,1,0] op_sel_hi:[1,1,1]
    v_pk_fma_f32 v[110:111], v[46:47], v[30:31], v[110:111] op_sel:[0,1,0] op_sel_hi:[1,1,1]
    s_branch L_join_50
L_acc_47:
    s_cmp_eq_u32 s71, 3
    s_cbranch_scc1 L_acc_48
    s_cmp_eq_u32 s71, 4
    s_cbranch_scc1 L_acc_49
    v_pk_fma_f32 v[112:113], v[32:33], v[18:19], v[112:113] op_sel:[0,1,0] op_sel_hi:[1,1,1]
    v_pk_fma_f32 v[114:115], v[34:35], v[18:19], v[114:115] op_sel:[0,1,0] op_sel_hi:[1,1,1]
    v_pk_fma_f32 v[116:117], v[36:37], v[22:23], v[116:117] op_sel:[0,1,0] op_sel_hi:[1,1,1]
    v_pk_fma_f32 v[118:119], v[38:39], v[22:23], v[118:119] op_sel:[0,1,0] op_sel_hi:[1,1,1]
    v_pk_fma_f32 v[120:121], v[40:41], v[26:27], v[120:121] op_sel:[0,1,0] op_sel_hi:[1,1,1]
    v_pk_fma_f32 v[122:123], v[42:43], v[26:27], v[122:123] op_sel:[0,1,0] op_sel_hi:[1,1,1]
    v_pk_fma_f32 v[124:125], v[44:45], v[30:31], v[124:125] op_sel:[0,1,0] op_sel_hi:[1,1,1]
    v_pk_fma_f32 v[126:127], v[46:47], v[30:31], v[126:127] op_sel:[0,1,0] op_sel_hi:[1,1,1]
    s_branch L_join_50
L_acc_48:
    v_pk_fma_f32 v[128:129], v[32:33], v[18:19], v[128:129] op_sel:[0,1,0] op_sel_hi:[1,1,1]
    v_pk_fma_f32 v[130:131], v[34:35], v[18:19], v[130:131] op_sel:[0,1,0] op_sel_hi:[1,1,1]
    v_pk_fma_f32 v[132:133], v[36:37], v[22:23], v[132:133] op_sel:[0,1,0] op_sel_hi:[1,1,1]
    v_pk_fma_f32 v[134:135], v[38:39], v[22:23], v[134:135] op_sel:[0,1,0] op_sel_hi:[1,1,1]
    v_pk_fma_f32 v[136:137], v[40:41], v[26:27], v[136:137] op_sel:[0,1,0] op_sel_hi:[1,1,1]
    v_pk_fma_f32 v[138:139], v[42:43], v[26:27], v[138:139] op_sel:[0,1,0] op_sel_hi:[1,1,1]
    v_pk_fma_f32 v[140:141], v[44:45], v[30:31], v[140:141] op_sel:[0,1,0] op_sel_hi:[1,1,1]
    v_pk_fma_f32 v[142:143], v[46:47], v[30:31], v[142:143] op_sel:[0,1,0] op_sel_hi:[1,1,1]
    s_branch L_join_50
L_acc_49:
    v_pk_fma_f32 v[144:145], v[32:33], v[18:19], v[144:145] op_sel:[0,1,0] op_sel_hi:[1,1,1]
    v_pk_fma_f32 v[146:147], v[34:35], v[18:19], v[146:147] op_sel:[0,1,0] op_sel_hi:[1,1,1]
    v_pk_fma_f32 v[148:149], v[36:37], v[22:23], v[148:149] op_sel:[0,1,0] op_sel_hi:[1,1,1]
    v_pk_fma_f32 v[150:151], v[38:39], v[22:23], v[150:151] op_sel:[0,1,0] op_sel_hi:[1,1,1]
    v_pk_fma_f32 v[152:153], v[40:41], v[26:27], v[152:153] op_sel:[0,1,0] op_sel_hi:[1,1,1]
    v_pk_fma_f32 v[154:155], v[42:43], v[26:27], v[154:155] op_sel:[0,1,0] op_sel_hi:[1,1,1]
    v_pk_fma_f32 v[156:157], v[44:45], v[30:31], v[156:157] op_sel:[0,1,0] op_sel_hi:[1,1,1]
    v_pk_fma_f32 v[158:159], v[46:47], v[30:31], v[158:159] op_sel:[0,1,0] op_sel_hi:[1,1,1]
L_join_50:
    s_and_b32 s71, s67, 7
    s_sub_u32 s62, s62, 1
    s_cmp_eq_u32 s62, 0
    s_cbranch_scc1 L_sweep_done
    v_add_u32 v5, 256, v5
    s_branch L_group
L_sweep_done:
    s_add_u32 s73, s73, 1
    s_cmp_lg_u32 s74, 0
    s_cbranch_scc1 L_round
    s_barrier
    v_mul_u32_u24 v16, 320, v1
    v_lshrrev_b32 v17, 2, v1
    v_lshl_add_u32 v16, v17, 3, v16
    s_lshl_b32 s53, s56, 3
    v_add_u32 v17, s53, v16
    s_lshl_b32 s53, s57, 3
    v_add_u32 v18, s53, v16
    s_lshl_b32 s53, s58, 3
    v_add_u32 v19, s53, v16
    s_lshl_b32 s53, s59, 3
    v_add_u32 v20, s53, v16
    s_lshl_b32 s53, s60, 3
    v_add_u32 v21, s53, v16
    v_cvt_pk_bf16_f32 v24, v80, v81
    v_cvt_pk_bf16_f32 v25, v82, v83
    ds_write_b64 v17, v[24:25] offset:0
    v_cvt_pk_bf16_f32 v26, v84, v85
    v_cvt_pk_bf16_f32 v27, v86, v87
    ds_write_b64 v17, v[26:27] offset:20608
    v_cvt_pk_bf16_f32 v28, v88, v89
    v_cvt_pk_bf16_f32 v29, v90, v91
    ds_write_b64 v17, v[28:29] offset:41216
    v_cvt_pk_bf16_f32 v30, v92, v93
    v_cvt_pk_bf16_f32 v31, v94, v95
    ds_write_b64 v17, v[30:31] offset:61824
    v_cvt_pk_bf16_f32 v32, v96, v97
    v_cvt_pk_bf16_f32 v33, v98, v99
    ds_write_b64 v18, v[32:33] offset:0
    v_cvt_pk_bf16_f32 v34, v100, v101
    v_cvt_pk_bf16_f32 v35, v102, v103
    ds_write_b64 v18, v[34:35] offset:20608
    v_cvt_pk_bf16_f32 v36, v104, v105
    v_cvt_pk_bf16_f32 v37, v106, v107
    ds_write_b64 v18, v[36:37] offset:41216
    v_cvt_pk_bf16_f32 v38, v108, v109
    v_cvt_pk_bf16_f32 v39, v110, v111
    ds_write_b64 v18, v[38:39] offset:61824
    v_cvt_pk_bf16_f32 v24, v112, v113
    v_cvt_pk_bf16_f32 v25, v114, v115
    ds_write_b64 v19, v[24:25] offset:0
    v_cvt_pk_bf16_f32 v26, v116, v117
    v_cvt_pk_bf16_f32 v27, v118, v119
    ds_write_b64 v19, v[26:27] offset:20608
    v_cvt_pk_bf16_f32 v28, v120, v121
    v_cvt_pk_bf16_f32 v29, v122, v123
    ds_write_b64 v19, v[28:29] offset:41216
    v_cvt_pk_bf16_f32 v30, v124, v125
    v_cvt_pk_bf16_f32 v31, v126, v127
    ds_write_b64 v19, v[30:31] offset:61824
    v_cvt_pk_bf16_f32 v32, v128, v129
    v_cvt_pk_bf16_f32 v33, v130, v131
    ds_write_b64 v20, v[32:33] offset:0
    v_cvt_pk_bf16_f32 v34, v132, v133
    v_cvt_pk_bf16_f32 v35, v134, v135
    ds_write_b64 v20, v[34:35] offset:20608
    v_cvt_pk_bf16_f32 v36, v136, v137
    v_cvt_pk_bf16_f32 v37, v138, v139
    ds_write_b64 v20, v[36:37] offset:41216
    v_cvt_pk_bf16_f32 v38, v140, v141
    v_cvt_pk_bf16_f32 v39, v142, v143
    ds_write_b64 v20, v[38:39] offset:61824
    v_cvt_pk_bf16_f32 v24, v144, v145
    v_cvt_pk_bf16_f32 v25, v146, v147
    ds_write_b64 v21, v[24:25] offset:0
    v_cvt_pk_bf16_f32 v26, v148, v149
    v_cvt_pk_bf16_f32 v27, v150, v151
    ds_write_b64 v21, v[26:27] offset:20608
    v_cvt_pk_bf16_f32 v28, v152, v153
    v_cvt_pk_bf16_f32 v29, v154, v155
    ds_write_b64 v21, v[28:29] offset:41216
    v_cvt_pk_bf16_f32 v30, v156, v157
    v_cvt_pk_bf16_f32 v31, v158, v159
    ds_write_b64 v21, v[30:31] offset:61824
    v_lshrrev_b32 v40, 5, v1
    v_mul_u32_u24 v41, 2576, v40
    v_bfe_u32 v42, v1, 2, 2
    v_mul_u32_u24 v42, 320, v42
    v_bfe_u32 v43, v1, 4, 1
    v_lshl_add_u32 v41, v43, 5, v41
    v_and_b32 v43, 3, v1
    v_lshl_add_u32 v41, v43, 3, v41
    v_add_u32 v2, v41, v42
    v_add_u32 v3, 41216, v2
    v_bfe_u32 v42, v1, 2, 3
    v_lshlrev_b32 v42, 19, v42
    v_lshl_add_u32 v42, v43, 9, v42
    v_lshl_add_u32 v42, v40, 4, v42
    s_lshl_b32 s53, s2, 11
    s_lshl_b32 s54, s3, 6
    s_add_u32 s53, s53, s54
    v_add_u32 v4, s53, v42
    s_waitcnt lgkmcnt(0)
    s_barrier
    ds_read_b64_tr_b16 v[16:17], v2 offset:0
    ds_read_b64_tr_b16 v[18:19], v2 offset:1288
    ds_read_b64_tr_b16 v[20:21], v2 offset:5152
    ds_read_b64_tr_b16 v[22:23], v2 offset:6440
    ds_read_b64_tr_b16 v[24:25], v2 offset:10304
    ds_read_b64_tr_b16 v[26:27], v2 offset:11592
    ds_read_b64_tr_b16 v[28:29], v2 offset:15456
    ds_read_b64_tr_b16 v[30:31], v2 offset:16744
    ds_read_b64_tr_b16 v[32:33], v2 offset:20608
    ds_read_b64_tr_b16 v[34:35], v2 offset:21896
    ds_read_b64_tr_b16 v[36:37], v2 offset:25760
    ds_read_b64_tr_b16 v[38:39], v2 offset:27048
    ds_read_b64_tr_b16 v[40:41], v2 offset:30912
    ds_read_b64_tr_b16 v[42:43], v2 offset:32200
    ds_read_b64_tr_b16 v[44:45], v2 offset:36064
    ds_read_b64_tr_b16 v[46:47], v2 offset:37352
    s_waitcnt lgkmcnt(8)
    v_mfma_f32_32x32x16_bf16 v[48:63], a[0:3], v[16:19], 0
    v_mfma_f32_32x32x16_bf16 v[48:63], a[4:7], v[20:23], v[48:63]
    v_mfma_f32_32x32x16_bf16 v[48:63], a[8:11], v[24:27], v[48:63]
    v_mfma_f32_32x32x16_bf16 v[48:63], a[12:15], v[28:31], v[48:63]
    ds_read_b64_tr_b16 v[16:17], v3 offset:0
    ds_read_b64_tr_b16 v[18:19], v3 offset:1288
    ds_read_b64_tr_b16 v[20:21], v3 offset:5152
    ds_read_b64_tr_b16 v[22:23], v3 offset:6440
    ds_read_b64_tr_b16 v[24:25], v3 offset:10304
    ds_read_b64_tr_b16 v[26:27], v3 offset:11592
    ds_read_b64_tr_b16 v[28:29], v3 offset:15456
    ds_read_b64_tr_b16 v[30:31], v3 offset:16744
    s_waitcnt lgkmcnt(8)
    v_mfma_f32_32x32x16_bf16 v[48:63], a[16:19], v[32:35], v[48:63]
    v_mfma_f32_32x32x16_bf16 v[48:63], a[20:23], v[36:39], v[48:63]
    v_mfma_f32_32x32x16_bf16 v[48:63], a[24:27], v[40:43], v[48:63]
    v_mfma_f32_32x32x16_bf16 v[48:63], a[28:31], v[44:47], v[48:63]
    ds_read_b64_tr_b16 v[32:33], v3 offset:20608
    ds_read_b64_tr_b16 v[34:35], v3 offset:21896
    ds_read_b64_tr_b16 v[36:37], v3 offset:25760
    ds_read_b64_tr_b16 v[38:39], v3 offset:27048
    ds_read_b64_tr_b16 v[40:41], v3 offset:30912
    ds_read_b64_tr_b16 v[42:43], v3 offset:32200
    ds_read_b64_tr_b16 v[44:45], v3 offset:36064
    ds_read_b64_tr_b16 v[46:47], v3 offset:37352
    s_waitcnt lgkmcnt(8)
    v_mfma_f32_32x32x16_bf16 v[48:63], a[32:35], v[16:19], v[48:63]
    v_mfma_f32_32x32x16_bf16 v[48:63], a[36:39], v[20:23], v[48:63]
    v_mfma_f32_32x32x16_bf16 v[48:63], a[40:43], v[24:27], v[48:63]
    v_mfma_f32_32x32x16_bf16 v[48:63], a[44:47], v[28:31], v[48:63]
    ds_read_b64_tr_b16 v[16:17], v2 offset:64
    ds_read_b64_tr_b16 v[18:19], v2 offset:1352
    ds_read_b64_tr_b16 v[20:21], v2 offset:5216
    ds_read_b64_tr_b16 v[22:23], v2 offset:6504
    ds_read_b64_tr_b16 v[24:25], v2 offset:10368
    ds_read_b64_tr_b16 v[26:27], v2 offset:11656
    ds_read_b64_tr_b16 v[28:29], v2 offset:15520
    ds_read_b64_tr_b16 v[30:31], v2 offset:16808
    s_waitcnt lgkmcnt(8)
    v_mfma_f32_32x32x16_bf16 v[48:63], a[48:51], v[32:35], v[48:63]
    v_mfma_f32_32x32x16_bf16 v[48:63], a[52:55], v[36:39], v[48:63]
    v_mfma_f32_32x32x16_bf16 v[48:63], a[56:59], v[40:43], v[48:63]
    v_mfma_f32_32x32x16_bf16 v[48:63], a[60:63], v[44:47], v[48:63]
    ds_read_b64_tr_b16 v[32:33], v2 offset:20672
    ds_read_b64_tr_b16 v[34:35], v2 offset:21960
    ds_read_b64_tr_b16 v[36:37], v2 offset:25824
    ds_read_b64_tr_b16 v[38:39], v2 offset:27112
    ds_read_b64_tr_b16 v[40:41], v2 offset:30976
    ds_read_b64_tr_b16 v[42:43], v2 offset:32264
    ds_read_b64_tr_b16 v[44:45], v2 offset:36128
    ds_read_b64_tr_b16 v[46:47], v2 offset:37416
    s_waitcnt lgkmcnt(8)
    v_mfma_f32_32x32x16_bf16 v[64:79], a[0:3], v[16:19], 0
    v_mfma_f32_32x32x16_bf16 v[64:79], a[4:7], v[20:23], v[64:79]
    v_mfma_f32_32x32x16_bf16 v[64:79], a[8:11], v[24:27], v[64:79]
    v_mfma_f32_32x32x16_bf16 v[64:79], a[12:15], v[28:31], v[64:79]
    s_nop 7
    v_cvt_pk_bf16_f32 v80, v48, v49
    v_cvt_pk_bf16_f32 v81, v50, v51
    v_cvt_pk_bf16_f32 v82, v52, v53
    v_cvt_pk_bf16_f32 v83, v54, v55
    v_cvt_pk_bf16_f32 v84, v56, v57
    v_cvt_pk_bf16_f32 v85, v58, v59
    v_cvt_pk_bf16_f32 v86, v60, v61
    v_cvt_pk_bf16_f32 v87, v62, v63
    s_nop 1
    v_permlane32_swap_b32 v80, v82
    v_permlane32_swap_b32 v81, v83
    v_permlane32_swap_b32 v84, v86
    v_permlane32_swap_b32 v85, v87
    buffer_store_dwordx4 v[80:83], v4, s[32:35], 0 offen
    buffer_store_dwordx4 v[84:87], v4, s[32:35], 0 offen offset:32
    v_add_u32 v4, 4194304, v4
    ds_read_b64_tr_b16 v[16:17], v3 offset:64
    ds_read_b64_tr_b16 v[18:19], v3 offset:1352
    ds_read_b64_tr_b16 v[20:21], v3 offset:5216
    ds_read_b64_tr_b16 v[22:23], v3 offset:6504
    ds_read_b64_tr_b16 v[24:25], v3 offset:10368
    ds_read_b64_tr_b16 v[26:27], v3 offset:11656
    ds_read_b64_tr_b16 v[28:29], v3 offset:15520
    ds_read_b64_tr_b16 v[30:31], v3 offset:16808
    s_waitcnt lgkmcnt(8)
    v_mfma_f32_32x32x16_bf16 v[64:79], a[16:19], v[32:35], v[64:79]
    v_mfma_f32_32x32x16_bf16 v[64:79], a[20:23], v[36:39], v[64:79]
    v_mfma_f32_32x32x16_bf16 v[64:79], a[24:27], v[40:43], v[64:79]
    v_mfma_f32_32x32x16_bf16 v[64:79], a[28:31], v[44:47], v[64:79]
    ds_read_b64_tr_b16 v[32:33], v3 offset:20672
    ds_read_b64_tr_b16 v[34:35], v3 offset:21960
    ds_read_b64_tr_b16 v[36:37], v3 offset:25824
    ds_read_b64_tr_b16 v[38:39], v3 offset:27112
    ds_read_b64_tr_b16 v[40:41], v3 offset:30976
    ds_read_b64_tr_b16 v[42:43], v3 offset:32264
    ds_read_b64_tr_b16 v[44:45], v3 offset:36128
    ds_read_b64_tr_b16 v[46:47], v3 offset:37416
    s_waitcnt lgkmcnt(8)
    v_mfma_f32_32x32x16_bf16 v[64:79], a[32:35], v[16:19], v[64:79]
    v_mfma_f32_32x32x16_bf16 v[64:79], a[36:39], v[20:23], v[64:79]
    v_mfma_f32_32x32x16_bf16 v[64:79], a[40:43], v[24:27], v[64:79]
    v_mfma_f32_32x32x16_bf16 v[64:79], a[44:47], v[28:31], v[64:79]
    ds_read_b64_tr_b16 v[16:17], v2 offset:128
    ds_read_b64_tr_b16 v[18:19], v2 offset:1416
    ds_read_b64_tr_b16 v[20:21], v2 offset:5280
    ds_read_b64_tr_b16 v[22:23], v2 offset:6568
    ds_read_b64_tr_b16 v[24:25], v2 offset:10432
    ds_read_b64_tr_b16 v[26:27], v2 offset:11720
    ds_read_b64_tr_b16 v[28:29], v2 offset:15584
    ds_read_b64_tr_b16 v[30:31], v2 offset:16872
    s_waitcnt lgkmcnt(8)
    v_mfma_f32_32x32x16_bf16 v[64:79], a[48:51], v[32:35], v[64:79]
    v_mfma_f32_32x32x16_bf16 v[64:79], a[52:55], v[36:39], v[64:79]
    v_mfma_f32_32x32x16_bf16 v[64:79], a[56:59], v[40:43], v[64:79]
    v_mfma_f32_32x32x16_bf16 v[64:79], a[60:63], v[44:47], v[64:79]
    ds_read_b64_tr_b16 v[32:33], v2 offset:20736
    ds_read_b64_tr_b16 v[34:35], v2 offset:22024
    ds_read_b64_tr_b16 v[36:37], v2 offset:25888
    ds_read_b64_tr_b16 v[38:39], v2 offset:27176
    ds_read_b64_tr_b16 v[40:41], v2 offset:31040
    ds_read_b64_tr_b16 v[42:43], v2 offset:32328
    ds_read_b64_tr_b16 v[44:45], v2 offset:36192
    ds_read_b64_tr_b16 v[46:47], v2 offset:37480
    s_waitcnt lgkmcnt(8)
    v_mfma_f32_32x32x16_bf16 v[48:63], a[0:3], v[16:19], 0
    v_mfma_f32_32x32x16_bf16 v[48:63], a[4:7], v[20:23], v[48:63]
    v_mfma_f32_32x32x16_bf16 v[48:63], a[8:11], v[24:27], v[48:63]
    v_mfma_f32_32x32x16_bf16 v[48:63], a[12:15], v[28:31], v[48:63]
    s_nop 7
    v_cvt_pk_bf16_f32 v88, v64, v65
    v_cvt_pk_bf16_f32 v89, v66, v67
    v_cvt_pk_bf16_f32 v90, v68, v69
    v_cvt_pk_bf16_f32 v91, v70, v71
    v_cvt_pk_bf16_f32 v92, v72, v73
    v_cvt_pk_bf16_f32 v93, v74, v75
    v_cvt_pk_bf16_f32 v94, v76, v77
    v_cvt_pk_bf16_f32 v95, v78, v79
    s_nop 1
    v_permlane32_swap_b32 v88, v90
    v_permlane32_swap_b32 v89, v91
    v_permlane32_swap_b32 v92, v94
    v_permlane32_swap_b32 v93, v95
    buffer_store_dwordx4 v[88:91], v4, s[32:35], 0 offen
    buffer_store_dwordx4 v[92:95], v4, s[32:35], 0 offen offset:32
    v_add_u32 v4, 4194304, v4
    ds_read_b64_tr_b16 v[16:17], v3 offset:128
    ds_read_b64_tr_b16 v[18:19], v3 offset:1416
    ds_read_b64_tr_b16 v[20:21], v3 offset:5280
    ds_read_b64_tr_b16 v[22:23], v3 offset:6568
    ds_read_b64_tr_b16 v[24:25], v3 offset:10432
    ds_read_b64_tr_b16 v[26:27], v3 offset:11720
    ds_read_b64_tr_b16 v[28:29], v3 offset:15584
    ds_read_b64_tr_b16 v[30:31], v3 offset:16872
    s_waitcnt lgkmcnt(8)
    v_mfma_f32_32x32x16_bf16 v[48:63], a[16:19], v[32:35], v[48:63]
    v_mfma_f32_32x32x16_bf16 v[48:63], a[20:23], v[36:39], v[48:63]
    v_mfma_f32_32x32x16_bf16 v[48:63], a[24:27], v[40:43], v[48:63]
    v_mfma_f32_32x32x16_bf16 v[48:63], a[28:31], v[44:47], v[48:63]
    ds_read_b64_tr_b16 v[32:33], v3 offset:20736
    ds_read_b64_tr_b16 v[34:35], v3 offset:22024
    ds_read_b64_tr_b16 v[36:37], v3 offset:25888
    ds_read_b64_tr_b16 v[38:39], v3 offset:27176
    ds_read_b64_tr_b16 v[40:41], v3 offset:31040
    ds_read_b64_tr_b16 v[42:43], v3 offset:32328
    ds_read_b64_tr_b16 v[44:45], v3 offset:36192
    ds_read_b64_tr_b16 v[46:47], v3 offset:37480
    s_waitcnt lgkmcnt(8)
    v_mfma_f32_32x32x16_bf16 v[48:63], a[32:35], v[16:19], v[48:63]
    v_mfma_f32_32x32x16_bf16 v[48:63], a[36:39], v[20:23], v[48:63]
    v_mfma_f32_32x32x16_bf16 v[48:63], a[40:43], v[24:27], v[48:63]
    v_mfma_f32_32x32x16_bf16 v[48:63], a[44:47], v[28:31], v[48:63]
    ds_read_b64_tr_b16 v[16:17], v2 offset:192
    ds_read_b64_tr_b16 v[18:19], v2 offset:1480
    ds_read_b64_tr_b16 v[20:21], v2 offset:5344
    ds_read_b64_tr_b16 v[22:23], v2 offset:6632
    ds_read_b64_tr_b16 v[24:25], v2 offset:10496
    ds_read_b64_tr_b16 v[26:27], v2 offset:11784
    ds_read_b64_tr_b16 v[28:29], v2 offset:15648
    ds_read_b64_tr_b16 v[30:31], v2 offset:16936
    s_waitcnt lgkmcnt(8)
    v_mfma_f32_32x32x16_bf16 v[48:63], a[48:51], v[32:35], v[48:63]
    v_mfma_f32_32x32x16_bf16 v[48:63], a[52:55], v[36:39], v[48:63]
    v_mfma_f32_32x32x16_bf16 v[48:63], a[56:59], v[40:43], v[48:63]
    v_mfma_f32_32x32x16_bf16 v[48:63], a[60:63], v[44:47], v[48:63]
    ds_read_b64_tr_b16 v[32:33], v2 offset:20800
    ds_read_b64_tr_b16 v[34:35], v2 offset:22088
    ds_read_b64_tr_b16 v[36:37], v2 offset:25952
    ds_read_b64_tr_b16 v[38:39], v2 offset:27240
    ds_read_b64_tr_b16 v[40:41], v2 offset:31104
    ds_read_b64_tr_b16 v[42:43], v2 offset:32392
    ds_read_b64_tr_b16 v[44:45], v2 offset:36256
    ds_read_b64_tr_b16 v[46:47], v2 offset:37544
    s_waitcnt lgkmcnt(8)
    v_mfma_f32_32x32x16_bf16 v[64:79], a[0:3], v[16:19], 0
    v_mfma_f32_32x32x16_bf16 v[64:79], a[4:7], v[20:23], v[64:79]
    v_mfma_f32_32x32x16_bf16 v[64:79], a[8:11], v[24:27], v[64:79]
    v_mfma_f32_32x32x16_bf16 v[64:79], a[12:15], v[28:31], v[64:79]
    s_nop 7
    v_cvt_pk_bf16_f32 v80, v48, v49
    v_cvt_pk_bf16_f32 v81, v50, v51
    v_cvt_pk_bf16_f32 v82, v52, v53
    v_cvt_pk_bf16_f32 v83, v54, v55
    v_cvt_pk_bf16_f32 v84, v56, v57
    v_cvt_pk_bf16_f32 v85, v58, v59
    v_cvt_pk_bf16_f32 v86, v60, v61
    v_cvt_pk_bf16_f32 v87, v62, v63
    s_nop 1
    v_permlane32_swap_b32 v80, v82
    v_permlane32_swap_b32 v81, v83
    v_permlane32_swap_b32 v84, v86
    v_permlane32_swap_b32 v85, v87
    buffer_store_dwordx4 v[80:83], v4, s[32:35], 0 offen
    buffer_store_dwordx4 v[84:87], v4, s[32:35], 0 offen offset:32
    v_add_u32 v4, 4194304, v4
    ds_read_b64_tr_b16 v[16:17], v3 offset:192
    ds_read_b64_tr_b16 v[18:19], v3 offset:1480
    ds_read_b64_tr_b16 v[20:21], v3 offset:5344
    ds_read_b64_tr_b16 v[22:23], v3 offset:6632
    ds_read_b64_tr_b16 v[24:25], v3 offset:10496
    ds_read_b64_tr_b16 v[26:27], v3 offset:11784
    ds_read_b64_tr_b16 v[28:29], v3 offset:15648
    ds_read_b64_tr_b16 v[30:31], v3 offset:16936
    s_waitcnt lgkmcnt(8)
    v_mfma_f32_32x32x16_bf16 v[64:79], a[16:19], v[32:35], v[64:79]
    v_mfma_f32_32x32x16_bf16 v[64:79], a[20:23], v[36:39], v[64:79]
    v_mfma_f32_32x32x16_bf16 v[64:79], a[24:27], v[40:43], v[64:79]
    v_mfma_f32_32x32x16_bf16 v[64:79], a[28:31], v[44:47], v[64:79]
    ds_read_b64_tr_b16 v[32:33], v3 offset:20800
    ds_read_b64_tr_b16 v[34:35], v3 offset:22088
    ds_read_b64_tr_b16 v[36:37], v3 offset:25952
    ds_read_b64_tr_b16 v[38:39], v3 offset:27240
    ds_read_b64_tr_b16 v[40:41], v3 offset:31104
    ds_read_b64_tr_b16 v[42:43], v3 offset:32392
    ds_read_b64_tr_b16 v[44:45], v3 offset:36256
    ds_read_b64_tr_b16 v[46:47], v3 offset:37544
    s_waitcnt lgkmcnt(8)
    v_mfma_f32_32x32x16_bf16 v[64:79], a[32:35], v[16:19], v[64:79]
    v_mfma_f32_32x32x16_bf16 v[64:79], a[36:39], v[20:23], v[64:79]
    v_mfma_f32_32x32x16_bf16 v[64:79], a[40:43], v[24:27], v[64:79]
    v_mfma_f32_32x32x16_bf16 v[64:79], a[44:47], v[28:31], v[64:79]
    ds_read_b64_tr_b16 v[16:17], v2 offset:256
    ds_read_b64_tr_b16 v[18:19], v2 offset:1544
    ds_read_b64_tr_b16 v[20:21], v2 offset:5408
    ds_read_b64_tr_b16 v[22:23], v2 offset:6696
    ds_read_b64_tr_b16 v[24:25], v2 offset:10560
    ds_read_b64_tr_b16 v[26:27], v2 offset:11848
    ds_read_b64_tr_b16 v[28:29], v2 offset:15712
    ds_read_b64_tr_b16 v[30:31], v2 offset:17000
    s_waitcnt lgkmcnt(8)
    v_mfma_f32_32x32x16_bf16 v[64:79], a[48:51], v[32:35], v[64:79]
    v_mfma_f32_32x32x16_bf16 v[64:79], a[52:55], v[36:39], v[64:79]
    v_mfma_f32_32x32x16_bf16 v[64:79], a[56:59], v[40:43], v[64:79]
    v_mfma_f32_32x32x16_bf16 v[64:79], a[60:63], v[44:47], v[64:79]
    ds_read_b64_tr_b16 v[32:33], v2 offset:20864
    ds_read_b64_tr_b16 v[34:35], v2 offset:22152
    ds_read_b64_tr_b16 v[36:37], v2 offset:26016
    ds_read_b64_tr_b16 v[38:39], v2 offset:27304
    ds_read_b64_tr_b16 v[40:41], v2 offset:31168
    ds_read_b64_tr_b16 v[42:43], v2 offset:32456
    ds_read_b64_tr_b16 v[44:45], v2 offset:36320
    ds_read_b64_tr_b16 v[46:47], v2 offset:37608
    s_waitcnt lgkmcnt(8)
    v_mfma_f32_32x32x16_bf16 v[48:63], a[0:3], v[16:19], 0
    v_mfma_f32_32x32x16_bf16 v[48:63], a[4:7], v[20:23], v[48:63]
    v_mfma_f32_32x32x16_bf16 v[48:63], a[8:11], v[24:27], v[48:63]
    v_mfma_f32_32x32x16_bf16 v[48:63], a[12:15], v[28:31], v[48:63]
    s_nop 7
    v_cvt_pk_bf16_f32 v88, v64, v65
    v_cvt_pk_bf16_f32 v89, v66, v67
    v_cvt_pk_bf16_f32 v90, v68, v69
    v_cvt_pk_bf16_f32 v91, v70, v71
    v_cvt_pk_bf16_f32 v92, v72, v73
    v_cvt_pk_bf16_f32 v93, v74, v75
    v_cvt_pk_bf16_f32 v94, v76, v77
    v_cvt_pk_bf16_f32 v95, v78, v79
    s_nop 1
    v_permlane32_swap_b32 v88, v90
    v_permlane32_swap_b32 v89, v91
    v_permlane32_swap_b32 v92, v94
    v_permlane32_swap_b32 v93, v95
    buffer_store_dwordx4 v[88:91], v4, s[32:35], 0 offen
    buffer_store_dwordx4 v[92:95], v4, s[32:35], 0 offen offset:32
    v_add_u32 v4, 4194304, v4
    ds_read_b64_tr_b16 v[16:17], v3 offset:256
    ds_read_b64_tr_b16 v[18:19], v3 offset:1544
    ds_read_b64_tr_b16 v[20:21], v3 offset:5408
    ds_read_b64_tr_b16 v[22:23], v3 offset:6696
    ds_read_b64_tr_b16 v[24:25], v3 offset:10560
    ds_read_b64_tr_b16 v[26:27], v3 offset:11848
    ds_read_b64_tr_b16 v[28:29], v3 offset:15712
    ds_read_b64_tr_b16 v[30:31], v3 offset:17000
    s_waitcnt lgkmcnt(8)
    v_mfma_f32_32x32x16_bf16 v[48:63], a[16:19], v[32:35], v[48:63]
    v_mfma_f32_32x32x16_bf16 v[48:63], a[20:23], v[36:39], v[48:63]
    v_mfma_f32_32x32x16_bf16 v[48:63], a[24:27], v[40:43], v[48:63]
    v_mfma_f32_32x32x16_bf16 v[48:63], a[28:31], v[44:47], v[48:63]
    ds_read_b64_tr_b16 v[32:33], v3 offset:20864
    ds_read_b64_tr_b16 v[34:35], v3 offset:22152
    ds_read_b64_tr_b16 v[36:37], v3 offset:26016
    ds_read_b64_tr_b16 v[38:39], v3 offset:27304
    ds_read_b64_tr_b16 v[40:41], v3 offset:31168
    ds_read_b64_tr_b16 v[42:43], v3 offset:32456
    ds_read_b64_tr_b16 v[44:45], v3 offset:36320
    ds_read_b64_tr_b16 v[46:47], v3 offset:37608
    s_waitcnt lgkmcnt(8)
    v_mfma_f32_32x32x16_bf16 v[48:63], a[32:35], v[16:19], v[48:63]
    v_mfma_f32_32x32x16_bf16 v[48:63], a[36:39], v[20:23], v[48:63]
    v_mfma_f32_32x32x16_bf16 v[48:63], a[40:43], v[24:27], v[48:63]
    v_mfma_f32_32x32x16_bf16 v[48:63], a[44:47], v[28:31], v[48:63]
    s_waitcnt lgkmcnt(0)
    v_mfma_f32_32x32x16_bf16 v[48:63], a[48:51], v[32:35], v[48:63]
    v_mfma_f32_32x32x16_bf16 v[48:63], a[52:55], v[36:39], v[48:63]
    v_mfma_f32_32x32x16_bf16 v[48:63], a[56:59], v[40:43], v[48:63]
    v_mfma_f32_32x32x16_bf16 v[48:63], a[60:63], v[44:47], v[48:63]
    s_nop 11
    v_cvt_pk_bf16_f32 v80, v48, v49
    v_cvt_pk_bf16_f32 v81, v50, v51
    v_cvt_pk_bf16_f32 v82, v52, v53
    v_cvt_pk_bf16_f32 v83, v54, v55
    v_cvt_pk_bf16_f32 v84, v56, v57
    v_cvt_pk_bf16_f32 v85, v58, v59
    v_cvt_pk_bf16_f32 v86, v60, v61
    v_cvt_pk_bf16_f32 v87, v62, v63
    s_nop 1
    v_permlane32_swap_b32 v80, v82
    v_permlane32_swap_b32 v81, v83
    v_permlane32_swap_b32 v84, v86
    v_permlane32_swap_b32 v85, v87
    buffer_store_dwordx4 v[80:83], v4, s[32:35], 0 offen
    buffer_store_dwordx4 v[84:87], v4, s[32:35], 0 offen offset:32
    v_add_u32 v4, 4194304, v4
L_end:
    s_endpgm
.section .rodata,"a"
.p2align 6
.amdhsa_kernel standalone__tensor_product_equiv_mace__graph_kernel
  .amdhsa_next_free_vgpr 256
  .amdhsa_next_free_sgpr 102
  .amdhsa_accum_offset 160
  .amdhsa_group_segment_fixed_size 0
  .amdhsa_kernarg_size 88
  .amdhsa_user_sgpr_count 2
  .amdhsa_user_sgpr_kernarg_segment_ptr 1
  .amdhsa_system_sgpr_workgroup_id_x 1
  .amdhsa_float_denorm_mode_32 3
.end_amdhsa_kernel
```

```asm
; @launch kernel=bin_edges_kernel grid=(78,1,1) block=(640,1,1) lds=33792
; @launch kernel=standalone__tensor_product_equiv_mace__graph_kernel grid=(256,1,1) block=(512,1,1) lds=156160
.amdgcn_target "amdgcn-amd-amdhsa--gfx950"
.text
.globl bin_edges_kernel
.p2align 8
.type bin_edges_kernel,@function
bin_edges_kernel:
    s_cmp_ge_u32 s2, 78
    s_cbranch_scc1 K_end
    s_load_dwordx16 s[16:31], s[0:1], 0
    s_load_dwordx2 s[32:33], s[0:1], 80
    s_cmp_ge_u32 s2, 64
    s_cbranch_scc1 K_weights
    s_mul_i32 s3, s2, 10000
    v_lshlrev_b32 v1, 4, v0
    v_add_u32 v2, s3, v1
    s_mov_b32 s14, 625
    v_cmp_gt_u32 s[34:35], s14, v0
    s_waitcnt lgkmcnt(0)
    s_mov_b32 s4, s20
    s_mov_b32 s5, s21
    s_mov_b32 s6, 640000
    s_mov_b32 s7, 0x00020000
    s_mov_b32 s8, s18
    s_mov_b32 s9, s19
    s_mov_b32 s10, 640000
    s_mov_b32 s11, 0x00020000
    buffer_load_dwordx4 v[4:7], v2, s[4:7], 0 offen
    buffer_load_dwordx4 v[8:11], v2, s[8:11], 0 offen
    s_mov_b32 s12, s32
    s_mov_b32 s13, s33
    s_mov_b32 s14, 8388608
    s_mov_b32 s15, 0x00020000
    v_mov_b32 v12, -1
    v_mov_b32 v13, -1
    v_mov_b32 v14, -1
    v_mov_b32 v15, -1
    ds_write_b128 v1, v[12:15]
    ds_write_b128 v1, v[12:15] offset:10240
    ds_write_b128 v1, v[12:15] offset:20480
    v_cmp_gt_u32 vcc, 128, v0
    v_mov_b32 v16, 0
    v_mov_b32 v17, 0
    v_lshlrev_b32 v3, 3, v0
    s_mov_b64 exec, vcc
    ds_write_b128 v1, v[12:15] offset:30720
    ds_write_b64 v3, v[16:17] offset:32768
    s_mov_b64 exec, -1
    v_mov_b32 v18, 1
    v_lshlrev_b32 v19, 22, v0
    s_waitcnt lgkmcnt(0)
    s_barrier
    s_waitcnt vmcnt(1)
    v_and_b32 v20, 255, v4
    v_lshlrev_b32 v24, 2, v20
    v_and_b32 v21, 255, v5
    v_lshlrev_b32 v25, 2, v21
    v_and_b32 v22, 255, v6
    v_lshlrev_b32 v26, 2, v22
    v_and_b32 v23, 255, v7
    v_lshlrev_b32 v27, 2, v23
    s_mov_b64 exec, s[34:35]
    ds_add_rtn_u32 v28, v24, v18 offset:32768
    ds_add_rtn_u32 v29, v25, v18 offset:32768
    ds_add_rtn_u32 v30, v26, v18 offset:32768
    ds_add_rtn_u32 v31, v27, v18 offset:32768
    s_mov_b64 exec, -1
    s_waitcnt vmcnt(0)
    v_bfe_u32 v4, v4, 8, 6
    v_and_b32 v8, 0x3fff, v8
    v_lshl_or_b32 v4, v8, 6, v4
    v_add_u32 v8, 0, v19
    v_or_b32 v4, v4, v8
    v_bfe_u32 v5, v5, 8, 6
    v_and_b32 v9, 0x3fff, v9
    v_lshl_or_b32 v5, v9, 6, v5
    v_add_u32 v9, 1048576, v19
    v_or_b32 v5, v5, v9
    v_bfe_u32 v6, v6, 8, 6
    v_and_b32 v10, 0x3fff, v10
    v_lshl_or_b32 v6, v10, 6, v6
    v_add_u32 v10, 2097152, v19
    v_or_b32 v6, v6, v10
    v_bfe_u32 v7, v7, 8, 6
    v_and_b32 v11, 0x3fff, v11
    v_lshl_or_b32 v7, v11, 6, v7
    v_add_u32 v11, 3145728, v19
    v_or_b32 v7, v7, v11
    v_mov_b32 v12, -2
    s_waitcnt lgkmcnt(0)
    v_cmp_gt_u32 vcc, 31, v28
    v_min_u32 v28, 31, v28
    v_lshlrev_b32 v28, 2, v28
    v_cndmask_b32 v4, v12, v4, vcc
    v_lshl_add_u32 v28, v20, 7, v28
    v_cmp_gt_u32 vcc, 31, v29
    v_min_u32 v29, 31, v29
    v_lshlrev_b32 v29, 2, v29
    v_cndmask_b32 v5, v12, v5, vcc
    v_lshl_add_u32 v29, v21, 7, v29
    v_cmp_gt_u32 vcc, 31, v30
    v_min_u32 v30, 31, v30
    v_lshlrev_b32 v30, 2, v30
    v_cndmask_b32 v6, v12, v6, vcc
    v_lshl_add_u32 v30, v22, 7, v30
    v_cmp_gt_u32 vcc, 31, v31
    v_min_u32 v31, 31, v31
    v_lshlrev_b32 v31, 2, v31
    v_cndmask_b32 v7, v12, v7, vcc
    v_lshl_add_u32 v31, v23, 7, v31
    s_mov_b64 exec, s[34:35]
    ds_write_b32 v28, v4
    ds_write_b32 v29, v5
    ds_write_b32 v30, v6
    ds_write_b32 v31, v7
    s_mov_b64 exec, -1
    v_lshrrev_b32 v2, 3, v0
    v_lshlrev_b32 v2, 13, v2
    v_and_b32 v3, 7, v0
    v_lshl_add_u32 v2, v3, 4, v2
    s_lshl_b32 s3, s2, 7
    v_add_u32 v2, s3, v2
    v_cmp_gt_u32 vcc, 128, v0
    s_waitcnt lgkmcnt(0)
    s_barrier
    ds_read_b128 v[32:35], v1 offset:0
    ds_read_b128 v[36:39], v1 offset:10240
    ds_read_b128 v[40:43], v1 offset:20480
    ds_read_b128 v[44:47], v1 offset:30720
    s_waitcnt lgkmcnt(3)
    buffer_store_dwordx4 v[32:35], v2, s[12:15], 0 offen
    v_add_u32 v2, 655360, v2
    s_waitcnt lgkmcnt(2)
    buffer_store_dwordx4 v[36:39], v2, s[12:15], 0 offen
    v_add_u32 v2, 655360, v2
    s_waitcnt lgkmcnt(1)
    buffer_store_dwordx4 v[40:43], v2, s[12:15], 0 offen
    v_add_u32 v2, 655360, v2
    s_and_saveexec_b64 s[36:37], vcc
    s_cbranch_execz K_end
    s_waitcnt lgkmcnt(0)
    buffer_store_dwordx4 v[44:47], v2, s[12:15], 0 offen
    s_branch K_end
K_weights:
    v_lshrrev_b32 v1, 6, v0
    v_and_b32 v2, 63, v0
    v_readfirstlane_b32 s3, v1
    s_sub_u32 s34, s2, 64
    s_mul_i32 s34, s34, 10
    s_add_u32 s3, s3, s34
    s_cmp_ge_u32 s3, 136
    s_cbranch_scc1 K_end
    s_waitcnt lgkmcnt(0)
    s_mov_b32 s12, s32
    s_mov_b32 s13, s33
    s_mov_b32 s14, 8388608
    s_mov_b32 s15, 0x00020000
    s_lshl_b32 s34, s3, 10
    s_add_u32 s34, s34, 2097152
    v_lshlrev_b32 v3, 4, v2
    v_add_u32 v3, s34, v3
    s_cmp_ge_u32 s3, 128
    s_cbranch_scc1 K_wr
    s_mov_b32 s4, s30
    s_mov_b32 s5, s31
    s_mov_b32 s6, 131072
    s_mov_b32 s7, 0x00020000
    s_and_b32 s34, s3, 15
    s_lshl_b32 s34, s34, 13
    s_lshr_b32 s35, s3, 4
    s_lshl_b32 s35, s35, 6
    s_add_u32 s34, s34, s35
    v_lshrrev_b32 v4, 5, v2
    v_lshlrev_b32 v4, 12, v4
    v_and_b32 v5, 31, v2
    v_lshl_add_u32 v4, v5, 1, v4
    v_add_u32 v4, s34, v4
    s_branch K_wgo
K_wr:
    s_mov_b32 s4, s28
    s_mov_b32 s5, s29
    s_mov_b32 s6, 8192
    s_mov_b32 s7, 0x00020000
    s_sub_u32 s34, s3, 128
    s_lshl_b32 s34, s34, 6
    v_bfe_u32 v4, v2, 4, 1
    v_lshlrev_b32 v4, 12, v4
    v_lshrrev_b32 v5, 5, v2
    v_lshl_add_u32 v4, v5, 5, v4
    v_and_b32 v5, 15, v2
    v_lshl_add_u32 v4, v5, 1, v4
    v_add_u32 v4, s34, v4
K_wgo:
    buffer_load_ushort v16, v4, s[4:7], 0 offen offset:0
    buffer_load_ushort v17, v4, s[4:7], 0 offen offset:512
    buffer_load_ushort v18, v4, s[4:7], 0 offen offset:1024
    buffer_load_ushort v19, v4, s[4:7], 0 offen offset:1536
    buffer_load_ushort v20, v4, s[4:7], 0 offen offset:2048
    buffer_load_ushort v21, v4, s[4:7], 0 offen offset:2560
    buffer_load_ushort v22, v4, s[4:7], 0 offen offset:3072
    buffer_load_ushort v23, v4, s[4:7], 0 offen offset:3584
    s_waitcnt vmcnt(0)
    v_lshl_or_b32 v8, v17, 16, v16
    v_lshl_or_b32 v9, v19, 16, v18
    v_lshl_or_b32 v10, v21, 16, v20
    v_lshl_or_b32 v11, v23, 16, v22
    buffer_store_dwordx4 v[8:11], v3, s[12:15], 0 offen
K_end:
    s_endpgm
.globl standalone__tensor_product_equiv_mace__graph_kernel
.p2align 8
.type standalone__tensor_product_equiv_mace__graph_kernel,@function
standalone__tensor_product_equiv_mace__graph_kernel:
    s_cmp_ge_u32 s2, 256
    s_cbranch_scc1 L_end
    s_load_dwordx16 s[64:79], s[0:1], 0
    s_load_dwordx4 s[80:83], s[0:1], 64
    s_load_dwordx2 s[84:85], s[0:1], 80
    v_and_b32 v1, 63, v0
    v_lshrrev_b32 v16, 6, v0
    v_mov_b32 v12, 0
    v_readfirstlane_b32 s3, v16
    s_lshl_b32 s53, s2, 13
    v_lshlrev_b32 v20, 4, v0
    v_add_u32 v20, s53, v20
    v_lshlrev_b32 v21, 4, v1
    v_add_u32 v21, 2228224, v21
    s_waitcnt lgkmcnt(0)
    s_mov_b32 s44, s84
    s_mov_b32 s45, s85
    s_mov_b32 s46, 8388608
    s_mov_b32 s47, 0x00020000
    buffer_load_dwordx4 v[16:19], v20, s[44:47], 0 offen
    v_add_u32 v22, 4096, v21
    buffer_load_dwordx4 a[0:3], v21, s[44:47], 0 offen offset:0
    buffer_load_dwordx4 a[4:7], v21, s[44:47], 0 offen offset:1024
    buffer_load_dwordx4 a[8:11], v21, s[44:47], 0 offen offset:2048
    buffer_load_dwordx4 a[12:15], v21, s[44:47], 0 offen offset:3072
    buffer_load_dwordx4 a[16:19], v22, s[44:47], 0 offen offset:0
    buffer_load_dwordx4 a[20:23], v22, s[44:47], 0 offen offset:1024
    buffer_load_dwordx4 a[24:27], v22, s[44:47], 0 offen offset:2048
    buffer_load_dwordx4 a[28:31], v22, s[44:47], 0 offen offset:3072
    s_mov_b32 s8, s64
    s_mov_b32 s9, s65
    s_mov_b32 s10, 20480000
    s_mov_b32 s11, 0x00020000
    s_mov_b32 s12, s66
    s_mov_b32 s13, s67
    s_mov_b32 s14, 640000
    s_mov_b32 s15, 0x00020000
    s_mov_b32 s16, s68
    s_mov_b32 s17, s69
    s_mov_b32 s18, 640000
    s_mov_b32 s19, 0x00020000
    s_mov_b32 s20, s70
    s_mov_b32 s21, s71
    s_mov_b32 s22, 1280000
    s_mov_b32 s23, 0x00020000
    s_mov_b32 s24, s72
    s_mov_b32 s25, s73
    s_mov_b32 s26, 5120000
    s_mov_b32 s27, 0x00020000
    s_mov_b32 s40, s74
    s_mov_b32 s41, s75
    s_mov_b32 s42, 128
    s_mov_b32 s43, 0x00020000
    s_mov_b32 s32, s80
    s_mov_b32 s33, s81
    s_mov_b32 s34, 20480000
    s_mov_b32 s35, 0x00020000
    v_mov_b32 v28, 0
    v_mov_b32 v29, 0
    v_lshlrev_b32 v20, 3, v0
    v_add_u32 v20, 147712, v20
    ds_write_b64 v20, v[28:29]
    v_and_b32 v20, 3, v1
    v_lshlrev_b32 v20, 3, v20
    v_add_u32 v20, 155904, v20
    ds_write_b64 v20, v[28:29]
    v_mov_b32 v80, 0
    v_mov_b32 v81, 0
    v_mov_b32 v82, 0
    v_mov_b32 v83, 0
    v_mov_b32 v84, 0
    v_mov_b32 v85, 0
    v_mov_b32 v86, 0
    v_mov_b32 v87, 0
    v_mov_b32 v88, 0
    v_mov_b32 v89, 0
    v_mov_b32 v90, 0
    v_mov_b32 v91, 0
    v_mov_b32 v92, 0
    v_mov_b32 v93, 0
    v_mov_b32 v94, 0
    v_mov_b32 v95, 0
    v_mov_b32 v96, 0
    v_mov_b32 v97, 0
    v_mov_b32 v98, 0
    v_mov_b32 v99, 0
    v_mov_b32 v100, 0
    v_mov_b32 v101, 0
    v_mov_b32 v102, 0
    v_mov_b32 v103, 0
    v_mov_b32 v104, 0
    v_mov_b32 v105, 0
    v_mov_b32 v106, 0
    v_mov_b32 v107, 0
    v_mov_b32 v108, 0
    v_mov_b32 v109, 0
    v_mov_b32 v110, 0
    v_mov_b32 v111, 0
    v_mov_b32 v112, 0
    v_mov_b32 v113, 0
    v_mov_b32 v114, 0
    v_mov_b32 v115, 0
    v_mov_b32 v116, 0
    v_mov_b32 v117, 0
    v_mov_b32 v118, 0
    v_mov_b32 v119, 0
    v_mov_b32 v120, 0
    v_mov_b32 v121, 0
    v_mov_b32 v122, 0
    v_mov_b32 v123, 0
    v_mov_b32 v124, 0
    v_mov_b32 v125, 0
    v_mov_b32 v126, 0
    v_mov_b32 v127, 0
    v_mov_b32 v128, 0
    v_mov_b32 v129, 0
    v_mov_b32 v130, 0
    v_mov_b32 v131, 0
    v_mov_b32 v132, 0
    v_mov_b32 v133, 0
    v_mov_b32 v134, 0
    v_mov_b32 v135, 0
    v_mov_b32 v136, 0
    v_mov_b32 v137, 0
    v_mov_b32 v138, 0
    v_mov_b32 v139, 0
    v_mov_b32 v140, 0
    v_mov_b32 v141, 0
    v_mov_b32 v142, 0
    v_mov_b32 v143, 0
    v_mov_b32 v144, 0
    v_mov_b32 v145, 0
    v_mov_b32 v146, 0
    v_mov_b32 v147, 0
    v_mov_b32 v148, 0
    v_mov_b32 v149, 0
    v_mov_b32 v150, 0
    v_mov_b32 v151, 0
    v_mov_b32 v152, 0
    v_mov_b32 v153, 0
    v_mov_b32 v154, 0
    v_mov_b32 v155, 0
    v_mov_b32 v156, 0
    v_mov_b32 v157, 0
    v_mov_b32 v158, 0
    v_mov_b32 v159, 0
    v_lshrrev_b32 v26, 4, v1
    v_and_b32 v27, 7, v1
    v_bfe_u32 v25, v1, 3, 1
    v_lshlrev_b32 v25, 9, v25
    v_lshl_add_u32 v25, v26, 7, v25
    v_lshl_add_u32 v2, v27, 4, v25
    v_xor_b32 v27, 4, v27
    v_lshl_add_u32 v3, v27, 4, v25
    s_lshl_b32 s63, s3, 13
    v_bfe_u32 v20, v1, 2, 2
    v_lshrrev_b32 v21, 4, v1
    v_bfe_u32 v22, v1, 1, 1
    v_lshl_add_u32 v22, v21, 1, v22
    v_lshrrev_b32 v23, 1, v20
    v_lshlrev_b32 v24, 2, v23
    v_xor_b32 v22, v22, v24
    v_and_b32 v24, 1, v20
    v_lshl_add_u32 v22, v24, 3, v22
    v_lshlrev_b32 v22, 4, v22
    v_lshl_add_u32 v22, v23, 10, v22
    v_and_b32 v24, 1, v1
    v_lshl_add_u32 v22, v24, 3, v22
    v_add_u32 v4, s63, v22
    v_lshrrev_b32 v21, 5, v1
    v_mov_b32 v23, 256
    v_cmp_eq_u32 vcc, v20, v21
    v_add_u32 v21, 2, v21
    s_nop 0
    v_cndmask_b32 v8, 0, v23, vcc
    v_cmp_eq_u32 vcc, v20, v21
    s_nop 1
    v_cndmask_b32 v9, 0, v23, vcc
    s_mov_b32 s82, 0x05040100
    s_mov_b32 s83, 0x07060302
    s_mov_b32 s52, 0
    s_mov_b32 s73, 0
    s_lshl_b32 s100, s3, 10
    s_add_u32 s100, s100, 139520
    s_add_u32 s51, s100, 1024
    v_lshrrev_b32 v24, 3, v0
    v_mul_u32_u24 v24, 2500, v24
    s_waitcnt lgkmcnt(0)
    s_barrier
    s_waitcnt vmcnt(8)
    v_cmp_gt_u32 s[84:85], -2, v16
    v_cmp_gt_u32 s[86:87], -2, v17
    v_cmp_gt_u32 s[88:89], -2, v18
    v_cmp_gt_u32 s[90:91], -2, v19
    v_cmp_eq_u32 vcc, -2, v19
    s_bcnt1_i32_b64 s92, s[84:85]
    s_bcnt1_i32_b64 s93, s[86:87]
    s_bcnt1_i32_b64 s94, s[88:89]
    s_bcnt1_i32_b64 s95, s[90:91]
    s_add_u32 s93, s93, s92
    s_add_u32 s94, s94, s93
    s_add_u32 s75, s95, s94
    s_mov_b32 s76, 0
    s_cbranch_vccnz L_scan
    s_cmp_gt_u32 s75, 128
    s_cbranch_scc1 L_scan
    s_mov_b32 s76, 79
    s_mov_b32 s101, 1
    v_mbcnt_lo_u32_b32 v20, s84, 0
    v_mbcnt_hi_u32_b32 v20, s85, v20
    v_lshl_add_u32 v20, v20, 3, s100
    v_lshrrev_b32 v26, 20, v16
    v_add_u32 v26, v26, v24
    v_mbcnt_lo_u32_b32 v21, s86, 0
    v_mbcnt_hi_u32_b32 v21, s87, v21
    v_add_u32 v21, s92, v21
    v_lshl_add_u32 v21, v21, 3, s100
    v_lshrrev_b32 v27, 20, v17
    v_add_u32 v27, v27, v24
    v_mbcnt_lo_u32_b32 v22, s88, 0
    v_mbcnt_hi_u32_b32 v22, s89, v22
    v_add_u32 v22, s93, v22
    v_lshl_add_u32 v22, v22, 3, s100
    v_lshrrev_b32 v28, 20, v18
    v_add_u32 v28, v28, v24
    v_mbcnt_lo_u32_b32 v23, s90, 0
    v_mbcnt_hi_u32_b32 v23, s91, v23
    v_add_u32 v23, s94, v23
    v_lshl_add_u32 v23, v23, 3, s100
    v_lshrrev_b32 v29, 20, v19
    v_add_u32 v29, v29, v24
    s_mov_b64 exec, s[84:85]
    ds_write2_b32 v20, v16, v26 offset0:0 offset1:1
    s_mov_b64 exec, s[86:87]
    ds_write2_b32 v21, v17, v27 offset0:0 offset1:1
    s_mov_b64 exec, s[88:89]
    ds_write2_b32 v22, v18, v28 offset0:0 offset1:1
    s_mov_b64 exec, s[90:91]
    ds_write2_b32 v23, v19, v29 offset0:0 offset1:1
    s_mov_b64 exec, -1
    s_branch L_have
L_round:
L_scan:
    s_mov_b32 s101, 0
    s_mov_b32 s50, s100
    s_xor_b32 s49, s2, 1
L_sloop:
    s_cmp_ge_u32 s76, 79
    s_cbranch_scc1 L_scan_done
    s_mul_i32 s53, s3, 20000
    s_lshl_b32 s54, s76, 8
    s_add_u32 s55, s53, s54
    v_lshlrev_b32 v13, 2, v1
    v_add_u32 v13, s55, v13
    v_lshlrev_b32 v15, 2, v13
    buffer_load_dwordx4 v[16:19], v15, s[16:19], 0 offen
    s_waitcnt vmcnt(0)
    s_cmp_lg_u32 s76, 78
    s_cbranch_scc1 L_snotlast
    s_mov_b32 exec_lo, 0xffffff00
    v_mov_b32 v16, s49
    v_mov_b32 v17, s49
    v_mov_b32 v18, s49
    v_mov_b32 v19, s49
    s_mov_b64 exec, -1
L_snotlast:
    s_cmp_gt_u32 s52, 0
    s_cbranch_scc1 L_1
    v_cmp_eq_u32_sdwa vcc, v16, s2 src0_sel:BYTE_0 src1_sel:DWORD
    s_cbranch_vccz L_1
    s_bcnt1_i32_b64 s53, vcc
    s_lshl3_add_u32 s54, s53, s50
    s_mov_b32 s52, 0
    s_cmp_gt_u32 s54, s51
    s_cbranch_scc1 L_ovf
    v_mbcnt_lo_u32_b32 v48, vcc_lo, 0
    v_mbcnt_hi_u32_b32 v48, vcc_hi, v48
    v_lshl_add_u32 v48, v48, 3, s50
    v_add_u32 v49, 0, v13
    s_mov_b64 exec, vcc
    ds_write2_b32 v48, v16, v49 offset0:0 offset1:1
    s_mov_b64 exec, -1
    s_mov_b32 s50, s54
L_1:
    s_cmp_gt_u32 s52, 1
    s_cbranch_scc1 L_2
    v_cmp_eq_u32_sdwa vcc, v17, s2 src0_sel:BYTE_0 src1_sel:DWORD
    s_cbranch_vccz L_2
    s_bcnt1_i32_b64 s53, vcc
    s_lshl3_add_u32 s54, s53, s50
    s_mov_b32 s52, 1
    s_cmp_gt_u32 s54, s51
    s_cbranch_scc1 L_ovf
    v_mbcnt_lo_u32_b32 v48, vcc_lo, 0
    v_mbcnt_hi_u32_b32 v48, vcc_hi, v48
    v_lshl_add_u32 v48, v48, 3, s50
    v_add_u32 v49, 1, v13
    s_mov_b64 exec, vcc
    ds_write2_b32 v48, v17, v49 offset0:0 offset1:1
    s_mov_b64 exec, -1
    s_mov_b32 s50, s54
L_2:
    s_cmp_gt_u32 s52, 2
    s_cbranch_scc1 L_3
    v_cmp_eq_u32_sdwa vcc, v18, s2 src0_sel:BYTE_0 src1_sel:DWORD
    s_cbranch_vccz L_3
    s_bcnt1_i32_b64 s53, vcc
    s_lshl3_add_u32 s54, s53, s50
    s_mov_b32 s52, 2
    s_cmp_gt_u32 s54, s51
    s_cbranch_scc1 L_ovf
    v_mbcnt_lo_u32_b32 v48, vcc_lo, 0
    v_mbcnt_hi_u32_b32 v48, vcc_hi, v48
    v_lshl_add_u32 v48, v48, 3, s50
    v_add_u32 v49, 2, v13
    s_mov_b64 exec, vcc
    ds_write2_b32 v48, v18, v49 offset0:0 offset1:1
    s_mov_b64 exec, -1
    s_mov_b32 s50, s54
L_3:
    s_cmp_gt_u32 s52, 3
    s_cbranch_scc1 L_4
    v_cmp_eq_u32_sdwa vcc, v19, s2 src0_sel:BYTE_0 src1_sel:DWORD
    s_cbranch_vccz L_4
    s_bcnt1_i32_b64 s53, vcc
    s_lshl3_add_u32 s54, s53, s50
    s_mov_b32 s52, 3
    s_cmp_gt_u32 s54, s51
    s_cbranch_scc1 L_ovf
    v_mbcnt_lo_u32_b32 v48, vcc_lo, 0
    v_mbcnt_hi_u32_b32 v48, vcc_hi, v48
    v_lshl_add_u32 v48, v48, 3, s50
    v_add_u32 v49, 3, v13
    s_mov_b64 exec, vcc
    ds_write2_b32 v48, v19, v49 offset0:0 offset1:1
    s_mov_b64 exec, -1
    s_mov_b32 s50, s54
L_4:
    s_mov_b32 s52, 0
    s_add_u32 s76, s76, 1
    s_branch L_sloop
L_ovf:
    v_mov_b32 v48, 1
    v_mov_b32 v49, 155920
    ds_write_b32 v49, v48
L_scan_done:
    s_sub_u32 s75, s50, s100
    s_lshr_b32 s75, s75, 3
L_have:
    v_lshlrev_b32 v72, 3, v1
    v_add_u32 v72, s100, v72
    s_waitcnt lgkmcnt(0)
    ds_read_b64 v[34:35], v72
    ds_read_b64 v[58:59], v72 offset:512
    v_and_b32 v73, 3, v1
    v_lshlrev_b32 v73, 5, v73
    v_cmp_gt_i32 s[78:79], s75, v1
    s_sub_u32 s53, s75, 64
    v_cmp_gt_i32 s[80:81], s53, v1
    s_waitcnt lgkmcnt(0)
    v_lshlrev_b32 v39, 2, v35
    v_lshlrev_b32 v36, 3, v35
    v_lshlrev_b32 v38, 5, v35
    v_lshlrev_b32 v63, 2, v59
    v_lshlrev_b32 v60, 3, v59
    v_lshlrev_b32 v62, 5, v59
    s_mov_b64 exec, s[78:79]
    s_cbranch_execz L_5
    buffer_load_dwordx2 v[32:33], v36, s[20:23], 0 offen
    buffer_load_dwordx4 v[16:19], v38, s[24:27], 0 offen
    buffer_load_dwordx4 v[20:23], v38, s[24:27], 0 offen offset:16
L_5:
    s_mov_b64 exec, s[80:81]
    s_cbranch_execz L_6
    buffer_load_dwordx2 v[56:57], v60, s[20:23], 0 offen
    buffer_load_dwordx4 v[40:43], v62, s[24:27], 0 offen
    buffer_load_dwordx4 v[44:47], v62, s[24:27], 0 offen offset:16
L_6:
    s_mov_b64 exec, -1
    buffer_load_dwordx4 v[24:27], v73, s[40:43], 0 offen
    buffer_load_dwordx4 v[28:31], v73, s[40:43], 0 offen offset:16
    s_cmp_eq_u32 s101, 0
    s_cbranch_scc1 L_dec_slow
    v_bfe_u32 v35, v34, 6, 14
    v_and_b32 v34, 63, v34
    v_bfe_u32 v59, v58, 6, 14
    v_and_b32 v58, 63, v58
    s_branch L_dec_done
L_dec_slow:
    buffer_load_dword v35, v39, s[12:15], 0 offen
    v_bfe_u32 v34, v34, 8, 6
    buffer_load_dword v59, v63, s[12:15], 0 offen
    v_bfe_u32 v58, v58, 8, 6
    s_waitcnt vmcnt(0)
L_dec_done:
    v_mov_b32 v72, 1
    v_mul_u32_u24 v38, 6711, v35
    v_lshrrev_b32 v38, 22, v38
    v_min_u32 v38, 15, v38
    v_lshlrev_b32 v38, 2, v38
    v_lshl_add_u32 v36, v34, 6, v38
    v_add_u32 v36, 147712, v36
    v_mul_u32_u24 v62, 6711, v59
    v_lshrrev_b32 v62, 22, v62
    v_min_u32 v62, 15, v62
    v_lshlrev_b32 v62, 2, v62
    v_lshl_add_u32 v60, v58, 6, v62
    v_add_u32 v60, 147712, v60
    s_mov_b64 exec, s[78:79]
    ds_add_rtn_u32 v37, v36, v72
    s_mov_b64 exec, s[80:81]
    ds_add_rtn_u32 v61, v60, v72
    s_mov_b64 exec, -1
    s_waitcnt lgkmcnt(0)
    s_barrier
    v_lshlrev_b32 v38, 6, v1
    v_add_u32 v38, 147712, v38
    v_mov_b32 v39, 155920
    ds_read_b128 v[64:67], v38 offset:0
    ds_read_b128 v[68:71], v38 offset:16
    ds_read_b128 v[72:75], v38 offset:32
    ds_read_b128 v[76:79], v38 offset:48
    ds_read_b32 v39, v39
    s_waitcnt lgkmcnt(0)
    v_readfirstlane_b32 s74, v39
    v_add3_u32 v64, v64, v65, v66
    v_add3_u32 v67, v67, v68, v69
    v_add3_u32 v70, v70, v71, v72
    v_add3_u32 v73, v73, v74, v75
    v_add3_u32 v76, v76, v77, v78
    v_add3_u32 v64, v64, v67, v70
    v_add3_u32 v73, v73, v76, v79
    v_add_u32 v64, v64, v73
    s_cmp_lg_u32 s73, 0
    s_cbranch_scc1 L_assigned
    v_sub_u32 v65, 63, v1
    v_lshl_add_u32 v65, v64, 6, v65
    v_mov_b32 v66, 0
    v_readlane_b32 s84, v65, 0
    v_readlane_b32 s85, v65, 1
    v_readlane_b32 s86, v65, 2
    v_readlane_b32 s87, v65, 3
    v_readlane_b32 s88, v65, 4
    v_readlane_b32 s89, v65, 5
    v_readlane_b32 s90, v65, 6
    v_readlane_b32 s91, v65, 7
    v_readlane_b32 s92, v65, 8
    v_readlane_b32 s93, v65, 9
    v_readlane_b32 s94, v65, 10
    v_readlane_b32 s95, v65, 11
    v_readlane_b32 s96, v65, 12
    v_readlane_b32 s97, v65, 13
    v_readlane_b32 s98, v65, 14
    v_readlane_b32 s99, v65, 15
    s_nop 1
    v_cmp_gt_u32 vcc, s84, v65
    v_cmp_gt_u32 s[4:5], s85, v65
    v_cmp_gt_u32 s[6:7], s86, v65
    v_addc_co_u32 v66, vcc, 0, v66, vcc
    v_addc_co_u32 v66, s[4:5], 0, v66, s[4:5]
    v_addc_co_u32 v66, s[6:7], 0, v66, s[6:7]
    v_cmp_gt_u32 vcc, s87, v65
    v_cmp_gt_u32 s[4:5], s88, v65
    v_cmp_gt_u32 s[6:7], s89, v65
    v_addc_co_u32 v66, vcc, 0, v66, vcc
    v_addc_co_u32 v66, s[4:5], 0, v66, s[4:5]
    v_addc_co_u32 v66, s[6:7], 0, v66, s[6:7]
    v_cmp_gt_u32 vcc, s90, v65
    v_cmp_gt_u32 s[4:5], s91, v65
    v_cmp_gt_u32 s[6:7], s92, v65
    v_addc_co_u32 v66, vcc, 0, v66, vcc
    v_addc_co_u32 v66, s[4:5], 0, v66, s[4:5]
    v_addc_co_u32 v66, s[6:7], 0, v66, s[6:7]
    v_cmp_gt_u32 vcc, s93, v65
    v_cmp_gt_u32 s[4:5], s94, v65
    v_cmp_gt_u32 s[6:7], s95, v65
    v_addc_co_u32 v66, vcc, 0, v66, vcc
    v_addc_co_u32 v66, s[4:5], 0, v66, s[4:5]
    v_addc_co_u32 v66, s[6:7], 0, v66, s[6:7]
    v_cmp_gt_u32 vcc, s96, v65
    v_cmp_gt_u32 s[4:5], s97, v65
    v_cmp_gt_u32 s[6:7], s98, v65
    v_addc_co_u32 v66, vcc, 0, v66, vcc
    v_addc_co_u32 v66, s[4:5], 0, v66, s[4:5]
    v_addc_co_u32 v66, s[6:7], 0, v66, s[6:7]
    v_cmp_gt_u32 vcc, s99, v65
    s_nop 1
    v_addc_co_u32 v66, vcc, 0, v66, vcc
    v_readlane_b32 s84, v65, 16
    v_readlane_b32 s85, v65, 17
    v_readlane_b32 s86, v65, 18
    v_readlane_b32 s87, v65, 19
    v_readlane_b32 s88, v65, 20
    v_readlane_b32 s89, v65, 21
    v_readlane_b32 s90, v65, 22
    v_readlane_b32 s91, v65, 23
    v_readlane_b32 s92, v65, 24
    v_readlane_b32 s93, v65, 25
    v_readlane_b32 s94, v65, 26
    v_readlane_b32 s95, v65, 27
    v_readlane_b32 s96, v65, 28
    v_readlane_b32 s97, v65, 29
    v_readlane_b32 s98, v65, 30
    v_readlane_b32 s99, v65, 31
    s_nop 1
    v_cmp_gt_u32 vcc, s84, v65
    v_cmp_gt_u32 s[4:5], s85, v65
    v_cmp_gt_u32 s[6:7], s86, v65
    v_addc_co_u32 v66, vcc, 0, v66, vcc
    v_addc_co_u32 v66, s[4:5], 0, v66, s[4:5]
    v_addc_co_u32 v66, s[6:7], 0, v66, s[6:7]
    v_cmp_gt_u32 vcc, s87, v65
    v_cmp_gt_u32 s[4:5], s88, v65
    v_cmp_gt_u32 s[6:7], s89, v65
    v_addc_co_u32 v66, vcc, 0, v66, vcc
    v_addc_co_u32 v66, s[4:5], 0, v66, s[4:5]
    v_addc_co_u32 v66, s[6:7], 0, v66, s[6:7]
    v_cmp_gt_u32 vcc, s90, v65
    v_cmp_gt_u32 s[4:5], s91, v65
    v_cmp_gt_u32 s[6:7], s92, v65
    v_addc_co_u32 v66, vcc, 0, v66, vcc
    v_addc_co_u32 v66, s[4:5], 0, v66, s[4:5]
    v_addc_co_u32 v66, s[6:7], 0, v66, s[6:7]
    v_cmp_gt_u32 vcc, s93, v65
    v_cmp_gt_u32 s[4:5], s94, v65
    v_cmp_gt_u32 s[6:7], s95, v65
    v_addc_co_u32 v66, vcc, 0, v66, vcc
    v_addc_co_u32 v66, s[4:5], 0, v66, s[4:5]
    v_addc_co_u32 v66, s[6:7], 0, v66, s[6:7]
    v_cmp_gt_u32 vcc, s96, v65
    v_cmp_gt_u32 s[4:5], s97, v65
    v_cmp_gt_u32 s[6:7], s98, v65
    v_addc_co_u32 v66, vcc, 0, v66, vcc
    v_addc_co_u32 v66, s[4:5], 0, v66, s[4:5]
    v_addc_co_u32 v66, s[6:7], 0, v66, s[6:7]
    v_cmp_gt_u32 vcc, s99, v65
    s_nop 1
    v_addc_co_u32 v66, vcc, 0, v66, vcc
    v_readlane_b32 s84, v65, 32
    v_readlane_b32 s85, v65, 33
    v_readlane_b32 s86, v65, 34
    v_readlane_b32 s87, v65, 35
    v_readlane_b32 s88, v65, 36
    v_readlane_b32 s89, v65, 37
    v_readlane_b32 s90, v65, 38
    v_readlane_b32 s91, v65, 39
    s_nop 1
    v_cmp_gt_u32 vcc, s84, v65
    v_cmp_gt_u32 s[4:5], s85, v65
    v_cmp_gt_u32 s[6:7], s86, v65
    v_addc_co_u32 v66, vcc, 0, v66, vcc
    v_addc_co_u32 v66, s[4:5], 0, v66, s[4:5]
    v_addc_co_u32 v66, s[6:7], 0, v66, s[6:7]
    v_cmp_gt_u32 vcc, s87, v65
    v_cmp_gt_u32 s[4:5], s88, v65
    v_cmp_gt_u32 s[6:7], s89, v65
    v_addc_co_u32 v66, vcc, 0, v66, vcc
    v_addc_co_u32 v66, s[4:5], 0, v66, s[4:5]
    v_addc_co_u32 v66, s[6:7], 0, v66, s[6:7]
    v_cmp_gt_u32 vcc, s90, v65
    v_cmp_gt_u32 s[4:5], s91, v65
    s_nop 0
    v_addc_co_u32 v66, vcc, 0, v66, vcc
    v_addc_co_u32 v66, s[4:5], 0, v66, s[4:5]
    v_bfe_u32 v67, v66, 3, 1
    v_mul_u32_u24 v67, 7, v67
    v_and_b32 v68, 7, v66
    v_xor_b32 v11, v67, v68
    s_sub_u32 s53, 7, s3
    s_add_u32 s54, s3, 0
    v_cmp_eq_u32 vcc, s54, v66
    s_ff1_i32_b64 s56, vcc
    s_add_u32 s54, s53, 8
    v_cmp_eq_u32 vcc, s54, v66
    s_ff1_i32_b64 s57, vcc
    s_add_u32 s54, s3, 16
    v_cmp_eq_u32 vcc, s54, v66
    s_ff1_i32_b64 s58, vcc
    s_add_u32 s54, s53, 24
    v_cmp_eq_u32 vcc, s54, v66
    s_ff1_i32_b64 s59, vcc
    s_add_u32 s54, s3, 32
    v_cmp_eq_u32 vcc, s54, v66
    s_ff1_i32_b64 s60, vcc
L_assigned:
    v_cmp_gt_u32 vcc, s3, v11
    v_and_b32 v68, 15, v1
    v_lshlrev_b32 v68, 2, v68
    v_cndmask_b32 v67, 0, v64, vcc
    v_add_u32 v68, 147712, v68
    s_lshl_b32 s84, s56, 6
    v_add_u32 v70, s84, v68
    ds_read_b32 v75, v70
    s_lshl_b32 s85, s57, 6
    v_add_u32 v71, s85, v68
    ds_read_b32 v76, v71
    s_lshl_b32 s86, s58, 6
    v_add_u32 v72, s86, v68
    ds_read_b32 v77, v72
    s_lshl_b32 s87, s59, 6
    v_add_u32 v73, s87, v68
    ds_read_b32 v78, v73
    s_lshl_b32 s88, s60, 6
    v_add_u32 v74, s88, v68
    ds_read_b32 v79, v74
    s_nop 1
    v_add_u32_dpp v67, v67, v67 row_shr:1 row_mask:0xf bank_mask:0xf bound_ctrl:1
    s_nop 1
    v_add_u32_dpp v67, v67, v67 row_shr:2 row_mask:0xf bank_mask:0xf bound_ctrl:1
    s_nop 1
    v_add_u32_dpp v67, v67, v67 row_shr:4 row_mask:0xf bank_mask:0xf bound_ctrl:1
    s_nop 1
    v_add_u32_dpp v67, v67, v67 row_shr:8 row_mask:0xf bank_mask:0xf bound_ctrl:1
    s_nop 0
    v_readlane_b32 s61, v67, 15
    v_readlane_b32 s53, v67, 31
    v_readlane_b32 s54, v67, 47
    v_readlane_b32 s92, v64, s56
    v_readlane_b32 s93, v64, s57
    v_readlane_b32 s94, v64, s58
    v_readlane_b32 s95, v64, s59
    v_readlane_b32 s96, v64, s60
    s_add_u32 s61, s61, s53
    s_add_u32 s61, s61, s54
    s_add_u32 s61, s61, 3
    s_andn2_b32 s61, s61, 3
    s_lshl2_add_u32 s61, s3, s61
    s_add_u32 s62, s92, s93
    s_add_u32 s62, s62, s94
    s_add_u32 s62, s62, s95
    s_add_u32 s62, s62, s96
    s_waitcnt lgkmcnt(0)
    v_add3_u32 v67, v75, v76, v77
    v_add3_u32 v67, v67, v78, v79
    v_mov_b32 v68, v67
    s_nop 1
    v_add_u32_dpp v68, v68, v68 row_shr:1 row_mask:0xf bank_mask:0xf bound_ctrl:1
    s_nop 1
    v_add_u32_dpp v68, v68, v68 row_shr:2 row_mask:0xf bank_mask:0xf bound_ctrl:1
    s_nop 1
    v_add_u32_dpp v68, v68, v68 row_shr:4 row_mask:0xf bank_mask:0xf bound_ctrl:1
    s_nop 1
    v_add_u32_dpp v68, v68, v68 row_shr:8 row_mask:0xf bank_mask:0xf bound_ctrl:1
    v_sub_u32 v68, v68, v67
    v_add_u32 v68, s61, v68
    v_lshl_add_u32 v69, v68, 3, 0
    ds_write_b32 v70, v69 offset:4096
    v_add_u32 v68, v68, v75
    s_nop 0
    v_lshl_add_u32 v69, v68, 3, 1
    ds_write_b32 v71, v69 offset:4096
    v_add_u32 v68, v68, v76
    s_nop 0
    v_lshl_add_u32 v69, v68, 3, 2
    ds_write_b32 v72, v69 offset:4096
    v_add_u32 v68, v68, v77
    s_nop 0
    v_lshl_add_u32 v69, v68, 3, 3
    ds_write_b32 v73, v69 offset:4096
    v_add_u32 v68, v68, v78
    s_nop 0
    v_lshl_add_u32 v69, v68, 3, 4
    ds_write_b32 v74, v69 offset:4096
    s_waitcnt lgkmcnt(0)
    s_barrier
    ds_read_b32 v38, v36 offset:4096
    ds_read_b32 v62, v60 offset:4096
    v_mov_b32 v64, 0
    v_mov_b32 v65, 0
    v_lshlrev_b32 v66, 3, v0
    v_add_u32 v66, 147712, v66
    ds_write_b64 v66, v[64:65]
    v_mov_b32 v66, 155920
    ds_write_b32 v66, v64
    s_waitcnt vmcnt(0)
    v_perm_b32 v72, v26, v24, s82
    v_perm_b32 v73, v30, v28, s82
    v_perm_b32 v74, v26, v24, s83
    v_perm_b32 v75, v30, v28, s83
    v_perm_b32 v76, v27, v25, s82
    v_perm_b32 v77, v31, v29, s82
    v_perm_b32 v78, v27, v25, s83
    v_perm_b32 v79, v31, v29, s83
    s_nop 1
    v_mfma_f32_4x4x4_16b_bf16 v[64:67], v[72:73], v[32:33], 0
    v_mfma_f32_4x4x4_16b_bf16 v[68:71], v[74:75], v[32:33], 0
    s_nop 5
    v_cvt_pk_bf16_f32 v24, v64, v65
    v_cvt_pk_bf16_f32 v25, v66, v67
    v_cvt_pk_bf16_f32 v26, v68, v69
    v_cvt_pk_bf16_f32 v27, v70, v71
    s_nop 1
    v_mfma_f32_4x4x4_16b_bf16 v[64:67], v[76:77], v[32:33], 0
    v_mfma_f32_4x4x4_16b_bf16 v[68:71], v[78:79], v[32:33], 0
    s_nop 5
    v_cvt_pk_bf16_f32 v28, v64, v65
    v_cvt_pk_bf16_f32 v29, v66, v67
    v_cvt_pk_bf16_f32 v30, v68, v69
    v_cvt_pk_bf16_f32 v31, v70, v71
    s_nop 1
    v_mfma_f32_4x4x4_16b_bf16 v[64:67], v[72:73], v[56:57], 0
    v_mfma_f32_4x4x4_16b_bf16 v[68:71], v[74:75], v[56:57], 0
    s_nop 5
    v_cvt_pk_bf16_f32 v48, v64, v65
    v_cvt_pk_bf16_f32 v49, v66, v67
    v_cvt_pk_bf16_f32 v50, v68, v69
    v_cvt_pk_bf16_f32 v51, v70, v71
    s_nop 1
    v_mfma_f32_4x4x4_16b_bf16 v[64:67], v[76:77], v[56:57], 0
    v_mfma_f32_4x4x4_16b_bf16 v[68:71], v[78:79], v[56:57], 0
    s_nop 5
    v_cvt_pk_bf16_f32 v52, v64, v65
    v_cvt_pk_bf16_f32 v53, v66, v67
    v_cvt_pk_bf16_f32 v54, v68, v69
    v_cvt_pk_bf16_f32 v55, v70, v71
    s_nop 1
    s_waitcnt lgkmcnt(0)
    v_lshrrev_b32 v39, 3, v38
    v_add_u32 v39, v39, v37
    v_and_b32 v38, 7, v38
    v_lshl_or_b32 v38, v35, 11, v38
    v_lshlrev_b32 v36, 2, v39
    v_add_u32 v36, 135168, v36
    v_lshlrev_b32 v39, 6, v39
    v_add_u32 v39, 65536, v39
    v_lshrrev_b32 v63, 3, v62
    v_add_u32 v63, v63, v61
    v_and_b32 v62, 7, v62
    v_lshl_or_b32 v62, v59, 11, v62
    v_lshlrev_b32 v60, 2, v63
    v_add_u32 v60, 135168, v60
    v_lshlrev_b32 v63, 6, v63
    v_add_u32 v63, 65536, v63
    s_mov_b64 exec, s[78:79]
    ds_write_b32 v36, v38
    ds_write_b128 v39, v[24:27]
    ds_write_b128 v39, v[28:31] offset:16
    ds_write_b128 v39, v[16:19] offset:32
    ds_write_b128 v39, v[20:23] offset:48
    s_mov_b64 exec, s[80:81]
    ds_write_b32 v60, v62
    ds_write_b128 v63, v[48:51]
    ds_write_b128 v63, v[52:55] offset:16
    ds_write_b128 v63, v[40:43] offset:32
    ds_write_b128 v63, v[44:47] offset:48
    s_mov_b64 exec, -1
    s_lshl_b32 s53, s61, 6
    s_add_u32 s53, s53, 65536
    v_and_b32 v64, 3, v1
    v_lshlrev_b32 v65, 3, v64
    v_add_u32 v5, s53, v65
    v_bfe_u32 v65, v1, 4, 1
    v_lshlrev_b32 v65, 4, v65
    v_lshl_add_u32 v65, v64, 6, v65
    v_add3_u32 v65, v65, s53, 32
    v_mov_b32 v66, 155904
    v_cmp_ne_u32 vcc, 0, v8
    v_cmp_ne_u32 s[4:5], 0, v9
    s_nop 0
    v_cndmask_b32 v6, v66, v65, vcc
    v_cndmask_b32 v7, v66, v65, s[4:5]
    s_lshl_b32 s53, s61, 2
    s_add_u32 s53, s53, 135168
    v_mov_b32 v10, s53
    s_waitcnt lgkmcnt(0)
    s_barrier
    s_cmp_eq_u32 s62, 0
    s_cbranch_scc1 L_sweep_done
    ds_read_b128 v[68:71], v10
    s_waitcnt lgkmcnt(0)
    v_readfirstlane_b32 s64, v68
    v_readfirstlane_b32 s65, v69
    v_readfirstlane_b32 s66, v70
    v_readfirstlane_b32 s67, v71
    s_add_u32 m0, s63, 0
    s_andn2_b32 s72, s64, 7
    buffer_load_dwordx4 v2, s[8:11], s72 offen lds
    buffer_load_dwordx4 v3, s[8:11], s72 offen offset:1024 lds
    s_and_b32 s68, s64, 7
    s_cmp_le_u32 s62, 1
    s_cbranch_scc1 L_group
    s_add_u32 m0, s63, 2048
    s_andn2_b32 s72, s65, 7
    buffer_load_dwordx4 v2, s[8:11], s72 offen lds
    buffer_load_dwordx4 v3, s[8:11], s72 offen offset:1024 lds
    s_and_b32 s69, s65, 7
    s_cmp_le_u32 s62, 2
    s_cbranch_scc1 L_group
    s_add_u32 m0, s63, 4096
    s_andn2_b32 s72, s66, 7
    buffer_load_dwordx4 v2, s[8:11], s72 offen lds
    buffer_load_dwordx4 v3, s[8:11], s72 offen offset:1024 lds
    s_and_b32 s70, s66, 7
    s_cmp_le_u32 s62, 3
    s_cbranch_scc1 L_group
    s_add_u32 m0, s63, 6144
    s_andn2_b32 s72, s67, 7
    buffer_load_dwordx4 v2, s[8:11], s72 offen lds
    buffer_load_dwordx4 v3, s[8:11], s72 offen offset:1024 lds
    s_and_b32 s71, s67, 7
L_group:
    ds_read_b128 v[60:63], v6
    ds_read_b128 v[64:67], v7
    ds_read_b128 v[68:71], v10 offset:16
    v_add_u32 v6, v6, v8
    v_add_u32 v7, v7, v9
    v_add_u32 v10, 16, v10
    s_waitcnt lgkmcnt(0)
    v_mfma_f32_16x16x32_bf16 v[16:19], v[60:63], a[0:3], 0
    v_mfma_f32_16x16x32_bf16 v[20:23], v[60:63], a[8:11], 0
    v_mfma_f32_16x16x32_bf16 v[24:27], v[60:63], a[16:19], 0
    v_mfma_f32_16x16x32_bf16 v[28:31], v[60:63], a[24:27], 0
    v_mfma_f32_16x16x32_bf16 v[16:19], v[64:67], a[4:7], v[16:19]
    v_mfma_f32_16x16x32_bf16 v[20:23], v[64:67], a[12:15], v[20:23]
    v_mfma_f32_16x16x32_bf16 v[24:27], v[64:67], a[20:23], v[24:27]
    v_mfma_f32_16x16x32_bf16 v[28:31], v[64:67], a[28:31], v[28:31]
    v_readfirstlane_b32 s64, v68
    v_readfirstlane_b32 s65, v69
    v_readfirstlane_b32 s66, v70
    v_readfirstlane_b32 s67, v71
    ds_read_b64 v[56:57], v5 offset:0
    s_cmp_ge_u32 s62, 4
    s_cbranch_scc1 L_7
    s_waitcnt vmcnt(0)
L_7:
    s_waitcnt vmcnt(6)
    ds_read_b64_tr_b16 v[48:49], v4 offset:0
    ds_read_b64_tr_b16 v[50:51], v4 offset:256
    ds_read_b64_tr_b16 v[52:53], v4 offset:512
    ds_read_b64_tr_b16 v[54:55], v4 offset:768
    s_waitcnt lgkmcnt(0)
    s_cmp_le_u32 s62, 4
    s_cbranch_scc1 L_8
    s_add_u32 m0, s63, 0
    s_andn2_b32 s72, s64, 7
    buffer_load_dwordx4 v2, s[8:11], s72 offen lds
    buffer_load_dwordx4 v3, s[8:11], s72 offen offset:1024 lds
L_8:
    v_mfma_f32_4x4x4_16b_bf16 v[32:35], v[56:57], v[48:49], 0
    v_mfma_f32_4x4x4_16b_bf16 v[36:39], v[56:57], v[50:51], 0
    v_mfma_f32_4x4x4_16b_bf16 v[40:43], v[56:57], v[52:53], 0
    v_mfma_f32_4x4x4_16b_bf16 v[44:47], v[56:57], v[54:55], 0
    s_nop 1
    s_cmp_ge_u32 s68, 2
    s_cbranch_scc1 L_acc_11
    s_cmp_eq_u32 s68, 1
    s_cbranch_scc1 L_acc_10
    v_pk_fma_f32 v[80:81], v[32:33], v[16:17], v[80:81] op_sel:[0,0,0] op_sel_hi:[1,0,1]
    v_pk_fma_f32 v[82:83], v[34:35], v[16:17], v[82:83] op_sel:[0,0,0] op_sel_hi:[1,0,1]
    v_pk_fma_f32 v[84:85], v[36:37], v[20:21], v[84:85] op_sel:[0,0,0] op_sel_hi:[1,0,1]
    v_pk_fma_f32 v[86:87], v[38:39], v[20:21], v[86:87] op_sel:[0,0,0] op_sel_hi:[1,0,1]
    v_pk_fma_f32 v[88:89], v[40:41], v[24:25], v[88:89] op_sel:[0,0,0] op_sel_hi:[1,0,1]
    v_pk_fma_f32 v[90:91], v[42:43], v[24:25], v[90:91] op_sel:[0,0,0] op_sel_hi:[1,0,1]
    v_pk_fma_f32 v[92:93], v[44:45], v[28:29], v[92:93] op_sel:[0,0,0] op_sel_hi:[1,0,1]
    v_pk_fma_f32 v[94:95], v[46:47], v[28:29], v[94:95] op_sel:[0,0,0] op_sel_hi:[1,0,1]
    s_branch L_join_14
L_acc_10:
    v_pk_fma_f32 v[96:97], v[32:33], v[16:17], v[96:97] op_sel:[0,0,0] op_sel_hi:[1,0,1]
    v_pk_fma_f32 v[98:99], v[34:35], v[16:17], v[98:99] op_sel:[0,0,0] op_sel_hi:[1,0,1]
    v_pk_fma_f32 v[100:101], v[36:37], v[20:21], v[100:101] op_sel:[0,0,0] op_sel_hi:[1,0,1]
    v_pk_fma_f32 v[102:103], v[38:39], v[20:21], v[102:103] op_sel:[0,0,0] op_sel_hi:[1,0,1]
    v_pk_fma_f32 v[104:105], v[40:41], v[24:25], v[104:105] op_sel:[0,0,0] op_sel_hi:[1,0,1]
    v_pk_fma_f32 v[106:107], v[42:43], v[24:25], v[106:107] op_sel:[0,0,0] op_sel_hi:[1,0,1]
    v_pk_fma_f32 v[108:109], v[44:45], v[28:29], v[108:109] op_sel:[0,0,0] op_sel_hi:[1,0,1]
    v_pk_fma_f32 v[110:111], v[46:47], v[28:29], v[110:111] op_sel:[0,0,0] op_sel_hi:[1,0,1]
    s_branch L_join_14
L_acc_11:
    s_cmp_eq_u32 s68, 3
    s_cbranch_scc1 L_acc_12
    s_cmp_eq_u32 s68, 4
    s_cbranch_scc1 L_acc_13
    v_pk_fma_f32 v[112:113], v[32:33], v[16:17], v[112:113] op_sel:[0,0,0] op_sel_hi:[1,0,1]
    v_pk_fma_f32 v[114:115], v[34:35], v[16:17], v[114:115] op_sel:[0,0,0] op_sel_hi:[1,0,1]
    v_pk_fma_f32 v[116:117], v[36:37], v[20:21], v[116:117] op_sel:[0,0,0] op_sel_hi:[1,0,1]
    v_pk_fma_f32 v[118:119], v[38:39], v[20:21], v[118:119] op_sel:[0,0,0] op_sel_hi:[1,0,1]
    v_pk_fma_f32 v[120:121], v[40:41], v[24:25], v[120:121] op_sel:[0,0,0] op_sel_hi:[1,0,1]
    v_pk_fma_f32 v[122:123], v[42:43], v[24:25], v[122:123] op_sel:[0,0,0] op_sel_hi:[1,0,1]
    v_pk_fma_f32 v[124:125], v[44:45], v[28:29], v[124:125] op_sel:[0,0,0] op_sel_hi:[1,0,1]
    v_pk_fma_f32 v[126:127], v[46:47], v[28:29], v[126:127] op_sel:[0,0,0] op_sel_hi:[1,0,1]
    s_branch L_join_14
L_acc_12:
    v_pk_fma_f32 v[128:129], v[32:33], v[16:17], v[128:129] op_sel:[0,0,0] op_sel_hi:[1,0,1]
    v_pk_fma_f32 v[130:131], v[34:35], v[16:17], v[130:131] op_sel:[0,0,0] op_sel_hi:[1,0,1]
    v_pk_fma_f32 v[132:133], v[36:37], v[20:21], v[132:133] op_sel:[0,0,0] op_sel_hi:[1,0,1]
    v_pk_fma_f32 v[134:135], v[38:39], v[20:21], v[134:135] op_sel:[0,0,0] op_sel_hi:[1,0,1]
    v_pk_fma_f32 v[136:137], v[40:41], v[24:25], v[136:137] op_sel:[0,0,0] op_sel_hi:[1,0,1]
    v_pk_fma_f32 v[138:139], v[42:43], v[24:25], v[138:139] op_sel:[0,0,0] op_sel_hi:[1,0,1]
    v_pk_fma_f32 v[140:141], v[44:45], v[28:29], v[140:141] op_sel:[0,0,0] op_sel_hi:[1,0,1]
    v_pk_fma_f32 v[142:143], v[46:47], v[28:29], v[142:143] op_sel:[0,0,0] op_sel_hi:[1,0,1]
    s_branch L_join_14
L_acc_13:
    v_pk_fma_f32 v[144:145], v[32:33], v[16:17], v[144:145] op_sel:[0,0,0] op_sel_hi:[1,0,1]
    v_pk_fma_f32 v[146:147], v[34:35], v[16:17], v[146:147] op_sel:[0,0,0] op_sel_hi:[1,0,1]
    v_pk_fma_f32 v[148:149], v[36:37], v[20:21], v[148:149] op_sel:[0,0,0] op_sel_hi:[1,0,1]
    v_pk_fma_f32 v[150:151], v[38:39], v[20:21], v[150:151] op_sel:[0,0,0] op_sel_hi:[1,0,1]
    v_pk_fma_f32 v[152:153], v[40:41], v[24:25], v[152:153] op_sel:[0,0,0] op_sel_hi:[1,0,1]
    v_pk_fma_f32 v[154:155], v[42:43], v[24:25], v[154:155] op_sel:[0,0,0] op_sel_hi:[1,0,1]
    v_pk_fma_f32 v[156:157], v[44:45], v[28:29], v[156:157] op_sel:[0,0,0] op_sel_hi:[1,0,1]
    v_pk_fma_f32 v[158:159], v[46:47], v[28:29], v[158:159] op_sel:[0,0,0] op_sel_hi:[1,0,1]
L_join_14:
    s_and_b32 s68, s64, 7
    s_sub_u32 s62, s62, 1
    s_cmp_eq_u32 s62, 0
    s_cbranch_scc1 L_sweep_done
    ds_read_b64 v[56:57], v5 offset:64
    s_cmp_ge_u32 s62, 4
    s_cbranch_scc1 L_15
    s_waitcnt vmcnt(0)
L_15:
    s_waitcnt vmcnt(6)
    ds_read_b64_tr_b16 v[48:49], v4 offset:2048
    ds_read_b64_tr_b16 v[50:51], v4 offset:2304
    ds_read_b64_tr_b16 v[52:53], v4 offset:2560
    ds_read_b64_tr_b16 v[54:55], v4 offset:2816
    s_waitcnt lgkmcnt(0)
    s_cmp_le_u32 s62, 4
    s_cbranch_scc1 L_16
    s_add_u32 m0, s63, 2048
    s_andn2_b32 s72, s65, 7
    buffer_load_dwordx4 v2, s[8:11], s72 offen lds
    buffer_load_dwordx4 v3, s[8:11], s72 offen offset:1024 lds
L_16:
    v_mfma_f32_4x4x4_16b_bf16 v[32:35], v[56:57], v[48:49], 0
    v_mfma_f32_4x4x4_16b_bf16 v[36:39], v[56:57], v[50:51], 0
    v_mfma_f32_4x4x4_16b_bf16 v[40:43], v[56:57], v[52:53], 0
    v_mfma_f32_4x4x4_16b_bf16 v[44:47], v[56:57], v[54:55], 0
    s_nop 1
    s_cmp_ge_u32 s69, 2
    s_cbranch_scc1 L_acc_19
    s_cmp_eq_u32 s69, 1
    s_cbranch_scc1 L_acc_18
    v_pk_fma_f32 v[80:81], v[32:33], v[16:17], v[80:81] op_sel:[0,1,0] op_sel_hi:[1,1,1]
    v_pk_fma_f32 v[82:83], v[34:35], v[16:17], v[82:83] op_sel:[0,1,0] op_sel_hi:[1,1,1]
    v_pk_fma_f32 v[84:85], v[36:37], v[20:21], v[84:85] op_sel:[0,1,0] op_sel_hi:[1,1,1]
    v_pk_fma_f32 v[86:87], v[38:39], v[20:21], v[86:87] op_sel:[0,1,0] op_sel_hi:[1,1,1]
    v_pk_fma_f32 v[88:89], v[40:41], v[24:25], v[88:89] op_sel:[0,1,0] op_sel_hi:[1,1,1]
    v_pk_fma_f32 v[90:91], v[42:43], v[24:25], v[90:91] op_sel:[0,1,0] op_sel_hi:[1,1,1]
    v_pk_fma_f32 v[92:93], v[44:45], v[28:29], v[92:93] op_sel:[0,1,0] op_sel_hi:[1,1,1]
    v_pk_fma_f32 v[94:95], v[46:47], v[28:29], v[94:95] op_sel:[0,1,0] op_sel_hi:[1,1,1]
    s_branch L_join_22
L_acc_18:
    v_pk_fma_f32 v[96:97], v[32:33], v[16:17], v[96:97] op_sel:[0,1,0] op_sel_hi:[1,1,1]
    v_pk_fma_f32 v[98:99], v[34:35], v[16:17], v[98:99] op_sel:[0,1,0] op_sel_hi:[1,1,1]
    v_pk_fma_f32 v[100:101], v[36:37], v[20:21], v[100:101] op_sel:[0,1,0] op_sel_hi:[1,1,1]
    v_pk_fma_f32 v[102:103], v[38:39], v[20:21], v[102:103] op_sel:[0,1,0] op_sel_hi:[1,1,1]
    v_pk_fma_f32 v[104:105], v[40:41], v[24:25], v[104:105] op_sel:[0,1,0] op_sel_hi:[1,1,1]
    v_pk_fma_f32 v[106:107], v[42:43], v[24:25], v[106:107] op_sel:[0,1,0] op_sel_hi:[1,1,1]
    v_pk_fma_f32 v[108:109], v[44:45], v[28:29], v[108:109] op_sel:[0,1,0] op_sel_hi:[1,1,1]
    v_pk_fma_f32 v[110:111], v[46:47], v[28:29], v[110:111] op_sel:[0,1,0] op_sel_hi:[1,1,1]
    s_branch L_join_22
L_acc_19:
    s_cmp_eq_u32 s69, 3
    s_cbranch_scc1 L_acc_20
    s_cmp_eq_u32 s69, 4
    s_cbranch_scc1 L_acc_21
    v_pk_fma_f32 v[112:113], v[32:33], v[16:17], v[112:113] op_sel:[0,1,0] op_sel_hi:[1,1,1]
    v_pk_fma_f32 v[114:115], v[34:35], v[16:17], v[114:115] op_sel:[0,1,0] op_sel_hi:[1,1,1]
    v_pk_fma_f32 v[116:117], v[36:37], v[20:21], v[116:117] op_sel:[0,1,0] op_sel_hi:[1,1,1]
    v_pk_fma_f32 v[118:119], v[38:39], v[20:21], v[118:119] op_sel:[0,1,0] op_sel_hi:[1,1,1]
    v_pk_fma_f32 v[120:121], v[40:41], v[24:25], v[120:121] op_sel:[0,1,0] op_sel_hi:[1,1,1]
    v_pk_fma_f32 v[122:123], v[42:43], v[24:25], v[122:123] op_sel:[0,1,0] op_sel_hi:[1,1,1]
    v_pk_fma_f32 v[124:125], v[44:45], v[28:29], v[124:125] op_sel:[0,1,0] op_sel_hi:[1,1,1]
    v_pk_fma_f32 v[126:127], v[46:47], v[28:29], v[126:127] op_sel:[0,1,0] op_sel_hi:[1,1,1]
    s_branch L_join_22
L_acc_20:
    v_pk_fma_f32 v[128:129], v[32:33], v[16:17], v[128:129] op_sel:[0,1,0] op_sel_hi:[1,1,1]
    v_pk_fma_f32 v[130:131], v[34:35], v[16:17], v[130:131] op_sel:[0,1,0] op_sel_hi:[1,1,1]
    v_pk_fma_f32 v[132:133], v[36:37], v[20:21], v[132:133] op_sel:[0,1,0] op_sel_hi:[1,1,1]
    v_pk_fma_f32 v[134:135], v[38:39], v[20:21], v[134:135] op_sel:[0,1,0] op_sel_hi:[1,1,1]
    v_pk_fma_f32 v[136:137], v[40:41], v[24:25], v[136:137] op_sel:[0,1,0] op_sel_hi:[1,1,1]
    v_pk_fma_f32 v[138:139], v[42:43], v[24:25], v[138:139] op_sel:[0,1,0] op_sel_hi:[1,1,1]
    v_pk_fma_f32 v[140:141], v[44:45], v[28:29], v[140:141] op_sel:[0,1,0] op_sel_hi:[1,1,1]
    v_pk_fma_f32 v[142:143], v[46:47], v[28:29], v[142:143] op_sel:[0,1,0] op_sel_hi:[1,1,1]
    s_branch L_join_22
L_acc_21:
    v_pk_fma_f32 v[144:145], v[32:33], v[16:17], v[144:145] op_sel:[0,1,0] op_sel_hi:[1,1,1]
    v_pk_fma_f32 v[146:147], v[34:35], v[16:17], v[146:147] op_sel:[0,1,0] op_sel_hi:[1,1,1]
    v_pk_fma_f32 v[148:149], v[36:37], v[20:21], v[148:149] op_sel:[0,1,0] op_sel_hi:[1,1,1]
    v_pk_fma_f32 v[150:151], v[38:39], v[20:21], v[150:151] op_sel:[0,1,0] op_sel_hi:[1,1,1]
    v_pk_fma_f32 v[152:153], v[40:41], v[24:25], v[152:153] op_sel:[0,1,0] op_sel_hi:[1,1,1]
    v_pk_fma_f32 v[154:155], v[42:43], v[24:25], v[154:155] op_sel:[0,1,0] op_sel_hi:[1,1,1]
    v_pk_fma_f32 v[156:157], v[44:45], v[28:29], v[156:157] op_sel:[0,1,0] op_sel_hi:[1,1,1]
    v_pk_fma_f32 v[158:159], v[46:47], v[28:29], v[158:159] op_sel:[0,1,0] op_sel_hi:[1,1,1]
L_join_22:
    s_and_b32 s69, s65, 7
    s_sub_u32 s62, s62, 1
    s_cmp_eq_u32 s62, 0
    s_cbranch_scc1 L_sweep_done
    ds_read_b64 v[56:57], v5 offset:128
    s_cmp_ge_u32 s62, 4
    s_cbranch_scc1 L_23
    s_waitcnt vmcnt(0)
L_23:
    s_waitcnt vmcnt(6)
    ds_read_b64_tr_b16 v[48:49], v4 offset:4096
    ds_read_b64_tr_b16 v[50:51], v4 offset:4352
    ds_read_b64_tr_b16 v[52:53], v4 offset:4608
    ds_read_b64_tr_b16 v[54:55], v4 offset:4864
    s_waitcnt lgkmcnt(0)
    s_cmp_le_u32 s62, 4
    s_cbranch_scc1 L_24
    s_add_u32 m0, s63, 4096
    s_andn2_b32 s72, s66, 7
    buffer_load_dwordx4 v2, s[8:11], s72 offen lds
    buffer_load_dwordx4 v3, s[8:11], s72 offen offset:1024 lds
L_24:
    v_mfma_f32_4x4x4_16b_bf16 v[32:35], v[56:57], v[48:49], 0
    v_mfma_f32_4x4x4_16b_bf16 v[36:39], v[56:57], v[50:51], 0
    v_mfma_f32_4x4x4_16b_bf16 v[40:43], v[56:57], v[52:53], 0
    v_mfma_f32_4x4x4_16b_bf16 v[44:47], v[56:57], v[54:55], 0
    s_nop 1
    s_cmp_ge_u32 s70, 2
    s_cbranch_scc1 L_acc_27
    s_cmp_eq_u32 s70, 1
    s_cbranch_scc1 L_acc_26
    v_pk_fma_f32 v[80:81], v[32:33], v[18:19], v[80:81] op_sel:[0,0,0] op_sel_hi:[1,0,1]
    v_pk_fma_f32 v[82:83], v[34:35], v[18:19], v[82:83] op_sel:[0,0,0] op_sel_hi:[1,0,1]
    v_pk_fma_f32 v[84:85], v[36:37], v[22:23], v[84:85] op_sel:[0,0,0] op_sel_hi:[1,0,1]
    v_pk_fma_f32 v[86:87], v[38:39], v[22:23], v[86:87] op_sel:[0,0,0] op_sel_hi:[1,0,1]
    v_pk_fma_f32 v[88:89], v[40:41], v[26:27], v[88:89] op_sel:[0,0,0] op_sel_hi:[1,0,1]
    v_pk_fma_f32 v[90:91], v[42:43], v[26:27], v[90:91] op_sel:[0,0,0] op_sel_hi:[1,0,1]
    v_pk_fma_f32 v[92:93], v[44:45], v[30:31], v[92:93] op_sel:[0,0,0] op_sel_hi:[1,0,1]
    v_pk_fma_f32 v[94:95], v[46:47], v[30:31], v[94:95] op_sel:[0,0,0] op_sel_hi:[1,0,1]
    s_branch L_join_30
L_acc_26:
    v_pk_fma_f32 v[96:97], v[32:33], v[18:19], v[96:97] op_sel:[0,0,0] op_sel_hi:[1,0,1]
    v_pk_fma_f32 v[98:99], v[34:35], v[18:19], v[98:99] op_sel:[0,0,0] op_sel_hi:[1,0,1]
    v_pk_fma_f32 v[100:101], v[36:37], v[22:23], v[100:101] op_sel:[0,0,0] op_sel_hi:[1,0,1]
    v_pk_fma_f32 v[102:103], v[38:39], v[22:23], v[102:103] op_sel:[0,0,0] op_sel_hi:[1,0,1]
    v_pk_fma_f32 v[104:105], v[40:41], v[26:27], v[104:105] op_sel:[0,0,0] op_sel_hi:[1,0,1]
    v_pk_fma_f32 v[106:107], v[42:43], v[26:27], v[106:107] op_sel:[0,0,0] op_sel_hi:[1,0,1]
    v_pk_fma_f32 v[108:109], v[44:45], v[30:31], v[108:109] op_sel:[0,0,0] op_sel_hi:[1,0,1]
    v_pk_fma_f32 v[110:111], v[46:47], v[30:31], v[110:111] op_sel:[0,0,0] op_sel_hi:[1,0,1]
    s_branch L_join_30
L_acc_27:
    s_cmp_eq_u32 s70, 3
    s_cbranch_scc1 L_acc_28
    s_cmp_eq_u32 s70, 4
    s_cbranch_scc1 L_acc_29
    v_pk_fma_f32 v[112:113], v[32:33], v[18:19], v[112:113] op_sel:[0,0,0] op_sel_hi:[1,0,1]
    v_pk_fma_f32 v[114:115], v[34:35], v[18:19], v[114:115] op_sel:[0,0,0] op_sel_hi:[1,0,1]
    v_pk_fma_f32 v[116:117], v[36:37], v[22:23], v[116:117] op_sel:[0,0,0] op_sel_hi:[1,0,1]
    v_pk_fma_f32 v[118:119], v[38:39], v[22:23], v[118:119] op_sel:[0,0,0] op_sel_hi:[1,0,1]
    v_pk_fma_f32 v[120:121], v[40:41], v[26:27], v[120:121] op_sel:[0,0,0] op_sel_hi:[1,0,1]
    v_pk_fma_f32 v[122:123], v[42:43], v[26:27], v[122:123] op_sel:[0,0,0] op_sel_hi:[1,0,1]
    v_pk_fma_f32 v[124:125], v[44:45], v[30:31], v[124:125] op_sel:[0,0,0] op_sel_hi:[1,0,1]
    v_pk_fma_f32 v[126:127], v[46:47], v[30:31], v[126:127] op_sel:[0,0,0] op_sel_hi:[1,0,1]
    s_branch L_join_30
L_acc_28:
    v_pk_fma_f32 v[128:129], v[32:33], v[18:19], v[128:129] op_sel:[0,0,0] op_sel_hi:[1,0,1]
    v_pk_fma_f32 v[130:131], v[34:35], v[18:19], v[130:131] op_sel:[0,0,0] op_sel_hi:[1,0,1]
    v_pk_fma_f32 v[132:133], v[36:37], v[22:23], v[132:133] op_sel:[0,0,0] op_sel_hi:[1,0,1]
    v_pk_fma_f32 v[134:135], v[38:39], v[22:23], v[134:135] op_sel:[0,0,0] op_sel_hi:[1,0,1]
    v_pk_fma_f32 v[136:137], v[40:41], v[26:27], v[136:137] op_sel:[0,0,0] op_sel_hi:[1,0,1]
    v_pk_fma_f32 v[138:139], v[42:43], v[26:27], v[138:139] op_sel:[0,0,0] op_sel_hi:[1,0,1]
    v_pk_fma_f32 v[140:141], v[44:45], v[30:31], v[140:141] op_sel:[0,0,0] op_sel_hi:[1,0,1]
    v_pk_fma_f32 v[142:143], v[46:47], v[30:31], v[142:143] op_sel:[0,0,0] op_sel_hi:[1,0,1]
    s_branch L_join_30
L_acc_29:
    v_pk_fma_f32 v[144:145], v[32:33], v[18:19], v[144:145] op_sel:[0,0,0] op_sel_hi:[1,0,1]
    v_pk_fma_f32 v[146:147], v[34:35], v[18:19], v[146:147] op_sel:[0,0,0] op_sel_hi:[1,0,1]
    v_pk_fma_f32 v[148:149], v[36:37], v[22:23], v[148:149] op_sel:[0,0,0] op_sel_hi:[1,0,1]
    v_pk_fma_f32 v[150:151], v[38:39], v[22:23], v[150:151] op_sel:[0,0,0] op_sel_hi:[1,0,1]
    v_pk_fma_f32 v[152:153], v[40:41], v[26:27], v[152:153] op_sel:[0,0,0] op_sel_hi:[1,0,1]
    v_pk_fma_f32 v[154:155], v[42:43], v[26:27], v[154:155] op_sel:[0,0,0] op_sel_hi:[1,0,1]
    v_pk_fma_f32 v[156:157], v[44:45], v[30:31], v[156:157] op_sel:[0,0,0] op_sel_hi:[1,0,1]
    v_pk_fma_f32 v[158:159], v[46:47], v[30:31], v[158:159] op_sel:[0,0,0] op_sel_hi:[1,0,1]
L_join_30:
    s_and_b32 s70, s66, 7
    s_sub_u32 s62, s62, 1
    s_cmp_eq_u32 s62, 0
    s_cbranch_scc1 L_sweep_done
    ds_read_b64 v[56:57], v5 offset:192
    s_cmp_ge_u32 s62, 4
    s_cbranch_scc1 L_31
    s_waitcnt vmcnt(0)
L_31:
    s_waitcnt vmcnt(6)
    ds_read_b64_tr_b16 v[48:49], v4 offset:6144
    ds_read_b64_tr_b16 v[50:51], v4 offset:6400
    ds_read_b64_tr_b16 v[52:53], v4 offset:6656
    ds_read_b64_tr_b16 v[54:55], v4 offset:6912
    s_waitcnt lgkmcnt(0)
    s_cmp_le_u32 s62, 4
    s_cbranch_scc1 L_32
    s_add_u32 m0, s63, 6144
    s_andn2_b32 s72, s67, 7
    buffer_load_dwordx4 v2, s[8:11], s72 offen lds
    buffer_load_dwordx4 v3, s[8:11], s72 offen offset:1024 lds
L_32:
    v_mfma_f32_4x4x4_16b_bf16 v[32:35], v[56:57], v[48:49], 0
    v_mfma_f32_4x4x4_16b_bf16 v[36:39], v[56:57], v[50:51], 0
    v_mfma_f32_4x4x4_16b_bf16 v[40:43], v[56:57], v[52:53], 0
    v_mfma_f32_4x4x4_16b_bf16 v[44:47], v[56:57], v[54:55], 0
    s_nop 1
    s_cmp_ge_u32 s71, 2
    s_cbranch_scc1 L_acc_35
    s_cmp_eq_u32 s71, 1
    s_cbranch_scc1 L_acc_34
    v_pk_fma_f32 v[80:81], v[32:33], v[18:19], v[80:81] op_sel:[0,1,0] op_sel_hi:[1,1,1]
    v_pk_fma_f32 v[82:83], v[34:35], v[18:19], v[82:83] op_sel:[0,1,0] op_sel_hi:[1,1,1]
    v_pk_fma_f32 v[84:85], v[36:37], v[22:23], v[84:85] op_sel:[0,1,0] op_sel_hi:[1,1,1]
    v_pk_fma_f32 v[86:87], v[38:39], v[22:23], v[86:87] op_sel:[0,1,0] op_sel_hi:[1,1,1]
    v_pk_fma_f32 v[88:89], v[40:41], v[26:27], v[88:89] op_sel:[0,1,0] op_sel_hi:[1,1,1]
    v_pk_fma_f32 v[90:91], v[42:43], v[26:27], v[90:91] op_sel:[0,1,0] op_sel_hi:[1,1,1]
    v_pk_fma_f32 v[92:93], v[44:45], v[30:31], v[92:93] op_sel:[0,1,0] op_sel_hi:[1,1,1]
    v_pk_fma_f32 v[94:95], v[46:47], v[30:31], v[94:95] op_sel:[0,1,0] op_sel_hi:[1,1,1]
    s_branch L_join_38
L_acc_34:
    v_pk_fma_f32 v[96:97], v[32:33], v[18:19], v[96:97] op_sel:[0,1,0] op_sel_hi:[1,1,1]
    v_pk_fma_f32 v[98:99], v[34:35], v[18:19], v[98:99] op_sel:[0,1,0] op_sel_hi:[1,1,1]
    v_pk_fma_f32 v[100:101], v[36:37], v[22:23], v[100:101] op_sel:[0,1,0] op_sel_hi:[1,1,1]
    v_pk_fma_f32 v[102:103], v[38:39], v[22:23], v[102:103] op_sel:[0,1,0] op_sel_hi:[1,1,1]
    v_pk_fma_f32 v[104:105], v[40:41], v[26:27], v[104:105] op_sel:[0,1,0] op_sel_hi:[1,1,1]
    v_pk_fma_f32 v[106:107], v[42:43], v[26:27], v[106:107] op_sel:[0,1,0] op_sel_hi:[1,1,1]
    v_pk_fma_f32 v[108:109], v[44:45], v[30:31], v[108:109] op_sel:[0,1,0] op_sel_hi:[1,1,1]
    v_pk_fma_f32 v[110:111], v[46:47], v[30:31], v[110:111] op_sel:[0,1,0] op_sel_hi:[1,1,1]
    s_branch L_join_38
L_acc_35:
    s_cmp_eq_u32 s71, 3
    s_cbranch_scc1 L_acc_36
    s_cmp_eq_u32 s71, 4
    s_cbranch_scc1 L_acc_37
    v_pk_fma_f32 v[112:113], v[32:33], v[18:19], v[112:113] op_sel:[0,1,0] op_sel_hi:[1,1,1]
    v_pk_fma_f32 v[114:115], v[34:35], v[18:19], v[114:115] op_sel:[0,1,0] op_sel_hi:[1,1,1]
    v_pk_fma_f32 v[116:117], v[36:37], v[22:23], v[116:117] op_sel:[0,1,0] op_sel_hi:[1,1,1]
    v_pk_fma_f32 v[118:119], v[38:39], v[22:23], v[118:119] op_sel:[0,1,0] op_sel_hi:[1,1,1]
    v_pk_fma_f32 v[120:121], v[40:41], v[26:27], v[120:121] op_sel:[0,1,0] op_sel_hi:[1,1,1]
    v_pk_fma_f32 v[122:123], v[42:43], v[26:27], v[122:123] op_sel:[0,1,0] op_sel_hi:[1,1,1]
    v_pk_fma_f32 v[124:125], v[44:45], v[30:31], v[124:125] op_sel:[0,1,0] op_sel_hi:[1,1,1]
    v_pk_fma_f32 v[126:127], v[46:47], v[30:31], v[126:127] op_sel:[0,1,0] op_sel_hi:[1,1,1]
    s_branch L_join_38
L_acc_36:
    v_pk_fma_f32 v[128:129], v[32:33], v[18:19], v[128:129] op_sel:[0,1,0] op_sel_hi:[1,1,1]
    v_pk_fma_f32 v[130:131], v[34:35], v[18:19], v[130:131] op_sel:[0,1,0] op_sel_hi:[1,1,1]
    v_pk_fma_f32 v[132:133], v[36:37], v[22:23], v[132:133] op_sel:[0,1,0] op_sel_hi:[1,1,1]
    v_pk_fma_f32 v[134:135], v[38:39], v[22:23], v[134:135] op_sel:[0,1,0] op_sel_hi:[1,1,1]
    v_pk_fma_f32 v[136:137], v[40:41], v[26:27], v[136:137] op_sel:[0,1,0] op_sel_hi:[1,1,1]
    v_pk_fma_f32 v[138:139], v[42:43], v[26:27], v[138:139] op_sel:[0,1,0] op_sel_hi:[1,1,1]
    v_pk_fma_f32 v[140:141], v[44:45], v[30:31], v[140:141] op_sel:[0,1,0] op_sel_hi:[1,1,1]
    v_pk_fma_f32 v[142:143], v[46:47], v[30:31], v[142:143] op_sel:[0,1,0] op_sel_hi:[1,1,1]
    s_branch L_join_38
L_acc_37:
    v_pk_fma_f32 v[144:145], v[32:33], v[18:19], v[144:145] op_sel:[0,1,0] op_sel_hi:[1,1,1]
    v_pk_fma_f32 v[146:147], v[34:35], v[18:19], v[146:147] op_sel:[0,1,0] op_sel_hi:[1,1,1]
    v_pk_fma_f32 v[148:149], v[36:37], v[22:23], v[148:149] op_sel:[0,1,0] op_sel_hi:[1,1,1]
    v_pk_fma_f32 v[150:151], v[38:39], v[22:23], v[150:151] op_sel:[0,1,0] op_sel_hi:[1,1,1]
    v_pk_fma_f32 v[152:153], v[40:41], v[26:27], v[152:153] op_sel:[0,1,0] op_sel_hi:[1,1,1]
    v_pk_fma_f32 v[154:155], v[42:43], v[26:27], v[154:155] op_sel:[0,1,0] op_sel_hi:[1,1,1]
    v_pk_fma_f32 v[156:157], v[44:45], v[30:31], v[156:157] op_sel:[0,1,0] op_sel_hi:[1,1,1]
    v_pk_fma_f32 v[158:159], v[46:47], v[30:31], v[158:159] op_sel:[0,1,0] op_sel_hi:[1,1,1]
L_join_38:
    s_and_b32 s71, s67, 7
    s_sub_u32 s62, s62, 1
    s_cmp_eq_u32 s62, 0
    s_cbranch_scc1 L_sweep_done
    v_add_u32 v5, 256, v5
    s_branch L_group
L_sweep_done:
    s_add_u32 s73, s73, 1
    s_cmp_lg_u32 s74, 0
    s_cbranch_scc1 L_round
    s_lshl_b32 s53, s3, 14
    s_add_u32 s53, s53, 2097152
    v_lshlrev_b32 v16, 4, v1
    v_add_u32 v16, s53, v16
    buffer_load_dwordx4 a[32:35], v16, s[44:47], 0 offen offset:0
    buffer_load_dwordx4 a[36:39], v16, s[44:47], 0 offen offset:1024
    buffer_load_dwordx4 a[40:43], v16, s[44:47], 0 offen offset:2048
    buffer_load_dwordx4 a[44:47], v16, s[44:47], 0 offen offset:3072
    v_add_u32 v16, 4096, v16
    buffer_load_dwordx4 a[48:51], v16, s[44:47], 0 offen offset:0
    buffer_load_dwordx4 a[52:55], v16, s[44:47], 0 offen offset:1024
    buffer_load_dwordx4 a[56:59], v16, s[44:47], 0 offen offset:2048
    buffer_load_dwordx4 a[60:63], v16, s[44:47], 0 offen offset:3072
    v_add_u32 v16, 4096, v16
    buffer_load_dwordx4 a[64:67], v16, s[44:47], 0 offen offset:0
    buffer_load_dwordx4 a[68:71], v16, s[44:47], 0 offen offset:1024
    buffer_load_dwordx4 a[72:75], v16, s[44:47], 0 offen offset:2048
    buffer_load_dwordx4 a[76:79], v16, s[44:47], 0 offen offset:3072
    v_add_u32 v16, 4096, v16
    buffer_load_dwordx4 a[80:83], v16, s[44:47], 0 offen offset:0
    buffer_load_dwordx4 a[84:87], v16, s[44:47], 0 offen offset:1024
    buffer_load_dwordx4 a[88:91], v16, s[44:47], 0 offen offset:2048
    buffer_load_dwordx4 a[92:95], v16, s[44:47], 0 offen offset:3072
    v_add_u32 v16, 4096, v16
    s_barrier
    v_mul_u32_u24 v16, 320, v1
    v_lshrrev_b32 v17, 2, v1
    v_lshl_add_u32 v16, v17, 3, v16
    s_lshl_b32 s53, s56, 3
    v_add_u32 v17, s53, v16
    s_lshl_b32 s53, s57, 3
    v_add_u32 v18, s53, v16
    s_lshl_b32 s53, s58, 3
    v_add_u32 v19, s53, v16
    s_lshl_b32 s53, s59, 3
    v_add_u32 v20, s53, v16
    s_lshl_b32 s53, s60, 3
    v_add_u32 v21, s53, v16
    v_cvt_pk_bf16_f32 v24, v80, v81
    v_cvt_pk_bf16_f32 v25, v82, v83
    ds_write_b64 v17, v[24:25] offset:0
    v_cvt_pk_bf16_f32 v26, v84, v85
    v_cvt_pk_bf16_f32 v27, v86, v87
    ds_write_b64 v17, v[26:27] offset:20608
    v_cvt_pk_bf16_f32 v28, v88, v89
    v_cvt_pk_bf16_f32 v29, v90, v91
    ds_write_b64 v17, v[28:29] offset:41216
    v_cvt_pk_bf16_f32 v30, v92, v93
    v_cvt_pk_bf16_f32 v31, v94, v95
    ds_write_b64 v17, v[30:31] offset:61824
    v_cvt_pk_bf16_f32 v32, v96, v97
    v_cvt_pk_bf16_f32 v33, v98, v99
    ds_write_b64 v18, v[32:33] offset:0
    v_cvt_pk_bf16_f32 v34, v100, v101
    v_cvt_pk_bf16_f32 v35, v102, v103
    ds_write_b64 v18, v[34:35] offset:20608
    v_cvt_pk_bf16_f32 v36, v104, v105
    v_cvt_pk_bf16_f32 v37, v106, v107
    ds_write_b64 v18, v[36:37] offset:41216
    v_cvt_pk_bf16_f32 v38, v108, v109
    v_cvt_pk_bf16_f32 v39, v110, v111
    ds_write_b64 v18, v[38:39] offset:61824
    v_cvt_pk_bf16_f32 v24, v112, v113
    v_cvt_pk_bf16_f32 v25, v114, v115
    ds_write_b64 v19, v[24:25] offset:0
    v_cvt_pk_bf16_f32 v26, v116, v117
    v_cvt_pk_bf16_f32 v27, v118, v119
    ds_write_b64 v19, v[26:27] offset:20608
    v_cvt_pk_bf16_f32 v28, v120, v121
    v_cvt_pk_bf16_f32 v29, v122, v123
    ds_write_b64 v19, v[28:29] offset:41216
    v_cvt_pk_bf16_f32 v30, v124, v125
    v_cvt_pk_bf16_f32 v31, v126, v127
    ds_write_b64 v19, v[30:31] offset:61824
    v_cvt_pk_bf16_f32 v32, v128, v129
    v_cvt_pk_bf16_f32 v33, v130, v131
    ds_write_b64 v20, v[32:33] offset:0
    v_cvt_pk_bf16_f32 v34, v132, v133
    v_cvt_pk_bf16_f32 v35, v134, v135
    ds_write_b64 v20, v[34:35] offset:20608
    v_cvt_pk_bf16_f32 v36, v136, v137
    v_cvt_pk_bf16_f32 v37, v138, v139
    ds_write_b64 v20, v[36:37] offset:41216
    v_cvt_pk_bf16_f32 v38, v140, v141
    v_cvt_pk_bf16_f32 v39, v142, v143
    ds_write_b64 v20, v[38:39] offset:61824
    v_cvt_pk_bf16_f32 v24, v144, v145
    v_cvt_pk_bf16_f32 v25, v146, v147
    ds_write_b64 v21, v[24:25] offset:0
    v_cvt_pk_bf16_f32 v26, v148, v149
    v_cvt_pk_bf16_f32 v27, v150, v151
    ds_write_b64 v21, v[26:27] offset:20608
    v_cvt_pk_bf16_f32 v28, v152, v153
    v_cvt_pk_bf16_f32 v29, v154, v155
    ds_write_b64 v21, v[28:29] offset:41216
    v_cvt_pk_bf16_f32 v30, v156, v157
    v_cvt_pk_bf16_f32 v31, v158, v159
    ds_write_b64 v21, v[30:31] offset:61824
    v_lshrrev_b32 v40, 5, v1
    v_mul_u32_u24 v41, 2576, v40
    v_bfe_u32 v42, v1, 2, 2
    v_mul_u32_u24 v42, 320, v42
    v_bfe_u32 v43, v1, 4, 1
    v_lshl_add_u32 v41, v43, 5, v41
    v_and_b32 v43, 3, v1
    v_lshl_add_u32 v41, v43, 3, v41
    v_add_u32 v2, v41, v42
    v_add_u32 v3, 41216, v2
    v_bfe_u32 v42, v1, 2, 3
    v_lshlrev_b32 v42, 19, v42
    v_lshl_add_u32 v42, v43, 9, v42
    v_lshl_add_u32 v42, v40, 4, v42
    s_lshl_b32 s53, s2, 11
    s_lshl_b32 s54, s3, 6
    s_add_u32 s53, s53, s54
    v_add_u32 v4, s53, v42
    s_waitcnt vmcnt(0) lgkmcnt(0)
    s_barrier
    ds_read_b64_tr_b16 v[16:17], v2 offset:0
    ds_read_b64_tr_b16 v[18:19], v2 offset:1288
    ds_read_b64_tr_b16 v[20:21], v2 offset:5152
    ds_read_b64_tr_b16 v[22:23], v2 offset:6440
    ds_read_b64_tr_b16 v[24:25], v2 offset:10304
    ds_read_b64_tr_b16 v[26:27], v2 offset:11592
    ds_read_b64_tr_b16 v[28:29], v2 offset:15456
    ds_read_b64_tr_b16 v[30:31], v2 offset:16744
    ds_read_b64_tr_b16 v[32:33], v2 offset:20608
    ds_read_b64_tr_b16 v[34:35], v2 offset:21896
    ds_read_b64_tr_b16 v[36:37], v2 offset:25760
    ds_read_b64_tr_b16 v[38:39], v2 offset:27048
    ds_read_b64_tr_b16 v[40:41], v2 offset:30912
    ds_read_b64_tr_b16 v[42:43], v2 offset:32200
    ds_read_b64_tr_b16 v[44:45], v2 offset:36064
    ds_read_b64_tr_b16 v[46:47], v2 offset:37352
    s_waitcnt lgkmcnt(8)
    v_mfma_f32_32x32x16_bf16 v[48:63], a[32:35], v[16:19], 0
    v_mfma_f32_32x32x16_bf16 v[48:63], a[36:39], v[20:23], v[48:63]
    v_mfma_f32_32x32x16_bf16 v[48:63], a[40:43], v[24:27], v[48:63]
    v_mfma_f32_32x32x16_bf16 v[48:63], a[44:47], v[28:31], v[48:63]
    ds_read_b64_tr_b16 v[16:17], v3 offset:0
    ds_read_b64_tr_b16 v[18:19], v3 offset:1288
    ds_read_b64_tr_b16 v[20:21], v3 offset:5152
    ds_read_b64_tr_b16 v[22:23], v3 offset:6440
    ds_read_b64_tr_b16 v[24:25], v3 offset:10304
    ds_read_b64_tr_b16 v[26:27], v3 offset:11592
    ds_read_b64_tr_b16 v[28:29], v3 offset:15456
    ds_read_b64_tr_b16 v[30:31], v3 offset:16744
    s_waitcnt lgkmcnt(8)
    v_mfma_f32_32x32x16_bf16 v[48:63], a[48:51], v[32:35], v[48:63]
    v_mfma_f32_32x32x16_bf16 v[48:63], a[52:55], v[36:39], v[48:63]
    v_mfma_f32_32x32x16_bf16 v[48:63], a[56:59], v[40:43], v[48:63]
    v_mfma_f32_32x32x16_bf16 v[48:63], a[60:63], v[44:47], v[48:63]
    ds_read_b64_tr_b16 v[32:33], v3 offset:20608
    ds_read_b64_tr_b16 v[34:35], v3 offset:21896
    ds_read_b64_tr_b16 v[36:37], v3 offset:25760
    ds_read_b64_tr_b16 v[38:39], v3 offset:27048
    ds_read_b64_tr_b16 v[40:41], v3 offset:30912
    ds_read_b64_tr_b16 v[42:43], v3 offset:32200
    ds_read_b64_tr_b16 v[44:45], v3 offset:36064
    ds_read_b64_tr_b16 v[46:47], v3 offset:37352
    s_waitcnt lgkmcnt(8)
    v_mfma_f32_32x32x16_bf16 v[48:63], a[64:67], v[16:19], v[48:63]
    v_mfma_f32_32x32x16_bf16 v[48:63], a[68:71], v[20:23], v[48:63]
    v_mfma_f32_32x32x16_bf16 v[48:63], a[72:75], v[24:27], v[48:63]
    v_mfma_f32_32x32x16_bf16 v[48:63], a[76:79], v[28:31], v[48:63]
    ds_read_b64_tr_b16 v[16:17], v2 offset:64
    ds_read_b64_tr_b16 v[18:19], v2 offset:1352
    ds_read_b64_tr_b16 v[20:21], v2 offset:5216
    ds_read_b64_tr_b16 v[22:23], v2 offset:6504
    ds_read_b64_tr_b16 v[24:25], v2 offset:10368
    ds_read_b64_tr_b16 v[26:27], v2 offset:11656
    ds_read_b64_tr_b16 v[28:29], v2 offset:15520
    ds_read_b64_tr_b16 v[30:31], v2 offset:16808
    s_waitcnt lgkmcnt(8)
    v_mfma_f32_32x32x16_bf16 v[48:63], a[80:83], v[32:35], v[48:63]
    v_mfma_f32_32x32x16_bf16 v[48:63], a[84:87], v[36:39], v[48:63]
    v_mfma_f32_32x32x16_bf16 v[48:63], a[88:91], v[40:43], v[48:63]
    v_mfma_f32_32x32x16_bf16 v[48:63], a[92:95], v[44:47], v[48:63]
    ds_read_b64_tr_b16 v[32:33], v2 offset:20672
    ds_read_b64_tr_b16 v[34:35], v2 offset:21960
    ds_read_b64_tr_b16 v[36:37], v2 offset:25824
    ds_read_b64_tr_b16 v[38:39], v2 offset:27112
    ds_read_b64_tr_b16 v[40:41], v2 offset:30976
    ds_read_b64_tr_b16 v[42:43], v2 offset:32264
    ds_read_b64_tr_b16 v[44:45], v2 offset:36128
    ds_read_b64_tr_b16 v[46:47], v2 offset:37416
    s_waitcnt lgkmcnt(8)
    v_mfma_f32_32x32x16_bf16 v[64:79], a[32:35], v[16:19], 0
    v_mfma_f32_32x32x16_bf16 v[64:79], a[36:39], v[20:23], v[64:79]
    v_mfma_f32_32x32x16_bf16 v[64:79], a[40:43], v[24:27], v[64:79]
    v_mfma_f32_32x32x16_bf16 v[64:79], a[44:47], v[28:31], v[64:79]
    s_nop 7
    v_cvt_pk_bf16_f32 v80, v48, v49
    v_cvt_pk_bf16_f32 v81, v50, v51
    v_cvt_pk_bf16_f32 v82, v52, v53
    v_cvt_pk_bf16_f32 v83, v54, v55
    v_cvt_pk_bf16_f32 v84, v56, v57
    v_cvt_pk_bf16_f32 v85, v58, v59
    v_cvt_pk_bf16_f32 v86, v60, v61
    v_cvt_pk_bf16_f32 v87, v62, v63
    s_nop 1
    v_permlane32_swap_b32 v80, v82
    v_permlane32_swap_b32 v81, v83
    v_permlane32_swap_b32 v84, v86
    v_permlane32_swap_b32 v85, v87
    buffer_store_dwordx4 v[80:83], v4, s[32:35], 0 offen
    buffer_store_dwordx4 v[84:87], v4, s[32:35], 0 offen offset:32
    v_add_u32 v4, 4194304, v4
    ds_read_b64_tr_b16 v[16:17], v3 offset:64
    ds_read_b64_tr_b16 v[18:19], v3 offset:1352
    ds_read_b64_tr_b16 v[20:21], v3 offset:5216
    ds_read_b64_tr_b16 v[22:23], v3 offset:6504
    ds_read_b64_tr_b16 v[24:25], v3 offset:10368
    ds_read_b64_tr_b16 v[26:27], v3 offset:11656
    ds_read_b64_tr_b16 v[28:29], v3 offset:15520
    ds_read_b64_tr_b16 v[30:31], v3 offset:16808
    s_waitcnt lgkmcnt(8)
    v_mfma_f32_32x32x16_bf16 v[64:79], a[48:51], v[32:35], v[64:79]
    v_mfma_f32_32x32x16_bf16 v[64:79], a[52:55], v[36:39], v[64:79]
    v_mfma_f32_32x32x16_bf16 v[64:79], a[56:59], v[40:43], v[64:79]
    v_mfma_f32_32x32x16_bf16 v[64:79], a[60:63], v[44:47], v[64:79]
    ds_read_b64_tr_b16 v[32:33], v3 offset:20672
    ds_read_b64_tr_b16 v[34:35], v3 offset:21960
    ds_read_b64_tr_b16 v[36:37], v3 offset:25824
    ds_read_b64_tr_b16 v[38:39], v3 offset:27112
    ds_read_b64_tr_b16 v[40:41], v3 offset:30976
    ds_read_b64_tr_b16 v[42:43], v3 offset:32264
    ds_read_b64_tr_b16 v[44:45], v3 offset:36128
    ds_read_b64_tr_b16 v[46:47], v3 offset:37416
    s_waitcnt lgkmcnt(8)
    v_mfma_f32_32x32x16_bf16 v[64:79], a[64:67], v[16:19], v[64:79]
    v_mfma_f32_32x32x16_bf16 v[64:79], a[68:71], v[20:23], v[64:79]
    v_mfma_f32_32x32x16_bf16 v[64:79], a[72:75], v[24:27], v[64:79]
    v_mfma_f32_32x32x16_bf16 v[64:79], a[76:79], v[28:31], v[64:79]
    ds_read_b64_tr_b16 v[16:17], v2 offset:128
    ds_read_b64_tr_b16 v[18:19], v2 offset:1416
    ds_read_b64_tr_b16 v[20:21], v2 offset:5280
    ds_read_b64_tr_b16 v[22:23], v2 offset:6568
    ds_read_b64_tr_b16 v[24:25], v2 offset:10432
    ds_read_b64_tr_b16 v[26:27], v2 offset:11720
    ds_read_b64_tr_b16 v[28:29], v2 offset:15584
    ds_read_b64_tr_b16 v[30:31], v2 offset:16872
    s_waitcnt lgkmcnt(8)
    v_mfma_f32_32x32x16_bf16 v[64:79], a[80:83], v[32:35], v[64:79]
    v_mfma_f32_32x32x16_bf16 v[64:79], a[84:87], v[36:39], v[64:79]
    v_mfma_f32_32x32x16_bf16 v[64:79], a[88:91], v[40:43], v[64:79]
    v_mfma_f32_32x32x16_bf16 v[64:79], a[92:95], v[44:47], v[64:79]
    ds_read_b64_tr_b16 v[32:33], v2 offset:20736
    ds_read_b64_tr_b16 v[34:35], v2 offset:22024
    ds_read_b64_tr_b16 v[36:37], v2 offset:25888
    ds_read_b64_tr_b16 v[38:39], v2 offset:27176
    ds_read_b64_tr_b16 v[40:41], v2 offset:31040
    ds_read_b64_tr_b16 v[42:43], v2 offset:32328
    ds_read_b64_tr_b16 v[44:45], v2 offset:36192
    ds_read_b64_tr_b16 v[46:47], v2 offset:37480
    s_waitcnt lgkmcnt(8)
    v_mfma_f32_32x32x16_bf16 v[48:63], a[32:35], v[16:19], 0
    v_mfma_f32_32x32x16_bf16 v[48:63], a[36:39], v[20:23], v[48:63]
    v_mfma_f32_32x32x16_bf16 v[48:63], a[40:43], v[24:27], v[48:63]
    v_mfma_f32_32x32x16_bf16 v[48:63], a[44:47], v[28:31], v[48:63]
    s_nop 7
    v_cvt_pk_bf16_f32 v88, v64, v65
    v_cvt_pk_bf16_f32 v89, v66, v67
    v_cvt_pk_bf16_f32 v90, v68, v69
    v_cvt_pk_bf16_f32 v91, v70, v71
    v_cvt_pk_bf16_f32 v92, v72, v73
    v_cvt_pk_bf16_f32 v93, v74, v75
    v_cvt_pk_bf16_f32 v94, v76, v77
    v_cvt_pk_bf16_f32 v95, v78, v79
    s_nop 1
    v_permlane32_swap_b32 v88, v90
    v_permlane32_swap_b32 v89, v91
    v_permlane32_swap_b32 v92, v94
    v_permlane32_swap_b32 v93, v95
    buffer_store_dwordx4 v[88:91], v4, s[32:35], 0 offen
    buffer_store_dwordx4 v[92:95], v4, s[32:35], 0 offen offset:32
    v_add_u32 v4, 4194304, v4
    ds_read_b64_tr_b16 v[16:17], v3 offset:128
    ds_read_b64_tr_b16 v[18:19], v3 offset:1416
    ds_read_b64_tr_b16 v[20:21], v3 offset:5280
    ds_read_b64_tr_b16 v[22:23], v3 offset:6568
    ds_read_b64_tr_b16 v[24:25], v3 offset:10432
    ds_read_b64_tr_b16 v[26:27], v3 offset:11720
    ds_read_b64_tr_b16 v[28:29], v3 offset:15584
    ds_read_b64_tr_b16 v[30:31], v3 offset:16872
    s_waitcnt lgkmcnt(8)
    v_mfma_f32_32x32x16_bf16 v[48:63], a[48:51], v[32:35], v[48:63]
    v_mfma_f32_32x32x16_bf16 v[48:63], a[52:55], v[36:39], v[48:63]
    v_mfma_f32_32x32x16_bf16 v[48:63], a[56:59], v[40:43], v[48:63]
    v_mfma_f32_32x32x16_bf16 v[48:63], a[60:63], v[44:47], v[48:63]
    ds_read_b64_tr_b16 v[32:33], v3 offset:20736
    ds_read_b64_tr_b16 v[34:35], v3 offset:22024
    ds_read_b64_tr_b16 v[36:37], v3 offset:25888
    ds_read_b64_tr_b16 v[38:39], v3 offset:27176
    ds_read_b64_tr_b16 v[40:41], v3 offset:31040
    ds_read_b64_tr_b16 v[42:43], v3 offset:32328
    ds_read_b64_tr_b16 v[44:45], v3 offset:36192
    ds_read_b64_tr_b16 v[46:47], v3 offset:37480
    s_waitcnt lgkmcnt(8)
    v_mfma_f32_32x32x16_bf16 v[48:63], a[64:67], v[16:19], v[48:63]
    v_mfma_f32_32x32x16_bf16 v[48:63], a[68:71], v[20:23], v[48:63]
    v_mfma_f32_32x32x16_bf16 v[48:63], a[72:75], v[24:27], v[48:63]
    v_mfma_f32_32x32x16_bf16 v[48:63], a[76:79], v[28:31], v[48:63]
    ds_read_b64_tr_b16 v[16:17], v2 offset:192
    ds_read_b64_tr_b16 v[18:19], v2 offset:1480
    ds_read_b64_tr_b16 v[20:21], v2 offset:5344
    ds_read_b64_tr_b16 v[22:23], v2 offset:6632
    ds_read_b64_tr_b16 v[24:25], v2 offset:10496
    ds_read_b64_tr_b16 v[26:27], v2 offset:11784
    ds_read_b64_tr_b16 v[28:29], v2 offset:15648
    ds_read_b64_tr_b16 v[30:31], v2 offset:16936
    s_waitcnt lgkmcnt(8)
    v_mfma_f32_32x32x16_bf16 v[48:63], a[80:83], v[32:35], v[48:63]
    v_mfma_f32_32x32x16_bf16 v[48:63], a[84:87], v[36:39], v[48:63]
    v_mfma_f32_32x32x16_bf16 v[48:63], a[88:91], v[40:43], v[48:63]
    v_mfma_f32_32x32x16_bf16 v[48:63], a[92:95], v[44:47], v[48:63]
    ds_read_b64_tr_b16 v[32:33], v2 offset:20800
    ds_read_b64_tr_b16 v[34:35], v2 offset:22088
    ds_read_b64_tr_b16 v[36:37], v2 offset:25952
    ds_read_b64_tr_b16 v[38:39], v2 offset:27240
    ds_read_b64_tr_b16 v[40:41], v2 offset:31104
    ds_read_b64_tr_b16 v[42:43], v2 offset:32392
    ds_read_b64_tr_b16 v[44:45], v2 offset:36256
    ds_read_b64_tr_b16 v[46:47], v2 offset:37544
    s_waitcnt lgkmcnt(8)
    v_mfma_f32_32x32x16_bf16 v[64:79], a[32:35], v[16:19], 0
    v_mfma_f32_32x32x16_bf16 v[64:79], a[36:39], v[20:23], v[64:79]
    v_mfma_f32_32x32x16_bf16 v[64:79], a[40:43], v[24:27], v[64:79]
    v_mfma_f32_32x32x16_bf16 v[64:79], a[44:47], v[28:31], v[64:79]
    s_nop 7
    v_cvt_pk_bf16_f32 v80, v48, v49
    v_cvt_pk_bf16_f32 v81, v50, v51
    v_cvt_pk_bf16_f32 v82, v52, v53
    v_cvt_pk_bf16_f32 v83, v54, v55
    v_cvt_pk_bf16_f32 v84, v56, v57
    v_cvt_pk_bf16_f32 v85, v58, v59
    v_cvt_pk_bf16_f32 v86, v60, v61
    v_cvt_pk_bf16_f32 v87, v62, v63
    s_nop 1
    v_permlane32_swap_b32 v80, v82
    v_permlane32_swap_b32 v81, v83
    v_permlane32_swap_b32 v84, v86
    v_permlane32_swap_b32 v85, v87
    buffer_store_dwordx4 v[80:83], v4, s[32:35], 0 offen
    buffer_store_dwordx4 v[84:87], v4, s[32:35], 0 offen offset:32
    v_add_u32 v4, 4194304, v4
    ds_read_b64_tr_b16 v[16:17], v3 offset:192
    ds_read_b64_tr_b16 v[18:19], v3 offset:1480
    ds_read_b64_tr_b16 v[20:21], v3 offset:5344
    ds_read_b64_tr_b16 v[22:23], v3 offset:6632
    ds_read_b64_tr_b16 v[24:25], v3 offset:10496
    ds_read_b64_tr_b16 v[26:27], v3 offset:11784
    ds_read_b64_tr_b16 v[28:29], v3 offset:15648
    ds_read_b64_tr_b16 v[30:31], v3 offset:16936
    s_waitcnt lgkmcnt(8)
    v_mfma_f32_32x32x16_bf16 v[64:79], a[48:51], v[32:35], v[64:79]
    v_mfma_f32_32x32x16_bf16 v[64:79], a[52:55], v[36:39], v[64:79]
    v_mfma_f32_32x32x16_bf16 v[64:79], a[56:59], v[40:43], v[64:79]
    v_mfma_f32_32x32x16_bf16 v[64:79], a[60:63], v[44:47], v[64:79]
    ds_read_b64_tr_b16 v[32:33], v3 offset:20800
    ds_read_b64_tr_b16 v[34:35], v3 offset:22088
    ds_read_b64_tr_b16 v[36:37], v3 offset:25952
    ds_read_b64_tr_b16 v[38:39], v3 offset:27240
    ds_read_b64_tr_b16 v[40:41], v3 offset:31104
    ds_read_b64_tr_b16 v[42:43], v3 offset:32392
    ds_read_b64_tr_b16 v[44:45], v3 offset:36256
    ds_read_b64_tr_b16 v[46:47], v3 offset:37544
    s_waitcnt lgkmcnt(8)
    v_mfma_f32_32x32x16_bf16 v[64:79], a[64:67], v[16:19], v[64:79]
    v_mfma_f32_32x32x16_bf16 v[64:79], a[68:71], v[20:23], v[64:79]
    v_mfma_f32_32x32x16_bf16 v[64:79], a[72:75], v[24:27], v[64:79]
    v_mfma_f32_32x32x16_bf16 v[64:79], a[76:79], v[28:31], v[64:79]
    ds_read_b64_tr_b16 v[16:17], v2 offset:256
    ds_read_b64_tr_b16 v[18:19], v2 offset:1544
    ds_read_b64_tr_b16 v[20:21], v2 offset:5408
    ds_read_b64_tr_b16 v[22:23], v2 offset:6696
    ds_read_b64_tr_b16 v[24:25], v2 offset:10560
    ds_read_b64_tr_b16 v[26:27], v2 offset:11848
    ds_read_b64_tr_b16 v[28:29], v2 offset:15712
    ds_read_b64_tr_b16 v[30:31], v2 offset:17000
    s_waitcnt lgkmcnt(8)
    v_mfma_f32_32x32x16_bf16 v[64:79], a[80:83], v[32:35], v[64:79]
    v_mfma_f32_32x32x16_bf16 v[64:79], a[84:87], v[36:39], v[64:79]
    v_mfma_f32_32x32x16_bf16 v[64:79], a[88:91], v[40:43], v[64:79]
    v_mfma_f32_32x32x16_bf16 v[64:79], a[92:95], v[44:47], v[64:79]
    ds_read_b64_tr_b16 v[32:33], v2 offset:20864
    ds_read_b64_tr_b16 v[34:35], v2 offset:22152
    ds_read_b64_tr_b16 v[36:37], v2 offset:26016
    ds_read_b64_tr_b16 v[38:39], v2 offset:27304
    ds_read_b64_tr_b16 v[40:41], v2 offset:31168
    ds_read_b64_tr_b16 v[42:43], v2 offset:32456
    ds_read_b64_tr_b16 v[44:45], v2 offset:36320
    ds_read_b64_tr_b16 v[46:47], v2 offset:37608
    s_waitcnt lgkmcnt(8)
    v_mfma_f32_32x32x16_bf16 v[48:63], a[32:35], v[16:19], 0
    v_mfma_f32_32x32x16_bf16 v[48:63], a[36:39], v[20:23], v[48:63]
    v_mfma_f32_32x32x16_bf16 v[48:63], a[40:43], v[24:27], v[48:63]
    v_mfma_f32_32x32x16_bf16 v[48:63], a[44:47], v[28:31], v[48:63]
    s_nop 7
    v_cvt_pk_bf16_f32 v88, v64, v65
    v_cvt_pk_bf16_f32 v89, v66, v67
    v_cvt_pk_bf16_f32 v90, v68, v69
    v_cvt_pk_bf16_f32 v91, v70, v71
    v_cvt_pk_bf16_f32 v92, v72, v73
    v_cvt_pk_bf16_f32 v93, v74, v75
    v_cvt_pk_bf16_f32 v94, v76, v77
    v_cvt_pk_bf16_f32 v95, v78, v79
    s_nop 1
    v_permlane32_swap_b32 v88, v90
    v_permlane32_swap_b32 v89, v91
    v_permlane32_swap_b32 v92, v94
    v_permlane32_swap_b32 v93, v95
    buffer_store_dwordx4 v[88:91], v4, s[32:35], 0 offen
    buffer_store_dwordx4 v[92:95], v4, s[32:35], 0 offen offset:32
    v_add_u32 v4, 4194304, v4
    ds_read_b64_tr_b16 v[16:17], v3 offset:256
    ds_read_b64_tr_b16 v[18:19], v3 offset:1544
    ds_read_b64_tr_b16 v[20:21], v3 offset:5408
    ds_read_b64_tr_b16 v[22:23], v3 offset:6696
    ds_read_b64_tr_b16 v[24:25], v3 offset:10560
    ds_read_b64_tr_b16 v[26:27], v3 offset:11848
    ds_read_b64_tr_b16 v[28:29], v3 offset:15712
    ds_read_b64_tr_b16 v[30:31], v3 offset:17000
    s_waitcnt lgkmcnt(8)
    v_mfma_f32_32x32x16_bf16 v[48:63], a[48:51], v[32:35], v[48:63]
    v_mfma_f32_32x32x16_bf16 v[48:63], a[52:55], v[36:39], v[48:63]
    v_mfma_f32_32x32x16_bf16 v[48:63], a[56:59], v[40:43], v[48:63]
    v_mfma_f32_32x32x16_bf16 v[48:63], a[60:63], v[44:47], v[48:63]
    ds_read_b64_tr_b16 v[32:33], v3 offset:20864
    ds_read_b64_tr_b16 v[34:35], v3 offset:22152
    ds_read_b64_tr_b16 v[36:37], v3 offset:26016
    ds_read_b64_tr_b16 v[38:39], v3 offset:27304
    ds_read_b64_tr_b16 v[40:41], v3 offset:31168
    ds_read_b64_tr_b16 v[42:43], v3 offset:32456
    ds_read_b64_tr_b16 v[44:45], v3 offset:36320
    ds_read_b64_tr_b16 v[46:47], v3 offset:37608
    s_waitcnt lgkmcnt(8)
    v_mfma_f32_32x32x16_bf16 v[48:63], a[64:67], v[16:19], v[48:63]
    v_mfma_f32_32x32x16_bf16 v[48:63], a[68:71], v[20:23], v[48:63]
    v_mfma_f32_32x32x16_bf16 v[48:63], a[72:75], v[24:27], v[48:63]
    v_mfma_f32_32x32x16_bf16 v[48:63], a[76:79], v[28:31], v[48:63]
    s_waitcnt lgkmcnt(0)
    v_mfma_f32_32x32x16_bf16 v[48:63], a[80:83], v[32:35], v[48:63]
    v_mfma_f32_32x32x16_bf16 v[48:63], a[84:87], v[36:39], v[48:63]
    v_mfma_f32_32x32x16_bf16 v[48:63], a[88:91], v[40:43], v[48:63]
    v_mfma_f32_32x32x16_bf16 v[48:63], a[92:95], v[44:47], v[48:63]
    s_nop 11
    v_cvt_pk_bf16_f32 v80, v48, v49
    v_cvt_pk_bf16_f32 v81, v50, v51
    v_cvt_pk_bf16_f32 v82, v52, v53
    v_cvt_pk_bf16_f32 v83, v54, v55
    v_cvt_pk_bf16_f32 v84, v56, v57
    v_cvt_pk_bf16_f32 v85, v58, v59
    v_cvt_pk_bf16_f32 v86, v60, v61
    v_cvt_pk_bf16_f32 v87, v62, v63
    s_nop 1
    v_permlane32_swap_b32 v80, v82
    v_permlane32_swap_b32 v81, v83
    v_permlane32_swap_b32 v84, v86
    v_permlane32_swap_b32 v85, v87
    buffer_store_dwordx4 v[80:83], v4, s[32:35], 0 offen
    buffer_store_dwordx4 v[84:87], v4, s[32:35], 0 offen offset:32
    v_add_u32 v4, 4194304, v4
L_end:
    s_endpgm
.section .rodata,"a"
.p2align 6
.amdhsa_kernel bin_edges_kernel
  .amdhsa_next_free_vgpr 48
  .amdhsa_next_free_sgpr 40
  .amdhsa_accum_offset 48
  .amdhsa_group_segment_fixed_size 0
  .amdhsa_kernarg_size 88
  .amdhsa_user_sgpr_count 2
  .amdhsa_user_sgpr_kernarg_segment_ptr 1
  .amdhsa_system_sgpr_workgroup_id_x 1
  .amdhsa_float_denorm_mode_32 3
.end_amdhsa_kernel
.section .rodata,"a"
.p2align 6
.amdhsa_kernel standalone__tensor_product_equiv_mace__graph_kernel
  .amdhsa_next_free_vgpr 256
  .amdhsa_next_free_sgpr 102
  .amdhsa_accum_offset 160
  .amdhsa_group_segment_fixed_size 0
  .amdhsa_kernarg_size 88
  .amdhsa_user_sgpr_count 2
  .amdhsa_user_sgpr_kernarg_segment_ptr 1
  .amdhsa_system_sgpr_workgroup_id_x 1
  .amdhsa_float_denorm_mode_32 3
.end_amdhsa_kernel
```

```asm
; @launch kernel=bin_edges_kernel grid=(78,1,1) block=(640,1,1) lds=33792
; @launch kernel=standalone__tensor_product_equiv_mace__graph_kernel grid=(256,1,1) block=(512,1,1) lds=156160
.amdgcn_target "amdgcn-amd-amdhsa--gfx950"
.text
.globl bin_edges_kernel
.p2align 8
.type bin_edges_kernel,@function
bin_edges_kernel:
    s_cmp_ge_u32 s2, 78
    s_cbranch_scc1 K_end
    s_load_dwordx16 s[16:31], s[0:1], 0
    s_load_dwordx2 s[32:33], s[0:1], 80
    s_cmp_ge_u32 s2, 64
    s_cbranch_scc1 K_weights
    s_mul_i32 s3, s2, 10000
    v_lshlrev_b32 v1, 4, v0
    v_add_u32 v2, s3, v1
    s_mov_b32 s14, 625
    v_cmp_gt_u32 s[34:35], s14, v0
    s_waitcnt lgkmcnt(0)
    s_mov_b32 s4, s20
    s_mov_b32 s5, s21
    s_mov_b32 s6, 640000
    s_mov_b32 s7, 0x00020000
    buffer_load_dwordx4 v[4:7], v2, s[4:7], 0 offen
    s_mov_b32 s8, s18
    s_mov_b32 s9, s19
    s_mov_b32 s10, 640000
    s_mov_b32 s11, 0x00020000
    buffer_load_dwordx4 v[8:11], v2, s[8:11], 0 offen
    s_mov_b32 s12, s32
    s_mov_b32 s13, s33
    s_mov_b32 s14, 8388608
    s_mov_b32 s15, 0x00020000
    v_mov_b32 v12, -1
    v_mov_b32 v13, -1
    v_mov_b32 v14, -1
    v_mov_b32 v15, -1
    ds_write_b128 v1, v[12:15]
    ds_write_b128 v1, v[12:15] offset:10240
    ds_write_b128 v1, v[12:15] offset:20480
    v_cmp_gt_u32 vcc, 128, v0
    v_mov_b32 v16, 0
    v_mov_b32 v17, 0
    v_lshlrev_b32 v3, 3, v0
    s_mov_b64 exec, vcc
    ds_write_b128 v1, v[12:15] offset:30720
    ds_write_b64 v3, v[16:17] offset:32768
    s_mov_b64 exec, -1
    v_mov_b32 v18, 1
    v_lshlrev_b32 v19, 22, v0
    v_lshrrev_b32 v2, 3, v0
    v_lshlrev_b32 v2, 13, v2
    v_and_b32 v3, 7, v0
    v_lshl_add_u32 v2, v3, 4, v2
    s_lshl_b32 s3, s2, 7
    v_add_u32 v2, s3, v2
    s_waitcnt lgkmcnt(0)
    s_barrier
    s_waitcnt vmcnt(1)
    v_and_b32 v20, 255, v4
    v_lshlrev_b32 v24, 2, v20
    v_and_b32 v21, 255, v5
    v_lshlrev_b32 v25, 2, v21
    v_and_b32 v22, 255, v6
    v_lshlrev_b32 v26, 2, v22
    v_and_b32 v23, 255, v7
    v_lshlrev_b32 v27, 2, v23
    s_mov_b64 exec, s[34:35]
    ds_add_rtn_u32 v28, v24, v18 offset:32768
    ds_add_rtn_u32 v29, v25, v18 offset:32768
    ds_add_rtn_u32 v30, v26, v18 offset:32768
    ds_add_rtn_u32 v31, v27, v18 offset:32768
    s_mov_b64 exec, -1
    s_waitcnt vmcnt(0)
    v_bfe_u32 v4, v4, 8, 6
    v_and_b32 v8, 0x3fff, v8
    v_lshl_or_b32 v4, v8, 6, v4
    v_add_u32 v8, 0, v19
    v_or_b32 v4, v4, v8
    v_bfe_u32 v5, v5, 8, 6
    v_and_b32 v9, 0x3fff, v9
    v_lshl_or_b32 v5, v9, 6, v5
    v_add_u32 v9, 1048576, v19
    v_or_b32 v5, v5, v9
    v_bfe_u32 v6, v6, 8, 6
    v_and_b32 v10, 0x3fff, v10
    v_lshl_or_b32 v6, v10, 6, v6
    v_add_u32 v10, 2097152, v19
    v_or_b32 v6, v6, v10
    v_bfe_u32 v7, v7, 8, 6
    v_and_b32 v11, 0x3fff, v11
    v_lshl_or_b32 v7, v11, 6, v7
    v_add_u32 v11, 3145728, v19
    v_or_b32 v7, v7, v11
    v_mov_b32 v12, -2
    s_waitcnt lgkmcnt(0)
    v_cmp_gt_u32 vcc, 31, v28
    v_min_u32 v28, 31, v28
    v_lshlrev_b32 v28, 2, v28
    v_cndmask_b32 v4, v12, v4, vcc
    v_lshl_add_u32 v28, v20, 7, v28
    v_cmp_gt_u32 vcc, 31, v29
    v_min_u32 v29, 31, v29
    v_lshlrev_b32 v29, 2, v29
    v_cndmask_b32 v5, v12, v5, vcc
    v_lshl_add_u32 v29, v21, 7, v29
    v_cmp_gt_u32 vcc, 31, v30
    v_min_u32 v30, 31, v30
    v_lshlrev_b32 v30, 2, v30
    v_cndmask_b32 v6, v12, v6, vcc
    v_lshl_add_u32 v30, v22, 7, v30
    v_cmp_gt_u32 vcc, 31, v31
    v_min_u32 v31, 31, v31
    v_lshlrev_b32 v31, 2, v31
    v_cndmask_b32 v7, v12, v7, vcc
    v_lshl_add_u32 v31, v23, 7, v31
    s_mov_b64 exec, s[34:35]
    ds_write_b32 v28, v4
    ds_write_b32 v29, v5
    ds_write_b32 v30, v6
    ds_write_b32 v31, v7
    s_mov_b64 exec, -1
    v_cmp_gt_u32 vcc, 128, v0
    s_waitcnt lgkmcnt(0)
    s_barrier
    ds_read_b128 v[32:35], v1 offset:0
    ds_read_b128 v[36:39], v1 offset:10240
    ds_read_b128 v[40:43], v1 offset:20480
    ds_read_b128 v[44:47], v1 offset:30720
    s_waitcnt lgkmcnt(3)
    buffer_store_dwordx4 v[32:35], v2, s[12:15], 0 offen
    v_add_u32 v2, 655360, v2
    s_waitcnt lgkmcnt(2)
    buffer_store_dwordx4 v[36:39], v2, s[12:15], 0 offen
    v_add_u32 v2, 655360, v2
    s_waitcnt lgkmcnt(1)
    buffer_store_dwordx4 v[40:43], v2, s[12:15], 0 offen
    v_add_u32 v2, 655360, v2
    s_and_saveexec_b64 s[36:37], vcc
    s_cbranch_execz K_end
    s_waitcnt lgkmcnt(0)
    buffer_store_dwordx4 v[44:47], v2, s[12:15], 0 offen
    s_branch K_end
K_weights:
    v_lshrrev_b32 v1, 6, v0
    v_and_b32 v2, 63, v0
    v_readfirstlane_b32 s3, v1
    s_sub_u32 s34, s2, 64
    s_mul_i32 s34, s34, 10
    s_add_u32 s3, s3, s34
    s_cmp_ge_u32 s3, 138
    s_cbranch_scc1 K_end
    s_waitcnt lgkmcnt(0)
    s_mov_b32 s12, s32
    s_mov_b32 s13, s33
    s_mov_b32 s14, 8388608
    s_mov_b32 s15, 0x00020000
    s_lshl_b32 s34, s3, 10
    s_add_u32 s34, s34, 2097152
    v_lshlrev_b32 v3, 4, v2
    v_add_u32 v3, s34, v3
    s_cmp_ge_u32 s3, 136
    s_cbranch_scc1 K_cg
    s_cmp_ge_u32 s3, 128
    s_cbranch_scc1 K_wr
    s_mov_b32 s4, s30
    s_mov_b32 s5, s31
    s_mov_b32 s6, 131072
    s_mov_b32 s7, 0x00020000
    s_and_b32 s34, s3, 15
    s_lshl_b32 s34, s34, 13
    s_lshr_b32 s35, s3, 4
    s_lshl_b32 s35, s35, 6
    s_add_u32 s34, s34, s35
    v_lshrrev_b32 v4, 5, v2
    v_lshlrev_b32 v4, 12, v4
    v_and_b32 v5, 31, v2
    v_lshl_add_u32 v4, v5, 1, v4
    v_add_u32 v4, s34, v4
    s_branch K_wgo
K_wr:
    s_mov_b32 s4, s28
    s_mov_b32 s5, s29
    s_mov_b32 s6, 8192
    s_mov_b32 s7, 0x00020000
    s_sub_u32 s34, s3, 128
    s_lshl_b32 s34, s34, 6
    v_bfe_u32 v4, v2, 4, 1
    v_lshlrev_b32 v4, 12, v4
    v_lshrrev_b32 v5, 5, v2
    v_lshl_add_u32 v4, v5, 5, v4
    v_and_b32 v5, 15, v2
    v_lshl_add_u32 v4, v5, 1, v4
    v_add_u32 v4, s34, v4
K_wgo:
    buffer_load_ushort v16, v4, s[4:7], 0 offen offset:0
    buffer_load_ushort v17, v4, s[4:7], 0 offen offset:512
    buffer_load_ushort v18, v4, s[4:7], 0 offen offset:1024
    buffer_load_ushort v19, v4, s[4:7], 0 offen offset:1536
    buffer_load_ushort v20, v4, s[4:7], 0 offen offset:2048
    buffer_load_ushort v21, v4, s[4:7], 0 offen offset:2560
    buffer_load_ushort v22, v4, s[4:7], 0 offen offset:3072
    buffer_load_ushort v23, v4, s[4:7], 0 offen offset:3584
    s_branch K_wst
K_cg:
    s_mov_b32 s4, s26
    s_mov_b32 s5, s27
    s_mov_b32 s6, 128
    s_mov_b32 s7, 0x00020000
    s_sub_u32 s34, s3, 136
    s_lshl_b32 s34, s34, 2
    v_and_b32 v4, 3, v2
    v_lshlrev_b32 v4, 5, v4
    v_add_u32 v4, s34, v4
    buffer_load_ushort v16, v4, s[4:7], 0 offen offset:0
    buffer_load_ushort v17, v4, s[4:7], 0 offen offset:8
    buffer_load_ushort v18, v4, s[4:7], 0 offen offset:16
    buffer_load_ushort v19, v4, s[4:7], 0 offen offset:24
    buffer_load_ushort v20, v4, s[4:7], 0 offen offset:2
    buffer_load_ushort v21, v4, s[4:7], 0 offen offset:10
    buffer_load_ushort v22, v4, s[4:7], 0 offen offset:18
    buffer_load_ushort v23, v4, s[4:7], 0 offen offset:26
K_wst:
    s_waitcnt vmcnt(0)
    v_lshl_or_b32 v8, v17, 16, v16
    v_lshl_or_b32 v9, v19, 16, v18
    v_lshl_or_b32 v10, v21, 16, v20
    v_lshl_or_b32 v11, v23, 16, v22
    buffer_store_dwordx4 v[8:11], v3, s[12:15], 0 offen
K_end:
    s_endpgm
.globl standalone__tensor_product_equiv_mace__graph_kernel
.p2align 8
.type standalone__tensor_product_equiv_mace__graph_kernel,@function
standalone__tensor_product_equiv_mace__graph_kernel:
    s_cmp_ge_u32 s2, 256
    s_cbranch_scc1 L_end
    s_load_dwordx2 s[84:85], s[0:1], 80
    s_load_dwordx16 s[64:79], s[0:1], 0
    s_load_dwordx2 s[80:81], s[0:1], 64
    v_and_b32 v1, 63, v0
    v_lshrrev_b32 v40, 6, v0
    v_mov_b32 v12, 0
    v_readfirstlane_b32 s3, v40
    s_lshl_b32 s53, s2, 13
    v_lshlrev_b32 v40, 4, v0
    v_add_u32 v40, s53, v40
    v_lshlrev_b32 v44, 4, v1
    v_add_u32 v41, 2228224, v44
    v_add_u32 v42, 2232320, v44
    v_add_u32 v43, 2236416, v44
    s_waitcnt lgkmcnt(0)
    s_mov_b32 s32, s84
    s_mov_b32 s33, s85
    s_mov_b32 s34, 8388608
    s_mov_b32 s35, 0x00020000
    buffer_load_dwordx4 v[16:19], v40, s[32:35], 0 offen
    s_mov_b32 s8, s64
    s_mov_b32 s9, s65
    s_mov_b32 s10, 20480000
    s_mov_b32 s11, 0x00020000
    s_mov_b32 s12, s66
    s_mov_b32 s13, s67
    s_mov_b32 s14, 640000
    s_mov_b32 s15, 0x00020000
    s_mov_b32 s16, s68
    s_mov_b32 s17, s69
    s_mov_b32 s18, 640000
    s_mov_b32 s19, 0x00020000
    s_mov_b32 s20, s70
    s_mov_b32 s21, s71
    s_mov_b32 s22, 1280000
    s_mov_b32 s23, 0x00020000
    s_mov_b32 s24, s72
    s_mov_b32 s25, s73
    s_mov_b32 s26, 5120000
    s_mov_b32 s27, 0x00020000
    s_mov_b32 s28, s80
    s_mov_b32 s29, s81
    s_mov_b32 s30, 20480000
    s_mov_b32 s31, 0x00020000
    buffer_load_dwordx4 a[0:3], v41, s[32:35], 0 offen offset:0
    buffer_load_dwordx4 a[4:7], v41, s[32:35], 0 offen offset:1024
    buffer_load_dwordx4 a[8:11], v41, s[32:35], 0 offen offset:2048
    buffer_load_dwordx4 a[12:15], v41, s[32:35], 0 offen offset:3072
    buffer_load_dwordx4 a[16:19], v42, s[32:35], 0 offen offset:0
    buffer_load_dwordx4 a[20:23], v42, s[32:35], 0 offen offset:1024
    buffer_load_dwordx4 a[24:27], v42, s[32:35], 0 offen offset:2048
    buffer_load_dwordx4 a[28:31], v42, s[32:35], 0 offen offset:3072
    buffer_load_dwordx4 a[32:35], v43, s[32:35], 0 offen offset:0
    buffer_load_dwordx4 a[36:39], v43, s[32:35], 0 offen offset:1024
    s_lshl_b32 s63, s3, 13
    s_add_u32 s78, s63, 65536
    v_mov_b32 v48, 0
    v_mov_b32 v49, 0
    v_lshlrev_b32 v40, 3, v0
    v_add_u32 v40, 147840, v40
    ds_write_b64 v40, v[48:49]
    v_and_b32 v40, 3, v1
    v_lshlrev_b32 v40, 3, v40
    v_add_u32 v40, 156032, v40
    ds_write_b64 v40, v[48:49]
    s_mov_b32 s52, 0
    s_mov_b32 s73, 0
    s_add_u32 s51, s63, 2048
    v_lshrrev_b32 v47, 3, v0
    v_mul_u32_u24 v47, 2500, v47
    s_waitcnt lgkmcnt(0)
    s_barrier
    v_lshrrev_b32 v46, 4, v1
    v_and_b32 v41, 7, v1
    v_bfe_u32 v45, v1, 3, 1
    v_lshlrev_b32 v45, 9, v45
    v_lshl_add_u32 v45, v46, 7, v45
    v_lshl_add_u32 v2, v41, 4, v45
    v_xor_b32 v41, 4, v41
    v_lshl_add_u32 v3, v41, 4, v45
    v_bfe_u32 v40, v1, 2, 2
    v_bfe_u32 v42, v1, 1, 1
    v_lshl_add_u32 v42, v46, 1, v42
    v_lshrrev_b32 v43, 1, v40
    v_lshlrev_b32 v44, 2, v43
    v_xor_b32 v42, v42, v44
    v_and_b32 v44, 1, v40
    v_lshl_add_u32 v42, v44, 3, v42
    v_lshlrev_b32 v42, 4, v42
    v_lshl_add_u32 v42, v43, 10, v42
    v_and_b32 v44, 1, v1
    v_lshl_add_u32 v42, v44, 3, v42
    v_add_u32 v4, s63, v42
    v_lshrrev_b32 v41, 5, v1
    v_mov_b32 v43, 128
    v_cmp_eq_u32 vcc, v40, v41
    v_add_u32 v41, 2, v41
    s_nop 0
    v_cndmask_b32 v8, 0, v43, vcc
    v_cmp_eq_u32 vcc, v40, v41
    s_nop 1
    v_cndmask_b32 v9, 0, v43, vcc
    s_waitcnt vmcnt(10)
    v_cmp_eq_u32 vcc, -2, v19
    s_mov_b32 s76, 0
    s_cbranch_vccnz L_scan
    s_mov_b32 s76, 79
    v_cmp_gt_u32 s[36:37], -2, v16
    v_lshrrev_b32 v20, 20, v16
    v_add_u32 v20, v20, v47
    v_bfe_u32 v24, v16, 6, 14
    v_and_b32 v16, 63, v16
    v_cmp_gt_u32 s[38:39], -2, v17
    v_lshrrev_b32 v21, 20, v17
    v_add_u32 v21, v21, v47
    v_bfe_u32 v25, v17, 6, 14
    v_and_b32 v17, 63, v17
    v_cmp_gt_u32 s[40:41], -2, v18
    v_lshrrev_b32 v22, 20, v18
    v_add_u32 v22, v22, v47
    v_bfe_u32 v26, v18, 6, 14
    v_and_b32 v18, 63, v18
    v_cmp_gt_u32 s[42:43], -2, v19
    v_lshrrev_b32 v23, 20, v19
    v_add_u32 v23, v23, v47
    v_bfe_u32 v27, v19, 6, 14
    v_and_b32 v19, 63, v19
    s_branch L_have
L_scan:
    s_mov_b32 s50, s63
    s_xor_b32 s49, s2, 1
L_sloop:
    s_cmp_ge_u32 s76, 79
    s_cbranch_scc1 L_scan_done
    s_mul_i32 s53, s3, 20000
    s_lshl_b32 s54, s76, 8
    s_add_u32 s55, s53, s54
    v_lshlrev_b32 v13, 2, v1
    v_add_u32 v13, s55, v13
    v_lshlrev_b32 v14, 2, v13
    buffer_load_dwordx4 v[40:43], v14, s[16:19], 0 offen
    s_waitcnt vmcnt(0)
    s_cmp_lg_u32 s76, 78
    s_cbranch_scc1 L_snotlast
    s_mov_b32 exec_lo, 0xffffff00
    v_mov_b32 v40, s49
    v_mov_b32 v41, s49
    v_mov_b32 v42, s49
    v_mov_b32 v43, s49
    s_mov_b64 exec, -1
L_snotlast:
    s_cmp_gt_u32 s52, 0
    s_cbranch_scc1 L_1
    v_cmp_eq_u32_sdwa vcc, v40, s2 src0_sel:BYTE_0 src1_sel:DWORD
    s_cbranch_vccz L_1
    s_bcnt1_i32_b64 s53, vcc
    s_lshl3_add_u32 s54, s53, s50
    s_mov_b32 s52, 0
    s_cmp_gt_u32 s54, s51
    s_cbranch_scc1 L_ovf
    v_mbcnt_lo_u32_b32 v48, vcc_lo, 0
    v_mbcnt_hi_u32_b32 v48, vcc_hi, v48
    v_lshl_add_u32 v48, v48, 3, s50
    v_add_u32 v49, 0, v13
    s_mov_b64 exec, vcc
    ds_write2_b32 v48, v40, v49 offset0:0 offset1:1
    s_mov_b64 exec, -1
    s_mov_b32 s50, s54
L_1:
    s_cmp_gt_u32 s52, 1
    s_cbranch_scc1 L_2
    v_cmp_eq_u32_sdwa vcc, v41, s2 src0_sel:BYTE_0 src1_sel:DWORD
    s_cbranch_vccz L_2
    s_bcnt1_i32_b64 s53, vcc
    s_lshl3_add_u32 s54, s53, s50
    s_mov_b32 s52, 1
    s_cmp_gt_u32 s54, s51
    s_cbranch_scc1 L_ovf
    v_mbcnt_lo_u32_b32 v48, vcc_lo, 0
    v_mbcnt_hi_u32_b32 v48, vcc_hi, v48
    v_lshl_add_u32 v48, v48, 3, s50
    v_add_u32 v49, 1, v13
    s_mov_b64 exec, vcc
    ds_write2_b32 v48, v41, v49 offset0:0 offset1:1
    s_mov_b64 exec, -1
    s_mov_b32 s50, s54
L_2:
    s_cmp_gt_u32 s52, 2
    s_cbranch_scc1 L_3
    v_cmp_eq_u32_sdwa vcc, v42, s2 src0_sel:BYTE_0 src1_sel:DWORD
    s_cbranch_vccz L_3
    s_bcnt1_i32_b64 s53, vcc
    s_lshl3_add_u32 s54, s53, s50
    s_mov_b32 s52, 2
    s_cmp_gt_u32 s54, s51
    s_cbranch_scc1 L_ovf
    v_mbcnt_lo_u32_b32 v48, vcc_lo, 0
    v_mbcnt_hi_u32_b32 v48, vcc_hi, v48
    v_lshl_add_u32 v48, v48, 3, s50
    v_add_u32 v49, 2, v13
    s_mov_b64 exec, vcc
    ds_write2_b32 v48, v42, v49 offset0:0 offset1:1
    s_mov_b64 exec, -1
    s_mov_b32 s50, s54
L_3:
    s_cmp_gt_u32 s52, 3
    s_cbranch_scc1 L_4
    v_cmp_eq_u32_sdwa vcc, v43, s2 src0_sel:BYTE_0 src1_sel:DWORD
    s_cbranch_vccz L_4
    s_bcnt1_i32_b64 s53, vcc
    s_lshl3_add_u32 s54, s53, s50
    s_mov_b32 s52, 3
    s_cmp_gt_u32 s54, s51
    s_cbranch_scc1 L_ovf
    v_mbcnt_lo_u32_b32 v48, vcc_lo, 0
    v_mbcnt_hi_u32_b32 v48, vcc_hi, v48
    v_lshl_add_u32 v48, v48, 3, s50
    v_add_u32 v49, 3, v13
    s_mov_b64 exec, vcc
    ds_write2_b32 v48, v43, v49 offset0:0 offset1:1
    s_mov_b64 exec, -1
    s_mov_b32 s50, s54
L_4:
    s_mov_b32 s52, 0
    s_add_u32 s76, s76, 1
    s_branch L_sloop
L_ovf:
    v_mov_b32 v48, 1
    v_mov_b32 v49, 156048
    ds_write_b32 v49, v48
L_scan_done:
    s_sub_u32 s75, s50, s63
    s_lshr_b32 s75, s75, 3
    v_lshlrev_b32 v48, 3, v1
    v_add_u32 v48, s63, v48
    s_waitcnt lgkmcnt(0)
    ds_read_b32 v16, v48 offset:0
    ds_read_b32 v20, v48 offset:4
    s_sub_u32 s53, s75, 0
    v_cmp_gt_i32 s[36:37], s53, v1
    ds_read_b32 v17, v48 offset:512
    ds_read_b32 v21, v48 offset:516
    s_sub_u32 s53, s75, 64
    v_cmp_gt_i32 s[38:39], s53, v1
    ds_read_b32 v18, v48 offset:1024
    ds_read_b32 v22, v48 offset:1028
    s_sub_u32 s53, s75, 128
    v_cmp_gt_i32 s[40:41], s53, v1
    ds_read_b32 v19, v48 offset:1536
    ds_read_b32 v23, v48 offset:1540
    s_sub_u32 s53, s75, 192
    v_cmp_gt_i32 s[42:43], s53, v1
    s_waitcnt lgkmcnt(0)
    v_lshlrev_b32 v36, 2, v20
    buffer_load_dword v24, v36, s[12:15], 0 offen
    v_bfe_u32 v16, v16, 8, 6
    v_lshlrev_b32 v37, 2, v21
    buffer_load_dword v25, v37, s[12:15], 0 offen
    v_bfe_u32 v17, v17, 8, 6
    v_lshlrev_b32 v38, 2, v22
    buffer_load_dword v26, v38, s[12:15], 0 offen
    v_bfe_u32 v18, v18, 8, 6
    v_lshlrev_b32 v39, 2, v23
    buffer_load_dword v27, v39, s[12:15], 0 offen
    v_bfe_u32 v19, v19, 8, 6
    s_waitcnt vmcnt(0)
L_have:
    v_mov_b32 v48, 1
    v_mul_u32_u24 v36, 6711, v24
    v_lshrrev_b32 v36, 22, v36
    v_min_u32 v36, 15, v36
    v_lshlrev_b32 v36, 2, v36
    v_lshl_add_u32 v28, v16, 6, v36
    v_add_u32 v28, 147840, v28
    s_mov_b64 exec, s[36:37]
    ds_add_rtn_u32 v32, v28, v48
    s_mov_b64 exec, -1
    v_mul_u32_u24 v37, 6711, v25
    v_lshrrev_b32 v37, 22, v37
    v_min_u32 v37, 15, v37
    v_lshlrev_b32 v37, 2, v37
    v_lshl_add_u32 v29, v17, 6, v37
    v_add_u32 v29, 147840, v29
    s_mov_b64 exec, s[38:39]
    ds_add_rtn_u32 v33, v29, v48
    s_mov_b64 exec, -1
    v_mul_u32_u24 v38, 6711, v26
    v_lshrrev_b32 v38, 22, v38
    v_min_u32 v38, 15, v38
    v_lshlrev_b32 v38, 2, v38
    v_lshl_add_u32 v30, v18, 6, v38
    v_add_u32 v30, 147840, v30
    s_mov_b64 exec, s[40:41]
    ds_add_rtn_u32 v34, v30, v48
    s_mov_b64 exec, -1
    v_mul_u32_u24 v39, 6711, v27
    v_lshrrev_b32 v39, 22, v39
    v_min_u32 v39, 15, v39
    v_lshlrev_b32 v39, 2, v39
    v_lshl_add_u32 v31, v19, 6, v39
    v_add_u32 v31, 147840, v31
    s_mov_b64 exec, s[42:43]
    ds_add_rtn_u32 v35, v31, v48
    s_mov_b64 exec, -1
    v_lshlrev_b32 v40, 6, v1
    v_add_u32 v40, 147840, v40
    v_mov_b32 v41, 156048
    s_waitcnt lgkmcnt(0)
    s_barrier
    ds_read_b128 v[64:67], v40 offset:0
    ds_read_b128 v[68:71], v40 offset:16
    ds_read_b128 v[72:75], v40 offset:32
    ds_read_b128 v[76:79], v40 offset:48
    ds_read_b32 v41, v41
    s_cmp_lg_u32 s73, 0
    s_cbranch_scc1 L_5
    v_mov_b64 v[80:81], 0
    v_mov_b64 v[82:83], 0
    v_mov_b64 v[84:85], 0
    v_mov_b64 v[86:87], 0
    v_mov_b64 v[88:89], 0
    v_mov_b64 v[90:91], 0
    v_mov_b64 v[92:93], 0
    v_mov_b64 v[94:95], 0
    v_mov_b64 v[96:97], 0
    v_mov_b64 v[98:99], 0
    v_mov_b64 v[100:101], 0
    v_mov_b64 v[102:103], 0
    v_mov_b64 v[104:105], 0
    v_mov_b64 v[106:107], 0
    v_mov_b64 v[108:109], 0
    v_mov_b64 v[110:111], 0
    v_mov_b64 v[112:113], 0
    v_mov_b64 v[114:115], 0
    v_mov_b64 v[116:117], 0
    v_mov_b64 v[118:119], 0
    v_mov_b64 v[120:121], 0
    v_mov_b64 v[122:123], 0
    v_mov_b64 v[124:125], 0
    v_mov_b64 v[126:127], 0
    v_mov_b64 v[128:129], 0
    v_mov_b64 v[130:131], 0
    v_mov_b64 v[132:133], 0
    v_mov_b64 v[134:135], 0
    v_mov_b64 v[136:137], 0
    v_mov_b64 v[138:139], 0
    v_mov_b64 v[140:141], 0
    v_mov_b64 v[142:143], 0
    v_mov_b64 v[144:145], 0
    v_mov_b64 v[146:147], 0
    v_mov_b64 v[148:149], 0
    v_mov_b64 v[150:151], 0
    v_mov_b64 v[152:153], 0
    v_mov_b64 v[154:155], 0
    v_mov_b64 v[156:157], 0
    v_mov_b64 v[158:159], 0
L_5:
    s_waitcnt lgkmcnt(0)
    v_readfirstlane_b32 s74, v41
    v_add3_u32 v64, v64, v65, v66
    v_add3_u32 v67, v67, v68, v69
    v_add3_u32 v70, v70, v71, v72
    v_add3_u32 v73, v73, v74, v75
    v_add3_u32 v76, v76, v77, v78
    v_add3_u32 v64, v64, v67, v70
    v_add3_u32 v73, v73, v76, v79
    v_add_u32 v64, v64, v73
    s_cmp_lg_u32 s73, 0
    s_cbranch_scc1 L_assigned
    v_sub_u32 v65, 63, v1
    v_lshl_add_u32 v65, v64, 6, v65
    v_mov_b32 v66, 0
    v_readlane_b32 s84, v65, 0
    v_readlane_b32 s85, v65, 1
    v_readlane_b32 s86, v65, 2
    v_readlane_b32 s87, v65, 3
    v_readlane_b32 s88, v65, 4
    v_readlane_b32 s89, v65, 5
    v_readlane_b32 s90, v65, 6
    v_readlane_b32 s91, v65, 7
    v_readlane_b32 s92, v65, 8
    v_readlane_b32 s93, v65, 9
    v_readlane_b32 s94, v65, 10
    v_readlane_b32 s95, v65, 11
    v_readlane_b32 s96, v65, 12
    v_readlane_b32 s97, v65, 13
    v_readlane_b32 s98, v65, 14
    v_readlane_b32 s99, v65, 15
    v_cmp_gt_u32 vcc, s84, v65
    v_cmp_gt_u32 s[4:5], s85, v65
    v_cmp_gt_u32 s[6:7], s86, v65
    v_addc_co_u32 v66, vcc, 0, v66, vcc
    v_addc_co_u32 v66, s[4:5], 0, v66, s[4:5]
    v_addc_co_u32 v66, s[6:7], 0, v66, s[6:7]
    v_cmp_gt_u32 vcc, s87, v65
    v_cmp_gt_u32 s[4:5], s88, v65
    v_cmp_gt_u32 s[6:7], s89, v65
    v_addc_co_u32 v66, vcc, 0, v66, vcc
    v_addc_co_u32 v66, s[4:5], 0, v66, s[4:5]
    v_addc_co_u32 v66, s[6:7], 0, v66, s[6:7]
    v_cmp_gt_u32 vcc, s90, v65
    v_cmp_gt_u32 s[4:5], s91, v65
    v_cmp_gt_u32 s[6:7], s92, v65
    v_addc_co_u32 v66, vcc, 0, v66, vcc
    v_addc_co_u32 v66, s[4:5], 0, v66, s[4:5]
    v_addc_co_u32 v66, s[6:7], 0, v66, s[6:7]
    v_cmp_gt_u32 vcc, s93, v65
    v_cmp_gt_u32 s[4:5], s94, v65
    v_cmp_gt_u32 s[6:7], s95, v65
    v_addc_co_u32 v66, vcc, 0, v66, vcc
    v_addc_co_u32 v66, s[4:5], 0, v66, s[4:5]
    v_addc_co_u32 v66, s[6:7], 0, v66, s[6:7]
    v_cmp_gt_u32 vcc, s96, v65
    v_cmp_gt_u32 s[4:5], s97, v65
    v_cmp_gt_u32 s[6:7], s98, v65
    v_addc_co_u32 v66, vcc, 0, v66, vcc
    v_addc_co_u32 v66, s[4:5], 0, v66, s[4:5]
    v_addc_co_u32 v66, s[6:7], 0, v66, s[6:7]
    v_cmp_gt_u32 vcc, s99, v65
    s_nop 1
    v_addc_co_u32 v66, vcc, 0, v66, vcc
    v_readlane_b32 s84, v65, 16
    v_readlane_b32 s85, v65, 17
    v_readlane_b32 s86, v65, 18
    v_readlane_b32 s87, v65, 19
    v_readlane_b32 s88, v65, 20
    v_readlane_b32 s89, v65, 21
    v_readlane_b32 s90, v65, 22
    v_readlane_b32 s91, v65, 23
    v_readlane_b32 s92, v65, 24
    v_readlane_b32 s93, v65, 25
    v_readlane_b32 s94, v65, 26
    v_readlane_b32 s95, v65, 27
    v_readlane_b32 s96, v65, 28
    v_readlane_b32 s97, v65, 29
    v_readlane_b32 s98, v65, 30
    v_readlane_b32 s99, v65, 31
    v_cmp_gt_u32 vcc, s84, v65
    v_cmp_gt_u32 s[4:5], s85, v65
    v_cmp_gt_u32 s[6:7], s86, v65
    v_addc_co_u32 v66, vcc, 0, v66, vcc
    v_addc_co_u32 v66, s[4:5], 0, v66, s[4:5]
    v_addc_co_u32 v66, s[6:7], 0, v66, s[6:7]
    v_cmp_gt_u32 vcc, s87, v65
    v_cmp_gt_u32 s[4:5], s88, v65
    v_cmp_gt_u32 s[6:7], s89, v65
    v_addc_co_u32 v66, vcc, 0, v66, vcc
    v_addc_co_u32 v66, s[4:5], 0, v66, s[4:5]
    v_addc_co_u32 v66, s[6:7], 0, v66, s[6:7]
    v_cmp_gt_u32 vcc, s90, v65
    v_cmp_gt_u32 s[4:5], s91, v65
    v_cmp_gt_u32 s[6:7], s92, v65
    v_addc_co_u32 v66, vcc, 0, v66, vcc
    v_addc_co_u32 v66, s[4:5], 0, v66, s[4:5]
    v_addc_co_u32 v66, s[6:7], 0, v66, s[6:7]
    v_cmp_gt_u32 vcc, s93, v65
    v_cmp_gt_u32 s[4:5], s94, v65
    v_cmp_gt_u32 s[6:7], s95, v65
    v_addc_co_u32 v66, vcc, 0, v66, vcc
    v_addc_co_u32 v66, s[4:5], 0, v66, s[4:5]
    v_addc_co_u32 v66, s[6:7], 0, v66, s[6:7]
    v_cmp_gt_u32 vcc, s96, v65
    v_cmp_gt_u32 s[4:5], s97, v65
    v_cmp_gt_u32 s[6:7], s98, v65
    v_addc_co_u32 v66, vcc, 0, v66, vcc
    v_addc_co_u32 v66, s[4:5], 0, v66, s[4:5]
    v_addc_co_u32 v66, s[6:7], 0, v66, s[6:7]
    v_cmp_gt_u32 vcc, s99, v65
    s_nop 1
    v_addc_co_u32 v66, vcc, 0, v66, vcc
    v_readlane_b32 s84, v65, 32
    v_readlane_b32 s85, v65, 33
    v_readlane_b32 s86, v65, 34
    v_readlane_b32 s87, v65, 35
    v_readlane_b32 s88, v65, 36
    v_readlane_b32 s89, v65, 37
    v_readlane_b32 s90, v65, 38
    v_readlane_b32 s91, v65, 39
    v_cmp_gt_u32 vcc, s84, v65
    v_cmp_gt_u32 s[4:5], s85, v65
    v_cmp_gt_u32 s[6:7], s86, v65
    v_addc_co_u32 v66, vcc, 0, v66, vcc
    v_addc_co_u32 v66, s[4:5], 0, v66, s[4:5]
    v_addc_co_u32 v66, s[6:7], 0, v66, s[6:7]
    v_cmp_gt_u32 vcc, s87, v65
    v_cmp_gt_u32 s[4:5], s88, v65
    v_cmp_gt_u32 s[6:7], s89, v65
    v_addc_co_u32 v66, vcc, 0, v66, vcc
    v_addc_co_u32 v66, s[4:5], 0, v66, s[4:5]
    v_addc_co_u32 v66, s[6:7], 0, v66, s[6:7]
    v_cmp_gt_u32 vcc, s90, v65
    v_cmp_gt_u32 s[4:5], s91, v65
    s_nop 0
    v_addc_co_u32 v66, vcc, 0, v66, vcc
    v_addc_co_u32 v66, s[4:5], 0, v66, s[4:5]
    v_bfe_u32 v67, v66, 3, 1
    v_mul_u32_u24 v67, 7, v67
    v_and_b32 v68, 7, v66
    v_xor_b32 v11, v67, v68
    s_sub_u32 s53, 7, s3
    s_add_u32 s54, s3, 0
    v_cmp_eq_u32 vcc, s54, v66
    s_ff1_i32_b64 s56, vcc
    s_add_u32 s54, s53, 8
    v_cmp_eq_u32 vcc, s54, v66
    s_ff1_i32_b64 s57, vcc
    s_add_u32 s54, s3, 16
    v_cmp_eq_u32 vcc, s54, v66
    s_ff1_i32_b64 s58, vcc
    s_add_u32 s54, s53, 24
    v_cmp_eq_u32 vcc, s54, v66
    s_ff1_i32_b64 s59, vcc
    s_add_u32 s54, s3, 32
    v_cmp_eq_u32 vcc, s54, v66
    s_ff1_i32_b64 s60, vcc
L_assigned:
    v_cmp_gt_u32 vcc, s3, v11
    v_and_b32 v68, 15, v1
    v_lshlrev_b32 v68, 2, v68
    v_cndmask_b32 v67, 0, v64, vcc
    v_add_u32 v68, 147840, v68
    s_lshl_b32 s84, s56, 6
    v_add_u32 v70, s84, v68
    ds_read_b32 v75, v70
    s_lshl_b32 s85, s57, 6
    v_add_u32 v71, s85, v68
    ds_read_b32 v76, v71
    s_lshl_b32 s86, s58, 6
    v_add_u32 v72, s86, v68
    ds_read_b32 v77, v72
    s_lshl_b32 s87, s59, 6
    v_add_u32 v73, s87, v68
    ds_read_b32 v78, v73
    s_lshl_b32 s88, s60, 6
    v_add_u32 v74, s88, v68
    ds_read_b32 v79, v74
    v_add_u32_dpp v67, v67, v67 row_shr:1 row_mask:0xf bank_mask:0xf bound_ctrl:1
    v_readlane_b32 s92, v64, s56
    s_nop 0
    v_add_u32_dpp v67, v67, v67 row_shr:2 row_mask:0xf bank_mask:0xf bound_ctrl:1
    v_readlane_b32 s93, v64, s57
    s_nop 0
    v_add_u32_dpp v67, v67, v67 row_shr:4 row_mask:0xf bank_mask:0xf bound_ctrl:1
    v_readlane_b32 s94, v64, s58
    s_nop 0
    v_add_u32_dpp v67, v67, v67 row_shr:8 row_mask:0xf bank_mask:0xf bound_ctrl:1
    v_readlane_b32 s95, v64, s59
    s_nop 0
    v_readlane_b32 s96, v64, s60
    v_readlane_b32 s61, v67, 15
    v_readlane_b32 s53, v67, 31
    v_readlane_b32 s54, v67, 47
    s_add_u32 s77, s92, s93
    s_add_u32 s77, s77, s94
    s_add_u32 s77, s77, s95
    s_add_u32 s77, s77, s96
    s_add_u32 s61, s61, s53
    s_add_u32 s61, s61, s54
    s_add_u32 s61, s61, 3
    s_andn2_b32 s61, s61, 3
    s_lshl2_add_u32 s61, s3, s61
    s_waitcnt lgkmcnt(0)
    v_add3_u32 v67, v75, v76, v77
    v_add3_u32 v67, v67, v78, v79
    v_mov_b32 v68, v67
    s_nop 1
    v_add_u32_dpp v68, v68, v68 row_shr:1 row_mask:0xf bank_mask:0xf bound_ctrl:1
    s_nop 1
    v_add_u32_dpp v68, v68, v68 row_shr:2 row_mask:0xf bank_mask:0xf bound_ctrl:1
    s_nop 1
    v_add_u32_dpp v68, v68, v68 row_shr:4 row_mask:0xf bank_mask:0xf bound_ctrl:1
    s_nop 1
    v_add_u32_dpp v68, v68, v68 row_shr:8 row_mask:0xf bank_mask:0xf bound_ctrl:1
    v_sub_u32 v68, v68, v67
    v_add_u32 v68, s61, v68
    v_lshl_add_u32 v40, v68, 3, 0
    ds_write_b32 v70, v40 offset:4096
    v_add_u32 v68, v68, v75
    v_lshl_add_u32 v41, v68, 3, 1
    ds_write_b32 v71, v41 offset:4096
    v_add_u32 v68, v68, v76
    v_lshl_add_u32 v42, v68, 3, 2
    ds_write_b32 v72, v42 offset:4096
    v_add_u32 v68, v68, v77
    v_lshl_add_u32 v43, v68, 3, 3
    ds_write_b32 v73, v43 offset:4096
    v_add_u32 v68, v68, v78
    v_lshl_add_u32 v44, v68, 3, 4
    ds_write_b32 v74, v44 offset:4096
    s_waitcnt lgkmcnt(0)
    s_barrier
    ds_read_b32 v36, v28 offset:4096
    ds_read_b32 v37, v29 offset:4096
    ds_read_b32 v38, v30 offset:4096
    ds_read_b32 v39, v31 offset:4096
    v_mov_b32 v64, 0
    v_mov_b32 v65, 0
    v_lshlrev_b32 v66, 3, v0
    v_add_u32 v66, 147840, v66
    ds_write_b64 v66, v[64:65]
    v_mov_b32 v66, 156048
    ds_write_b32 v66, v64
    s_mov_b32 s53, 131072
    s_waitcnt lgkmcnt(2)
    v_lshrrev_b32 v28, 3, v36
    v_add_u32 v28, v28, v32
    v_and_b32 v36, 7, v36
    v_lshl_or_b32 v36, v24, 11, v36
    v_lshl_add_u32 v28, v28, 2, s53
    s_mov_b64 exec, s[36:37]
    ds_write_b32 v28, v36
    ds_write_b32 v28, v20 offset:8384
    s_mov_b64 exec, -1
    v_lshrrev_b32 v29, 3, v37
    v_add_u32 v29, v29, v33
    v_and_b32 v37, 7, v37
    v_lshl_or_b32 v37, v25, 11, v37
    v_lshl_add_u32 v29, v29, 2, s53
    s_mov_b64 exec, s[38:39]
    ds_write_b32 v29, v37
    ds_write_b32 v29, v21 offset:8384
    s_mov_b64 exec, -1
    v_lshrrev_b32 v30, 3, v38
    v_add_u32 v30, v30, v34
    v_and_b32 v38, 7, v38
    v_lshl_or_b32 v38, v26, 11, v38
    v_lshl_add_u32 v30, v30, 2, s53
    s_mov_b64 exec, s[40:41]
    ds_write_b32 v30, v38
    ds_write_b32 v30, v22 offset:8384
    s_mov_b64 exec, -1
    v_lshrrev_b32 v31, 3, v39
    v_add_u32 v31, v31, v35
    v_and_b32 v39, 7, v39
    v_lshl_or_b32 v39, v27, 11, v39
    v_lshl_add_u32 v31, v31, 2, s53
    s_mov_b64 exec, s[42:43]
    ds_write_b32 v31, v39
    ds_write_b32 v31, v23 offset:8384
    s_mov_b64 exec, -1
    s_lshl_b32 s61, s61, 2
    s_add_u32 s61, s61, 131072
    s_waitcnt lgkmcnt(0)
    s_barrier
L_block:
    s_cmp_eq_u32 s77, 0
    s_cbranch_scc1 L_round_done
    s_min_u32 s62, s77, 128
    s_sub_u32 s77, s77, s62
    v_mov_b32 v10, s61
    v_lshl_add_u32 v40, v1, 2, s61
    v_lshrrev_b32 v42, 1, v1
    v_lshl_add_u32 v41, v42, 2, s61
    ds_read_b128 v[68:71], v10
    ds_read_b32 v44, v40 offset:8384
    ds_read_b32 v45, v40 offset:8640
    ds_read_b32 v48, v41 offset:8384
    ds_read_b32 v49, v41 offset:8512
    ds_read_b32 v50, v41 offset:8640
    ds_read_b32 v51, v41 offset:8768
    s_add_u32 s61, s61, 512
    v_and_b32 v43, 1, v1
    v_lshlrev_b32 v43, 4, v43
    s_waitcnt lgkmcnt(6)
    v_readfirstlane_b32 s64, v68
    v_readfirstlane_b32 s65, v69
    v_readfirstlane_b32 s66, v70
    v_readfirstlane_b32 s67, v71
    s_add_u32 m0, s63, 0
    s_andn2_b32 s72, s64, 7
    buffer_load_dwordx4 v2, s[8:11], s72 offen lds
    buffer_load_dwordx4 v3, s[8:11], s72 offen offset:1024 lds
    s_and_b32 s68, s64, 7
    s_cmp_le_u32 s62, 1
    s_cbranch_scc1 L_6
    s_add_u32 m0, s63, 2048
    s_andn2_b32 s72, s65, 7
    buffer_load_dwordx4 v2, s[8:11], s72 offen lds
    buffer_load_dwordx4 v3, s[8:11], s72 offen offset:1024 lds
    s_and_b32 s69, s65, 7
    s_cmp_le_u32 s62, 2
    s_cbranch_scc1 L_6
    s_add_u32 m0, s63, 4096
    s_andn2_b32 s72, s66, 7
    buffer_load_dwordx4 v2, s[8:11], s72 offen lds
    buffer_load_dwordx4 v3, s[8:11], s72 offen offset:1024 lds
    s_and_b32 s70, s66, 7
    s_cmp_le_u32 s62, 3
    s_cbranch_scc1 L_6
    s_add_u32 m0, s63, 6144
    s_andn2_b32 s72, s67, 7
    buffer_load_dwordx4 v2, s[8:11], s72 offen lds
    buffer_load_dwordx4 v3, s[8:11], s72 offen offset:1024 lds
    s_and_b32 s71, s67, 7
L_6:
    s_waitcnt lgkmcnt(0)
    v_lshlrev_b32 v44, 3, v44
    v_lshlrev_b32 v45, 3, v45
    v_lshl_add_u32 v48, v48, 5, v43
    v_lshl_add_u32 v49, v49, 5, v43
    v_lshl_add_u32 v50, v50, 5, v43
    v_lshl_add_u32 v51, v51, 5, v43
    s_sub_u32 s53, s62, 0
    v_cmp_gt_u32 vcc, s53, v1
    s_mov_b64 exec, vcc
    buffer_load_dwordx2 v[52:53], v44, s[20:23], 0 offen
    s_mov_b64 exec, -1
    v_cmp_gt_u32 vcc, s53, v42
    s_add_u32 m0, s78, 4096
    s_mov_b64 exec, vcc
    buffer_load_dwordx4 v48, s[24:27], 0 offen lds
    s_mov_b64 exec, -1
    s_cmp_le_u32 s62, 32
    s_cbranch_scc1 L_7
    s_sub_u32 s53, s62, 32
    v_cmp_gt_u32 vcc, s53, v42
    s_add_u32 m0, s78, 5120
    s_mov_b64 exec, vcc
    buffer_load_dwordx4 v49, s[24:27], 0 offen lds
    s_mov_b64 exec, -1
    s_cmp_le_u32 s62, 64
    s_cbranch_scc1 L_7
    s_sub_u32 s53, s62, 64
    v_cmp_gt_u32 vcc, s53, v1
    s_mov_b64 exec, vcc
    buffer_load_dwordx2 v[54:55], v45, s[20:23], 0 offen
    s_mov_b64 exec, -1
    v_cmp_gt_u32 vcc, s53, v42
    s_add_u32 m0, s78, 6144
    s_mov_b64 exec, vcc
    buffer_load_dwordx4 v50, s[24:27], 0 offen lds
    s_mov_b64 exec, -1
    s_cmp_le_u32 s62, 96
    s_cbranch_scc1 L_7
    s_sub_u32 s53, s62, 96
    v_cmp_gt_u32 vcc, s53, v42
    s_add_u32 m0, s78, 7168
    s_mov_b64 exec, vcc
    buffer_load_dwordx4 v51, s[24:27], 0 offen lds
    s_mov_b64 exec, -1
L_7:
    v_and_b32 v40, 3, v1
    v_lshl_add_u32 v5, v40, 3, s78
    v_bfe_u32 v41, v1, 4, 1
    v_lshlrev_b32 v41, 4, v41
    v_lshl_add_u32 v41, v40, 5, v41
    s_add_u32 s53, s78, 4096
    v_add_u32 v41, s53, v41
    v_mov_b32 v42, 156032
    v_cmp_ne_u32 vcc, 0, v8
    v_cmp_ne_u32 s[4:5], 0, v9
    v_lshl_add_u32 v43, v1, 5, s78
    v_cndmask_b32 v6, v42, v41, vcc
    v_cndmask_b32 v7, v42, v41, s[4:5]
    s_waitcnt vmcnt(0)
    v_mfma_f32_4x4x4_16b_bf16 v[16:19], a[32:33], v[52:53], 0
    v_mfma_f32_4x4x4_16b_bf16 v[20:23], a[34:35], v[52:53], 0
    v_mfma_f32_4x4x4_16b_bf16 v[24:27], a[36:37], v[52:53], 0
    v_mfma_f32_4x4x4_16b_bf16 v[28:31], a[38:39], v[52:53], 0
    s_nop 2
    v_cvt_pk_bf16_f32 v32, v16, v17
    v_cvt_pk_bf16_f32 v33, v18, v19
    v_cvt_pk_bf16_f32 v34, v20, v21
    v_cvt_pk_bf16_f32 v35, v22, v23
    v_cvt_pk_bf16_f32 v36, v24, v25
    v_cvt_pk_bf16_f32 v37, v26, v27
    v_cvt_pk_bf16_f32 v38, v28, v29
    v_cvt_pk_bf16_f32 v39, v30, v31
    ds_write_b128 v43, v[32:35] offset:0
    ds_write_b128 v43, v[36:39] offset:16
    s_cmp_le_u32 s62, 64
    s_cbranch_scc1 L_group
    v_mfma_f32_4x4x4_16b_bf16 v[16:19], a[32:33], v[54:55], 0
    v_mfma_f32_4x4x4_16b_bf16 v[20:23], a[34:35], v[54:55], 0
    v_mfma_f32_4x4x4_16b_bf16 v[24:27], a[36:37], v[54:55], 0
    v_mfma_f32_4x4x4_16b_bf16 v[28:31], a[38:39], v[54:55], 0
    s_nop 2
    v_cvt_pk_bf16_f32 v32, v16, v17
    v_cvt_pk_bf16_f32 v33, v18, v19
    v_cvt_pk_bf16_f32 v34, v20, v21
    v_cvt_pk_bf16_f32 v35, v22, v23
    v_cvt_pk_bf16_f32 v36, v24, v25
    v_cvt_pk_bf16_f32 v37, v26, v27
    v_cvt_pk_bf16_f32 v38, v28, v29
    v_cvt_pk_bf16_f32 v39, v30, v31
    ds_write_b128 v43, v[32:35] offset:2048
    ds_write_b128 v43, v[36:39] offset:2064
L_group:
    ds_read_b128 v[60:63], v6
    ds_read_b128 v[64:67], v7
    ds_read_b128 v[68:71], v10 offset:16
    v_add_u32 v6, v6, v8
    v_add_u32 v7, v7, v9
    v_add_u32 v10, 16, v10
    s_waitcnt lgkmcnt(0)
    v_mfma_f32_16x16x32_bf16 v[16:19], v[60:63], a[0:3], 0
    v_mfma_f32_16x16x32_bf16 v[20:23], v[60:63], a[8:11], 0
    v_mfma_f32_16x16x32_bf16 v[24:27], v[60:63], a[16:19], 0
    v_mfma_f32_16x16x32_bf16 v[28:31], v[60:63], a[24:27], 0
    v_mfma_f32_16x16x32_bf16 v[16:19], v[64:67], a[4:7], v[16:19]
    v_mfma_f32_16x16x32_bf16 v[20:23], v[64:67], a[12:15], v[20:23]
    v_mfma_f32_16x16x32_bf16 v[24:27], v[64:67], a[20:23], v[24:27]
    v_mfma_f32_16x16x32_bf16 v[28:31], v[64:67], a[28:31], v[28:31]
    v_readfirstlane_b32 s64, v68
    v_readfirstlane_b32 s65, v69
    v_readfirstlane_b32 s66, v70
    v_readfirstlane_b32 s67, v71
    ds_read_b64 v[56:57], v5 offset:0
    s_cmp_ge_u32 s62, 4
    s_cbranch_scc1 L_8
    s_waitcnt vmcnt(0)
L_8:
    s_waitcnt vmcnt(6)
    ds_read_b64_tr_b16 v[48:49], v4 offset:0
    ds_read_b64_tr_b16 v[50:51], v4 offset:256
    ds_read_b64_tr_b16 v[52:53], v4 offset:512
    ds_read_b64_tr_b16 v[54:55], v4 offset:768
    s_waitcnt lgkmcnt(0)
    s_cmp_le_u32 s62, 4
    s_cbranch_scc1 L_9
    s_add_u32 m0, s63, 0
    s_andn2_b32 s72, s64, 7
    buffer_load_dwordx4 v2, s[8:11], s72 offen lds
    buffer_load_dwordx4 v3, s[8:11], s72 offen offset:1024 lds
L_9:
    v_mfma_f32_4x4x4_16b_bf16 v[32:35], v[56:57], v[48:49], 0
    v_mfma_f32_4x4x4_16b_bf16 v[36:39], v[56:57], v[50:51], 0
    v_mfma_f32_4x4x4_16b_bf16 v[40:43], v[56:57], v[52:53], 0
    v_mfma_f32_4x4x4_16b_bf16 v[44:47], v[56:57], v[54:55], 0
    s_nop 1
    s_cmp_ge_u32 s68, 2
    s_cbranch_scc1 L_acc_12
    s_cmp_eq_u32 s68, 1
    s_cbranch_scc1 L_acc_11
    v_pk_fma_f32 v[80:81], v[32:33], v[16:17], v[80:81] op_sel:[0,0,0] op_sel_hi:[1,0,1]
    v_pk_fma_f32 v[82:83], v[34:35], v[16:17], v[82:83] op_sel:[0,0,0] op_sel_hi:[1,0,1]
    v_pk_fma_f32 v[84:85], v[36:37], v[20:21], v[84:85] op_sel:[0,0,0] op_sel_hi:[1,0,1]
    v_pk_fma_f32 v[86:87], v[38:39], v[20:21], v[86:87] op_sel:[0,0,0] op_sel_hi:[1,0,1]
    v_pk_fma_f32 v[88:89], v[40:41], v[24:25], v[88:89] op_sel:[0,0,0] op_sel_hi:[1,0,1]
    v_pk_fma_f32 v[90:91], v[42:43], v[24:25], v[90:91] op_sel:[0,0,0] op_sel_hi:[1,0,1]
    v_pk_fma_f32 v[92:93], v[44:45], v[28:29], v[92:93] op_sel:[0,0,0] op_sel_hi:[1,0,1]
    v_pk_fma_f32 v[94:95], v[46:47], v[28:29], v[94:95] op_sel:[0,0,0] op_sel_hi:[1,0,1]
    s_branch L_join_15
L_acc_11:
    v_pk_fma_f32 v[96:97], v[32:33], v[16:17], v[96:97] op_sel:[0,0,0] op_sel_hi:[1,0,1]
    v_pk_fma_f32 v[98:99], v[34:35], v[16:17], v[98:99] op_sel:[0,0,0] op_sel_hi:[1,0,1]
    v_pk_fma_f32 v[100:101], v[36:37], v[20:21], v[100:101] op_sel:[0,0,0] op_sel_hi:[1,0,1]
    v_pk_fma_f32 v[102:103], v[38:39], v[20:21], v[102:103] op_sel:[0,0,0] op_sel_hi:[1,0,1]
    v_pk_fma_f32 v[104:105], v[40:41], v[24:25], v[104:105] op_sel:[0,0,0] op_sel_hi:[1,0,1]
    v_pk_fma_f32 v[106:107], v[42:43], v[24:25], v[106:107] op_sel:[0,0,0] op_sel_hi:[1,0,1]
    v_pk_fma_f32 v[108:109], v[44:45], v[28:29], v[108:109] op_sel:[0,0,0] op_sel_hi:[1,0,1]
    v_pk_fma_f32 v[110:111], v[46:47], v[28:29], v[110:111] op_sel:[0,0,0] op_sel_hi:[1,0,1]
    s_branch L_join_15
L_acc_12:
    s_cmp_eq_u32 s68, 3
    s_cbranch_scc1 L_acc_13
    s_cmp_eq_u32 s68, 4
    s_cbranch_scc1 L_acc_14
    v_pk_fma_f32 v[112:113], v[32:33], v[16:17], v[112:113] op_sel:[0,0,0] op_sel_hi:[1,0,1]
    v_pk_fma_f32 v[114:115], v[34:35], v[16:17], v[114:115] op_sel:[0,0,0] op_sel_hi:[1,0,1]
    v_pk_fma_f32 v[116:117], v[36:37], v[20:21], v[116:117] op_sel:[0,0,0] op_sel_hi:[1,0,1]
    v_pk_fma_f32 v[118:119], v[38:39], v[20:21], v[118:119] op_sel:[0,0,0] op_sel_hi:[1,0,1]
    v_pk_fma_f32 v[120:121], v[40:41], v[24:25], v[120:121] op_sel:[0,0,0] op_sel_hi:[1,0,1]
    v_pk_fma_f32 v[122:123], v[42:43], v[24:25], v[122:123] op_sel:[0,0,0] op_sel_hi:[1,0,1]
    v_pk_fma_f32 v[124:125], v[44:45], v[28:29], v[124:125] op_sel:[0,0,0] op_sel_hi:[1,0,1]
    v_pk_fma_f32 v[126:127], v[46:47], v[28:29], v[126:127] op_sel:[0,0,0] op_sel_hi:[1,0,1]
    s_branch L_join_15
L_acc_13:
    v_pk_fma_f32 v[128:129], v[32:33], v[16:17], v[128:129] op_sel:[0,0,0] op_sel_hi:[1,0,1]
    v_pk_fma_f32 v[130:131], v[34:35], v[16:17], v[130:131] op_sel:[0,0,0] op_sel_hi:[1,0,1]
    v_pk_fma_f32 v[132:133], v[36:37], v[20:21], v[132:133] op_sel:[0,0,0] op_sel_hi:[1,0,1]
    v_pk_fma_f32 v[134:135], v[38:39], v[20:21], v[134:135] op_sel:[0,0,0] op_sel_hi:[1,0,1]
    v_pk_fma_f32 v[136:137], v[40:41], v[24:25], v[136:137] op_sel:[0,0,0] op_sel_hi:[1,0,1]
    v_pk_fma_f32 v[138:139], v[42:43], v[24:25], v[138:139] op_sel:[0,0,0] op_sel_hi:[1,0,1]
    v_pk_fma_f32 v[140:141], v[44:45], v[28:29], v[140:141] op_sel:[0,0,0] op_sel_hi:[1,0,1]
    v_pk_fma_f32 v[142:143], v[46:47], v[28:29], v[142:143] op_sel:[0,0,0] op_sel_hi:[1,0,1]
    s_branch L_join_15
L_acc_14:
    v_pk_fma_f32 v[144:145], v[32:33], v[16:17], v[144:145] op_sel:[0,0,0] op_sel_hi:[1,0,1]
    v_pk_fma_f32 v[146:147], v[34:35], v[16:17], v[146:147] op_sel:[0,0,0] op_sel_hi:[1,0,1]
    v_pk_fma_f32 v[148:149], v[36:37], v[20:21], v[148:149] op_sel:[0,0,0] op_sel_hi:[1,0,1]
    v_pk_fma_f32 v[150:151], v[38:39], v[20:21], v[150:151] op_sel:[0,0,0] op_sel_hi:[1,0,1]
    v_pk_fma_f32 v[152:153], v[40:41], v[24:25], v[152:153] op_sel:[0,0,0] op_sel_hi:[1,0,1]
    v_pk_fma_f32 v[154:155], v[42:43], v[24:25], v[154:155] op_sel:[0,0,0] op_sel_hi:[1,0,1]
    v_pk_fma_f32 v[156:157], v[44:45], v[28:29], v[156:157] op_sel:[0,0,0] op_sel_hi:[1,0,1]
    v_pk_fma_f32 v[158:159], v[46:47], v[28:29], v[158:159] op_sel:[0,0,0] op_sel_hi:[1,0,1]
L_join_15:
    s_and_b32 s68, s64, 7
    s_sub_u32 s62, s62, 1
    s_cmp_eq_u32 s62, 0
    s_cbranch_scc1 L_block
    ds_read_b64 v[56:57], v5 offset:32
    s_cmp_ge_u32 s62, 4
    s_cbranch_scc1 L_16
    s_waitcnt vmcnt(0)
L_16:
    s_waitcnt vmcnt(6)
    ds_read_b64_tr_b16 v[48:49], v4 offset:2048
    ds_read_b64_tr_b16 v[50:51], v4 offset:2304
    ds_read_b64_tr_b16 v[52:53], v4 offset:2560
    ds_read_b64_tr_b16 v[54:55], v4 offset:2816
    s_waitcnt lgkmcnt(0)
    s_cmp_le_u32 s62, 4
    s_cbranch_scc1 L_17
    s_add_u32 m0, s63, 2048
    s_andn2_b32 s72, s65, 7
    buffer_load_dwordx4 v2, s[8:11], s72 offen lds
    buffer_load_dwordx4 v3, s[8:11], s72 offen offset:1024 lds
L_17:
    v_mfma_f32_4x4x4_16b_bf16 v[32:35], v[56:57], v[48:49], 0
    v_mfma_f32_4x4x4_16b_bf16 v[36:39], v[56:57], v[50:51], 0
    v_mfma_f32_4x4x4_16b_bf16 v[40:43], v[56:57], v[52:53], 0
    v_mfma_f32_4x4x4_16b_bf16 v[44:47], v[56:57], v[54:55], 0
    s_nop 1
    s_cmp_ge_u32 s69, 2
    s_cbranch_scc1 L_acc_20
    s_cmp_eq_u32 s69, 1
    s_cbranch_scc1 L_acc_19
    v_pk_fma_f32 v[80:81], v[32:33], v[16:17], v[80:81] op_sel:[0,1,0] op_sel_hi:[1,1,1]
    v_pk_fma_f32 v[82:83], v[34:35], v[16:17], v[82:83] op_sel:[0,1,0] op_sel_hi:[1,1,1]
    v_pk_fma_f32 v[84:85], v[36:37], v[20:21], v[84:85] op_sel:[0,1,0] op_sel_hi:[1,1,1]
    v_pk_fma_f32 v[86:87], v[38:39], v[20:21], v[86:87] op_sel:[0,1,0] op_sel_hi:[1,1,1]
    v_pk_fma_f32 v[88:89], v[40:41], v[24:25], v[88:89] op_sel:[0,1,0] op_sel_hi:[1,1,1]
    v_pk_fma_f32 v[90:91], v[42:43], v[24:25], v[90:91] op_sel:[0,1,0] op_sel_hi:[1,1,1]
    v_pk_fma_f32 v[92:93], v[44:45], v[28:29], v[92:93] op_sel:[0,1,0] op_sel_hi:[1,1,1]
    v_pk_fma_f32 v[94:95], v[46:47], v[28:29], v[94:95] op_sel:[0,1,0] op_sel_hi:[1,1,1]
    s_branch L_join_23
L_acc_19:
    v_pk_fma_f32 v[96:97], v[32:33], v[16:17], v[96:97] op_sel:[0,1,0] op_sel_hi:[1,1,1]
    v_pk_fma_f32 v[98:99], v[34:35], v[16:17], v[98:99] op_sel:[0,1,0] op_sel_hi:[1,1,1]
    v_pk_fma_f32 v[100:101], v[36:37], v[20:21], v[100:101] op_sel:[0,1,0] op_sel_hi:[1,1,1]
    v_pk_fma_f32 v[102:103], v[38:39], v[20:21], v[102:103] op_sel:[0,1,0] op_sel_hi:[1,1,1]
    v_pk_fma_f32 v[104:105], v[40:41], v[24:25], v[104:105] op_sel:[0,1,0] op_sel_hi:[1,1,1]
    v_pk_fma_f32 v[106:107], v[42:43], v[24:25], v[106:107] op_sel:[0,1,0] op_sel_hi:[1,1,1]
    v_pk_fma_f32 v[108:109], v[44:45], v[28:29], v[108:109] op_sel:[0,1,0] op_sel_hi:[1,1,1]
    v_pk_fma_f32 v[110:111], v[46:47], v[28:29], v[110:111] op_sel:[0,1,0] op_sel_hi:[1,1,1]
    s_branch L_join_23
L_acc_20:
    s_cmp_eq_u32 s69, 3
    s_cbranch_scc1 L_acc_21
    s_cmp_eq_u32 s69, 4
    s_cbranch_scc1 L_acc_22
    v_pk_fma_f32 v[112:113], v[32:33], v[16:17], v[112:113] op_sel:[0,1,0] op_sel_hi:[1,1,1]
    v_pk_fma_f32 v[114:115], v[34:35], v[16:17], v[114:115] op_sel:[0,1,0] op_sel_hi:[1,1,1]
    v_pk_fma_f32 v[116:117], v[36:37], v[20:21], v[116:117] op_sel:[0,1,0] op_sel_hi:[1,1,1]
    v_pk_fma_f32 v[118:119], v[38:39], v[20:21], v[118:119] op_sel:[0,1,0] op_sel_hi:[1,1,1]
    v_pk_fma_f32 v[120:121], v[40:41], v[24:25], v[120:121] op_sel:[0,1,0] op_sel_hi:[1,1,1]
    v_pk_fma_f32 v[122:123], v[42:43], v[24:25], v[122:123] op_sel:[0,1,0] op_sel_hi:[1,1,1]
    v_pk_fma_f32 v[124:125], v[44:45], v[28:29], v[124:125] op_sel:[0,1,0] op_sel_hi:[1,1,1]
    v_pk_fma_f32 v[126:127], v[46:47], v[28:29], v[126:127] op_sel:[0,1,0] op_sel_hi:[1,1,1]
    s_branch L_join_23
L_acc_21:
    v_pk_fma_f32 v[128:129], v[32:33], v[16:17], v[128:129] op_sel:[0,1,0] op_sel_hi:[1,1,1]
    v_pk_fma_f32 v[130:131], v[34:35], v[16:17], v[130:131] op_sel:[0,1,0] op_sel_hi:[1,1,1]
    v_pk_fma_f32 v[132:133], v[36:37], v[20:21], v[132:133] op_sel:[0,1,0] op_sel_hi:[1,1,1]
    v_pk_fma_f32 v[134:135], v[38:39], v[20:21], v[134:135] op_sel:[0,1,0] op_sel_hi:[1,1,1]
    v_pk_fma_f32 v[136:137], v[40:41], v[24:25], v[136:137] op_sel:[0,1,0] op_sel_hi:[1,1,1]
    v_pk_fma_f32 v[138:139], v[42:43], v[24:25], v[138:139] op_sel:[0,1,0] op_sel_hi:[1,1,1]
    v_pk_fma_f32 v[140:141], v[44:45], v[28:29], v[140:141] op_sel:[0,1,0] op_sel_hi:[1,1,1]
    v_pk_fma_f32 v[142:143], v[46:47], v[28:29], v[142:143] op_sel:[0,1,0] op_sel_hi:[1,1,1]
    s_branch L_join_23
L_acc_22:
    v_pk_fma_f32 v[144:145], v[32:33], v[16:17], v[144:145] op_sel:[0,1,0] op_sel_hi:[1,1,1]
    v_pk_fma_f32 v[146:147], v[34:35], v[16:17], v[146:147] op_sel:[0,1,0] op_sel_hi:[1,1,1]
    v_pk_fma_f32 v[148:149], v[36:37], v[20:21], v[148:149] op_sel:[0,1,0] op_sel_hi:[1,1,1]
    v_pk_fma_f32 v[150:151], v[38:39], v[20:21], v[150:151] op_sel:[0,1,0] op_sel_hi:[1,1,1]
    v_pk_fma_f32 v[152:153], v[40:41], v[24:25], v[152:153] op_sel:[0,1,0] op_sel_hi:[1,1,1]
    v_pk_fma_f32 v[154:155], v[42:43], v[24:25], v[154:155] op_sel:[0,1,0] op_sel_hi:[1,1,1]
    v_pk_fma_f32 v[156:157], v[44:45], v[28:29], v[156:157] op_sel:[0,1,0] op_sel_hi:[1,1,1]
    v_pk_fma_f32 v[158:159], v[46:47], v[28:29], v[158:159] op_sel:[0,1,0] op_sel_hi:[1,1,1]
L_join_23:
    s_and_b32 s69, s65, 7
    s_sub_u32 s62, s62, 1
    s_cmp_eq_u32 s62, 0
    s_cbranch_scc1 L_block
    ds_read_b64 v[56:57], v5 offset:64
    s_cmp_ge_u32 s62, 4
    s_cbranch_scc1 L_24
    s_waitcnt vmcnt(0)
L_24:
    s_waitcnt vmcnt(6)
    ds_read_b64_tr_b16 v[48:49], v4 offset:4096
    ds_read_b64_tr_b16 v[50:51], v4 offset:4352
    ds_read_b64_tr_b16 v[52:53], v4 offset:4608
    ds_read_b64_tr_b16 v[54:55], v4 offset:4864
    s_waitcnt lgkmcnt(0)
    s_cmp_le_u32 s62, 4
    s_cbranch_scc1 L_25
    s_add_u32 m0, s63, 4096
    s_andn2_b32 s72, s66, 7
    buffer_load_dwordx4 v2, s[8:11], s72 offen lds
    buffer_load_dwordx4 v3, s[8:11], s72 offen offset:1024 lds
L_25:
    v_mfma_f32_4x4x4_16b_bf16 v[32:35], v[56:57], v[48:49], 0
    v_mfma_f32_4x4x4_16b_bf16 v[36:39], v[56:57], v[50:51], 0
    v_mfma_f32_4x4x4_16b_bf16 v[40:43], v[56:57], v[52:53], 0
    v_mfma_f32_4x4x4_16b_bf16 v[44:47], v[56:57], v[54:55], 0
    s_nop 1
    s_cmp_ge_u32 s70, 2
    s_cbranch_scc1 L_acc_28
    s_cmp_eq_u32 s70, 1
    s_cbranch_scc1 L_acc_27
    v_pk_fma_f32 v[80:81], v[32:33], v[18:19], v[80:81] op_sel:[0,0,0] op_sel_hi:[1,0,1]
    v_pk_fma_f32 v[82:83], v[34:35], v[18:19], v[82:83] op_sel:[0,0,0] op_sel_hi:[1,0,1]
    v_pk_fma_f32 v[84:85], v[36:37], v[22:23], v[84:85] op_sel:[0,0,0] op_sel_hi:[1,0,1]
    v_pk_fma_f32 v[86:87], v[38:39], v[22:23], v[86:87] op_sel:[0,0,0] op_sel_hi:[1,0,1]
    v_pk_fma_f32 v[88:89], v[40:41], v[26:27], v[88:89] op_sel:[0,0,0] op_sel_hi:[1,0,1]
    v_pk_fma_f32 v[90:91], v[42:43], v[26:27], v[90:91] op_sel:[0,0,0] op_sel_hi:[1,0,1]
    v_pk_fma_f32 v[92:93], v[44:45], v[30:31], v[92:93] op_sel:[0,0,0] op_sel_hi:[1,0,1]
    v_pk_fma_f32 v[94:95], v[46:47], v[30:31], v[94:95] op_sel:[0,0,0] op_sel_hi:[1,0,1]
    s_branch L_join_31
L_acc_27:
    v_pk_fma_f32 v[96:97], v[32:33], v[18:19], v[96:97] op_sel:[0,0,0] op_sel_hi:[1,0,1]
    v_pk_fma_f32 v[98:99], v[34:35], v[18:19], v[98:99] op_sel:[0,0,0] op_sel_hi:[1,0,1]
    v_pk_fma_f32 v[100:101], v[36:37], v[22:23], v[100:101] op_sel:[0,0,0] op_sel_hi:[1,0,1]
    v_pk_fma_f32 v[102:103], v[38:39], v[22:23], v[102:103] op_sel:[0,0,0] op_sel_hi:[1,0,1]
    v_pk_fma_f32 v[104:105], v[40:41], v[26:27], v[104:105] op_sel:[0,0,0] op_sel_hi:[1,0,1]
    v_pk_fma_f32 v[106:107], v[42:43], v[26:27], v[106:107] op_sel:[0,0,0] op_sel_hi:[1,0,1]
    v_pk_fma_f32 v[108:109], v[44:45], v[30:31], v[108:109] op_sel:[0,0,0] op_sel_hi:[1,0,1]
    v_pk_fma_f32 v[110:111], v[46:47], v[30:31], v[110:111] op_sel:[0,0,0] op_sel_hi:[1,0,1]
    s_branch L_join_31
L_acc_28:
    s_cmp_eq_u32 s70, 3
    s_cbranch_scc1 L_acc_29
    s_cmp_eq_u32 s70, 4
    s_cbranch_scc1 L_acc_30
    v_pk_fma_f32 v[112:113], v[32:33], v[18:19], v[112:113] op_sel:[0,0,0] op_sel_hi:[1,0,1]
    v_pk_fma_f32 v[114:115], v[34:35], v[18:19], v[114:115] op_sel:[0,0,0] op_sel_hi:[1,0,1]
    v_pk_fma_f32 v[116:117], v[36:37], v[22:23], v[116:117] op_sel:[0,0,0] op_sel_hi:[1,0,1]
    v_pk_fma_f32 v[118:119], v[38:39], v[22:23], v[118:119] op_sel:[0,0,0] op_sel_hi:[1,0,1]
    v_pk_fma_f32 v[120:121], v[40:41], v[26:27], v[120:121] op_sel:[0,0,0] op_sel_hi:[1,0,1]
    v_pk_fma_f32 v[122:123], v[42:43], v[26:27], v[122:123] op_sel:[0,0,0] op_sel_hi:[1,0,1]
    v_pk_fma_f32 v[124:125], v[44:45], v[30:31], v[124:125] op_sel:[0,0,0] op_sel_hi:[1,0,1]
    v_pk_fma_f32 v[126:127], v[46:47], v[30:31], v[126:127] op_sel:[0,0,0] op_sel_hi:[1,0,1]
    s_branch L_join_31
L_acc_29:
    v_pk_fma_f32 v[128:129], v[32:33], v[18:19], v[128:129] op_sel:[0,0,0] op_sel_hi:[1,0,1]
    v_pk_fma_f32 v[130:131], v[34:35], v[18:19], v[130:131] op_sel:[0,0,0] op_sel_hi:[1,0,1]
    v_pk_fma_f32 v[132:133], v[36:37], v[22:23], v[132:133] op_sel:[0,0,0] op_sel_hi:[1,0,1]
    v_pk_fma_f32 v[134:135], v[38:39], v[22:23], v[134:135] op_sel:[0,0,0] op_sel_hi:[1,0,1]
    v_pk_fma_f32 v[136:137], v[40:41], v[26:27], v[136:137] op_sel:[0,0,0] op_sel_hi:[1,0,1]
    v_pk_fma_f32 v[138:139], v[42:43], v[26:27], v[138:139] op_sel:[0,0,0] op_sel_hi:[1,0,1]
    v_pk_fma_f32 v[140:141], v[44:45], v[30:31], v[140:141] op_sel:[0,0,0] op_sel_hi:[1,0,1]
    v_pk_fma_f32 v[142:143], v[46:47], v[30:31], v[142:143] op_sel:[0,0,0] op_sel_hi:[1,0,1]
    s_branch L_join_31
L_acc_30:
    v_pk_fma_f32 v[144:145], v[32:33], v[18:19], v[144:145] op_sel:[0,0,0] op_sel_hi:[1,0,1]
    v_pk_fma_f32 v[146:147], v[34:35], v[18:19], v[146:147] op_sel:[0,0,0] op_sel_hi:[1,0,1]
    v_pk_fma_f32 v[148:149], v[36:37], v[22:23], v[148:149] op_sel:[0,0,0] op_sel_hi:[1,0,1]
    v_pk_fma_f32 v[150:151], v[38:39], v[22:23], v[150:151] op_sel:[0,0,0] op_sel_hi:[1,0,1]
    v_pk_fma_f32 v[152:153], v[40:41], v[26:27], v[152:153] op_sel:[0,0,0] op_sel_hi:[1,0,1]
    v_pk_fma_f32 v[154:155], v[42:43], v[26:27], v[154:155] op_sel:[0,0,0] op_sel_hi:[1,0,1]
    v_pk_fma_f32 v[156:157], v[44:45], v[30:31], v[156:157] op_sel:[0,0,0] op_sel_hi:[1,0,1]
    v_pk_fma_f32 v[158:159], v[46:47], v[30:31], v[158:159] op_sel:[0,0,0] op_sel_hi:[1,0,1]
L_join_31:
    s_and_b32 s70, s66, 7
    s_sub_u32 s62, s62, 1
    s_cmp_eq_u32 s62, 0
    s_cbranch_scc1 L_block
    ds_read_b64 v[56:57], v5 offset:96
    s_cmp_ge_u32 s62, 4
    s_cbranch_scc1 L_32
    s_waitcnt vmcnt(0)
L_32:
    s_waitcnt vmcnt(6)
    ds_read_b64_tr_b16 v[48:49], v4 offset:6144
    ds_read_b64_tr_b16 v[50:51], v4 offset:6400
    ds_read_b64_tr_b16 v[52:53], v4 offset:6656
    ds_read_b64_tr_b16 v[54:55], v4 offset:6912
    s_waitcnt lgkmcnt(0)
    s_cmp_le_u32 s62, 4
    s_cbranch_scc1 L_33
    s_add_u32 m0, s63, 6144
    s_andn2_b32 s72, s67, 7
    buffer_load_dwordx4 v2, s[8:11], s72 offen lds
    buffer_load_dwordx4 v3, s[8:11], s72 offen offset:1024 lds
L_33:
    v_mfma_f32_4x4x4_16b_bf16 v[32:35], v[56:57], v[48:49], 0
    v_mfma_f32_4x4x4_16b_bf16 v[36:39], v[56:57], v[50:51], 0
    v_mfma_f32_4x4x4_16b_bf16 v[40:43], v[56:57], v[52:53], 0
    v_mfma_f32_4x4x4_16b_bf16 v[44:47], v[56:57], v[54:55], 0
    s_nop 1
    s_cmp_ge_u32 s71, 2
    s_cbranch_scc1 L_acc_36
    s_cmp_eq_u32 s71, 1
    s_cbranch_scc1 L_acc_35
    v_pk_fma_f32 v[80:81], v[32:33], v[18:19], v[80:81] op_sel:[0,1,0] op_sel_hi:[1,1,1]
    v_pk_fma_f32 v[82:83], v[34:35], v[18:19], v[82:83] op_sel:[0,1,0] op_sel_hi:[1,1,1]
    v_pk_fma_f32 v[84:85], v[36:37], v[22:23], v[84:85] op_sel:[0,1,0] op_sel_hi:[1,1,1]
    v_pk_fma_f32 v[86:87], v[38:39], v[22:23], v[86:87] op_sel:[0,1,0] op_sel_hi:[1,1,1]
    v_pk_fma_f32 v[88:89], v[40:41], v[26:27], v[88:89] op_sel:[0,1,0] op_sel_hi:[1,1,1]
    v_pk_fma_f32 v[90:91], v[42:43], v[26:27], v[90:91] op_sel:[0,1,0] op_sel_hi:[1,1,1]
    v_pk_fma_f32 v[92:93], v[44:45], v[30:31], v[92:93] op_sel:[0,1,0] op_sel_hi:[1,1,1]
    v_pk_fma_f32 v[94:95], v[46:47], v[30:31], v[94:95] op_sel:[0,1,0] op_sel_hi:[1,1,1]
    s_branch L_join_39
L_acc_35:
    v_pk_fma_f32 v[96:97], v[32:33], v[18:19], v[96:97] op_sel:[0,1,0] op_sel_hi:[1,1,1]
    v_pk_fma_f32 v[98:99], v[34:35], v[18:19], v[98:99] op_sel:[0,1,0] op_sel_hi:[1,1,1]
    v_pk_fma_f32 v[100:101], v[36:37], v[22:23], v[100:101] op_sel:[0,1,0] op_sel_hi:[1,1,1]
    v_pk_fma_f32 v[102:103], v[38:39], v[22:23], v[102:103] op_sel:[0,1,0] op_sel_hi:[1,1,1]
    v_pk_fma_f32 v[104:105], v[40:41], v[26:27], v[104:105] op_sel:[0,1,0] op_sel_hi:[1,1,1]
    v_pk_fma_f32 v[106:107], v[42:43], v[26:27], v[106:107] op_sel:[0,1,0] op_sel_hi:[1,1,1]
    v_pk_fma_f32 v[108:109], v[44:45], v[30:31], v[108:109] op_sel:[0,1,0] op_sel_hi:[1,1,1]
    v_pk_fma_f32 v[110:111], v[46:47], v[30:31], v[110:111] op_sel:[0,1,0] op_sel_hi:[1,1,1]
    s_branch L_join_39
L_acc_36:
    s_cmp_eq_u32 s71, 3
    s_cbranch_scc1 L_acc_37
    s_cmp_eq_u32 s71, 4
    s_cbranch_scc1 L_acc_38
    v_pk_fma_f32 v[112:113], v[32:33], v[18:19], v[112:113] op_sel:[0,1,0] op_sel_hi:[1,1,1]
    v_pk_fma_f32 v[114:115], v[34:35], v[18:19], v[114:115] op_sel:[0,1,0] op_sel_hi:[1,1,1]
    v_pk_fma_f32 v[116:117], v[36:37], v[22:23], v[116:117] op_sel:[0,1,0] op_sel_hi:[1,1,1]
    v_pk_fma_f32 v[118:119], v[38:39], v[22:23], v[118:119] op_sel:[0,1,0] op_sel_hi:[1,1,1]
    v_pk_fma_f32 v[120:121], v[40:41], v[26:27], v[120:121] op_sel:[0,1,0] op_sel_hi:[1,1,1]
    v_pk_fma_f32 v[122:123], v[42:43], v[26:27], v[122:123] op_sel:[0,1,0] op_sel_hi:[1,1,1]
    v_pk_fma_f32 v[124:125], v[44:45], v[30:31], v[124:125] op_sel:[0,1,0] op_sel_hi:[1,1,1]
    v_pk_fma_f32 v[126:127], v[46:47], v[30:31], v[126:127] op_sel:[0,1,0] op_sel_hi:[1,1,1]
    s_branch L_join_39
L_acc_37:
    v_pk_fma_f32 v[128:129], v[32:33], v[18:19], v[128:129] op_sel:[0,1,0] op_sel_hi:[1,1,1]
    v_pk_fma_f32 v[130:131], v[34:35], v[18:19], v[130:131] op_sel:[0,1,0] op_sel_hi:[1,1,1]
    v_pk_fma_f32 v[132:133], v[36:37], v[22:23], v[132:133] op_sel:[0,1,0] op_sel_hi:[1,1,1]
    v_pk_fma_f32 v[134:135], v[38:39], v[22:23], v[134:135] op_sel:[0,1,0] op_sel_hi:[1,1,1]
    v_pk_fma_f32 v[136:137], v[40:41], v[26:27], v[136:137] op_sel:[0,1,0] op_sel_hi:[1,1,1]
    v_pk_fma_f32 v[138:139], v[42:43], v[26:27], v[138:139] op_sel:[0,1,0] op_sel_hi:[1,1,1]
    v_pk_fma_f32 v[140:141], v[44:45], v[30:31], v[140:141] op_sel:[0,1,0] op_sel_hi:[1,1,1]
    v_pk_fma_f32 v[142:143], v[46:47], v[30:31], v[142:143] op_sel:[0,1,0] op_sel_hi:[1,1,1]
    s_branch L_join_39
L_acc_38:
    v_pk_fma_f32 v[144:145], v[32:33], v[18:19], v[144:145] op_sel:[0,1,0] op_sel_hi:[1,1,1]
    v_pk_fma_f32 v[146:147], v[34:35], v[18:19], v[146:147] op_sel:[0,1,0] op_sel_hi:[1,1,1]
    v_pk_fma_f32 v[148:149], v[36:37], v[22:23], v[148:149] op_sel:[0,1,0] op_sel_hi:[1,1,1]
    v_pk_fma_f32 v[150:151], v[38:39], v[22:23], v[150:151] op_sel:[0,1,0] op_sel_hi:[1,1,1]
    v_pk_fma_f32 v[152:153], v[40:41], v[26:27], v[152:153] op_sel:[0,1,0] op_sel_hi:[1,1,1]
    v_pk_fma_f32 v[154:155], v[42:43], v[26:27], v[154:155] op_sel:[0,1,0] op_sel_hi:[1,1,1]
    v_pk_fma_f32 v[156:157], v[44:45], v[30:31], v[156:157] op_sel:[0,1,0] op_sel_hi:[1,1,1]
    v_pk_fma_f32 v[158:159], v[46:47], v[30:31], v[158:159] op_sel:[0,1,0] op_sel_hi:[1,1,1]
L_join_39:
    s_and_b32 s71, s67, 7
    s_sub_u32 s62, s62, 1
    s_cmp_eq_u32 s62, 0
    s_cbranch_scc1 L_block
    v_add_u32 v5, 128, v5
    s_branch L_group
L_round_done:
    s_add_u32 s73, s73, 1
    s_cmp_lg_u32 s74, 0
    s_cbranch_scc1 L_scan
    s_lshl_b32 s53, s3, 14
    s_add_u32 s53, s53, 2097152
    v_lshlrev_b32 v16, 4, v1
    v_add_u32 v16, s53, v16
    s_waitcnt vmcnt(0)
    buffer_load_dwordx4 a[32:35], v16, s[32:35], 0 offen offset:0
    buffer_load_dwordx4 a[36:39], v16, s[32:35], 0 offen offset:1024
    buffer_load_dwordx4 a[40:43], v16, s[32:35], 0 offen offset:2048
    buffer_load_dwordx4 a[44:47], v16, s[32:35], 0 offen offset:3072
    v_add_u32 v16, 4096, v16
    buffer_load_dwordx4 a[48:51], v16, s[32:35], 0 offen offset:0
    buffer_load_dwordx4 a[52:55], v16, s[32:35], 0 offen offset:1024
    buffer_load_dwordx4 a[56:59], v16, s[32:35], 0 offen offset:2048
    buffer_load_dwordx4 a[60:63], v16, s[32:35], 0 offen offset:3072
    v_add_u32 v16, 4096, v16
    buffer_load_dwordx4 a[64:67], v16, s[32:35], 0 offen offset:0
    buffer_load_dwordx4 a[68:71], v16, s[32:35], 0 offen offset:1024
    buffer_load_dwordx4 a[72:75], v16, s[32:35], 0 offen offset:2048
    buffer_load_dwordx4 a[76:79], v16, s[32:35], 0 offen offset:3072
    v_add_u32 v16, 4096, v16
    buffer_load_dwordx4 a[80:83], v16, s[32:35], 0 offen offset:0
    buffer_load_dwordx4 a[84:87], v16, s[32:35], 0 offen offset:1024
    buffer_load_dwordx4 a[88:91], v16, s[32:35], 0 offen offset:2048
    buffer_load_dwordx4 a[92:95], v16, s[32:35], 0 offen offset:3072
    v_add_u32 v16, 4096, v16
    v_mul_u32_u24 v16, 320, v1
    v_lshrrev_b32 v17, 2, v1
    v_lshl_add_u32 v16, v17, 3, v16
    s_lshl_b32 s53, s56, 3
    v_add_u32 v17, s53, v16
    s_lshl_b32 s53, s57, 3
    v_add_u32 v18, s53, v16
    s_lshl_b32 s53, s58, 3
    v_add_u32 v19, s53, v16
    s_lshl_b32 s53, s59, 3
    v_add_u32 v20, s53, v16
    s_lshl_b32 s53, s60, 3
    v_add_u32 v21, s53, v16
    v_cvt_pk_bf16_f32 v24, v80, v81
    v_cvt_pk_bf16_f32 v25, v82, v83
    v_cvt_pk_bf16_f32 v26, v84, v85
    v_cvt_pk_bf16_f32 v27, v86, v87
    v_cvt_pk_bf16_f32 v28, v88, v89
    v_cvt_pk_bf16_f32 v29, v90, v91
    v_cvt_pk_bf16_f32 v30, v92, v93
    v_cvt_pk_bf16_f32 v31, v94, v95
    v_cvt_pk_bf16_f32 v32, v96, v97
    v_cvt_pk_bf16_f32 v33, v98, v99
    v_cvt_pk_bf16_f32 v34, v100, v101
    v_cvt_pk_bf16_f32 v35, v102, v103
    v_cvt_pk_bf16_f32 v36, v104, v105
    v_cvt_pk_bf16_f32 v37, v106, v107
    v_cvt_pk_bf16_f32 v38, v108, v109
    v_cvt_pk_bf16_f32 v39, v110, v111
    v_cvt_pk_bf16_f32 v40, v112, v113
    v_cvt_pk_bf16_f32 v41, v114, v115
    v_cvt_pk_bf16_f32 v42, v116, v117
    v_cvt_pk_bf16_f32 v43, v118, v119
    v_cvt_pk_bf16_f32 v44, v120, v121
    v_cvt_pk_bf16_f32 v45, v122, v123
    v_cvt_pk_bf16_f32 v46, v124, v125
    v_cvt_pk_bf16_f32 v47, v126, v127
    v_cvt_pk_bf16_f32 v48, v128, v129
    v_cvt_pk_bf16_f32 v49, v130, v131
    v_cvt_pk_bf16_f32 v50, v132, v133
    v_cvt_pk_bf16_f32 v51, v134, v135
    v_cvt_pk_bf16_f32 v52, v136, v137
    v_cvt_pk_bf16_f32 v53, v138, v139
    v_cvt_pk_bf16_f32 v54, v140, v141
    v_cvt_pk_bf16_f32 v55, v142, v143
    v_cvt_pk_bf16_f32 v56, v144, v145
    v_cvt_pk_bf16_f32 v57, v146, v147
    v_cvt_pk_bf16_f32 v58, v148, v149
    v_cvt_pk_bf16_f32 v59, v150, v151
    v_cvt_pk_bf16_f32 v60, v152, v153
    v_cvt_pk_bf16_f32 v61, v154, v155
    v_cvt_pk_bf16_f32 v62, v156, v157
    v_cvt_pk_bf16_f32 v63, v158, v159
    v_lshrrev_b32 v70, 5, v1
    v_mul_u32_u24 v71, 2576, v70
    v_bfe_u32 v72, v1, 2, 2
    v_mul_u32_u24 v72, 320, v72
    v_bfe_u32 v73, v1, 4, 1
    v_lshl_add_u32 v71, v73, 5, v71
    v_and_b32 v73, 3, v1
    v_lshl_add_u32 v71, v73, 3, v71
    v_add_u32 v2, v71, v72
    v_add_u32 v3, 41216, v2
    v_bfe_u32 v72, v1, 2, 3
    v_lshlrev_b32 v72, 19, v72
    v_lshl_add_u32 v72, v73, 9, v72
    v_lshl_add_u32 v72, v70, 4, v72
    s_lshl_b32 s53, s2, 11
    s_lshl_b32 s54, s3, 6
    s_add_u32 s53, s53, s54
    v_add_u32 v4, s53, v72
    s_barrier
    ds_write_b64 v17, v[24:25] offset:0
    ds_write_b64 v17, v[26:27] offset:20608
    ds_write_b64 v17, v[28:29] offset:41216
    ds_write_b64 v17, v[30:31] offset:61824
    ds_write_b64 v18, v[32:33] offset:0
    ds_write_b64 v18, v[34:35] offset:20608
    ds_write_b64 v18, v[36:37] offset:41216
    ds_write_b64 v18, v[38:39] offset:61824
    ds_write_b64 v19, v[40:41] offset:0
    ds_write_b64 v19, v[42:43] offset:20608
    ds_write_b64 v19, v[44:45] offset:41216
    ds_write_b64 v19, v[46:47] offset:61824
    ds_write_b64 v20, v[48:49] offset:0
    ds_write_b64 v20, v[50:51] offset:20608
    ds_write_b64 v20, v[52:53] offset:41216
    ds_write_b64 v20, v[54:55] offset:61824
    ds_write_b64 v21, v[56:57] offset:0
    ds_write_b64 v21, v[58:59] offset:20608
    ds_write_b64 v21, v[60:61] offset:41216
    ds_write_b64 v21, v[62:63] offset:61824
    s_waitcnt lgkmcnt(0)
    s_barrier
    ds_read_b64_tr_b16 v[16:17], v2 offset:0
    ds_read_b64_tr_b16 v[18:19], v2 offset:1288
    ds_read_b64_tr_b16 v[20:21], v2 offset:5152
    ds_read_b64_tr_b16 v[22:23], v2 offset:6440
    ds_read_b64_tr_b16 v[24:25], v2 offset:10304
    ds_read_b64_tr_b16 v[26:27], v2 offset:11592
    ds_read_b64_tr_b16 v[28:29], v2 offset:15456
    ds_read_b64_tr_b16 v[30:31], v2 offset:16744
    s_waitcnt vmcnt(0)
    ds_read_b64_tr_b16 v[32:33], v2 offset:20608
    ds_read_b64_tr_b16 v[34:35], v2 offset:21896
    ds_read_b64_tr_b16 v[36:37], v2 offset:25760
    ds_read_b64_tr_b16 v[38:39], v2 offset:27048
    ds_read_b64_tr_b16 v[40:41], v2 offset:30912
    ds_read_b64_tr_b16 v[42:43], v2 offset:32200
    ds_read_b64_tr_b16 v[44:45], v2 offset:36064
    ds_read_b64_tr_b16 v[46:47], v2 offset:37352
    s_waitcnt lgkmcnt(8)
    v_mfma_f32_32x32x16_bf16 v[48:63], a[32:35], v[16:19], 0
    v_mfma_f32_32x32x16_bf16 v[48:63], a[36:39], v[20:23], v[48:63]
    v_mfma_f32_32x32x16_bf16 v[48:63], a[40:43], v[24:27], v[48:63]
    v_mfma_f32_32x32x16_bf16 v[48:63], a[44:47], v[28:31], v[48:63]
    ds_read_b64_tr_b16 v[16:17], v3 offset:0
    ds_read_b64_tr_b16 v[18:19], v3 offset:1288
    ds_read_b64_tr_b16 v[20:21], v3 offset:5152
    ds_read_b64_tr_b16 v[22:23], v3 offset:6440
    ds_read_b64_tr_b16 v[24:25], v3 offset:10304
    ds_read_b64_tr_b16 v[26:27], v3 offset:11592
    ds_read_b64_tr_b16 v[28:29], v3 offset:15456
    ds_read_b64_tr_b16 v[30:31], v3 offset:16744
    s_waitcnt lgkmcnt(8)
    v_mfma_f32_32x32x16_bf16 v[48:63], a[48:51], v[32:35], v[48:63]
    v_mfma_f32_32x32x16_bf16 v[48:63], a[52:55], v[36:39], v[48:63]
    v_mfma_f32_32x32x16_bf16 v[48:63], a[56:59], v[40:43], v[48:63]
    v_mfma_f32_32x32x16_bf16 v[48:63], a[60:63], v[44:47], v[48:63]
    ds_read_b64_tr_b16 v[32:33], v3 offset:20608
    ds_read_b64_tr_b16 v[34:35], v3 offset:21896
    ds_read_b64_tr_b16 v[36:37], v3 offset:25760
    ds_read_b64_tr_b16 v[38:39], v3 offset:27048
    ds_read_b64_tr_b16 v[40:41], v3 offset:30912
    ds_read_b64_tr_b16 v[42:43], v3 offset:32200
    ds_read_b64_tr_b16 v[44:45], v3 offset:36064
    ds_read_b64_tr_b16 v[46:47], v3 offset:37352
    s_waitcnt lgkmcnt(8)
    v_mfma_f32_32x32x16_bf16 v[48:63], a[64:67], v[16:19], v[48:63]
    v_mfma_f32_32x32x16_bf16 v[48:63], a[68:71], v[20:23], v[48:63]
    v_mfma_f32_32x32x16_bf16 v[48:63], a[72:75], v[24:27], v[48:63]
    v_mfma_f32_32x32x16_bf16 v[48:63], a[76:79], v[28:31], v[48:63]
    ds_read_b64_tr_b16 v[16:17], v2 offset:64
    ds_read_b64_tr_b16 v[18:19], v2 offset:1352
    ds_read_b64_tr_b16 v[20:21], v2 offset:5216
    ds_read_b64_tr_b16 v[22:23], v2 offset:6504
    ds_read_b64_tr_b16 v[24:25], v2 offset:10368
    ds_read_b64_tr_b16 v[26:27], v2 offset:11656
    ds_read_b64_tr_b16 v[28:29], v2 offset:15520
    ds_read_b64_tr_b16 v[30:31], v2 offset:16808
    s_waitcnt lgkmcnt(8)
    v_mfma_f32_32x32x16_bf16 v[48:63], a[80:83], v[32:35], v[48:63]
    v_mfma_f32_32x32x16_bf16 v[48:63], a[84:87], v[36:39], v[48:63]
    v_mfma_f32_32x32x16_bf16 v[48:63], a[88:91], v[40:43], v[48:63]
    v_mfma_f32_32x32x16_bf16 v[48:63], a[92:95], v[44:47], v[48:63]
    ds_read_b64_tr_b16 v[32:33], v2 offset:20672
    ds_read_b64_tr_b16 v[34:35], v2 offset:21960
    ds_read_b64_tr_b16 v[36:37], v2 offset:25824
    ds_read_b64_tr_b16 v[38:39], v2 offset:27112
    ds_read_b64_tr_b16 v[40:41], v2 offset:30976
    ds_read_b64_tr_b16 v[42:43], v2 offset:32264
    ds_read_b64_tr_b16 v[44:45], v2 offset:36128
    ds_read_b64_tr_b16 v[46:47], v2 offset:37416
    s_waitcnt lgkmcnt(8)
    v_mfma_f32_32x32x16_bf16 v[64:79], a[32:35], v[16:19], 0
    v_mfma_f32_32x32x16_bf16 v[64:79], a[36:39], v[20:23], v[64:79]
    v_mfma_f32_32x32x16_bf16 v[64:79], a[40:43], v[24:27], v[64:79]
    v_mfma_f32_32x32x16_bf16 v[64:79], a[44:47], v[28:31], v[64:79]
    v_cvt_pk_bf16_f32 v80, v48, v49
    v_cvt_pk_bf16_f32 v81, v50, v51
    v_cvt_pk_bf16_f32 v82, v52, v53
    v_cvt_pk_bf16_f32 v83, v54, v55
    v_cvt_pk_bf16_f32 v84, v56, v57
    v_cvt_pk_bf16_f32 v85, v58, v59
    v_cvt_pk_bf16_f32 v86, v60, v61
    v_cvt_pk_bf16_f32 v87, v62, v63
    s_nop 1
    v_permlane32_swap_b32 v80, v82
    v_permlane32_swap_b32 v81, v83
    v_permlane32_swap_b32 v84, v86
    v_permlane32_swap_b32 v85, v87
    buffer_store_dwordx4 v[80:83], v4, s[28:31], 0 offen
    buffer_store_dwordx4 v[84:87], v4, s[28:31], 0 offen offset:32
    v_add_u32 v4, 4194304, v4
    ds_read_b64_tr_b16 v[16:17], v3 offset:64
    ds_read_b64_tr_b16 v[18:19], v3 offset:1352
    ds_read_b64_tr_b16 v[20:21], v3 offset:5216
    ds_read_b64_tr_b16 v[22:23], v3 offset:6504
    ds_read_b64_tr_b16 v[24:25], v3 offset:10368
    ds_read_b64_tr_b16 v[26:27], v3 offset:11656
    ds_read_b64_tr_b16 v[28:29], v3 offset:15520
    ds_read_b64_tr_b16 v[30:31], v3 offset:16808
    s_waitcnt lgkmcnt(8)
    v_mfma_f32_32x32x16_bf16 v[64:79], a[48:51], v[32:35], v[64:79]
    v_mfma_f32_32x32x16_bf16 v[64:79], a[52:55], v[36:39], v[64:79]
    v_mfma_f32_32x32x16_bf16 v[64:79], a[56:59], v[40:43], v[64:79]
    v_mfma_f32_32x32x16_bf16 v[64:79], a[60:63], v[44:47], v[64:79]
    ds_read_b64_tr_b16 v[32:33], v3 offset:20672
    ds_read_b64_tr_b16 v[34:35], v3 offset:21960
    ds_read_b64_tr_b16 v[36:37], v3 offset:25824
    ds_read_b64_tr_b16 v[38:39], v3 offset:27112
    ds_read_b64_tr_b16 v[40:41], v3 offset:30976
    ds_read_b64_tr_b16 v[42:43], v3 offset:32264
    ds_read_b64_tr_b16 v[44:45], v3 offset:36128
    ds_read_b64_tr_b16 v[46:47], v3 offset:37416
    s_waitcnt lgkmcnt(8)
    v_mfma_f32_32x32x16_bf16 v[64:79], a[64:67], v[16:19], v[64:79]
    v_mfma_f32_32x32x16_bf16 v[64:79], a[68:71], v[20:23], v[64:79]
    v_mfma_f32_32x32x16_bf16 v[64:79], a[72:75], v[24:27], v[64:79]
    v_mfma_f32_32x32x16_bf16 v[64:79], a[76:79], v[28:31], v[64:79]
    ds_read_b64_tr_b16 v[16:17], v2 offset:128
    ds_read_b64_tr_b16 v[18:19], v2 offset:1416
    ds_read_b64_tr_b16 v[20:21], v2 offset:5280
    ds_read_b64_tr_b16 v[22:23], v2 offset:6568
    ds_read_b64_tr_b16 v[24:25], v2 offset:10432
    ds_read_b64_tr_b16 v[26:27], v2 offset:11720
    ds_read_b64_tr_b16 v[28:29], v2 offset:15584
    ds_read_b64_tr_b16 v[30:31], v2 offset:16872
    s_waitcnt lgkmcnt(8)
    v_mfma_f32_32x32x16_bf16 v[64:79], a[80:83], v[32:35], v[64:79]
    v_mfma_f32_32x32x16_bf16 v[64:79], a[84:87], v[36:39], v[64:79]
    v_mfma_f32_32x32x16_bf16 v[64:79], a[88:91], v[40:43], v[64:79]
    v_mfma_f32_32x32x16_bf16 v[64:79], a[92:95], v[44:47], v[64:79]
    ds_read_b64_tr_b16 v[32:33], v2 offset:20736
    ds_read_b64_tr_b16 v[34:35], v2 offset:22024
    ds_read_b64_tr_b16 v[36:37], v2 offset:25888
    ds_read_b64_tr_b16 v[38:39], v2 offset:27176
    ds_read_b64_tr_b16 v[40:41], v2 offset:31040
    ds_read_b64_tr_b16 v[42:43], v2 offset:32328
    ds_read_b64_tr_b16 v[44:45], v2 offset:36192
    ds_read_b64_tr_b16 v[46:47], v2 offset:37480
    s_waitcnt lgkmcnt(8)
    v_mfma_f32_32x32x16_bf16 v[48:63], a[32:35], v[16:19], 0
    v_mfma_f32_32x32x16_bf16 v[48:63], a[36:39], v[20:23], v[48:63]
    v_mfma_f32_32x32x16_bf16 v[48:63], a[40:43], v[24:27], v[48:63]
    v_mfma_f32_32x32x16_bf16 v[48:63], a[44:47], v[28:31], v[48:63]
    v_cvt_pk_bf16_f32 v88, v64, v65
    v_cvt_pk_bf16_f32 v89, v66, v67
    v_cvt_pk_bf16_f32 v90, v68, v69
    v_cvt_pk_bf16_f32 v91, v70, v71
    v_cvt_pk_bf16_f32 v92, v72, v73
    v_cvt_pk_bf16_f32 v93, v74, v75
    v_cvt_pk_bf16_f32 v94, v76, v77
    v_cvt_pk_bf16_f32 v95, v78, v79
    s_nop 1
    v_permlane32_swap_b32 v88, v90
    v_permlane32_swap_b32 v89, v91
    v_permlane32_swap_b32 v92, v94
    v_permlane32_swap_b32 v93, v95
    buffer_store_dwordx4 v[88:91], v4, s[28:31], 0 offen
    buffer_store_dwordx4 v[92:95], v4, s[28:31], 0 offen offset:32
    v_add_u32 v4, 4194304, v4
    ds_read_b64_tr_b16 v[16:17], v3 offset:128
    ds_read_b64_tr_b16 v[18:19], v3 offset:1416
    ds_read_b64_tr_b16 v[20:21], v3 offset:5280
    ds_read_b64_tr_b16 v[22:23], v3 offset:6568
    ds_read_b64_tr_b16 v[24:25], v3 offset:10432
    ds_read_b64_tr_b16 v[26:27], v3 offset:11720
    ds_read_b64_tr_b16 v[28:29], v3 offset:15584
    ds_read_b64_tr_b16 v[30:31], v3 offset:16872
    s_waitcnt lgkmcnt(8)
    v_mfma_f32_32x32x16_bf16 v[48:63], a[48:51], v[32:35], v[48:63]
    v_mfma_f32_32x32x16_bf16 v[48:63], a[52:55], v[36:39], v[48:63]
    v_mfma_f32_32x32x16_bf16 v[48:63], a[56:59], v[40:43], v[48:63]
    v_mfma_f32_32x32x16_bf16 v[48:63], a[60:63], v[44:47], v[48:63]
    ds_read_b64_tr_b16 v[32:33], v3 offset:20736
    ds_read_b64_tr_b16 v[34:35], v3 offset:22024
    ds_read_b64_tr_b16 v[36:37], v3 offset:25888
    ds_read_b64_tr_b16 v[38:39], v3 offset:27176
    ds_read_b64_tr_b16 v[40:41], v3 offset:31040
    ds_read_b64_tr_b16 v[42:43], v3 offset:32328
    ds_read_b64_tr_b16 v[44:45], v3 offset:36192
    ds_read_b64_tr_b16 v[46:47], v3 offset:37480
    s_waitcnt lgkmcnt(8)
    v_mfma_f32_32x32x16_bf16 v[48:63], a[64:67], v[16:19], v[48:63]
    v_mfma_f32_32x32x16_bf16 v[48:63], a[68:71], v[20:23], v[48:63]
    v_mfma_f32_32x32x16_bf16 v[48:63], a[72:75], v[24:27], v[48:63]
    v_mfma_f32_32x32x16_bf16 v[48:63], a[76:79], v[28:31], v[48:63]
    ds_read_b64_tr_b16 v[16:17], v2 offset:192
    ds_read_b64_tr_b16 v[18:19], v2 offset:1480
    ds_read_b64_tr_b16 v[20:21], v2 offset:5344
    ds_read_b64_tr_b16 v[22:23], v2 offset:6632
    ds_read_b64_tr_b16 v[24:25], v2 offset:10496
    ds_read_b64_tr_b16 v[26:27], v2 offset:11784
    ds_read_b64_tr_b16 v[28:29], v2 offset:15648
    ds_read_b64_tr_b16 v[30:31], v2 offset:16936
    s_waitcnt lgkmcnt(8)
    v_mfma_f32_32x32x16_bf16 v[48:63], a[80:83], v[32:35], v[48:63]
    v_mfma_f32_32x32x16_bf16 v[48:63], a[84:87], v[36:39], v[48:63]
    v_mfma_f32_32x32x16_bf16 v[48:63], a[88:91], v[40:43], v[48:63]
    v_mfma_f32_32x32x16_bf16 v[48:63], a[92:95], v[44:47], v[48:63]
    ds_read_b64_tr_b16 v[32:33], v2 offset:20800
    ds_read_b64_tr_b16 v[34:35], v2 offset:22088
    ds_read_b64_tr_b16 v[36:37], v2 offset:25952
    ds_read_b64_tr_b16 v[38:39], v2 offset:27240
    ds_read_b64_tr_b16 v[40:41], v2 offset:31104
    ds_read_b64_tr_b16 v[42:43], v2 offset:32392
    ds_read_b64_tr_b16 v[44:45], v2 offset:36256
    ds_read_b64_tr_b16 v[46:47], v2 offset:37544
    s_waitcnt lgkmcnt(8)
    v_mfma_f32_32x32x16_bf16 v[64:79], a[32:35], v[16:19], 0
    v_mfma_f32_32x32x16_bf16 v[64:79], a[36:39], v[20:23], v[64:79]
    v_mfma_f32_32x32x16_bf16 v[64:79], a[40:43], v[24:27], v[64:79]
    v_mfma_f32_32x32x16_bf16 v[64:79], a[44:47], v[28:31], v[64:79]
    v_cvt_pk_bf16_f32 v80, v48, v49
    v_cvt_pk_bf16_f32 v81, v50, v51
    v_cvt_pk_bf16_f32 v82, v52, v53
    v_cvt_pk_bf16_f32 v83, v54, v55
    v_cvt_pk_bf16_f32 v84, v56, v57
    v_cvt_pk_bf16_f32 v85, v58, v59
    v_cvt_pk_bf16_f32 v86, v60, v61
    v_cvt_pk_bf16_f32 v87, v62, v63
    s_nop 1
    v_permlane32_swap_b32 v80, v82
    v_permlane32_swap_b32 v81, v83
    v_permlane32_swap_b32 v84, v86
    v_permlane32_swap_b32 v85, v87
    buffer_store_dwordx4 v[80:83], v4, s[28:31], 0 offen
    buffer_store_dwordx4 v[84:87], v4, s[28:31], 0 offen offset:32
    v_add_u32 v4, 4194304, v4
    ds_read_b64_tr_b16 v[16:17], v3 offset:192
    ds_read_b64_tr_b16 v[18:19], v3 offset:1480
    ds_read_b64_tr_b16 v[20:21], v3 offset:5344
    ds_read_b64_tr_b16 v[22:23], v3 offset:6632
    ds_read_b64_tr_b16 v[24:25], v3 offset:10496
    ds_read_b64_tr_b16 v[26:27], v3 offset:11784
    ds_read_b64_tr_b16 v[28:29], v3 offset:15648
    ds_read_b64_tr_b16 v[30:31], v3 offset:16936
    s_waitcnt lgkmcnt(8)
    v_mfma_f32_32x32x16_bf16 v[64:79], a[48:51], v[32:35], v[64:79]
    v_mfma_f32_32x32x16_bf16 v[64:79], a[52:55], v[36:39], v[64:79]
    v_mfma_f32_32x32x16_bf16 v[64:79], a[56:59], v[40:43], v[64:79]
    v_mfma_f32_32x32x16_bf16 v[64:79], a[60:63], v[44:47], v[64:79]
    ds_read_b64_tr_b16 v[32:33], v3 offset:20800
    ds_read_b64_tr_b16 v[34:35], v3 offset:22088
    ds_read_b64_tr_b16 v[36:37], v3 offset:25952
    ds_read_b64_tr_b16 v[38:39], v3 offset:27240
    ds_read_b64_tr_b16 v[40:41], v3 offset:31104
    ds_read_b64_tr_b16 v[42:43], v3 offset:32392
    ds_read_b64_tr_b16 v[44:45], v3 offset:36256
    ds_read_b64_tr_b16 v[46:47], v3 offset:37544
    s_waitcnt lgkmcnt(8)
    v_mfma_f32_32x32x16_bf16 v[64:79], a[64:67], v[16:19], v[64:79]
    v_mfma_f32_32x32x16_bf16 v[64:79], a[68:71], v[20:23], v[64:79]
    v_mfma_f32_32x32x16_bf16 v[64:79], a[72:75], v[24:27], v[64:79]
    v_mfma_f32_32x32x16_bf16 v[64:79], a[76:79], v[28:31], v[64:79]
    ds_read_b64_tr_b16 v[16:17], v2 offset:256
    ds_read_b64_tr_b16 v[18:19], v2 offset:1544
    ds_read_b64_tr_b16 v[20:21], v2 offset:5408
    ds_read_b64_tr_b16 v[22:23], v2 offset:6696
    ds_read_b64_tr_b16 v[24:25], v2 offset:10560
    ds_read_b64_tr_b16 v[26:27], v2 offset:11848
    ds_read_b64_tr_b16 v[28:29], v2 offset:15712
    ds_read_b64_tr_b16 v[30:31], v2 offset:17000
    s_waitcnt lgkmcnt(8)
    v_mfma_f32_32x32x16_bf16 v[64:79], a[80:83], v[32:35], v[64:79]
    v_mfma_f32_32x32x16_bf16 v[64:79], a[84:87], v[36:39], v[64:79]
    v_mfma_f32_32x32x16_bf16 v[64:79], a[88:91], v[40:43], v[64:79]
    v_mfma_f32_32x32x16_bf16 v[64:79], a[92:95], v[44:47], v[64:79]
    ds_read_b64_tr_b16 v[32:33], v2 offset:20864
    ds_read_b64_tr_b16 v[34:35], v2 offset:22152
    ds_read_b64_tr_b16 v[36:37], v2 offset:26016
    ds_read_b64_tr_b16 v[38:39], v2 offset:27304
    ds_read_b64_tr_b16 v[40:41], v2 offset:31168
    ds_read_b64_tr_b16 v[42:43], v2 offset:32456
    ds_read_b64_tr_b16 v[44:45], v2 offset:36320
    ds_read_b64_tr_b16 v[46:47], v2 offset:37608
    s_waitcnt lgkmcnt(8)
    v_mfma_f32_32x32x16_bf16 v[48:63], a[32:35], v[16:19], 0
    v_mfma_f32_32x32x16_bf16 v[48:63], a[36:39], v[20:23], v[48:63]
    v_mfma_f32_32x32x16_bf16 v[48:63], a[40:43], v[24:27], v[48:63]
    v_mfma_f32_32x32x16_bf16 v[48:63], a[44:47], v[28:31], v[48:63]
    v_cvt_pk_bf16_f32 v88, v64, v65
    v_cvt_pk_bf16_f32 v89, v66, v67
    v_cvt_pk_bf16_f32 v90, v68, v69
    v_cvt_pk_bf16_f32 v91, v70, v71
    v_cvt_pk_bf16_f32 v92, v72, v73
    v_cvt_pk_bf16_f32 v93, v74, v75
    v_cvt_pk_bf16_f32 v94, v76, v77
    v_cvt_pk_bf16_f32 v95, v78, v79
    s_nop 1
    v_permlane32_swap_b32 v88, v90
    v_permlane32_swap_b32 v89, v91
    v_permlane32_swap_b32 v92, v94
    v_permlane32_swap_b32 v93, v95
    buffer_store_dwordx4 v[88:91], v4, s[28:31], 0 offen
    buffer_store_dwordx4 v[92:95], v4, s[28:31], 0 offen offset:32
    v_add_u32 v4, 4194304, v4
    ds_read_b64_tr_b16 v[16:17], v3 offset:256
    ds_read_b64_tr_b16 v[18:19], v3 offset:1544
    ds_read_b64_tr_b16 v[20:21], v3 offset:5408
    ds_read_b64_tr_b16 v[22:23], v3 offset:6696
    ds_read_b64_tr_b16 v[24:25], v3 offset:10560
    ds_read_b64_tr_b16 v[26:27], v3 offset:11848
    ds_read_b64_tr_b16 v[28:29], v3 offset:15712
    ds_read_b64_tr_b16 v[30:31], v3 offset:17000
    s_waitcnt lgkmcnt(8)
    v_mfma_f32_32x32x16_bf16 v[48:63], a[48:51], v[32:35], v[48:63]
    v_mfma_f32_32x32x16_bf16 v[48:63], a[52:55], v[36:39], v[48:63]
    v_mfma_f32_32x32x16_bf16 v[48:63], a[56:59], v[40:43], v[48:63]
    v_mfma_f32_32x32x16_bf16 v[48:63], a[60:63], v[44:47], v[48:63]
    ds_read_b64_tr_b16 v[32:33], v3 offset:20864
    ds_read_b64_tr_b16 v[34:35], v3 offset:22152
    ds_read_b64_tr_b16 v[36:37], v3 offset:26016
    ds_read_b64_tr_b16 v[38:39], v3 offset:27304
    ds_read_b64_tr_b16 v[40:41], v3 offset:31168
    ds_read_b64_tr_b16 v[42:43], v3 offset:32456
    ds_read_b64_tr_b16 v[44:45], v3 offset:36320
    ds_read_b64_tr_b16 v[46:47], v3 offset:37608
    s_waitcnt lgkmcnt(8)
    v_mfma_f32_32x32x16_bf16 v[48:63], a[64:67], v[16:19], v[48:63]
    v_mfma_f32_32x32x16_bf16 v[48:63], a[68:71], v[20:23], v[48:63]
    v_mfma_f32_32x32x16_bf16 v[48:63], a[72:75], v[24:27], v[48:63]
    v_mfma_f32_32x32x16_bf16 v[48:63], a[76:79], v[28:31], v[48:63]
    s_waitcnt lgkmcnt(0)
    v_mfma_f32_32x32x16_bf16 v[48:63], a[80:83], v[32:35], v[48:63]
    v_mfma_f32_32x32x16_bf16 v[48:63], a[84:87], v[36:39], v[48:63]
    v_mfma_f32_32x32x16_bf16 v[48:63], a[88:91], v[40:43], v[48:63]
    v_mfma_f32_32x32x16_bf16 v[48:63], a[92:95], v[44:47], v[48:63]
    s_nop 11
    v_cvt_pk_bf16_f32 v80, v48, v49
    v_cvt_pk_bf16_f32 v81, v50, v51
    v_cvt_pk_bf16_f32 v82, v52, v53
    v_cvt_pk_bf16_f32 v83, v54, v55
    v_cvt_pk_bf16_f32 v84, v56, v57
    v_cvt_pk_bf16_f32 v85, v58, v59
    v_cvt_pk_bf16_f32 v86, v60, v61
    v_cvt_pk_bf16_f32 v87, v62, v63
    s_nop 1
    v_permlane32_swap_b32 v80, v82
    v_permlane32_swap_b32 v81, v83
    v_permlane32_swap_b32 v84, v86
    v_permlane32_swap_b32 v85, v87
    buffer_store_dwordx4 v[80:83], v4, s[28:31], 0 offen
    buffer_store_dwordx4 v[84:87], v4, s[28:31], 0 offen offset:32
    v_add_u32 v4, 4194304, v4
L_end:
    s_endpgm
.section .rodata,"a"
.p2align 6
.amdhsa_kernel bin_edges_kernel
  .amdhsa_next_free_vgpr 48
  .amdhsa_next_free_sgpr 40
  .amdhsa_accum_offset 48
  .amdhsa_group_segment_fixed_size 0
  .amdhsa_kernarg_size 88
  .amdhsa_user_sgpr_count 2
  .amdhsa_user_sgpr_kernarg_segment_ptr 1
  .amdhsa_system_sgpr_workgroup_id_x 1
  .amdhsa_float_denorm_mode_32 3
.end_amdhsa_kernel
.section .rodata,"a"
.p2align 6
.amdhsa_kernel standalone__tensor_product_equiv_mace__graph_kernel
  .amdhsa_next_free_vgpr 256
  .amdhsa_next_free_sgpr 102
  .amdhsa_accum_offset 160
  .amdhsa_group_segment_fixed_size 0
  .amdhsa_kernarg_size 88
  .amdhsa_user_sgpr_count 2
  .amdhsa_user_sgpr_kernarg_segment_ptr 1
  .amdhsa_system_sgpr_workgroup_id_x 1
  .amdhsa_float_denorm_mode_32 3
.end_amdhsa_kernel
```

```asm
; @launch kernel=bin_edges_kernel grid=(80,1,1) block=(640,1,1) lds=33792
; @launch kernel=standalone__tensor_product_equiv_mace__graph_kernel grid=(256,1,1) block=(512,1,1) lds=124160
.amdgcn_target "amdgcn-amd-amdhsa--gfx950"
.text
.globl bin_edges_kernel
.p2align 8
.type bin_edges_kernel,@function
bin_edges_kernel:
    s_cmp_ge_u32 s2, 80
    s_cbranch_scc1 K_end
    s_load_dwordx16 s[16:31], s[0:1], 0
    s_load_dwordx2 s[32:33], s[0:1], 80
    s_cmp_ge_u32 s2, 64
    s_cbranch_scc1 K_weights
    s_mul_i32 s3, s2, 10000
    v_lshlrev_b32 v1, 4, v0
    v_add_u32 v2, s3, v1
    s_mov_b32 s14, 625
    v_cmp_gt_u32 s[34:35], s14, v0
    s_waitcnt lgkmcnt(0)
    s_mov_b32 s4, s20
    s_mov_b32 s5, s21
    s_mov_b32 s6, 640000
    s_mov_b32 s7, 0x00020000
    buffer_load_dwordx4 v[4:7], v2, s[4:7], 0 offen
    s_mov_b32 s8, s18
    s_mov_b32 s9, s19
    s_mov_b32 s10, 640000
    s_mov_b32 s11, 0x00020000
    buffer_load_dwordx4 v[8:11], v2, s[8:11], 0 offen
    s_mov_b32 s12, s32
    s_mov_b32 s13, s33
    s_mov_b32 s14, 8388608
    s_mov_b32 s15, 0x00020000
    v_mov_b32 v12, -1
    v_mov_b32 v13, -1
    v_mov_b32 v14, -1
    v_mov_b32 v15, -1
    ds_write_b128 v1, v[12:15]
    ds_write_b128 v1, v[12:15] offset:10240
    ds_write_b128 v1, v[12:15] offset:20480
    v_cmp_gt_u32 vcc, 128, v0
    v_mov_b32 v16, 0
    v_mov_b32 v17, 0
    v_lshlrev_b32 v3, 3, v0
    s_mov_b64 exec, vcc
    ds_write_b128 v1, v[12:15] offset:30720
    ds_write_b64 v3, v[16:17] offset:32768
    s_mov_b64 exec, -1
    v_mov_b32 v18, 1
    v_lshlrev_b32 v19, 22, v0
    v_lshrrev_b32 v2, 3, v0
    v_lshlrev_b32 v2, 13, v2
    v_and_b32 v3, 7, v0
    v_lshl_add_u32 v2, v3, 4, v2
    s_lshl_b32 s3, s2, 7
    v_add_u32 v2, s3, v2
    s_waitcnt lgkmcnt(0)
    s_barrier
    s_waitcnt vmcnt(1)
    v_and_b32 v20, 255, v4
    v_lshlrev_b32 v24, 2, v20
    v_and_b32 v21, 255, v5
    v_lshlrev_b32 v25, 2, v21
    v_and_b32 v22, 255, v6
    v_lshlrev_b32 v26, 2, v22
    v_and_b32 v23, 255, v7
    v_lshlrev_b32 v27, 2, v23
    s_mov_b64 exec, s[34:35]
    ds_add_rtn_u32 v28, v24, v18 offset:32768
    ds_add_rtn_u32 v29, v25, v18 offset:32768
    ds_add_rtn_u32 v30, v26, v18 offset:32768
    ds_add_rtn_u32 v31, v27, v18 offset:32768
    s_mov_b64 exec, -1
    s_waitcnt vmcnt(0)
    v_bfe_u32 v4, v4, 8, 6
    v_min_u32 v4, 47, v4
    v_and_b32 v8, 0x3fff, v8
    v_lshl_or_b32 v4, v8, 6, v4
    v_add_u32 v8, 0, v19
    v_or_b32 v4, v4, v8
    v_bfe_u32 v5, v5, 8, 6
    v_min_u32 v5, 47, v5
    v_and_b32 v9, 0x3fff, v9
    v_lshl_or_b32 v5, v9, 6, v5
    v_add_u32 v9, 1048576, v19
    v_or_b32 v5, v5, v9
    v_bfe_u32 v6, v6, 8, 6
    v_min_u32 v6, 47, v6
    v_and_b32 v10, 0x3fff, v10
    v_lshl_or_b32 v6, v10, 6, v6
    v_add_u32 v10, 2097152, v19
    v_or_b32 v6, v6, v10
    v_bfe_u32 v7, v7, 8, 6
    v_min_u32 v7, 47, v7
    v_and_b32 v11, 0x3fff, v11
    v_lshl_or_b32 v7, v11, 6, v7
    v_add_u32 v11, 3145728, v19
    v_or_b32 v7, v7, v11
    v_mov_b32 v12, -2
    s_waitcnt lgkmcnt(0)
    v_cmp_gt_u32 vcc, 31, v28
    v_min_u32 v28, 31, v28
    v_lshlrev_b32 v28, 2, v28
    v_cndmask_b32 v4, v12, v4, vcc
    v_lshl_add_u32 v28, v20, 7, v28
    v_cmp_gt_u32 vcc, 31, v29
    v_min_u32 v29, 31, v29
    v_lshlrev_b32 v29, 2, v29
    v_cndmask_b32 v5, v12, v5, vcc
    v_lshl_add_u32 v29, v21, 7, v29
    v_cmp_gt_u32 vcc, 31, v30
    v_min_u32 v30, 31, v30
    v_lshlrev_b32 v30, 2, v30
    v_cndmask_b32 v6, v12, v6, vcc
    v_lshl_add_u32 v30, v22, 7, v30
    v_cmp_gt_u32 vcc, 31, v31
    v_min_u32 v31, 31, v31
    v_lshlrev_b32 v31, 2, v31
    v_cndmask_b32 v7, v12, v7, vcc
    v_lshl_add_u32 v31, v23, 7, v31
    s_mov_b64 exec, s[34:35]
    ds_write_b32 v28, v4
    ds_write_b32 v29, v5
    ds_write_b32 v30, v6
    ds_write_b32 v31, v7
    s_mov_b64 exec, -1
    v_cmp_gt_u32 vcc, 128, v0
    s_waitcnt lgkmcnt(0)
    s_barrier
    ds_read_b128 v[32:35], v1 offset:0
    ds_read_b128 v[36:39], v1 offset:10240
    ds_read_b128 v[40:43], v1 offset:20480
    ds_read_b128 v[44:47], v1 offset:30720
    s_waitcnt lgkmcnt(3)
    buffer_store_dwordx4 v[32:35], v2, s[12:15], 0 offen
    v_add_u32 v2, 655360, v2
    s_waitcnt lgkmcnt(2)
    buffer_store_dwordx4 v[36:39], v2, s[12:15], 0 offen
    v_add_u32 v2, 655360, v2
    s_waitcnt lgkmcnt(1)
    buffer_store_dwordx4 v[40:43], v2, s[12:15], 0 offen
    v_add_u32 v2, 655360, v2
    s_and_saveexec_b64 s[36:37], vcc
    s_cbranch_execz K_end
    s_waitcnt lgkmcnt(0)
    buffer_store_dwordx4 v[44:47], v2, s[12:15], 0 offen
    s_branch K_end
K_weights:
    v_lshrrev_b32 v1, 6, v0
    v_and_b32 v2, 63, v0
    v_readfirstlane_b32 s3, v1
    s_sub_u32 s34, s2, 64
    s_mul_i32 s34, s34, 10
    s_add_u32 s3, s3, s34
    s_cmp_ge_u32 s3, 137
    s_cbranch_scc1 K_end
    s_waitcnt lgkmcnt(0)
    s_mov_b32 s12, s32
    s_mov_b32 s13, s33
    s_mov_b32 s14, 8388608
    s_mov_b32 s15, 0x00020000
    s_lshl_b32 s34, s3, 10
    s_add_u32 s34, s34, 2097152
    v_lshlrev_b32 v3, 4, v2
    v_add_u32 v3, s34, v3
    s_cmp_ge_u32 s3, 136
    s_cbranch_scc1 K_cg
    s_cmp_ge_u32 s3, 128
    s_cbranch_scc1 K_wr
    s_mov_b32 s4, s30
    s_mov_b32 s5, s31
    s_mov_b32 s6, 131072
    s_mov_b32 s7, 0x00020000
    s_and_b32 s34, s3, 15
    s_lshl_b32 s34, s34, 13
    s_lshr_b32 s35, s3, 4
    s_lshl_b32 s35, s35, 6
    s_add_u32 s34, s34, s35
    v_lshrrev_b32 v4, 5, v2
    v_lshlrev_b32 v4, 12, v4
    v_and_b32 v5, 31, v2
    v_lshl_add_u32 v4, v5, 1, v4
    v_add_u32 v4, s34, v4
    s_branch K_wgo
K_wr:
    s_mov_b32 s4, s28
    s_mov_b32 s5, s29
    s_mov_b32 s6, 8192
    s_mov_b32 s7, 0x00020000
    s_sub_u32 s34, s3, 128
    s_lshl_b32 s34, s34, 6
    v_bfe_u32 v4, v2, 4, 1
    v_lshlrev_b32 v4, 12, v4
    v_lshrrev_b32 v5, 5, v2
    v_lshl_add_u32 v4, v5, 5, v4
    v_and_b32 v5, 15, v2
    v_lshl_add_u32 v4, v5, 1, v4
    v_add_u32 v4, s34, v4
K_wgo:
    buffer_load_ushort v16, v4, s[4:7], 0 offen offset:0
    buffer_load_ushort v17, v4, s[4:7], 0 offen offset:512
    buffer_load_ushort v18, v4, s[4:7], 0 offen offset:1024
    buffer_load_ushort v19, v4, s[4:7], 0 offen offset:1536
    buffer_load_ushort v20, v4, s[4:7], 0 offen offset:2048
    buffer_load_ushort v21, v4, s[4:7], 0 offen offset:2560
    buffer_load_ushort v22, v4, s[4:7], 0 offen offset:3072
    buffer_load_ushort v23, v4, s[4:7], 0 offen offset:3584
    s_branch K_wst
K_cg:
    s_mov_b32 s4, s26
    s_mov_b32 s5, s27
    s_mov_b32 s6, 128
    s_mov_b32 s7, 0x00020000
    v_and_b32 v4, 3, v2
    v_lshlrev_b32 v4, 5, v4
    v_lshrrev_b32 v5, 4, v2
    v_lshl_add_u32 v4, v5, 1, v4
    buffer_load_ushort v16, v4, s[4:7], 0 offen offset:0
    buffer_load_ushort v17, v4, s[4:7], 0 offen offset:8
    buffer_load_ushort v18, v4, s[4:7], 0 offen offset:16
    buffer_load_ushort v19, v4, s[4:7], 0 offen offset:24
    v_lshlrev_b32 v3, 3, v2
    v_add_u32 v3, 2236416, v3
    s_waitcnt vmcnt(0)
    v_lshl_or_b32 v8, v17, 16, v16
    v_lshl_or_b32 v9, v19, 16, v18
    buffer_store_dwordx2 v[8:9], v3, s[12:15], 0 offen
    s_branch K_end
K_wst:
    s_waitcnt vmcnt(0)
    v_lshl_or_b32 v8, v17, 16, v16
    v_lshl_or_b32 v9, v19, 16, v18
    v_lshl_or_b32 v10, v21, 16, v20
    v_lshl_or_b32 v11, v23, 16, v22
    buffer_store_dwordx4 v[8:11], v3, s[12:15], 0 offen
K_end:
    s_endpgm
.globl standalone__tensor_product_equiv_mace__graph_kernel
.p2align 8
.type standalone__tensor_product_equiv_mace__graph_kernel,@function
standalone__tensor_product_equiv_mace__graph_kernel:
    s_cmp_ge_u32 s2, 256
    s_cbranch_scc1 L_end
    s_load_dwordx2 s[84:85], s[0:1], 80
    s_load_dwordx16 s[64:79], s[0:1], 0
    s_load_dwordx2 s[80:81], s[0:1], 64
    v_and_b32 v1, 63, v0
    v_lshrrev_b32 v60, 6, v0
    v_mov_b32 v12, 0
    v_readfirstlane_b32 s3, v60
    s_lshl_b32 s53, s2, 13
    v_lshlrev_b32 v60, 4, v0
    v_add_u32 v60, s53, v60
    v_lshlrev_b32 v64, 4, v1
    v_add_u32 v61, 2228224, v64
    v_add_u32 v62, 2232320, v64
    v_lshlrev_b32 v63, 3, v1
    v_add_u32 v63, 2236416, v63
    s_waitcnt lgkmcnt(0)
    s_mov_b32 s32, s84
    s_mov_b32 s33, s85
    s_mov_b32 s34, 8388608
    s_mov_b32 s35, 0x00020000
    buffer_load_dwordx4 v[16:19], v60, s[32:35], 0 offen
    s_mov_b32 s8, s64
    s_mov_b32 s9, s65
    s_mov_b32 s10, 20480000
    s_mov_b32 s11, 0x00020000
    s_mov_b32 s12, s66
    s_mov_b32 s13, s67
    s_mov_b32 s14, 640000
    s_mov_b32 s15, 0x00020000
    s_mov_b32 s16, s68
    s_mov_b32 s17, s69
    s_mov_b32 s18, 640000
    s_mov_b32 s19, 0x00020000
    s_mov_b32 s20, s70
    s_mov_b32 s21, s71
    s_mov_b32 s22, 1280000
    s_mov_b32 s23, 0x00020000
    s_mov_b32 s24, s72
    s_mov_b32 s25, s73
    s_mov_b32 s26, 5120000
    s_mov_b32 s27, 0x00020000
    s_mov_b32 s28, s80
    s_mov_b32 s29, s81
    s_mov_b32 s30, 20480000
    s_mov_b32 s31, 0x00020000
    buffer_load_dwordx4 a[0:3], v61, s[32:35], 0 offen offset:0
    buffer_load_dwordx4 a[4:7], v61, s[32:35], 0 offen offset:1024
    buffer_load_dwordx4 a[8:11], v61, s[32:35], 0 offen offset:2048
    buffer_load_dwordx4 a[12:15], v61, s[32:35], 0 offen offset:3072
    buffer_load_dwordx4 a[16:19], v62, s[32:35], 0 offen offset:0
    buffer_load_dwordx4 a[20:23], v62, s[32:35], 0 offen offset:1024
    buffer_load_dwordx4 a[24:27], v62, s[32:35], 0 offen offset:2048
    buffer_load_dwordx4 a[28:31], v62, s[32:35], 0 offen offset:3072
    buffer_load_dwordx2 a[32:33], v63, s[32:35], 0 offen
    v_mov_b32 v68, 0
    v_mov_b32 v69, 0
    v_lshlrev_b32 v60, 3, v0
    v_add_u32 v60, 110848, v60
    ds_write_b64 v60, v[68:69]
    v_and_b32 v60, 3, v1
    v_lshlrev_b32 v60, 3, v60
    v_add_u32 v60, 119040, v60
    ds_write_b64 v60, v[68:69]
    s_lshl_b32 s63, s3, 13
    s_mov_b32 s52, 0
    s_mov_b32 s77, 0
    s_mov_b32 s82, 0x3fff00
    s_waitcnt lgkmcnt(0)
    s_barrier
    v_lshrrev_b32 v66, 4, v1
    v_and_b32 v61, 7, v1
    v_bfe_u32 v65, v1, 3, 1
    v_lshlrev_b32 v65, 9, v65
    v_lshl_add_u32 v65, v66, 7, v65
    v_lshl_add_u32 v2, v61, 4, v65
    v_xor_b32 v61, 4, v61
    v_lshl_add_u32 v3, v61, 4, v65
    v_bfe_u32 v60, v1, 2, 2
    v_bfe_u32 v62, v1, 1, 1
    v_lshl_add_u32 v62, v66, 1, v62
    v_lshrrev_b32 v63, 1, v60
    v_lshlrev_b32 v64, 2, v63
    v_xor_b32 v62, v62, v64
    v_and_b32 v64, 1, v60
    v_lshl_add_u32 v62, v64, 3, v62
    v_lshlrev_b32 v62, 4, v62
    v_lshl_add_u32 v62, v63, 10, v62
    v_and_b32 v64, 1, v1
    v_lshl_add_u32 v62, v64, 3, v62
    v_add_u32 v4, s63, v62
    v_lshrrev_b32 v61, 5, v1
    v_mov_b32 v63, 32
    v_cmp_eq_u32 vcc, v60, v61
    v_add_u32 v61, 2, v61
    v_and_b32 v64, 3, v1
    v_cndmask_b32 v7, 0, v63, vcc
    v_cmp_eq_u32 vcc, v60, v61
    v_cmp_eq_u32 s[4:5], v64, v66
    v_mov_b32 v65, 8
    v_cndmask_b32 v8, 0, v63, vcc
    v_cndmask_b32 v10, 0, v65, s[4:5]
    v_lshrrev_b32 v67, 3, v0
    v_mul_u32_u24 v67, 2500, v67
    v_mov_b32 v69, 114624
    v_mov_b64 v[80:81], 0
    v_mov_b64 v[82:83], 0
    v_mov_b64 v[84:85], 0
    v_mov_b64 v[86:87], 0
    v_mov_b64 v[88:89], 0
    v_mov_b64 v[90:91], 0
    v_mov_b64 v[92:93], 0
    v_mov_b64 v[94:95], 0
    v_mov_b64 v[96:97], 0
    v_mov_b64 v[98:99], 0
    v_mov_b64 v[100:101], 0
    v_mov_b64 v[102:103], 0
    v_mov_b64 v[104:105], 0
    v_mov_b64 v[106:107], 0
    v_mov_b64 v[108:109], 0
    v_mov_b64 v[110:111], 0
    v_mov_b64 v[112:113], 0
    v_mov_b64 v[114:115], 0
    v_mov_b64 v[116:117], 0
    v_mov_b64 v[118:119], 0
    v_mov_b64 v[120:121], 0
    v_mov_b64 v[122:123], 0
    v_mov_b64 v[124:125], 0
    v_mov_b64 v[126:127], 0
    v_mov_b64 v[128:129], 0
    v_mov_b64 v[130:131], 0
    v_mov_b64 v[132:133], 0
    v_mov_b64 v[134:135], 0
    v_mov_b64 v[136:137], 0
    v_mov_b64 v[138:139], 0
    v_mov_b64 v[140:141], 0
    v_mov_b64 v[142:143], 0
    v_mov_b64 v[144:145], 0
    v_mov_b64 v[146:147], 0
    v_mov_b64 v[148:149], 0
    v_mov_b64 v[150:151], 0
    v_mov_b64 v[152:153], 0
    v_mov_b64 v[154:155], 0
    v_mov_b64 v[156:157], 0
    v_mov_b64 v[158:159], 0
    s_waitcnt vmcnt(9)
    v_cmp_gt_u32 s[36:37], -2, v16
    v_cmp_gt_u32 s[38:39], -2, v17
    v_cmp_gt_u32 s[40:41], -2, v18
    v_cmp_gt_u32 s[42:43], -2, v19
    v_cmp_eq_u32 vcc, -2, v19
    s_bcnt1_i32_b64 s79, s[36:37]
    s_bcnt1_i32_b64 s53, s[38:39]
    s_add_u32 s79, s79, s53
    s_bcnt1_i32_b64 s53, s[40:41]
    s_add_u32 s79, s79, s53
    s_bcnt1_i32_b64 s53, s[42:43]
    s_add_u32 s79, s79, s53
    v_mov_b32 v70, s79
    s_mov_b64 exec, 1
    ds_add_rtn_u32 v70, v69, v70
    s_mov_b64 exec, -1
    v_mov_b32 v56, 0
    v_mbcnt_lo_u32_b32 v56, s36, v56
    v_mbcnt_hi_u32_b32 v56, s37, v56
    v_mbcnt_lo_u32_b32 v56, s38, v56
    v_mbcnt_hi_u32_b32 v56, s39, v56
    v_mbcnt_lo_u32_b32 v56, s40, v56
    v_mbcnt_hi_u32_b32 v56, s41, v56
    v_mbcnt_lo_u32_b32 v56, s42, v56
    v_mbcnt_hi_u32_b32 v56, s43, v56
    s_add_u32 s53, s63, 4096
    v_lshl_add_u32 v58, v56, 2, s53
    v_lshrrev_b32 v20, 20, v16
    v_add_u32 v20, v20, v67
    s_mov_b64 exec, s[36:37]
    ds_write_b32 v58, v20 offset:0
    s_mov_b64 exec, -1
    v_lshrrev_b32 v21, 20, v17
    v_add_u32 v21, v21, v67
    s_mov_b64 exec, s[38:39]
    ds_write_b32 v58, v21 offset:4
    s_mov_b64 exec, -1
    v_lshrrev_b32 v22, 20, v18
    v_add_u32 v22, v22, v67
    s_mov_b64 exec, s[40:41]
    ds_write_b32 v58, v22 offset:8
    s_mov_b64 exec, -1
    v_lshrrev_b32 v23, 20, v19
    v_add_u32 v23, v23, v67
    s_mov_b64 exec, s[42:43]
    ds_write_b32 v58, v23 offset:12
    s_mov_b64 exec, -1
    v_lshlrev_b32 v24, 2, v16
    v_and_b32 v24, s82, v24
    v_and_b32 v16, 63, v16
    v_lshlrev_b32 v25, 2, v17
    v_and_b32 v25, s82, v25
    v_and_b32 v17, 63, v17
    v_lshlrev_b32 v26, 2, v18
    v_and_b32 v26, s82, v26
    v_and_b32 v18, 63, v18
    v_lshlrev_b32 v27, 2, v19
    v_and_b32 v27, s82, v27
    v_and_b32 v19, 63, v19
    s_mov_b32 s80, 79
    s_waitcnt lgkmcnt(0)
    v_readfirstlane_b32 s44, v70
    s_cbranch_vccnz L_defer
    s_add_u32 s53, s44, s79
    s_cmp_gt_u32 s53, 1024
    s_cbranch_scc1 L_defer
    v_add_u32 v56, s44, v56
    v_lshl_or_b32 v24, v56, 22, v24
    v_add_u32 v56, 1, v56
    v_lshl_or_b32 v25, v56, 22, v25
    v_add_u32 v56, 1, v56
    v_lshl_or_b32 v26, v56, 22, v26
    v_add_u32 v56, 1, v56
    v_lshl_or_b32 v27, v56, 22, v27
    s_branch L_have
L_defer:
    s_mov_b32 s80, 0
    s_mov_b32 s79, 0
    s_mov_b32 s44, 0
    s_mov_b64 s[36:37], 0
    s_mov_b64 s[38:39], 0
    s_mov_b64 s[40:41], 0
    s_mov_b64 s[42:43], 0
    v_mov_b32 v58, 1
    v_mov_b32 v59, 119056
    ds_write_b32 v59, v58
    s_branch L_have
L_scan:
    s_barrier
    s_mov_b32 s64, s63
    s_add_u32 s65, s63, 1024
    s_xor_b32 s47, s2, 1
L_sloop:
    s_cmp_ge_u32 s80, 79
    s_cbranch_scc1 L_scan_done
    s_mul_i32 s53, s3, 20000
    s_lshl_b32 s54, s80, 8
    s_add_u32 s55, s53, s54
    v_lshlrev_b32 v56, 2, v1
    v_add_u32 v56, s55, v56
    v_lshlrev_b32 v57, 2, v56
    buffer_load_dwordx4 v[60:63], v57, s[16:19], 0 offen
    s_waitcnt vmcnt(0)
    s_cmp_lg_u32 s80, 78
    s_cbranch_scc1 L_snotlast
    s_mov_b32 exec_lo, 0xffffff00
    v_mov_b32 v60, s47
    v_mov_b32 v61, s47
    v_mov_b32 v62, s47
    v_mov_b32 v63, s47
    s_mov_b64 exec, -1
L_snotlast:
    s_cmp_gt_u32 s52, 0
    s_cbranch_scc1 L_1
    v_cmp_eq_u32_sdwa vcc, v60, s2 src0_sel:BYTE_0 src1_sel:DWORD
    s_cbranch_vccz L_1
    s_bcnt1_i32_b64 s53, vcc
    s_lshl3_add_u32 s54, s53, s64
    s_mov_b32 s52, 0
    s_cmp_gt_u32 s54, s65
    s_cbranch_scc1 L_ovf
    v_mbcnt_lo_u32_b32 v58, vcc_lo, 0
    v_mbcnt_hi_u32_b32 v58, vcc_hi, v58
    v_lshl_add_u32 v58, v58, 3, s64
    v_add_u32 v59, 0, v56
    s_mov_b64 exec, vcc
    ds_write2_b32 v58, v60, v59 offset0:0 offset1:1
    s_mov_b64 exec, -1
    s_mov_b32 s64, s54
L_1:
    s_cmp_gt_u32 s52, 1
    s_cbranch_scc1 L_2
    v_cmp_eq_u32_sdwa vcc, v61, s2 src0_sel:BYTE_0 src1_sel:DWORD
    s_cbranch_vccz L_2
    s_bcnt1_i32_b64 s53, vcc
    s_lshl3_add_u32 s54, s53, s64
    s_mov_b32 s52, 1
    s_cmp_gt_u32 s54, s65
    s_cbranch_scc1 L_ovf
    v_mbcnt_lo_u32_b32 v58, vcc_lo, 0
    v_mbcnt_hi_u32_b32 v58, vcc_hi, v58
    v_lshl_add_u32 v58, v58, 3, s64
    v_add_u32 v59, 1, v56
    s_mov_b64 exec, vcc
    ds_write2_b32 v58, v61, v59 offset0:0 offset1:1
    s_mov_b64 exec, -1
    s_mov_b32 s64, s54
L_2:
    s_cmp_gt_u32 s52, 2
    s_cbranch_scc1 L_3
    v_cmp_eq_u32_sdwa vcc, v62, s2 src0_sel:BYTE_0 src1_sel:DWORD
    s_cbranch_vccz L_3
    s_bcnt1_i32_b64 s53, vcc
    s_lshl3_add_u32 s54, s53, s64
    s_mov_b32 s52, 2
    s_cmp_gt_u32 s54, s65
    s_cbranch_scc1 L_ovf
    v_mbcnt_lo_u32_b32 v58, vcc_lo, 0
    v_mbcnt_hi_u32_b32 v58, vcc_hi, v58
    v_lshl_add_u32 v58, v58, 3, s64
    v_add_u32 v59, 2, v56
    s_mov_b64 exec, vcc
    ds_write2_b32 v58, v62, v59 offset0:0 offset1:1
    s_mov_b64 exec, -1
    s_mov_b32 s64, s54
L_3:
    s_cmp_gt_u32 s52, 3
    s_cbranch_scc1 L_4
    v_cmp_eq_u32_sdwa vcc, v63, s2 src0_sel:BYTE_0 src1_sel:DWORD
    s_cbranch_vccz L_4
    s_bcnt1_i32_b64 s53, vcc
    s_lshl3_add_u32 s54, s53, s64
    s_mov_b32 s52, 3
    s_cmp_gt_u32 s54, s65
    s_cbranch_scc1 L_ovf
    v_mbcnt_lo_u32_b32 v58, vcc_lo, 0
    v_mbcnt_hi_u32_b32 v58, vcc_hi, v58
    v_lshl_add_u32 v58, v58, 3, s64
    v_add_u32 v59, 3, v56
    s_mov_b64 exec, vcc
    ds_write2_b32 v58, v63, v59 offset0:0 offset1:1
    s_mov_b64 exec, -1
    s_mov_b32 s64, s54
L_4:
    s_mov_b32 s52, 0
    s_add_u32 s80, s80, 1
    s_branch L_sloop
L_ovf:
    v_mov_b32 v58, 1
    v_mov_b32 v59, 119056
    ds_write_b32 v59, v58
L_scan_done:
    s_sub_u32 s79, s64, s63
    s_lshr_b32 s79, s79, 3
    s_lshl_b32 s44, s3, 7
    v_lshlrev_b32 v58, 3, v1
    v_add_u32 v58, s63, v58
    s_waitcnt lgkmcnt(0)
    ds_read_b32 v16, v58 offset:0
    ds_read_b32 v20, v58 offset:4
    s_sub_u32 s53, s79, 0
    v_cmp_gt_i32 s[36:37], s53, v1
    ds_read_b32 v17, v58 offset:512
    ds_read_b32 v21, v58 offset:516
    s_sub_u32 s53, s79, 64
    v_cmp_gt_i32 s[38:39], s53, v1
    s_mov_b64 s[40:41], 0
    v_mov_b32 v18, 0
    v_mov_b32 v26, 0
    s_mov_b64 s[42:43], 0
    v_mov_b32 v19, 0
    v_mov_b32 v27, 0
    v_lshl_add_u32 v58, v1, 2, s63
    v_add_u32 v59, s44, v1
    v_lshlrev_b32 v59, 22, v59
    s_waitcnt lgkmcnt(0)
    v_lshlrev_b32 v28, 2, v20
    buffer_load_dword v24, v28, s[12:15], 0 offen
    v_bfe_u32 v16, v16, 8, 6
    v_min_u32 v16, 47, v16
    ds_write_b32 v58, v20 offset:4096
    v_lshlrev_b32 v29, 2, v21
    buffer_load_dword v25, v29, s[12:15], 0 offen
    v_bfe_u32 v17, v17, 8, 6
    v_min_u32 v17, 47, v17
    ds_write_b32 v58, v21 offset:4352
    s_waitcnt vmcnt(0)
    v_and_b32 v24, 0x3fff, v24
    v_lshl_or_b32 v24, v24, 8, v59
    v_add_u32 v59, 268435456, v59
    v_and_b32 v25, 0x3fff, v25
    v_lshl_or_b32 v25, v25, 8, v59
    v_add_u32 v59, 268435456, v59
L_have:
    v_mov_b32 v58, 1
    s_mov_b32 s53, 110848
    s_mov_b32 s54, 114688
    v_bfe_u32 v28, v24, 8, 14
    v_mul_u32_u24 v28, 6711, v28
    v_lshrrev_b32 v28, 22, v28
    v_min_u32 v28, 15, v28
    v_lshl_add_u32 v28, v28, 2, s53
    v_lshl_add_u32 v28, v16, 6, v28
    v_lshl_add_u32 v16, v16, 2, s54
    s_mov_b64 exec, s[36:37]
    ds_add_rtn_u32 v32, v28, v58
    ds_add_u32 v16, v58
    s_mov_b64 exec, -1
    v_bfe_u32 v29, v25, 8, 14
    v_mul_u32_u24 v29, 6711, v29
    v_lshrrev_b32 v29, 22, v29
    v_min_u32 v29, 15, v29
    v_lshl_add_u32 v29, v29, 2, s53
    v_lshl_add_u32 v29, v17, 6, v29
    v_lshl_add_u32 v17, v17, 2, s54
    s_mov_b64 exec, s[38:39]
    ds_add_rtn_u32 v33, v29, v58
    ds_add_u32 v17, v58
    s_mov_b64 exec, -1
    v_bfe_u32 v30, v26, 8, 14
    v_mul_u32_u24 v30, 6711, v30
    v_lshrrev_b32 v30, 22, v30
    v_min_u32 v30, 15, v30
    v_lshl_add_u32 v30, v30, 2, s53
    v_lshl_add_u32 v30, v18, 6, v30
    v_lshl_add_u32 v18, v18, 2, s54
    s_mov_b64 exec, s[40:41]
    ds_add_rtn_u32 v34, v30, v58
    ds_add_u32 v18, v58
    s_mov_b64 exec, -1
    v_bfe_u32 v31, v27, 8, 14
    v_mul_u32_u24 v31, 6711, v31
    v_lshrrev_b32 v31, 22, v31
    v_min_u32 v31, 15, v31
    v_lshl_add_u32 v31, v31, 2, s53
    v_lshl_add_u32 v31, v19, 6, v31
    v_lshl_add_u32 v19, v19, 2, s54
    s_mov_b64 exec, s[42:43]
    ds_add_rtn_u32 v35, v31, v58
    ds_add_u32 v19, v58
    s_mov_b64 exec, -1
    v_lshrrev_b32 v36, 1, v1
    s_add_u32 s53, s63, 4096
    v_lshl_add_u32 v39, v36, 2, s53
    ds_read_b32 v40, v39 offset:0
    ds_read_b32 v41, v39 offset:128
    ds_read_b32 v42, v39 offset:256
    ds_read_b32 v43, v39 offset:384
    v_and_b32 v38, 1, v1
    v_lshlrev_b32 v37, 4, v38
    v_lshlrev_b32 v38, 2, v38
    s_mov_b32 s46, s79
    s_mov_b32 s45, s44
    v_lshl_add_u32 v56, v1, 2, s54
    v_mov_b32 v57, 119056
    s_waitcnt lgkmcnt(0)
    s_cmp_le_i32 s46, 0
    s_cbranch_scc1 L_5
    v_lshl_add_u32 v44, v40, 5, v37
    v_lshl_add_u32 v45, v40, 3, v38
    v_cmp_gt_i32 vcc, s46, v36
    s_lshl_b32 s76, s45, 5
    s_add_u32 m0, s76, 65536
    s_mov_b64 exec, vcc
    buffer_load_dwordx4 v44, s[24:27], 0 offen lds
    s_lshl3_add_u32 m0, s45, 98304
    s_add_u32 s45, s45, 32
    buffer_load_dword v45, s[20:23], 0 offen lds
    s_mov_b64 exec, -1
    s_sub_i32 s46, s46, 32
L_5:
    s_barrier
    ds_read_b32 v56, v56
    ds_read_b32 v57, v57
    s_cmp_le_i32 s46, 0
    s_cbranch_scc1 L_6
    v_lshl_add_u32 v44, v41, 5, v37
    v_lshl_add_u32 v45, v41, 3, v38
    v_cmp_gt_i32 vcc, s46, v36
    s_lshl_b32 s76, s45, 5
    s_add_u32 m0, s76, 65536
    s_mov_b64 exec, vcc
    buffer_load_dwordx4 v44, s[24:27], 0 offen lds
    s_lshl3_add_u32 m0, s45, 98304
    s_add_u32 s45, s45, 32
    buffer_load_dword v45, s[20:23], 0 offen lds
    s_mov_b64 exec, -1
    s_sub_i32 s46, s46, 32
L_6:
    s_waitcnt lgkmcnt(0)
    v_readfirstlane_b32 s78, v57
    s_cmp_lg_u32 s77, 0
    s_cbranch_scc1 L_assigned
    v_sub_u32 v57, 63, v1
    v_lshl_add_u32 v57, v56, 6, v57
    v_mov_b32 v59, 0
    v_readlane_b32 s84, v57, 0
    v_readlane_b32 s85, v57, 1
    v_readlane_b32 s86, v57, 2
    v_readlane_b32 s87, v57, 3
    v_readlane_b32 s88, v57, 4
    v_readlane_b32 s89, v57, 5
    v_readlane_b32 s90, v57, 6
    v_readlane_b32 s91, v57, 7
    v_readlane_b32 s92, v57, 8
    v_readlane_b32 s93, v57, 9
    v_readlane_b32 s94, v57, 10
    v_readlane_b32 s95, v57, 11
    v_readlane_b32 s96, v57, 12
    v_readlane_b32 s97, v57, 13
    v_readlane_b32 s98, v57, 14
    v_readlane_b32 s99, v57, 15
    v_cmp_gt_u32 vcc, s84, v57
    v_cmp_gt_u32 s[4:5], s85, v57
    v_cmp_gt_u32 s[6:7], s86, v57
    v_addc_co_u32 v59, vcc, 0, v59, vcc
    v_addc_co_u32 v59, s[4:5], 0, v59, s[4:5]
    v_addc_co_u32 v59, s[6:7], 0, v59, s[6:7]
    v_cmp_gt_u32 vcc, s87, v57
    v_cmp_gt_u32 s[4:5], s88, v57
    v_cmp_gt_u32 s[6:7], s89, v57
    v_addc_co_u32 v59, vcc, 0, v59, vcc
    v_addc_co_u32 v59, s[4:5], 0, v59, s[4:5]
    v_addc_co_u32 v59, s[6:7], 0, v59, s[6:7]
    v_cmp_gt_u32 vcc, s90, v57
    v_cmp_gt_u32 s[4:5], s91, v57
    v_cmp_gt_u32 s[6:7], s92, v57
    v_addc_co_u32 v59, vcc, 0, v59, vcc
    v_addc_co_u32 v59, s[4:5], 0, v59, s[4:5]
    v_addc_co_u32 v59, s[6:7], 0, v59, s[6:7]
    v_cmp_gt_u32 vcc, s93, v57
    v_cmp_gt_u32 s[4:5], s94, v57
    v_cmp_gt_u32 s[6:7], s95, v57
    v_addc_co_u32 v59, vcc, 0, v59, vcc
    v_addc_co_u32 v59, s[4:5], 0, v59, s[4:5]
    v_addc_co_u32 v59, s[6:7], 0, v59, s[6:7]
    v_cmp_gt_u32 vcc, s96, v57
    v_cmp_gt_u32 s[4:5], s97, v57
    v_cmp_gt_u32 s[6:7], s98, v57
    v_addc_co_u32 v59, vcc, 0, v59, vcc
    v_addc_co_u32 v59, s[4:5], 0, v59, s[4:5]
    v_addc_co_u32 v59, s[6:7], 0, v59, s[6:7]
    v_cmp_gt_u32 vcc, s99, v57
    s_nop 1
    v_addc_co_u32 v59, vcc, 0, v59, vcc
    v_readlane_b32 s84, v57, 16
    v_readlane_b32 s85, v57, 17
    v_readlane_b32 s86, v57, 18
    v_readlane_b32 s87, v57, 19
    v_readlane_b32 s88, v57, 20
    v_readlane_b32 s89, v57, 21
    v_readlane_b32 s90, v57, 22
    v_readlane_b32 s91, v57, 23
    v_readlane_b32 s92, v57, 24
    v_readlane_b32 s93, v57, 25
    v_readlane_b32 s94, v57, 26
    v_readlane_b32 s95, v57, 27
    v_readlane_b32 s96, v57, 28
    v_readlane_b32 s97, v57, 29
    v_readlane_b32 s98, v57, 30
    v_readlane_b32 s99, v57, 31
    v_cmp_gt_u32 vcc, s84, v57
    v_cmp_gt_u32 s[4:5], s85, v57
    v_cmp_gt_u32 s[6:7], s86, v57
    v_addc_co_u32 v59, vcc, 0, v59, vcc
    v_addc_co_u32 v59, s[4:5], 0, v59, s[4:5]
    v_addc_co_u32 v59, s[6:7], 0, v59, s[6:7]
    v_cmp_gt_u32 vcc, s87, v57
    v_cmp_gt_u32 s[4:5], s88, v57
    v_cmp_gt_u32 s[6:7], s89, v57
    v_addc_co_u32 v59, vcc, 0, v59, vcc
    v_addc_co_u32 v59, s[4:5], 0, v59, s[4:5]
    v_addc_co_u32 v59, s[6:7], 0, v59, s[6:7]
    v_cmp_gt_u32 vcc, s90, v57
    v_cmp_gt_u32 s[4:5], s91, v57
    v_cmp_gt_u32 s[6:7], s92, v57
    v_addc_co_u32 v59, vcc, 0, v59, vcc
    v_addc_co_u32 v59, s[4:5], 0, v59, s[4:5]
    v_addc_co_u32 v59, s[6:7], 0, v59, s[6:7]
    v_cmp_gt_u32 vcc, s93, v57
    v_cmp_gt_u32 s[4:5], s94, v57
    v_cmp_gt_u32 s[6:7], s95, v57
    v_addc_co_u32 v59, vcc, 0, v59, vcc
    v_addc_co_u32 v59, s[4:5], 0, v59, s[4:5]
    v_addc_co_u32 v59, s[6:7], 0, v59, s[6:7]
    v_cmp_gt_u32 vcc, s96, v57
    v_cmp_gt_u32 s[4:5], s97, v57
    v_cmp_gt_u32 s[6:7], s98, v57
    v_addc_co_u32 v59, vcc, 0, v59, vcc
    v_addc_co_u32 v59, s[4:5], 0, v59, s[4:5]
    v_addc_co_u32 v59, s[6:7], 0, v59, s[6:7]
    v_cmp_gt_u32 vcc, s99, v57
    s_nop 1
    v_addc_co_u32 v59, vcc, 0, v59, vcc
    v_readlane_b32 s84, v57, 32
    v_readlane_b32 s85, v57, 33
    v_readlane_b32 s86, v57, 34
    v_readlane_b32 s87, v57, 35
    v_readlane_b32 s88, v57, 36
    v_readlane_b32 s89, v57, 37
    v_readlane_b32 s90, v57, 38
    v_readlane_b32 s91, v57, 39
    v_cmp_gt_u32 vcc, s84, v57
    v_cmp_gt_u32 s[4:5], s85, v57
    v_cmp_gt_u32 s[6:7], s86, v57
    v_addc_co_u32 v59, vcc, 0, v59, vcc
    v_addc_co_u32 v59, s[4:5], 0, v59, s[4:5]
    v_addc_co_u32 v59, s[6:7], 0, v59, s[6:7]
    v_cmp_gt_u32 vcc, s87, v57
    v_cmp_gt_u32 s[4:5], s88, v57
    v_cmp_gt_u32 s[6:7], s89, v57
    v_addc_co_u32 v59, vcc, 0, v59, vcc
    v_addc_co_u32 v59, s[4:5], 0, v59, s[4:5]
    v_addc_co_u32 v59, s[6:7], 0, v59, s[6:7]
    v_cmp_gt_u32 vcc, s90, v57
    v_cmp_gt_u32 s[4:5], s91, v57
    s_nop 0
    v_addc_co_u32 v59, vcc, 0, v59, vcc
    v_addc_co_u32 v59, s[4:5], 0, v59, s[4:5]
    v_bfe_u32 v60, v59, 3, 1
    v_mul_u32_u24 v60, 7, v60
    v_and_b32 v61, 7, v59
    v_xor_b32 v11, v60, v61
    s_sub_u32 s53, 7, s3
    s_add_u32 s54, s3, 0
    v_cmp_eq_u32 vcc, s54, v59
    s_ff1_i32_b64 s56, vcc
    s_add_u32 s54, s53, 8
    v_cmp_eq_u32 vcc, s54, v59
    s_ff1_i32_b64 s57, vcc
    s_add_u32 s54, s3, 16
    v_cmp_eq_u32 vcc, s54, v59
    s_ff1_i32_b64 s58, vcc
    s_add_u32 s54, s53, 24
    v_cmp_eq_u32 vcc, s54, v59
    s_ff1_i32_b64 s59, vcc
    s_add_u32 s54, s3, 32
    v_cmp_eq_u32 vcc, s54, v59
    s_ff1_i32_b64 s60, vcc
L_assigned:
    v_cmp_gt_u32 vcc, s3, v11
    v_and_b32 v61, 15, v1
    v_lshlrev_b32 v61, 2, v61
    v_cndmask_b32 v60, 0, v56, vcc
    v_add_u32 v61, 110848, v61
    s_lshl_b32 s84, s56, 6
    v_add_u32 v64, s84, v61
    ds_read_b32 v70, v64
    s_lshl_b32 s85, s57, 6
    v_add_u32 v65, s85, v61
    ds_read_b32 v71, v65
    s_lshl_b32 s86, s58, 6
    v_add_u32 v66, s86, v61
    ds_read_b32 v72, v66
    s_lshl_b32 s87, s59, 6
    v_add_u32 v67, s87, v61
    ds_read_b32 v73, v67
    s_lshl_b32 s88, s60, 6
    v_add_u32 v68, s88, v61
    ds_read_b32 v74, v68
    v_add_u32_dpp v60, v60, v60 row_shr:1 row_mask:0xf bank_mask:0xf bound_ctrl:1
    v_readlane_b32 s92, v56, s56
    s_nop 0
    v_add_u32_dpp v60, v60, v60 row_shr:2 row_mask:0xf bank_mask:0xf bound_ctrl:1
    v_readlane_b32 s93, v56, s57
    s_nop 0
    v_add_u32_dpp v60, v60, v60 row_shr:4 row_mask:0xf bank_mask:0xf bound_ctrl:1
    v_readlane_b32 s94, v56, s58
    s_nop 0
    v_add_u32_dpp v60, v60, v60 row_shr:8 row_mask:0xf bank_mask:0xf bound_ctrl:1
    v_readlane_b32 s95, v56, s59
    s_nop 0
    v_readlane_b32 s96, v56, s60
    v_readlane_b32 s61, v60, 15
    v_readlane_b32 s53, v60, 31
    v_readlane_b32 s54, v60, 47
    s_add_u32 s62, s92, s93
    s_add_u32 s62, s62, s94
    s_add_u32 s62, s62, s95
    s_add_u32 s62, s62, s96
    s_add_u32 s61, s61, s53
    s_add_u32 s61, s61, s54
    s_add_u32 s61, s61, 3
    s_andn2_b32 s61, s61, 3
    s_lshl2_add_u32 s61, s3, s61
    s_waitcnt lgkmcnt(0)
    v_add3_u32 v60, v70, v71, v72
    v_add3_u32 v60, v60, v73, v74
    v_mov_b32 v61, v60
    s_nop 1
    v_add_u32_dpp v61, v61, v61 row_shr:1 row_mask:0xf bank_mask:0xf bound_ctrl:1
    s_nop 1
    v_add_u32_dpp v61, v61, v61 row_shr:2 row_mask:0xf bank_mask:0xf bound_ctrl:1
    s_nop 1
    v_add_u32_dpp v61, v61, v61 row_shr:4 row_mask:0xf bank_mask:0xf bound_ctrl:1
    s_nop 1
    v_add_u32_dpp v61, v61, v61 row_shr:8 row_mask:0xf bank_mask:0xf bound_ctrl:1
    v_sub_u32 v61, v61, v60
    v_add_u32 v61, s61, v61
    v_lshl_add_u32 v75, v61, 8, 0
    ds_write_b32 v64, v75 offset:4096
    v_add_u32 v61, v61, v70
    v_lshl_add_u32 v76, v61, 8, 16
    ds_write_b32 v65, v76 offset:4096
    v_add_u32 v61, v61, v71
    v_lshl_add_u32 v77, v61, 8, 32
    ds_write_b32 v66, v77 offset:4096
    v_add_u32 v61, v61, v72
    v_lshl_add_u32 v78, v61, 8, 48
    ds_write_b32 v67, v78 offset:4096
    v_add_u32 v61, v61, v73
    v_lshl_add_u32 v79, v61, 8, 64
    ds_write_b32 v68, v79 offset:4096
    s_cmp_le_i32 s46, 0
    s_cbranch_scc1 L_7
    v_lshl_add_u32 v44, v42, 5, v37
    v_lshl_add_u32 v45, v42, 3, v38
    v_cmp_gt_i32 vcc, s46, v36
    s_lshl_b32 s76, s45, 5
    s_add_u32 m0, s76, 65536
    s_mov_b64 exec, vcc
    buffer_load_dwordx4 v44, s[24:27], 0 offen lds
    s_lshl3_add_u32 m0, s45, 98304
    s_add_u32 s45, s45, 32
    buffer_load_dword v45, s[20:23], 0 offen lds
    s_mov_b64 exec, -1
    s_sub_i32 s46, s46, 32
L_7:
    s_waitcnt lgkmcnt(0)
    s_barrier
    ds_read_b32 v16, v28 offset:4096
    ds_read_b32 v17, v29 offset:4096
    ds_read_b32 v18, v30 offset:4096
    ds_read_b32 v19, v31 offset:4096
    v_mov_b32 v60, 0
    v_mov_b32 v61, 0
    v_lshlrev_b32 v64, 3, v0
    v_add_u32 v64, 110848, v64
    ds_write_b64 v64, v[60:61]
    v_mov_b32 v64, 119056
    ds_write_b32 v64, v60
    s_mov_b32 s53, 106496
    s_movk_i32 s54, 255
    s_waitcnt lgkmcnt(2)
    v_lshrrev_b32 v28, 8, v16
    v_add_u32 v28, v28, v32
    v_and_or_b32 v16, v16, s54, v24
    v_lshl_add_u32 v28, v28, 2, s53
    s_mov_b64 exec, s[36:37]
    ds_write_b32 v28, v16
    s_mov_b64 exec, -1
    v_lshrrev_b32 v29, 8, v17
    v_add_u32 v29, v29, v33
    v_and_or_b32 v17, v17, s54, v25
    v_lshl_add_u32 v29, v29, 2, s53
    s_mov_b64 exec, s[38:39]
    ds_write_b32 v29, v17
    s_mov_b64 exec, -1
    v_lshrrev_b32 v30, 8, v18
    v_add_u32 v30, v30, v34
    v_and_or_b32 v18, v18, s54, v26
    v_lshl_add_u32 v30, v30, 2, s53
    s_mov_b64 exec, s[40:41]
    ds_write_b32 v30, v18
    s_mov_b64 exec, -1
    v_lshrrev_b32 v31, 8, v19
    v_add_u32 v31, v31, v35
    v_and_or_b32 v19, v19, s54, v27
    v_lshl_add_u32 v31, v31, 2, s53
    s_mov_b64 exec, s[42:43]
    ds_write_b32 v31, v19
    s_mov_b64 exec, -1
    s_cmp_le_i32 s46, 0
    s_cbranch_scc1 L_8
    v_lshl_add_u32 v44, v43, 5, v37
    v_lshl_add_u32 v45, v43, 3, v38
    v_cmp_gt_i32 vcc, s46, v36
    s_lshl_b32 s76, s45, 5
    s_add_u32 m0, s76, 65536
    s_mov_b64 exec, vcc
    buffer_load_dwordx4 v44, s[24:27], 0 offen lds
    s_lshl3_add_u32 m0, s45, 98304
    s_add_u32 s45, s45, 32
    buffer_load_dword v45, s[20:23], 0 offen lds
    s_mov_b64 exec, -1
    s_sub_i32 s46, s46, 32
L_8:
L_paymore:
    s_cmp_le_i32 s46, 0
    s_cbranch_scc1 L_paydone
    ds_read_b32 v40, v39 offset:512
    v_add_u32 v39, 128, v39
    s_waitcnt lgkmcnt(0)
    s_cmp_le_i32 s46, 0
    s_cbranch_scc1 L_9
    v_lshl_add_u32 v44, v40, 5, v37
    v_lshl_add_u32 v45, v40, 3, v38
    v_cmp_gt_i32 vcc, s46, v36
    s_lshl_b32 s76, s45, 5
    s_add_u32 m0, s76, 65536
    s_mov_b64 exec, vcc
    buffer_load_dwordx4 v44, s[24:27], 0 offen lds
    s_lshl3_add_u32 m0, s45, 98304
    s_add_u32 s45, s45, 32
    buffer_load_dword v45, s[20:23], 0 offen lds
    s_mov_b64 exec, -1
    s_sub_i32 s46, s46, 32
L_9:
    s_branch L_paymore
L_paydone:
    s_lshl_b32 s61, s61, 2
    s_add_u32 s61, s61, 106496
    v_mov_b32 v13, s61
    v_and_b32 v62, 3, v1
    v_lshl_add_u32 v77, v62, 2, s61
    v_bfe_u32 v62, v1, 2, 2
    v_lshl_add_u32 v78, v62, 2, s61
    v_bfe_u32 v63, v1, 4, 1
    v_lshlrev_b32 v63, 4, v63
    v_add_u32 v63, 65536, v63
    v_mov_b32 v65, 98304
    v_mov_b32 v62, 119040
    v_cmp_ne_u32 vcc, 0, v7
    v_cmp_ne_u32 s[4:5], 0, v8
    v_cmp_ne_u32 s[6:7], 0, v10
    v_cndmask_b32 v74, v62, v63, vcc
    v_cndmask_b32 v75, v62, v63, s[4:5]
    v_cndmask_b32 v76, v62, v65, s[6:7]
    s_waitcnt lgkmcnt(0)
    s_barrier
    ds_read_b128 v[68:71], v13
    ds_read_b32 v72, v77
    ds_read_b32 v73, v78
    s_cmp_lt_u32 s62, 3
    s_cbranch_scc1 L_short
    s_waitcnt lgkmcnt(2)
    v_readfirstlane_b32 s64, v68
    v_readfirstlane_b32 s65, v69
    v_readfirstlane_b32 s66, v70
    v_readfirstlane_b32 s67, v71
    s_and_b32 s76, s64, s82
    s_add_u32 m0, s63, 0
    s_lshl_b32 s76, s76, 3
    buffer_load_dwordx4 v2, s[8:11], s76 offen lds
    buffer_load_dwordx4 v3, s[8:11], s76 offen offset:1024 lds
    s_and_b32 s76, s65, s82
    s_add_u32 m0, s63, 2048
    s_lshl_b32 s76, s76, 3
    buffer_load_dwordx4 v2, s[8:11], s76 offen lds
    buffer_load_dwordx4 v3, s[8:11], s76 offen offset:1024 lds
    s_and_b32 s76, s66, s82
    s_add_u32 m0, s63, 4096
    s_lshl_b32 s76, s76, 3
    buffer_load_dwordx4 v2, s[8:11], s76 offen lds
    buffer_load_dwordx4 v3, s[8:11], s76 offen offset:1024 lds
    s_waitcnt vmcnt(6)
    s_branch L_go
L_short:
    s_waitcnt vmcnt(0) lgkmcnt(0)
    v_readfirstlane_b32 s64, v68
    v_readfirstlane_b32 s65, v69
    v_readfirstlane_b32 s66, v70
    v_readfirstlane_b32 s67, v71
    s_cmp_le_u32 s62, 0
    s_cbranch_scc1 L_go
    s_and_b32 s76, s64, s82
    s_add_u32 m0, s63, 0
    s_lshl_b32 s76, s76, 3
    buffer_load_dwordx4 v2, s[8:11], s76 offen lds
    buffer_load_dwordx4 v3, s[8:11], s76 offen offset:1024 lds
    s_cmp_le_u32 s62, 1
    s_cbranch_scc1 L_go
    s_and_b32 s76, s65, s82
    s_add_u32 m0, s63, 2048
    s_lshl_b32 s76, s76, 3
    buffer_load_dwordx4 v2, s[8:11], s76 offen lds
    buffer_load_dwordx4 v3, s[8:11], s76 offen offset:1024 lds
L_go:
    s_waitcnt lgkmcnt(0)
    v_lshrrev_b32 v72, 22, v72
    v_lshrrev_b32 v73, 22, v73
    v_mad_u32_u24 v5, v72, v7, v74
    v_mad_u32_u24 v6, v72, v8, v75
    v_mad_u32_u24 v9, v73, v10, v76
    s_barrier
    s_cmp_eq_u32 s62, 0
    s_cbranch_scc1 L_round_done
L_group:
    ds_read_b64 v[14:15], v9
    ds_read_b128 v[56:59], v5
    ds_read_b128 v[60:63], v6
    ds_read_b128 v[68:71], v13 offset:16
    ds_read_b32 v72, v77 offset:16
    ds_read_b32 v73, v78 offset:16
    v_add_u32 v13, 16, v13
    v_add_u32 v77, 16, v77
    v_add_u32 v78, 16, v78
    s_waitcnt lgkmcnt(0)
    v_mfma_f32_16x16x16_bf16 v[64:67], a[32:33], v[14:15], 0
    v_mfma_f32_16x16x32_bf16 v[16:19], v[56:59], a[0:3], 0
    v_mfma_f32_16x16x32_bf16 v[20:23], v[56:59], a[8:11], 0
    v_mfma_f32_16x16x32_bf16 v[24:27], v[56:59], a[16:19], 0
    v_mfma_f32_16x16x32_bf16 v[28:31], v[56:59], a[24:27], 0
    v_mfma_f32_16x16x32_bf16 v[16:19], v[60:63], a[4:7], v[16:19]
    v_mfma_f32_16x16x32_bf16 v[20:23], v[60:63], a[12:15], v[20:23]
    v_mfma_f32_16x16x32_bf16 v[24:27], v[60:63], a[20:23], v[24:27]
    v_mfma_f32_16x16x32_bf16 v[28:31], v[60:63], a[28:31], v[28:31]
    v_readfirstlane_b32 s68, v68
    v_readfirstlane_b32 s69, v69
    v_readfirstlane_b32 s70, v70
    v_readfirstlane_b32 s71, v71
    v_cvt_pk_bf16_f32 v14, v64, v65
    v_cvt_pk_bf16_f32 v15, v66, v67
    v_lshrrev_b32 v72, 22, v72
    v_lshrrev_b32 v73, 22, v73
    v_mad_u32_u24 v5, v72, v7, v74
    v_mad_u32_u24 v6, v72, v8, v75
    v_mad_u32_u24 v9, v73, v10, v76
    s_cmp_ge_u32 s62, 3
    s_cbranch_scc1 L_10
    s_waitcnt vmcnt(0)
L_10:
    s_waitcnt vmcnt(4)
    ds_read_b64_tr_b16 v[48:49], v4 offset:0
    ds_read_b64_tr_b16 v[50:51], v4 offset:256
    ds_read_b64_tr_b16 v[52:53], v4 offset:512
    ds_read_b64_tr_b16 v[54:55], v4 offset:768
    s_cmp_le_u32 s62, 3
    s_cbranch_scc1 L_11
    s_and_b32 s76, s67, s82
    s_add_u32 m0, s63, 6144
    s_lshl_b32 s76, s76, 3
    buffer_load_dwordx4 v2, s[8:11], s76 offen lds
    buffer_load_dwordx4 v3, s[8:11], s76 offen offset:1024 lds
L_11:
    s_waitcnt lgkmcnt(0)
    v_mfma_f32_4x4x4_16b_bf16 v[32:35], v[14:15], v[48:49], 0 cbsz:4 abid:0
    v_mfma_f32_4x4x4_16b_bf16 v[36:39], v[14:15], v[50:51], 0 cbsz:4 abid:0
    v_mfma_f32_4x4x4_16b_bf16 v[40:43], v[14:15], v[52:53], 0 cbsz:4 abid:0
    v_mfma_f32_4x4x4_16b_bf16 v[44:47], v[14:15], v[54:55], 0 cbsz:4 abid:0
    s_nop 0
    s_set_gpr_idx_on s64, gpr_idx(SRC2,DST)
    v_pk_fma_f32 v[80:81], v[32:33], v[16:17], v[80:81] op_sel:[0,0,0] op_sel_hi:[1,0,1]
    v_pk_fma_f32 v[82:83], v[34:35], v[16:17], v[82:83] op_sel:[0,0,0] op_sel_hi:[1,0,1]
    v_pk_fma_f32 v[84:85], v[36:37], v[20:21], v[84:85] op_sel:[0,0,0] op_sel_hi:[1,0,1]
    v_pk_fma_f32 v[86:87], v[38:39], v[20:21], v[86:87] op_sel:[0,0,0] op_sel_hi:[1,0,1]
    v_pk_fma_f32 v[88:89], v[40:41], v[24:25], v[88:89] op_sel:[0,0,0] op_sel_hi:[1,0,1]
    v_pk_fma_f32 v[90:91], v[42:43], v[24:25], v[90:91] op_sel:[0,0,0] op_sel_hi:[1,0,1]
    v_pk_fma_f32 v[92:93], v[44:45], v[28:29], v[92:93] op_sel:[0,0,0] op_sel_hi:[1,0,1]
    v_pk_fma_f32 v[94:95], v[46:47], v[28:29], v[94:95] op_sel:[0,0,0] op_sel_hi:[1,0,1]
    s_set_gpr_idx_off
    s_mov_b32 s64, s68
    s_sub_u32 s62, s62, 1
    s_cmp_eq_u32 s62, 0
    s_cbranch_scc1 L_round_done
    s_cmp_ge_u32 s62, 3
    s_cbranch_scc1 L_12
    s_waitcnt vmcnt(0)
L_12:
    s_waitcnt vmcnt(4)
    ds_read_b64_tr_b16 v[48:49], v4 offset:2048
    ds_read_b64_tr_b16 v[50:51], v4 offset:2304
    ds_read_b64_tr_b16 v[52:53], v4 offset:2560
    ds_read_b64_tr_b16 v[54:55], v4 offset:2816
    s_cmp_le_u32 s62, 3
    s_cbranch_scc1 L_13
    s_and_b32 s76, s68, s82
    s_add_u32 m0, s63, 0
    s_lshl_b32 s76, s76, 3
    buffer_load_dwordx4 v2, s[8:11], s76 offen lds
    buffer_load_dwordx4 v3, s[8:11], s76 offen offset:1024 lds
L_13:
    s_waitcnt lgkmcnt(0)
    v_mfma_f32_4x4x4_16b_bf16 v[32:35], v[14:15], v[48:49], 0 cbsz:4 abid:1
    v_mfma_f32_4x4x4_16b_bf16 v[36:39], v[14:15], v[50:51], 0 cbsz:4 abid:1
    v_mfma_f32_4x4x4_16b_bf16 v[40:43], v[14:15], v[52:53], 0 cbsz:4 abid:1
    v_mfma_f32_4x4x4_16b_bf16 v[44:47], v[14:15], v[54:55], 0 cbsz:4 abid:1
    s_nop 0
    s_set_gpr_idx_on s65, gpr_idx(SRC2,DST)
    v_pk_fma_f32 v[80:81], v[32:33], v[16:17], v[80:81] op_sel:[0,1,0] op_sel_hi:[1,1,1]
    v_pk_fma_f32 v[82:83], v[34:35], v[16:17], v[82:83] op_sel:[0,1,0] op_sel_hi:[1,1,1]
    v_pk_fma_f32 v[84:85], v[36:37], v[20:21], v[84:85] op_sel:[0,1,0] op_sel_hi:[1,1,1]
    v_pk_fma_f32 v[86:87], v[38:39], v[20:21], v[86:87] op_sel:[0,1,0] op_sel_hi:[1,1,1]
    v_pk_fma_f32 v[88:89], v[40:41], v[24:25], v[88:89] op_sel:[0,1,0] op_sel_hi:[1,1,1]
    v_pk_fma_f32 v[90:91], v[42:43], v[24:25], v[90:91] op_sel:[0,1,0] op_sel_hi:[1,1,1]
    v_pk_fma_f32 v[92:93], v[44:45], v[28:29], v[92:93] op_sel:[0,1,0] op_sel_hi:[1,1,1]
    v_pk_fma_f32 v[94:95], v[46:47], v[28:29], v[94:95] op_sel:[0,1,0] op_sel_hi:[1,1,1]
    s_set_gpr_idx_off
    s_mov_b32 s65, s69
    s_sub_u32 s62, s62, 1
    s_cmp_eq_u32 s62, 0
    s_cbranch_scc1 L_round_done
    s_cmp_ge_u32 s62, 3
    s_cbranch_scc1 L_14
    s_waitcnt vmcnt(0)
L_14:
    s_waitcnt vmcnt(4)
    ds_read_b64_tr_b16 v[48:49], v4 offset:4096
    ds_read_b64_tr_b16 v[50:51], v4 offset:4352
    ds_read_b64_tr_b16 v[52:53], v4 offset:4608
    ds_read_b64_tr_b16 v[54:55], v4 offset:4864
    s_cmp_le_u32 s62, 3
    s_cbranch_scc1 L_15
    s_and_b32 s76, s69, s82
    s_add_u32 m0, s63, 2048
    s_lshl_b32 s76, s76, 3
    buffer_load_dwordx4 v2, s[8:11], s76 offen lds
    buffer_load_dwordx4 v3, s[8:11], s76 offen offset:1024 lds
L_15:
    s_waitcnt lgkmcnt(0)
    v_mfma_f32_4x4x4_16b_bf16 v[32:35], v[14:15], v[48:49], 0 cbsz:4 abid:2
    v_mfma_f32_4x4x4_16b_bf16 v[36:39], v[14:15], v[50:51], 0 cbsz:4 abid:2
    v_mfma_f32_4x4x4_16b_bf16 v[40:43], v[14:15], v[52:53], 0 cbsz:4 abid:2
    v_mfma_f32_4x4x4_16b_bf16 v[44:47], v[14:15], v[54:55], 0 cbsz:4 abid:2
    s_nop 0
    s_set_gpr_idx_on s66, gpr_idx(SRC2,DST)
    v_pk_fma_f32 v[80:81], v[32:33], v[18:19], v[80:81] op_sel:[0,0,0] op_sel_hi:[1,0,1]
    v_pk_fma_f32 v[82:83], v[34:35], v[18:19], v[82:83] op_sel:[0,0,0] op_sel_hi:[1,0,1]
    v_pk_fma_f32 v[84:85], v[36:37], v[22:23], v[84:85] op_sel:[0,0,0] op_sel_hi:[1,0,1]
    v_pk_fma_f32 v[86:87], v[38:39], v[22:23], v[86:87] op_sel:[0,0,0] op_sel_hi:[1,0,1]
    v_pk_fma_f32 v[88:89], v[40:41], v[26:27], v[88:89] op_sel:[0,0,0] op_sel_hi:[1,0,1]
    v_pk_fma_f32 v[90:91], v[42:43], v[26:27], v[90:91] op_sel:[0,0,0] op_sel_hi:[1,0,1]
    v_pk_fma_f32 v[92:93], v[44:45], v[30:31], v[92:93] op_sel:[0,0,0] op_sel_hi:[1,0,1]
    v_pk_fma_f32 v[94:95], v[46:47], v[30:31], v[94:95] op_sel:[0,0,0] op_sel_hi:[1,0,1]
    s_set_gpr_idx_off
    s_mov_b32 s66, s70
    s_sub_u32 s62, s62, 1
    s_cmp_eq_u32 s62, 0
    s_cbranch_scc1 L_round_done
    s_cmp_ge_u32 s62, 3
    s_cbranch_scc1 L_16
    s_waitcnt vmcnt(0)
L_16:
    s_waitcnt vmcnt(4)
    ds_read_b64_tr_b16 v[48:49], v4 offset:6144
    ds_read_b64_tr_b16 v[50:51], v4 offset:6400
    ds_read_b64_tr_b16 v[52:53], v4 offset:6656
    ds_read_b64_tr_b16 v[54:55], v4 offset:6912
    s_cmp_le_u32 s62, 3
    s_cbranch_scc1 L_17
    s_and_b32 s76, s70, s82
    s_add_u32 m0, s63, 4096
    s_lshl_b32 s76, s76, 3
    buffer_load_dwordx4 v2, s[8:11], s76 offen lds
    buffer_load_dwordx4 v3, s[8:11], s76 offen offset:1024 lds
L_17:
    s_waitcnt lgkmcnt(0)
    v_mfma_f32_4x4x4_16b_bf16 v[32:35], v[14:15], v[48:49], 0 cbsz:4 abid:3
    v_mfma_f32_4x4x4_16b_bf16 v[36:39], v[14:15], v[50:51], 0 cbsz:4 abid:3
    v_mfma_f32_4x4x4_16b_bf16 v[40:43], v[14:15], v[52:53], 0 cbsz:4 abid:3
    v_mfma_f32_4x4x4_16b_bf16 v[44:47], v[14:15], v[54:55], 0 cbsz:4 abid:3
    s_nop 0
    s_set_gpr_idx_on s67, gpr_idx(SRC2,DST)
    v_pk_fma_f32 v[80:81], v[32:33], v[18:19], v[80:81] op_sel:[0,1,0] op_sel_hi:[1,1,1]
    v_pk_fma_f32 v[82:83], v[34:35], v[18:19], v[82:83] op_sel:[0,1,0] op_sel_hi:[1,1,1]
    v_pk_fma_f32 v[84:85], v[36:37], v[22:23], v[84:85] op_sel:[0,1,0] op_sel_hi:[1,1,1]
    v_pk_fma_f32 v[86:87], v[38:39], v[22:23], v[86:87] op_sel:[0,1,0] op_sel_hi:[1,1,1]
    v_pk_fma_f32 v[88:89], v[40:41], v[26:27], v[88:89] op_sel:[0,1,0] op_sel_hi:[1,1,1]
    v_pk_fma_f32 v[90:91], v[42:43], v[26:27], v[90:91] op_sel:[0,1,0] op_sel_hi:[1,1,1]
    v_pk_fma_f32 v[92:93], v[44:45], v[30:31], v[92:93] op_sel:[0,1,0] op_sel_hi:[1,1,1]
    v_pk_fma_f32 v[94:95], v[46:47], v[30:31], v[94:95] op_sel:[0,1,0] op_sel_hi:[1,1,1]
    s_set_gpr_idx_off
    s_mov_b32 s67, s71
    s_sub_u32 s62, s62, 1
    s_cmp_eq_u32 s62, 0
    s_cbranch_scc0 L_group
L_round_done:
    s_add_u32 s77, s77, 1
    s_cmp_lg_u32 s78, 0
    s_cbranch_scc1 L_scan
    s_lshl_b32 s53, s3, 14
    s_add_u32 s53, s53, 2097152
    v_lshlrev_b32 v16, 4, v1
    v_add_u32 v16, s53, v16
    buffer_load_dwordx4 a[32:35], v16, s[32:35], 0 offen offset:0
    buffer_load_dwordx4 a[36:39], v16, s[32:35], 0 offen offset:1024
    buffer_load_dwordx4 a[40:43], v16, s[32:35], 0 offen offset:2048
    buffer_load_dwordx4 a[44:47], v16, s[32:35], 0 offen offset:3072
    v_add_u32 v16, 4096, v16
    buffer_load_dwordx4 a[48:51], v16, s[32:35], 0 offen offset:0
    buffer_load_dwordx4 a[52:55], v16, s[32:35], 0 offen offset:1024
    buffer_load_dwordx4 a[56:59], v16, s[32:35], 0 offen offset:2048
    buffer_load_dwordx4 a[60:63], v16, s[32:35], 0 offen offset:3072
    v_add_u32 v16, 4096, v16
    buffer_load_dwordx4 a[64:67], v16, s[32:35], 0 offen offset:0
    buffer_load_dwordx4 a[68:71], v16, s[32:35], 0 offen offset:1024
    buffer_load_dwordx4 a[72:75], v16, s[32:35], 0 offen offset:2048
    buffer_load_dwordx4 a[76:79], v16, s[32:35], 0 offen offset:3072
    v_add_u32 v16, 4096, v16
    buffer_load_dwordx4 a[80:83], v16, s[32:35], 0 offen offset:0
    buffer_load_dwordx4 a[84:87], v16, s[32:35], 0 offen offset:1024
    buffer_load_dwordx4 a[88:91], v16, s[32:35], 0 offen offset:2048
    buffer_load_dwordx4 a[92:95], v16, s[32:35], 0 offen offset:3072
    v_add_u32 v16, 4096, v16
    v_mul_u32_u24 v16, 320, v1
    v_lshrrev_b32 v17, 2, v1
    v_lshl_add_u32 v16, v17, 3, v16
    s_lshl_b32 s53, s56, 3
    v_add_u32 v17, s53, v16
    s_lshl_b32 s53, s57, 3
    v_add_u32 v18, s53, v16
    s_lshl_b32 s53, s58, 3
    v_add_u32 v19, s53, v16
    s_lshl_b32 s53, s59, 3
    v_add_u32 v20, s53, v16
    s_lshl_b32 s53, s60, 3
    v_add_u32 v21, s53, v16
    v_cvt_pk_bf16_f32 v24, v80, v81
    v_cvt_pk_bf16_f32 v25, v82, v83
    v_cvt_pk_bf16_f32 v26, v84, v85
    v_cvt_pk_bf16_f32 v27, v86, v87
    v_cvt_pk_bf16_f32 v28, v88, v89
    v_cvt_pk_bf16_f32 v29, v90, v91
    v_cvt_pk_bf16_f32 v30, v92, v93
    v_cvt_pk_bf16_f32 v31, v94, v95
    v_cvt_pk_bf16_f32 v32, v96, v97
    v_cvt_pk_bf16_f32 v33, v98, v99
    v_cvt_pk_bf16_f32 v34, v100, v101
    v_cvt_pk_bf16_f32 v35, v102, v103
    v_cvt_pk_bf16_f32 v36, v104, v105
    v_cvt_pk_bf16_f32 v37, v106, v107
    v_cvt_pk_bf16_f32 v38, v108, v109
    v_cvt_pk_bf16_f32 v39, v110, v111
    v_cvt_pk_bf16_f32 v40, v112, v113
    v_cvt_pk_bf16_f32 v41, v114, v115
    v_cvt_pk_bf16_f32 v42, v116, v117
    v_cvt_pk_bf16_f32 v43, v118, v119
    v_cvt_pk_bf16_f32 v44, v120, v121
    v_cvt_pk_bf16_f32 v45, v122, v123
    v_cvt_pk_bf16_f32 v46, v124, v125
    v_cvt_pk_bf16_f32 v47, v126, v127
    v_cvt_pk_bf16_f32 v48, v128, v129
    v_cvt_pk_bf16_f32 v49, v130, v131
    v_cvt_pk_bf16_f32 v50, v132, v133
    v_cvt_pk_bf16_f32 v51, v134, v135
    v_cvt_pk_bf16_f32 v52, v136, v137
    v_cvt_pk_bf16_f32 v53, v138, v139
    v_cvt_pk_bf16_f32 v54, v140, v141
    v_cvt_pk_bf16_f32 v55, v142, v143
    v_cvt_pk_bf16_f32 v56, v144, v145
    v_cvt_pk_bf16_f32 v57, v146, v147
    v_cvt_pk_bf16_f32 v58, v148, v149
    v_cvt_pk_bf16_f32 v59, v150, v151
    v_cvt_pk_bf16_f32 v60, v152, v153
    v_cvt_pk_bf16_f32 v61, v154, v155
    v_cvt_pk_bf16_f32 v62, v156, v157
    v_cvt_pk_bf16_f32 v63, v158, v159
    v_lshrrev_b32 v70, 5, v1
    v_mul_u32_u24 v71, 2576, v70
    v_bfe_u32 v72, v1, 2, 2
    v_mul_u32_u24 v74, 320, v72
    v_bfe_u32 v73, v1, 4, 1
    v_lshl_add_u32 v71, v73, 5, v71
    v_and_b32 v73, 3, v1
    v_lshl_add_u32 v71, v73, 3, v71
    v_add_u32 v2, v71, v74
    v_add_u32 v3, 41216, v2
    s_mul_i32 s53, s3, 5120
    s_add_u32 s53, s53, 82432
    v_and_b32 v74, 31, v1
    v_mul_u32_u24 v74, 80, v74
    v_lshl_add_u32 v74, v70, 3, v74
    v_add_u32 v5, s53, v74
    v_lshrrev_b32 v74, 2, v1
    v_mul_u32_u24 v74, 80, v74
    v_lshl_add_u32 v74, v73, 4, v74
    v_add_u32 v6, s53, v74
    v_lshrrev_b32 v74, 4, v1
    v_lshlrev_b32 v74, 19, v74
    v_lshl_add_u32 v74, v72, 9, v74
    v_lshl_add_u32 v74, v73, 4, v74
    s_lshl_b32 s53, s2, 11
    s_lshl_b32 s54, s3, 6
    s_add_u32 s53, s53, s54
    v_add_u32 v4, s53, v74
    s_barrier
    ds_write_b64 v17, v[24:25] offset:0
    ds_write_b64 v17, v[26:27] offset:20608
    ds_write_b64 v17, v[28:29] offset:41216
    ds_write_b64 v17, v[30:31] offset:61824
    ds_write_b64 v18, v[32:33] offset:0
    ds_write_b64 v18, v[34:35] offset:20608
    ds_write_b64 v18, v[36:37] offset:41216
    ds_write_b64 v18, v[38:39] offset:61824
    ds_write_b64 v19, v[40:41] offset:0
    ds_write_b64 v19, v[42:43] offset:20608
    ds_write_b64 v19, v[44:45] offset:41216
    ds_write_b64 v19, v[46:47] offset:61824
    ds_write_b64 v20, v[48:49] offset:0
    ds_write_b64 v20, v[50:51] offset:20608
    ds_write_b64 v20, v[52:53] offset:41216
    ds_write_b64 v20, v[54:55] offset:61824
    ds_write_b64 v21, v[56:57] offset:0
    ds_write_b64 v21, v[58:59] offset:20608
    ds_write_b64 v21, v[60:61] offset:41216
    ds_write_b64 v21, v[62:63] offset:61824
    s_waitcnt lgkmcnt(0)
    s_barrier
    ds_read_b64_tr_b16 v[16:17], v2 offset:0
    ds_read_b64_tr_b16 v[18:19], v2 offset:1288
    ds_read_b64_tr_b16 v[20:21], v2 offset:5152
    ds_read_b64_tr_b16 v[22:23], v2 offset:6440
    ds_read_b64_tr_b16 v[24:25], v2 offset:10304
    ds_read_b64_tr_b16 v[26:27], v2 offset:11592
    ds_read_b64_tr_b16 v[28:29], v2 offset:15456
    ds_read_b64_tr_b16 v[30:31], v2 offset:16744
    s_waitcnt vmcnt(0)
    ds_read_b64_tr_b16 v[32:33], v2 offset:20608
    ds_read_b64_tr_b16 v[34:35], v2 offset:21896
    ds_read_b64_tr_b16 v[36:37], v2 offset:25760
    ds_read_b64_tr_b16 v[38:39], v2 offset:27048
    ds_read_b64_tr_b16 v[40:41], v2 offset:30912
    ds_read_b64_tr_b16 v[42:43], v2 offset:32200
    ds_read_b64_tr_b16 v[44:45], v2 offset:36064
    ds_read_b64_tr_b16 v[46:47], v2 offset:37352
    s_waitcnt lgkmcnt(8)
    v_mfma_f32_32x32x16_bf16 v[48:63], a[32:35], v[16:19], 0
    v_mfma_f32_32x32x16_bf16 v[48:63], a[36:39], v[20:23], v[48:63]
    v_mfma_f32_32x32x16_bf16 v[48:63], a[40:43], v[24:27], v[48:63]
    v_mfma_f32_32x32x16_bf16 v[48:63], a[44:47], v[28:31], v[48:63]
    ds_read_b64_tr_b16 v[16:17], v3 offset:0
    ds_read_b64_tr_b16 v[18:19], v3 offset:1288
    ds_read_b64_tr_b16 v[20:21], v3 offset:5152
    ds_read_b64_tr_b16 v[22:23], v3 offset:6440
    ds_read_b64_tr_b16 v[24:25], v3 offset:10304
    ds_read_b64_tr_b16 v[26:27], v3 offset:11592
    ds_read_b64_tr_b16 v[28:29], v3 offset:15456
    ds_read_b64_tr_b16 v[30:31], v3 offset:16744
    s_waitcnt lgkmcnt(8)
    v_mfma_f32_32x32x16_bf16 v[48:63], a[48:51], v[32:35], v[48:63]
    v_mfma_f32_32x32x16_bf16 v[48:63], a[52:55], v[36:39], v[48:63]
    v_mfma_f32_32x32x16_bf16 v[48:63], a[56:59], v[40:43], v[48:63]
    v_mfma_f32_32x32x16_bf16 v[48:63], a[60:63], v[44:47], v[48:63]
    ds_read_b64_tr_b16 v[32:33], v3 offset:20608
    ds_read_b64_tr_b16 v[34:35], v3 offset:21896
    ds_read_b64_tr_b16 v[36:37], v3 offset:25760
    ds_read_b64_tr_b16 v[38:39], v3 offset:27048
    ds_read_b64_tr_b16 v[40:41], v3 offset:30912
    ds_read_b64_tr_b16 v[42:43], v3 offset:32200
    ds_read_b64_tr_b16 v[44:45], v3 offset:36064
    ds_read_b64_tr_b16 v[46:47], v3 offset:37352
    s_waitcnt lgkmcnt(8)
    v_mfma_f32_32x32x16_bf16 v[48:63], a[64:67], v[16:19], v[48:63]
    v_mfma_f32_32x32x16_bf16 v[48:63], a[68:71], v[20:23], v[48:63]
    v_mfma_f32_32x32x16_bf16 v[48:63], a[72:75], v[24:27], v[48:63]
    v_mfma_f32_32x32x16_bf16 v[48:63], a[76:79], v[28:31], v[48:63]
    ds_read_b64_tr_b16 v[16:17], v2 offset:64
    ds_read_b64_tr_b16 v[18:19], v2 offset:1352
    ds_read_b64_tr_b16 v[20:21], v2 offset:5216
    ds_read_b64_tr_b16 v[22:23], v2 offset:6504
    ds_read_b64_tr_b16 v[24:25], v2 offset:10368
    ds_read_b64_tr_b16 v[26:27], v2 offset:11656
    ds_read_b64_tr_b16 v[28:29], v2 offset:15520
    ds_read_b64_tr_b16 v[30:31], v2 offset:16808
    s_waitcnt lgkmcnt(8)
    v_mfma_f32_32x32x16_bf16 v[48:63], a[80:83], v[32:35], v[48:63]
    v_mfma_f32_32x32x16_bf16 v[48:63], a[84:87], v[36:39], v[48:63]
    v_mfma_f32_32x32x16_bf16 v[48:63], a[88:91], v[40:43], v[48:63]
    v_mfma_f32_32x32x16_bf16 v[48:63], a[92:95], v[44:47], v[48:63]
    ds_read_b64_tr_b16 v[32:33], v2 offset:20672
    ds_read_b64_tr_b16 v[34:35], v2 offset:21960
    ds_read_b64_tr_b16 v[36:37], v2 offset:25824
    ds_read_b64_tr_b16 v[38:39], v2 offset:27112
    ds_read_b64_tr_b16 v[40:41], v2 offset:30976
    ds_read_b64_tr_b16 v[42:43], v2 offset:32264
    ds_read_b64_tr_b16 v[44:45], v2 offset:36128
    ds_read_b64_tr_b16 v[46:47], v2 offset:37416
    s_waitcnt lgkmcnt(8)
    v_mfma_f32_32x32x16_bf16 v[64:79], a[32:35], v[16:19], 0
    v_mfma_f32_32x32x16_bf16 v[64:79], a[36:39], v[20:23], v[64:79]
    v_mfma_f32_32x32x16_bf16 v[64:79], a[40:43], v[24:27], v[64:79]
    v_mfma_f32_32x32x16_bf16 v[64:79], a[44:47], v[28:31], v[64:79]
    v_cvt_pk_bf16_f32 v80, v48, v49
    v_cvt_pk_bf16_f32 v81, v50, v51
    v_cvt_pk_bf16_f32 v82, v52, v53
    v_cvt_pk_bf16_f32 v83, v54, v55
    v_cvt_pk_bf16_f32 v84, v56, v57
    v_cvt_pk_bf16_f32 v85, v58, v59
    v_cvt_pk_bf16_f32 v86, v60, v61
    v_cvt_pk_bf16_f32 v87, v62, v63
    ds_write_b64 v5, v[80:81] offset:0
    ds_write_b64 v5, v[82:83] offset:16
    ds_write_b64 v5, v[84:85] offset:32
    ds_write_b64 v5, v[86:87] offset:48
    ds_read_b128 v[96:99], v6 offset:0
    ds_read_b128 v[100:103], v6 offset:1280
    ds_read_b64_tr_b16 v[16:17], v3 offset:64
    ds_read_b64_tr_b16 v[18:19], v3 offset:1352
    ds_read_b64_tr_b16 v[20:21], v3 offset:5216
    ds_read_b64_tr_b16 v[22:23], v3 offset:6504
    ds_read_b64_tr_b16 v[24:25], v3 offset:10368
    ds_read_b64_tr_b16 v[26:27], v3 offset:11656
    ds_read_b64_tr_b16 v[28:29], v3 offset:15520
    ds_read_b64_tr_b16 v[30:31], v3 offset:16808
    s_waitcnt lgkmcnt(8)
    v_mfma_f32_32x32x16_bf16 v[64:79], a[48:51], v[32:35], v[64:79]
    v_mfma_f32_32x32x16_bf16 v[64:79], a[52:55], v[36:39], v[64:79]
    v_mfma_f32_32x32x16_bf16 v[64:79], a[56:59], v[40:43], v[64:79]
    v_mfma_f32_32x32x16_bf16 v[64:79], a[60:63], v[44:47], v[64:79]
    buffer_store_dwordx4 v[96:99], v4, s[28:31], 0 offen
    v_add_u32 v4, 2097152, v4
    buffer_store_dwordx4 v[100:103], v4, s[28:31], 0 offen
    v_add_u32 v4, 2097152, v4
    ds_read_b64_tr_b16 v[32:33], v3 offset:20672
    ds_read_b64_tr_b16 v[34:35], v3 offset:21960
    ds_read_b64_tr_b16 v[36:37], v3 offset:25824
    ds_read_b64_tr_b16 v[38:39], v3 offset:27112
    ds_read_b64_tr_b16 v[40:41], v3 offset:30976
    ds_read_b64_tr_b16 v[42:43], v3 offset:32264
    ds_read_b64_tr_b16 v[44:45], v3 offset:36128
    ds_read_b64_tr_b16 v[46:47], v3 offset:37416
    s_waitcnt lgkmcnt(8)
    v_mfma_f32_32x32x16_bf16 v[64:79], a[64:67], v[16:19], v[64:79]
    v_mfma_f32_32x32x16_bf16 v[64:79], a[68:71], v[20:23], v[64:79]
    v_mfma_f32_32x32x16_bf16 v[64:79], a[72:75], v[24:27], v[64:79]
    v_mfma_f32_32x32x16_bf16 v[64:79], a[76:79], v[28:31], v[64:79]
    ds_read_b64_tr_b16 v[16:17], v2 offset:128
    ds_read_b64_tr_b16 v[18:19], v2 offset:1416
    ds_read_b64_tr_b16 v[20:21], v2 offset:5280
    ds_read_b64_tr_b16 v[22:23], v2 offset:6568
    ds_read_b64_tr_b16 v[24:25], v2 offset:10432
    ds_read_b64_tr_b16 v[26:27], v2 offset:11720
    ds_read_b64_tr_b16 v[28:29], v2 offset:15584
    ds_read_b64_tr_b16 v[30:31], v2 offset:16872
    s_waitcnt lgkmcnt(8)
    v_mfma_f32_32x32x16_bf16 v[64:79], a[80:83], v[32:35], v[64:79]
    v_mfma_f32_32x32x16_bf16 v[64:79], a[84:87], v[36:39], v[64:79]
    v_mfma_f32_32x32x16_bf16 v[64:79], a[88:91], v[40:43], v[64:79]
    v_mfma_f32_32x32x16_bf16 v[64:79], a[92:95], v[44:47], v[64:79]
    ds_read_b64_tr_b16 v[32:33], v2 offset:20736
    ds_read_b64_tr_b16 v[34:35], v2 offset:22024
    ds_read_b64_tr_b16 v[36:37], v2 offset:25888
    ds_read_b64_tr_b16 v[38:39], v2 offset:27176
    ds_read_b64_tr_b16 v[40:41], v2 offset:31040
    ds_read_b64_tr_b16 v[42:43], v2 offset:32328
    ds_read_b64_tr_b16 v[44:45], v2 offset:36192
    ds_read_b64_tr_b16 v[46:47], v2 offset:37480
    s_waitcnt lgkmcnt(8)
    v_mfma_f32_32x32x16_bf16 v[48:63], a[32:35], v[16:19], 0
    v_mfma_f32_32x32x16_bf16 v[48:63], a[36:39], v[20:23], v[48:63]
    v_mfma_f32_32x32x16_bf16 v[48:63], a[40:43], v[24:27], v[48:63]
    v_mfma_f32_32x32x16_bf16 v[48:63], a[44:47], v[28:31], v[48:63]
    v_cvt_pk_bf16_f32 v88, v64, v65
    v_cvt_pk_bf16_f32 v89, v66, v67
    v_cvt_pk_bf16_f32 v90, v68, v69
    v_cvt_pk_bf16_f32 v91, v70, v71
    v_cvt_pk_bf16_f32 v92, v72, v73
    v_cvt_pk_bf16_f32 v93, v74, v75
    v_cvt_pk_bf16_f32 v94, v76, v77
    v_cvt_pk_bf16_f32 v95, v78, v79
    ds_write_b64 v5, v[88:89] offset:2560
    ds_write_b64 v5, v[90:91] offset:2576
    ds_write_b64 v5, v[92:93] offset:2592
    ds_write_b64 v5, v[94:95] offset:2608
    ds_read_b128 v[104:107], v6 offset:2560
    ds_read_b128 v[108:111], v6 offset:3840
    ds_read_b64_tr_b16 v[16:17], v3 offset:128
    ds_read_b64_tr_b16 v[18:19], v3 offset:1416
    ds_read_b64_tr_b16 v[20:21], v3 offset:5280
    ds_read_b64_tr_b16 v[22:23], v3 offset:6568
    ds_read_b64_tr_b16 v[24:25], v3 offset:10432
    ds_read_b64_tr_b16 v[26:27], v3 offset:11720
    ds_read_b64_tr_b16 v[28:29], v3 offset:15584
    ds_read_b64_tr_b16 v[30:31], v3 offset:16872
    s_waitcnt lgkmcnt(8)
    v_mfma_f32_32x32x16_bf16 v[48:63], a[48:51], v[32:35], v[48:63]
    v_mfma_f32_32x32x16_bf16 v[48:63], a[52:55], v[36:39], v[48:63]
    v_mfma_f32_32x32x16_bf16 v[48:63], a[56:59], v[40:43], v[48:63]
    v_mfma_f32_32x32x16_bf16 v[48:63], a[60:63], v[44:47], v[48:63]
    buffer_store_dwordx4 v[104:107], v4, s[28:31], 0 offen
    v_add_u32 v4, 2097152, v4
    buffer_store_dwordx4 v[108:111], v4, s[28:31], 0 offen
    v_add_u32 v4, 2097152, v4
    ds_read_b64_tr_b16 v[32:33], v3 offset:20736
    ds_read_b64_tr_b16 v[34:35], v3 offset:22024
    ds_read_b64_tr_b16 v[36:37], v3 offset:25888
    ds_read_b64_tr_b16 v[38:39], v3 offset:27176
    ds_read_b64_tr_b16 v[40:41], v3 offset:31040
    ds_read_b64_tr_b16 v[42:43], v3 offset:32328
    ds_read_b64_tr_b16 v[44:45], v3 offset:36192
    ds_read_b64_tr_b16 v[46:47], v3 offset:37480
    s_waitcnt lgkmcnt(8)
    v_mfma_f32_32x32x16_bf16 v[48:63], a[64:67], v[16:19], v[48:63]
    v_mfma_f32_32x32x16_bf16 v[48:63], a[68:71], v[20:23], v[48:63]
    v_mfma_f32_32x32x16_bf16 v[48:63], a[72:75], v[24:27], v[48:63]
    v_mfma_f32_32x32x16_bf16 v[48:63], a[76:79], v[28:31], v[48:63]
    ds_read_b64_tr_b16 v[16:17], v2 offset:192
    ds_read_b64_tr_b16 v[18:19], v2 offset:1480
    ds_read_b64_tr_b16 v[20:21], v2 offset:5344
    ds_read_b64_tr_b16 v[22:23], v2 offset:6632
    ds_read_b64_tr_b16 v[24:25], v2 offset:10496
    ds_read_b64_tr_b16 v[26:27], v2 offset:11784
    ds_read_b64_tr_b16 v[28:29], v2 offset:15648
    ds_read_b64_tr_b16 v[30:31], v2 offset:16936
    s_waitcnt lgkmcnt(8)
    v_mfma_f32_32x32x16_bf16 v[48:63], a[80:83], v[32:35], v[48:63]
    v_mfma_f32_32x32x16_bf16 v[48:63], a[84:87], v[36:39], v[48:63]
    v_mfma_f32_32x32x16_bf16 v[48:63], a[88:91], v[40:43], v[48:63]
    v_mfma_f32_32x32x16_bf16 v[48:63], a[92:95], v[44:47], v[48:63]
    ds_read_b64_tr_b16 v[32:33], v2 offset:20800
    ds_read_b64_tr_b16 v[34:35], v2 offset:22088
    ds_read_b64_tr_b16 v[36:37], v2 offset:25952
    ds_read_b64_tr_b16 v[38:39], v2 offset:27240
    ds_read_b64_tr_b16 v[40:41], v2 offset:31104
    ds_read_b64_tr_b16 v[42:43], v2 offset:32392
    ds_read_b64_tr_b16 v[44:45], v2 offset:36256
    ds_read_b64_tr_b16 v[46:47], v2 offset:37544
    s_waitcnt lgkmcnt(8)
    v_mfma_f32_32x32x16_bf16 v[64:79], a[32:35], v[16:19], 0
    v_mfma_f32_32x32x16_bf16 v[64:79], a[36:39], v[20:23], v[64:79]
    v_mfma_f32_32x32x16_bf16 v[64:79], a[40:43], v[24:27], v[64:79]
    v_mfma_f32_32x32x16_bf16 v[64:79], a[44:47], v[28:31], v[64:79]
    v_cvt_pk_bf16_f32 v80, v48, v49
    v_cvt_pk_bf16_f32 v81, v50, v51
    v_cvt_pk_bf16_f32 v82, v52, v53
    v_cvt_pk_bf16_f32 v83, v54, v55
    v_cvt_pk_bf16_f32 v84, v56, v57
    v_cvt_pk_bf16_f32 v85, v58, v59
    v_cvt_pk_bf16_f32 v86, v60, v61
    v_cvt_pk_bf16_f32 v87, v62, v63
    ds_write_b64 v5, v[80:81] offset:0
    ds_write_b64 v5, v[82:83] offset:16
    ds_write_b64 v5, v[84:85] offset:32
    ds_write_b64 v5, v[86:87] offset:48
    ds_read_b128 v[96:99], v6 offset:0
    ds_read_b128 v[100:103], v6 offset:1280
    ds_read_b64_tr_b16 v[16:17], v3 offset:192
    ds_read_b64_tr_b16 v[18:19], v3 offset:1480
    ds_read_b64_tr_b16 v[20:21], v3 offset:5344
    ds_read_b64_tr_b16 v[22:23], v3 offset:6632
    ds_read_b64_tr_b16 v[24:25], v3 offset:10496
    ds_read_b64_tr_b16 v[26:27], v3 offset:11784
    ds_read_b64_tr_b16 v[28:29], v3 offset:15648
    ds_read_b64_tr_b16 v[30:31], v3 offset:16936
    s_waitcnt lgkmcnt(8)
    v_mfma_f32_32x32x16_bf16 v[64:79], a[48:51], v[32:35], v[64:79]
    v_mfma_f32_32x32x16_bf16 v[64:79], a[52:55], v[36:39], v[64:79]
    v_mfma_f32_32x32x16_bf16 v[64:79], a[56:59], v[40:43], v[64:79]
    v_mfma_f32_32x32x16_bf16 v[64:79], a[60:63], v[44:47], v[64:79]
    buffer_store_dwordx4 v[96:99], v4, s[28:31], 0 offen
    v_add_u32 v4, 2097152, v4
    buffer_store_dwordx4 v[100:103], v4, s[28:31], 0 offen
    v_add_u32 v4, 2097152, v4
    ds_read_b64_tr_b16 v[32:33], v3 offset:20800
    ds_read_b64_tr_b16 v[34:35], v3 offset:22088
    ds_read_b64_tr_b16 v[36:37], v3 offset:25952
    ds_read_b64_tr_b16 v[38:39], v3 offset:27240
    ds_read_b64_tr_b16 v[40:41], v3 offset:31104
    ds_read_b64_tr_b16 v[42:43], v3 offset:32392
    ds_read_b64_tr_b16 v[44:45], v3 offset:36256
    ds_read_b64_tr_b16 v[46:47], v3 offset:37544
    s_waitcnt lgkmcnt(8)
    v_mfma_f32_32x32x16_bf16 v[64:79], a[64:67], v[16:19], v[64:79]
    v_mfma_f32_32x32x16_bf16 v[64:79], a[68:71], v[20:23], v[64:79]
    v_mfma_f32_32x32x16_bf16 v[64:79], a[72:75], v[24:27], v[64:79]
    v_mfma_f32_32x32x16_bf16 v[64:79], a[76:79], v[28:31], v[64:79]
    ds_read_b64_tr_b16 v[16:17], v2 offset:256
    ds_read_b64_tr_b16 v[18:19], v2 offset:1544
    ds_read_b64_tr_b16 v[20:21], v2 offset:5408
    ds_read_b64_tr_b16 v[22:23], v2 offset:6696
    ds_read_b64_tr_b16 v[24:25], v2 offset:10560
    ds_read_b64_tr_b16 v[26:27], v2 offset:11848
    ds_read_b64_tr_b16 v[28:29], v2 offset:15712
    ds_read_b64_tr_b16 v[30:31], v2 offset:17000
    s_waitcnt lgkmcnt(8)
    v_mfma_f32_32x32x16_bf16 v[64:79], a[80:83], v[32:35], v[64:79]
    v_mfma_f32_32x32x16_bf16 v[64:79], a[84:87], v[36:39], v[64:79]
    v_mfma_f32_32x32x16_bf16 v[64:79], a[88:91], v[40:43], v[64:79]
    v_mfma_f32_32x32x16_bf16 v[64:79], a[92:95], v[44:47], v[64:79]
    ds_read_b64_tr_b16 v[32:33], v2 offset:20864
    ds_read_b64_tr_b16 v[34:35], v2 offset:22152
    ds_read_b64_tr_b16 v[36:37], v2 offset:26016
    ds_read_b64_tr_b16 v[38:39], v2 offset:27304
    ds_read_b64_tr_b16 v[40:41], v2 offset:31168
    ds_read_b64_tr_b16 v[42:43], v2 offset:32456
    ds_read_b64_tr_b16 v[44:45], v2 offset:36320
    ds_read_b64_tr_b16 v[46:47], v2 offset:37608
    s_waitcnt lgkmcnt(8)
    v_mfma_f32_32x32x16_bf16 v[48:63], a[32:35], v[16:19], 0
    v_mfma_f32_32x32x16_bf16 v[48:63], a[36:39], v[20:23], v[48:63]
    v_mfma_f32_32x32x16_bf16 v[48:63], a[40:43], v[24:27], v[48:63]
    v_mfma_f32_32x32x16_bf16 v[48:63], a[44:47], v[28:31], v[48:63]
    v_cvt_pk_bf16_f32 v88, v64, v65
    v_cvt_pk_bf16_f32 v89, v66, v67
    v_cvt_pk_bf16_f32 v90, v68, v69
    v_cvt_pk_bf16_f32 v91, v70, v71
    v_cvt_pk_bf16_f32 v92, v72, v73
    v_cvt_pk_bf16_f32 v93, v74, v75
    v_cvt_pk_bf16_f32 v94, v76, v77
    v_cvt_pk_bf16_f32 v95, v78, v79
    ds_write_b64 v5, v[88:89] offset:2560
    ds_write_b64 v5, v[90:91] offset:2576
    ds_write_b64 v5, v[92:93] offset:2592
    ds_write_b64 v5, v[94:95] offset:2608
    ds_read_b128 v[104:107], v6 offset:2560
    ds_read_b128 v[108:111], v6 offset:3840
    ds_read_b64_tr_b16 v[16:17], v3 offset:256
    ds_read_b64_tr_b16 v[18:19], v3 offset:1544
    ds_read_b64_tr_b16 v[20:21], v3 offset:5408
    ds_read_b64_tr_b16 v[22:23], v3 offset:6696
    ds_read_b64_tr_b16 v[24:25], v3 offset:10560
    ds_read_b64_tr_b16 v[26:27], v3 offset:11848
    ds_read_b64_tr_b16 v[28:29], v3 offset:15712
    ds_read_b64_tr_b16 v[30:31], v3 offset:17000
    s_waitcnt lgkmcnt(8)
    v_mfma_f32_32x32x16_bf16 v[48:63], a[48:51], v[32:35], v[48:63]
    v_mfma_f32_32x32x16_bf16 v[48:63], a[52:55], v[36:39], v[48:63]
    v_mfma_f32_32x32x16_bf16 v[48:63], a[56:59], v[40:43], v[48:63]
    v_mfma_f32_32x32x16_bf16 v[48:63], a[60:63], v[44:47], v[48:63]
    buffer_store_dwordx4 v[104:107], v4, s[28:31], 0 offen
    v_add_u32 v4, 2097152, v4
    buffer_store_dwordx4 v[108:111], v4, s[28:31], 0 offen
    v_add_u32 v4, 2097152, v4
    ds_read_b64_tr_b16 v[32:33], v3 offset:20864
    ds_read_b64_tr_b16 v[34:35], v3 offset:22152
    ds_read_b64_tr_b16 v[36:37], v3 offset:26016
    ds_read_b64_tr_b16 v[38:39], v3 offset:27304
    ds_read_b64_tr_b16 v[40:41], v3 offset:31168
    ds_read_b64_tr_b16 v[42:43], v3 offset:32456
    ds_read_b64_tr_b16 v[44:45], v3 offset:36320
    ds_read_b64_tr_b16 v[46:47], v3 offset:37608
    s_waitcnt lgkmcnt(8)
    v_mfma_f32_32x32x16_bf16 v[48:63], a[64:67], v[16:19], v[48:63]
    v_mfma_f32_32x32x16_bf16 v[48:63], a[68:71], v[20:23], v[48:63]
    v_mfma_f32_32x32x16_bf16 v[48:63], a[72:75], v[24:27], v[48:63]
    v_mfma_f32_32x32x16_bf16 v[48:63], a[76:79], v[28:31], v[48:63]
    s_waitcnt lgkmcnt(0)
    v_mfma_f32_32x32x16_bf16 v[48:63], a[80:83], v[32:35], v[48:63]
    v_mfma_f32_32x32x16_bf16 v[48:63], a[84:87], v[36:39], v[48:63]
    v_mfma_f32_32x32x16_bf16 v[48:63], a[88:91], v[40:43], v[48:63]
    v_mfma_f32_32x32x16_bf16 v[48:63], a[92:95], v[44:47], v[48:63]
    s_nop 11
    v_cvt_pk_bf16_f32 v80, v48, v49
    v_cvt_pk_bf16_f32 v81, v50, v51
    v_cvt_pk_bf16_f32 v82, v52, v53
    v_cvt_pk_bf16_f32 v83, v54, v55
    v_cvt_pk_bf16_f32 v84, v56, v57
    v_cvt_pk_bf16_f32 v85, v58, v59
    v_cvt_pk_bf16_f32 v86, v60, v61
    v_cvt_pk_bf16_f32 v87, v62, v63
    ds_write_b64 v5, v[80:81] offset:0
    ds_write_b64 v5, v[82:83] offset:16
    ds_write_b64 v5, v[84:85] offset:32
    ds_write_b64 v5, v[86:87] offset:48
    ds_read_b128 v[96:99], v6 offset:0
    ds_read_b128 v[100:103], v6 offset:1280
    s_waitcnt lgkmcnt(0)
    buffer_store_dwordx4 v[96:99], v4, s[28:31], 0 offen
    v_add_u32 v4, 2097152, v4
    buffer_store_dwordx4 v[100:103], v4, s[28:31], 0 offen
    v_add_u32 v4, 2097152, v4
L_end:
    s_endpgm
.section .rodata,"a"
.p2align 6
.amdhsa_kernel bin_edges_kernel
  .amdhsa_next_free_vgpr 48
  .amdhsa_next_free_sgpr 40
  .amdhsa_accum_offset 48
  .amdhsa_group_segment_fixed_size 0
  .amdhsa_kernarg_size 88
  .amdhsa_user_sgpr_count 2
  .amdhsa_user_sgpr_kernarg_segment_ptr 1
  .amdhsa_system_sgpr_workgroup_id_x 1
  .amdhsa_float_denorm_mode_32 3
.end_amdhsa_kernel
.section .rodata,"a"
.p2align 6
.amdhsa_kernel standalone__tensor_product_equiv_mace__graph_kernel
  .amdhsa_next_free_vgpr 256
  .amdhsa_next_free_sgpr 102
  .amdhsa_accum_offset 160
  .amdhsa_group_segment_fixed_size 0
  .amdhsa_kernarg_size 88
  .amdhsa_user_sgpr_count 2
  .amdhsa_user_sgpr_kernarg_segment_ptr 1
  .amdhsa_system_sgpr_workgroup_id_x 1
  .amdhsa_float_denorm_mode_32 3
.end_amdhsa_kernel
```

```asm
; @launch kernel=bin_edges_kernel grid=(80,1,1) block=(640,1,1) lds=33792
; @launch kernel=standalone__tensor_product_equiv_mace__graph_kernel grid=(256,1,1) block=(512,1,1) lds=124160
.amdgcn_target "amdgcn-amd-amdhsa--gfx950"
.text
.globl bin_edges_kernel
.p2align 8
.type bin_edges_kernel,@function
bin_edges_kernel:
    s_cmp_ge_u32 s2, 80
    s_cbranch_scc1 K_end
    s_load_dwordx16 s[16:31], s[0:1], 0
    s_load_dwordx2 s[32:33], s[0:1], 80
    s_cmp_ge_u32 s2, 64
    s_cbranch_scc1 K_weights
    s_mul_i32 s3, s2, 10000
    v_lshlrev_b32 v1, 4, v0
    v_add_u32 v2, s3, v1
    s_mov_b32 s14, 625
    v_cmp_gt_u32 s[34:35], s14, v0
    s_waitcnt lgkmcnt(0)
    s_mov_b32 s4, s20
    s_mov_b32 s5, s21
    s_mov_b32 s6, 640000
    s_mov_b32 s7, 0x00020000
    buffer_load_dwordx4 v[4:7], v2, s[4:7], 0 offen
    s_mov_b32 s8, s18
    s_mov_b32 s9, s19
    s_mov_b32 s10, 640000
    s_mov_b32 s11, 0x00020000
    buffer_load_dwordx4 v[8:11], v2, s[8:11], 0 offen
    s_mov_b32 s12, s32
    s_mov_b32 s13, s33
    s_mov_b32 s14, 8388608
    s_mov_b32 s15, 0x00020000
    v_mov_b32 v12, -1
    v_mov_b32 v13, -1
    v_mov_b32 v14, -1
    v_mov_b32 v15, -1
    ds_write_b128 v1, v[12:15]
    ds_write_b128 v1, v[12:15] offset:10240
    ds_write_b128 v1, v[12:15] offset:20480
    v_cmp_gt_u32 vcc, 128, v0
    v_mov_b32 v16, 0
    v_mov_b32 v17, 0
    v_lshlrev_b32 v3, 3, v0
    s_mov_b64 exec, vcc
    ds_write_b128 v1, v[12:15] offset:30720
    ds_write_b64 v3, v[16:17] offset:32768
    s_mov_b64 exec, -1
    v_mov_b32 v18, 1
    v_lshlrev_b32 v19, 22, v0
    v_lshrrev_b32 v2, 3, v0
    v_lshlrev_b32 v2, 13, v2
    v_and_b32 v3, 7, v0
    v_lshl_add_u32 v2, v3, 4, v2
    s_lshl_b32 s3, s2, 7
    v_add_u32 v2, s3, v2
    s_waitcnt lgkmcnt(0)
    s_barrier
    s_waitcnt vmcnt(1)
    v_and_b32 v20, 255, v4
    v_lshlrev_b32 v24, 2, v20
    v_and_b32 v21, 255, v5
    v_lshlrev_b32 v25, 2, v21
    v_and_b32 v22, 255, v6
    v_lshlrev_b32 v26, 2, v22
    v_and_b32 v23, 255, v7
    v_lshlrev_b32 v27, 2, v23
    s_mov_b64 exec, s[34:35]
    ds_add_rtn_u32 v28, v24, v18 offset:32768
    ds_add_rtn_u32 v29, v25, v18 offset:32768
    ds_add_rtn_u32 v30, v26, v18 offset:32768
    ds_add_rtn_u32 v31, v27, v18 offset:32768
    s_mov_b64 exec, -1
    s_waitcnt vmcnt(0)
    v_bfe_u32 v4, v4, 8, 6
    v_min_u32 v4, 47, v4
    v_and_b32 v8, 0x3fff, v8
    v_lshl_or_b32 v4, v8, 6, v4
    v_add_u32 v8, 0, v19
    v_or_b32 v4, v4, v8
    v_bfe_u32 v5, v5, 8, 6
    v_min_u32 v5, 47, v5
    v_and_b32 v9, 0x3fff, v9
    v_lshl_or_b32 v5, v9, 6, v5
    v_add_u32 v9, 1048576, v19
    v_or_b32 v5, v5, v9
    v_bfe_u32 v6, v6, 8, 6
    v_min_u32 v6, 47, v6
    v_and_b32 v10, 0x3fff, v10
    v_lshl_or_b32 v6, v10, 6, v6
    v_add_u32 v10, 2097152, v19
    v_or_b32 v6, v6, v10
    v_bfe_u32 v7, v7, 8, 6
    v_min_u32 v7, 47, v7
    v_and_b32 v11, 0x3fff, v11
    v_lshl_or_b32 v7, v11, 6, v7
    v_add_u32 v11, 3145728, v19
    v_or_b32 v7, v7, v11
    v_mov_b32 v12, -2
    s_waitcnt lgkmcnt(0)
    v_cmp_gt_u32 vcc, 31, v28
    v_min_u32 v28, 31, v28
    v_lshlrev_b32 v28, 2, v28
    v_cndmask_b32 v4, v12, v4, vcc
    v_lshl_add_u32 v28, v20, 7, v28
    v_cmp_gt_u32 vcc, 31, v29
    v_min_u32 v29, 31, v29
    v_lshlrev_b32 v29, 2, v29
    v_cndmask_b32 v5, v12, v5, vcc
    v_lshl_add_u32 v29, v21, 7, v29
    v_cmp_gt_u32 vcc, 31, v30
    v_min_u32 v30, 31, v30
    v_lshlrev_b32 v30, 2, v30
    v_cndmask_b32 v6, v12, v6, vcc
    v_lshl_add_u32 v30, v22, 7, v30
    v_cmp_gt_u32 vcc, 31, v31
    v_min_u32 v31, 31, v31
    v_lshlrev_b32 v31, 2, v31
    v_cndmask_b32 v7, v12, v7, vcc
    v_lshl_add_u32 v31, v23, 7, v31
    s_mov_b64 exec, s[34:35]
    ds_write_b32 v28, v4
    ds_write_b32 v29, v5
    ds_write_b32 v30, v6
    ds_write_b32 v31, v7
    s_mov_b64 exec, -1
    v_cmp_gt_u32 vcc, 128, v0
    s_waitcnt lgkmcnt(0)
    s_barrier
    ds_read_b128 v[32:35], v1 offset:0
    ds_read_b128 v[36:39], v1 offset:10240
    ds_read_b128 v[40:43], v1 offset:20480
    ds_read_b128 v[44:47], v1 offset:30720
    s_waitcnt lgkmcnt(3)
    buffer_store_dwordx4 v[32:35], v2, s[12:15], 0 offen
    v_add_u32 v2, 655360, v2
    s_waitcnt lgkmcnt(2)
    buffer_store_dwordx4 v[36:39], v2, s[12:15], 0 offen
    v_add_u32 v2, 655360, v2
    s_waitcnt lgkmcnt(1)
    buffer_store_dwordx4 v[40:43], v2, s[12:15], 0 offen
    v_add_u32 v2, 655360, v2
    s_and_saveexec_b64 s[36:37], vcc
    s_cbranch_execz K_end
    s_waitcnt lgkmcnt(0)
    buffer_store_dwordx4 v[44:47], v2, s[12:15], 0 offen
    s_branch K_end
K_weights:
    v_lshrrev_b32 v1, 6, v0
    v_and_b32 v2, 63, v0
    v_readfirstlane_b32 s3, v1
    s_sub_u32 s34, s2, 64
    s_mul_i32 s34, s34, 10
    s_add_u32 s3, s3, s34
    s_cmp_ge_u32 s3, 137
    s_cbranch_scc1 K_end
    s_waitcnt lgkmcnt(0)
    s_mov_b32 s12, s32
    s_mov_b32 s13, s33
    s_mov_b32 s14, 8388608
    s_mov_b32 s15, 0x00020000
    s_lshl_b32 s34, s3, 10
    s_add_u32 s34, s34, 2097152
    v_lshlrev_b32 v3, 4, v2
    v_add_u32 v3, s34, v3
    s_cmp_ge_u32 s3, 136
    s_cbranch_scc1 K_cg
    s_cmp_ge_u32 s3, 128
    s_cbranch_scc1 K_wr
    s_mov_b32 s4, s30
    s_mov_b32 s5, s31
    s_mov_b32 s6, 131072
    s_mov_b32 s7, 0x00020000
    s_and_b32 s34, s3, 15
    s_lshl_b32 s34, s34, 13
    s_lshr_b32 s35, s3, 4
    s_lshl_b32 s35, s35, 6
    s_add_u32 s34, s34, s35
    v_lshrrev_b32 v4, 5, v2
    v_lshlrev_b32 v4, 12, v4
    v_and_b32 v5, 31, v2
    v_lshl_add_u32 v4, v5, 1, v4
    v_add_u32 v4, s34, v4
    s_branch K_wgo
K_wr:
    s_mov_b32 s4, s28
    s_mov_b32 s5, s29
    s_mov_b32 s6, 8192
    s_mov_b32 s7, 0x00020000
    s_sub_u32 s34, s3, 128
    s_lshl_b32 s34, s34, 6
    v_bfe_u32 v4, v2, 4, 1
    v_lshlrev_b32 v4, 12, v4
    v_lshrrev_b32 v5, 5, v2
    v_lshl_add_u32 v4, v5, 5, v4
    v_and_b32 v5, 15, v2
    v_lshl_add_u32 v4, v5, 1, v4
    v_add_u32 v4, s34, v4
K_wgo:
    buffer_load_ushort v16, v4, s[4:7], 0 offen offset:0
    buffer_load_ushort v17, v4, s[4:7], 0 offen offset:512
    buffer_load_ushort v18, v4, s[4:7], 0 offen offset:1024
    buffer_load_ushort v19, v4, s[4:7], 0 offen offset:1536
    buffer_load_ushort v20, v4, s[4:7], 0 offen offset:2048
    buffer_load_ushort v21, v4, s[4:7], 0 offen offset:2560
    buffer_load_ushort v22, v4, s[4:7], 0 offen offset:3072
    buffer_load_ushort v23, v4, s[4:7], 0 offen offset:3584
    s_branch K_wst
K_cg:
    s_mov_b32 s4, s26
    s_mov_b32 s5, s27
    s_mov_b32 s6, 128
    s_mov_b32 s7, 0x00020000
    v_and_b32 v4, 3, v2
    v_lshlrev_b32 v4, 5, v4
    v_lshrrev_b32 v5, 4, v2
    v_lshl_add_u32 v4, v5, 1, v4
    buffer_load_ushort v16, v4, s[4:7], 0 offen offset:0
    buffer_load_ushort v17, v4, s[4:7], 0 offen offset:8
    buffer_load_ushort v18, v4, s[4:7], 0 offen offset:16
    buffer_load_ushort v19, v4, s[4:7], 0 offen offset:24
    v_lshlrev_b32 v3, 3, v2
    v_add_u32 v3, 2236416, v3
    s_waitcnt vmcnt(0)
    v_lshl_or_b32 v8, v17, 16, v16
    v_lshl_or_b32 v9, v19, 16, v18
    buffer_store_dwordx2 v[8:9], v3, s[12:15], 0 offen
    s_branch K_end
K_wst:
    s_waitcnt vmcnt(0)
    v_lshl_or_b32 v8, v17, 16, v16
    v_lshl_or_b32 v9, v19, 16, v18
    v_lshl_or_b32 v10, v21, 16, v20
    v_lshl_or_b32 v11, v23, 16, v22
    buffer_store_dwordx4 v[8:11], v3, s[12:15], 0 offen
K_end:
    s_endpgm
.globl standalone__tensor_product_equiv_mace__graph_kernel
.p2align 8
.type standalone__tensor_product_equiv_mace__graph_kernel,@function
standalone__tensor_product_equiv_mace__graph_kernel:
    s_cmp_ge_u32 s2, 256
    s_cbranch_scc1 L_end
    s_load_dwordx2 s[84:85], s[0:1], 80
    s_load_dwordx16 s[64:79], s[0:1], 0
    s_load_dwordx2 s[80:81], s[0:1], 64
    v_and_b32 v1, 63, v0
    v_lshrrev_b32 v60, 6, v0
    v_mov_b32 v12, 0
    v_readfirstlane_b32 s3, v60
    s_lshl_b32 s53, s2, 13
    v_lshlrev_b32 v60, 4, v0
    v_add_u32 v60, s53, v60
    v_lshlrev_b32 v64, 4, v1
    v_add_u32 v61, 2228224, v64
    v_add_u32 v62, 2232320, v64
    v_lshlrev_b32 v63, 3, v1
    v_add_u32 v63, 2236416, v63
    s_waitcnt lgkmcnt(0)
    s_mov_b32 s32, s84
    s_mov_b32 s33, s85
    s_mov_b32 s34, 8388608
    s_mov_b32 s35, 0x00020000
    buffer_load_dwordx4 v[16:19], v60, s[32:35], 0 offen
    s_mov_b32 s8, s64
    s_mov_b32 s9, s65
    s_mov_b32 s10, 20480000
    s_mov_b32 s11, 0x00020000
    s_mov_b32 s12, s66
    s_mov_b32 s13, s67
    s_mov_b32 s14, 640000
    s_mov_b32 s15, 0x00020000
    s_mov_b32 s16, s68
    s_mov_b32 s17, s69
    s_mov_b32 s18, 640000
    s_mov_b32 s19, 0x00020000
    s_mov_b32 s20, s70
    s_mov_b32 s21, s71
    s_mov_b32 s22, 1280000
    s_mov_b32 s23, 0x00020000
    s_mov_b32 s24, s72
    s_mov_b32 s25, s73
    s_mov_b32 s26, 5120000
    s_mov_b32 s27, 0x00020000
    s_mov_b32 s28, s80
    s_mov_b32 s29, s81
    s_mov_b32 s30, 20480000
    s_mov_b32 s31, 0x00020000
    buffer_load_dwordx4 a[0:3], v61, s[32:35], 0 offen offset:0
    buffer_load_dwordx4 a[4:7], v61, s[32:35], 0 offen offset:1024
    buffer_load_dwordx4 a[8:11], v61, s[32:35], 0 offen offset:2048
    buffer_load_dwordx4 a[12:15], v61, s[32:35], 0 offen offset:3072
    buffer_load_dwordx4 a[16:19], v62, s[32:35], 0 offen offset:0
    buffer_load_dwordx4 a[20:23], v62, s[32:35], 0 offen offset:1024
    buffer_load_dwordx4 a[24:27], v62, s[32:35], 0 offen offset:2048
    buffer_load_dwordx4 a[28:31], v62, s[32:35], 0 offen offset:3072
    buffer_load_dwordx2 a[32:33], v63, s[32:35], 0 offen
    v_mov_b32 v68, 0
    v_mov_b32 v69, 0
    v_lshlrev_b32 v60, 3, v0
    v_add_u32 v60, 110848, v60
    ds_write_b64 v60, v[68:69]
    v_and_b32 v60, 3, v1
    v_lshlrev_b32 v60, 3, v60
    v_add_u32 v60, 119040, v60
    ds_write_b64 v60, v[68:69]
    s_lshl_b32 s63, s3, 13
    s_mov_b32 s52, 0
    s_mov_b32 s77, 0
    s_mov_b32 s82, 0x3fff00
    s_waitcnt lgkmcnt(0)
    s_barrier
    v_lshrrev_b32 v66, 4, v1
    v_and_b32 v61, 7, v1
    v_bfe_u32 v65, v1, 3, 1
    v_lshlrev_b32 v65, 9, v65
    v_lshl_add_u32 v65, v66, 7, v65
    v_lshl_add_u32 v2, v61, 4, v65
    v_xor_b32 v61, 4, v61
    v_lshl_add_u32 v3, v61, 4, v65
    v_bfe_u32 v60, v1, 2, 2
    v_bfe_u32 v62, v1, 1, 1
    v_lshl_add_u32 v62, v66, 1, v62
    v_lshrrev_b32 v63, 1, v60
    v_lshlrev_b32 v64, 2, v63
    v_xor_b32 v62, v62, v64
    v_and_b32 v64, 1, v60
    v_lshl_add_u32 v62, v64, 3, v62
    v_lshlrev_b32 v62, 4, v62
    v_lshl_add_u32 v62, v63, 10, v62
    v_and_b32 v64, 1, v1
    v_lshl_add_u32 v62, v64, 3, v62
    v_add_u32 v4, s63, v62
    v_lshrrev_b32 v61, 5, v1
    v_mov_b32 v63, 32
    v_cmp_eq_u32 vcc, v60, v61
    v_add_u32 v61, 2, v61
    v_and_b32 v64, 3, v1
    v_cndmask_b32 v7, 0, v63, vcc
    v_cmp_eq_u32 vcc, v60, v61
    v_cmp_eq_u32 s[4:5], v64, v66
    v_mov_b32 v65, 8
    v_cndmask_b32 v8, 0, v63, vcc
    v_cndmask_b32 v10, 0, v65, s[4:5]
    v_lshrrev_b32 v67, 3, v0
    v_mul_u32_u24 v67, 2500, v67
    v_mov_b32 v69, 114624
    v_mov_b64 v[80:81], 0
    v_mov_b64 v[82:83], 0
    v_mov_b64 v[84:85], 0
    v_mov_b64 v[86:87], 0
    v_mov_b64 v[88:89], 0
    v_mov_b64 v[90:91], 0
    v_mov_b64 v[92:93], 0
    v_mov_b64 v[94:95], 0
    v_mov_b64 v[96:97], 0
    v_mov_b64 v[98:99], 0
    v_mov_b64 v[100:101], 0
    v_mov_b64 v[102:103], 0
    v_mov_b64 v[104:105], 0
    v_mov_b64 v[106:107], 0
    v_mov_b64 v[108:109], 0
    v_mov_b64 v[110:111], 0
    v_mov_b64 v[112:113], 0
    v_mov_b64 v[114:115], 0
    v_mov_b64 v[116:117], 0
    v_mov_b64 v[118:119], 0
    v_mov_b64 v[120:121], 0
    v_mov_b64 v[122:123], 0
    v_mov_b64 v[124:125], 0
    v_mov_b64 v[126:127], 0
    v_mov_b64 v[128:129], 0
    v_mov_b64 v[130:131], 0
    v_mov_b64 v[132:133], 0
    v_mov_b64 v[134:135], 0
    v_mov_b64 v[136:137], 0
    v_mov_b64 v[138:139], 0
    v_mov_b64 v[140:141], 0
    v_mov_b64 v[142:143], 0
    v_mov_b64 v[144:145], 0
    v_mov_b64 v[146:147], 0
    v_mov_b64 v[148:149], 0
    v_mov_b64 v[150:151], 0
    v_mov_b64 v[152:153], 0
    v_mov_b64 v[154:155], 0
    v_mov_b64 v[156:157], 0
    v_mov_b64 v[158:159], 0
    s_waitcnt vmcnt(9)
    v_cmp_gt_u32 s[36:37], -2, v16
    v_cmp_gt_u32 s[38:39], -2, v17
    v_cmp_gt_u32 s[40:41], -2, v18
    v_cmp_gt_u32 s[42:43], -2, v19
    v_cmp_eq_u32 vcc, -2, v19
    s_bcnt1_i32_b64 s79, s[36:37]
    s_bcnt1_i32_b64 s53, s[38:39]
    s_add_u32 s79, s79, s53
    s_bcnt1_i32_b64 s53, s[40:41]
    s_add_u32 s79, s79, s53
    s_bcnt1_i32_b64 s53, s[42:43]
    s_add_u32 s79, s79, s53
    v_mov_b32 v70, s79
    s_mov_b64 exec, 1
    ds_add_rtn_u32 v70, v69, v70
    s_mov_b64 exec, -1
    v_mov_b32 v56, 0
    v_mbcnt_lo_u32_b32 v56, s36, v56
    v_mbcnt_hi_u32_b32 v56, s37, v56
    v_mbcnt_lo_u32_b32 v56, s38, v56
    v_mbcnt_hi_u32_b32 v56, s39, v56
    v_mbcnt_lo_u32_b32 v56, s40, v56
    v_mbcnt_hi_u32_b32 v56, s41, v56
    v_mbcnt_lo_u32_b32 v56, s42, v56
    v_mbcnt_hi_u32_b32 v56, s43, v56
    s_add_u32 s53, s63, 4096
    v_lshl_add_u32 v58, v56, 2, s53
    v_lshrrev_b32 v20, 20, v16
    v_add_u32 v20, v20, v67
    s_mov_b64 exec, s[36:37]
    ds_write_b32 v58, v20 offset:0
    s_mov_b64 exec, -1
    v_lshrrev_b32 v21, 20, v17
    v_add_u32 v21, v21, v67
    s_mov_b64 exec, s[38:39]
    ds_write_b32 v58, v21 offset:4
    s_mov_b64 exec, -1
    v_lshrrev_b32 v22, 20, v18
    v_add_u32 v22, v22, v67
    s_mov_b64 exec, s[40:41]
    ds_write_b32 v58, v22 offset:8
    s_mov_b64 exec, -1
    v_lshrrev_b32 v23, 20, v19
    v_add_u32 v23, v23, v67
    s_mov_b64 exec, s[42:43]
    ds_write_b32 v58, v23 offset:12
    s_mov_b64 exec, -1
    v_lshlrev_b32 v24, 2, v16
    v_and_b32 v24, s82, v24
    v_and_b32 v16, 63, v16
    v_lshlrev_b32 v25, 2, v17
    v_and_b32 v25, s82, v25
    v_and_b32 v17, 63, v17
    v_lshlrev_b32 v26, 2, v18
    v_and_b32 v26, s82, v26
    v_and_b32 v18, 63, v18
    v_lshlrev_b32 v27, 2, v19
    v_and_b32 v27, s82, v27
    v_and_b32 v19, 63, v19
    s_mov_b32 s80, 79
    s_waitcnt lgkmcnt(0)
    v_readfirstlane_b32 s44, v70
    s_cbranch_vccnz L_defer
    s_add_u32 s53, s44, s79
    s_cmp_gt_u32 s53, 1024
    s_cbranch_scc1 L_defer
    v_add_u32 v56, s44, v56
    v_lshl_or_b32 v24, v56, 22, v24
    v_add_u32 v56, 1, v56
    v_lshl_or_b32 v25, v56, 22, v25
    v_add_u32 v56, 1, v56
    v_lshl_or_b32 v26, v56, 22, v26
    v_add_u32 v56, 1, v56
    v_lshl_or_b32 v27, v56, 22, v27
    s_branch L_have
L_defer:
    s_mov_b32 s80, 0
    s_mov_b32 s79, 0
    s_mov_b32 s44, 0
    s_mov_b64 s[36:37], 0
    s_mov_b64 s[38:39], 0
    s_mov_b64 s[40:41], 0
    s_mov_b64 s[42:43], 0
    v_mov_b32 v58, 1
    v_mov_b32 v59, 119056
    ds_write_b32 v59, v58
    s_branch L_have
L_scan:
    s_barrier
    s_mov_b32 s64, s63
    s_add_u32 s65, s63, 1024
    s_xor_b32 s47, s2, 1
L_sloop:
    s_cmp_ge_u32 s80, 79
    s_cbranch_scc1 L_scan_done
    s_mul_i32 s53, s3, 20000
    s_lshl_b32 s54, s80, 8
    s_add_u32 s55, s53, s54
    v_lshlrev_b32 v56, 2, v1
    v_add_u32 v56, s55, v56
    v_lshlrev_b32 v57, 2, v56
    buffer_load_dwordx4 v[60:63], v57, s[16:19], 0 offen
    s_waitcnt vmcnt(0)
    s_cmp_lg_u32 s80, 78
    s_cbranch_scc1 L_snotlast
    s_mov_b32 exec_lo, 0xffffff00
    v_mov_b32 v60, s47
    v_mov_b32 v61, s47
    v_mov_b32 v62, s47
    v_mov_b32 v63, s47
    s_mov_b64 exec, -1
L_snotlast:
    s_cmp_gt_u32 s52, 0
    s_cbranch_scc1 L_1
    v_cmp_eq_u32_sdwa vcc, v60, s2 src0_sel:BYTE_0 src1_sel:DWORD
    s_cbranch_vccz L_1
    s_bcnt1_i32_b64 s53, vcc
    s_lshl3_add_u32 s54, s53, s64
    s_mov_b32 s52, 0
    s_cmp_gt_u32 s54, s65
    s_cbranch_scc1 L_ovf
    v_mbcnt_lo_u32_b32 v58, vcc_lo, 0
    v_mbcnt_hi_u32_b32 v58, vcc_hi, v58
    v_lshl_add_u32 v58, v58, 3, s64
    v_add_u32 v59, 0, v56
    s_mov_b64 exec, vcc
    ds_write2_b32 v58, v60, v59 offset0:0 offset1:1
    s_mov_b64 exec, -1
    s_mov_b32 s64, s54
L_1:
    s_cmp_gt_u32 s52, 1
    s_cbranch_scc1 L_2
    v_cmp_eq_u32_sdwa vcc, v61, s2 src0_sel:BYTE_0 src1_sel:DWORD
    s_cbranch_vccz L_2
    s_bcnt1_i32_b64 s53, vcc
    s_lshl3_add_u32 s54, s53, s64
    s_mov_b32 s52, 1
    s_cmp_gt_u32 s54, s65
    s_cbranch_scc1 L_ovf
    v_mbcnt_lo_u32_b32 v58, vcc_lo, 0
    v_mbcnt_hi_u32_b32 v58, vcc_hi, v58
    v_lshl_add_u32 v58, v58, 3, s64
    v_add_u32 v59, 1, v56
    s_mov_b64 exec, vcc
    ds_write2_b32 v58, v61, v59 offset0:0 offset1:1
    s_mov_b64 exec, -1
    s_mov_b32 s64, s54
L_2:
    s_cmp_gt_u32 s52, 2
    s_cbranch_scc1 L_3
    v_cmp_eq_u32_sdwa vcc, v62, s2 src0_sel:BYTE_0 src1_sel:DWORD
    s_cbranch_vccz L_3
    s_bcnt1_i32_b64 s53, vcc
    s_lshl3_add_u32 s54, s53, s64
    s_mov_b32 s52, 2
    s_cmp_gt_u32 s54, s65
    s_cbranch_scc1 L_ovf
    v_mbcnt_lo_u32_b32 v58, vcc_lo, 0
    v_mbcnt_hi_u32_b32 v58, vcc_hi, v58
    v_lshl_add_u32 v58, v58, 3, s64
    v_add_u32 v59, 2, v56
    s_mov_b64 exec, vcc
    ds_write2_b32 v58, v62, v59 offset0:0 offset1:1
    s_mov_b64 exec, -1
    s_mov_b32 s64, s54
L_3:
    s_cmp_gt_u32 s52, 3
    s_cbranch_scc1 L_4
    v_cmp_eq_u32_sdwa vcc, v63, s2 src0_sel:BYTE_0 src1_sel:DWORD
    s_cbranch_vccz L_4
    s_bcnt1_i32_b64 s53, vcc
    s_lshl3_add_u32 s54, s53, s64
    s_mov_b32 s52, 3
    s_cmp_gt_u32 s54, s65
    s_cbranch_scc1 L_ovf
    v_mbcnt_lo_u32_b32 v58, vcc_lo, 0
    v_mbcnt_hi_u32_b32 v58, vcc_hi, v58
    v_lshl_add_u32 v58, v58, 3, s64
    v_add_u32 v59, 3, v56
    s_mov_b64 exec, vcc
    ds_write2_b32 v58, v63, v59 offset0:0 offset1:1
    s_mov_b64 exec, -1
    s_mov_b32 s64, s54
L_4:
    s_mov_b32 s52, 0
    s_add_u32 s80, s80, 1
    s_branch L_sloop
L_ovf:
    v_mov_b32 v58, 1
    v_mov_b32 v59, 119056
    ds_write_b32 v59, v58
L_scan_done:
    s_sub_u32 s79, s64, s63
    s_lshr_b32 s79, s79, 3
    s_lshl_b32 s44, s3, 7
    v_lshlrev_b32 v58, 3, v1
    v_add_u32 v58, s63, v58
    s_waitcnt lgkmcnt(0)
    ds_read_b32 v16, v58 offset:0
    ds_read_b32 v20, v58 offset:4
    s_sub_u32 s53, s79, 0
    v_cmp_gt_i32 s[36:37], s53, v1
    ds_read_b32 v17, v58 offset:512
    ds_read_b32 v21, v58 offset:516
    s_sub_u32 s53, s79, 64
    v_cmp_gt_i32 s[38:39], s53, v1
    s_mov_b64 s[40:41], 0
    v_mov_b32 v18, 0
    v_mov_b32 v26, 0
    s_mov_b64 s[42:43], 0
    v_mov_b32 v19, 0
    v_mov_b32 v27, 0
    v_lshl_add_u32 v58, v1, 2, s63
    v_add_u32 v59, s44, v1
    v_lshlrev_b32 v59, 22, v59
    s_waitcnt lgkmcnt(0)
    v_lshlrev_b32 v28, 2, v20
    buffer_load_dword v24, v28, s[12:15], 0 offen
    v_bfe_u32 v16, v16, 8, 6
    v_min_u32 v16, 47, v16
    ds_write_b32 v58, v20 offset:4096
    v_lshlrev_b32 v29, 2, v21
    buffer_load_dword v25, v29, s[12:15], 0 offen
    v_bfe_u32 v17, v17, 8, 6
    v_min_u32 v17, 47, v17
    ds_write_b32 v58, v21 offset:4352
    s_waitcnt vmcnt(0)
    v_and_b32 v24, 0x3fff, v24
    v_lshl_or_b32 v24, v24, 8, v59
    v_add_u32 v59, 268435456, v59
    v_and_b32 v25, 0x3fff, v25
    v_lshl_or_b32 v25, v25, 8, v59
    v_add_u32 v59, 268435456, v59
L_have:
    v_mov_b32 v58, 1
    s_mov_b32 s53, 110848
    s_mov_b32 s54, 114688
    v_bfe_u32 v28, v24, 8, 14
    v_mul_u32_u24 v28, 6711, v28
    v_lshrrev_b32 v28, 22, v28
    v_min_u32 v28, 15, v28
    v_lshl_add_u32 v28, v28, 2, s53
    v_lshl_add_u32 v28, v16, 6, v28
    v_lshl_add_u32 v16, v16, 2, s54
    s_mov_b64 exec, s[36:37]
    ds_add_rtn_u32 v32, v28, v58
    ds_add_u32 v16, v58
    s_mov_b64 exec, -1
    v_bfe_u32 v29, v25, 8, 14
    v_mul_u32_u24 v29, 6711, v29
    v_lshrrev_b32 v29, 22, v29
    v_min_u32 v29, 15, v29
    v_lshl_add_u32 v29, v29, 2, s53
    v_lshl_add_u32 v29, v17, 6, v29
    v_lshl_add_u32 v17, v17, 2, s54
    s_mov_b64 exec, s[38:39]
    ds_add_rtn_u32 v33, v29, v58
    ds_add_u32 v17, v58
    s_mov_b64 exec, -1
    v_bfe_u32 v30, v26, 8, 14
    v_mul_u32_u24 v30, 6711, v30
    v_lshrrev_b32 v30, 22, v30
    v_min_u32 v30, 15, v30
    v_lshl_add_u32 v30, v30, 2, s53
    v_lshl_add_u32 v30, v18, 6, v30
    v_lshl_add_u32 v18, v18, 2, s54
    s_mov_b64 exec, s[40:41]
    ds_add_rtn_u32 v34, v30, v58
    ds_add_u32 v18, v58
    s_mov_b64 exec, -1
    v_bfe_u32 v31, v27, 8, 14
    v_mul_u32_u24 v31, 6711, v31
    v_lshrrev_b32 v31, 22, v31
    v_min_u32 v31, 15, v31
    v_lshl_add_u32 v31, v31, 2, s53
    v_lshl_add_u32 v31, v19, 6, v31
    v_lshl_add_u32 v19, v19, 2, s54
    s_mov_b64 exec, s[42:43]
    ds_add_rtn_u32 v35, v31, v58
    ds_add_u32 v19, v58
    s_mov_b64 exec, -1
    v_lshrrev_b32 v36, 1, v1
    s_add_u32 s53, s63, 4096
    v_lshl_add_u32 v39, v36, 2, s53
    ds_read_b32 v40, v39 offset:0
    ds_read_b32 v41, v39 offset:128
    ds_read_b32 v42, v39 offset:256
    ds_read_b32 v43, v39 offset:384
    v_and_b32 v38, 1, v1
    v_lshlrev_b32 v37, 4, v38
    v_lshlrev_b32 v38, 2, v38
    s_mov_b32 s46, s79
    s_mov_b32 s45, s44
    v_lshl_add_u32 v56, v1, 2, s54
    v_mov_b32 v57, 119056
    s_waitcnt lgkmcnt(0)
    s_cmp_le_i32 s46, 0
    s_cbranch_scc1 L_5
    v_lshl_add_u32 v44, v40, 5, v37
    v_lshl_add_u32 v45, v40, 3, v38
    v_cmp_gt_i32 vcc, s46, v36
    s_lshl_b32 s76, s45, 5
    s_add_u32 m0, s76, 65536
    s_mov_b64 exec, vcc
    buffer_load_dwordx4 v44, s[24:27], 0 offen lds
    s_lshl3_add_u32 m0, s45, 98304
    s_add_u32 s45, s45, 32
    buffer_load_dword v45, s[20:23], 0 offen lds
    s_mov_b64 exec, -1
    s_sub_i32 s46, s46, 32
L_5:
    s_barrier
    ds_read_b32 v56, v56
    ds_read_b32 v57, v57
    s_cmp_le_i32 s46, 0
    s_cbranch_scc1 L_6
    v_lshl_add_u32 v44, v41, 5, v37
    v_lshl_add_u32 v45, v41, 3, v38
    v_cmp_gt_i32 vcc, s46, v36
    s_lshl_b32 s76, s45, 5
    s_add_u32 m0, s76, 65536
    s_mov_b64 exec, vcc
    buffer_load_dwordx4 v44, s[24:27], 0 offen lds
    s_lshl3_add_u32 m0, s45, 98304
    s_add_u32 s45, s45, 32
    buffer_load_dword v45, s[20:23], 0 offen lds
    s_mov_b64 exec, -1
    s_sub_i32 s46, s46, 32
L_6:
    s_waitcnt lgkmcnt(0)
    v_readfirstlane_b32 s78, v57
    s_cmp_lg_u32 s77, 0
    s_cbranch_scc1 L_assigned
    v_sub_u32 v57, 63, v1
    v_lshl_add_u32 v57, v56, 6, v57
    v_mov_b32 v59, 0
    v_readlane_b32 s84, v57, 0
    v_readlane_b32 s85, v57, 1
    v_readlane_b32 s86, v57, 2
    v_readlane_b32 s87, v57, 3
    v_readlane_b32 s88, v57, 4
    v_readlane_b32 s89, v57, 5
    v_readlane_b32 s90, v57, 6
    v_readlane_b32 s91, v57, 7
    v_readlane_b32 s92, v57, 8
    v_readlane_b32 s93, v57, 9
    v_readlane_b32 s94, v57, 10
    v_readlane_b32 s95, v57, 11
    v_readlane_b32 s96, v57, 12
    v_readlane_b32 s97, v57, 13
    v_readlane_b32 s98, v57, 14
    v_readlane_b32 s99, v57, 15
    v_cmp_gt_u32 vcc, s84, v57
    v_cmp_gt_u32 s[4:5], s85, v57
    v_cmp_gt_u32 s[6:7], s86, v57
    v_addc_co_u32 v59, vcc, 0, v59, vcc
    v_addc_co_u32 v59, s[4:5], 0, v59, s[4:5]
    v_addc_co_u32 v59, s[6:7], 0, v59, s[6:7]
    v_cmp_gt_u32 vcc, s87, v57
    v_cmp_gt_u32 s[4:5], s88, v57
    v_cmp_gt_u32 s[6:7], s89, v57
    v_addc_co_u32 v59, vcc, 0, v59, vcc
    v_addc_co_u32 v59, s[4:5], 0, v59, s[4:5]
    v_addc_co_u32 v59, s[6:7], 0, v59, s[6:7]
    v_cmp_gt_u32 vcc, s90, v57
    v_cmp_gt_u32 s[4:5], s91, v57
    v_cmp_gt_u32 s[6:7], s92, v57
    v_addc_co_u32 v59, vcc, 0, v59, vcc
    v_addc_co_u32 v59, s[4:5], 0, v59, s[4:5]
    v_addc_co_u32 v59, s[6:7], 0, v59, s[6:7]
    v_cmp_gt_u32 vcc, s93, v57
    v_cmp_gt_u32 s[4:5], s94, v57
    v_cmp_gt_u32 s[6:7], s95, v57
    v_addc_co_u32 v59, vcc, 0, v59, vcc
    v_addc_co_u32 v59, s[4:5], 0, v59, s[4:5]
    v_addc_co_u32 v59, s[6:7], 0, v59, s[6:7]
    v_cmp_gt_u32 vcc, s96, v57
    v_cmp_gt_u32 s[4:5], s97, v57
    v_cmp_gt_u32 s[6:7], s98, v57
    v_addc_co_u32 v59, vcc, 0, v59, vcc
    v_addc_co_u32 v59, s[4:5], 0, v59, s[4:5]
    v_addc_co_u32 v59, s[6:7], 0, v59, s[6:7]
    v_cmp_gt_u32 vcc, s99, v57
    s_nop 1
    v_addc_co_u32 v59, vcc, 0, v59, vcc
    v_readlane_b32 s84, v57, 16
    v_readlane_b32 s85, v57, 17
    v_readlane_b32 s86, v57, 18
    v_readlane_b32 s87, v57, 19
    v_readlane_b32 s88, v57, 20
    v_readlane_b32 s89, v57, 21
    v_readlane_b32 s90, v57, 22
    v_readlane_b32 s91, v57, 23
    v_readlane_b32 s92, v57, 24
    v_readlane_b32 s93, v57, 25
    v_readlane_b32 s94, v57, 26
    v_readlane_b32 s95, v57, 27
    v_readlane_b32 s96, v57, 28
    v_readlane_b32 s97, v57, 29
    v_readlane_b32 s98, v57, 30
    v_readlane_b32 s99, v57, 31
    v_cmp_gt_u32 vcc, s84, v57
    v_cmp_gt_u32 s[4:5], s85, v57
    v_cmp_gt_u32 s[6:7], s86, v57
    v_addc_co_u32 v59, vcc, 0, v59, vcc
    v_addc_co_u32 v59, s[4:5], 0, v59, s[4:5]
    v_addc_co_u32 v59, s[6:7], 0, v59, s[6:7]
    v_cmp_gt_u32 vcc, s87, v57
    v_cmp_gt_u32 s[4:5], s88, v57
    v_cmp_gt_u32 s[6:7], s89, v57
    v_addc_co_u32 v59, vcc, 0, v59, vcc
    v_addc_co_u32 v59, s[4:5], 0, v59, s[4:5]
    v_addc_co_u32 v59, s[6:7], 0, v59, s[6:7]
    v_cmp_gt_u32 vcc, s90, v57
    v_cmp_gt_u32 s[4:5], s91, v57
    v_cmp_gt_u32 s[6:7], s92, v57
    v_addc_co_u32 v59, vcc, 0, v59, vcc
    v_addc_co_u32 v59, s[4:5], 0, v59, s[4:5]
    v_addc_co_u32 v59, s[6:7], 0, v59, s[6:7]
    v_cmp_gt_u32 vcc, s93, v57
    v_cmp_gt_u32 s[4:5], s94, v57
    v_cmp_gt_u32 s[6:7], s95, v57
    v_addc_co_u32 v59, vcc, 0, v59, vcc
    v_addc_co_u32 v59, s[4:5], 0, v59, s[4:5]
    v_addc_co_u32 v59, s[6:7], 0, v59, s[6:7]
    v_cmp_gt_u32 vcc, s96, v57
    v_cmp_gt_u32 s[4:5], s97, v57
    v_cmp_gt_u32 s[6:7], s98, v57
    v_addc_co_u32 v59, vcc, 0, v59, vcc
    v_addc_co_u32 v59, s[4:5], 0, v59, s[4:5]
    v_addc_co_u32 v59, s[6:7], 0, v59, s[6:7]
    v_cmp_gt_u32 vcc, s99, v57
    s_nop 1
    v_addc_co_u32 v59, vcc, 0, v59, vcc
    v_readlane_b32 s84, v57, 32
    v_readlane_b32 s85, v57, 33
    v_readlane_b32 s86, v57, 34
    v_readlane_b32 s87, v57, 35
    v_readlane_b32 s88, v57, 36
    v_readlane_b32 s89, v57, 37
    v_readlane_b32 s90, v57, 38
    v_readlane_b32 s91, v57, 39
    v_cmp_gt_u32 vcc, s84, v57
    v_cmp_gt_u32 s[4:5], s85, v57
    v_cmp_gt_u32 s[6:7], s86, v57
    v_addc_co_u32 v59, vcc, 0, v59, vcc
    v_addc_co_u32 v59, s[4:5], 0, v59, s[4:5]
    v_addc_co_u32 v59, s[6:7], 0, v59, s[6:7]
    v_cmp_gt_u32 vcc, s87, v57
    v_cmp_gt_u32 s[4:5], s88, v57
    v_cmp_gt_u32 s[6:7], s89, v57
    v_addc_co_u32 v59, vcc, 0, v59, vcc
    v_addc_co_u32 v59, s[4:5], 0, v59, s[4:5]
    v_addc_co_u32 v59, s[6:7], 0, v59, s[6:7]
    v_cmp_gt_u32 vcc, s90, v57
    v_cmp_gt_u32 s[4:5], s91, v57
    s_nop 0
    v_addc_co_u32 v59, vcc, 0, v59, vcc
    v_addc_co_u32 v59, s[4:5], 0, v59, s[4:5]
    v_bfe_u32 v60, v59, 3, 1
    v_mul_u32_u24 v60, 7, v60
    v_and_b32 v61, 7, v59
    v_xor_b32 v11, v60, v61
    s_sub_u32 s53, 7, s3
    s_add_u32 s54, s3, 0
    v_cmp_eq_u32 vcc, s54, v59
    s_ff1_i32_b64 s56, vcc
    s_add_u32 s54, s53, 8
    v_cmp_eq_u32 vcc, s54, v59
    s_ff1_i32_b64 s57, vcc
    s_add_u32 s54, s3, 16
    v_cmp_eq_u32 vcc, s54, v59
    s_ff1_i32_b64 s58, vcc
    s_add_u32 s54, s53, 24
    v_cmp_eq_u32 vcc, s54, v59
    s_ff1_i32_b64 s59, vcc
    s_add_u32 s54, s3, 32
    v_cmp_eq_u32 vcc, s54, v59
    s_ff1_i32_b64 s60, vcc
L_assigned:
    v_cmp_gt_u32 vcc, s3, v11
    v_and_b32 v61, 15, v1
    v_lshlrev_b32 v61, 2, v61
    v_cndmask_b32 v60, 0, v56, vcc
    v_add_u32 v61, 110848, v61
    s_lshl_b32 s84, s56, 6
    v_add_u32 v64, s84, v61
    ds_read_b32 v70, v64
    s_lshl_b32 s85, s57, 6
    v_add_u32 v65, s85, v61
    ds_read_b32 v71, v65
    s_lshl_b32 s86, s58, 6
    v_add_u32 v66, s86, v61
    ds_read_b32 v72, v66
    s_lshl_b32 s87, s59, 6
    v_add_u32 v67, s87, v61
    ds_read_b32 v73, v67
    s_lshl_b32 s88, s60, 6
    v_add_u32 v68, s88, v61
    ds_read_b32 v74, v68
    v_add_u32_dpp v60, v60, v60 row_shr:1 row_mask:0xf bank_mask:0xf bound_ctrl:1
    v_readlane_b32 s92, v56, s56
    s_nop 0
    v_add_u32_dpp v60, v60, v60 row_shr:2 row_mask:0xf bank_mask:0xf bound_ctrl:1
    v_readlane_b32 s93, v56, s57
    s_nop 0
    v_add_u32_dpp v60, v60, v60 row_shr:4 row_mask:0xf bank_mask:0xf bound_ctrl:1
    v_readlane_b32 s94, v56, s58
    s_nop 0
    v_add_u32_dpp v60, v60, v60 row_shr:8 row_mask:0xf bank_mask:0xf bound_ctrl:1
    v_readlane_b32 s95, v56, s59
    s_nop 0
    v_readlane_b32 s96, v56, s60
    v_readlane_b32 s61, v60, 15
    v_readlane_b32 s53, v60, 31
    v_readlane_b32 s54, v60, 47
    s_add_u32 s62, s92, s93
    s_add_u32 s62, s62, s94
    s_add_u32 s62, s62, s95
    s_add_u32 s62, s62, s96
    s_add_u32 s61, s61, s53
    s_add_u32 s61, s61, s54
    s_add_u32 s61, s61, 3
    s_andn2_b32 s61, s61, 3
    s_lshl2_add_u32 s61, s3, s61
    s_waitcnt lgkmcnt(0)
    v_add3_u32 v60, v70, v71, v72
    v_add3_u32 v60, v60, v73, v74
    v_mov_b32 v61, v60
    s_nop 1
    v_add_u32_dpp v61, v61, v61 row_shr:1 row_mask:0xf bank_mask:0xf bound_ctrl:1
    s_nop 1
    v_add_u32_dpp v61, v61, v61 row_shr:2 row_mask:0xf bank_mask:0xf bound_ctrl:1
    s_nop 1
    v_add_u32_dpp v61, v61, v61 row_shr:4 row_mask:0xf bank_mask:0xf bound_ctrl:1
    s_nop 1
    v_add_u32_dpp v61, v61, v61 row_shr:8 row_mask:0xf bank_mask:0xf bound_ctrl:1
    v_sub_u32 v61, v61, v60
    v_add_u32 v61, s61, v61
    v_lshl_add_u32 v75, v61, 8, 0
    ds_write_b32 v64, v75 offset:4096
    v_add_u32 v61, v61, v70
    v_lshl_add_u32 v76, v61, 8, 16
    ds_write_b32 v65, v76 offset:4096
    v_add_u32 v61, v61, v71
    v_lshl_add_u32 v77, v61, 8, 32
    ds_write_b32 v66, v77 offset:4096
    v_add_u32 v61, v61, v72
    v_lshl_add_u32 v78, v61, 8, 48
    ds_write_b32 v67, v78 offset:4096
    v_add_u32 v61, v61, v73
    v_lshl_add_u32 v79, v61, 8, 64
    ds_write_b32 v68, v79 offset:4096
    s_cmp_le_i32 s46, 0
    s_cbranch_scc1 L_7
    v_lshl_add_u32 v44, v42, 5, v37
    v_lshl_add_u32 v45, v42, 3, v38
    v_cmp_gt_i32 vcc, s46, v36
    s_lshl_b32 s76, s45, 5
    s_add_u32 m0, s76, 65536
    s_mov_b64 exec, vcc
    buffer_load_dwordx4 v44, s[24:27], 0 offen lds
    s_lshl3_add_u32 m0, s45, 98304
    s_add_u32 s45, s45, 32
    buffer_load_dword v45, s[20:23], 0 offen lds
    s_mov_b64 exec, -1
    s_sub_i32 s46, s46, 32
L_7:
    s_waitcnt lgkmcnt(0)
    s_barrier
    ds_read_b32 v16, v28 offset:4096
    ds_read_b32 v17, v29 offset:4096
    ds_read_b32 v18, v30 offset:4096
    ds_read_b32 v19, v31 offset:4096
    v_mov_b32 v60, 0
    v_mov_b32 v61, 0
    v_lshlrev_b32 v64, 3, v0
    v_add_u32 v64, 110848, v64
    ds_write_b64 v64, v[60:61]
    v_mov_b32 v64, 119056
    ds_write_b32 v64, v60
    s_mov_b32 s53, 106496
    s_movk_i32 s54, 255
    s_waitcnt lgkmcnt(2)
    v_lshrrev_b32 v28, 8, v16
    v_add_u32 v28, v28, v32
    v_and_or_b32 v16, v16, s54, v24
    v_lshl_add_u32 v28, v28, 2, s53
    s_mov_b64 exec, s[36:37]
    ds_write_b32 v28, v16
    s_mov_b64 exec, -1
    v_lshrrev_b32 v29, 8, v17
    v_add_u32 v29, v29, v33
    v_and_or_b32 v17, v17, s54, v25
    v_lshl_add_u32 v29, v29, 2, s53
    s_mov_b64 exec, s[38:39]
    ds_write_b32 v29, v17
    s_mov_b64 exec, -1
    v_lshrrev_b32 v30, 8, v18
    v_add_u32 v30, v30, v34
    v_and_or_b32 v18, v18, s54, v26
    v_lshl_add_u32 v30, v30, 2, s53
    s_mov_b64 exec, s[40:41]
    ds_write_b32 v30, v18
    s_mov_b64 exec, -1
    v_lshrrev_b32 v31, 8, v19
    v_add_u32 v31, v31, v35
    v_and_or_b32 v19, v19, s54, v27
    v_lshl_add_u32 v31, v31, 2, s53
    s_mov_b64 exec, s[42:43]
    ds_write_b32 v31, v19
    s_mov_b64 exec, -1
    s_cmp_le_i32 s46, 0
    s_cbranch_scc1 L_8
    v_lshl_add_u32 v44, v43, 5, v37
    v_lshl_add_u32 v45, v43, 3, v38
    v_cmp_gt_i32 vcc, s46, v36
    s_lshl_b32 s76, s45, 5
    s_add_u32 m0, s76, 65536
    s_mov_b64 exec, vcc
    buffer_load_dwordx4 v44, s[24:27], 0 offen lds
    s_lshl3_add_u32 m0, s45, 98304
    s_add_u32 s45, s45, 32
    buffer_load_dword v45, s[20:23], 0 offen lds
    s_mov_b64 exec, -1
    s_sub_i32 s46, s46, 32
L_8:
L_paymore:
    s_cmp_le_i32 s46, 0
    s_cbranch_scc1 L_paydone
    ds_read_b32 v40, v39 offset:512
    v_add_u32 v39, 128, v39
    s_waitcnt lgkmcnt(0)
    s_cmp_le_i32 s46, 0
    s_cbranch_scc1 L_9
    v_lshl_add_u32 v44, v40, 5, v37
    v_lshl_add_u32 v45, v40, 3, v38
    v_cmp_gt_i32 vcc, s46, v36
    s_lshl_b32 s76, s45, 5
    s_add_u32 m0, s76, 65536
    s_mov_b64 exec, vcc
    buffer_load_dwordx4 v44, s[24:27], 0 offen lds
    s_lshl3_add_u32 m0, s45, 98304
    s_add_u32 s45, s45, 32
    buffer_load_dword v45, s[20:23], 0 offen lds
    s_mov_b64 exec, -1
    s_sub_i32 s46, s46, 32
L_9:
    s_branch L_paymore
L_paydone:
    s_lshl_b32 s61, s61, 2
    s_add_u32 s61, s61, 106496
    v_mov_b32 v13, s61
    v_and_b32 v62, 3, v1
    v_lshl_add_u32 v77, v62, 2, s61
    v_bfe_u32 v62, v1, 2, 2
    v_lshl_add_u32 v78, v62, 2, s61
    v_bfe_u32 v63, v1, 4, 1
    v_lshlrev_b32 v63, 4, v63
    v_add_u32 v63, 65536, v63
    v_mov_b32 v65, 98304
    v_mov_b32 v62, 119040
    v_cmp_ne_u32 vcc, 0, v7
    v_cmp_ne_u32 s[4:5], 0, v8
    v_cmp_ne_u32 s[6:7], 0, v10
    v_cndmask_b32 v74, v62, v63, vcc
    v_cndmask_b32 v75, v62, v63, s[4:5]
    v_cndmask_b32 v76, v62, v65, s[6:7]
    s_waitcnt lgkmcnt(0)
    s_barrier
    ds_read_b128 v[68:71], v13
    ds_read_b32 v72, v77
    ds_read_b32 v73, v78
    s_cmp_lt_u32 s62, 3
    s_cbranch_scc1 L_short
    s_waitcnt lgkmcnt(2)
    v_readfirstlane_b32 s64, v68
    v_readfirstlane_b32 s65, v69
    v_readfirstlane_b32 s66, v70
    v_readfirstlane_b32 s67, v71
    s_and_b32 s76, s64, s82
    s_add_u32 m0, s63, 0
    s_lshl_b32 s76, s76, 3
    buffer_load_dwordx4 v2, s[8:11], s76 offen lds
    buffer_load_dwordx4 v3, s[8:11], s76 offen offset:1024 lds
    s_and_b32 s76, s65, s82
    s_add_u32 m0, s63, 2048
    s_lshl_b32 s76, s76, 3
    buffer_load_dwordx4 v2, s[8:11], s76 offen lds
    buffer_load_dwordx4 v3, s[8:11], s76 offen offset:1024 lds
    s_and_b32 s76, s66, s82
    s_add_u32 m0, s63, 4096
    s_lshl_b32 s76, s76, 3
    buffer_load_dwordx4 v2, s[8:11], s76 offen lds
    buffer_load_dwordx4 v3, s[8:11], s76 offen offset:1024 lds
    s_waitcnt vmcnt(6)
    s_branch L_go
L_short:
    s_waitcnt vmcnt(0) lgkmcnt(0)
    v_readfirstlane_b32 s64, v68
    v_readfirstlane_b32 s65, v69
    v_readfirstlane_b32 s66, v70
    v_readfirstlane_b32 s67, v71
    s_cmp_le_u32 s62, 0
    s_cbranch_scc1 L_go
    s_and_b32 s76, s64, s82
    s_add_u32 m0, s63, 0
    s_lshl_b32 s76, s76, 3
    buffer_load_dwordx4 v2, s[8:11], s76 offen lds
    buffer_load_dwordx4 v3, s[8:11], s76 offen offset:1024 lds
    s_cmp_le_u32 s62, 1
    s_cbranch_scc1 L_go
    s_and_b32 s76, s65, s82
    s_add_u32 m0, s63, 2048
    s_lshl_b32 s76, s76, 3
    buffer_load_dwordx4 v2, s[8:11], s76 offen lds
    buffer_load_dwordx4 v3, s[8:11], s76 offen offset:1024 lds
L_go:
    s_waitcnt lgkmcnt(0)
    v_lshrrev_b32 v72, 22, v72
    v_lshrrev_b32 v73, 22, v73
    v_mad_u32_u24 v5, v72, v7, v74
    v_mad_u32_u24 v6, v72, v8, v75
    v_mad_u32_u24 v9, v73, v10, v76
    s_barrier
    s_cmp_eq_u32 s62, 0
    s_cbranch_scc1 L_round_done
L_group:
    ds_read_b64 v[14:15], v9
    ds_read_b128 v[56:59], v5
    ds_read_b128 v[60:63], v6
    ds_read_b128 v[68:71], v13 offset:16
    ds_read_b32 v72, v77 offset:16
    ds_read_b32 v73, v78 offset:16
    v_add_u32 v13, 16, v13
    v_add_u32 v77, 16, v77
    v_add_u32 v78, 16, v78
    s_waitcnt lgkmcnt(0)
    v_mfma_f32_16x16x16_bf16 v[64:67], a[32:33], v[14:15], 0
    v_mfma_f32_16x16x32_bf16 v[16:19], v[56:59], a[0:3], 0
    v_mfma_f32_16x16x32_bf16 v[20:23], v[56:59], a[8:11], 0
    v_mfma_f32_16x16x32_bf16 v[24:27], v[56:59], a[16:19], 0
    v_mfma_f32_16x16x32_bf16 v[28:31], v[56:59], a[24:27], 0
    v_mfma_f32_16x16x32_bf16 v[16:19], v[60:63], a[4:7], v[16:19]
    v_mfma_f32_16x16x32_bf16 v[20:23], v[60:63], a[12:15], v[20:23]
    v_mfma_f32_16x16x32_bf16 v[24:27], v[60:63], a[20:23], v[24:27]
    v_mfma_f32_16x16x32_bf16 v[28:31], v[60:63], a[28:31], v[28:31]
    v_readfirstlane_b32 s68, v68
    v_readfirstlane_b32 s69, v69
    v_readfirstlane_b32 s70, v70
    v_readfirstlane_b32 s71, v71
    v_cvt_pk_bf16_f32 v14, v64, v65
    v_cvt_pk_bf16_f32 v15, v66, v67
    v_lshrrev_b32 v72, 22, v72
    v_lshrrev_b32 v73, 22, v73
    v_mad_u32_u24 v5, v72, v7, v74
    v_mad_u32_u24 v6, v72, v8, v75
    v_mad_u32_u24 v9, v73, v10, v76
    s_cmp_ge_u32 s62, 3
    s_cbranch_scc1 L_10
    s_waitcnt vmcnt(0)
L_10:
    s_waitcnt vmcnt(4)
    ds_read_b64_tr_b16 v[48:49], v4 offset:0
    ds_read_b64_tr_b16 v[50:51], v4 offset:256
    ds_read_b64_tr_b16 v[52:53], v4 offset:512
    ds_read_b64_tr_b16 v[54:55], v4 offset:768
    s_cmp_le_u32 s62, 3
    s_cbranch_scc1 L_11
    s_and_b32 s76, s67, s82
    s_add_u32 m0, s63, 6144
    s_lshl_b32 s76, s76, 3
    buffer_load_dwordx4 v2, s[8:11], s76 offen lds
    buffer_load_dwordx4 v3, s[8:11], s76 offen offset:1024 lds
L_11:
    s_waitcnt lgkmcnt(0)
    v_mfma_f32_4x4x4_16b_bf16 v[32:35], v[14:15], v[48:49], 0 cbsz:4 abid:0
    v_mfma_f32_4x4x4_16b_bf16 v[36:39], v[14:15], v[50:51], 0 cbsz:4 abid:0
    v_mfma_f32_4x4x4_16b_bf16 v[40:43], v[14:15], v[52:53], 0 cbsz:4 abid:0
    v_mfma_f32_4x4x4_16b_bf16 v[44:47], v[14:15], v[54:55], 0 cbsz:4 abid:0
    s_nop 0
    s_set_gpr_idx_on s64, gpr_idx(SRC2,DST)
    v_pk_fma_f32 v[80:81], v[32:33], v[16:17], v[80:81] op_sel:[0,0,0] op_sel_hi:[1,0,1]
    v_pk_fma_f32 v[82:83], v[34:35], v[16:17], v[82:83] op_sel:[0,0,0] op_sel_hi:[1,0,1]
    v_pk_fma_f32 v[84:85], v[36:37], v[20:21], v[84:85] op_sel:[0,0,0] op_sel_hi:[1,0,1]
    v_pk_fma_f32 v[86:87], v[38:39], v[20:21], v[86:87] op_sel:[0,0,0] op_sel_hi:[1,0,1]
    v_pk_fma_f32 v[88:89], v[40:41], v[24:25], v[88:89] op_sel:[0,0,0] op_sel_hi:[1,0,1]
    v_pk_fma_f32 v[90:91], v[42:43], v[24:25], v[90:91] op_sel:[0,0,0] op_sel_hi:[1,0,1]
    v_pk_fma_f32 v[92:93], v[44:45], v[28:29], v[92:93] op_sel:[0,0,0] op_sel_hi:[1,0,1]
    v_pk_fma_f32 v[94:95], v[46:47], v[28:29], v[94:95] op_sel:[0,0,0] op_sel_hi:[1,0,1]
    s_set_gpr_idx_off
    s_mov_b32 s64, s68
    s_sub_u32 s62, s62, 1
    s_cmp_eq_u32 s62, 0
    s_cbranch_scc1 L_round_done
    s_cmp_ge_u32 s62, 3
    s_cbranch_scc1 L_12
    s_waitcnt vmcnt(0)
L_12:
    s_waitcnt vmcnt(4)
    ds_read_b64_tr_b16 v[48:49], v4 offset:2048
    ds_read_b64_tr_b16 v[50:51], v4 offset:2304
    ds_read_b64_tr_b16 v[52:53], v4 offset:2560
    ds_read_b64_tr_b16 v[54:55], v4 offset:2816
    s_cmp_le_u32 s62, 3
    s_cbranch_scc1 L_13
    s_and_b32 s76, s68, s82
    s_add_u32 m0, s63, 0
    s_lshl_b32 s76, s76, 3
    buffer_load_dwordx4 v2, s[8:11], s76 offen lds
    buffer_load_dwordx4 v3, s[8:11], s76 offen offset:1024 lds
L_13:
    s_waitcnt lgkmcnt(0)
    v_mfma_f32_4x4x4_16b_bf16 v[32:35], v[14:15], v[48:49], 0 cbsz:4 abid:1
    v_mfma_f32_4x4x4_16b_bf16 v[36:39], v[14:15], v[50:51], 0 cbsz:4 abid:1
    v_mfma_f32_4x4x4_16b_bf16 v[40:43], v[14:15], v[52:53], 0 cbsz:4 abid:1
    v_mfma_f32_4x4x4_16b_bf16 v[44:47], v[14:15], v[54:55], 0 cbsz:4 abid:1
    s_nop 0
    s_set_gpr_idx_on s65, gpr_idx(SRC2,DST)
    v_pk_fma_f32 v[80:81], v[32:33], v[16:17], v[80:81] op_sel:[0,1,0] op_sel_hi:[1,1,1]
    v_pk_fma_f32 v[82:83], v[34:35], v[16:17], v[82:83] op_sel:[0,1,0] op_sel_hi:[1,1,1]
    v_pk_fma_f32 v[84:85], v[36:37], v[20:21], v[84:85] op_sel:[0,1,0] op_sel_hi:[1,1,1]
    v_pk_fma_f32 v[86:87], v[38:39], v[20:21], v[86:87] op_sel:[0,1,0] op_sel_hi:[1,1,1]
    v_pk_fma_f32 v[88:89], v[40:41], v[24:25], v[88:89] op_sel:[0,1,0] op_sel_hi:[1,1,1]
    v_pk_fma_f32 v[90:91], v[42:43], v[24:25], v[90:91] op_sel:[0,1,0] op_sel_hi:[1,1,1]
    v_pk_fma_f32 v[92:93], v[44:45], v[28:29], v[92:93] op_sel:[0,1,0] op_sel_hi:[1,1,1]
    v_pk_fma_f32 v[94:95], v[46:47], v[28:29], v[94:95] op_sel:[0,1,0] op_sel_hi:[1,1,1]
    s_set_gpr_idx_off
    s_mov_b32 s65, s69
    s_sub_u32 s62, s62, 1
    s_cmp_eq_u32 s62, 0
    s_cbranch_scc1 L_round_done
    s_cmp_ge_u32 s62, 3
    s_cbranch_scc1 L_14
    s_waitcnt vmcnt(0)
L_14:
    s_waitcnt vmcnt(4)
    ds_read_b64_tr_b16 v[48:49], v4 offset:4096
    ds_read_b64_tr_b16 v[50:51], v4 offset:4352
    ds_read_b64_tr_b16 v[52:53], v4 offset:4608
    ds_read_b64_tr_b16 v[54:55], v4 offset:4864
    s_cmp_le_u32 s62, 3
    s_cbranch_scc1 L_15
    s_and_b32 s76, s69, s82
    s_add_u32 m0, s63, 2048
    s_lshl_b32 s76, s76, 3
    buffer_load_dwordx4 v2, s[8:11], s76 offen lds
    buffer_load_dwordx4 v3, s[8:11], s76 offen offset:1024 lds
L_15:
    s_waitcnt lgkmcnt(0)
    v_mfma_f32_4x4x4_16b_bf16 v[32:35], v[14:15], v[48:49], 0 cbsz:4 abid:2
    v_mfma_f32_4x4x4_16b_bf16 v[36:39], v[14:15], v[50:51], 0 cbsz:4 abid:2
    v_mfma_f32_4x4x4_16b_bf16 v[40:43], v[14:15], v[52:53], 0 cbsz:4 abid:2
    v_mfma_f32_4x4x4_16b_bf16 v[44:47], v[14:15], v[54:55], 0 cbsz:4 abid:2
    s_nop 0
    s_set_gpr_idx_on s66, gpr_idx(SRC2,DST)
    v_pk_fma_f32 v[80:81], v[32:33], v[18:19], v[80:81] op_sel:[0,0,0] op_sel_hi:[1,0,1]
    v_pk_fma_f32 v[82:83], v[34:35], v[18:19], v[82:83] op_sel:[0,0,0] op_sel_hi:[1,0,1]
    v_pk_fma_f32 v[84:85], v[36:37], v[22:23], v[84:85] op_sel:[0,0,0] op_sel_hi:[1,0,1]
    v_pk_fma_f32 v[86:87], v[38:39], v[22:23], v[86:87] op_sel:[0,0,0] op_sel_hi:[1,0,1]
    v_pk_fma_f32 v[88:89], v[40:41], v[26:27], v[88:89] op_sel:[0,0,0] op_sel_hi:[1,0,1]
    v_pk_fma_f32 v[90:91], v[42:43], v[26:27], v[90:91] op_sel:[0,0,0] op_sel_hi:[1,0,1]
    v_pk_fma_f32 v[92:93], v[44:45], v[30:31], v[92:93] op_sel:[0,0,0] op_sel_hi:[1,0,1]
    v_pk_fma_f32 v[94:95], v[46:47], v[30:31], v[94:95] op_sel:[0,0,0] op_sel_hi:[1,0,1]
    s_set_gpr_idx_off
    s_mov_b32 s66, s70
    s_sub_u32 s62, s62, 1
    s_cmp_eq_u32 s62, 0
    s_cbranch_scc1 L_round_done
    s_cmp_ge_u32 s62, 3
    s_cbranch_scc1 L_16
    s_waitcnt vmcnt(0)
L_16:
    s_waitcnt vmcnt(4)
    ds_read_b64_tr_b16 v[48:49], v4 offset:6144
    ds_read_b64_tr_b16 v[50:51], v4 offset:6400
    ds_read_b64_tr_b16 v[52:53], v4 offset:6656
    ds_read_b64_tr_b16 v[54:55], v4 offset:6912
    s_cmp_le_u32 s62, 3
    s_cbranch_scc1 L_17
    s_and_b32 s76, s70, s82
    s_add_u32 m0, s63, 4096
    s_lshl_b32 s76, s76, 3
    buffer_load_dwordx4 v2, s[8:11], s76 offen lds
    buffer_load_dwordx4 v3, s[8:11], s76 offen offset:1024 lds
L_17:
    s_waitcnt lgkmcnt(0)
    v_mfma_f32_4x4x4_16b_bf16 v[32:35], v[14:15], v[48:49], 0 cbsz:4 abid:3
    v_mfma_f32_4x4x4_16b_bf16 v[36:39], v[14:15], v[50:51], 0 cbsz:4 abid:3
    v_mfma_f32_4x4x4_16b_bf16 v[40:43], v[14:15], v[52:53], 0 cbsz:4 abid:3
    v_mfma_f32_4x4x4_16b_bf16 v[44:47], v[14:15], v[54:55], 0 cbsz:4 abid:3
    s_nop 0
    s_set_gpr_idx_on s67, gpr_idx(SRC2,DST)
    v_pk_fma_f32 v[80:81], v[32:33], v[18:19], v[80:81] op_sel:[0,1,0] op_sel_hi:[1,1,1]
    v_pk_fma_f32 v[82:83], v[34:35], v[18:19], v[82:83] op_sel:[0,1,0] op_sel_hi:[1,1,1]
    v_pk_fma_f32 v[84:85], v[36:37], v[22:23], v[84:85] op_sel:[0,1,0] op_sel_hi:[1,1,1]
    v_pk_fma_f32 v[86:87], v[38:39], v[22:23], v[86:87] op_sel:[0,1,0] op_sel_hi:[1,1,1]
    v_pk_fma_f32 v[88:89], v[40:41], v[26:27], v[88:89] op_sel:[0,1,0] op_sel_hi:[1,1,1]
    v_pk_fma_f32 v[90:91], v[42:43], v[26:27], v[90:91] op_sel:[0,1,0] op_sel_hi:[1,1,1]
    v_pk_fma_f32 v[92:93], v[44:45], v[30:31], v[92:93] op_sel:[0,1,0] op_sel_hi:[1,1,1]
    v_pk_fma_f32 v[94:95], v[46:47], v[30:31], v[94:95] op_sel:[0,1,0] op_sel_hi:[1,1,1]
    s_set_gpr_idx_off
    s_mov_b32 s67, s71
    s_sub_u32 s62, s62, 1
    s_cmp_eq_u32 s62, 0
    s_cbranch_scc0 L_group
L_round_done:
    s_add_u32 s77, s77, 1
    s_cmp_lg_u32 s78, 0
    s_cbranch_scc1 L_scan
    s_lshl_b32 s53, s3, 14
    s_add_u32 s53, s53, 2097152
    v_lshlrev_b32 v16, 4, v1
    v_add_u32 v16, s53, v16
    buffer_load_dwordx4 a[32:35], v16, s[32:35], 0 offen offset:0
    buffer_load_dwordx4 a[36:39], v16, s[32:35], 0 offen offset:1024
    buffer_load_dwordx4 a[40:43], v16, s[32:35], 0 offen offset:2048
    buffer_load_dwordx4 a[44:47], v16, s[32:35], 0 offen offset:3072
    v_add_u32 v16, 4096, v16
    buffer_load_dwordx4 a[48:51], v16, s[32:35], 0 offen offset:0
    buffer_load_dwordx4 a[52:55], v16, s[32:35], 0 offen offset:1024
    buffer_load_dwordx4 a[56:59], v16, s[32:35], 0 offen offset:2048
    buffer_load_dwordx4 a[60:63], v16, s[32:35], 0 offen offset:3072
    v_add_u32 v16, 4096, v16
    buffer_load_dwordx4 a[64:67], v16, s[32:35], 0 offen offset:0
    buffer_load_dwordx4 a[68:71], v16, s[32:35], 0 offen offset:1024
    buffer_load_dwordx4 a[72:75], v16, s[32:35], 0 offen offset:2048
    buffer_load_dwordx4 a[76:79], v16, s[32:35], 0 offen offset:3072
    v_add_u32 v16, 4096, v16
    buffer_load_dwordx4 a[80:83], v16, s[32:35], 0 offen offset:0
    buffer_load_dwordx4 a[84:87], v16, s[32:35], 0 offen offset:1024
    buffer_load_dwordx4 a[88:91], v16, s[32:35], 0 offen offset:2048
    buffer_load_dwordx4 a[92:95], v16, s[32:35], 0 offen offset:3072
    v_add_u32 v16, 4096, v16
    v_mul_u32_u24 v16, 320, v1
    v_lshrrev_b32 v17, 2, v1
    v_lshl_add_u32 v16, v17, 3, v16
    s_lshl_b32 s53, s56, 3
    v_add_u32 v17, s53, v16
    s_lshl_b32 s53, s57, 3
    v_add_u32 v18, s53, v16
    s_lshl_b32 s53, s58, 3
    v_add_u32 v19, s53, v16
    s_lshl_b32 s53, s59, 3
    v_add_u32 v20, s53, v16
    s_lshl_b32 s53, s60, 3
    v_add_u32 v21, s53, v16
    v_cvt_pk_bf16_f32 v24, v80, v81
    v_cvt_pk_bf16_f32 v25, v82, v83
    v_cvt_pk_bf16_f32 v26, v84, v85
    v_cvt_pk_bf16_f32 v27, v86, v87
    v_cvt_pk_bf16_f32 v28, v88, v89
    v_cvt_pk_bf16_f32 v29, v90, v91
    v_cvt_pk_bf16_f32 v30, v92, v93
    v_cvt_pk_bf16_f32 v31, v94, v95
    v_cvt_pk_bf16_f32 v32, v96, v97
    v_cvt_pk_bf16_f32 v33, v98, v99
    v_cvt_pk_bf16_f32 v34, v100, v101
    v_cvt_pk_bf16_f32 v35, v102, v103
    v_cvt_pk_bf16_f32 v36, v104, v105
    v_cvt_pk_bf16_f32 v37, v106, v107
    v_cvt_pk_bf16_f32 v38, v108, v109
    v_cvt_pk_bf16_f32 v39, v110, v111
    v_cvt_pk_bf16_f32 v40, v112, v113
    v_cvt_pk_bf16_f32 v41, v114, v115
    v_cvt_pk_bf16_f32 v42, v116, v117
    v_cvt_pk_bf16_f32 v43, v118, v119
    v_cvt_pk_bf16_f32 v44, v120, v121
    v_cvt_pk_bf16_f32 v45, v122, v123
    v_cvt_pk_bf16_f32 v46, v124, v125
    v_cvt_pk_bf16_f32 v47, v126, v127
    v_cvt_pk_bf16_f32 v48, v128, v129
    v_cvt_pk_bf16_f32 v49, v130, v131
    v_cvt_pk_bf16_f32 v50, v132, v133
    v_cvt_pk_bf16_f32 v51, v134, v135
    v_cvt_pk_bf16_f32 v52, v136, v137
    v_cvt_pk_bf16_f32 v53, v138, v139
    v_cvt_pk_bf16_f32 v54, v140, v141
    v_cvt_pk_bf16_f32 v55, v142, v143
    v_cvt_pk_bf16_f32 v56, v144, v145
    v_cvt_pk_bf16_f32 v57, v146, v147
    v_cvt_pk_bf16_f32 v58, v148, v149
    v_cvt_pk_bf16_f32 v59, v150, v151
    v_cvt_pk_bf16_f32 v60, v152, v153
    v_cvt_pk_bf16_f32 v61, v154, v155
    v_cvt_pk_bf16_f32 v62, v156, v157
    v_cvt_pk_bf16_f32 v63, v158, v159
    v_lshrrev_b32 v70, 5, v1
    v_mul_u32_u24 v71, 2576, v70
    v_bfe_u32 v72, v1, 2, 2
    v_mul_u32_u24 v74, 320, v72
    v_bfe_u32 v73, v1, 4, 1
    v_lshl_add_u32 v71, v73, 5, v71
    v_and_b32 v73, 3, v1
    v_lshl_add_u32 v71, v73, 3, v71
    v_add_u32 v2, v71, v74
    v_add_u32 v3, 41216, v2
    s_mul_i32 s53, s3, 5120
    s_add_u32 s53, s53, 82432
    v_and_b32 v74, 31, v1
    v_mul_u32_u24 v74, 80, v74
    v_lshl_add_u32 v74, v70, 3, v74
    v_add_u32 v5, s53, v74
    v_lshrrev_b32 v74, 2, v1
    v_mul_u32_u24 v74, 80, v74
    v_lshl_add_u32 v74, v73, 4, v74
    v_add_u32 v6, s53, v74
    v_lshrrev_b32 v74, 4, v1
    v_lshlrev_b32 v74, 19, v74
    v_lshl_add_u32 v74, v72, 9, v74
    v_lshl_add_u32 v74, v73, 4, v74
    s_lshl_b32 s53, s2, 11
    s_lshl_b32 s54, s3, 6
    s_add_u32 s53, s53, s54
    v_add_u32 v4, s53, v74
    s_barrier
    ds_write_b64 v17, v[24:25] offset:0
    ds_write_b64 v17, v[26:27] offset:20608
    ds_write_b64 v17, v[28:29] offset:41216
    ds_write_b64 v17, v[30:31] offset:61824
    ds_write_b64 v18, v[32:33] offset:0
    ds_write_b64 v18, v[34:35] offset:20608
    ds_write_b64 v18, v[36:37] offset:41216
    ds_write_b64 v18, v[38:39] offset:61824
    ds_write_b64 v19, v[40:41] offset:0
    ds_write_b64 v19, v[42:43] offset:20608
    ds_write_b64 v19, v[44:45] offset:41216
    ds_write_b64 v19, v[46:47] offset:61824
    ds_write_b64 v20, v[48:49] offset:0
    ds_write_b64 v20, v[50:51] offset:20608
    ds_write_b64 v20, v[52:53] offset:41216
    ds_write_b64 v20, v[54:55] offset:61824
    ds_write_b64 v21, v[56:57] offset:0
    ds_write_b64 v21, v[58:59] offset:20608
    ds_write_b64 v21, v[60:61] offset:41216
    ds_write_b64 v21, v[62:63] offset:61824
    s_waitcnt lgkmcnt(0)
    s_barrier
    ds_read_b64_tr_b16 v[16:17], v2 offset:0
    ds_read_b64_tr_b16 v[18:19], v2 offset:1288
    ds_read_b64_tr_b16 v[20:21], v2 offset:5152
    ds_read_b64_tr_b16 v[22:23], v2 offset:6440
    ds_read_b64_tr_b16 v[24:25], v2 offset:10304
    ds_read_b64_tr_b16 v[26:27], v2 offset:11592
    ds_read_b64_tr_b16 v[28:29], v2 offset:15456
    ds_read_b64_tr_b16 v[30:31], v2 offset:16744
    ds_read_b64_tr_b16 v[32:33], v2 offset:20608
    ds_read_b64_tr_b16 v[34:35], v2 offset:21896
    ds_read_b64_tr_b16 v[36:37], v2 offset:25760
    ds_read_b64_tr_b16 v[38:39], v2 offset:27048
    s_waitcnt vmcnt(0)
    s_waitcnt lgkmcnt(10)
    v_mfma_f32_32x32x16_bf16 v[48:63], a[32:35], v[16:19], 0
    ds_read_b64_tr_b16 v[40:41], v2 offset:30912
    ds_read_b64_tr_b16 v[42:43], v2 offset:32200
    s_waitcnt lgkmcnt(10)
    v_mfma_f32_32x32x16_bf16 v[48:63], a[36:39], v[20:23], v[48:63]
    ds_read_b64_tr_b16 v[44:45], v2 offset:36064
    ds_read_b64_tr_b16 v[46:47], v2 offset:37352
    s_waitcnt lgkmcnt(10)
    v_mfma_f32_32x32x16_bf16 v[48:63], a[40:43], v[24:27], v[48:63]
    ds_read_b64_tr_b16 v[16:17], v3 offset:0
    ds_read_b64_tr_b16 v[18:19], v3 offset:1288
    s_waitcnt lgkmcnt(10)
    v_mfma_f32_32x32x16_bf16 v[48:63], a[44:47], v[28:31], v[48:63]
    ds_read_b64_tr_b16 v[20:21], v3 offset:5152
    ds_read_b64_tr_b16 v[22:23], v3 offset:6440
    s_waitcnt lgkmcnt(10)
    v_mfma_f32_32x32x16_bf16 v[48:63], a[48:51], v[32:35], v[48:63]
    ds_read_b64_tr_b16 v[24:25], v3 offset:10304
    ds_read_b64_tr_b16 v[26:27], v3 offset:11592
    s_waitcnt lgkmcnt(10)
    v_mfma_f32_32x32x16_bf16 v[48:63], a[52:55], v[36:39], v[48:63]
    ds_read_b64_tr_b16 v[28:29], v3 offset:15456
    ds_read_b64_tr_b16 v[30:31], v3 offset:16744
    s_waitcnt lgkmcnt(10)
    v_mfma_f32_32x32x16_bf16 v[48:63], a[56:59], v[40:43], v[48:63]
    ds_read_b64_tr_b16 v[32:33], v3 offset:20608
    ds_read_b64_tr_b16 v[34:35], v3 offset:21896
    s_waitcnt lgkmcnt(10)
    v_mfma_f32_32x32x16_bf16 v[48:63], a[60:63], v[44:47], v[48:63]
    ds_read_b64_tr_b16 v[36:37], v3 offset:25760
    ds_read_b64_tr_b16 v[38:39], v3 offset:27048
    s_waitcnt lgkmcnt(10)
    v_mfma_f32_32x32x16_bf16 v[48:63], a[64:67], v[16:19], v[48:63]
    ds_read_b64_tr_b16 v[40:41], v3 offset:30912
    ds_read_b64_tr_b16 v[42:43], v3 offset:32200
    s_waitcnt lgkmcnt(10)
    v_mfma_f32_32x32x16_bf16 v[48:63], a[68:71], v[20:23], v[48:63]
    ds_read_b64_tr_b16 v[44:45], v3 offset:36064
    ds_read_b64_tr_b16 v[46:47], v3 offset:37352
    s_waitcnt lgkmcnt(10)
    v_mfma_f32_32x32x16_bf16 v[48:63], a[72:75], v[24:27], v[48:63]
    ds_read_b64_tr_b16 v[16:17], v2 offset:64
    ds_read_b64_tr_b16 v[18:19], v2 offset:1352
    s_waitcnt lgkmcnt(10)
    v_mfma_f32_32x32x16_bf16 v[48:63], a[76:79], v[28:31], v[48:63]
    ds_read_b64_tr_b16 v[20:21], v2 offset:5216
    ds_read_b64_tr_b16 v[22:23], v2 offset:6504
    s_waitcnt lgkmcnt(10)
    v_mfma_f32_32x32x16_bf16 v[48:63], a[80:83], v[32:35], v[48:63]
    ds_read_b64_tr_b16 v[24:25], v2 offset:10368
    ds_read_b64_tr_b16 v[26:27], v2 offset:11656
    s_waitcnt lgkmcnt(10)
    v_mfma_f32_32x32x16_bf16 v[48:63], a[84:87], v[36:39], v[48:63]
    ds_read_b64_tr_b16 v[28:29], v2 offset:15520
    ds_read_b64_tr_b16 v[30:31], v2 offset:16808
    s_waitcnt lgkmcnt(10)
    v_mfma_f32_32x32x16_bf16 v[48:63], a[88:91], v[40:43], v[48:63]
    ds_read_b64_tr_b16 v[32:33], v2 offset:20672
    ds_read_b64_tr_b16 v[34:35], v2 offset:21960
    s_waitcnt lgkmcnt(10)
    v_mfma_f32_32x32x16_bf16 v[48:63], a[92:95], v[44:47], v[48:63]
    ds_read_b64_tr_b16 v[36:37], v2 offset:25824
    ds_read_b64_tr_b16 v[38:39], v2 offset:27112
    s_waitcnt lgkmcnt(10)
    v_mfma_f32_32x32x16_bf16 v[64:79], a[32:35], v[16:19], 0
    ds_read_b64_tr_b16 v[40:41], v2 offset:30976
    ds_read_b64_tr_b16 v[42:43], v2 offset:32264
    s_waitcnt lgkmcnt(10)
    v_mfma_f32_32x32x16_bf16 v[64:79], a[36:39], v[20:23], v[64:79]
    ds_read_b64_tr_b16 v[44:45], v2 offset:36128
    ds_read_b64_tr_b16 v[46:47], v2 offset:37416
    s_waitcnt lgkmcnt(10)
    v_mfma_f32_32x32x16_bf16 v[64:79], a[40:43], v[24:27], v[64:79]
    ds_read_b64_tr_b16 v[16:17], v3 offset:64
    ds_read_b64_tr_b16 v[18:19], v3 offset:1352
    s_waitcnt lgkmcnt(10)
    v_mfma_f32_32x32x16_bf16 v[64:79], a[44:47], v[28:31], v[64:79]
    ds_read_b64_tr_b16 v[20:21], v3 offset:5216
    ds_read_b64_tr_b16 v[22:23], v3 offset:6504
    v_cvt_pk_bf16_f32 v80, v48, v49
    v_cvt_pk_bf16_f32 v81, v50, v51
    ds_write_b64 v5, v[80:81] offset:0
    s_waitcnt lgkmcnt(10)
    v_mfma_f32_32x32x16_bf16 v[64:79], a[48:51], v[32:35], v[64:79]
    ds_read_b64_tr_b16 v[24:25], v3 offset:10368
    ds_read_b64_tr_b16 v[26:27], v3 offset:11656
    v_cvt_pk_bf16_f32 v82, v52, v53
    v_cvt_pk_bf16_f32 v83, v54, v55
    ds_write_b64 v5, v[82:83] offset:16
    s_waitcnt lgkmcnt(10)
    v_mfma_f32_32x32x16_bf16 v[64:79], a[52:55], v[36:39], v[64:79]
    ds_read_b64_tr_b16 v[28:29], v3 offset:15520
    ds_read_b64_tr_b16 v[30:31], v3 offset:16808
    v_cvt_pk_bf16_f32 v84, v56, v57
    v_cvt_pk_bf16_f32 v85, v58, v59
    ds_write_b64 v5, v[84:85] offset:32
    s_waitcnt lgkmcnt(10)
    v_mfma_f32_32x32x16_bf16 v[64:79], a[56:59], v[40:43], v[64:79]
    ds_read_b64_tr_b16 v[32:33], v3 offset:20672
    ds_read_b64_tr_b16 v[34:35], v3 offset:21960
    v_cvt_pk_bf16_f32 v86, v60, v61
    v_cvt_pk_bf16_f32 v87, v62, v63
    ds_write_b64 v5, v[86:87] offset:48
    s_waitcnt lgkmcnt(10)
    v_mfma_f32_32x32x16_bf16 v[64:79], a[60:63], v[44:47], v[64:79]
    ds_read_b64_tr_b16 v[36:37], v3 offset:25824
    ds_read_b64_tr_b16 v[38:39], v3 offset:27112
    ds_read_b128 v[96:99], v6 offset:0
    s_waitcnt lgkmcnt(10)
    v_mfma_f32_32x32x16_bf16 v[64:79], a[64:67], v[16:19], v[64:79]
    ds_read_b64_tr_b16 v[40:41], v3 offset:30976
    ds_read_b64_tr_b16 v[42:43], v3 offset:32264
    ds_read_b128 v[100:103], v6 offset:1280
    s_waitcnt lgkmcnt(10)
    v_mfma_f32_32x32x16_bf16 v[64:79], a[68:71], v[20:23], v[64:79]
    ds_read_b64_tr_b16 v[44:45], v3 offset:36128
    ds_read_b64_tr_b16 v[46:47], v3 offset:37416
    s_waitcnt lgkmcnt(10)
    v_mfma_f32_32x32x16_bf16 v[64:79], a[72:75], v[24:27], v[64:79]
    ds_read_b64_tr_b16 v[16:17], v2 offset:128
    ds_read_b64_tr_b16 v[18:19], v2 offset:1416
    s_waitcnt lgkmcnt(10)
    v_mfma_f32_32x32x16_bf16 v[64:79], a[76:79], v[28:31], v[64:79]
    ds_read_b64_tr_b16 v[20:21], v2 offset:5280
    ds_read_b64_tr_b16 v[22:23], v2 offset:6568
    s_waitcnt lgkmcnt(10)
    v_mfma_f32_32x32x16_bf16 v[64:79], a[80:83], v[32:35], v[64:79]
    ds_read_b64_tr_b16 v[24:25], v2 offset:10432
    ds_read_b64_tr_b16 v[26:27], v2 offset:11720
    s_waitcnt lgkmcnt(10)
    v_mfma_f32_32x32x16_bf16 v[64:79], a[84:87], v[36:39], v[64:79]
    ds_read_b64_tr_b16 v[28:29], v2 offset:15584
    ds_read_b64_tr_b16 v[30:31], v2 offset:16872
    s_waitcnt lgkmcnt(10)
    v_mfma_f32_32x32x16_bf16 v[64:79], a[88:91], v[40:43], v[64:79]
    ds_read_b64_tr_b16 v[32:33], v2 offset:20736
    ds_read_b64_tr_b16 v[34:35], v2 offset:22024
    s_waitcnt lgkmcnt(10)
    v_mfma_f32_32x32x16_bf16 v[64:79], a[92:95], v[44:47], v[64:79]
    ds_read_b64_tr_b16 v[36:37], v2 offset:25888
    ds_read_b64_tr_b16 v[38:39], v2 offset:27176
    buffer_store_dwordx4 v[96:99], v4, s[28:31], 0 offen sc1
    v_add_u32 v4, 2097152, v4
    buffer_store_dwordx4 v[100:103], v4, s[28:31], 0 offen sc1
    v_add_u32 v4, 2097152, v4
    s_waitcnt lgkmcnt(10)
    v_mfma_f32_32x32x16_bf16 v[48:63], a[32:35], v[16:19], 0
    ds_read_b64_tr_b16 v[40:41], v2 offset:31040
    ds_read_b64_tr_b16 v[42:43], v2 offset:32328
    s_waitcnt lgkmcnt(10)
    v_mfma_f32_32x32x16_bf16 v[48:63], a[36:39], v[20:23], v[48:63]
    ds_read_b64_tr_b16 v[44:45], v2 offset:36192
    ds_read_b64_tr_b16 v[46:47], v2 offset:37480
    s_waitcnt lgkmcnt(10)
    v_mfma_f32_32x32x16_bf16 v[48:63], a[40:43], v[24:27], v[48:63]
    ds_read_b64_tr_b16 v[16:17], v3 offset:128
    ds_read_b64_tr_b16 v[18:19], v3 offset:1416
    s_waitcnt lgkmcnt(10)
    v_mfma_f32_32x32x16_bf16 v[48:63], a[44:47], v[28:31], v[48:63]
    ds_read_b64_tr_b16 v[20:21], v3 offset:5280
    ds_read_b64_tr_b16 v[22:23], v3 offset:6568
    v_cvt_pk_bf16_f32 v88, v64, v65
    v_cvt_pk_bf16_f32 v89, v66, v67
    ds_write_b64 v5, v[88:89] offset:2560
    s_waitcnt lgkmcnt(10)
    v_mfma_f32_32x32x16_bf16 v[48:63], a[48:51], v[32:35], v[48:63]
    ds_read_b64_tr_b16 v[24:25], v3 offset:10432
    ds_read_b64_tr_b16 v[26:27], v3 offset:11720
    v_cvt_pk_bf16_f32 v90, v68, v69
    v_cvt_pk_bf16_f32 v91, v70, v71
    ds_write_b64 v5, v[90:91] offset:2576
    s_waitcnt lgkmcnt(10)
    v_mfma_f32_32x32x16_bf16 v[48:63], a[52:55], v[36:39], v[48:63]
    ds_read_b64_tr_b16 v[28:29], v3 offset:15584
    ds_read_b64_tr_b16 v[30:31], v3 offset:16872
    v_cvt_pk_bf16_f32 v92, v72, v73
    v_cvt_pk_bf16_f32 v93, v74, v75
    ds_write_b64 v5, v[92:93] offset:2592
    s_waitcnt lgkmcnt(10)
    v_mfma_f32_32x32x16_bf16 v[48:63], a[56:59], v[40:43], v[48:63]
    ds_read_b64_tr_b16 v[32:33], v3 offset:20736
    ds_read_b64_tr_b16 v[34:35], v3 offset:22024
    v_cvt_pk_bf16_f32 v94, v76, v77
    v_cvt_pk_bf16_f32 v95, v78, v79
    ds_write_b64 v5, v[94:95] offset:2608
    s_waitcnt lgkmcnt(10)
    v_mfma_f32_32x32x16_bf16 v[48:63], a[60:63], v[44:47], v[48:63]
    ds_read_b64_tr_b16 v[36:37], v3 offset:25888
    ds_read_b64_tr_b16 v[38:39], v3 offset:27176
    ds_read_b128 v[104:107], v6 offset:2560
    s_waitcnt lgkmcnt(10)
    v_mfma_f32_32x32x16_bf16 v[48:63], a[64:67], v[16:19], v[48:63]
    ds_read_b64_tr_b16 v[40:41], v3 offset:31040
    ds_read_b64_tr_b16 v[42:43], v3 offset:32328
    ds_read_b128 v[108:111], v6 offset:3840
    s_waitcnt lgkmcnt(10)
    v_mfma_f32_32x32x16_bf16 v[48:63], a[68:71], v[20:23], v[48:63]
    ds_read_b64_tr_b16 v[44:45], v3 offset:36192
    ds_read_b64_tr_b16 v[46:47], v3 offset:37480
    s_waitcnt lgkmcnt(10)
    v_mfma_f32_32x32x16_bf16 v[48:63], a[72:75], v[24:27], v[48:63]
    ds_read_b64_tr_b16 v[16:17], v2 offset:192
    ds_read_b64_tr_b16 v[18:19], v2 offset:1480
    s_waitcnt lgkmcnt(10)
    v_mfma_f32_32x32x16_bf16 v[48:63], a[76:79], v[28:31], v[48:63]
    ds_read_b64_tr_b16 v[20:21], v2 offset:5344
    ds_read_b64_tr_b16 v[22:23], v2 offset:6632
    s_waitcnt lgkmcnt(10)
    v_mfma_f32_32x32x16_bf16 v[48:63], a[80:83], v[32:35], v[48:63]
    ds_read_b64_tr_b16 v[24:25], v2 offset:10496
    ds_read_b64_tr_b16 v[26:27], v2 offset:11784
    s_waitcnt lgkmcnt(10)
    v_mfma_f32_32x32x16_bf16 v[48:63], a[84:87], v[36:39], v[48:63]
    ds_read_b64_tr_b16 v[28:29], v2 offset:15648
    ds_read_b64_tr_b16 v[30:31], v2 offset:16936
    s_waitcnt lgkmcnt(10)
    v_mfma_f32_32x32x16_bf16 v[48:63], a[88:91], v[40:43], v[48:63]
    ds_read_b64_tr_b16 v[32:33], v2 offset:20800
    ds_read_b64_tr_b16 v[34:35], v2 offset:22088
    s_waitcnt lgkmcnt(10)
    v_mfma_f32_32x32x16_bf16 v[48:63], a[92:95], v[44:47], v[48:63]
    ds_read_b64_tr_b16 v[36:37], v2 offset:25952
    ds_read_b64_tr_b16 v[38:39], v2 offset:27240
    buffer_store_dwordx4 v[104:107], v4, s[28:31], 0 offen sc1
    v_add_u32 v4, 2097152, v4
    buffer_store_dwordx4 v[108:111], v4, s[28:31], 0 offen sc1
    v_add_u32 v4, 2097152, v4
    s_waitcnt lgkmcnt(10)
    v_mfma_f32_32x32x16_bf16 v[64:79], a[32:35], v[16:19], 0
    ds_read_b64_tr_b16 v[40:41], v2 offset:31104
    ds_read_b64_tr_b16 v[42:43], v2 offset:32392
    s_waitcnt lgkmcnt(10)
    v_mfma_f32_32x32x16_bf16 v[64:79], a[36:39], v[20:23], v[64:79]
    ds_read_b64_tr_b16 v[44:45], v2 offset:36256
    ds_read_b64_tr_b16 v[46:47], v2 offset:37544
    s_waitcnt lgkmcnt(10)
    v_mfma_f32_32x32x16_bf16 v[64:79], a[40:43], v[24:27], v[64:79]
    ds_read_b64_tr_b16 v[16:17], v3 offset:192
    ds_read_b64_tr_b16 v[18:19], v3 offset:1480
    s_waitcnt lgkmcnt(10)
    v_mfma_f32_32x32x16_bf16 v[64:79], a[44:47], v[28:31], v[64:79]
    ds_read_b64_tr_b16 v[20:21], v3 offset:5344
    ds_read_b64_tr_b16 v[22:23], v3 offset:6632
    v_cvt_pk_bf16_f32 v80, v48, v49
    v_cvt_pk_bf16_f32 v81, v50, v51
    ds_write_b64 v5, v[80:81] offset:0
    s_waitcnt lgkmcnt(10)
    v_mfma_f32_32x32x16_bf16 v[64:79], a[48:51], v[32:35], v[64:79]
    ds_read_b64_tr_b16 v[24:25], v3 offset:10496
    ds_read_b64_tr_b16 v[26:27], v3 offset:11784
    v_cvt_pk_bf16_f32 v82, v52, v53
    v_cvt_pk_bf16_f32 v83, v54, v55
    ds_write_b64 v5, v[82:83] offset:16
    s_waitcnt lgkmcnt(10)
    v_mfma_f32_32x32x16_bf16 v[64:79], a[52:55], v[36:39], v[64:79]
    ds_read_b64_tr_b16 v[28:29], v3 offset:15648
    ds_read_b64_tr_b16 v[30:31], v3 offset:16936
    v_cvt_pk_bf16_f32 v84, v56, v57
    v_cvt_pk_bf16_f32 v85, v58, v59
    ds_write_b64 v5, v[84:85] offset:32
    s_waitcnt lgkmcnt(10)
    v_mfma_f32_32x32x16_bf16 v[64:79], a[56:59], v[40:43], v[64:79]
    ds_read_b64_tr_b16 v[32:33], v3 offset:20800
    ds_read_b64_tr_b16 v[34:35], v3 offset:22088
    v_cvt_pk_bf16_f32 v86, v60, v61
    v_cvt_pk_bf16_f32 v87, v62, v63
    ds_write_b64 v5, v[86:87] offset:48
    s_waitcnt lgkmcnt(10)
    v_mfma_f32_32x32x16_bf16 v[64:79], a[60:63], v[44:47], v[64:79]
    ds_read_b64_tr_b16 v[36:37], v3 offset:25952
    ds_read_b64_tr_b16 v[38:39], v3 offset:27240
    ds_read_b128 v[96:99], v6 offset:0
    s_waitcnt lgkmcnt(10)
    v_mfma_f32_32x32x16_bf16 v[64:79], a[64:67], v[16:19], v[64:79]
    ds_read_b64_tr_b16 v[40:41], v3 offset:31104
    ds_read_b64_tr_b16 v[42:43], v3 offset:32392
    ds_read_b128 v[100:103], v6 offset:1280
    s_waitcnt lgkmcnt(10)
    v_mfma_f32_32x32x16_bf16 v[64:79], a[68:71], v[20:23], v[64:79]
    ds_read_b64_tr_b16 v[44:45], v3 offset:36256
    ds_read_b64_tr_b16 v[46:47], v3 offset:37544
    s_waitcnt lgkmcnt(10)
    v_mfma_f32_32x32x16_bf16 v[64:79], a[72:75], v[24:27], v[64:79]
    ds_read_b64_tr_b16 v[16:17], v2 offset:256
    ds_read_b64_tr_b16 v[18:19], v2 offset:1544
    s_waitcnt lgkmcnt(10)
    v_mfma_f32_32x32x16_bf16 v[64:79], a[76:79], v[28:31], v[64:79]
    ds_read_b64_tr_b16 v[20:21], v2 offset:5408
    ds_read_b64_tr_b16 v[22:23], v2 offset:6696
    s_waitcnt lgkmcnt(10)
    v_mfma_f32_32x32x16_bf16 v[64:79], a[80:83], v[32:35], v[64:79]
    ds_read_b64_tr_b16 v[24:25], v2 offset:10560
    ds_read_b64_tr_b16 v[26:27], v2 offset:11848
    s_waitcnt lgkmcnt(10)
    v_mfma_f32_32x32x16_bf16 v[64:79], a[84:87], v[36:39], v[64:79]
    ds_read_b64_tr_b16 v[28:29], v2 offset:15712
    ds_read_b64_tr_b16 v[30:31], v2 offset:17000
    s_waitcnt lgkmcnt(10)
    v_mfma_f32_32x32x16_bf16 v[64:79], a[88:91], v[40:43], v[64:79]
    ds_read_b64_tr_b16 v[32:33], v2 offset:20864
    ds_read_b64_tr_b16 v[34:35], v2 offset:22152
    s_waitcnt lgkmcnt(10)
    v_mfma_f32_32x32x16_bf16 v[64:79], a[92:95], v[44:47], v[64:79]
    ds_read_b64_tr_b16 v[36:37], v2 offset:26016
    ds_read_b64_tr_b16 v[38:39], v2 offset:27304
    buffer_store_dwordx4 v[96:99], v4, s[28:31], 0 offen sc1
    v_add_u32 v4, 2097152, v4
    buffer_store_dwordx4 v[100:103], v4, s[28:31], 0 offen sc1
    v_add_u32 v4, 2097152, v4
    s_waitcnt lgkmcnt(10)
    v_mfma_f32_32x32x16_bf16 v[48:63], a[32:35], v[16:19], 0
    ds_read_b64_tr_b16 v[40:41], v2 offset:31168
    ds_read_b64_tr_b16 v[42:43], v2 offset:32456
    s_waitcnt lgkmcnt(10)
    v_mfma_f32_32x32x16_bf16 v[48:63], a[36:39], v[20:23], v[48:63]
    ds_read_b64_tr_b16 v[44:45], v2 offset:36320
    ds_read_b64_tr_b16 v[46:47], v2 offset:37608
    s_waitcnt lgkmcnt(10)
    v_mfma_f32_32x32x16_bf16 v[48:63], a[40:43], v[24:27], v[48:63]
    ds_read_b64_tr_b16 v[16:17], v3 offset:256
    ds_read_b64_tr_b16 v[18:19], v3 offset:1544
    s_waitcnt lgkmcnt(10)
    v_mfma_f32_32x32x16_bf16 v[48:63], a[44:47], v[28:31], v[48:63]
    ds_read_b64_tr_b16 v[20:21], v3 offset:5408
    ds_read_b64_tr_b16 v[22:23], v3 offset:6696
    v_cvt_pk_bf16_f32 v88, v64, v65
    v_cvt_pk_bf16_f32 v89, v66, v67
    ds_write_b64 v5, v[88:89] offset:2560
    s_waitcnt lgkmcnt(10)
    v_mfma_f32_32x32x16_bf16 v[48:63], a[48:51], v[32:35], v[48:63]
    ds_read_b64_tr_b16 v[24:25], v3 offset:10560
    ds_read_b64_tr_b16 v[26:27], v3 offset:11848
    v_cvt_pk_bf16_f32 v90, v68, v69
    v_cvt_pk_bf16_f32 v91, v70, v71
    ds_write_b64 v5, v[90:91] offset:2576
    s_waitcnt lgkmcnt(10)
    v_mfma_f32_32x32x16_bf16 v[48:63], a[52:55], v[36:39], v[48:63]
    ds_read_b64_tr_b16 v[28:29], v3 offset:15712
    ds_read_b64_tr_b16 v[30:31], v3 offset:17000
    v_cvt_pk_bf16_f32 v92, v72, v73
    v_cvt_pk_bf16_f32 v93, v74, v75
    ds_write_b64 v5, v[92:93] offset:2592
    s_waitcnt lgkmcnt(10)
    v_mfma_f32_32x32x16_bf16 v[48:63], a[56:59], v[40:43], v[48:63]
    ds_read_b64_tr_b16 v[32:33], v3 offset:20864
    ds_read_b64_tr_b16 v[34:35], v3 offset:22152
    v_cvt_pk_bf16_f32 v94, v76, v77
    v_cvt_pk_bf16_f32 v95, v78, v79
    ds_write_b64 v5, v[94:95] offset:2608
    s_waitcnt lgkmcnt(10)
    v_mfma_f32_32x32x16_bf16 v[48:63], a[60:63], v[44:47], v[48:63]
    ds_read_b64_tr_b16 v[36:37], v3 offset:26016
    ds_read_b64_tr_b16 v[38:39], v3 offset:27304
    ds_read_b128 v[104:107], v6 offset:2560
    s_waitcnt lgkmcnt(10)
    v_mfma_f32_32x32x16_bf16 v[48:63], a[64:67], v[16:19], v[48:63]
    ds_read_b64_tr_b16 v[40:41], v3 offset:31168
    ds_read_b64_tr_b16 v[42:43], v3 offset:32456
    ds_read_b128 v[108:111], v6 offset:3840
    s_waitcnt lgkmcnt(10)
    v_mfma_f32_32x32x16_bf16 v[48:63], a[68:71], v[20:23], v[48:63]
    ds_read_b64_tr_b16 v[44:45], v3 offset:36320
    ds_read_b64_tr_b16 v[46:47], v3 offset:37608
    s_waitcnt lgkmcnt(10)
    v_mfma_f32_32x32x16_bf16 v[48:63], a[72:75], v[24:27], v[48:63]
    s_waitcnt lgkmcnt(8)
    v_mfma_f32_32x32x16_bf16 v[48:63], a[76:79], v[28:31], v[48:63]
    s_waitcnt lgkmcnt(6)
    v_mfma_f32_32x32x16_bf16 v[48:63], a[80:83], v[32:35], v[48:63]
    s_waitcnt lgkmcnt(4)
    v_mfma_f32_32x32x16_bf16 v[48:63], a[84:87], v[36:39], v[48:63]
    s_waitcnt lgkmcnt(2)
    v_mfma_f32_32x32x16_bf16 v[48:63], a[88:91], v[40:43], v[48:63]
    s_waitcnt lgkmcnt(0)
    v_mfma_f32_32x32x16_bf16 v[48:63], a[92:95], v[44:47], v[48:63]
    buffer_store_dwordx4 v[104:107], v4, s[28:31], 0 offen sc1
    v_add_u32 v4, 2097152, v4
    buffer_store_dwordx4 v[108:111], v4, s[28:31], 0 offen sc1
    v_add_u32 v4, 2097152, v4
    s_nop 11
    v_cvt_pk_bf16_f32 v80, v48, v49
    v_cvt_pk_bf16_f32 v81, v50, v51
    v_cvt_pk_bf16_f32 v82, v52, v53
    v_cvt_pk_bf16_f32 v83, v54, v55
    v_cvt_pk_bf16_f32 v84, v56, v57
    v_cvt_pk_bf16_f32 v85, v58, v59
    v_cvt_pk_bf16_f32 v86, v60, v61
    v_cvt_pk_bf16_f32 v87, v62, v63
    ds_write_b64 v5, v[80:81] offset:0
    ds_write_b64 v5, v[82:83] offset:16
    ds_write_b64 v5, v[84:85] offset:32
    ds_write_b64 v5, v[86:87] offset:48
    ds_read_b128 v[96:99], v6 offset:0
    ds_read_b128 v[100:103], v6 offset:1280
    s_waitcnt lgkmcnt(0)
    buffer_store_dwordx4 v[96:99], v4, s[28:31], 0 offen sc1
    v_add_u32 v4, 2097152, v4
    buffer_store_dwordx4 v[100:103], v4, s[28:31], 0 offen sc1
    v_add_u32 v4, 2097152, v4
L_end:
    s_endpgm
.section .rodata,"a"
.p2align 6
.amdhsa_kernel bin_edges_kernel
  .amdhsa_next_free_vgpr 48
  .amdhsa_next_free_sgpr 40
  .amdhsa_accum_offset 48
  .amdhsa_group_segment_fixed_size 0
  .amdhsa_kernarg_size 88
  .amdhsa_user_sgpr_count 2
  .amdhsa_user_sgpr_kernarg_segment_ptr 1
  .amdhsa_system_sgpr_workgroup_id_x 1
  .amdhsa_float_denorm_mode_32 3
.end_amdhsa_kernel
.section .rodata,"a"
.p2align 6
.amdhsa_kernel standalone__tensor_product_equiv_mace__graph_kernel
  .amdhsa_next_free_vgpr 256
  .amdhsa_next_free_sgpr 102
  .amdhsa_accum_offset 160
  .amdhsa_group_segment_fixed_size 0
  .amdhsa_kernarg_size 88
  .amdhsa_user_sgpr_count 2
  .amdhsa_user_sgpr_kernarg_segment_ptr 1
  .amdhsa_system_sgpr_workgroup_id_x 1
  .amdhsa_float_denorm_mode_32 3
.end_amdhsa_kernel
```

```asm
; @launch kernel=bin_edges_kernel grid=(272,1,1) block=(640,1,1) lds=17408
; @launch kernel=standalone__tensor_product_equiv_mace__graph_kernel grid=(256,1,1) block=(512,1,1) lds=124160
.amdgcn_target "amdgcn-amd-amdhsa--gfx950"
.text
.globl bin_edges_kernel
.p2align 8
.type bin_edges_kernel,@function
bin_edges_kernel:
    s_cmp_ge_u32 s2, 272
    s_cbranch_scc1 K_end
    s_load_dwordx16 s[16:31], s[0:1], 0
    s_load_dwordx2 s[32:33], s[0:1], 80
    s_cmp_ge_u32 s2, 256
    s_cbranch_scc1 K_weights
    s_and_b32 s38, s2, 63
    s_lshr_b32 s39, s2, 6
    s_mul_i32 s39, s39, 64
    s_mul_i32 s3, s38, 10000
    v_lshlrev_b32 v1, 4, v0
    v_add_u32 v2, s3, v1
    v_lshlrev_b32 v3, 1, v2
    s_mov_b32 s14, 625
    v_cmp_gt_u32 s[34:35], s14, v0
    v_mov_b32 v47, 0
    s_waitcnt lgkmcnt(0)
    s_mov_b32 s4, s20
    s_mov_b32 s5, s21
    s_mov_b32 s6, 640000
    s_mov_b32 s7, 0x00020000
    buffer_load_dwordx4 v[4:7], v2, s[4:7], 0 offen nt
    s_mov_b32 s8, s18
    s_mov_b32 s9, s19
    s_mov_b32 s10, 640000
    s_mov_b32 s11, 0x00020000
    buffer_load_dwordx4 v[8:11], v2, s[8:11], 0 offen nt
    s_mov_b32 s40, s22
    s_mov_b32 s41, s23
    s_mov_b32 s42, 1280000
    s_mov_b32 s43, 0x00020000
    buffer_load_dwordx4 v[32:35], v3, s[40:43], 0 offen
    buffer_load_dwordx4 v[36:39], v3, s[40:43], 0 offen offset:16
    s_mov_b32 s12, s32
    s_mov_b32 s13, s33
    s_mov_b32 s14, 12582912
    s_mov_b32 s15, 0x00020000
    v_mov_b32 v12, -1
    v_mov_b32 v13, -1
    v_mov_b32 v14, -1
    v_mov_b32 v15, -1
    s_movk_i32 s36, 512
    v_cmp_gt_u32 s[44:45], s36, v0
    s_movk_i32 s54, 64
    v_cmp_gt_u32 vcc, s54, v0
    v_mov_b32 v16, 0
    v_lshlrev_b32 v3, 2, v0
    s_mov_b64 exec, s[44:45]
    ds_write_b128 v1, v[12:15] offset:0
    s_mov_b64 exec, vcc
    v_add_u32 v3, 16384, v3
    ds_write_b32 v3, v16
    s_mov_b64 exec, -1
    v_mov_b32 v18, 1
    v_lshlrev_b32 v19, 22, v0
    v_lshrrev_b32 v2, 3, v0
    v_add_u32 v2, s39, v2
    v_lshlrev_b32 v2, 6, v2
    v_add_u32 v2, s38, v2
    v_and_b32 v3, 7, v0
    v_lshlrev_b32 v3, 4, v3
    v_lshl_add_u32 v17, v2, 8, v3
    v_add_u32 v17, 8388608, v17
    v_lshl_add_u32 v2, v2, 7, v3
    s_mov_b32 s3, 16384
    s_waitcnt lgkmcnt(0)
    s_barrier
    s_waitcnt vmcnt(3)
    v_and_b32 v20, 255, v4
    v_subrev_u32 v20, s39, v20
    v_cmp_gt_u32 vcc, s54, v20
    v_lshl_add_u32 v24, v20, 2, s3
    s_and_b64 s[46:47], vcc, s[34:35]
    s_mov_b64 exec, s[46:47]
    ds_add_rtn_u32 v28, v24, v18
    s_mov_b64 exec, -1
    v_and_b32 v21, 255, v5
    v_subrev_u32 v21, s39, v21
    v_cmp_gt_u32 vcc, s54, v21
    v_lshl_add_u32 v25, v21, 2, s3
    s_and_b64 s[48:49], vcc, s[34:35]
    s_mov_b64 exec, s[48:49]
    ds_add_rtn_u32 v29, v25, v18
    s_mov_b64 exec, -1
    v_and_b32 v22, 255, v6
    v_subrev_u32 v22, s39, v22
    v_cmp_gt_u32 vcc, s54, v22
    v_lshl_add_u32 v26, v22, 2, s3
    s_and_b64 s[50:51], vcc, s[34:35]
    s_mov_b64 exec, s[50:51]
    ds_add_rtn_u32 v30, v26, v18
    s_mov_b64 exec, -1
    v_and_b32 v23, 255, v7
    v_subrev_u32 v23, s39, v23
    v_cmp_gt_u32 vcc, s54, v23
    v_lshl_add_u32 v27, v23, 2, s3
    s_and_b64 s[52:53], vcc, s[34:35]
    s_mov_b64 exec, s[52:53]
    ds_add_rtn_u32 v31, v27, v18
    s_mov_b64 exec, -1
    s_waitcnt vmcnt(2)
    v_bfe_u32 v4, v4, 8, 6
    v_min_u32 v4, 47, v4
    v_and_b32 v8, 0x3fff, v8
    v_lshl_or_b32 v4, v8, 6, v4
    v_add_u32 v8, 0, v19
    v_or_b32 v4, v4, v8
    v_bfe_u32 v5, v5, 8, 6
    v_min_u32 v5, 47, v5
    v_and_b32 v9, 0x3fff, v9
    v_lshl_or_b32 v5, v9, 6, v5
    v_add_u32 v9, 1048576, v19
    v_or_b32 v5, v5, v9
    v_bfe_u32 v6, v6, 8, 6
    v_min_u32 v6, 47, v6
    v_and_b32 v10, 0x3fff, v10
    v_lshl_or_b32 v6, v10, 6, v6
    v_add_u32 v10, 2097152, v19
    v_or_b32 v6, v6, v10
    v_bfe_u32 v7, v7, 8, 6
    v_min_u32 v7, 47, v7
    v_and_b32 v11, 0x3fff, v11
    v_lshl_or_b32 v7, v11, 6, v7
    v_add_u32 v11, 3145728, v19
    v_or_b32 v7, v7, v11
    v_mov_b32 v12, -2
    s_waitcnt lgkmcnt(0)
    v_cmp_gt_u32 vcc, 31, v28
    v_min_u32 v28, 31, v28
    v_lshlrev_b32 v24, 7, v20
    v_cndmask_b32 v4, v12, v4, vcc
    v_lshl_add_u32 v8, v28, 2, v24
    s_mov_b64 exec, s[46:47]
    ds_write_b32 v8, v4
    s_mov_b64 exec, -1
    v_lshl_add_u32 v24, v28, 3, v24
    v_cmp_gt_u32 vcc, 31, v29
    v_min_u32 v29, 31, v29
    v_lshlrev_b32 v25, 7, v21
    v_cndmask_b32 v5, v12, v5, vcc
    v_lshl_add_u32 v9, v29, 2, v25
    s_mov_b64 exec, s[48:49]
    ds_write_b32 v9, v5
    s_mov_b64 exec, -1
    v_lshl_add_u32 v25, v29, 3, v25
    v_cmp_gt_u32 vcc, 31, v30
    v_min_u32 v30, 31, v30
    v_lshlrev_b32 v26, 7, v22
    v_cndmask_b32 v6, v12, v6, vcc
    v_lshl_add_u32 v10, v30, 2, v26
    s_mov_b64 exec, s[50:51]
    ds_write_b32 v10, v6
    s_mov_b64 exec, -1
    v_lshl_add_u32 v26, v30, 3, v26
    v_cmp_gt_u32 vcc, 31, v31
    v_min_u32 v31, 31, v31
    v_lshlrev_b32 v27, 7, v23
    v_cndmask_b32 v7, v12, v7, vcc
    v_lshl_add_u32 v11, v31, 2, v27
    s_mov_b64 exec, s[52:53]
    ds_write_b32 v11, v7
    s_mov_b64 exec, -1
    v_lshl_add_u32 v27, v31, 3, v27
    s_waitcnt vmcnt(0)
    v_cmp_gt_u32 vcc, 16, v28
    s_and_b64 exec, vcc, s[46:47]
    ds_write_b64 v24, v[32:33] offset:8192
    s_andn2_b64 exec, s[46:47], vcc
    s_cbranch_execz K_1
    v_add_u32 v13, s39, v20
    v_lshlrev_b32 v13, 6, v13
    v_add_u32 v13, s38, v13
    v_lshlrev_b32 v13, 8, v13
    v_lshl_add_u32 v13, v28, 3, v13
    v_add_u32 v13, 8388608, v13
    buffer_store_dwordx2 v[32:33], v13, s[12:15], 0 offen
K_1:
    s_mov_b64 exec, -1
    v_cmp_gt_u32 vcc, 16, v29
    s_and_b64 exec, vcc, s[48:49]
    ds_write_b64 v25, v[34:35] offset:8192
    s_andn2_b64 exec, s[48:49], vcc
    s_cbranch_execz K_2
    v_add_u32 v13, s39, v21
    v_lshlrev_b32 v13, 6, v13
    v_add_u32 v13, s38, v13
    v_lshlrev_b32 v13, 8, v13
    v_lshl_add_u32 v13, v29, 3, v13
    v_add_u32 v13, 8388608, v13
    buffer_store_dwordx2 v[34:35], v13, s[12:15], 0 offen
K_2:
    s_mov_b64 exec, -1
    v_cmp_gt_u32 vcc, 16, v30
    s_and_b64 exec, vcc, s[50:51]
    ds_write_b64 v26, v[36:37] offset:8192
    s_andn2_b64 exec, s[50:51], vcc
    s_cbranch_execz K_3
    v_add_u32 v13, s39, v22
    v_lshlrev_b32 v13, 6, v13
    v_add_u32 v13, s38, v13
    v_lshlrev_b32 v13, 8, v13
    v_lshl_add_u32 v13, v30, 3, v13
    v_add_u32 v13, 8388608, v13
    buffer_store_dwordx2 v[36:37], v13, s[12:15], 0 offen
K_3:
    s_mov_b64 exec, -1
    v_cmp_gt_u32 vcc, 16, v31
    s_and_b64 exec, vcc, s[52:53]
    ds_write_b64 v27, v[38:39] offset:8192
    s_andn2_b64 exec, s[52:53], vcc
    s_cbranch_execz K_4
    v_add_u32 v13, s39, v23
    v_lshlrev_b32 v13, 6, v13
    v_add_u32 v13, s38, v13
    v_lshlrev_b32 v13, 8, v13
    v_lshl_add_u32 v13, v31, 3, v13
    v_add_u32 v13, 8388608, v13
    buffer_store_dwordx2 v[38:39], v13, s[12:15], 0 offen
K_4:
    s_mov_b64 exec, -1
    s_waitcnt lgkmcnt(0)
    s_barrier
    ds_read_b128 v[48:51], v1 offset:0
    ds_read_b128 v[52:55], v1 offset:8192
    s_mov_b64 exec, s[44:45]
    s_cbranch_execz K_sdone
    s_waitcnt lgkmcnt(1)
    buffer_store_dwordx4 v[48:51], v2, s[12:15], 0 offen sc1
    s_waitcnt lgkmcnt(0)
    buffer_store_dwordx4 v[52:55], v17, s[12:15], 0 offen sc1
K_sdone:
    s_branch K_end
K_weights:
    v_lshrrev_b32 v1, 6, v0
    v_and_b32 v2, 63, v0
    v_readfirstlane_b32 s3, v1
    s_sub_u32 s34, s2, 256
    s_mul_i32 s34, s34, 10
    s_add_u32 s3, s3, s34
    s_cmp_ge_u32 s3, 137
    s_cbranch_scc1 K_end
    s_waitcnt lgkmcnt(0)
    s_mov_b32 s12, s32
    s_mov_b32 s13, s33
    s_mov_b32 s14, 12582912
    s_mov_b32 s15, 0x00020000
    s_lshl_b32 s34, s3, 10
    s_add_u32 s34, s34, 2097152
    v_lshlrev_b32 v3, 4, v2
    v_add_u32 v3, s34, v3
    s_cmp_ge_u32 s3, 136
    s_cbranch_scc1 K_cg
    s_cmp_ge_u32 s3, 128
    s_cbranch_scc1 K_wr
    s_mov_b32 s4, s30
    s_mov_b32 s5, s31
    s_mov_b32 s6, 131072
    s_mov_b32 s7, 0x00020000
    s_and_b32 s34, s3, 15
    s_lshl_b32 s34, s34, 13
    s_lshr_b32 s35, s3, 4
    s_lshl_b32 s35, s35, 6
    s_add_u32 s34, s34, s35
    v_lshrrev_b32 v4, 5, v2
    v_lshlrev_b32 v4, 12, v4
    v_and_b32 v5, 31, v2
    v_lshl_add_u32 v4, v5, 1, v4
    v_add_u32 v4, s34, v4
    s_branch K_wgo
K_wr:
    s_mov_b32 s4, s28
    s_mov_b32 s5, s29
    s_mov_b32 s6, 8192
    s_mov_b32 s7, 0x00020000
    s_sub_u32 s34, s3, 128
    s_lshl_b32 s34, s34, 6
    v_bfe_u32 v4, v2, 4, 1
    v_lshlrev_b32 v4, 12, v4
    v_lshrrev_b32 v5, 5, v2
    v_lshl_add_u32 v4, v5, 5, v4
    v_and_b32 v5, 15, v2
    v_lshl_add_u32 v4, v5, 1, v4
    v_add_u32 v4, s34, v4
K_wgo:
    buffer_load_ushort v16, v4, s[4:7], 0 offen offset:0
    buffer_load_ushort v17, v4, s[4:7], 0 offen offset:512
    buffer_load_ushort v18, v4, s[4:7], 0 offen offset:1024
    buffer_load_ushort v19, v4, s[4:7], 0 offen offset:1536
    buffer_load_ushort v20, v4, s[4:7], 0 offen offset:2048
    buffer_load_ushort v21, v4, s[4:7], 0 offen offset:2560
    buffer_load_ushort v22, v4, s[4:7], 0 offen offset:3072
    buffer_load_ushort v23, v4, s[4:7], 0 offen offset:3584
    s_branch K_wst
K_cg:
    s_mov_b32 s4, s26
    s_mov_b32 s5, s27
    s_mov_b32 s6, 128
    s_mov_b32 s7, 0x00020000
    v_and_b32 v4, 3, v2
    v_lshlrev_b32 v4, 5, v4
    v_lshrrev_b32 v5, 4, v2
    v_lshl_add_u32 v4, v5, 1, v4
    buffer_load_ushort v16, v4, s[4:7], 0 offen offset:0
    buffer_load_ushort v17, v4, s[4:7], 0 offen offset:8
    buffer_load_ushort v18, v4, s[4:7], 0 offen offset:16
    buffer_load_ushort v19, v4, s[4:7], 0 offen offset:24
    v_lshlrev_b32 v3, 3, v2
    v_add_u32 v3, 2236416, v3
    s_waitcnt vmcnt(0)
    v_lshl_or_b32 v8, v17, 16, v16
    v_lshl_or_b32 v9, v19, 16, v18
    buffer_store_dwordx2 v[8:9], v3, s[12:15], 0 offen
    s_branch K_end
K_wst:
    s_waitcnt vmcnt(0)
    v_lshl_or_b32 v8, v17, 16, v16
    v_lshl_or_b32 v9, v19, 16, v18
    v_lshl_or_b32 v10, v21, 16, v20
    v_lshl_or_b32 v11, v23, 16, v22
    buffer_store_dwordx4 v[8:11], v3, s[12:15], 0 offen
K_end:
    s_endpgm
.globl standalone__tensor_product_equiv_mace__graph_kernel
.p2align 8
.type standalone__tensor_product_equiv_mace__graph_kernel,@function
standalone__tensor_product_equiv_mace__graph_kernel:
    s_cmp_ge_u32 s2, 256
    s_cbranch_scc1 L_end
    s_load_dwordx2 s[84:85], s[0:1], 80
    s_load_dwordx16 s[64:79], s[0:1], 0
    s_load_dwordx2 s[80:81], s[0:1], 64
    v_and_b32 v1, 63, v0
    v_lshrrev_b32 v60, 6, v0
    v_mov_b32 v12, 0
    v_readfirstlane_b32 s3, v60
    s_lshl_b32 s53, s2, 13
    v_lshlrev_b32 v60, 4, v0
    v_add_u32 v60, s53, v60
    v_lshlrev_b32 v64, 4, v1
    v_add_u32 v61, 2228224, v64
    v_add_u32 v62, 2232320, v64
    v_lshlrev_b32 v63, 3, v1
    v_add_u32 v63, 2236416, v63
    s_waitcnt lgkmcnt(0)
    s_mov_b32 s32, s84
    s_mov_b32 s33, s85
    s_mov_b32 s34, 12582912
    s_mov_b32 s35, 0x00020000
    buffer_load_dwordx4 v[16:19], v60, s[32:35], 0 offen
    s_mov_b32 s8, s64
    s_mov_b32 s9, s65
    s_mov_b32 s10, 20480000
    s_mov_b32 s11, 0x00020000
    s_mov_b32 s12, s66
    s_mov_b32 s13, s67
    s_mov_b32 s14, 640000
    s_mov_b32 s15, 0x00020000
    s_mov_b32 s16, s68
    s_mov_b32 s17, s69
    s_mov_b32 s18, 640000
    s_mov_b32 s19, 0x00020000
    s_mov_b32 s20, s70
    s_mov_b32 s21, s71
    s_mov_b32 s22, 1280000
    s_mov_b32 s23, 0x00020000
    s_mov_b32 s24, s72
    s_mov_b32 s25, s73
    s_mov_b32 s26, 5120000
    s_mov_b32 s27, 0x00020000
    s_mov_b32 s28, s80
    s_mov_b32 s29, s81
    s_mov_b32 s30, 20480000
    s_mov_b32 s31, 0x00020000
    buffer_load_dwordx4 a[0:3], v61, s[32:35], 0 offen offset:0
    buffer_load_dwordx4 a[4:7], v61, s[32:35], 0 offen offset:1024
    buffer_load_dwordx4 a[8:11], v61, s[32:35], 0 offen offset:2048
    buffer_load_dwordx4 a[12:15], v61, s[32:35], 0 offen offset:3072
    buffer_load_dwordx4 a[16:19], v62, s[32:35], 0 offen offset:0
    buffer_load_dwordx4 a[20:23], v62, s[32:35], 0 offen offset:1024
    buffer_load_dwordx4 a[24:27], v62, s[32:35], 0 offen offset:2048
    buffer_load_dwordx4 a[28:31], v62, s[32:35], 0 offen offset:3072
    buffer_load_dwordx2 a[32:33], v63, s[32:35], 0 offen
    v_mov_b32 v68, 0
    v_mov_b32 v69, 0
    v_lshlrev_b32 v60, 3, v0
    v_add_u32 v60, 110848, v60
    ds_write_b64 v60, v[68:69]
    v_and_b32 v60, 3, v1
    v_lshlrev_b32 v60, 3, v60
    v_add_u32 v60, 119040, v60
    ds_write_b64 v60, v[68:69]
    s_lshl_b32 s63, s3, 13
    s_mov_b32 s52, 0
    s_mov_b32 s77, 0
    s_mov_b32 s82, 0x3fff00
    s_waitcnt lgkmcnt(0)
    s_barrier
    v_lshrrev_b32 v66, 4, v1
    v_and_b32 v61, 7, v1
    v_bfe_u32 v65, v1, 3, 1
    v_lshlrev_b32 v65, 9, v65
    v_lshl_add_u32 v65, v66, 7, v65
    v_lshl_add_u32 v2, v61, 4, v65
    v_xor_b32 v61, 4, v61
    v_lshl_add_u32 v3, v61, 4, v65
    v_bfe_u32 v60, v1, 2, 2
    v_bfe_u32 v62, v1, 1, 1
    v_lshl_add_u32 v62, v66, 1, v62
    v_lshrrev_b32 v63, 1, v60
    v_lshlrev_b32 v64, 2, v63
    v_xor_b32 v62, v62, v64
    v_and_b32 v64, 1, v60
    v_lshl_add_u32 v62, v64, 3, v62
    v_lshlrev_b32 v62, 4, v62
    v_lshl_add_u32 v62, v63, 10, v62
    v_and_b32 v64, 1, v1
    v_lshl_add_u32 v62, v64, 3, v62
    v_add_u32 v4, s63, v62
    v_lshrrev_b32 v61, 5, v1
    v_mov_b32 v63, 32
    v_cmp_eq_u32 vcc, v60, v61
    v_add_u32 v61, 2, v61
    v_and_b32 v64, 3, v1
    v_cndmask_b32 v7, 0, v63, vcc
    v_cmp_eq_u32 vcc, v60, v61
    v_cmp_eq_u32 s[4:5], v64, v66
    v_mov_b32 v65, 8
    v_cndmask_b32 v8, 0, v63, vcc
    v_cndmask_b32 v10, 0, v65, s[4:5]
    v_lshrrev_b32 v67, 3, v0
    v_mul_u32_u24 v67, 2500, v67
    v_lshl_add_u32 v67, v1, 20, v67
    v_mov_b32 v69, 114624
    v_mov_b64 v[80:81], 0
    v_mov_b64 v[82:83], 0
    v_mov_b64 v[84:85], 0
    v_mov_b64 v[86:87], 0
    v_mov_b64 v[88:89], 0
    v_mov_b64 v[90:91], 0
    v_mov_b64 v[92:93], 0
    v_mov_b64 v[94:95], 0
    v_mov_b64 v[96:97], 0
    v_mov_b64 v[98:99], 0
    v_mov_b64 v[100:101], 0
    v_mov_b64 v[102:103], 0
    v_mov_b64 v[104:105], 0
    v_mov_b64 v[106:107], 0
    v_mov_b64 v[108:109], 0
    v_mov_b64 v[110:111], 0
    v_mov_b64 v[112:113], 0
    v_mov_b64 v[114:115], 0
    v_mov_b64 v[116:117], 0
    v_mov_b64 v[118:119], 0
    v_mov_b64 v[120:121], 0
    v_mov_b64 v[122:123], 0
    v_mov_b64 v[124:125], 0
    v_mov_b64 v[126:127], 0
    v_mov_b64 v[128:129], 0
    v_mov_b64 v[130:131], 0
    v_mov_b64 v[132:133], 0
    v_mov_b64 v[134:135], 0
    v_mov_b64 v[136:137], 0
    v_mov_b64 v[138:139], 0
    v_mov_b64 v[140:141], 0
    v_mov_b64 v[142:143], 0
    v_mov_b64 v[144:145], 0
    v_mov_b64 v[146:147], 0
    v_mov_b64 v[148:149], 0
    v_mov_b64 v[150:151], 0
    v_mov_b64 v[152:153], 0
    v_mov_b64 v[154:155], 0
    v_mov_b64 v[156:157], 0
    v_mov_b64 v[158:159], 0
    s_waitcnt vmcnt(9)
    v_cmp_gt_u32 s[36:37], -2, v16
    v_cmp_gt_u32 s[38:39], -2, v17
    v_cmp_gt_u32 s[40:41], -2, v18
    v_cmp_gt_u32 s[42:43], -2, v19
    v_cmp_eq_u32 vcc, -2, v19
    s_bcnt1_i32_b64 s79, s[36:37]
    s_bcnt1_i32_b64 s53, s[38:39]
    s_add_u32 s79, s79, s53
    s_bcnt1_i32_b64 s53, s[40:41]
    s_add_u32 s79, s79, s53
    s_bcnt1_i32_b64 s53, s[42:43]
    s_add_u32 s79, s79, s53
    v_mov_b32 v70, s79
    s_mov_b64 exec, 1
    ds_add_rtn_u32 v70, v69, v70
    s_mov_b64 exec, -1
    v_mov_b32 v56, 0
    v_mbcnt_lo_u32_b32 v56, s36, v56
    v_mbcnt_hi_u32_b32 v56, s37, v56
    v_mbcnt_lo_u32_b32 v56, s38, v56
    v_mbcnt_hi_u32_b32 v56, s39, v56
    v_mbcnt_lo_u32_b32 v56, s40, v56
    v_mbcnt_hi_u32_b32 v56, s41, v56
    v_mbcnt_lo_u32_b32 v56, s42, v56
    v_mbcnt_hi_u32_b32 v56, s43, v56
    s_add_u32 s53, s63, 4096
    v_lshl_add_u32 v58, v56, 2, s53
    v_lshrrev_b32 v20, 20, v16
    v_add_u32 v20, v20, v67
    v_add_u32 v67, 262144, v67
    s_mov_b64 exec, s[36:37]
    ds_write_b32 v58, v20 offset:0
    s_mov_b64 exec, -1
    v_lshrrev_b32 v21, 20, v17
    v_add_u32 v21, v21, v67
    v_add_u32 v67, 262144, v67
    s_mov_b64 exec, s[38:39]
    ds_write_b32 v58, v21 offset:4
    s_mov_b64 exec, -1
    v_lshrrev_b32 v22, 20, v18
    v_add_u32 v22, v22, v67
    v_add_u32 v67, 262144, v67
    s_mov_b64 exec, s[40:41]
    ds_write_b32 v58, v22 offset:8
    s_mov_b64 exec, -1
    v_lshrrev_b32 v23, 20, v19
    v_add_u32 v23, v23, v67
    s_mov_b64 exec, s[42:43]
    ds_write_b32 v58, v23 offset:12
    s_mov_b64 exec, -1
    v_lshlrev_b32 v24, 2, v16
    v_and_b32 v24, s82, v24
    v_and_b32 v16, 63, v16
    v_lshlrev_b32 v25, 2, v17
    v_and_b32 v25, s82, v25
    v_and_b32 v17, 63, v17
    v_lshlrev_b32 v26, 2, v18
    v_and_b32 v26, s82, v26
    v_and_b32 v18, 63, v18
    v_lshlrev_b32 v27, 2, v19
    v_and_b32 v27, s82, v27
    v_and_b32 v19, 63, v19
    s_mov_b32 s80, 79
    s_waitcnt lgkmcnt(0)
    v_readfirstlane_b32 s44, v70
    s_cbranch_vccnz L_defer
    s_add_u32 s53, s44, s79
    s_cmp_gt_u32 s53, 1024
    s_cbranch_scc1 L_defer
    v_add_u32 v56, s44, v56
    v_lshl_or_b32 v24, v56, 22, v24
    v_add_u32 v56, 1, v56
    v_lshl_or_b32 v25, v56, 22, v25
    v_add_u32 v56, 1, v56
    v_lshl_or_b32 v26, v56, 22, v26
    v_add_u32 v56, 1, v56
    v_lshl_or_b32 v27, v56, 22, v27
    s_branch L_have
L_defer:
    s_mov_b32 s80, 0
    s_mov_b32 s79, 0
    s_mov_b32 s44, 0
    s_mov_b64 s[36:37], 0
    s_mov_b64 s[38:39], 0
    s_mov_b64 s[40:41], 0
    s_mov_b64 s[42:43], 0
    v_mov_b32 v58, 1
    v_mov_b32 v59, 119056
    ds_write_b32 v59, v58
    s_branch L_have
L_scan:
    s_barrier
    s_mov_b32 s64, s63
    s_add_u32 s65, s63, 1024
    s_xor_b32 s47, s2, 1
L_sloop:
    s_cmp_ge_u32 s80, 79
    s_cbranch_scc1 L_scan_done
    s_mul_i32 s53, s3, 20000
    s_lshl_b32 s54, s80, 8
    s_add_u32 s55, s53, s54
    v_lshlrev_b32 v56, 2, v1
    v_add_u32 v56, s55, v56
    v_lshlrev_b32 v57, 2, v56
    buffer_load_dwordx4 v[60:63], v57, s[16:19], 0 offen
    s_waitcnt vmcnt(0)
    s_cmp_lg_u32 s80, 78
    s_cbranch_scc1 L_snotlast
    s_mov_b32 exec_lo, 0xffffff00
    v_mov_b32 v60, s47
    v_mov_b32 v61, s47
    v_mov_b32 v62, s47
    v_mov_b32 v63, s47
    s_mov_b64 exec, -1
L_snotlast:
    s_cmp_gt_u32 s52, 0
    s_cbranch_scc1 L_1
    v_cmp_eq_u32_sdwa vcc, v60, s2 src0_sel:BYTE_0 src1_sel:DWORD
    s_cbranch_vccz L_1
    s_bcnt1_i32_b64 s53, vcc
    s_lshl3_add_u32 s54, s53, s64
    s_mov_b32 s52, 0
    s_cmp_gt_u32 s54, s65
    s_cbranch_scc1 L_ovf
    v_mbcnt_lo_u32_b32 v58, vcc_lo, 0
    v_mbcnt_hi_u32_b32 v58, vcc_hi, v58
    v_lshl_add_u32 v58, v58, 3, s64
    v_add_u32 v59, 0, v56
    s_mov_b64 exec, vcc
    ds_write2_b32 v58, v60, v59 offset0:0 offset1:1
    s_mov_b64 exec, -1
    s_mov_b32 s64, s54
L_1:
    s_cmp_gt_u32 s52, 1
    s_cbranch_scc1 L_2
    v_cmp_eq_u32_sdwa vcc, v61, s2 src0_sel:BYTE_0 src1_sel:DWORD
    s_cbranch_vccz L_2
    s_bcnt1_i32_b64 s53, vcc
    s_lshl3_add_u32 s54, s53, s64
    s_mov_b32 s52, 1
    s_cmp_gt_u32 s54, s65
    s_cbranch_scc1 L_ovf
    v_mbcnt_lo_u32_b32 v58, vcc_lo, 0
    v_mbcnt_hi_u32_b32 v58, vcc_hi, v58
    v_lshl_add_u32 v58, v58, 3, s64
    v_add_u32 v59, 1, v56
    s_mov_b64 exec, vcc
    ds_write2_b32 v58, v61, v59 offset0:0 offset1:1
    s_mov_b64 exec, -1
    s_mov_b32 s64, s54
L_2:
    s_cmp_gt_u32 s52, 2
    s_cbranch_scc1 L_3
    v_cmp_eq_u32_sdwa vcc, v62, s2 src0_sel:BYTE_0 src1_sel:DWORD
    s_cbranch_vccz L_3
    s_bcnt1_i32_b64 s53, vcc
    s_lshl3_add_u32 s54, s53, s64
    s_mov_b32 s52, 2
    s_cmp_gt_u32 s54, s65
    s_cbranch_scc1 L_ovf
    v_mbcnt_lo_u32_b32 v58, vcc_lo, 0
    v_mbcnt_hi_u32_b32 v58, vcc_hi, v58
    v_lshl_add_u32 v58, v58, 3, s64
    v_add_u32 v59, 2, v56
    s_mov_b64 exec, vcc
    ds_write2_b32 v58, v62, v59 offset0:0 offset1:1
    s_mov_b64 exec, -1
    s_mov_b32 s64, s54
L_3:
    s_cmp_gt_u32 s52, 3
    s_cbranch_scc1 L_4
    v_cmp_eq_u32_sdwa vcc, v63, s2 src0_sel:BYTE_0 src1_sel:DWORD
    s_cbranch_vccz L_4
    s_bcnt1_i32_b64 s53, vcc
    s_lshl3_add_u32 s54, s53, s64
    s_mov_b32 s52, 3
    s_cmp_gt_u32 s54, s65
    s_cbranch_scc1 L_ovf
    v_mbcnt_lo_u32_b32 v58, vcc_lo, 0
    v_mbcnt_hi_u32_b32 v58, vcc_hi, v58
    v_lshl_add_u32 v58, v58, 3, s64
    v_add_u32 v59, 3, v56
    s_mov_b64 exec, vcc
    ds_write2_b32 v58, v63, v59 offset0:0 offset1:1
    s_mov_b64 exec, -1
    s_mov_b32 s64, s54
L_4:
    s_mov_b32 s52, 0
    s_add_u32 s80, s80, 1
    s_branch L_sloop
L_ovf:
    v_mov_b32 v58, 1
    v_mov_b32 v59, 119056
    ds_write_b32 v59, v58
L_scan_done:
    s_sub_u32 s79, s64, s63
    s_lshr_b32 s79, s79, 3
    s_lshl_b32 s44, s3, 7
    v_lshlrev_b32 v58, 3, v1
    v_add_u32 v58, s63, v58
    s_waitcnt lgkmcnt(0)
    ds_read_b32 v16, v58 offset:0
    ds_read_b32 v20, v58 offset:4
    s_sub_u32 s53, s79, 0
    v_cmp_gt_i32 s[36:37], s53, v1
    ds_read_b32 v17, v58 offset:512
    ds_read_b32 v21, v58 offset:516
    s_sub_u32 s53, s79, 64
    v_cmp_gt_i32 s[38:39], s53, v1
    s_mov_b64 s[40:41], 0
    v_mov_b32 v18, 0
    v_mov_b32 v26, 0
    s_mov_b64 s[42:43], 0
    v_mov_b32 v19, 0
    v_mov_b32 v27, 0
    v_lshl_add_u32 v58, v1, 2, s63
    v_add_u32 v59, s44, v1
    v_lshlrev_b32 v59, 22, v59
    s_waitcnt lgkmcnt(0)
    v_lshlrev_b32 v28, 2, v20
    buffer_load_dword v24, v28, s[12:15], 0 offen
    v_bfe_u32 v16, v16, 8, 6
    v_min_u32 v16, 47, v16
    ds_write_b32 v58, v20 offset:4096
    v_lshlrev_b32 v29, 2, v21
    buffer_load_dword v25, v29, s[12:15], 0 offen
    v_bfe_u32 v17, v17, 8, 6
    v_min_u32 v17, 47, v17
    ds_write_b32 v58, v21 offset:4352
    s_waitcnt vmcnt(0)
    v_and_b32 v24, 0x3fff, v24
    v_lshl_or_b32 v24, v24, 8, v59
    v_add_u32 v59, 268435456, v59
    v_and_b32 v25, 0x3fff, v25
    v_lshl_or_b32 v25, v25, 8, v59
    v_add_u32 v59, 268435456, v59
L_have:
    v_mov_b32 v58, 1
    s_mov_b32 s53, 110848
    s_mov_b32 s54, 114688
    v_bfe_u32 v28, v24, 8, 14
    v_mul_u32_u24 v28, 6711, v28
    v_lshrrev_b32 v28, 22, v28
    v_min_u32 v28, 15, v28
    v_lshl_add_u32 v28, v28, 2, s53
    v_lshl_add_u32 v28, v16, 6, v28
    v_lshl_add_u32 v16, v16, 2, s54
    s_mov_b64 exec, s[36:37]
    ds_add_rtn_u32 v32, v28, v58
    ds_add_u32 v16, v58
    s_mov_b64 exec, -1
    v_bfe_u32 v29, v25, 8, 14
    v_mul_u32_u24 v29, 6711, v29
    v_lshrrev_b32 v29, 22, v29
    v_min_u32 v29, 15, v29
    v_lshl_add_u32 v29, v29, 2, s53
    v_lshl_add_u32 v29, v17, 6, v29
    v_lshl_add_u32 v17, v17, 2, s54
    s_mov_b64 exec, s[38:39]
    ds_add_rtn_u32 v33, v29, v58
    ds_add_u32 v17, v58
    s_mov_b64 exec, -1
    v_bfe_u32 v30, v26, 8, 14
    v_mul_u32_u24 v30, 6711, v30
    v_lshrrev_b32 v30, 22, v30
    v_min_u32 v30, 15, v30
    v_lshl_add_u32 v30, v30, 2, s53
    v_lshl_add_u32 v30, v18, 6, v30
    v_lshl_add_u32 v18, v18, 2, s54
    s_mov_b64 exec, s[40:41]
    ds_add_rtn_u32 v34, v30, v58
    ds_add_u32 v18, v58
    s_mov_b64 exec, -1
    v_bfe_u32 v31, v27, 8, 14
    v_mul_u32_u24 v31, 6711, v31
    v_lshrrev_b32 v31, 22, v31
    v_min_u32 v31, 15, v31
    v_lshl_add_u32 v31, v31, 2, s53
    v_lshl_add_u32 v31, v19, 6, v31
    v_lshl_add_u32 v19, v19, 2, s54
    s_mov_b64 exec, s[42:43]
    ds_add_rtn_u32 v35, v31, v58
    ds_add_u32 v19, v58
    s_mov_b64 exec, -1
    v_lshrrev_b32 v36, 1, v1
    s_add_u32 s53, s63, 4096
    v_lshl_add_u32 v39, v36, 2, s53
    ds_read_b32 v40, v39 offset:0
    ds_read_b32 v41, v39 offset:128
    ds_read_b32 v42, v39 offset:256
    ds_read_b32 v43, v39 offset:384
    v_and_b32 v38, 1, v1
    v_lshlrev_b32 v37, 4, v38
    v_lshlrev_b32 v38, 2, v38
    s_lshl3_add_u32 s53, s2, s3
    s_lshl_b32 s53, s53, 11
    s_add_u32 s53, s53, 8388608
    s_cmp_eq_u32 s77, 0
    s_cselect_b32 s53, s53, 0
    s_cselect_b32 s47, 18, 0
    v_add_u32 v38, s53, v38
    s_mov_b32 s46, s79
    s_mov_b32 s45, s44
    v_lshl_add_u32 v56, v1, 2, s54
    v_mov_b32 v57, 119056
    s_waitcnt lgkmcnt(0)
    s_cmp_le_i32 s46, 0
    s_cbranch_scc1 L_5
    v_and_b32 v44, 0x3ffff, v40
    v_lshl_add_u32 v44, v44, 5, v37
    v_lshrrev_b32 v45, s47, v40
    v_lshl_add_u32 v45, v45, 3, v38
    v_cmp_gt_i32 vcc, s46, v36
    s_lshl_b32 s76, s45, 5
    s_add_u32 m0, s76, 65536
    s_mov_b64 exec, vcc
    buffer_load_dwordx4 v44, s[24:27], 0 offen lds
    s_lshl3_add_u32 m0, s45, 98304
    s_add_u32 s45, s45, 32
    s_cmp_lg_u32 s77, 0
    s_cbranch_scc1 L_6
    buffer_load_dword v45, s[32:35], 0 offen lds
    s_branch L_7
L_6:
    buffer_load_dword v45, s[20:23], 0 offen lds
L_7:
    s_mov_b64 exec, -1
    s_sub_i32 s46, s46, 32
L_5:
    s_barrier
    ds_read_b32 v56, v56
    ds_read_b32 v57, v57
    s_cmp_le_i32 s46, 0
    s_cbranch_scc1 L_8
    v_and_b32 v44, 0x3ffff, v41
    v_lshl_add_u32 v44, v44, 5, v37
    v_lshrrev_b32 v45, s47, v41
    v_lshl_add_u32 v45, v45, 3, v38
    v_cmp_gt_i32 vcc, s46, v36
    s_lshl_b32 s76, s45, 5
    s_add_u32 m0, s76, 65536
    s_mov_b64 exec, vcc
    buffer_load_dwordx4 v44, s[24:27], 0 offen lds
    s_lshl3_add_u32 m0, s45, 98304
    s_add_u32 s45, s45, 32
    s_cmp_lg_u32 s77, 0
    s_cbranch_scc1 L_9
    buffer_load_dword v45, s[32:35], 0 offen lds
    s_branch L_10
L_9:
    buffer_load_dword v45, s[20:23], 0 offen lds
L_10:
    s_mov_b64 exec, -1
    s_sub_i32 s46, s46, 32
L_8:
    s_waitcnt lgkmcnt(0)
    v_readfirstlane_b32 s78, v57
    s_cmp_lg_u32 s77, 0
    s_cbranch_scc1 L_assigned
    v_sub_u32 v57, 63, v1
    v_lshl_add_u32 v57, v56, 6, v57
    v_mov_b32 v59, 0
    v_readlane_b32 s84, v57, 0
    v_readlane_b32 s85, v57, 1
    v_readlane_b32 s86, v57, 2
    v_readlane_b32 s87, v57, 3
    v_readlane_b32 s88, v57, 4
    v_readlane_b32 s89, v57, 5
    v_readlane_b32 s90, v57, 6
    v_readlane_b32 s91, v57, 7
    v_readlane_b32 s92, v57, 8
    v_readlane_b32 s93, v57, 9
    v_readlane_b32 s94, v57, 10
    v_readlane_b32 s95, v57, 11
    v_readlane_b32 s96, v57, 12
    v_readlane_b32 s97, v57, 13
    v_readlane_b32 s98, v57, 14
    v_readlane_b32 s99, v57, 15
    v_cmp_gt_u32 vcc, s84, v57
    v_cmp_gt_u32 s[4:5], s85, v57
    v_cmp_gt_u32 s[6:7], s86, v57
    v_addc_co_u32 v59, vcc, 0, v59, vcc
    v_addc_co_u32 v59, s[4:5], 0, v59, s[4:5]
    v_addc_co_u32 v59, s[6:7], 0, v59, s[6:7]
    v_cmp_gt_u32 vcc, s87, v57
    v_cmp_gt_u32 s[4:5], s88, v57
    v_cmp_gt_u32 s[6:7], s89, v57
    v_addc_co_u32 v59, vcc, 0, v59, vcc
    v_addc_co_u32 v59, s[4:5], 0, v59, s[4:5]
    v_addc_co_u32 v59, s[6:7], 0, v59, s[6:7]
    v_cmp_gt_u32 vcc, s90, v57
    v_cmp_gt_u32 s[4:5], s91, v57
    v_cmp_gt_u32 s[6:7], s92, v57
    v_addc_co_u32 v59, vcc, 0, v59, vcc
    v_addc_co_u32 v59, s[4:5], 0, v59, s[4:5]
    v_addc_co_u32 v59, s[6:7], 0, v59, s[6:7]
    v_cmp_gt_u32 vcc, s93, v57
    v_cmp_gt_u32 s[4:5], s94, v57
    v_cmp_gt_u32 s[6:7], s95, v57
    v_addc_co_u32 v59, vcc, 0, v59, vcc
    v_addc_co_u32 v59, s[4:5], 0, v59, s[4:5]
    v_addc_co_u32 v59, s[6:7], 0, v59, s[6:7]
    v_cmp_gt_u32 vcc, s96, v57
    v_cmp_gt_u32 s[4:5], s97, v57
    v_cmp_gt_u32 s[6:7], s98, v57
    v_addc_co_u32 v59, vcc, 0, v59, vcc
    v_addc_co_u32 v59, s[4:5], 0, v59, s[4:5]
    v_addc_co_u32 v59, s[6:7], 0, v59, s[6:7]
    v_cmp_gt_u32 vcc, s99, v57
    s_nop 1
    v_addc_co_u32 v59, vcc, 0, v59, vcc
    v_readlane_b32 s84, v57, 16
    v_readlane_b32 s85, v57, 17
    v_readlane_b32 s86, v57, 18
    v_readlane_b32 s87, v57, 19
    v_readlane_b32 s88, v57, 20
    v_readlane_b32 s89, v57, 21
    v_readlane_b32 s90, v57, 22
    v_readlane_b32 s91, v57, 23
    v_readlane_b32 s92, v57, 24
    v_readlane_b32 s93, v57, 25
    v_readlane_b32 s94, v57, 26
    v_readlane_b32 s95, v57, 27
    v_readlane_b32 s96, v57, 28
    v_readlane_b32 s97, v57, 29
    v_readlane_b32 s98, v57, 30
    v_readlane_b32 s99, v57, 31
    v_cmp_gt_u32 vcc, s84, v57
    v_cmp_gt_u32 s[4:5], s85, v57
    v_cmp_gt_u32 s[6:7], s86, v57
    v_addc_co_u32 v59, vcc, 0, v59, vcc
    v_addc_co_u32 v59, s[4:5], 0, v59, s[4:5]
    v_addc_co_u32 v59, s[6:7], 0, v59, s[6:7]
    v_cmp_gt_u32 vcc, s87, v57
    v_cmp_gt_u32 s[4:5], s88, v57
    v_cmp_gt_u32 s[6:7], s89, v57
    v_addc_co_u32 v59, vcc, 0, v59, vcc
    v_addc_co_u32 v59, s[4:5], 0, v59, s[4:5]
    v_addc_co_u32 v59, s[6:7], 0, v59, s[6:7]
    v_cmp_gt_u32 vcc, s90, v57
    v_cmp_gt_u32 s[4:5], s91, v57
    v_cmp_gt_u32 s[6:7], s92, v57
    v_addc_co_u32 v59, vcc, 0, v59, vcc
    v_addc_co_u32 v59, s[4:5], 0, v59, s[4:5]
    v_addc_co_u32 v59, s[6:7], 0, v59, s[6:7]
    v_cmp_gt_u32 vcc, s93, v57
    v_cmp_gt_u32 s[4:5], s94, v57
    v_cmp_gt_u32 s[6:7], s95, v57
    v_addc_co_u32 v59, vcc, 0, v59, vcc
    v_addc_co_u32 v59, s[4:5], 0, v59, s[4:5]
    v_addc_co_u32 v59, s[6:7], 0, v59, s[6:7]
    v_cmp_gt_u32 vcc, s96, v57
    v_cmp_gt_u32 s[4:5], s97, v57
    v_cmp_gt_u32 s[6:7], s98, v57
    v_addc_co_u32 v59, vcc, 0, v59, vcc
    v_addc_co_u32 v59, s[4:5], 0, v59, s[4:5]
    v_addc_co_u32 v59, s[6:7], 0, v59, s[6:7]
    v_cmp_gt_u32 vcc, s99, v57
    s_nop 1
    v_addc_co_u32 v59, vcc, 0, v59, vcc
    v_readlane_b32 s84, v57, 32
    v_readlane_b32 s85, v57, 33
    v_readlane_b32 s86, v57, 34
    v_readlane_b32 s87, v57, 35
    v_readlane_b32 s88, v57, 36
    v_readlane_b32 s89, v57, 37
    v_readlane_b32 s90, v57, 38
    v_readlane_b32 s91, v57, 39
    v_cmp_gt_u32 vcc, s84, v57
    v_cmp_gt_u32 s[4:5], s85, v57
    v_cmp_gt_u32 s[6:7], s86, v57
    v_addc_co_u32 v59, vcc, 0, v59, vcc
    v_addc_co_u32 v59, s[4:5], 0, v59, s[4:5]
    v_addc_co_u32 v59, s[6:7], 0, v59, s[6:7]
    v_cmp_gt_u32 vcc, s87, v57
    v_cmp_gt_u32 s[4:5], s88, v57
    v_cmp_gt_u32 s[6:7], s89, v57
    v_addc_co_u32 v59, vcc, 0, v59, vcc
    v_addc_co_u32 v59, s[4:5], 0, v59, s[4:5]
    v_addc_co_u32 v59, s[6:7], 0, v59, s[6:7]
    v_cmp_gt_u32 vcc, s90, v57
    v_cmp_gt_u32 s[4:5], s91, v57
    s_nop 0
    v_addc_co_u32 v59, vcc, 0, v59, vcc
    v_addc_co_u32 v59, s[4:5], 0, v59, s[4:5]
    v_bfe_u32 v60, v59, 3, 1
    v_mul_u32_u24 v60, 7, v60
    v_and_b32 v61, 7, v59
    v_xor_b32 v11, v60, v61
    s_sub_u32 s53, 7, s3
    s_add_u32 s54, s3, 0
    v_cmp_eq_u32 vcc, s54, v59
    s_ff1_i32_b64 s56, vcc
    s_add_u32 s54, s53, 8
    v_cmp_eq_u32 vcc, s54, v59
    s_ff1_i32_b64 s57, vcc
    s_add_u32 s54, s3, 16
    v_cmp_eq_u32 vcc, s54, v59
    s_ff1_i32_b64 s58, vcc
    s_add_u32 s54, s53, 24
    v_cmp_eq_u32 vcc, s54, v59
    s_ff1_i32_b64 s59, vcc
    s_add_u32 s54, s3, 32
    v_cmp_eq_u32 vcc, s54, v59
    s_ff1_i32_b64 s60, vcc
L_assigned:
    v_cmp_gt_u32 vcc, s3, v11
    v_and_b32 v61, 15, v1
    v_lshlrev_b32 v61, 2, v61
    v_cndmask_b32 v60, 0, v56, vcc
    v_add_u32 v61, 110848, v61
    s_lshl_b32 s84, s56, 6
    v_add_u32 v64, s84, v61
    ds_read_b32 v70, v64
    s_lshl_b32 s85, s57, 6
    v_add_u32 v65, s85, v61
    ds_read_b32 v71, v65
    s_lshl_b32 s86, s58, 6
    v_add_u32 v66, s86, v61
    ds_read_b32 v72, v66
    s_lshl_b32 s87, s59, 6
    v_add_u32 v67, s87, v61
    ds_read_b32 v73, v67
    s_lshl_b32 s88, s60, 6
    v_add_u32 v68, s88, v61
    ds_read_b32 v74, v68
    v_add_u32_dpp v60, v60, v60 row_shr:1 row_mask:0xf bank_mask:0xf bound_ctrl:1
    v_readlane_b32 s92, v56, s56
    s_nop 0
    v_add_u32_dpp v60, v60, v60 row_shr:2 row_mask:0xf bank_mask:0xf bound_ctrl:1
    v_readlane_b32 s93, v56, s57
    s_nop 0
    v_add_u32_dpp v60, v60, v60 row_shr:4 row_mask:0xf bank_mask:0xf bound_ctrl:1
    v_readlane_b32 s94, v56, s58
    s_nop 0
    v_add_u32_dpp v60, v60, v60 row_shr:8 row_mask:0xf bank_mask:0xf bound_ctrl:1
    v_readlane_b32 s95, v56, s59
    s_nop 0
    v_readlane_b32 s96, v56, s60
    v_readlane_b32 s61, v60, 15
    v_readlane_b32 s53, v60, 31
    v_readlane_b32 s54, v60, 47
    s_add_u32 s62, s92, s93
    s_add_u32 s62, s62, s94
    s_add_u32 s62, s62, s95
    s_add_u32 s62, s62, s96
    s_add_u32 s61, s61, s53
    s_add_u32 s61, s61, s54
    s_add_u32 s61, s61, 3
    s_andn2_b32 s61, s61, 3
    s_lshl2_add_u32 s61, s3, s61
    s_waitcnt lgkmcnt(0)
    v_add3_u32 v60, v70, v71, v72
    v_add3_u32 v60, v60, v73, v74
    v_mov_b32 v61, v60
    s_nop 1
    v_add_u32_dpp v61, v61, v61 row_shr:1 row_mask:0xf bank_mask:0xf bound_ctrl:1
    s_nop 1
    v_add_u32_dpp v61, v61, v61 row_shr:2 row_mask:0xf bank_mask:0xf bound_ctrl:1
    s_nop 1
    v_add_u32_dpp v61, v61, v61 row_shr:4 row_mask:0xf bank_mask:0xf bound_ctrl:1
    s_nop 1
    v_add_u32_dpp v61, v61, v61 row_shr:8 row_mask:0xf bank_mask:0xf bound_ctrl:1
    v_sub_u32 v61, v61, v60
    v_add_u32 v61, s61, v61
    v_lshl_add_u32 v75, v61, 8, 0
    ds_write_b32 v64, v75 offset:4096
    v_add_u32 v61, v61, v70
    v_lshl_add_u32 v76, v61, 8, 16
    ds_write_b32 v65, v76 offset:4096
    v_add_u32 v61, v61, v71
    v_lshl_add_u32 v77, v61, 8, 32
    ds_write_b32 v66, v77 offset:4096
    v_add_u32 v61, v61, v72
    v_lshl_add_u32 v78, v61, 8, 48
    ds_write_b32 v67, v78 offset:4096
    v_add_u32 v61, v61, v73
    v_lshl_add_u32 v79, v61, 8, 64
    ds_write_b32 v68, v79 offset:4096
    s_cmp_le_i32 s46, 0
    s_cbranch_scc1 L_11
    v_and_b32 v44, 0x3ffff, v42
    v_lshl_add_u32 v44, v44, 5, v37
    v_lshrrev_b32 v45, s47, v42
    v_lshl_add_u32 v45, v45, 3, v38
    v_cmp_gt_i32 vcc, s46, v36
    s_lshl_b32 s76, s45, 5
    s_add_u32 m0, s76, 65536
    s_mov_b64 exec, vcc
    buffer_load_dwordx4 v44, s[24:27], 0 offen lds
    s_lshl3_add_u32 m0, s45, 98304
    s_add_u32 s45, s45, 32
    s_cmp_lg_u32 s77, 0
    s_cbranch_scc1 L_12
    buffer_load_dword v45, s[32:35], 0 offen lds
    s_branch L_13
L_12:
    buffer_load_dword v45, s[20:23], 0 offen lds
L_13:
    s_mov_b64 exec, -1
    s_sub_i32 s46, s46, 32
L_11:
    s_waitcnt lgkmcnt(0)
    s_barrier
    ds_read_b32 v16, v28 offset:4096
    ds_read_b32 v17, v29 offset:4096
    ds_read_b32 v18, v30 offset:4096
    ds_read_b32 v19, v31 offset:4096
    v_mov_b32 v60, 0
    v_mov_b32 v61, 0
    v_lshlrev_b32 v64, 3, v0
    v_add_u32 v64, 110848, v64
    ds_write_b64 v64, v[60:61]
    v_mov_b32 v64, 119056
    ds_write_b32 v64, v60
    s_mov_b32 s53, 106496
    s_movk_i32 s54, 255
    s_waitcnt lgkmcnt(2)
    v_lshrrev_b32 v28, 8, v16
    v_add_u32 v28, v28, v32
    v_and_or_b32 v16, v16, s54, v24
    v_lshl_add_u32 v28, v28, 2, s53
    s_mov_b64 exec, s[36:37]
    ds_write_b32 v28, v16
    s_mov_b64 exec, -1
    v_lshrrev_b32 v29, 8, v17
    v_add_u32 v29, v29, v33
    v_and_or_b32 v17, v17, s54, v25
    v_lshl_add_u32 v29, v29, 2, s53
    s_mov_b64 exec, s[38:39]
    ds_write_b32 v29, v17
    s_mov_b64 exec, -1
    v_lshrrev_b32 v30, 8, v18
    v_add_u32 v30, v30, v34
    v_and_or_b32 v18, v18, s54, v26
    v_lshl_add_u32 v30, v30, 2, s53
    s_mov_b64 exec, s[40:41]
    ds_write_b32 v30, v18
    s_mov_b64 exec, -1
    v_lshrrev_b32 v31, 8, v19
    v_add_u32 v31, v31, v35
    v_and_or_b32 v19, v19, s54, v27
    v_lshl_add_u32 v31, v31, 2, s53
    s_mov_b64 exec, s[42:43]
    ds_write_b32 v31, v19
    s_mov_b64 exec, -1
    s_cmp_le_i32 s46, 0
    s_cbranch_scc1 L_14
    v_and_b32 v44, 0x3ffff, v43
    v_lshl_add_u32 v44, v44, 5, v37
    v_lshrrev_b32 v45, s47, v43
    v_lshl_add_u32 v45, v45, 3, v38
    v_cmp_gt_i32 vcc, s46, v36
    s_lshl_b32 s76, s45, 5
    s_add_u32 m0, s76, 65536
    s_mov_b64 exec, vcc
    buffer_load_dwordx4 v44, s[24:27], 0 offen lds
    s_lshl3_add_u32 m0, s45, 98304
    s_add_u32 s45, s45, 32
    s_cmp_lg_u32 s77, 0
    s_cbranch_scc1 L_15
    buffer_load_dword v45, s[32:35], 0 offen lds
    s_branch L_16
L_15:
    buffer_load_dword v45, s[20:23], 0 offen lds
L_16:
    s_mov_b64 exec, -1
    s_sub_i32 s46, s46, 32
L_14:
L_paymore:
    s_cmp_le_i32 s46, 0
    s_cbranch_scc1 L_paydone
    ds_read_b32 v40, v39 offset:512
    v_add_u32 v39, 128, v39
    s_waitcnt lgkmcnt(0)
    s_cmp_le_i32 s46, 0
    s_cbranch_scc1 L_17
    v_and_b32 v44, 0x3ffff, v40
    v_lshl_add_u32 v44, v44, 5, v37
    v_lshrrev_b32 v45, s47, v40
    v_lshl_add_u32 v45, v45, 3, v38
    v_cmp_gt_i32 vcc, s46, v36
    s_lshl_b32 s76, s45, 5
    s_add_u32 m0, s76, 65536
    s_mov_b64 exec, vcc
    buffer_load_dwordx4 v44, s[24:27], 0 offen lds
    s_lshl3_add_u32 m0, s45, 98304
    s_add_u32 s45, s45, 32
    s_cmp_lg_u32 s77, 0
    s_cbranch_scc1 L_18
    buffer_load_dword v45, s[32:35], 0 offen lds
    s_branch L_19
L_18:
    buffer_load_dword v45, s[20:23], 0 offen lds
L_19:
    s_mov_b64 exec, -1
    s_sub_i32 s46, s46, 32
L_17:
    s_branch L_paymore
L_paydone:
    s_lshl_b32 s61, s61, 2
    s_add_u32 s61, s61, 106496
    v_mov_b32 v13, s61
    v_and_b32 v62, 3, v1
    v_lshl_add_u32 v77, v62, 2, s61
    v_bfe_u32 v62, v1, 2, 2
    v_lshl_add_u32 v78, v62, 2, s61
    v_bfe_u32 v63, v1, 4, 1
    v_lshlrev_b32 v63, 4, v63
    v_add_u32 v63, 65536, v63
    v_mov_b32 v65, 98304
    v_mov_b32 v62, 119040
    v_cmp_ne_u32 vcc, 0, v7
    v_cmp_ne_u32 s[4:5], 0, v8
    v_cmp_ne_u32 s[6:7], 0, v10
    v_cndmask_b32 v74, v62, v63, vcc
    v_cndmask_b32 v75, v62, v63, s[4:5]
    v_cndmask_b32 v76, v62, v65, s[6:7]
    s_waitcnt lgkmcnt(0)
    s_barrier
    ds_read_b128 v[68:71], v13
    ds_read_b32 v72, v77
    ds_read_b32 v73, v78
    s_cmp_lt_u32 s62, 3
    s_cbranch_scc1 L_short
    s_waitcnt lgkmcnt(2)
    v_readfirstlane_b32 s64, v68
    v_readfirstlane_b32 s65, v69
    v_readfirstlane_b32 s66, v70
    v_readfirstlane_b32 s67, v71
    s_and_b32 s76, s64, s82
    s_add_u32 m0, s63, 0
    s_lshl_b32 s76, s76, 3
    buffer_load_dwordx4 v2, s[8:11], s76 offen lds
    buffer_load_dwordx4 v3, s[8:11], s76 offen offset:1024 lds
    s_and_b32 s76, s65, s82
    s_add_u32 m0, s63, 2048
    s_lshl_b32 s76, s76, 3
    buffer_load_dwordx4 v2, s[8:11], s76 offen lds
    buffer_load_dwordx4 v3, s[8:11], s76 offen offset:1024 lds
    s_and_b32 s76, s66, s82
    s_add_u32 m0, s63, 4096
    s_lshl_b32 s76, s76, 3
    buffer_load_dwordx4 v2, s[8:11], s76 offen lds
    buffer_load_dwordx4 v3, s[8:11], s76 offen offset:1024 lds
    s_waitcnt vmcnt(6)
    s_branch L_go
L_short:
    s_waitcnt vmcnt(0) lgkmcnt(0)
    v_readfirstlane_b32 s64, v68
    v_readfirstlane_b32 s65, v69
    v_readfirstlane_b32 s66, v70
    v_readfirstlane_b32 s67, v71
    s_cmp_le_u32 s62, 0
    s_cbranch_scc1 L_go
    s_and_b32 s76, s64, s82
    s_add_u32 m0, s63, 0
    s_lshl_b32 s76, s76, 3
    buffer_load_dwordx4 v2, s[8:11], s76 offen lds
    buffer_load_dwordx4 v3, s[8:11], s76 offen offset:1024 lds
    s_cmp_le_u32 s62, 1
    s_cbranch_scc1 L_go
    s_and_b32 s76, s65, s82
    s_add_u32 m0, s63, 2048
    s_lshl_b32 s76, s76, 3
    buffer_load_dwordx4 v2, s[8:11], s76 offen lds
    buffer_load_dwordx4 v3, s[8:11], s76 offen offset:1024 lds
L_go:
    s_waitcnt lgkmcnt(0)
    v_lshrrev_b32 v72, 22, v72
    v_lshrrev_b32 v73, 22, v73
    v_mad_u32_u24 v5, v72, v7, v74
    v_mad_u32_u24 v6, v72, v8, v75
    v_mad_u32_u24 v9, v73, v10, v76
    s_barrier
    s_cmp_eq_u32 s62, 0
    s_cbranch_scc1 L_round_done
L_group:
    ds_read_b64 v[14:15], v9
    ds_read_b128 v[56:59], v5
    ds_read_b128 v[60:63], v6
    ds_read_b128 v[68:71], v13 offset:16
    ds_read_b32 v72, v77 offset:16
    ds_read_b32 v73, v78 offset:16
    v_add_u32 v13, 16, v13
    v_add_u32 v77, 16, v77
    v_add_u32 v78, 16, v78
    s_waitcnt lgkmcnt(0)
    v_mfma_f32_16x16x16_bf16 v[64:67], a[32:33], v[14:15], 0
    v_mfma_f32_16x16x32_bf16 v[16:19], v[56:59], a[0:3], 0
    v_mfma_f32_16x16x32_bf16 v[20:23], v[56:59], a[8:11], 0
    v_mfma_f32_16x16x32_bf16 v[24:27], v[56:59], a[16:19], 0
    v_mfma_f32_16x16x32_bf16 v[28:31], v[56:59], a[24:27], 0
    v_mfma_f32_16x16x32_bf16 v[16:19], v[60:63], a[4:7], v[16:19]
    v_mfma_f32_16x16x32_bf16 v[20:23], v[60:63], a[12:15], v[20:23]
    v_mfma_f32_16x16x32_bf16 v[24:27], v[60:63], a[20:23], v[24:27]
    v_mfma_f32_16x16x32_bf16 v[28:31], v[60:63], a[28:31], v[28:31]
    v_readfirstlane_b32 s68, v68
    v_readfirstlane_b32 s69, v69
    v_readfirstlane_b32 s70, v70
    v_readfirstlane_b32 s71, v71
    v_cvt_pk_bf16_f32 v14, v64, v65
    v_cvt_pk_bf16_f32 v15, v66, v67
    v_lshrrev_b32 v72, 22, v72
    v_lshrrev_b32 v73, 22, v73
    v_mad_u32_u24 v5, v72, v7, v74
    v_mad_u32_u24 v6, v72, v8, v75
    v_mad_u32_u24 v9, v73, v10, v76
    s_cmp_ge_u32 s62, 3
    s_cbranch_scc1 L_20
    s_waitcnt vmcnt(0)
L_20:
    s_waitcnt vmcnt(4)
    ds_read_b64_tr_b16 v[48:49], v4 offset:0
    ds_read_b64_tr_b16 v[50:51], v4 offset:256
    ds_read_b64_tr_b16 v[52:53], v4 offset:512
    ds_read_b64_tr_b16 v[54:55], v4 offset:768
    s_cmp_le_u32 s62, 3
    s_cbranch_scc1 L_21
    s_and_b32 s76, s67, s82
    s_add_u32 m0, s63, 6144
    s_lshl_b32 s76, s76, 3
    buffer_load_dwordx4 v2, s[8:11], s76 offen lds
    buffer_load_dwordx4 v3, s[8:11], s76 offen offset:1024 lds
L_21:
    s_waitcnt lgkmcnt(0)
    v_mfma_f32_4x4x4_16b_bf16 v[32:35], v[14:15], v[48:49], 0 cbsz:4 abid:0
    v_mfma_f32_4x4x4_16b_bf16 v[36:39], v[14:15], v[50:51], 0 cbsz:4 abid:0
    v_mfma_f32_4x4x4_16b_bf16 v[40:43], v[14:15], v[52:53], 0 cbsz:4 abid:0
    v_mfma_f32_4x4x4_16b_bf16 v[44:47], v[14:15], v[54:55], 0 cbsz:4 abid:0
    s_nop 0
    s_set_gpr_idx_on s64, gpr_idx(SRC2,DST)
    v_pk_fma_f32 v[80:81], v[32:33], v[16:17], v[80:81] op_sel:[0,0,0] op_sel_hi:[1,0,1]
    v_pk_fma_f32 v[82:83], v[34:35], v[16:17], v[82:83] op_sel:[0,0,0] op_sel_hi:[1,0,1]
    v_pk_fma_f32 v[84:85], v[36:37], v[20:21], v[84:85] op_sel:[0,0,0] op_sel_hi:[1,0,1]
    v_pk_fma_f32 v[86:87], v[38:39], v[20:21], v[86:87] op_sel:[0,0,0] op_sel_hi:[1,0,1]
    v_pk_fma_f32 v[88:89], v[40:41], v[24:25], v[88:89] op_sel:[0,0,0] op_sel_hi:[1,0,1]
    v_pk_fma_f32 v[90:91], v[42:43], v[24:25], v[90:91] op_sel:[0,0,0] op_sel_hi:[1,0,1]
    v_pk_fma_f32 v[92:93], v[44:45], v[28:29], v[92:93] op_sel:[0,0,0] op_sel_hi:[1,0,1]
    v_pk_fma_f32 v[94:95], v[46:47], v[28:29], v[94:95] op_sel:[0,0,0] op_sel_hi:[1,0,1]
    s_set_gpr_idx_off
    s_mov_b32 s64, s68
    s_sub_u32 s62, s62, 1
    s_cmp_eq_u32 s62, 0
    s_cbranch_scc1 L_round_done
    s_cmp_ge_u32 s62, 3
    s_cbranch_scc1 L_22
    s_waitcnt vmcnt(0)
L_22:
    s_waitcnt vmcnt(4)
    ds_read_b64_tr_b16 v[48:49], v4 offset:2048
    ds_read_b64_tr_b16 v[50:51], v4 offset:2304
    ds_read_b64_tr_b16 v[52:53], v4 offset:2560
    ds_read_b64_tr_b16 v[54:55], v4 offset:2816
    s_cmp_le_u32 s62, 3
    s_cbranch_scc1 L_23
    s_and_b32 s76, s68, s82
    s_add_u32 m0, s63, 0
    s_lshl_b32 s76, s76, 3
    buffer_load_dwordx4 v2, s[8:11], s76 offen lds
    buffer_load_dwordx4 v3, s[8:11], s76 offen offset:1024 lds
L_23:
    s_waitcnt lgkmcnt(0)
    v_mfma_f32_4x4x4_16b_bf16 v[32:35], v[14:15], v[48:49], 0 cbsz:4 abid:1
    v_mfma_f32_4x4x4_16b_bf16 v[36:39], v[14:15], v[50:51], 0 cbsz:4 abid:1
    v_mfma_f32_4x4x4_16b_bf16 v[40:43], v[14:15], v[52:53], 0 cbsz:4 abid:1
    v_mfma_f32_4x4x4_16b_bf16 v[44:47], v[14:15], v[54:55], 0 cbsz:4 abid:1
    s_nop 0
    s_set_gpr_idx_on s65, gpr_idx(SRC2,DST)
    v_pk_fma_f32 v[80:81], v[32:33], v[16:17], v[80:81] op_sel:[0,1,0] op_sel_hi:[1,1,1]
    v_pk_fma_f32 v[82:83], v[34:35], v[16:17], v[82:83] op_sel:[0,1,0] op_sel_hi:[1,1,1]
    v_pk_fma_f32 v[84:85], v[36:37], v[20:21], v[84:85] op_sel:[0,1,0] op_sel_hi:[1,1,1]
    v_pk_fma_f32 v[86:87], v[38:39], v[20:21], v[86:87] op_sel:[0,1,0] op_sel_hi:[1,1,1]
    v_pk_fma_f32 v[88:89], v[40:41], v[24:25], v[88:89] op_sel:[0,1,0] op_sel_hi:[1,1,1]
    v_pk_fma_f32 v[90:91], v[42:43], v[24:25], v[90:91] op_sel:[0,1,0] op_sel_hi:[1,1,1]
    v_pk_fma_f32 v[92:93], v[44:45], v[28:29], v[92:93] op_sel:[0,1,0] op_sel_hi:[1,1,1]
    v_pk_fma_f32 v[94:95], v[46:47], v[28:29], v[94:95] op_sel:[0,1,0] op_sel_hi:[1,1,1]
    s_set_gpr_idx_off
    s_mov_b32 s65, s69
    s_sub_u32 s62, s62, 1
    s_cmp_eq_u32 s62, 0
    s_cbranch_scc1 L_round_done
    s_cmp_ge_u32 s62, 3
    s_cbranch_scc1 L_24
    s_waitcnt vmcnt(0)
L_24:
    s_waitcnt vmcnt(4)
    ds_read_b64_tr_b16 v[48:49], v4 offset:4096
    ds_read_b64_tr_b16 v[50:51], v4 offset:4352
    ds_read_b64_tr_b16 v[52:53], v4 offset:4608
    ds_read_b64_tr_b16 v[54:55], v4 offset:4864
    s_cmp_le_u32 s62, 3
    s_cbranch_scc1 L_25
    s_and_b32 s76, s69, s82
    s_add_u32 m0, s63, 2048
    s_lshl_b32 s76, s76, 3
    buffer_load_dwordx4 v2, s[8:11], s76 offen lds
    buffer_load_dwordx4 v3, s[8:11], s76 offen offset:1024 lds
L_25:
    s_waitcnt lgkmcnt(0)
    v_mfma_f32_4x4x4_16b_bf16 v[32:35], v[14:15], v[48:49], 0 cbsz:4 abid:2
    v_mfma_f32_4x4x4_16b_bf16 v[36:39], v[14:15], v[50:51], 0 cbsz:4 abid:2
    v_mfma_f32_4x4x4_16b_bf16 v[40:43], v[14:15], v[52:53], 0 cbsz:4 abid:2
    v_mfma_f32_4x4x4_16b_bf16 v[44:47], v[14:15], v[54:55], 0 cbsz:4 abid:2
    s_nop 0
    s_set_gpr_idx_on s66, gpr_idx(SRC2,DST)
    v_pk_fma_f32 v[80:81], v[32:33], v[18:19], v[80:81] op_sel:[0,0,0] op_sel_hi:[1,0,1]
    v_pk_fma_f32 v[82:83], v[34:35], v[18:19], v[82:83] op_sel:[0,0,0] op_sel_hi:[1,0,1]
    v_pk_fma_f32 v[84:85], v[36:37], v[22:23], v[84:85] op_sel:[0,0,0] op_sel_hi:[1,0,1]
    v_pk_fma_f32 v[86:87], v[38:39], v[22:23], v[86:87] op_sel:[0,0,0] op_sel_hi:[1,0,1]
    v_pk_fma_f32 v[88:89], v[40:41], v[26:27], v[88:89] op_sel:[0,0,0] op_sel_hi:[1,0,1]
    v_pk_fma_f32 v[90:91], v[42:43], v[26:27], v[90:91] op_sel:[0,0,0] op_sel_hi:[1,0,1]
    v_pk_fma_f32 v[92:93], v[44:45], v[30:31], v[92:93] op_sel:[0,0,0] op_sel_hi:[1,0,1]
    v_pk_fma_f32 v[94:95], v[46:47], v[30:31], v[94:95] op_sel:[0,0,0] op_sel_hi:[1,0,1]
    s_set_gpr_idx_off
    s_mov_b32 s66, s70
    s_sub_u32 s62, s62, 1
    s_cmp_eq_u32 s62, 0
    s_cbranch_scc1 L_round_done
    s_cmp_ge_u32 s62, 3
    s_cbranch_scc1 L_26
    s_waitcnt vmcnt(0)
L_26:
    s_waitcnt vmcnt(4)
    ds_read_b64_tr_b16 v[48:49], v4 offset:6144
    ds_read_b64_tr_b16 v[50:51], v4 offset:6400
    ds_read_b64_tr_b16 v[52:53], v4 offset:6656
    ds_read_b64_tr_b16 v[54:55], v4 offset:6912
    s_cmp_le_u32 s62, 3
    s_cbranch_scc1 L_27
    s_and_b32 s76, s70, s82
    s_add_u32 m0, s63, 4096
    s_lshl_b32 s76, s76, 3
    buffer_load_dwordx4 v2, s[8:11], s76 offen lds
    buffer_load_dwordx4 v3, s[8:11], s76 offen offset:1024 lds
L_27:
    s_waitcnt lgkmcnt(0)
    v_mfma_f32_4x4x4_16b_bf16 v[32:35], v[14:15], v[48:49], 0 cbsz:4 abid:3
    v_mfma_f32_4x4x4_16b_bf16 v[36:39], v[14:15], v[50:51], 0 cbsz:4 abid:3
    v_mfma_f32_4x4x4_16b_bf16 v[40:43], v[14:15], v[52:53], 0 cbsz:4 abid:3
    v_mfma_f32_4x4x4_16b_bf16 v[44:47], v[14:15], v[54:55], 0 cbsz:4 abid:3
    s_nop 0
    s_set_gpr_idx_on s67, gpr_idx(SRC2,DST)
    v_pk_fma_f32 v[80:81], v[32:33], v[18:19], v[80:81] op_sel:[0,1,0] op_sel_hi:[1,1,1]
    v_pk_fma_f32 v[82:83], v[34:35], v[18:19], v[82:83] op_sel:[0,1,0] op_sel_hi:[1,1,1]
    v_pk_fma_f32 v[84:85], v[36:37], v[22:23], v[84:85] op_sel:[0,1,0] op_sel_hi:[1,1,1]
    v_pk_fma_f32 v[86:87], v[38:39], v[22:23], v[86:87] op_sel:[0,1,0] op_sel_hi:[1,1,1]
    v_pk_fma_f32 v[88:89], v[40:41], v[26:27], v[88:89] op_sel:[0,1,0] op_sel_hi:[1,1,1]
    v_pk_fma_f32 v[90:91], v[42:43], v[26:27], v[90:91] op_sel:[0,1,0] op_sel_hi:[1,1,1]
    v_pk_fma_f32 v[92:93], v[44:45], v[30:31], v[92:93] op_sel:[0,1,0] op_sel_hi:[1,1,1]
    v_pk_fma_f32 v[94:95], v[46:47], v[30:31], v[94:95] op_sel:[0,1,0] op_sel_hi:[1,1,1]
    s_set_gpr_idx_off
    s_mov_b32 s67, s71
    s_sub_u32 s62, s62, 1
    s_cmp_eq_u32 s62, 0
    s_cbranch_scc0 L_group
L_round_done:
    s_add_u32 s77, s77, 1
    s_cmp_lg_u32 s78, 0
    s_cbranch_scc1 L_scan
    s_lshl_b32 s53, s3, 14
    s_add_u32 s53, s53, 2097152
    v_lshlrev_b32 v16, 4, v1
    v_add_u32 v16, s53, v16
    buffer_load_dwordx4 a[32:35], v16, s[32:35], 0 offen offset:0
    buffer_load_dwordx4 a[36:39], v16, s[32:35], 0 offen offset:1024
    buffer_load_dwordx4 a[40:43], v16, s[32:35], 0 offen offset:2048
    buffer_load_dwordx4 a[44:47], v16, s[32:35], 0 offen offset:3072
    v_add_u32 v16, 4096, v16
    buffer_load_dwordx4 a[48:51], v16, s[32:35], 0 offen offset:0
    buffer_load_dwordx4 a[52:55], v16, s[32:35], 0 offen offset:1024
    buffer_load_dwordx4 a[56:59], v16, s[32:35], 0 offen offset:2048
    buffer_load_dwordx4 a[60:63], v16, s[32:35], 0 offen offset:3072
    v_add_u32 v16, 4096, v16
    buffer_load_dwordx4 a[64:67], v16, s[32:35], 0 offen offset:0
    buffer_load_dwordx4 a[68:71], v16, s[32:35], 0 offen offset:1024
    buffer_load_dwordx4 a[72:75], v16, s[32:35], 0 offen offset:2048
    buffer_load_dwordx4 a[76:79], v16, s[32:35], 0 offen offset:3072
    v_add_u32 v16, 4096, v16
    buffer_load_dwordx4 a[80:83], v16, s[32:35], 0 offen offset:0
    buffer_load_dwordx4 a[84:87], v16, s[32:35], 0 offen offset:1024
    buffer_load_dwordx4 a[88:91], v16, s[32:35], 0 offen offset:2048
    buffer_load_dwordx4 a[92:95], v16, s[32:35], 0 offen offset:3072
    v_add_u32 v16, 4096, v16
    v_mul_u32_u24 v16, 320, v1
    v_lshrrev_b32 v17, 2, v1
    v_lshl_add_u32 v16, v17, 3, v16
    s_lshl_b32 s53, s56, 3
    v_add_u32 v17, s53, v16
    s_lshl_b32 s53, s57, 3
    v_add_u32 v18, s53, v16
    s_lshl_b32 s53, s58, 3
    v_add_u32 v19, s53, v16
    s_lshl_b32 s53, s59, 3
    v_add_u32 v20, s53, v16
    s_lshl_b32 s53, s60, 3
    v_add_u32 v21, s53, v16
    v_cvt_pk_bf16_f32 v24, v80, v81
    v_cvt_pk_bf16_f32 v25, v82, v83
    v_cvt_pk_bf16_f32 v26, v84, v85
    v_cvt_pk_bf16_f32 v27, v86, v87
    v_cvt_pk_bf16_f32 v28, v88, v89
    v_cvt_pk_bf16_f32 v29, v90, v91
    v_cvt_pk_bf16_f32 v30, v92, v93
    v_cvt_pk_bf16_f32 v31, v94, v95
    v_cvt_pk_bf16_f32 v32, v96, v97
    v_cvt_pk_bf16_f32 v33, v98, v99
    v_cvt_pk_bf16_f32 v34, v100, v101
    v_cvt_pk_bf16_f32 v35, v102, v103
    v_cvt_pk_bf16_f32 v36, v104, v105
    v_cvt_pk_bf16_f32 v37, v106, v107
    v_cvt_pk_bf16_f32 v38, v108, v109
    v_cvt_pk_bf16_f32 v39, v110, v111
    v_cvt_pk_bf16_f32 v40, v112, v113
    v_cvt_pk_bf16_f32 v41, v114, v115
    v_cvt_pk_bf16_f32 v42, v116, v117
    v_cvt_pk_bf16_f32 v43, v118, v119
    v_cvt_pk_bf16_f32 v44, v120, v121
    v_cvt_pk_bf16_f32 v45, v122, v123
    v_cvt_pk_bf16_f32 v46, v124, v125
    v_cvt_pk_bf16_f32 v47, v126, v127
    v_cvt_pk_bf16_f32 v48, v128, v129
    v_cvt_pk_bf16_f32 v49, v130, v131
    v_cvt_pk_bf16_f32 v50, v132, v133
    v_cvt_pk_bf16_f32 v51, v134, v135
    v_cvt_pk_bf16_f32 v52, v136, v137
    v_cvt_pk_bf16_f32 v53, v138, v139
    v_cvt_pk_bf16_f32 v54, v140, v141
    v_cvt_pk_bf16_f32 v55, v142, v143
    v_cvt_pk_bf16_f32 v56, v144, v145
    v_cvt_pk_bf16_f32 v57, v146, v147
    v_cvt_pk_bf16_f32 v58, v148, v149
    v_cvt_pk_bf16_f32 v59, v150, v151
    v_cvt_pk_bf16_f32 v60, v152, v153
    v_cvt_pk_bf16_f32 v61, v154, v155
    v_cvt_pk_bf16_f32 v62, v156, v157
    v_cvt_pk_bf16_f32 v63, v158, v159
    v_lshrrev_b32 v70, 5, v1
    v_mul_u32_u24 v71, 2576, v70
    v_bfe_u32 v72, v1, 2, 2
    v_mul_u32_u24 v74, 320, v72
    v_bfe_u32 v73, v1, 4, 1
    v_lshl_add_u32 v71, v73, 5, v71
    v_and_b32 v73, 3, v1
    v_lshl_add_u32 v71, v73, 3, v71
    v_add_u32 v2, v71, v74
    v_add_u32 v3, 41216, v2
    s_mul_i32 s53, s3, 5120
    s_add_u32 s53, s53, 82432
    v_and_b32 v74, 31, v1
    v_mul_u32_u24 v74, 80, v74
    v_lshl_add_u32 v74, v70, 3, v74
    v_add_u32 v5, s53, v74
    v_lshrrev_b32 v74, 2, v1
    v_mul_u32_u24 v74, 80, v74
    v_lshl_add_u32 v74, v73, 4, v74
    v_add_u32 v6, s53, v74
    v_lshrrev_b32 v74, 4, v1
    v_lshlrev_b32 v74, 19, v74
    v_lshl_add_u32 v74, v72, 9, v74
    v_lshl_add_u32 v74, v73, 4, v74
    s_lshl_b32 s53, s2, 11
    s_lshl_b32 s54, s3, 6
    s_add_u32 s53, s53, s54
    v_add_u32 v4, s53, v74
    s_barrier
    ds_write_b64 v17, v[24:25] offset:0
    ds_write_b64 v17, v[26:27] offset:20608
    ds_write_b64 v17, v[28:29] offset:41216
    ds_write_b64 v17, v[30:31] offset:61824
    ds_write_b64 v18, v[32:33] offset:0
    ds_write_b64 v18, v[34:35] offset:20608
    ds_write_b64 v18, v[36:37] offset:41216
    ds_write_b64 v18, v[38:39] offset:61824
    ds_write_b64 v19, v[40:41] offset:0
    ds_write_b64 v19, v[42:43] offset:20608
    ds_write_b64 v19, v[44:45] offset:41216
    ds_write_b64 v19, v[46:47] offset:61824
    ds_write_b64 v20, v[48:49] offset:0
    ds_write_b64 v20, v[50:51] offset:20608
    ds_write_b64 v20, v[52:53] offset:41216
    ds_write_b64 v20, v[54:55] offset:61824
    ds_write_b64 v21, v[56:57] offset:0
    ds_write_b64 v21, v[58:59] offset:20608
    ds_write_b64 v21, v[60:61] offset:41216
    ds_write_b64 v21, v[62:63] offset:61824
    s_waitcnt lgkmcnt(0)
    s_barrier
    ds_read_b64_tr_b16 v[16:17], v2 offset:0
    ds_read_b64_tr_b16 v[18:19], v2 offset:1288
    ds_read_b64_tr_b16 v[20:21], v2 offset:5152
    ds_read_b64_tr_b16 v[22:23], v2 offset:6440
    ds_read_b64_tr_b16 v[24:25], v2 offset:10304
    ds_read_b64_tr_b16 v[26:27], v2 offset:11592
    ds_read_b64_tr_b16 v[28:29], v2 offset:15456
    ds_read_b64_tr_b16 v[30:31], v2 offset:16744
    ds_read_b64_tr_b16 v[32:33], v2 offset:20608
    ds_read_b64_tr_b16 v[34:35], v2 offset:21896
    ds_read_b64_tr_b16 v[36:37], v2 offset:25760
    ds_read_b64_tr_b16 v[38:39], v2 offset:27048
    s_waitcnt vmcnt(0)
    s_waitcnt lgkmcnt(10)
    v_mfma_f32_32x32x16_bf16 v[48:63], a[32:35], v[16:19], 0
    ds_read_b64_tr_b16 v[40:41], v2 offset:30912
    ds_read_b64_tr_b16 v[42:43], v2 offset:32200
    s_waitcnt lgkmcnt(10)
    v_mfma_f32_32x32x16_bf16 v[48:63], a[36:39], v[20:23], v[48:63]
    ds_read_b64_tr_b16 v[44:45], v2 offset:36064
    ds_read_b64_tr_b16 v[46:47], v2 offset:37352
    s_waitcnt lgkmcnt(10)
    v_mfma_f32_32x32x16_bf16 v[48:63], a[40:43], v[24:27], v[48:63]
    ds_read_b64_tr_b16 v[16:17], v3 offset:0
    ds_read_b64_tr_b16 v[18:19], v3 offset:1288
    s_waitcnt lgkmcnt(10)
    v_mfma_f32_32x32x16_bf16 v[48:63], a[44:47], v[28:31], v[48:63]
    ds_read_b64_tr_b16 v[20:21], v3 offset:5152
    ds_read_b64_tr_b16 v[22:23], v3 offset:6440
    s_waitcnt lgkmcnt(10)
    v_mfma_f32_32x32x16_bf16 v[48:63], a[48:51], v[32:35], v[48:63]
    ds_read_b64_tr_b16 v[24:25], v3 offset:10304
    ds_read_b64_tr_b16 v[26:27], v3 offset:11592
    s_waitcnt lgkmcnt(10)
    v_mfma_f32_32x32x16_bf16 v[48:63], a[52:55], v[36:39], v[48:63]
    ds_read_b64_tr_b16 v[28:29], v3 offset:15456
    ds_read_b64_tr_b16 v[30:31], v3 offset:16744
    s_waitcnt lgkmcnt(10)
    v_mfma_f32_32x32x16_bf16 v[48:63], a[56:59], v[40:43], v[48:63]
    ds_read_b64_tr_b16 v[32:33], v3 offset:20608
    ds_read_b64_tr_b16 v[34:35], v3 offset:21896
    s_waitcnt lgkmcnt(10)
    v_mfma_f32_32x32x16_bf16 v[48:63], a[60:63], v[44:47], v[48:63]
    ds_read_b64_tr_b16 v[36:37], v3 offset:25760
    ds_read_b64_tr_b16 v[38:39], v3 offset:27048
    s_waitcnt lgkmcnt(10)
    v_mfma_f32_32x32x16_bf16 v[48:63], a[64:67], v[16:19], v[48:63]
    ds_read_b64_tr_b16 v[40:41], v3 offset:30912
    ds_read_b64_tr_b16 v[42:43], v3 offset:32200
    s_waitcnt lgkmcnt(10)
    v_mfma_f32_32x32x16_bf16 v[48:63], a[68:71], v[20:23], v[48:63]
    ds_read_b64_tr_b16 v[44:45], v3 offset:36064
    ds_read_b64_tr_b16 v[46:47], v3 offset:37352
    s_waitcnt lgkmcnt(10)
    v_mfma_f32_32x32x16_bf16 v[48:63], a[72:75], v[24:27], v[48:63]
    ds_read_b64_tr_b16 v[16:17], v2 offset:64
    ds_read_b64_tr_b16 v[18:19], v2 offset:1352
    s_waitcnt lgkmcnt(10)
    v_mfma_f32_32x32x16_bf16 v[48:63], a[76:79], v[28:31], v[48:63]
    ds_read_b64_tr_b16 v[20:21], v2 offset:5216
    ds_read_b64_tr_b16 v[22:23], v2 offset:6504
    s_waitcnt lgkmcnt(10)
    v_mfma_f32_32x32x16_bf16 v[48:63], a[80:83], v[32:35], v[48:63]
    ds_read_b64_tr_b16 v[24:25], v2 offset:10368
    ds_read_b64_tr_b16 v[26:27], v2 offset:11656
    s_waitcnt lgkmcnt(10)
    v_mfma_f32_32x32x16_bf16 v[48:63], a[84:87], v[36:39], v[48:63]
    ds_read_b64_tr_b16 v[28:29], v2 offset:15520
    ds_read_b64_tr_b16 v[30:31], v2 offset:16808
    s_waitcnt lgkmcnt(10)
    v_mfma_f32_32x32x16_bf16 v[48:63], a[88:91], v[40:43], v[48:63]
    ds_read_b64_tr_b16 v[32:33], v2 offset:20672
    ds_read_b64_tr_b16 v[34:35], v2 offset:21960
    s_waitcnt lgkmcnt(10)
    v_mfma_f32_32x32x16_bf16 v[48:63], a[92:95], v[44:47], v[48:63]
    ds_read_b64_tr_b16 v[36:37], v2 offset:25824
    ds_read_b64_tr_b16 v[38:39], v2 offset:27112
    s_waitcnt lgkmcnt(10)
    v_mfma_f32_32x32x16_bf16 v[64:79], a[32:35], v[16:19], 0
    ds_read_b64_tr_b16 v[40:41], v2 offset:30976
    ds_read_b64_tr_b16 v[42:43], v2 offset:32264
    s_waitcnt lgkmcnt(10)
    v_mfma_f32_32x32x16_bf16 v[64:79], a[36:39], v[20:23], v[64:79]
    ds_read_b64_tr_b16 v[44:45], v2 offset:36128
    ds_read_b64_tr_b16 v[46:47], v2 offset:37416
    s_waitcnt lgkmcnt(10)
    v_mfma_f32_32x32x16_bf16 v[64:79], a[40:43], v[24:27], v[64:79]
    ds_read_b64_tr_b16 v[16:17], v3 offset:64
    ds_read_b64_tr_b16 v[18:19], v3 offset:1352
    s_waitcnt lgkmcnt(10)
    v_mfma_f32_32x32x16_bf16 v[64:79], a[44:47], v[28:31], v[64:79]
    ds_read_b64_tr_b16 v[20:21], v3 offset:5216
    ds_read_b64_tr_b16 v[22:23], v3 offset:6504
    v_cvt_pk_bf16_f32 v80, v48, v49
    v_cvt_pk_bf16_f32 v81, v50, v51
    ds_write_b64 v5, v[80:81] offset:0
    s_waitcnt lgkmcnt(10)
    v_mfma_f32_32x32x16_bf16 v[64:79], a[48:51], v[32:35], v[64:79]
    ds_read_b64_tr_b16 v[24:25], v3 offset:10368
    ds_read_b64_tr_b16 v[26:27], v3 offset:11656
    v_cvt_pk_bf16_f32 v82, v52, v53
    v_cvt_pk_bf16_f32 v83, v54, v55
    ds_write_b64 v5, v[82:83] offset:16
    s_waitcnt lgkmcnt(10)
    v_mfma_f32_32x32x16_bf16 v[64:79], a[52:55], v[36:39], v[64:79]
    ds_read_b64_tr_b16 v[28:29], v3 offset:15520
    ds_read_b64_tr_b16 v[30:31], v3 offset:16808
    v_cvt_pk_bf16_f32 v84, v56, v57
    v_cvt_pk_bf16_f32 v85, v58, v59
    ds_write_b64 v5, v[84:85] offset:32
    s_waitcnt lgkmcnt(10)
    v_mfma_f32_32x32x16_bf16 v[64:79], a[56:59], v[40:43], v[64:79]
    ds_read_b64_tr_b16 v[32:33], v3 offset:20672
    ds_read_b64_tr_b16 v[34:35], v3 offset:21960
    v_cvt_pk_bf16_f32 v86, v60, v61
    v_cvt_pk_bf16_f32 v87, v62, v63
    ds_write_b64 v5, v[86:87] offset:48
    s_waitcnt lgkmcnt(10)
    v_mfma_f32_32x32x16_bf16 v[64:79], a[60:63], v[44:47], v[64:79]
    ds_read_b64_tr_b16 v[36:37], v3 offset:25824
    ds_read_b64_tr_b16 v[38:39], v3 offset:27112
    ds_read_b128 v[96:99], v6 offset:0
    s_waitcnt lgkmcnt(10)
    v_mfma_f32_32x32x16_bf16 v[64:79], a[64:67], v[16:19], v[64:79]
    ds_read_b64_tr_b16 v[40:41], v3 offset:30976
    ds_read_b64_tr_b16 v[42:43], v3 offset:32264
    ds_read_b128 v[100:103], v6 offset:1280
    s_waitcnt lgkmcnt(10)
    v_mfma_f32_32x32x16_bf16 v[64:79], a[68:71], v[20:23], v[64:79]
    ds_read_b64_tr_b16 v[44:45], v3 offset:36128
    ds_read_b64_tr_b16 v[46:47], v3 offset:37416
    s_waitcnt lgkmcnt(10)
    v_mfma_f32_32x32x16_bf16 v[64:79], a[72:75], v[24:27], v[64:79]
    ds_read_b64_tr_b16 v[16:17], v2 offset:128
    ds_read_b64_tr_b16 v[18:19], v2 offset:1416
    s_waitcnt lgkmcnt(10)
    v_mfma_f32_32x32x16_bf16 v[64:79], a[76:79], v[28:31], v[64:79]
    ds_read_b64_tr_b16 v[20:21], v2 offset:5280
    ds_read_b64_tr_b16 v[22:23], v2 offset:6568
    s_waitcnt lgkmcnt(10)
    v_mfma_f32_32x32x16_bf16 v[64:79], a[80:83], v[32:35], v[64:79]
    ds_read_b64_tr_b16 v[24:25], v2 offset:10432
    ds_read_b64_tr_b16 v[26:27], v2 offset:11720
    s_waitcnt lgkmcnt(10)
    v_mfma_f32_32x32x16_bf16 v[64:79], a[84:87], v[36:39], v[64:79]
    ds_read_b64_tr_b16 v[28:29], v2 offset:15584
    ds_read_b64_tr_b16 v[30:31], v2 offset:16872
    s_waitcnt lgkmcnt(10)
    v_mfma_f32_32x32x16_bf16 v[64:79], a[88:91], v[40:43], v[64:79]
    ds_read_b64_tr_b16 v[32:33], v2 offset:20736
    ds_read_b64_tr_b16 v[34:35], v2 offset:22024
    s_waitcnt lgkmcnt(10)
    v_mfma_f32_32x32x16_bf16 v[64:79], a[92:95], v[44:47], v[64:79]
    ds_read_b64_tr_b16 v[36:37], v2 offset:25888
    ds_read_b64_tr_b16 v[38:39], v2 offset:27176
    buffer_store_dwordx4 v[96:99], v4, s[28:31], 0 offen sc1
    v_add_u32 v4, 2097152, v4
    buffer_store_dwordx4 v[100:103], v4, s[28:31], 0 offen sc1
    v_add_u32 v4, 2097152, v4
    s_waitcnt lgkmcnt(10)
    v_mfma_f32_32x32x16_bf16 v[48:63], a[32:35], v[16:19], 0
    ds_read_b64_tr_b16 v[40:41], v2 offset:31040
    ds_read_b64_tr_b16 v[42:43], v2 offset:32328
    s_waitcnt lgkmcnt(10)
    v_mfma_f32_32x32x16_bf16 v[48:63], a[36:39], v[20:23], v[48:63]
    ds_read_b64_tr_b16 v[44:45], v2 offset:36192
    ds_read_b64_tr_b16 v[46:47], v2 offset:37480
    s_waitcnt lgkmcnt(10)
    v_mfma_f32_32x32x16_bf16 v[48:63], a[40:43], v[24:27], v[48:63]
    ds_read_b64_tr_b16 v[16:17], v3 offset:128
    ds_read_b64_tr_b16 v[18:19], v3 offset:1416
    s_waitcnt lgkmcnt(10)
    v_mfma_f32_32x32x16_bf16 v[48:63], a[44:47], v[28:31], v[48:63]
    ds_read_b64_tr_b16 v[20:21], v3 offset:5280
    ds_read_b64_tr_b16 v[22:23], v3 offset:6568
    v_cvt_pk_bf16_f32 v88, v64, v65
    v_cvt_pk_bf16_f32 v89, v66, v67
    ds_write_b64 v5, v[88:89] offset:2560
    s_waitcnt lgkmcnt(10)
    v_mfma_f32_32x32x16_bf16 v[48:63], a[48:51], v[32:35], v[48:63]
    ds_read_b64_tr_b16 v[24:25], v3 offset:10432
    ds_read_b64_tr_b16 v[26:27], v3 offset:11720
    v_cvt_pk_bf16_f32 v90, v68, v69
    v_cvt_pk_bf16_f32 v91, v70, v71
    ds_write_b64 v5, v[90:91] offset:2576
    s_waitcnt lgkmcnt(10)
    v_mfma_f32_32x32x16_bf16 v[48:63], a[52:55], v[36:39], v[48:63]
    ds_read_b64_tr_b16 v[28:29], v3 offset:15584
    ds_read_b64_tr_b16 v[30:31], v3 offset:16872
    v_cvt_pk_bf16_f32 v92, v72, v73
    v_cvt_pk_bf16_f32 v93, v74, v75
    ds_write_b64 v5, v[92:93] offset:2592
    s_waitcnt lgkmcnt(10)
    v_mfma_f32_32x32x16_bf16 v[48:63], a[56:59], v[40:43], v[48:63]
    ds_read_b64_tr_b16 v[32:33], v3 offset:20736
    ds_read_b64_tr_b16 v[34:35], v3 offset:22024
    v_cvt_pk_bf16_f32 v94, v76, v77
    v_cvt_pk_bf16_f32 v95, v78, v79
    ds_write_b64 v5, v[94:95] offset:2608
    s_waitcnt lgkmcnt(10)
    v_mfma_f32_32x32x16_bf16 v[48:63], a[60:63], v[44:47], v[48:63]
    ds_read_b64_tr_b16 v[36:37], v3 offset:25888
    ds_read_b64_tr_b16 v[38:39], v3 offset:27176
    ds_read_b128 v[104:107], v6 offset:2560
    s_waitcnt lgkmcnt(10)
    v_mfma_f32_32x32x16_bf16 v[48:63], a[64:67], v[16:19], v[48:63]
    ds_read_b64_tr_b16 v[40:41], v3 offset:31040
    ds_read_b64_tr_b16 v[42:43], v3 offset:32328
    ds_read_b128 v[108:111], v6 offset:3840
    s_waitcnt lgkmcnt(10)
    v_mfma_f32_32x32x16_bf16 v[48:63], a[68:71], v[20:23], v[48:63]
    ds_read_b64_tr_b16 v[44:45], v3 offset:36192
    ds_read_b64_tr_b16 v[46:47], v3 offset:37480
    s_waitcnt lgkmcnt(10)
    v_mfma_f32_32x32x16_bf16 v[48:63], a[72:75], v[24:27], v[48:63]
    ds_read_b64_tr_b16 v[16:17], v2 offset:192
    ds_read_b64_tr_b16 v[18:19], v2 offset:1480
    s_waitcnt lgkmcnt(10)
    v_mfma_f32_32x32x16_bf16 v[48:63], a[76:79], v[28:31], v[48:63]
    ds_read_b64_tr_b16 v[20:21], v2 offset:5344
    ds_read_b64_tr_b16 v[22:23], v2 offset:6632
    s_waitcnt lgkmcnt(10)
    v_mfma_f32_32x32x16_bf16 v[48:63], a[80:83], v[32:35], v[48:63]
    ds_read_b64_tr_b16 v[24:25], v2 offset:10496
    ds_read_b64_tr_b16 v[26:27], v2 offset:11784
    s_waitcnt lgkmcnt(10)
    v_mfma_f32_32x32x16_bf16 v[48:63], a[84:87], v[36:39], v[48:63]
    ds_read_b64_tr_b16 v[28:29], v2 offset:15648
    ds_read_b64_tr_b16 v[30:31], v2 offset:16936
    s_waitcnt lgkmcnt(10)
    v_mfma_f32_32x32x16_bf16 v[48:63], a[88:91], v[40:43], v[48:63]
    ds_read_b64_tr_b16 v[32:33], v2 offset:20800
    ds_read_b64_tr_b16 v[34:35], v2 offset:22088
    s_waitcnt lgkmcnt(10)
    v_mfma_f32_32x32x16_bf16 v[48:63], a[92:95], v[44:47], v[48:63]
    ds_read_b64_tr_b16 v[36:37], v2 offset:25952
    ds_read_b64_tr_b16 v[38:39], v2 offset:27240
    buffer_store_dwordx4 v[104:107], v4, s[28:31], 0 offen sc1
    v_add_u32 v4, 2097152, v4
    buffer_store_dwordx4 v[108:111], v4, s[28:31], 0 offen sc1
    v_add_u32 v4, 2097152, v4
    s_waitcnt lgkmcnt(10)
    v_mfma_f32_32x32x16_bf16 v[64:79], a[32:35], v[16:19], 0
    ds_read_b64_tr_b16 v[40:41], v2 offset:31104
    ds_read_b64_tr_b16 v[42:43], v2 offset:32392
    s_waitcnt lgkmcnt(10)
    v_mfma_f32_32x32x16_bf16 v[64:79], a[36:39], v[20:23], v[64:79]
    ds_read_b64_tr_b16 v[44:45], v2 offset:36256
    ds_read_b64_tr_b16 v[46:47], v2 offset:37544
    s_waitcnt lgkmcnt(10)
    v_mfma_f32_32x32x16_bf16 v[64:79], a[40:43], v[24:27], v[64:79]
    ds_read_b64_tr_b16 v[16:17], v3 offset:192
    ds_read_b64_tr_b16 v[18:19], v3 offset:1480
    s_waitcnt lgkmcnt(10)
    v_mfma_f32_32x32x16_bf16 v[64:79], a[44:47], v[28:31], v[64:79]
    ds_read_b64_tr_b16 v[20:21], v3 offset:5344
    ds_read_b64_tr_b16 v[22:23], v3 offset:6632
    v_cvt_pk_bf16_f32 v80, v48, v49
    v_cvt_pk_bf16_f32 v81, v50, v51
    ds_write_b64 v5, v[80:81] offset:0
    s_waitcnt lgkmcnt(10)
    v_mfma_f32_32x32x16_bf16 v[64:79], a[48:51], v[32:35], v[64:79]
    ds_read_b64_tr_b16 v[24:25], v3 offset:10496
    ds_read_b64_tr_b16 v[26:27], v3 offset:11784
    v_cvt_pk_bf16_f32 v82, v52, v53
    v_cvt_pk_bf16_f32 v83, v54, v55
    ds_write_b64 v5, v[82:83] offset:16
    s_waitcnt lgkmcnt(10)
    v_mfma_f32_32x32x16_bf16 v[64:79], a[52:55], v[36:39], v[64:79]
    ds_read_b64_tr_b16 v[28:29], v3 offset:15648
    ds_read_b64_tr_b16 v[30:31], v3 offset:16936
    v_cvt_pk_bf16_f32 v84, v56, v57
    v_cvt_pk_bf16_f32 v85, v58, v59
    ds_write_b64 v5, v[84:85] offset:32
    s_waitcnt lgkmcnt(10)
    v_mfma_f32_32x32x16_bf16 v[64:79], a[56:59], v[40:43], v[64:79]
    ds_read_b64_tr_b16 v[32:33], v3 offset:20800
    ds_read_b64_tr_b16 v[34:35], v3 offset:22088
    v_cvt_pk_bf16_f32 v86, v60, v61
    v_cvt_pk_bf16_f32 v87, v62, v63
    ds_write_b64 v5, v[86:87] offset:48
    s_waitcnt lgkmcnt(10)
    v_mfma_f32_32x32x16_bf16 v[64:79], a[60:63], v[44:47], v[64:79]
    ds_read_b64_tr_b16 v[36:37], v3 offset:25952
    ds_read_b64_tr_b16 v[38:39], v3 offset:27240
    ds_read_b128 v[96:99], v6 offset:0
    s_waitcnt lgkmcnt(10)
    v_mfma_f32_32x32x16_bf16 v[64:79], a[64:67], v[16:19], v[64:79]
    ds_read_b64_tr_b16 v[40:41], v3 offset:31104
    ds_read_b64_tr_b16 v[42:43], v3 offset:32392
    ds_read_b128 v[100:103], v6 offset:1280
    s_waitcnt lgkmcnt(10)
    v_mfma_f32_32x32x16_bf16 v[64:79], a[68:71], v[20:23], v[64:79]
    ds_read_b64_tr_b16 v[44:45], v3 offset:36256
    ds_read_b64_tr_b16 v[46:47], v3 offset:37544
    s_waitcnt lgkmcnt(10)
    v_mfma_f32_32x32x16_bf16 v[64:79], a[72:75], v[24:27], v[64:79]
    ds_read_b64_tr_b16 v[16:17], v2 offset:256
    ds_read_b64_tr_b16 v[18:19], v2 offset:1544
    s_waitcnt lgkmcnt(10)
    v_mfma_f32_32x32x16_bf16 v[64:79], a[76:79], v[28:31], v[64:79]
    ds_read_b64_tr_b16 v[20:21], v2 offset:5408
    ds_read_b64_tr_b16 v[22:23], v2 offset:6696
    s_waitcnt lgkmcnt(10)
    v_mfma_f32_32x32x16_bf16 v[64:79], a[80:83], v[32:35], v[64:79]
    ds_read_b64_tr_b16 v[24:25], v2 offset:10560
    ds_read_b64_tr_b16 v[26:27], v2 offset:11848
    s_waitcnt lgkmcnt(10)
    v_mfma_f32_32x32x16_bf16 v[64:79], a[84:87], v[36:39], v[64:79]
    ds_read_b64_tr_b16 v[28:29], v2 offset:15712
    ds_read_b64_tr_b16 v[30:31], v2 offset:17000
    s_waitcnt lgkmcnt(10)
    v_mfma_f32_32x32x16_bf16 v[64:79], a[88:91], v[40:43], v[64:79]
    ds_read_b64_tr_b16 v[32:33], v2 offset:20864
    ds_read_b64_tr_b16 v[34:35], v2 offset:22152
    s_waitcnt lgkmcnt(10)
    v_mfma_f32_32x32x16_bf16 v[64:79], a[92:95], v[44:47], v[64:79]
    ds_read_b64_tr_b16 v[36:37], v2 offset:26016
    ds_read_b64_tr_b16 v[38:39], v2 offset:27304
    buffer_store_dwordx4 v[96:99], v4, s[28:31], 0 offen sc1
    v_add_u32 v4, 2097152, v4
    buffer_store_dwordx4 v[100:103], v4, s[28:31], 0 offen sc1
    v_add_u32 v4, 2097152, v4
    s_waitcnt lgkmcnt(10)
    v_mfma_f32_32x32x16_bf16 v[48:63], a[32:35], v[16:19], 0
    ds_read_b64_tr_b16 v[40:41], v2 offset:31168
    ds_read_b64_tr_b16 v[42:43], v2 offset:32456
    s_waitcnt lgkmcnt(10)
    v_mfma_f32_32x32x16_bf16 v[48:63], a[36:39], v[20:23], v[48:63]
    ds_read_b64_tr_b16 v[44:45], v2 offset:36320
    ds_read_b64_tr_b16 v[46:47], v2 offset:37608
    s_waitcnt lgkmcnt(10)
    v_mfma_f32_32x32x16_bf16 v[48:63], a[40:43], v[24:27], v[48:63]
    ds_read_b64_tr_b16 v[16:17], v3 offset:256
    ds_read_b64_tr_b16 v[18:19], v3 offset:1544
    s_waitcnt lgkmcnt(10)
    v_mfma_f32_32x32x16_bf16 v[48:63], a[44:47], v[28:31], v[48:63]
    ds_read_b64_tr_b16 v[20:21], v3 offset:5408
    ds_read_b64_tr_b16 v[22:23], v3 offset:6696
    v_cvt_pk_bf16_f32 v88, v64, v65
    v_cvt_pk_bf16_f32 v89, v66, v67
    ds_write_b64 v5, v[88:89] offset:2560
    s_waitcnt lgkmcnt(10)
    v_mfma_f32_32x32x16_bf16 v[48:63], a[48:51], v[32:35], v[48:63]
    ds_read_b64_tr_b16 v[24:25], v3 offset:10560
    ds_read_b64_tr_b16 v[26:27], v3 offset:11848
    v_cvt_pk_bf16_f32 v90, v68, v69
    v_cvt_pk_bf16_f32 v91, v70, v71
    ds_write_b64 v5, v[90:91] offset:2576
    s_waitcnt lgkmcnt(10)
    v_mfma_f32_32x32x16_bf16 v[48:63], a[52:55], v[36:39], v[48:63]
    ds_read_b64_tr_b16 v[28:29], v3 offset:15712
    ds_read_b64_tr_b16 v[30:31], v3 offset:17000
    v_cvt_pk_bf16_f32 v92, v72, v73
    v_cvt_pk_bf16_f32 v93, v74, v75
    ds_write_b64 v5, v[92:93] offset:2592
    s_waitcnt lgkmcnt(10)
    v_mfma_f32_32x32x16_bf16 v[48:63], a[56:59], v[40:43], v[48:63]
    ds_read_b64_tr_b16 v[32:33], v3 offset:20864
    ds_read_b64_tr_b16 v[34:35], v3 offset:22152
    v_cvt_pk_bf16_f32 v94, v76, v77
    v_cvt_pk_bf16_f32 v95, v78, v79
    ds_write_b64 v5, v[94:95] offset:2608
    s_waitcnt lgkmcnt(10)
    v_mfma_f32_32x32x16_bf16 v[48:63], a[60:63], v[44:47], v[48:63]
    ds_read_b64_tr_b16 v[36:37], v3 offset:26016
    ds_read_b64_tr_b16 v[38:39], v3 offset:27304
    ds_read_b128 v[104:107], v6 offset:2560
    s_waitcnt lgkmcnt(10)
    v_mfma_f32_32x32x16_bf16 v[48:63], a[64:67], v[16:19], v[48:63]
    ds_read_b64_tr_b16 v[40:41], v3 offset:31168
    ds_read_b64_tr_b16 v[42:43], v3 offset:32456
    ds_read_b128 v[108:111], v6 offset:3840
    s_waitcnt lgkmcnt(10)
    v_mfma_f32_32x32x16_bf16 v[48:63], a[68:71], v[20:23], v[48:63]
    ds_read_b64_tr_b16 v[44:45], v3 offset:36320
    ds_read_b64_tr_b16 v[46:47], v3 offset:37608
    s_waitcnt lgkmcnt(10)
    v_mfma_f32_32x32x16_bf16 v[48:63], a[72:75], v[24:27], v[48:63]
    s_waitcnt lgkmcnt(8)
    v_mfma_f32_32x32x16_bf16 v[48:63], a[76:79], v[28:31], v[48:63]
    s_waitcnt lgkmcnt(6)
    v_mfma_f32_32x32x16_bf16 v[48:63], a[80:83], v[32:35], v[48:63]
    s_waitcnt lgkmcnt(4)
    v_mfma_f32_32x32x16_bf16 v[48:63], a[84:87], v[36:39], v[48:63]
    s_waitcnt lgkmcnt(2)
    v_mfma_f32_32x32x16_bf16 v[48:63], a[88:91], v[40:43], v[48:63]
    s_waitcnt lgkmcnt(0)
    v_mfma_f32_32x32x16_bf16 v[48:63], a[92:95], v[44:47], v[48:63]
    buffer_store_dwordx4 v[104:107], v4, s[28:31], 0 offen sc1
    v_add_u32 v4, 2097152, v4
    buffer_store_dwordx4 v[108:111], v4, s[28:31], 0 offen sc1
    v_add_u32 v4, 2097152, v4
    s_nop 11
    v_cvt_pk_bf16_f32 v80, v48, v49
    v_cvt_pk_bf16_f32 v81, v50, v51
    v_cvt_pk_bf16_f32 v82, v52, v53
    v_cvt_pk_bf16_f32 v83, v54, v55
    v_cvt_pk_bf16_f32 v84, v56, v57
    v_cvt_pk_bf16_f32 v85, v58, v59
    v_cvt_pk_bf16_f32 v86, v60, v61
    v_cvt_pk_bf16_f32 v87, v62, v63
    ds_write_b64 v5, v[80:81] offset:0
    ds_write_b64 v5, v[82:83] offset:16
    ds_write_b64 v5, v[84:85] offset:32
    ds_write_b64 v5, v[86:87] offset:48
    ds_read_b128 v[96:99], v6 offset:0
    ds_read_b128 v[100:103], v6 offset:1280
    s_waitcnt lgkmcnt(0)
    buffer_store_dwordx4 v[96:99], v4, s[28:31], 0 offen sc1
    v_add_u32 v4, 2097152, v4
    buffer_store_dwordx4 v[100:103], v4, s[28:31], 0 offen sc1
    v_add_u32 v4, 2097152, v4
L_end:
    s_endpgm
.section .rodata,"a"
.p2align 6
.amdhsa_kernel bin_edges_kernel
  .amdhsa_next_free_vgpr 80
  .amdhsa_next_free_sgpr 56
  .amdhsa_accum_offset 80
  .amdhsa_group_segment_fixed_size 0
  .amdhsa_kernarg_size 88
  .amdhsa_user_sgpr_count 2
  .amdhsa_user_sgpr_kernarg_segment_ptr 1
  .amdhsa_system_sgpr_workgroup_id_x 1
  .amdhsa_float_denorm_mode_32 3
.end_amdhsa_kernel
.section .rodata,"a"
.p2align 6
.amdhsa_kernel standalone__tensor_product_equiv_mace__graph_kernel
  .amdhsa_next_free_vgpr 256
  .amdhsa_next_free_sgpr 102
  .amdhsa_accum_offset 160
  .amdhsa_group_segment_fixed_size 0
  .amdhsa_kernarg_size 88
  .amdhsa_user_sgpr_count 2
  .amdhsa_user_sgpr_kernarg_segment_ptr 1
  .amdhsa_system_sgpr_workgroup_id_x 1
  .amdhsa_float_denorm_mode_32 3
.end_amdhsa_kernel
```

```asm
; @launch grid=(256,1,1) block=(512,1,1) lds=128000
.amdgcn_target "amdgcn-amd-amdhsa--gfx950"
.text
.globl standalone__tensor_product_equiv_mace__graph_kernel
.p2align 8
.type standalone__tensor_product_equiv_mace__graph_kernel,@function
standalone__tensor_product_equiv_mace__graph_kernel:
    s_cmp_ge_u32 s2, 256
    s_cbranch_scc1 L_end
    s_load_dwordx2 s[84:85], s[0:1], 80
    s_load_dwordx16 s[64:79], s[0:1], 0
    s_load_dwordx2 s[80:81], s[0:1], 64
    v_and_b32 v1, 63, v0
    v_lshrrev_b32 v60, 6, v0
    v_mov_b32 v12, 0
    v_readfirstlane_b32 s3, v60
    s_and_b32 s55, s2, 63
    s_and_b32 s54, s2, 192
    s_mul_i32 s53, s55, 10000
    v_lshlrev_b32 v63, 4, v0
    v_add_u32 v60, s53, v63
    s_add_u32 s53, s53, 8192
    v_lshl_add_u32 v61, v0, 2, s53
    v_lshlrev_b32 v64, 1, v60
    v_lshlrev_b32 v65, 1, v61
    s_lshl_b32 s53, s54, 1
    v_mov_b32 v62, s53
    s_waitcnt lgkmcnt(0)
    s_mov_b32 s16, s68
    s_mov_b32 s17, s69
    s_mov_b32 s18, 640000
    s_mov_b32 s19, 0x00020000
    buffer_load_dwordx4 v[16:19], v60, s[16:19], 0 offen
    buffer_load_dword v20, v61, s[16:19], 0 offen
    s_mov_b32 s12, s66
    s_mov_b32 s13, s67
    s_mov_b32 s14, 640000
    s_mov_b32 s15, 0x00020000
    buffer_load_dwordx4 v[24:27], v60, s[12:15], 0 offen
    buffer_load_dword v28, v61, s[12:15], 0 offen
    s_mov_b32 s32, s84
    s_mov_b32 s33, s85
    s_mov_b32 s34, 20971520
    s_mov_b32 s35, 0x00020000
    buffer_load_dword v42, v62, s[32:35], 0 offen sc1
    s_mov_b32 s20, s70
    s_mov_b32 s21, s71
    s_mov_b32 s22, 1280000
    s_mov_b32 s23, 0x00020000
    buffer_load_dwordx4 v[32:35], v64, s[20:23], 0 offen
    buffer_load_dwordx4 v[36:39], v64, s[20:23], 0 offen offset:16
    buffer_load_dwordx2 v[40:41], v65, s[20:23], 0 offen
    v_mov_b32 v72, -1
    v_mov_b32 v73, -1
    v_mov_b32 v74, -1
    v_mov_b32 v75, -1
    ds_write_b128 v63, v[72:75] offset:0
    ds_write_b128 v63, v[72:75] offset:8192
    ds_write_b128 v63, v[72:75] offset:16384
    ds_write_b128 v63, v[72:75] offset:24576
    v_mov_b32 v68, 0
    v_mov_b32 v69, 0
    v_lshlrev_b32 v60, 3, v0
    v_add_u32 v60, 110848, v60
    ds_write_b64 v60, v[68:69]
    v_min_u32 v60, 35, v1
    v_lshlrev_b32 v60, 3, v60
    v_add_u32 v60, 119040, v60
    ds_write_b64 v60, v[68:69]
    s_mov_b32 s8, s64
    s_mov_b32 s9, s65
    s_mov_b32 s10, 20480000
    s_mov_b32 s11, 0x00020000
    s_mov_b32 s24, s72
    s_mov_b32 s25, s73
    s_mov_b32 s26, 5120000
    s_mov_b32 s27, 0x00020000
    s_mov_b32 s28, s80
    s_mov_b32 s29, s81
    s_mov_b32 s30, 20480000
    s_mov_b32 s31, 0x00020000
    s_mov_b32 s96, s74
    s_mov_b32 s97, s75
    s_mov_b32 s98, 128
    s_mov_b32 s99, 0x00020000
    s_mov_b32 s92, s76
    s_mov_b32 s93, s77
    s_mov_b32 s94, 8192
    s_mov_b32 s95, 0x00020000
    s_mov_b32 s88, s78
    s_mov_b32 s89, s79
    s_mov_b32 s90, 131072
    s_mov_b32 s91, 0x00020000
    s_lshl_b32 s63, s3, 13
    s_mov_b32 s52, 0
    s_mov_b32 s77, 0
    s_mov_b32 s82, 0x3fff00
    s_mov_b32 s83, 20971520
    s_lshl_b32 s49, s3, 10
    s_add_u32 s49, s49, 119328
    s_movk_i32 s53, 452
    v_cmp_gt_u32 s[50:51], s53, v0
    v_lshlrev_b32 v43, 22, v0
    v_lshlrev_b32 v59, 20, v0
    v_mov_b32 v58, 1
    s_waitcnt lgkmcnt(0)
    s_barrier
    v_and_b32 v60, 3, v1
    v_lshlrev_b32 v61, 5, v60
    v_lshrrev_b32 v66, 4, v1
    v_lshl_add_u32 v61, v66, 1, v61
    buffer_load_ushort v44, v61, s[96:99], 0 offen offset:0
    buffer_load_ushort v45, v61, s[96:99], 0 offen offset:8
    buffer_load_ushort v46, v61, s[96:99], 0 offen offset:16
    buffer_load_ushort v47, v61, s[96:99], 0 offen offset:24
    s_lshl_b32 s53, s3, 10
    s_add_u32 m0, s53, 32768
    v_lshlrev_b32 v64, 4, v1
    buffer_load_dwordx4 v64, s[92:95], s53 offen lds
    s_lshr_b32 s53, s2, 3
    s_lshl3_add_u32 s53, s53, s3
    s_lshl_b32 s53, s53, 10
    v_add_u32 v79, s53, v64
    v_and_b32 v61, 7, v1
    v_bfe_u32 v65, v1, 3, 1
    v_lshlrev_b32 v65, 9, v65
    v_lshl_add_u32 v65, v66, 7, v65
    v_lshl_add_u32 v2, v61, 4, v65
    v_xor_b32 v61, 4, v61
    v_lshl_add_u32 v3, v61, 4, v65
    v_bfe_u32 v60, v1, 2, 2
    v_bfe_u32 v62, v1, 1, 1
    v_lshl_add_u32 v62, v66, 1, v62
    v_lshrrev_b32 v63, 1, v60
    v_lshlrev_b32 v64, 2, v63
    v_xor_b32 v62, v62, v64
    v_and_b32 v64, 1, v60
    v_lshl_add_u32 v62, v64, 3, v62
    v_lshlrev_b32 v62, 4, v62
    v_lshl_add_u32 v62, v63, 10, v62
    v_and_b32 v64, 1, v1
    v_lshl_add_u32 v62, v64, 3, v62
    v_add_u32 v4, s63, v62
    v_lshrrev_b32 v61, 5, v1
    v_mov_b32 v63, 32
    v_cmp_eq_u32 vcc, v60, v61
    v_add_u32 v61, 2, v61
    v_and_b32 v64, 3, v1
    v_cndmask_b32 v7, 0, v63, vcc
    v_cmp_eq_u32 vcc, v60, v61
    v_cmp_eq_u32 s[4:5], v64, v66
    v_mov_b32 v65, 8
    v_cndmask_b32 v8, 0, v63, vcc
    v_cndmask_b32 v10, 0, v65, s[4:5]
    v_add_u32 v61, 0, v1
    v_mul_u32_u24 v73, 2731, v61
    v_lshrrev_b32 v73, 16, v73
    v_lshlrev_b32 v61, 4, v61
    v_lshl_add_u32 v70, v73, 7, v61
    v_add_u32 v61, 64, v1
    v_mul_u32_u24 v74, 2731, v61
    v_lshrrev_b32 v74, 16, v74
    v_lshlrev_b32 v61, 4, v61
    v_lshl_add_u32 v71, v74, 7, v61
    v_add_u32 v61, 128, v1
    v_mul_u32_u24 v75, 2731, v61
    v_lshrrev_b32 v75, 16, v75
    v_lshlrev_b32 v61, 4, v61
    v_lshl_add_u32 v72, v75, 7, v61
    s_lshl_b32 s44, s3, 12
    s_lshl3_add_u32 s53, s3, s54
    s_mul_i32 s45, s53, 24704
    s_mul_i32 s46, s55, 384
    s_add_u32 s45, s45, s46
    s_add_u32 s45, s45, 8388608
    s_movk_i32 s46, 24192
    v_add_u32 v61, s44, v70
    v_mad_u32_u24 v64, v73, s46, v70
    v_add_u32 v64, s45, v64
    v_add_u32 v62, s44, v71
    v_mad_u32_u24 v65, v74, s46, v71
    v_add_u32 v65, s45, v65
    v_add_u32 v63, s44, v72
    v_mad_u32_u24 v66, v75, s46, v72
    v_add_u32 v66, s45, v66
    s_lshl_b32 s45, s53, 6
    s_add_u32 s45, s45, s55
    s_lshl_b32 s45, s45, 7
    s_add_u32 s45, s45, 16777216
    v_lshrrev_b32 v68, 3, v1
    s_lshl_b32 s76, s3, 5
    s_add_u32 s76, s76, 119072
    v_lshl_add_u32 v67, v68, 2, s76
    s_mov_b32 s53, 119072
    s_waitcnt vmcnt(11)
    v_and_b32 v48, 255, v16
    v_subrev_u32 v48, s54, v48
    v_cmp_gt_u32 s[64:65], 64, v48
    v_lshl_add_u32 v60, v48, 2, s53
    s_mov_b64 exec, s[64:65]
    ds_add_rtn_u32 v53, v60, v58
    s_mov_b64 exec, -1
    v_and_b32 v49, 255, v17
    v_subrev_u32 v49, s54, v49
    v_cmp_gt_u32 s[66:67], 64, v49
    v_lshl_add_u32 v60, v49, 2, s53
    s_mov_b64 exec, s[66:67]
    ds_add_rtn_u32 v54, v60, v58
    s_mov_b64 exec, -1
    v_and_b32 v50, 255, v18
    v_subrev_u32 v50, s54, v50
    v_cmp_gt_u32 s[68:69], 64, v50
    v_lshl_add_u32 v60, v50, 2, s53
    s_mov_b64 exec, s[68:69]
    ds_add_rtn_u32 v55, v60, v58
    s_mov_b64 exec, -1
    v_and_b32 v51, 255, v19
    v_subrev_u32 v51, s54, v51
    v_cmp_gt_u32 s[70:71], 64, v51
    v_lshl_add_u32 v60, v51, 2, s53
    s_mov_b64 exec, s[70:71]
    ds_add_rtn_u32 v56, v60, v58
    s_mov_b64 exec, -1
    v_and_b32 v52, 255, v20
    v_subrev_u32 v52, s54, v52
    v_cmp_gt_u32 s[72:73], 64, v52
    v_lshl_add_u32 v60, v52, 2, s53
    s_and_b64 s[72:73], s[72:73], s[50:51]
    s_mov_b64 exec, s[72:73]
    ds_add_rtn_u32 v57, v60, v58
    s_mov_b64 exec, -1
    s_waitcnt vmcnt(9)
    v_bfe_u32 v16, v16, 8, 6
    v_min_u32 v16, 47, v16
    v_and_b32 v24, 0x3fff, v24
    v_lshl_or_b32 v16, v24, 6, v16
    v_add_u32 v24, 0, v43
    v_or_b32 v16, v16, v24
    v_lshlrev_b32 v48, 9, v48
    v_bfe_u32 v17, v17, 8, 6
    v_min_u32 v17, 47, v17
    v_and_b32 v25, 0x3fff, v25
    v_lshl_or_b32 v17, v25, 6, v17
    v_add_u32 v25, 1048576, v43
    v_or_b32 v17, v17, v25
    v_lshlrev_b32 v49, 9, v49
    v_bfe_u32 v18, v18, 8, 6
    v_min_u32 v18, 47, v18
    v_and_b32 v26, 0x3fff, v26
    v_lshl_or_b32 v18, v26, 6, v18
    v_add_u32 v26, 2097152, v43
    v_or_b32 v18, v18, v26
    v_lshlrev_b32 v50, 9, v50
    v_bfe_u32 v19, v19, 8, 6
    v_min_u32 v19, 47, v19
    v_and_b32 v27, 0x3fff, v27
    v_lshl_or_b32 v19, v27, 6, v19
    v_add_u32 v27, 3145728, v43
    v_or_b32 v19, v19, v27
    v_lshlrev_b32 v51, 9, v51
    v_bfe_u32 v20, v20, 8, 6
    v_min_u32 v20, 47, v20
    v_and_b32 v28, 0x3fff, v28
    v_lshl_or_b32 v20, v28, 6, v20
    v_add_u32 v28, 2147483648, v59
    v_or_b32 v20, v20, v28
    v_lshlrev_b32 v52, 9, v52
    v_mov_b32 v59, -2
    s_waitcnt vmcnt(5) lgkmcnt(0)
    v_readfirstlane_b32 s48, v42
    v_cmp_gt_u32 vcc, 31, v53
    v_min_u32 v53, 31, v53
    v_lshl_add_u32 v48, v53, 4, v48
    v_cndmask_b32 v16, v59, v16, vcc
    s_mov_b64 exec, s[64:65]
    ds_write_b32 v48, v16 offset:0
    ds_write_b64 v48, v[32:33] offset:8
    s_mov_b64 exec, -1
    v_cmp_gt_u32 vcc, 31, v54
    v_min_u32 v54, 31, v54
    v_lshl_add_u32 v49, v54, 4, v49
    v_cndmask_b32 v17, v59, v17, vcc
    s_mov_b64 exec, s[66:67]
    ds_write_b32 v49, v17 offset:0
    ds_write_b64 v49, v[34:35] offset:8
    s_mov_b64 exec, -1
    v_cmp_gt_u32 vcc, 31, v55
    v_min_u32 v55, 31, v55
    v_lshl_add_u32 v50, v55, 4, v50
    v_cndmask_b32 v18, v59, v18, vcc
    s_mov_b64 exec, s[68:69]
    ds_write_b32 v50, v18 offset:0
    ds_write_b64 v50, v[36:37] offset:8
    s_mov_b64 exec, -1
    v_cmp_gt_u32 vcc, 31, v56
    v_min_u32 v56, 31, v56
    v_lshl_add_u32 v51, v56, 4, v51
    v_cndmask_b32 v19, v59, v19, vcc
    s_mov_b64 exec, s[70:71]
    ds_write_b32 v51, v19 offset:0
    ds_write_b64 v51, v[38:39] offset:8
    s_mov_b64 exec, -1
    v_cmp_gt_u32 vcc, 31, v57
    v_min_u32 v57, 31, v57
    v_lshl_add_u32 v52, v57, 4, v52
    v_cndmask_b32 v20, v59, v20, vcc
    s_mov_b64 exec, s[72:73]
    ds_write_b32 v52, v20 offset:0
    ds_write_b64 v52, v[40:41] offset:8
    s_mov_b64 exec, -1
    s_add_u32 s48, s48, 1
    s_waitcnt lgkmcnt(0)
    s_barrier
    ds_read_b128 v[16:19], v61 offset:0
    ds_read_b128 v[20:23], v62 offset:0
    ds_read_b128 v[24:27], v63 offset:0
    ds_read_b32 v67, v67
    s_waitcnt lgkmcnt(3)
    v_mov_b32 v17, s48
    buffer_store_dwordx4 v[16:19], v64, s[32:35], 0 offen sc1
    s_waitcnt lgkmcnt(2)
    v_mov_b32 v21, s48
    buffer_store_dwordx4 v[20:23], v65, s[32:35], 0 offen sc1
    s_waitcnt lgkmcnt(1)
    v_mov_b32 v25, s48
    buffer_store_dwordx4 v[24:27], v66, s[32:35], 0 offen sc1
    s_waitcnt lgkmcnt(0)
    v_cmp_lt_u32 vcc, 23, v67
    s_cbranch_vccz L_noup
    v_and_b32 v60, 7, v1
    v_lshlrev_b32 v60, 4, v60
    v_lshl_add_u32 v69, v68, 9, v60
    v_add_u32 v69, s44, v69
    ds_read_b128 v[28:31], v69 offset:384
    v_lshl_add_u32 v69, v68, 13, v60
    v_add_u32 v69, s45, v69
    s_waitcnt lgkmcnt(0)
    v_mov_b32 v29, s48
    s_mov_b64 exec, vcc
    buffer_store_dwordx4 v[28:31], v69, s[32:35], 0 offen sc1
    s_mov_b64 exec, -1
L_noup:
    s_cmp_ge_u32 s3, 2
    s_cbranch_scc1 L_nowf
    s_lshl1_add_u32 s44, s55, s3
    s_and_b32 s53, s44, 15
    s_lshl_b32 s53, s53, 13
    s_lshr_b32 s76, s44, 4
    s_lshl_b32 s76, s76, 6
    s_add_u32 s53, s53, s76
    v_lshrrev_b32 v60, 5, v1
    v_lshlrev_b32 v60, 12, v60
    v_and_b32 v61, 31, v1
    v_lshl_add_u32 v60, v61, 1, v60
    v_add_u32 v60, s53, v60
    buffer_load_ushort v32, v60, s[88:91], 0 offen offset:0
    buffer_load_ushort v33, v60, s[88:91], 0 offen offset:512
    buffer_load_ushort v34, v60, s[88:91], 0 offen offset:1024
    buffer_load_ushort v35, v60, s[88:91], 0 offen offset:1536
    buffer_load_ushort v36, v60, s[88:91], 0 offen offset:2048
    buffer_load_ushort v37, v60, s[88:91], 0 offen offset:2560
    buffer_load_ushort v38, v60, s[88:91], 0 offen offset:3072
    buffer_load_ushort v39, v60, s[88:91], 0 offen offset:3584
L_nowf:
    v_lshrrev_b32 v60, 5, v1
    v_bfe_u32 v61, v1, 2, 2
    v_bfe_u32 v62, v1, 4, 1
    v_and_b32 v63, 3, v1
    v_lshlrev_b32 v77, 12, v62
    v_lshl_add_u32 v77, v61, 9, v77
    v_lshl_add_u32 v77, v60, 5, v77
    v_lshl_add_u32 v77, v63, 3, v77
    s_mul_i32 s53, s2, 24704
    s_mul_i32 s45, s3, 3072
    s_add_u32 s53, s53, s45
    s_add_u32 s53, s53, 8388608
    v_lshl_add_u32 v70, v1, 4, s53
    s_lshl3_add_u32 s45, s2, s3
    s_lshl_b32 s45, s45, 10
    s_add_u32 s45, s45, 16777216
    s_mul_i32 s55, s3, 20000
    s_movk_i32 s46, 2500
    v_mul_u32_u24 v73, s46, v73
    v_add_u32 v73, s55, v73
    v_mul_u32_u24 v74, s46, v74
    v_add_u32 v74, s55, v74
    v_mul_u32_u24 v75, s46, v75
    v_add_u32 v75, s55, v75
    v_mov_b64 v[80:81], 0
    v_mov_b64 v[82:83], 0
    v_mov_b64 v[84:85], 0
    v_mov_b64 v[86:87], 0
    v_mov_b64 v[88:89], 0
    v_mov_b64 v[90:91], 0
    v_mov_b64 v[92:93], 0
    v_mov_b64 v[94:95], 0
    v_mov_b64 v[96:97], 0
    v_mov_b64 v[98:99], 0
    v_mov_b64 v[100:101], 0
    v_mov_b64 v[102:103], 0
    v_mov_b64 v[104:105], 0
    v_mov_b64 v[106:107], 0
    v_mov_b64 v[108:109], 0
    v_mov_b64 v[110:111], 0
    v_mov_b64 v[112:113], 0
    v_mov_b64 v[114:115], 0
    v_mov_b64 v[116:117], 0
    v_mov_b64 v[118:119], 0
    v_mov_b64 v[120:121], 0
    v_mov_b64 v[122:123], 0
    v_mov_b64 v[124:125], 0
    v_mov_b64 v[126:127], 0
    v_mov_b64 v[128:129], 0
    v_mov_b64 v[130:131], 0
    v_mov_b64 v[132:133], 0
    v_mov_b64 v[134:135], 0
    v_mov_b64 v[136:137], 0
    v_mov_b64 v[138:139], 0
    v_mov_b64 v[140:141], 0
    v_mov_b64 v[142:143], 0
    v_mov_b64 v[144:145], 0
    v_mov_b64 v[146:147], 0
    v_mov_b64 v[148:149], 0
    v_mov_b64 v[150:151], 0
    v_mov_b64 v[152:153], 0
    v_mov_b64 v[154:155], 0
    s_mov_b64 s[36:37], -1
    s_mov_b64 s[38:39], -1
    s_mov_b64 s[40:41], -1
    s_mov_b32 s55, 0
    s_waitcnt vmcnt(0)
L_poll:
    s_mov_b64 exec, s[36:37]
    s_cbranch_execz L_1
    buffer_load_dwordx4 v[48:51], v70, s[32:35], 0 offen offset:0 sc1
L_1:
    s_mov_b64 exec, s[38:39]
    s_cbranch_execz L_2
    buffer_load_dwordx4 v[52:55], v70, s[32:35], 0 offen offset:1024 sc1
L_2:
    s_mov_b64 exec, s[40:41]
    s_cbranch_execz L_3
    buffer_load_dwordx4 v[56:59], v70, s[32:35], 0 offen offset:2048 sc1
L_3:
    s_mov_b64 exec, -1
    s_waitcnt vmcnt(0)
    v_cmp_ne_u32 s[36:37], s48, v49
    v_cmp_ne_u32 s[38:39], s48, v53
    v_cmp_ne_u32 s[40:41], s48, v57
    s_or_b64 s[4:5], s[36:37], s[38:39]
    s_or_b64 s[4:5], s[4:5], s[40:41]
    s_cbranch_scc0 L_got
    s_sleep 4
    s_add_u32 s55, s55, 1
    s_cmp_lt_u32 s55, 0x400000
    s_cbranch_scc1 L_poll
L_got:
    v_lshl_or_b32 v14, v45, 16, v44
    v_lshl_or_b32 v15, v47, 16, v46
    s_cmp_ge_u32 s3, 2
    s_cbranch_scc1 L_4
    v_lshl_or_b32 v44, v33, 16, v32
    v_lshl_or_b32 v45, v35, 16, v34
    v_lshl_or_b32 v46, v37, 16, v36
    v_lshl_or_b32 v47, v39, 16, v38
    s_lshl_b32 s53, s54, 1
    s_add_u32 s53, s53, s44
    s_lshl2_add_u32 s83, s53, 4096
    s_lshl_b32 s53, s53, 10
    s_add_u32 s53, s53, 1048576
    v_lshl_add_u32 v60, v1, 4, s53
    buffer_store_dwordx4 v[44:47], v60, s[32:35], 0 offen sc1
L_4:
    v_mov_b64 v[156:157], 0
    v_mov_b64 v[158:159], 0
    v_cmp_gt_u32 s[36:37], -2, v48
    v_cmp_gt_u32 s[38:39], -2, v52
    v_cmp_gt_u32 s[40:41], -2, v56
    v_mov_b32 v40, -1
    s_mov_b64 s[42:43], 0
    s_mov_b64 s[6:7], 0
    s_bitcmp1_b64 s[36:37], 23
    s_cselect_b32 s53, 255, 0
    s_or_b32 s6, s6, s53
    s_bitcmp1_b64 s[36:37], 47
    s_cselect_b32 s53, 65280, 0
    s_or_b32 s6, s6, s53
    s_bitcmp1_b64 s[38:39], 7
    s_cselect_b32 s53, 16711680, 0
    s_or_b32 s6, s6, s53
    s_bitcmp1_b64 s[38:39], 31
    s_cselect_b32 s53, 4278190080, 0
    s_or_b32 s6, s6, s53
    s_bitcmp1_b64 s[38:39], 55
    s_cselect_b32 s53, 255, 0
    s_or_b32 s7, s7, s53
    s_bitcmp1_b64 s[40:41], 15
    s_cselect_b32 s53, 65280, 0
    s_or_b32 s7, s7, s53
    s_bitcmp1_b64 s[40:41], 39
    s_cselect_b32 s53, 16711680, 0
    s_or_b32 s7, s7, s53
    s_bitcmp1_b64 s[40:41], 63
    s_cselect_b32 s53, 4278190080, 0
    s_or_b32 s7, s7, s53
    s_cmp_eq_u64 s[6:7], 0
    s_cbranch_scc1 L_noext
    v_lshl_add_u32 v61, v1, 4, s45
    v_mov_b32 v41, s48
L_poll2:
    s_mov_b64 exec, s[6:7]
    buffer_load_dwordx4 v[40:43], v61, s[32:35], 0 offen sc1
    s_mov_b64 exec, -1
    s_waitcnt vmcnt(0)
    v_cmp_ne_u32 vcc, s48, v41
    s_cbranch_vccz L_got2
    s_sleep 1
    s_add_u32 s55, s55, 1
    s_cmp_lt_u32 s55, 0x400000
    s_cbranch_scc1 L_poll2
L_got2:
    v_cmp_gt_u32 s[42:43], -2, v40
L_noext:
    v_lshrrev_b32 v60, 3, v1
    v_mul_u32_u24 v72, s46, v60
    s_mul_i32 s55, s3, 20000
    v_add_u32 v72, s55, v72
    v_cmp_eq_u32 vcc, -2, v40
    s_bcnt1_i32_b64 s64, s[36:37]
    s_bcnt1_i32_b64 s65, s[38:39]
    s_bcnt1_i32_b64 s66, s[40:41]
    s_bcnt1_i32_b64 s67, s[42:43]
    s_add_u32 s65, s65, s64
    s_add_u32 s66, s66, s65
    s_add_u32 s79, s67, s66
    v_mov_b32 v61, s79
    v_mov_b32 v60, 114624
    s_mov_b64 exec, 1
    ds_add_rtn_u32 v61, v60, v61
    s_mov_b64 exec, -1
    v_mbcnt_lo_u32_b32 v62, s36, 0
    v_mbcnt_hi_u32_b32 v62, s37, v62
    v_lshrrev_b32 v20, 20, v48
    v_add_u32 v20, v20, v73
    v_lshl_add_u32 v66, v62, 2, s49
    s_mov_b64 exec, s[36:37]
    ds_write_b32 v66, v20
    s_mov_b64 exec, -1
    v_lshlrev_b32 v24, 2, v48
    v_and_b32 v24, s82, v24
    v_and_b32 v16, 63, v48
    v_mbcnt_lo_u32_b32 v63, s38, 0
    v_mbcnt_hi_u32_b32 v63, s39, v63
    v_add_u32 v63, s64, v63
    v_lshrrev_b32 v21, 20, v52
    v_add_u32 v21, v21, v74
    v_lshl_add_u32 v66, v63, 2, s49
    s_mov_b64 exec, s[38:39]
    ds_write_b32 v66, v21
    s_mov_b64 exec, -1
    v_lshlrev_b32 v25, 2, v52
    v_and_b32 v25, s82, v25
    v_and_b32 v17, 63, v52
    v_mbcnt_lo_u32_b32 v64, s40, 0
    v_mbcnt_hi_u32_b32 v64, s41, v64
    v_add_u32 v64, s65, v64
    v_lshrrev_b32 v22, 20, v56
    v_add_u32 v22, v22, v75
    v_lshl_add_u32 v66, v64, 2, s49
    s_mov_b64 exec, s[40:41]
    ds_write_b32 v66, v22
    s_mov_b64 exec, -1
    v_lshlrev_b32 v26, 2, v56
    v_and_b32 v26, s82, v26
    v_and_b32 v18, 63, v56
    v_mbcnt_lo_u32_b32 v65, s42, 0
    v_mbcnt_hi_u32_b32 v65, s43, v65
    v_add_u32 v65, s66, v65
    v_lshrrev_b32 v23, 20, v40
    v_add_u32 v23, v23, v72
    v_lshl_add_u32 v66, v65, 2, s49
    s_mov_b64 exec, s[42:43]
    ds_write_b32 v66, v23
    s_mov_b64 exec, -1
    v_lshlrev_b32 v27, 2, v40
    v_and_b32 v27, s82, v27
    v_and_b32 v19, 63, v40
    s_mov_b32 s80, 79
    s_waitcnt lgkmcnt(0)
    v_readfirstlane_b32 s44, v61
    s_cbranch_vccnz L_defer
    s_add_u32 s53, s44, s79
    s_cmp_gt_u32 s53, 1024
    s_cbranch_scc1 L_defer
    s_mov_b32 s53, 98304
    v_add_u32 v62, s44, v62
    v_lshl_or_b32 v24, v62, 22, v24
    v_lshl_add_u32 v62, v62, 3, s53
    s_mov_b64 exec, s[36:37]
    ds_write_b64 v62, v[50:51]
    s_mov_b64 exec, -1
    v_add_u32 v63, s44, v63
    v_lshl_or_b32 v25, v63, 22, v25
    v_lshl_add_u32 v63, v63, 3, s53
    s_mov_b64 exec, s[38:39]
    ds_write_b64 v63, v[54:55]
    s_mov_b64 exec, -1
    v_add_u32 v64, s44, v64
    v_lshl_or_b32 v26, v64, 22, v26
    v_lshl_add_u32 v64, v64, 3, s53
    s_mov_b64 exec, s[40:41]
    ds_write_b64 v64, v[58:59]
    s_mov_b64 exec, -1
    v_add_u32 v65, s44, v65
    v_lshl_or_b32 v27, v65, 22, v27
    v_lshl_add_u32 v65, v65, 3, s53
    s_mov_b64 exec, s[42:43]
    ds_write_b64 v65, v[42:43]
    s_mov_b64 exec, -1
    s_branch L_have
L_defer:
    s_mov_b32 s80, 0
    s_mov_b32 s79, 0
    s_mov_b32 s44, 0
    s_mov_b64 s[36:37], 0
    s_mov_b64 s[38:39], 0
    s_mov_b64 s[40:41], 0
    s_mov_b64 s[42:43], 0
    v_mov_b32 v58, 1
    v_mov_b32 v59, 119056
    ds_write_b32 v59, v58
    s_branch L_have
L_scan:
    s_barrier
    s_mov_b32 s64, s63
    s_add_u32 s65, s63, 1024
    s_xor_b32 s47, s2, 1
L_sloop:
    s_cmp_ge_u32 s80, 79
    s_cbranch_scc1 L_scan_done
    s_mul_i32 s53, s3, 20000
    s_lshl_b32 s54, s80, 8
    s_add_u32 s55, s53, s54
    v_lshlrev_b32 v56, 2, v1
    v_add_u32 v56, s55, v56
    v_lshlrev_b32 v57, 2, v56
    buffer_load_dwordx4 v[60:63], v57, s[16:19], 0 offen
    s_waitcnt vmcnt(0)
    s_cmp_lg_u32 s80, 78
    s_cbranch_scc1 L_snotlast
    s_mov_b32 exec_lo, 0xffffff00
    v_mov_b32 v60, s47
    v_mov_b32 v61, s47
    v_mov_b32 v62, s47
    v_mov_b32 v63, s47
    s_mov_b64 exec, -1
L_snotlast:
    s_cmp_gt_u32 s52, 0
    s_cbranch_scc1 L_5
    v_cmp_eq_u32_sdwa vcc, v60, s2 src0_sel:BYTE_0 src1_sel:DWORD
    s_cbranch_vccz L_5
    s_bcnt1_i32_b64 s53, vcc
    s_lshl3_add_u32 s54, s53, s64
    s_mov_b32 s52, 0
    s_cmp_gt_u32 s54, s65
    s_cbranch_scc1 L_ovf
    v_mbcnt_lo_u32_b32 v58, vcc_lo, 0
    v_mbcnt_hi_u32_b32 v58, vcc_hi, v58
    v_lshl_add_u32 v58, v58, 3, s64
    v_add_u32 v59, 0, v56
    s_mov_b64 exec, vcc
    ds_write2_b32 v58, v60, v59 offset0:0 offset1:1
    s_mov_b64 exec, -1
    s_mov_b32 s64, s54
L_5:
    s_cmp_gt_u32 s52, 1
    s_cbranch_scc1 L_6
    v_cmp_eq_u32_sdwa vcc, v61, s2 src0_sel:BYTE_0 src1_sel:DWORD
    s_cbranch_vccz L_6
    s_bcnt1_i32_b64 s53, vcc
    s_lshl3_add_u32 s54, s53, s64
    s_mov_b32 s52, 1
    s_cmp_gt_u32 s54, s65
    s_cbranch_scc1 L_ovf
    v_mbcnt_lo_u32_b32 v58, vcc_lo, 0
    v_mbcnt_hi_u32_b32 v58, vcc_hi, v58
    v_lshl_add_u32 v58, v58, 3, s64
    v_add_u32 v59, 1, v56
    s_mov_b64 exec, vcc
    ds_write2_b32 v58, v61, v59 offset0:0 offset1:1
    s_mov_b64 exec, -1
    s_mov_b32 s64, s54
L_6:
    s_cmp_gt_u32 s52, 2
    s_cbranch_scc1 L_7
    v_cmp_eq_u32_sdwa vcc, v62, s2 src0_sel:BYTE_0 src1_sel:DWORD
    s_cbranch_vccz L_7
    s_bcnt1_i32_b64 s53, vcc
    s_lshl3_add_u32 s54, s53, s64
    s_mov_b32 s52, 2
    s_cmp_gt_u32 s54, s65
    s_cbranch_scc1 L_ovf
    v_mbcnt_lo_u32_b32 v58, vcc_lo, 0
    v_mbcnt_hi_u32_b32 v58, vcc_hi, v58
    v_lshl_add_u32 v58, v58, 3, s64
    v_add_u32 v59, 2, v56
    s_mov_b64 exec, vcc
    ds_write2_b32 v58, v62, v59 offset0:0 offset1:1
    s_mov_b64 exec, -1
    s_mov_b32 s64, s54
L_7:
    s_cmp_gt_u32 s52, 3
    s_cbranch_scc1 L_8
    v_cmp_eq_u32_sdwa vcc, v63, s2 src0_sel:BYTE_0 src1_sel:DWORD
    s_cbranch_vccz L_8
    s_bcnt1_i32_b64 s53, vcc
    s_lshl3_add_u32 s54, s53, s64
    s_mov_b32 s52, 3
    s_cmp_gt_u32 s54, s65
    s_cbranch_scc1 L_ovf
    v_mbcnt_lo_u32_b32 v58, vcc_lo, 0
    v_mbcnt_hi_u32_b32 v58, vcc_hi, v58
    v_lshl_add_u32 v58, v58, 3, s64
    v_add_u32 v59, 3, v56
    s_mov_b64 exec, vcc
    ds_write2_b32 v58, v63, v59 offset0:0 offset1:1
    s_mov_b64 exec, -1
    s_mov_b32 s64, s54
L_8:
    s_mov_b32 s52, 0
    s_add_u32 s80, s80, 1
    s_branch L_sloop
L_ovf:
    v_mov_b32 v58, 1
    v_mov_b32 v59, 119056
    ds_write_b32 v59, v58
L_scan_done:
    s_sub_u32 s79, s64, s63
    s_lshr_b32 s79, s79, 3
    s_lshl_b32 s44, s3, 7
    v_lshlrev_b32 v58, 3, v1
    v_add_u32 v58, s63, v58
    s_waitcnt lgkmcnt(0)
    ds_read_b32 v16, v58 offset:0
    ds_read_b32 v20, v58 offset:4
    s_sub_u32 s53, s79, 0
    v_cmp_gt_i32 s[36:37], s53, v1
    ds_read_b32 v17, v58 offset:512
    ds_read_b32 v21, v58 offset:516
    s_sub_u32 s53, s79, 64
    v_cmp_gt_i32 s[38:39], s53, v1
    s_mov_b64 s[40:41], 0
    v_mov_b32 v18, 0
    v_mov_b32 v26, 0
    s_mov_b64 s[42:43], 0
    v_mov_b32 v19, 0
    v_mov_b32 v27, 0
    v_lshl_add_u32 v58, v1, 2, s49
    v_add_u32 v59, s44, v1
    v_lshlrev_b32 v59, 22, v59
    s_waitcnt lgkmcnt(0)
    v_lshlrev_b32 v28, 2, v20
    buffer_load_dword v24, v28, s[12:15], 0 offen
    v_bfe_u32 v16, v16, 8, 6
    v_min_u32 v16, 47, v16
    ds_write_b32 v58, v20 offset:0
    v_lshlrev_b32 v29, 2, v21
    buffer_load_dword v25, v29, s[12:15], 0 offen
    v_bfe_u32 v17, v17, 8, 6
    v_min_u32 v17, 47, v17
    ds_write_b32 v58, v21 offset:256
    s_waitcnt vmcnt(0)
    v_and_b32 v24, 0x3fff, v24
    v_lshl_or_b32 v24, v24, 8, v59
    v_add_u32 v59, 268435456, v59
    v_and_b32 v25, 0x3fff, v25
    v_lshl_or_b32 v25, v25, 8, v59
    v_add_u32 v59, 268435456, v59
L_have:
    v_mov_b32 v58, 1
    s_mov_b32 s53, 110848
    s_mov_b32 s54, 114688
    v_bfe_u32 v28, v24, 8, 14
    v_mul_u32_u24 v28, 6711, v28
    v_lshrrev_b32 v28, 22, v28
    v_min_u32 v28, 15, v28
    v_lshl_add_u32 v28, v28, 2, s53
    v_lshl_add_u32 v28, v16, 6, v28
    v_lshl_add_u32 v16, v16, 2, s54
    s_mov_b64 exec, s[36:37]
    ds_add_rtn_u32 v32, v28, v58
    ds_add_u32 v16, v58
    s_mov_b64 exec, -1
    v_bfe_u32 v29, v25, 8, 14
    v_mul_u32_u24 v29, 6711, v29
    v_lshrrev_b32 v29, 22, v29
    v_min_u32 v29, 15, v29
    v_lshl_add_u32 v29, v29, 2, s53
    v_lshl_add_u32 v29, v17, 6, v29
    v_lshl_add_u32 v17, v17, 2, s54
    s_mov_b64 exec, s[38:39]
    ds_add_rtn_u32 v33, v29, v58
    ds_add_u32 v17, v58
    s_mov_b64 exec, -1
    v_bfe_u32 v30, v26, 8, 14
    v_mul_u32_u24 v30, 6711, v30
    v_lshrrev_b32 v30, 22, v30
    v_min_u32 v30, 15, v30
    v_lshl_add_u32 v30, v30, 2, s53
    v_lshl_add_u32 v30, v18, 6, v30
    v_lshl_add_u32 v18, v18, 2, s54
    s_mov_b64 exec, s[40:41]
    ds_add_rtn_u32 v34, v30, v58
    ds_add_u32 v18, v58
    s_mov_b64 exec, -1
    v_bfe_u32 v31, v27, 8, 14
    v_mul_u32_u24 v31, 6711, v31
    v_lshrrev_b32 v31, 22, v31
    v_min_u32 v31, 15, v31
    v_lshl_add_u32 v31, v31, 2, s53
    v_lshl_add_u32 v31, v19, 6, v31
    v_lshl_add_u32 v19, v19, 2, s54
    s_mov_b64 exec, s[42:43]
    ds_add_rtn_u32 v35, v31, v58
    ds_add_u32 v19, v58
    s_mov_b64 exec, -1
    v_lshrrev_b32 v36, 1, v1
    v_lshl_add_u32 v39, v36, 2, s49
    ds_read_b32 v40, v39 offset:0
    ds_read_b32 v41, v39 offset:128
    ds_read_b32 v42, v39 offset:256
    ds_read_b32 v43, v39 offset:384
    v_and_b32 v38, 1, v1
    v_lshlrev_b32 v37, 4, v38
    v_lshlrev_b32 v38, 2, v38
    s_mov_b32 s46, s79
    s_mov_b32 s45, s44
    v_lshl_add_u32 v56, v1, 2, s54
    v_mov_b32 v57, 119056
    s_waitcnt lgkmcnt(0)
    s_cmp_le_i32 s46, 0
    s_cbranch_scc1 L_9
    v_lshl_add_u32 v44, v40, 5, v37
    v_lshl_add_u32 v45, v40, 3, v38
    v_cmp_gt_i32 vcc, s46, v36
    s_lshl_b32 s76, s45, 5
    s_add_u32 m0, s76, 65536
    s_mov_b64 exec, vcc
    buffer_load_dwordx4 v44, s[24:27], 0 offen lds
    s_lshl3_add_u32 m0, s45, 98304
    s_cmp_eq_u32 s77, 0
    s_cbranch_scc1 L_10
    buffer_load_dword v45, s[20:23], 0 offen lds
L_10:
    s_mov_b64 exec, -1
    s_add_u32 s45, s45, 32
    s_sub_i32 s46, s46, 32
L_9:
    s_barrier
    ds_read_b32 v56, v56
    ds_read_b32 v57, v57
    s_cmp_le_i32 s46, 0
    s_cbranch_scc1 L_11
    v_lshl_add_u32 v44, v41, 5, v37
    v_lshl_add_u32 v45, v41, 3, v38
    v_cmp_gt_i32 vcc, s46, v36
    s_lshl_b32 s76, s45, 5
    s_add_u32 m0, s76, 65536
    s_mov_b64 exec, vcc
    buffer_load_dwordx4 v44, s[24:27], 0 offen lds
    s_lshl3_add_u32 m0, s45, 98304
    s_cmp_eq_u32 s77, 0
    s_cbranch_scc1 L_12
    buffer_load_dword v45, s[20:23], 0 offen lds
L_12:
    s_mov_b64 exec, -1
    s_add_u32 s45, s45, 32
    s_sub_i32 s46, s46, 32
L_11:
    s_waitcnt lgkmcnt(0)
    v_readfirstlane_b32 s78, v57
    s_cmp_lg_u32 s77, 0
    s_cbranch_scc1 L_assigned
    ds_read_b64_tr_b16 a[0:1], v77 offset:32768
    ds_read_b64_tr_b16 a[2:3], v77 offset:34816
    ds_read_b64_tr_b16 a[4:5], v77 offset:32832
    ds_read_b64_tr_b16 a[6:7], v77 offset:34880
    ds_read_b64_tr_b16 a[8:9], v77 offset:32896
    ds_read_b64_tr_b16 a[10:11], v77 offset:34944
    ds_read_b64_tr_b16 a[12:13], v77 offset:32960
    ds_read_b64_tr_b16 a[14:15], v77 offset:35008
    ds_read_b64_tr_b16 a[16:17], v77 offset:33024
    ds_read_b64_tr_b16 a[18:19], v77 offset:35072
    ds_read_b64_tr_b16 a[20:21], v77 offset:33088
    ds_read_b64_tr_b16 a[22:23], v77 offset:35136
    ds_read_b64_tr_b16 a[24:25], v77 offset:33152
    ds_read_b64_tr_b16 a[26:27], v77 offset:35200
    ds_read_b64_tr_b16 a[28:29], v77 offset:33216
    ds_read_b64_tr_b16 a[30:31], v77 offset:35264
    s_and_b32 s53, s2, 63
    s_or_b32 s53, s53, s3
    s_cbranch_scc1 L_13
    s_lshl_b32 s53, s2, 1
    v_mov_b32 v60, s53
    v_mov_b32 v61, s48
    s_mov_b64 exec, 1
    buffer_store_dword v61, v60, s[32:35], 0 offen sc1
    s_mov_b64 exec, -1
L_13:
    v_sub_u32 v57, 63, v1
    v_lshl_add_u32 v57, v56, 6, v57
    v_mov_b32 v59, 0
    v_readlane_b32 s84, v57, 0
    v_readlane_b32 s85, v57, 1
    v_readlane_b32 s86, v57, 2
    v_readlane_b32 s87, v57, 3
    v_readlane_b32 s88, v57, 4
    v_readlane_b32 s89, v57, 5
    v_readlane_b32 s90, v57, 6
    v_readlane_b32 s91, v57, 7
    v_readlane_b32 s92, v57, 8
    v_readlane_b32 s93, v57, 9
    v_readlane_b32 s94, v57, 10
    v_readlane_b32 s95, v57, 11
    v_readlane_b32 s96, v57, 12
    v_readlane_b32 s97, v57, 13
    v_readlane_b32 s98, v57, 14
    v_readlane_b32 s99, v57, 15
    v_cmp_gt_u32 vcc, s84, v57
    v_cmp_gt_u32 s[4:5], s85, v57
    v_cmp_gt_u32 s[6:7], s86, v57
    v_addc_co_u32 v59, vcc, 0, v59, vcc
    v_addc_co_u32 v59, s[4:5], 0, v59, s[4:5]
    v_addc_co_u32 v59, s[6:7], 0, v59, s[6:7]
    v_cmp_gt_u32 vcc, s87, v57
    v_cmp_gt_u32 s[4:5], s88, v57
    v_cmp_gt_u32 s[6:7], s89, v57
    v_addc_co_u32 v59, vcc, 0, v59, vcc
    v_addc_co_u32 v59, s[4:5], 0, v59, s[4:5]
    v_addc_co_u32 v59, s[6:7], 0, v59, s[6:7]
    v_cmp_gt_u32 vcc, s90, v57
    v_cmp_gt_u32 s[4:5], s91, v57
    v_cmp_gt_u32 s[6:7], s92, v57
    v_addc_co_u32 v59, vcc, 0, v59, vcc
    v_addc_co_u32 v59, s[4:5], 0, v59, s[4:5]
    v_addc_co_u32 v59, s[6:7], 0, v59, s[6:7]
    v_cmp_gt_u32 vcc, s93, v57
    v_cmp_gt_u32 s[4:5], s94, v57
    v_cmp_gt_u32 s[6:7], s95, v57
    v_addc_co_u32 v59, vcc, 0, v59, vcc
    v_addc_co_u32 v59, s[4:5], 0, v59, s[4:5]
    v_addc_co_u32 v59, s[6:7], 0, v59, s[6:7]
    v_cmp_gt_u32 vcc, s96, v57
    v_cmp_gt_u32 s[4:5], s97, v57
    v_cmp_gt_u32 s[6:7], s98, v57
    v_addc_co_u32 v59, vcc, 0, v59, vcc
    v_addc_co_u32 v59, s[4:5], 0, v59, s[4:5]
    v_addc_co_u32 v59, s[6:7], 0, v59, s[6:7]
    v_cmp_gt_u32 vcc, s99, v57
    s_nop 1
    v_addc_co_u32 v59, vcc, 0, v59, vcc
    v_readlane_b32 s84, v57, 16
    v_readlane_b32 s85, v57, 17
    v_readlane_b32 s86, v57, 18
    v_readlane_b32 s87, v57, 19
    v_readlane_b32 s88, v57, 20
    v_readlane_b32 s89, v57, 21
    v_readlane_b32 s90, v57, 22
    v_readlane_b32 s91, v57, 23
    v_readlane_b32 s92, v57, 24
    v_readlane_b32 s93, v57, 25
    v_readlane_b32 s94, v57, 26
    v_readlane_b32 s95, v57, 27
    v_readlane_b32 s96, v57, 28
    v_readlane_b32 s97, v57, 29
    v_readlane_b32 s98, v57, 30
    v_readlane_b32 s99, v57, 31
    v_cmp_gt_u32 vcc, s84, v57
    v_cmp_gt_u32 s[4:5], s85, v57
    v_cmp_gt_u32 s[6:7], s86, v57
    v_addc_co_u32 v59, vcc, 0, v59, vcc
    v_addc_co_u32 v59, s[4:5], 0, v59, s[4:5]
    v_addc_co_u32 v59, s[6:7], 0, v59, s[6:7]
    v_cmp_gt_u32 vcc, s87, v57
    v_cmp_gt_u32 s[4:5], s88, v57
    v_cmp_gt_u32 s[6:7], s89, v57
    v_addc_co_u32 v59, vcc, 0, v59, vcc
    v_addc_co_u32 v59, s[4:5], 0, v59, s[4:5]
    v_addc_co_u32 v59, s[6:7], 0, v59, s[6:7]
    v_cmp_gt_u32 vcc, s90, v57
    v_cmp_gt_u32 s[4:5], s91, v57
    v_cmp_gt_u32 s[6:7], s92, v57
    v_addc_co_u32 v59, vcc, 0, v59, vcc
    v_addc_co_u32 v59, s[4:5], 0, v59, s[4:5]
    v_addc_co_u32 v59, s[6:7], 0, v59, s[6:7]
    v_cmp_gt_u32 vcc, s93, v57
    v_cmp_gt_u32 s[4:5], s94, v57
    v_cmp_gt_u32 s[6:7], s95, v57
    v_addc_co_u32 v59, vcc, 0, v59, vcc
    v_addc_co_u32 v59, s[4:5], 0, v59, s[4:5]
    v_addc_co_u32 v59, s[6:7], 0, v59, s[6:7]
    v_cmp_gt_u32 vcc, s96, v57
    v_cmp_gt_u32 s[4:5], s97, v57
    v_cmp_gt_u32 s[6:7], s98, v57
    v_addc_co_u32 v59, vcc, 0, v59, vcc
    v_addc_co_u32 v59, s[4:5], 0, v59, s[4:5]
    v_addc_co_u32 v59, s[6:7], 0, v59, s[6:7]
    v_cmp_gt_u32 vcc, s99, v57
    s_nop 1
    v_addc_co_u32 v59, vcc, 0, v59, vcc
    v_readlane_b32 s84, v57, 32
    v_readlane_b32 s85, v57, 33
    v_readlane_b32 s86, v57, 34
    v_readlane_b32 s87, v57, 35
    v_readlane_b32 s88, v57, 36
    v_readlane_b32 s89, v57, 37
    v_readlane_b32 s90, v57, 38
    v_readlane_b32 s91, v57, 39
    v_cmp_gt_u32 vcc, s84, v57
    v_cmp_gt_u32 s[4:5], s85, v57
    v_cmp_gt_u32 s[6:7], s86, v57
    v_addc_co_u32 v59, vcc, 0, v59, vcc
    v_addc_co_u32 v59, s[4:5], 0, v59, s[4:5]
    v_addc_co_u32 v59, s[6:7], 0, v59, s[6:7]
    v_cmp_gt_u32 vcc, s87, v57
    v_cmp_gt_u32 s[4:5], s88, v57
    v_cmp_gt_u32 s[6:7], s89, v57
    v_addc_co_u32 v59, vcc, 0, v59, vcc
    v_addc_co_u32 v59, s[4:5], 0, v59, s[4:5]
    v_addc_co_u32 v59, s[6:7], 0, v59, s[6:7]
    v_cmp_gt_u32 vcc, s90, v57
    v_cmp_gt_u32 s[4:5], s91, v57
    s_nop 0
    v_addc_co_u32 v59, vcc, 0, v59, vcc
    v_addc_co_u32 v59, s[4:5], 0, v59, s[4:5]
    v_bfe_u32 v60, v59, 3, 1
    v_mul_u32_u24 v60, 7, v60
    v_and_b32 v61, 7, v59
    v_xor_b32 v11, v60, v61
    s_sub_u32 s53, 7, s3
    s_add_u32 s54, s3, 0
    v_cmp_eq_u32 vcc, s54, v59
    s_ff1_i32_b64 s56, vcc
    s_add_u32 s54, s53, 8
    v_cmp_eq_u32 vcc, s54, v59
    s_ff1_i32_b64 s57, vcc
    s_add_u32 s54, s3, 16
    v_cmp_eq_u32 vcc, s54, v59
    s_ff1_i32_b64 s58, vcc
    s_add_u32 s54, s53, 24
    v_cmp_eq_u32 vcc, s54, v59
    s_ff1_i32_b64 s59, vcc
    s_add_u32 s54, s3, 32
    v_cmp_eq_u32 vcc, s54, v59
    s_ff1_i32_b64 s60, vcc
L_assigned:
    v_cmp_gt_u32 vcc, s3, v11
    v_and_b32 v61, 15, v1
    v_lshlrev_b32 v61, 2, v61
    v_cndmask_b32 v60, 0, v56, vcc
    v_add_u32 v61, 110848, v61
    s_lshl_b32 s84, s56, 6
    v_add_u32 v64, s84, v61
    ds_read_b32 v70, v64
    s_lshl_b32 s85, s57, 6
    v_add_u32 v65, s85, v61
    ds_read_b32 v71, v65
    s_lshl_b32 s86, s58, 6
    v_add_u32 v66, s86, v61
    ds_read_b32 v72, v66
    s_lshl_b32 s87, s59, 6
    v_add_u32 v67, s87, v61
    ds_read_b32 v73, v67
    s_lshl_b32 s88, s60, 6
    v_add_u32 v68, s88, v61
    ds_read_b32 v74, v68
    v_add_u32_dpp v60, v60, v60 row_shr:1 row_mask:0xf bank_mask:0xf bound_ctrl:1
    v_readlane_b32 s92, v56, s56
    s_nop 0
    v_add_u32_dpp v60, v60, v60 row_shr:2 row_mask:0xf bank_mask:0xf bound_ctrl:1
    v_readlane_b32 s93, v56, s57
    s_nop 0
    v_add_u32_dpp v60, v60, v60 row_shr:4 row_mask:0xf bank_mask:0xf bound_ctrl:1
    v_readlane_b32 s94, v56, s58
    s_nop 0
    v_add_u32_dpp v60, v60, v60 row_shr:8 row_mask:0xf bank_mask:0xf bound_ctrl:1
    v_readlane_b32 s95, v56, s59
    s_nop 0
    v_readlane_b32 s96, v56, s60
    v_readlane_b32 s61, v60, 15
    v_readlane_b32 s53, v60, 31
    v_readlane_b32 s54, v60, 47
    s_add_u32 s62, s92, s93
    s_add_u32 s62, s62, s94
    s_add_u32 s62, s62, s95
    s_add_u32 s62, s62, s96
    s_add_u32 s61, s61, s53
    s_add_u32 s61, s61, s54
    s_add_u32 s61, s61, 3
    s_andn2_b32 s61, s61, 3
    s_lshl2_add_u32 s61, s3, s61
    s_waitcnt lgkmcnt(0)
    v_add3_u32 v60, v70, v71, v72
    v_add3_u32 v60, v60, v73, v74
    v_mov_b32 v61, v60
    s_nop 1
    v_add_u32_dpp v61, v61, v61 row_shr:1 row_mask:0xf bank_mask:0xf bound_ctrl:1
    s_nop 1
    v_add_u32_dpp v61, v61, v61 row_shr:2 row_mask:0xf bank_mask:0xf bound_ctrl:1
    s_nop 1
    v_add_u32_dpp v61, v61, v61 row_shr:4 row_mask:0xf bank_mask:0xf bound_ctrl:1
    s_nop 1
    v_add_u32_dpp v61, v61, v61 row_shr:8 row_mask:0xf bank_mask:0xf bound_ctrl:1
    v_sub_u32 v61, v61, v60
    v_add_u32 v61, s61, v61
    v_lshl_add_u32 v75, v61, 8, 0
    ds_write_b32 v64, v75 offset:4096
    v_add_u32 v61, v61, v70
    v_lshl_add_u32 v76, v61, 8, 16
    ds_write_b32 v65, v76 offset:4096
    v_add_u32 v61, v61, v71
    v_lshl_add_u32 v77, v61, 8, 32
    ds_write_b32 v66, v77 offset:4096
    v_add_u32 v61, v61, v72
    v_lshl_add_u32 v78, v61, 8, 48
    ds_write_b32 v67, v78 offset:4096
    v_add_u32 v61, v61, v73
    v_lshl_add_u32 v79, v61, 8, 64
    ds_write_b32 v68, v79 offset:4096
    s_cmp_le_i32 s46, 0
    s_cbranch_scc1 L_14
    v_lshl_add_u32 v44, v42, 5, v37
    v_lshl_add_u32 v45, v42, 3, v38
    v_cmp_gt_i32 vcc, s46, v36
    s_lshl_b32 s76, s45, 5
    s_add_u32 m0, s76, 65536
    s_mov_b64 exec, vcc
    buffer_load_dwordx4 v44, s[24:27], 0 offen lds
    s_lshl3_add_u32 m0, s45, 98304
    s_cmp_eq_u32 s77, 0
    s_cbranch_scc1 L_15
    buffer_load_dword v45, s[20:23], 0 offen lds
L_15:
    s_mov_b64 exec, -1
    s_add_u32 s45, s45, 32
    s_sub_i32 s46, s46, 32
L_14:
    s_waitcnt lgkmcnt(0)
    s_barrier
    ds_read_b32 v16, v28 offset:4096
    ds_read_b32 v17, v29 offset:4096
    ds_read_b32 v18, v30 offset:4096
    ds_read_b32 v19, v31 offset:4096
    v_mov_b32 v60, 0
    v_mov_b32 v61, 0
    v_lshlrev_b32 v64, 3, v0
    v_add_u32 v64, 110848, v64
    ds_write_b64 v64, v[60:61]
    v_mov_b32 v64, 119056
    ds_write_b32 v64, v60
    s_mov_b32 s53, 106496
    s_movk_i32 s54, 255
    s_waitcnt lgkmcnt(2)
    v_lshrrev_b32 v28, 8, v16
    v_add_u32 v28, v28, v32
    v_and_or_b32 v16, v16, s54, v24
    v_lshl_add_u32 v28, v28, 2, s53
    s_mov_b64 exec, s[36:37]
    ds_write_b32 v28, v16
    s_mov_b64 exec, -1
    v_lshrrev_b32 v29, 8, v17
    v_add_u32 v29, v29, v33
    v_and_or_b32 v17, v17, s54, v25
    v_lshl_add_u32 v29, v29, 2, s53
    s_mov_b64 exec, s[38:39]
    ds_write_b32 v29, v17
    s_mov_b64 exec, -1
    v_lshrrev_b32 v30, 8, v18
    v_add_u32 v30, v30, v34
    v_and_or_b32 v18, v18, s54, v26
    v_lshl_add_u32 v30, v30, 2, s53
    s_mov_b64 exec, s[40:41]
    ds_write_b32 v30, v18
    s_mov_b64 exec, -1
    v_lshrrev_b32 v31, 8, v19
    v_add_u32 v31, v31, v35
    v_and_or_b32 v19, v19, s54, v27
    v_lshl_add_u32 v31, v31, 2, s53
    s_mov_b64 exec, s[42:43]
    ds_write_b32 v31, v19
    s_mov_b64 exec, -1
    s_cmp_le_i32 s46, 0
    s_cbranch_scc1 L_16
    v_lshl_add_u32 v44, v43, 5, v37
    v_lshl_add_u32 v45, v43, 3, v38
    v_cmp_gt_i32 vcc, s46, v36
    s_lshl_b32 s76, s45, 5
    s_add_u32 m0, s76, 65536
    s_mov_b64 exec, vcc
    buffer_load_dwordx4 v44, s[24:27], 0 offen lds
    s_lshl3_add_u32 m0, s45, 98304
    s_cmp_eq_u32 s77, 0
    s_cbranch_scc1 L_17
    buffer_load_dword v45, s[20:23], 0 offen lds
L_17:
    s_mov_b64 exec, -1
    s_add_u32 s45, s45, 32
    s_sub_i32 s46, s46, 32
L_16:
L_paymore:
    s_cmp_le_i32 s46, 0
    s_cbranch_scc1 L_paydone
    ds_read_b32 v40, v39 offset:512
    v_add_u32 v39, 128, v39
    s_waitcnt lgkmcnt(0)
    s_cmp_le_i32 s46, 0
    s_cbranch_scc1 L_18
    v_lshl_add_u32 v44, v40, 5, v37
    v_lshl_add_u32 v45, v40, 3, v38
    v_cmp_gt_i32 vcc, s46, v36
    s_lshl_b32 s76, s45, 5
    s_add_u32 m0, s76, 65536
    s_mov_b64 exec, vcc
    buffer_load_dwordx4 v44, s[24:27], 0 offen lds
    s_lshl3_add_u32 m0, s45, 98304
    s_cmp_eq_u32 s77, 0
    s_cbranch_scc1 L_19
    buffer_load_dword v45, s[20:23], 0 offen lds
L_19:
    s_mov_b64 exec, -1
    s_add_u32 s45, s45, 32
    s_sub_i32 s46, s46, 32
L_18:
    s_branch L_paymore
L_paydone:
    s_lshl_b32 s61, s61, 2
    s_add_u32 s61, s61, 106496
    v_mov_b32 v13, s61
    v_and_b32 v62, 3, v1
    v_lshl_add_u32 v77, v62, 2, s61
    v_bfe_u32 v62, v1, 2, 2
    v_lshl_add_u32 v78, v62, 2, s61
    v_bfe_u32 v63, v1, 4, 1
    v_lshlrev_b32 v63, 4, v63
    v_add_u32 v63, 65536, v63
    v_mov_b32 v65, 98304
    v_mov_b32 v62, 119040
    v_cmp_ne_u32 vcc, 0, v7
    v_cmp_ne_u32 s[4:5], 0, v8
    v_cmp_ne_u32 s[6:7], 0, v10
    v_cndmask_b32 v74, v62, v63, vcc
    v_cndmask_b32 v75, v62, v63, s[4:5]
    v_cndmask_b32 v76, v62, v65, s[6:7]
    s_waitcnt lgkmcnt(0)
    s_barrier
    ds_read_b128 v[68:71], v13
    ds_read_b32 v72, v77
    ds_read_b32 v73, v78
    s_cmp_lt_u32 s62, 3
    s_cbranch_scc1 L_short
    s_waitcnt lgkmcnt(2)
    v_readfirstlane_b32 s64, v68
    v_readfirstlane_b32 s65, v69
    v_readfirstlane_b32 s66, v70
    v_readfirstlane_b32 s67, v71
    s_and_b32 s76, s64, s82
    s_add_u32 m0, s63, 0
    s_lshl_b32 s76, s76, 3
    buffer_load_dwordx4 v2, s[8:11], s76 offen lds
    buffer_load_dwordx4 v3, s[8:11], s76 offen offset:1024 lds
    s_and_b32 s76, s65, s82
    s_add_u32 m0, s63, 2048
    s_lshl_b32 s76, s76, 3
    buffer_load_dwordx4 v2, s[8:11], s76 offen lds
    buffer_load_dwordx4 v3, s[8:11], s76 offen offset:1024 lds
    s_and_b32 s76, s66, s82
    s_add_u32 m0, s63, 4096
    s_lshl_b32 s76, s76, 3
    buffer_load_dwordx4 v2, s[8:11], s76 offen lds
    buffer_load_dwordx4 v3, s[8:11], s76 offen offset:1024 lds
    s_waitcnt vmcnt(6)
    s_branch L_go
L_short:
    s_waitcnt vmcnt(0) lgkmcnt(0)
    v_readfirstlane_b32 s64, v68
    v_readfirstlane_b32 s65, v69
    v_readfirstlane_b32 s66, v70
    v_readfirstlane_b32 s67, v71
    s_cmp_le_u32 s62, 0
    s_cbranch_scc1 L_go
    s_and_b32 s76, s64, s82
    s_add_u32 m0, s63, 0
    s_lshl_b32 s76, s76, 3
    buffer_load_dwordx4 v2, s[8:11], s76 offen lds
    buffer_load_dwordx4 v3, s[8:11], s76 offen offset:1024 lds
    s_cmp_le_u32 s62, 1
    s_cbranch_scc1 L_go
    s_and_b32 s76, s65, s82
    s_add_u32 m0, s63, 2048
    s_lshl_b32 s76, s76, 3
    buffer_load_dwordx4 v2, s[8:11], s76 offen lds
    buffer_load_dwordx4 v3, s[8:11], s76 offen offset:1024 lds
L_go:
    s_cmp_ge_u32 s3, 2
    s_cbranch_scc1 L_20
    s_cmp_lg_u32 s77, 0
    s_cbranch_scc1 L_20
    v_mov_b32 v62, s83
    v_mov_b32 v63, s48
    s_mov_b64 exec, 1
    buffer_store_dword v63, v62, s[32:35], 0 offen sc1
    s_mov_b64 exec, -1
L_20:
    s_waitcnt lgkmcnt(0)
    v_lshrrev_b32 v72, 22, v72
    v_lshrrev_b32 v73, 22, v73
    v_mad_u32_u24 v5, v72, v7, v74
    v_mad_u32_u24 v6, v72, v8, v75
    v_mad_u32_u24 v9, v73, v10, v76
    s_barrier
    s_cmp_eq_u32 s62, 0
    s_cbranch_scc1 L_round_done
L_group:
    ds_read_b64 v[64:65], v9
    ds_read_b128 v[56:59], v5
    ds_read_b128 v[60:63], v6
    ds_read_b128 v[68:71], v13 offset:16
    ds_read_b32 v72, v77 offset:16
    ds_read_b32 v73, v78 offset:16
    v_add_u32 v13, 16, v13
    v_add_u32 v77, 16, v77
    v_add_u32 v78, 16, v78
    s_waitcnt lgkmcnt(0)
    v_mfma_f32_16x16x16_bf16 v[32:35], v[14:15], v[64:65], 0
    v_mfma_f32_16x16x32_bf16 v[16:19], v[56:59], a[0:3], 0
    v_mfma_f32_16x16x32_bf16 v[20:23], v[56:59], a[8:11], 0
    v_mfma_f32_16x16x32_bf16 v[24:27], v[56:59], a[16:19], 0
    v_mfma_f32_16x16x32_bf16 v[28:31], v[56:59], a[24:27], 0
    v_mfma_f32_16x16x32_bf16 v[16:19], v[60:63], a[4:7], v[16:19]
    v_mfma_f32_16x16x32_bf16 v[20:23], v[60:63], a[12:15], v[20:23]
    v_mfma_f32_16x16x32_bf16 v[24:27], v[60:63], a[20:23], v[24:27]
    v_mfma_f32_16x16x32_bf16 v[28:31], v[60:63], a[28:31], v[28:31]
    v_readfirstlane_b32 s68, v68
    v_readfirstlane_b32 s69, v69
    v_readfirstlane_b32 s70, v70
    v_readfirstlane_b32 s71, v71
    v_cvt_pk_bf16_f32 v64, v32, v33
    v_cvt_pk_bf16_f32 v65, v34, v35
    v_lshrrev_b32 v72, 22, v72
    v_lshrrev_b32 v73, 22, v73
    v_mad_u32_u24 v5, v72, v7, v74
    v_mad_u32_u24 v6, v72, v8, v75
    v_mad_u32_u24 v9, v73, v10, v76
    s_cmp_ge_u32 s62, 3
    s_cbranch_scc1 L_21
    s_waitcnt vmcnt(0)
L_21:
    s_waitcnt vmcnt(4)
    ds_read_b64_tr_b16 v[48:49], v4 offset:0
    ds_read_b64_tr_b16 v[50:51], v4 offset:256
    ds_read_b64_tr_b16 v[52:53], v4 offset:512
    ds_read_b64_tr_b16 v[54:55], v4 offset:768
    s_cmp_le_u32 s62, 3
    s_cbranch_scc1 L_22
    s_and_b32 s76, s67, s82
    s_add_u32 m0, s63, 6144
    s_lshl_b32 s76, s76, 3
    buffer_load_dwordx4 v2, s[8:11], s76 offen lds
    buffer_load_dwordx4 v3, s[8:11], s76 offen offset:1024 lds
L_22:
    s_waitcnt lgkmcnt(0)
    v_mfma_f32_4x4x4_16b_bf16 v[32:35], v[64:65], v[48:49], 0 cbsz:4 abid:0
    v_mfma_f32_4x4x4_16b_bf16 v[36:39], v[64:65], v[50:51], 0 cbsz:4 abid:0
    v_mfma_f32_4x4x4_16b_bf16 v[40:43], v[64:65], v[52:53], 0 cbsz:4 abid:0
    v_mfma_f32_4x4x4_16b_bf16 v[44:47], v[64:65], v[54:55], 0 cbsz:4 abid:0
    s_nop 0
    s_set_gpr_idx_on s64, gpr_idx(SRC2,DST)
    v_pk_fma_f32 v[80:81], v[32:33], v[16:17], v[80:81] op_sel:[0,0,0] op_sel_hi:[1,0,1]
    v_pk_fma_f32 v[82:83], v[34:35], v[16:17], v[82:83] op_sel:[0,0,0] op_sel_hi:[1,0,1]
    v_pk_fma_f32 v[84:85], v[36:37], v[20:21], v[84:85] op_sel:[0,0,0] op_sel_hi:[1,0,1]
    v_pk_fma_f32 v[86:87], v[38:39], v[20:21], v[86:87] op_sel:[0,0,0] op_sel_hi:[1,0,1]
    v_pk_fma_f32 v[88:89], v[40:41], v[24:25], v[88:89] op_sel:[0,0,0] op_sel_hi:[1,0,1]
    v_pk_fma_f32 v[90:91], v[42:43], v[24:25], v[90:91] op_sel:[0,0,0] op_sel_hi:[1,0,1]
    v_pk_fma_f32 v[92:93], v[44:45], v[28:29], v[92:93] op_sel:[0,0,0] op_sel_hi:[1,0,1]
    v_pk_fma_f32 v[94:95], v[46:47], v[28:29], v[94:95] op_sel:[0,0,0] op_sel_hi:[1,0,1]
    s_set_gpr_idx_off
    s_mov_b32 s64, s68
    s_sub_u32 s62, s62, 1
    s_cmp_eq_u32 s62, 0
    s_cbranch_scc1 L_round_done
    s_cmp_ge_u32 s62, 3
    s_cbranch_scc1 L_23
    s_waitcnt vmcnt(0)
L_23:
    s_waitcnt vmcnt(4)
    ds_read_b64_tr_b16 v[48:49], v4 offset:2048
    ds_read_b64_tr_b16 v[50:51], v4 offset:2304
    ds_read_b64_tr_b16 v[52:53], v4 offset:2560
    ds_read_b64_tr_b16 v[54:55], v4 offset:2816
    s_cmp_le_u32 s62, 3
    s_cbranch_scc1 L_24
    s_and_b32 s76, s68, s82
    s_add_u32 m0, s63, 0
    s_lshl_b32 s76, s76, 3
    buffer_load_dwordx4 v2, s[8:11], s76 offen lds
    buffer_load_dwordx4 v3, s[8:11], s76 offen offset:1024 lds
L_24:
    s_waitcnt lgkmcnt(0)
    v_mfma_f32_4x4x4_16b_bf16 v[32:35], v[64:65], v[48:49], 0 cbsz:4 abid:1
    v_mfma_f32_4x4x4_16b_bf16 v[36:39], v[64:65], v[50:51], 0 cbsz:4 abid:1
    v_mfma_f32_4x4x4_16b_bf16 v[40:43], v[64:65], v[52:53], 0 cbsz:4 abid:1
    v_mfma_f32_4x4x4_16b_bf16 v[44:47], v[64:65], v[54:55], 0 cbsz:4 abid:1
    s_nop 0
    s_set_gpr_idx_on s65, gpr_idx(SRC2,DST)
    v_pk_fma_f32 v[80:81], v[32:33], v[16:17], v[80:81] op_sel:[0,1,0] op_sel_hi:[1,1,1]
    v_pk_fma_f32 v[82:83], v[34:35], v[16:17], v[82:83] op_sel:[0,1,0] op_sel_hi:[1,1,1]
    v_pk_fma_f32 v[84:85], v[36:37], v[20:21], v[84:85] op_sel:[0,1,0] op_sel_hi:[1,1,1]
    v_pk_fma_f32 v[86:87], v[38:39], v[20:21], v[86:87] op_sel:[0,1,0] op_sel_hi:[1,1,1]
    v_pk_fma_f32 v[88:89], v[40:41], v[24:25], v[88:89] op_sel:[0,1,0] op_sel_hi:[1,1,1]
    v_pk_fma_f32 v[90:91], v[42:43], v[24:25], v[90:91] op_sel:[0,1,0] op_sel_hi:[1,1,1]
    v_pk_fma_f32 v[92:93], v[44:45], v[28:29], v[92:93] op_sel:[0,1,0] op_sel_hi:[1,1,1]
    v_pk_fma_f32 v[94:95], v[46:47], v[28:29], v[94:95] op_sel:[0,1,0] op_sel_hi:[1,1,1]
    s_set_gpr_idx_off
    s_mov_b32 s65, s69
    s_sub_u32 s62, s62, 1
    s_cmp_eq_u32 s62, 0
    s_cbranch_scc1 L_round_done
    s_cmp_ge_u32 s62, 3
    s_cbranch_scc1 L_25
    s_waitcnt vmcnt(0)
L_25:
    s_waitcnt vmcnt(4)
    ds_read_b64_tr_b16 v[48:49], v4 offset:4096
    ds_read_b64_tr_b16 v[50:51], v4 offset:4352
    ds_read_b64_tr_b16 v[52:53], v4 offset:4608
    ds_read_b64_tr_b16 v[54:55], v4 offset:4864
    s_cmp_le_u32 s62, 3
    s_cbranch_scc1 L_26
    s_and_b32 s76, s69, s82
    s_add_u32 m0, s63, 2048
    s_lshl_b32 s76, s76, 3
    buffer_load_dwordx4 v2, s[8:11], s76 offen lds
    buffer_load_dwordx4 v3, s[8:11], s76 offen offset:1024 lds
L_26:
    s_waitcnt lgkmcnt(0)
    v_mfma_f32_4x4x4_16b_bf16 v[32:35], v[64:65], v[48:49], 0 cbsz:4 abid:2
    v_mfma_f32_4x4x4_16b_bf16 v[36:39], v[64:65], v[50:51], 0 cbsz:4 abid:2
    v_mfma_f32_4x4x4_16b_bf16 v[40:43], v[64:65], v[52:53], 0 cbsz:4 abid:2
    v_mfma_f32_4x4x4_16b_bf16 v[44:47], v[64:65], v[54:55], 0 cbsz:4 abid:2
    s_nop 0
    s_set_gpr_idx_on s66, gpr_idx(SRC2,DST)
    v_pk_fma_f32 v[80:81], v[32:33], v[18:19], v[80:81] op_sel:[0,0,0] op_sel_hi:[1,0,1]
    v_pk_fma_f32 v[82:83], v[34:35], v[18:19], v[82:83] op_sel:[0,0,0] op_sel_hi:[1,0,1]
    v_pk_fma_f32 v[84:85], v[36:37], v[22:23], v[84:85] op_sel:[0,0,0] op_sel_hi:[1,0,1]
    v_pk_fma_f32 v[86:87], v[38:39], v[22:23], v[86:87] op_sel:[0,0,0] op_sel_hi:[1,0,1]
    v_pk_fma_f32 v[88:89], v[40:41], v[26:27], v[88:89] op_sel:[0,0,0] op_sel_hi:[1,0,1]
    v_pk_fma_f32 v[90:91], v[42:43], v[26:27], v[90:91] op_sel:[0,0,0] op_sel_hi:[1,0,1]
    v_pk_fma_f32 v[92:93], v[44:45], v[30:31], v[92:93] op_sel:[0,0,0] op_sel_hi:[1,0,1]
    v_pk_fma_f32 v[94:95], v[46:47], v[30:31], v[94:95] op_sel:[0,0,0] op_sel_hi:[1,0,1]
    s_set_gpr_idx_off
    s_mov_b32 s66, s70
    s_sub_u32 s62, s62, 1
    s_cmp_eq_u32 s62, 0
    s_cbranch_scc1 L_round_done
    s_cmp_ge_u32 s62, 3
    s_cbranch_scc1 L_27
    s_waitcnt vmcnt(0)
L_27:
    s_waitcnt vmcnt(4)
    ds_read_b64_tr_b16 v[48:49], v4 offset:6144
    ds_read_b64_tr_b16 v[50:51], v4 offset:6400
    ds_read_b64_tr_b16 v[52:53], v4 offset:6656
    ds_read_b64_tr_b16 v[54:55], v4 offset:6912
    s_cmp_le_u32 s62, 3
    s_cbranch_scc1 L_28
    s_and_b32 s76, s70, s82
    s_add_u32 m0, s63, 4096
    s_lshl_b32 s76, s76, 3
    buffer_load_dwordx4 v2, s[8:11], s76 offen lds
    buffer_load_dwordx4 v3, s[8:11], s76 offen offset:1024 lds
L_28:
    s_waitcnt lgkmcnt(0)
    v_mfma_f32_4x4x4_16b_bf16 v[32:35], v[64:65], v[48:49], 0 cbsz:4 abid:3
    v_mfma_f32_4x4x4_16b_bf16 v[36:39], v[64:65], v[50:51], 0 cbsz:4 abid:3
    v_mfma_f32_4x4x4_16b_bf16 v[40:43], v[64:65], v[52:53], 0 cbsz:4 abid:3
    v_mfma_f32_4x4x4_16b_bf16 v[44:47], v[64:65], v[54:55], 0 cbsz:4 abid:3
    s_nop 0
    s_set_gpr_idx_on s67, gpr_idx(SRC2,DST)
    v_pk_fma_f32 v[80:81], v[32:33], v[18:19], v[80:81] op_sel:[0,1,0] op_sel_hi:[1,1,1]
    v_pk_fma_f32 v[82:83], v[34:35], v[18:19], v[82:83] op_sel:[0,1,0] op_sel_hi:[1,1,1]
    v_pk_fma_f32 v[84:85], v[36:37], v[22:23], v[84:85] op_sel:[0,1,0] op_sel_hi:[1,1,1]
    v_pk_fma_f32 v[86:87], v[38:39], v[22:23], v[86:87] op_sel:[0,1,0] op_sel_hi:[1,1,1]
    v_pk_fma_f32 v[88:89], v[40:41], v[26:27], v[88:89] op_sel:[0,1,0] op_sel_hi:[1,1,1]
    v_pk_fma_f32 v[90:91], v[42:43], v[26:27], v[90:91] op_sel:[0,1,0] op_sel_hi:[1,1,1]
    v_pk_fma_f32 v[92:93], v[44:45], v[30:31], v[92:93] op_sel:[0,1,0] op_sel_hi:[1,1,1]
    v_pk_fma_f32 v[94:95], v[46:47], v[30:31], v[94:95] op_sel:[0,1,0] op_sel_hi:[1,1,1]
    s_set_gpr_idx_off
    s_mov_b32 s67, s71
    s_sub_u32 s62, s62, 1
    s_cmp_eq_u32 s62, 0
    s_cbranch_scc0 L_group
L_round_done:
    s_add_u32 s77, s77, 1
    s_cmp_lg_u32 s78, 0
    s_cbranch_scc1 L_scan
    s_and_b32 s54, s2, 192
    s_lshl_b32 s54, s54, 1
    s_lshl4_add_u32 s54, s3, s54
    s_lshl2_add_u32 s53, s54, 4096
    v_and_b32 v16, 15, v1
    v_lshl_add_u32 v16, v16, 2, s53
    s_lshl_b32 s53, s54, 10
    s_add_u32 s53, s53, 1048576
    v_lshl_add_u32 v18, v1, 4, s53
    s_mov_b32 s55, 0
L_pollw:
    buffer_load_dword v17, v16, s[32:35], 0 offen sc1
    s_waitcnt vmcnt(0)
    v_cmp_ne_u32 vcc, s48, v17
    s_cbranch_vccz L_gotw
    s_sleep 1
    s_add_u32 s55, s55, 1
    s_cmp_lt_u32 s55, 0x400000
    s_cbranch_scc1 L_pollw
L_gotw:
    buffer_load_dwordx4 a[32:35], v18, s[32:35], 0 offen offset:0 sc1
    buffer_load_dwordx4 a[36:39], v18, s[32:35], 0 offen offset:1024 sc1
    buffer_load_dwordx4 a[40:43], v18, s[32:35], 0 offen offset:2048 sc1
    buffer_load_dwordx4 a[44:47], v18, s[32:35], 0 offen offset:3072 sc1
    v_add_u32 v18, 4096, v18
    buffer_load_dwordx4 a[48:51], v18, s[32:35], 0 offen offset:0 sc1
    buffer_load_dwordx4 a[52:55], v18, s[32:35], 0 offen offset:1024 sc1
    buffer_load_dwordx4 a[56:59], v18, s[32:35], 0 offen offset:2048 sc1
    buffer_load_dwordx4 a[60:63], v18, s[32:35], 0 offen offset:3072 sc1
    v_add_u32 v18, 4096, v18
    buffer_load_dwordx4 a[64:67], v18, s[32:35], 0 offen offset:0 sc1
    buffer_load_dwordx4 a[68:71], v18, s[32:35], 0 offen offset:1024 sc1
    buffer_load_dwordx4 a[72:75], v18, s[32:35], 0 offen offset:2048 sc1
    buffer_load_dwordx4 a[76:79], v18, s[32:35], 0 offen offset:3072 sc1
    v_add_u32 v18, 4096, v18
    buffer_load_dwordx4 a[80:83], v18, s[32:35], 0 offen offset:0 sc1
    buffer_load_dwordx4 a[84:87], v18, s[32:35], 0 offen offset:1024 sc1
    buffer_load_dwordx4 a[88:91], v18, s[32:35], 0 offen offset:2048 sc1
    buffer_load_dwordx4 a[92:95], v18, s[32:35], 0 offen offset:3072 sc1
    v_add_u32 v18, 4096, v18
    v_mul_u32_u24 v16, 320, v1
    v_lshrrev_b32 v17, 2, v1
    v_lshl_add_u32 v16, v17, 3, v16
    s_lshl_b32 s53, s56, 3
    v_add_u32 v17, s53, v16
    s_lshl_b32 s53, s57, 3
    v_add_u32 v18, s53, v16
    s_lshl_b32 s53, s58, 3
    v_add_u32 v19, s53, v16
    s_lshl_b32 s53, s59, 3
    v_add_u32 v20, s53, v16
    s_lshl_b32 s53, s60, 3
    v_add_u32 v21, s53, v16
    v_cvt_pk_bf16_f32 v24, v80, v81
    v_cvt_pk_bf16_f32 v25, v82, v83
    v_cvt_pk_bf16_f32 v26, v84, v85
    v_cvt_pk_bf16_f32 v27, v86, v87
    v_cvt_pk_bf16_f32 v28, v88, v89
    v_cvt_pk_bf16_f32 v29, v90, v91
    v_cvt_pk_bf16_f32 v30, v92, v93
    v_cvt_pk_bf16_f32 v31, v94, v95
    v_cvt_pk_bf16_f32 v32, v96, v97
    v_cvt_pk_bf16_f32 v33, v98, v99
    v_cvt_pk_bf16_f32 v34, v100, v101
    v_cvt_pk_bf16_f32 v35, v102, v103
    v_cvt_pk_bf16_f32 v36, v104, v105
    v_cvt_pk_bf16_f32 v37, v106, v107
    v_cvt_pk_bf16_f32 v38, v108, v109
    v_cvt_pk_bf16_f32 v39, v110, v111
    v_cvt_pk_bf16_f32 v40, v112, v113
    v_cvt_pk_bf16_f32 v41, v114, v115
    v_cvt_pk_bf16_f32 v42, v116, v117
    v_cvt_pk_bf16_f32 v43, v118, v119
    v_cvt_pk_bf16_f32 v44, v120, v121
    v_cvt_pk_bf16_f32 v45, v122, v123
    v_cvt_pk_bf16_f32 v46, v124, v125
    v_cvt_pk_bf16_f32 v47, v126, v127
    v_cvt_pk_bf16_f32 v48, v128, v129
    v_cvt_pk_bf16_f32 v49, v130, v131
    v_cvt_pk_bf16_f32 v50, v132, v133
    v_cvt_pk_bf16_f32 v51, v134, v135
    v_cvt_pk_bf16_f32 v52, v136, v137
    v_cvt_pk_bf16_f32 v53, v138, v139
    v_cvt_pk_bf16_f32 v54, v140, v141
    v_cvt_pk_bf16_f32 v55, v142, v143
    v_cvt_pk_bf16_f32 v56, v144, v145
    v_cvt_pk_bf16_f32 v57, v146, v147
    v_cvt_pk_bf16_f32 v58, v148, v149
    v_cvt_pk_bf16_f32 v59, v150, v151
    v_cvt_pk_bf16_f32 v60, v152, v153
    v_cvt_pk_bf16_f32 v61, v154, v155
    v_cvt_pk_bf16_f32 v62, v156, v157
    v_cvt_pk_bf16_f32 v63, v158, v159
    v_lshrrev_b32 v70, 5, v1
    v_mul_u32_u24 v71, 2576, v70
    v_bfe_u32 v72, v1, 2, 2
    v_mul_u32_u24 v74, 320, v72
    v_bfe_u32 v73, v1, 4, 1
    v_lshl_add_u32 v71, v73, 5, v71
    v_and_b32 v73, 3, v1
    v_lshl_add_u32 v71, v73, 3, v71
    v_add_u32 v2, v71, v74
    v_add_u32 v3, 41216, v2
    s_mul_i32 s53, s3, 5120
    s_add_u32 s53, s53, 82432
    v_and_b32 v74, 31, v1
    v_mul_u32_u24 v74, 80, v74
    v_lshl_add_u32 v74, v70, 3, v74
    v_add_u32 v5, s53, v74
    v_lshrrev_b32 v74, 2, v1
    v_mul_u32_u24 v74, 80, v74
    v_lshl_add_u32 v74, v73, 4, v74
    v_add_u32 v6, s53, v74
    v_lshrrev_b32 v74, 4, v1
    v_lshlrev_b32 v74, 19, v74
    v_lshl_add_u32 v74, v72, 9, v74
    v_lshl_add_u32 v74, v73, 4, v74
    s_lshl_b32 s53, s2, 11
    s_lshl_b32 s54, s3, 6
    s_add_u32 s53, s53, s54
    v_add_u32 v4, s53, v74
    s_barrier
    ds_write_b64 v17, v[24:25] offset:0
    ds_write_b64 v17, v[26:27] offset:20608
    ds_write_b64 v17, v[28:29] offset:41216
    ds_write_b64 v17, v[30:31] offset:61824
    ds_write_b64 v18, v[32:33] offset:0
    ds_write_b64 v18, v[34:35] offset:20608
    ds_write_b64 v18, v[36:37] offset:41216
    ds_write_b64 v18, v[38:39] offset:61824
    ds_write_b64 v19, v[40:41] offset:0
    ds_write_b64 v19, v[42:43] offset:20608
    ds_write_b64 v19, v[44:45] offset:41216
    ds_write_b64 v19, v[46:47] offset:61824
    ds_write_b64 v20, v[48:49] offset:0
    ds_write_b64 v20, v[50:51] offset:20608
    ds_write_b64 v20, v[52:53] offset:41216
    ds_write_b64 v20, v[54:55] offset:61824
    ds_write_b64 v21, v[56:57] offset:0
    ds_write_b64 v21, v[58:59] offset:20608
    ds_write_b64 v21, v[60:61] offset:41216
    ds_write_b64 v21, v[62:63] offset:61824
    s_waitcnt lgkmcnt(0)
    s_barrier
    ds_read_b64_tr_b16 v[16:17], v2 offset:0
    ds_read_b64_tr_b16 v[18:19], v2 offset:1288
    ds_read_b64_tr_b16 v[20:21], v2 offset:5152
    ds_read_b64_tr_b16 v[22:23], v2 offset:6440
    ds_read_b64_tr_b16 v[24:25], v2 offset:10304
    ds_read_b64_tr_b16 v[26:27], v2 offset:11592
    ds_read_b64_tr_b16 v[28:29], v2 offset:15456
    ds_read_b64_tr_b16 v[30:31], v2 offset:16744
    ds_read_b64_tr_b16 v[32:33], v2 offset:20608
    ds_read_b64_tr_b16 v[34:35], v2 offset:21896
    ds_read_b64_tr_b16 v[36:37], v2 offset:25760
    ds_read_b64_tr_b16 v[38:39], v2 offset:27048
    s_waitcnt vmcnt(0)
    s_waitcnt lgkmcnt(10)
    v_mfma_f32_32x32x16_bf16 v[48:63], a[32:35], v[16:19], 0
    ds_read_b64_tr_b16 v[40:41], v2 offset:30912
    ds_read_b64_tr_b16 v[42:43], v2 offset:32200
    s_waitcnt lgkmcnt(10)
    v_mfma_f32_32x32x16_bf16 v[48:63], a[36:39], v[20:23], v[48:63]
    ds_read_b64_tr_b16 v[44:45], v2 offset:36064
    ds_read_b64_tr_b16 v[46:47], v2 offset:37352
    s_waitcnt lgkmcnt(10)
    v_mfma_f32_32x32x16_bf16 v[48:63], a[40:43], v[24:27], v[48:63]
    ds_read_b64_tr_b16 v[16:17], v3 offset:0
    ds_read_b64_tr_b16 v[18:19], v3 offset:1288
    s_waitcnt lgkmcnt(10)
    v_mfma_f32_32x32x16_bf16 v[48:63], a[44:47], v[28:31], v[48:63]
    ds_read_b64_tr_b16 v[20:21], v3 offset:5152
    ds_read_b64_tr_b16 v[22:23], v3 offset:6440
    s_waitcnt lgkmcnt(10)
    v_mfma_f32_32x32x16_bf16 v[48:63], a[48:51], v[32:35], v[48:63]
    ds_read_b64_tr_b16 v[24:25], v3 offset:10304
    ds_read_b64_tr_b16 v[26:27], v3 offset:11592
    s_waitcnt lgkmcnt(10)
    v_mfma_f32_32x32x16_bf16 v[48:63], a[52:55], v[36:39], v[48:63]
    ds_read_b64_tr_b16 v[28:29], v3 offset:15456
    ds_read_b64_tr_b16 v[30:31], v3 offset:16744
    s_waitcnt lgkmcnt(10)
    v_mfma_f32_32x32x16_bf16 v[48:63], a[56:59], v[40:43], v[48:63]
    ds_read_b64_tr_b16 v[32:33], v3 offset:20608
    ds_read_b64_tr_b16 v[34:35], v3 offset:21896
    s_waitcnt lgkmcnt(10)
    v_mfma_f32_32x32x16_bf16 v[48:63], a[60:63], v[44:47], v[48:63]
    ds_read_b64_tr_b16 v[36:37], v3 offset:25760
    ds_read_b64_tr_b16 v[38:39], v3 offset:27048
    s_waitcnt lgkmcnt(10)
    v_mfma_f32_32x32x16_bf16 v[48:63], a[64:67], v[16:19], v[48:63]
    ds_read_b64_tr_b16 v[40:41], v3 offset:30912
    ds_read_b64_tr_b16 v[42:43], v3 offset:32200
    s_waitcnt lgkmcnt(10)
    v_mfma_f32_32x32x16_bf16 v[48:63], a[68:71], v[20:23], v[48:63]
    ds_read_b64_tr_b16 v[44:45], v3 offset:36064
    ds_read_b64_tr_b16 v[46:47], v3 offset:37352
    s_waitcnt lgkmcnt(10)
    v_mfma_f32_32x32x16_bf16 v[48:63], a[72:75], v[24:27], v[48:63]
    ds_read_b64_tr_b16 v[16:17], v2 offset:64
    ds_read_b64_tr_b16 v[18:19], v2 offset:1352
    s_waitcnt lgkmcnt(10)
    v_mfma_f32_32x32x16_bf16 v[48:63], a[76:79], v[28:31], v[48:63]
    ds_read_b64_tr_b16 v[20:21], v2 offset:5216
    ds_read_b64_tr_b16 v[22:23], v2 offset:6504
    s_waitcnt lgkmcnt(10)
    v_mfma_f32_32x32x16_bf16 v[48:63], a[80:83], v[32:35], v[48:63]
    ds_read_b64_tr_b16 v[24:25], v2 offset:10368
    ds_read_b64_tr_b16 v[26:27], v2 offset:11656
    s_waitcnt lgkmcnt(10)
    v_mfma_f32_32x32x16_bf16 v[48:63], a[84:87], v[36:39], v[48:63]
    ds_read_b64_tr_b16 v[28:29], v2 offset:15520
    ds_read_b64_tr_b16 v[30:31], v2 offset:16808
    s_waitcnt lgkmcnt(10)
    v_mfma_f32_32x32x16_bf16 v[48:63], a[88:91], v[40:43], v[48:63]
    ds_read_b64_tr_b16 v[32:33], v2 offset:20672
    ds_read_b64_tr_b16 v[34:35], v2 offset:21960
    s_waitcnt lgkmcnt(10)
    v_mfma_f32_32x32x16_bf16 v[48:63], a[92:95], v[44:47], v[48:63]
    ds_read_b64_tr_b16 v[36:37], v2 offset:25824
    ds_read_b64_tr_b16 v[38:39], v2 offset:27112
    s_waitcnt lgkmcnt(10)
    v_mfma_f32_32x32x16_bf16 v[64:79], a[32:35], v[16:19], 0
    ds_read_b64_tr_b16 v[40:41], v2 offset:30976
    ds_read_b64_tr_b16 v[42:43], v2 offset:32264
    s_waitcnt lgkmcnt(10)
    v_mfma_f32_32x32x16_bf16 v[64:79], a[36:39], v[20:23], v[64:79]
    ds_read_b64_tr_b16 v[44:45], v2 offset:36128
    ds_read_b64_tr_b16 v[46:47], v2 offset:37416
    s_waitcnt lgkmcnt(10)
    v_mfma_f32_32x32x16_bf16 v[64:79], a[40:43], v[24:27], v[64:79]
    ds_read_b64_tr_b16 v[16:17], v3 offset:64
    ds_read_b64_tr_b16 v[18:19], v3 offset:1352
    s_waitcnt lgkmcnt(10)
    v_mfma_f32_32x32x16_bf16 v[64:79], a[44:47], v[28:31], v[64:79]
    ds_read_b64_tr_b16 v[20:21], v3 offset:5216
    ds_read_b64_tr_b16 v[22:23], v3 offset:6504
    v_cvt_pk_bf16_f32 v80, v48, v49
    v_cvt_pk_bf16_f32 v81, v50, v51
    ds_write_b64 v5, v[80:81] offset:0
    s_waitcnt lgkmcnt(10)
    v_mfma_f32_32x32x16_bf16 v[64:79], a[48:51], v[32:35], v[64:79]
    ds_read_b64_tr_b16 v[24:25], v3 offset:10368
    ds_read_b64_tr_b16 v[26:27], v3 offset:11656
    v_cvt_pk_bf16_f32 v82, v52, v53
    v_cvt_pk_bf16_f32 v83, v54, v55
    ds_write_b64 v5, v[82:83] offset:16
    s_waitcnt lgkmcnt(10)
    v_mfma_f32_32x32x16_bf16 v[64:79], a[52:55], v[36:39], v[64:79]
    ds_read_b64_tr_b16 v[28:29], v3 offset:15520
    ds_read_b64_tr_b16 v[30:31], v3 offset:16808
    v_cvt_pk_bf16_f32 v84, v56, v57
    v_cvt_pk_bf16_f32 v85, v58, v59
    ds_write_b64 v5, v[84:85] offset:32
    s_waitcnt lgkmcnt(10)
    v_mfma_f32_32x32x16_bf16 v[64:79], a[56:59], v[40:43], v[64:79]
    ds_read_b64_tr_b16 v[32:33], v3 offset:20672
    ds_read_b64_tr_b16 v[34:35], v3 offset:21960
    v_cvt_pk_bf16_f32 v86, v60, v61
    v_cvt_pk_bf16_f32 v87, v62, v63
    ds_write_b64 v5, v[86:87] offset:48
    s_waitcnt lgkmcnt(10)
    v_mfma_f32_32x32x16_bf16 v[64:79], a[60:63], v[44:47], v[64:79]
    ds_read_b64_tr_b16 v[36:37], v3 offset:25824
    ds_read_b64_tr_b16 v[38:39], v3 offset:27112
    ds_read_b128 v[96:99], v6 offset:0
    s_waitcnt lgkmcnt(10)
    v_mfma_f32_32x32x16_bf16 v[64:79], a[64:67], v[16:19], v[64:79]
    ds_read_b64_tr_b16 v[40:41], v3 offset:30976
    ds_read_b64_tr_b16 v[42:43], v3 offset:32264
    ds_read_b128 v[100:103], v6 offset:1280
    s_waitcnt lgkmcnt(10)
    v_mfma_f32_32x32x16_bf16 v[64:79], a[68:71], v[20:23], v[64:79]
    ds_read_b64_tr_b16 v[44:45], v3 offset:36128
    ds_read_b64_tr_b16 v[46:47], v3 offset:37416
    s_waitcnt lgkmcnt(10)
    v_mfma_f32_32x32x16_bf16 v[64:79], a[72:75], v[24:27], v[64:79]
    ds_read_b64_tr_b16 v[16:17], v2 offset:128
    ds_read_b64_tr_b16 v[18:19], v2 offset:1416
    s_waitcnt lgkmcnt(10)
    v_mfma_f32_32x32x16_bf16 v[64:79], a[76:79], v[28:31], v[64:79]
    ds_read_b64_tr_b16 v[20:21], v2 offset:5280
    ds_read_b64_tr_b16 v[22:23], v2 offset:6568
    s_waitcnt lgkmcnt(10)
    v_mfma_f32_32x32x16_bf16 v[64:79], a[80:83], v[32:35], v[64:79]
    ds_read_b64_tr_b16 v[24:25], v2 offset:10432
    ds_read_b64_tr_b16 v[26:27], v2 offset:11720
    s_waitcnt lgkmcnt(10)
    v_mfma_f32_32x32x16_bf16 v[64:79], a[84:87], v[36:39], v[64:79]
    ds_read_b64_tr_b16 v[28:29], v2 offset:15584
    ds_read_b64_tr_b16 v[30:31], v2 offset:16872
    s_waitcnt lgkmcnt(10)
    v_mfma_f32_32x32x16_bf16 v[64:79], a[88:91], v[40:43], v[64:79]
    ds_read_b64_tr_b16 v[32:33], v2 offset:20736
    ds_read_b64_tr_b16 v[34:35], v2 offset:22024
    s_waitcnt lgkmcnt(10)
    v_mfma_f32_32x32x16_bf16 v[64:79], a[92:95], v[44:47], v[64:79]
    ds_read_b64_tr_b16 v[36:37], v2 offset:25888
    ds_read_b64_tr_b16 v[38:39], v2 offset:27176
    buffer_store_dwordx4 v[96:99], v4, s[28:31], 0 offen sc1
    v_add_u32 v4, 2097152, v4
    buffer_store_dwordx4 v[100:103], v4, s[28:31], 0 offen sc1
    v_add_u32 v4, 2097152, v4
    s_waitcnt lgkmcnt(10)
    v_mfma_f32_32x32x16_bf16 v[48:63], a[32:35], v[16:19], 0
    ds_read_b64_tr_b16 v[40:41], v2 offset:31040
    ds_read_b64_tr_b16 v[42:43], v2 offset:32328
    s_waitcnt lgkmcnt(10)
    v_mfma_f32_32x32x16_bf16 v[48:63], a[36:39], v[20:23], v[48:63]
    ds_read_b64_tr_b16 v[44:45], v2 offset:36192
    ds_read_b64_tr_b16 v[46:47], v2 offset:37480
    s_waitcnt lgkmcnt(10)
    v_mfma_f32_32x32x16_bf16 v[48:63], a[40:43], v[24:27], v[48:63]
    ds_read_b64_tr_b16 v[16:17], v3 offset:128
    ds_read_b64_tr_b16 v[18:19], v3 offset:1416
    s_waitcnt lgkmcnt(10)
    v_mfma_f32_32x32x16_bf16 v[48:63], a[44:47], v[28:31], v[48:63]
    ds_read_b64_tr_b16 v[20:21], v3 offset:5280
    ds_read_b64_tr_b16 v[22:23], v3 offset:6568
    v_cvt_pk_bf16_f32 v88, v64, v65
    v_cvt_pk_bf16_f32 v89, v66, v67
    ds_write_b64 v5, v[88:89] offset:2560
    s_waitcnt lgkmcnt(10)
    v_mfma_f32_32x32x16_bf16 v[48:63], a[48:51], v[32:35], v[48:63]
    ds_read_b64_tr_b16 v[24:25], v3 offset:10432
    ds_read_b64_tr_b16 v[26:27], v3 offset:11720
    v_cvt_pk_bf16_f32 v90, v68, v69
    v_cvt_pk_bf16_f32 v91, v70, v71
    ds_write_b64 v5, v[90:91] offset:2576
    s_waitcnt lgkmcnt(10)
    v_mfma_f32_32x32x16_bf16 v[48:63], a[52:55], v[36:39], v[48:63]
    ds_read_b64_tr_b16 v[28:29], v3 offset:15584
    ds_read_b64_tr_b16 v[30:31], v3 offset:16872
    v_cvt_pk_bf16_f32 v92, v72, v73
    v_cvt_pk_bf16_f32 v93, v74, v75
    ds_write_b64 v5, v[92:93] offset:2592
    s_waitcnt lgkmcnt(10)
    v_mfma_f32_32x32x16_bf16 v[48:63], a[56:59], v[40:43], v[48:63]
    ds_read_b64_tr_b16 v[32:33], v3 offset:20736
    ds_read_b64_tr_b16 v[34:35], v3 offset:22024
    v_cvt_pk_bf16_f32 v94, v76, v77
    v_cvt_pk_bf16_f32 v95, v78, v79
    ds_write_b64 v5, v[94:95] offset:2608
    s_waitcnt lgkmcnt(10)
    v_mfma_f32_32x32x16_bf16 v[48:63], a[60:63], v[44:47], v[48:63]
    ds_read_b64_tr_b16 v[36:37], v3 offset:25888
    ds_read_b64_tr_b16 v[38:39], v3 offset:27176
    ds_read_b128 v[104:107], v6 offset:2560
    s_waitcnt lgkmcnt(10)
    v_mfma_f32_32x32x16_bf16 v[48:63], a[64:67], v[16:19], v[48:63]
    ds_read_b64_tr_b16 v[40:41], v3 offset:31040
    ds_read_b64_tr_b16 v[42:43], v3 offset:32328
    ds_read_b128 v[108:111], v6 offset:3840
    s_waitcnt lgkmcnt(10)
    v_mfma_f32_32x32x16_bf16 v[48:63], a[68:71], v[20:23], v[48:63]
    ds_read_b64_tr_b16 v[44:45], v3 offset:36192
    ds_read_b64_tr_b16 v[46:47], v3 offset:37480
    s_waitcnt lgkmcnt(10)
    v_mfma_f32_32x32x16_bf16 v[48:63], a[72:75], v[24:27], v[48:63]
    ds_read_b64_tr_b16 v[16:17], v2 offset:192
    ds_read_b64_tr_b16 v[18:19], v2 offset:1480
    s_waitcnt lgkmcnt(10)
    v_mfma_f32_32x32x16_bf16 v[48:63], a[76:79], v[28:31], v[48:63]
    ds_read_b64_tr_b16 v[20:21], v2 offset:5344
    ds_read_b64_tr_b16 v[22:23], v2 offset:6632
    s_waitcnt lgkmcnt(10)
    v_mfma_f32_32x32x16_bf16 v[48:63], a[80:83], v[32:35], v[48:63]
    ds_read_b64_tr_b16 v[24:25], v2 offset:10496
    ds_read_b64_tr_b16 v[26:27], v2 offset:11784
    s_waitcnt lgkmcnt(10)
    v_mfma_f32_32x32x16_bf16 v[48:63], a[84:87], v[36:39], v[48:63]
    ds_read_b64_tr_b16 v[28:29], v2 offset:15648
    ds_read_b64_tr_b16 v[30:31], v2 offset:16936
    s_waitcnt lgkmcnt(10)
    v_mfma_f32_32x32x16_bf16 v[48:63], a[88:91], v[40:43], v[48:63]
    ds_read_b64_tr_b16 v[32:33], v2 offset:20800
    ds_read_b64_tr_b16 v[34:35], v2 offset:22088
    s_waitcnt lgkmcnt(10)
    v_mfma_f32_32x32x16_bf16 v[48:63], a[92:95], v[44:47], v[48:63]
    ds_read_b64_tr_b16 v[36:37], v2 offset:25952
    ds_read_b64_tr_b16 v[38:39], v2 offset:27240
    buffer_store_dwordx4 v[104:107], v4, s[28:31], 0 offen sc1
    v_add_u32 v4, 2097152, v4
    buffer_store_dwordx4 v[108:111], v4, s[28:31], 0 offen sc1
    v_add_u32 v4, 2097152, v4
    s_waitcnt lgkmcnt(10)
    v_mfma_f32_32x32x16_bf16 v[64:79], a[32:35], v[16:19], 0
    ds_read_b64_tr_b16 v[40:41], v2 offset:31104
    ds_read_b64_tr_b16 v[42:43], v2 offset:32392
    s_waitcnt lgkmcnt(10)
    v_mfma_f32_32x32x16_bf16 v[64:79], a[36:39], v[20:23], v[64:79]
    ds_read_b64_tr_b16 v[44:45], v2 offset:36256
    ds_read_b64_tr_b16 v[46:47], v2 offset:37544
    s_waitcnt lgkmcnt(10)
    v_mfma_f32_32x32x16_bf16 v[64:79], a[40:43], v[24:27], v[64:79]
    ds_read_b64_tr_b16 v[16:17], v3 offset:192
    ds_read_b64_tr_b16 v[18:19], v3 offset:1480
    s_waitcnt lgkmcnt(10)
    v_mfma_f32_32x32x16_bf16 v[64:79], a[44:47], v[28:31], v[64:79]
    ds_read_b64_tr_b16 v[20:21], v3 offset:5344
    ds_read_b64_tr_b16 v[22:23], v3 offset:6632
    v_cvt_pk_bf16_f32 v80, v48, v49
    v_cvt_pk_bf16_f32 v81, v50, v51
    ds_write_b64 v5, v[80:81] offset:0
    s_waitcnt lgkmcnt(10)
    v_mfma_f32_32x32x16_bf16 v[64:79], a[48:51], v[32:35], v[64:79]
    ds_read_b64_tr_b16 v[24:25], v3 offset:10496
    ds_read_b64_tr_b16 v[26:27], v3 offset:11784
    v_cvt_pk_bf16_f32 v82, v52, v53
    v_cvt_pk_bf16_f32 v83, v54, v55
    ds_write_b64 v5, v[82:83] offset:16
    s_waitcnt lgkmcnt(10)
    v_mfma_f32_32x32x16_bf16 v[64:79], a[52:55], v[36:39], v[64:79]
    ds_read_b64_tr_b16 v[28:29], v3 offset:15648
    ds_read_b64_tr_b16 v[30:31], v3 offset:16936
    v_cvt_pk_bf16_f32 v84, v56, v57
    v_cvt_pk_bf16_f32 v85, v58, v59
    ds_write_b64 v5, v[84:85] offset:32
    s_waitcnt lgkmcnt(10)
    v_mfma_f32_32x32x16_bf16 v[64:79], a[56:59], v[40:43], v[64:79]
    ds_read_b64_tr_b16 v[32:33], v3 offset:20800
    ds_read_b64_tr_b16 v[34:35], v3 offset:22088
    v_cvt_pk_bf16_f32 v86, v60, v61
    v_cvt_pk_bf16_f32 v87, v62, v63
    ds_write_b64 v5, v[86:87] offset:48
    s_waitcnt lgkmcnt(10)
    v_mfma_f32_32x32x16_bf16 v[64:79], a[60:63], v[44:47], v[64:79]
    ds_read_b64_tr_b16 v[36:37], v3 offset:25952
    ds_read_b64_tr_b16 v[38:39], v3 offset:27240
    ds_read_b128 v[96:99], v6 offset:0
    s_waitcnt lgkmcnt(10)
    v_mfma_f32_32x32x16_bf16 v[64:79], a[64:67], v[16:19], v[64:79]
    ds_read_b64_tr_b16 v[40:41], v3 offset:31104
    ds_read_b64_tr_b16 v[42:43], v3 offset:32392
    ds_read_b128 v[100:103], v6 offset:1280
    s_waitcnt lgkmcnt(10)
    v_mfma_f32_32x32x16_bf16 v[64:79], a[68:71], v[20:23], v[64:79]
    ds_read_b64_tr_b16 v[44:45], v3 offset:36256
    ds_read_b64_tr_b16 v[46:47], v3 offset:37544
    s_waitcnt lgkmcnt(10)
    v_mfma_f32_32x32x16_bf16 v[64:79], a[72:75], v[24:27], v[64:79]
    ds_read_b64_tr_b16 v[16:17], v2 offset:256
    ds_read_b64_tr_b16 v[18:19], v2 offset:1544
    s_waitcnt lgkmcnt(10)
    v_mfma_f32_32x32x16_bf16 v[64:79], a[76:79], v[28:31], v[64:79]
    ds_read_b64_tr_b16 v[20:21], v2 offset:5408
    ds_read_b64_tr_b16 v[22:23], v2 offset:6696
    s_waitcnt lgkmcnt(10)
    v_mfma_f32_32x32x16_bf16 v[64:79], a[80:83], v[32:35], v[64:79]
    ds_read_b64_tr_b16 v[24:25], v2 offset:10560
    ds_read_b64_tr_b16 v[26:27], v2 offset:11848
    s_waitcnt lgkmcnt(10)
    v_mfma_f32_32x32x16_bf16 v[64:79], a[84:87], v[36:39], v[64:79]
    ds_read_b64_tr_b16 v[28:29], v2 offset:15712
    ds_read_b64_tr_b16 v[30:31], v2 offset:17000
    s_waitcnt lgkmcnt(10)
    v_mfma_f32_32x32x16_bf16 v[64:79], a[88:91], v[40:43], v[64:79]
    ds_read_b64_tr_b16 v[32:33], v2 offset:20864
    ds_read_b64_tr_b16 v[34:35], v2 offset:22152
    s_waitcnt lgkmcnt(10)
    v_mfma_f32_32x32x16_bf16 v[64:79], a[92:95], v[44:47], v[64:79]
    ds_read_b64_tr_b16 v[36:37], v2 offset:26016
    ds_read_b64_tr_b16 v[38:39], v2 offset:27304
    buffer_store_dwordx4 v[96:99], v4, s[28:31], 0 offen sc1
    v_add_u32 v4, 2097152, v4
    buffer_store_dwordx4 v[100:103], v4, s[28:31], 0 offen sc1
    v_add_u32 v4, 2097152, v4
    s_waitcnt lgkmcnt(10)
    v_mfma_f32_32x32x16_bf16 v[48:63], a[32:35], v[16:19], 0
    ds_read_b64_tr_b16 v[40:41], v2 offset:31168
    ds_read_b64_tr_b16 v[42:43], v2 offset:32456
    s_waitcnt lgkmcnt(10)
    v_mfma_f32_32x32x16_bf16 v[48:63], a[36:39], v[20:23], v[48:63]
    ds_read_b64_tr_b16 v[44:45], v2 offset:36320
    ds_read_b64_tr_b16 v[46:47], v2 offset:37608
    s_waitcnt lgkmcnt(10)
    v_mfma_f32_32x32x16_bf16 v[48:63], a[40:43], v[24:27], v[48:63]
    ds_read_b64_tr_b16 v[16:17], v3 offset:256
    ds_read_b64_tr_b16 v[18:19], v3 offset:1544
    s_waitcnt lgkmcnt(10)
    v_mfma_f32_32x32x16_bf16 v[48:63], a[44:47], v[28:31], v[48:63]
    ds_read_b64_tr_b16 v[20:21], v3 offset:5408
    ds_read_b64_tr_b16 v[22:23], v3 offset:6696
    v_cvt_pk_bf16_f32 v88, v64, v65
    v_cvt_pk_bf16_f32 v89, v66, v67
    ds_write_b64 v5, v[88:89] offset:2560
    s_waitcnt lgkmcnt(10)
    v_mfma_f32_32x32x16_bf16 v[48:63], a[48:51], v[32:35], v[48:63]
    ds_read_b64_tr_b16 v[24:25], v3 offset:10560
    ds_read_b64_tr_b16 v[26:27], v3 offset:11848
    v_cvt_pk_bf16_f32 v90, v68, v69
    v_cvt_pk_bf16_f32 v91, v70, v71
    ds_write_b64 v5, v[90:91] offset:2576
    s_waitcnt lgkmcnt(10)
    v_mfma_f32_32x32x16_bf16 v[48:63], a[52:55], v[36:39], v[48:63]
    ds_read_b64_tr_b16 v[28:29], v3 offset:15712
    ds_read_b64_tr_b16 v[30:31], v3 offset:17000
    v_cvt_pk_bf16_f32 v92, v72, v73
    v_cvt_pk_bf16_f32 v93, v74, v75
    ds_write_b64 v5, v[92:93] offset:2592
    s_waitcnt lgkmcnt(10)
    v_mfma_f32_32x32x16_bf16 v[48:63], a[56:59], v[40:43], v[48:63]
    ds_read_b64_tr_b16 v[32:33], v3 offset:20864
    ds_read_b64_tr_b16 v[34:35], v3 offset:22152
    v_cvt_pk_bf16_f32 v94, v76, v77
    v_cvt_pk_bf16_f32 v95, v78, v79
    ds_write_b64 v5, v[94:95] offset:2608
    s_waitcnt lgkmcnt(10)
    v_mfma_f32_32x32x16_bf16 v[48:63], a[60:63], v[44:47], v[48:63]
    ds_read_b64_tr_b16 v[36:37], v3 offset:26016
    ds_read_b64_tr_b16 v[38:39], v3 offset:27304
    ds_read_b128 v[104:107], v6 offset:2560
    s_waitcnt lgkmcnt(10)
    v_mfma_f32_32x32x16_bf16 v[48:63], a[64:67], v[16:19], v[48:63]
    ds_read_b64_tr_b16 v[40:41], v3 offset:31168
    ds_read_b64_tr_b16 v[42:43], v3 offset:32456
    ds_read_b128 v[108:111], v6 offset:3840
    s_waitcnt lgkmcnt(10)
    v_mfma_f32_32x32x16_bf16 v[48:63], a[68:71], v[20:23], v[48:63]
    ds_read_b64_tr_b16 v[44:45], v3 offset:36320
    ds_read_b64_tr_b16 v[46:47], v3 offset:37608
    s_waitcnt lgkmcnt(10)
    v_mfma_f32_32x32x16_bf16 v[48:63], a[72:75], v[24:27], v[48:63]
    s_waitcnt lgkmcnt(8)
    v_mfma_f32_32x32x16_bf16 v[48:63], a[76:79], v[28:31], v[48:63]
    s_waitcnt lgkmcnt(6)
    v_mfma_f32_32x32x16_bf16 v[48:63], a[80:83], v[32:35], v[48:63]
    s_waitcnt lgkmcnt(4)
    v_mfma_f32_32x32x16_bf16 v[48:63], a[84:87], v[36:39], v[48:63]
    s_waitcnt lgkmcnt(2)
    v_mfma_f32_32x32x16_bf16 v[48:63], a[88:91], v[40:43], v[48:63]
    s_waitcnt lgkmcnt(0)
    v_mfma_f32_32x32x16_bf16 v[48:63], a[92:95], v[44:47], v[48:63]
    buffer_store_dwordx4 v[104:107], v4, s[28:31], 0 offen sc1
    v_add_u32 v4, 2097152, v4
    buffer_store_dwordx4 v[108:111], v4, s[28:31], 0 offen sc1
    v_add_u32 v4, 2097152, v4
    s_nop 11
    v_cvt_pk_bf16_f32 v80, v48, v49
    v_cvt_pk_bf16_f32 v81, v50, v51
    v_cvt_pk_bf16_f32 v82, v52, v53
    v_cvt_pk_bf16_f32 v83, v54, v55
    v_cvt_pk_bf16_f32 v84, v56, v57
    v_cvt_pk_bf16_f32 v85, v58, v59
    v_cvt_pk_bf16_f32 v86, v60, v61
    v_cvt_pk_bf16_f32 v87, v62, v63
    ds_write_b64 v5, v[80:81] offset:0
    ds_write_b64 v5, v[82:83] offset:16
    ds_write_b64 v5, v[84:85] offset:32
    ds_write_b64 v5, v[86:87] offset:48
    ds_read_b128 v[96:99], v6 offset:0
    ds_read_b128 v[100:103], v6 offset:1280
    s_waitcnt lgkmcnt(0)
    buffer_store_dwordx4 v[96:99], v4, s[28:31], 0 offen sc1
    v_add_u32 v4, 2097152, v4
    buffer_store_dwordx4 v[100:103], v4, s[28:31], 0 offen sc1
    v_add_u32 v4, 2097152, v4
L_end:
    s_endpgm
.section .rodata,"a"
.p2align 6
.amdhsa_kernel standalone__tensor_product_equiv_mace__graph_kernel
  .amdhsa_next_free_vgpr 256
  .amdhsa_next_free_sgpr 102
  .amdhsa_accum_offset 160
  .amdhsa_group_segment_fixed_size 0
  .amdhsa_kernarg_size 88
  .amdhsa_user_sgpr_count 2
  .amdhsa_user_sgpr_kernarg_segment_ptr 1
  .amdhsa_system_sgpr_workgroup_id_x 1
  .amdhsa_float_denorm_mode_32 3
.end_amdhsa_kernel
```

```asm
; @launch grid=(256,1,1) block=(512,1,1) lds=157440
.amdgcn_target "amdgcn-amd-amdhsa--gfx950"
.text
.globl standalone__tensor_product_equiv_mace__graph_kernel
.p2align 8
.type standalone__tensor_product_equiv_mace__graph_kernel,@function
standalone__tensor_product_equiv_mace__graph_kernel:
    s_cmp_ge_u32 s2, 256
    s_cbranch_scc1 L_end
    s_load_dwordx2 s[84:85], s[0:1], 80
    s_load_dwordx16 s[64:79], s[0:1], 0
    s_load_dwordx2 s[80:81], s[0:1], 64
    v_and_b32 v1, 63, v0
    v_lshrrev_b32 v60, 6, v0
    v_mov_b32 v12, 0
    v_readfirstlane_b32 s3, v60
    s_and_b32 s55, s2, 63
    s_and_b32 s54, s2, 192
    s_mul_i32 s53, s55, 10000
    v_lshlrev_b32 v63, 4, v0
    v_add_u32 v60, s53, v63
    s_add_u32 s53, s53, 8192
    v_lshl_add_u32 v61, v0, 2, s53
    s_lshl_b32 s53, s54, 1
    v_mov_b32 v62, s53
    s_waitcnt lgkmcnt(0)
    s_mov_b32 s16, s68
    s_mov_b32 s17, s69
    s_mov_b32 s18, 640000
    s_mov_b32 s19, 0x00020000
    buffer_load_dwordx4 v[16:19], v60, s[16:19], 0 offen
    buffer_load_dword v20, v61, s[16:19], 0 offen
    s_mov_b32 s12, s66
    s_mov_b32 s13, s67
    s_mov_b32 s14, 640000
    s_mov_b32 s15, 0x00020000
    buffer_load_dwordx4 v[24:27], v60, s[12:15], 0 offen
    buffer_load_dword v28, v61, s[12:15], 0 offen
    s_mov_b32 s32, s84
    s_mov_b32 s33, s85
    s_mov_b32 s34, 20971520
    s_mov_b32 s35, 0x00020000
    buffer_load_dword v42, v62, s[32:35], 0 offen sc1
    s_mov_b32 s20, s70
    s_mov_b32 s21, s71
    s_mov_b32 s22, 1280000
    s_mov_b32 s23, 0x00020000
    v_mov_b32 v72, -1
    v_mov_b32 v73, -1
    v_mov_b32 v74, -1
    v_mov_b32 v75, -1
    ds_write_b128 v63, v[72:75] offset:0
    ds_write_b128 v63, v[72:75] offset:8192
    v_mov_b32 v68, 0
    v_mov_b32 v69, 0
    v_lshlrev_b32 v60, 3, v0
    v_add_u32 v60, 139776, v60
    ds_write_b64 v60, v[68:69]
    v_min_u32 v60, 35, v1
    v_lshlrev_b32 v60, 3, v60
    v_add_u32 v60, 147968, v60
    ds_write_b64 v60, v[68:69]
    s_mov_b32 s8, s64
    s_mov_b32 s9, s65
    s_mov_b32 s10, 20480000
    s_mov_b32 s11, 0x00020000
    s_mov_b32 s24, s72
    s_mov_b32 s25, s73
    s_mov_b32 s26, 5120000
    s_mov_b32 s27, 0x00020000
    s_mov_b32 s28, s80
    s_mov_b32 s29, s81
    s_mov_b32 s30, 20480000
    s_mov_b32 s31, 0x00020000
    s_mov_b32 s96, s74
    s_mov_b32 s97, s75
    s_mov_b32 s98, 128
    s_mov_b32 s99, 0x00020000
    s_mov_b32 s92, s76
    s_mov_b32 s93, s77
    s_mov_b32 s94, 8192
    s_mov_b32 s95, 0x00020000
    s_mov_b32 s88, s78
    s_mov_b32 s89, s79
    s_mov_b32 s90, 131072
    s_mov_b32 s91, 0x00020000
    s_lshl_b32 s63, s3, 13
    s_mov_b32 s52, 0
    s_mov_b32 s77, 0
    s_mov_b32 s82, 0x3fff00
    s_mov_b32 s83, 20971520
    s_lshl_b32 s49, s3, 10
    s_add_u32 s49, s49, 148256
    s_movk_i32 s53, 452
    v_cmp_gt_u32 s[50:51], s53, v0
    v_lshlrev_b32 v43, 22, v0
    v_lshlrev_b32 v59, 20, v0
    v_mov_b32 v58, 1
    s_waitcnt lgkmcnt(0)
    s_barrier
    v_and_b32 v60, 3, v1
    v_lshlrev_b32 v61, 5, v60
    v_lshrrev_b32 v66, 4, v1
    v_lshl_add_u32 v61, v66, 1, v61
    buffer_load_ushort v44, v61, s[96:99], 0 offen offset:0
    buffer_load_ushort v45, v61, s[96:99], 0 offen offset:8
    buffer_load_ushort v46, v61, s[96:99], 0 offen offset:16
    buffer_load_ushort v47, v61, s[96:99], 0 offen offset:24
    s_lshl_b32 s53, s3, 10
    s_add_u32 m0, s53, 32768
    v_lshlrev_b32 v64, 4, v1
    buffer_load_dwordx4 v64, s[92:95], s53 offen lds
    s_lshr_b32 s53, s2, 3
    s_lshl3_add_u32 s53, s53, s3
    s_lshl_b32 s53, s53, 10
    v_add_u32 v79, s53, v64
    buffer_load_dwordx4 v[156:159], v79, s[20:23], 0 offen
    v_add_u32 v79, 262144, v79
    buffer_load_dwordx4 v[156:159], v79, s[20:23], 0 offen
    v_add_u32 v79, 262144, v79
    buffer_load_dwordx4 v[156:159], v79, s[20:23], 0 offen
    v_add_u32 v79, 262144, v79
    buffer_load_dwordx4 v[156:159], v79, s[20:23], 0 offen
    v_add_u32 v79, 262144, v79
    buffer_load_dwordx4 v[156:159], v79, s[20:23], 0 offen
    v_add_u32 v79, 262144, v79
    v_subrev_u32 v79, 1310720, v79
    v_and_b32 v61, 7, v1
    v_bfe_u32 v65, v1, 3, 1
    v_lshlrev_b32 v65, 9, v65
    v_lshl_add_u32 v65, v66, 7, v65
    v_lshl_add_u32 v2, v61, 4, v65
    v_xor_b32 v61, 4, v61
    v_lshl_add_u32 v3, v61, 4, v65
    v_bfe_u32 v60, v1, 2, 2
    v_bfe_u32 v62, v1, 1, 1
    v_lshl_add_u32 v62, v66, 1, v62
    v_lshrrev_b32 v63, 1, v60
    v_lshlrev_b32 v64, 2, v63
    v_xor_b32 v62, v62, v64
    v_and_b32 v64, 1, v60
    v_lshl_add_u32 v62, v64, 3, v62
    v_lshlrev_b32 v62, 4, v62
    v_lshl_add_u32 v62, v63, 10, v62
    v_and_b32 v64, 1, v1
    v_lshl_add_u32 v62, v64, 3, v62
    v_add_u32 v4, s63, v62
    v_lshrrev_b32 v61, 5, v1
    v_mov_b32 v63, 32
    v_cmp_eq_u32 vcc, v60, v61
    v_add_u32 v61, 2, v61
    v_and_b32 v64, 3, v1
    v_cndmask_b32 v7, 0, v63, vcc
    v_cmp_eq_u32 vcc, v60, v61
    v_cmp_eq_u32 s[4:5], v64, v66
    v_mov_b32 v65, 8
    v_cndmask_b32 v8, 0, v63, vcc
    v_cndmask_b32 v10, 0, v65, s[4:5]
    v_lshrrev_b32 v68, 3, v0
    v_and_b32 v69, 7, v0
    v_lshlrev_b32 v69, 4, v69
    v_add_u32 v61, s54, v68
    s_movk_i32 s46, 8320
    v_mad_u32_u24 v64, v61, s46, v69
    s_lshl_b32 s45, s55, 7
    s_add_u32 s53, s45, 8388608
    v_add_u32 v64, s53, v64
    v_lshl_add_u32 v65, v61, 13, v69
    s_add_u32 s53, s45, 16777216
    v_add_u32 v65, s53, v65
    v_lshlrev_b32 v61, 4, v0
    s_mov_b32 s53, 148000
    v_lshl_add_u32 v67, v68, 2, s53
    s_waitcnt vmcnt(13)
    v_and_b32 v48, 255, v16
    v_subrev_u32 v48, s54, v48
    v_cmp_gt_u32 s[64:65], 64, v48
    v_lshl_add_u32 v60, v48, 2, s53
    s_mov_b64 exec, s[64:65]
    ds_add_rtn_u32 v53, v60, v58
    s_mov_b64 exec, -1
    v_and_b32 v49, 255, v17
    v_subrev_u32 v49, s54, v49
    v_cmp_gt_u32 s[66:67], 64, v49
    v_lshl_add_u32 v60, v49, 2, s53
    s_mov_b64 exec, s[66:67]
    ds_add_rtn_u32 v54, v60, v58
    s_mov_b64 exec, -1
    v_and_b32 v50, 255, v18
    v_subrev_u32 v50, s54, v50
    v_cmp_gt_u32 s[68:69], 64, v50
    v_lshl_add_u32 v60, v50, 2, s53
    s_mov_b64 exec, s[68:69]
    ds_add_rtn_u32 v55, v60, v58
    s_mov_b64 exec, -1
    v_and_b32 v51, 255, v19
    v_subrev_u32 v51, s54, v51
    v_cmp_gt_u32 s[70:71], 64, v51
    v_lshl_add_u32 v60, v51, 2, s53
    s_mov_b64 exec, s[70:71]
    ds_add_rtn_u32 v56, v60, v58
    s_mov_b64 exec, -1
    v_and_b32 v52, 255, v20
    v_subrev_u32 v52, s54, v52
    v_cmp_gt_u32 s[72:73], 64, v52
    v_lshl_add_u32 v60, v52, 2, s53
    s_and_b64 s[72:73], s[72:73], s[50:51]
    s_mov_b64 exec, s[72:73]
    ds_add_rtn_u32 v57, v60, v58
    s_mov_b64 exec, -1
    s_waitcnt vmcnt(10)
    v_readfirstlane_b32 s48, v42
    v_bfe_u32 v16, v16, 8, 6
    v_min_u32 v16, 47, v16
    v_and_b32 v24, 0x3fff, v24
    v_lshl_or_b32 v16, v24, 6, v16
    v_add_u32 v24, 0, v43
    v_or_b32 v16, v16, v24
    v_lshlrev_b32 v48, 7, v48
    v_bfe_u32 v17, v17, 8, 6
    v_min_u32 v17, 47, v17
    v_and_b32 v25, 0x3fff, v25
    v_lshl_or_b32 v17, v25, 6, v17
    v_add_u32 v25, 1048576, v43
    v_or_b32 v17, v17, v25
    v_lshlrev_b32 v49, 7, v49
    v_bfe_u32 v18, v18, 8, 6
    v_min_u32 v18, 47, v18
    v_and_b32 v26, 0x3fff, v26
    v_lshl_or_b32 v18, v26, 6, v18
    v_add_u32 v26, 2097152, v43
    v_or_b32 v18, v18, v26
    v_lshlrev_b32 v50, 7, v50
    v_bfe_u32 v19, v19, 8, 6
    v_min_u32 v19, 47, v19
    v_and_b32 v27, 0x3fff, v27
    v_lshl_or_b32 v19, v27, 6, v19
    v_add_u32 v27, 3145728, v43
    v_or_b32 v19, v19, v27
    v_lshlrev_b32 v51, 7, v51
    v_bfe_u32 v20, v20, 8, 6
    v_min_u32 v20, 47, v20
    v_and_b32 v28, 0x3fff, v28
    v_lshl_or_b32 v20, v28, 6, v20
    v_add_u32 v28, 2147483648, v59
    v_or_b32 v20, v20, v28
    v_lshlrev_b32 v52, 7, v52
    v_mov_b32 v59, -2
    s_add_u32 s48, s48, 1
    s_movk_i32 s53, 7808
    s_waitcnt lgkmcnt(0)
    v_cmp_gt_u32 vcc, 31, v53
    v_min_u32 v53, 31, v53
    v_mul_u32_u24 v32, 43, v53
    v_cndmask_b32 v16, v59, v16, vcc
    v_lshrrev_b32 v32, 7, v32
    v_cmp_gt_u32 vcc, 24, v53
    v_add_lshl_u32 v32, v32, v53, 2
    v_lshl_add_u32 v33, v53, 4, s53
    v_cndmask_b32 v32, v33, v32, vcc
    v_add_u32 v48, v48, v32
    s_mov_b64 exec, s[64:65]
    ds_write_b32 v48, v16 offset:0
    s_mov_b64 exec, -1
    v_cmp_gt_u32 vcc, 31, v54
    v_min_u32 v54, 31, v54
    v_mul_u32_u24 v32, 43, v54
    v_cndmask_b32 v17, v59, v17, vcc
    v_lshrrev_b32 v32, 7, v32
    v_cmp_gt_u32 vcc, 24, v54
    v_add_lshl_u32 v32, v32, v54, 2
    v_lshl_add_u32 v33, v54, 4, s53
    v_cndmask_b32 v32, v33, v32, vcc
    v_add_u32 v49, v49, v32
    s_mov_b64 exec, s[66:67]
    ds_write_b32 v49, v17 offset:0
    s_mov_b64 exec, -1
    v_cmp_gt_u32 vcc, 31, v55
    v_min_u32 v55, 31, v55
    v_mul_u32_u24 v32, 43, v55
    v_cndmask_b32 v18, v59, v18, vcc
    v_lshrrev_b32 v32, 7, v32
    v_cmp_gt_u32 vcc, 24, v55
    v_add_lshl_u32 v32, v32, v55, 2
    v_lshl_add_u32 v33, v55, 4, s53
    v_cndmask_b32 v32, v33, v32, vcc
    v_add_u32 v50, v50, v32
    s_mov_b64 exec, s[68:69]
    ds_write_b32 v50, v18 offset:0
    s_mov_b64 exec, -1
    v_cmp_gt_u32 vcc, 31, v56
    v_min_u32 v56, 31, v56
    v_mul_u32_u24 v32, 43, v56
    v_cndmask_b32 v19, v59, v19, vcc
    v_lshrrev_b32 v32, 7, v32
    v_cmp_gt_u32 vcc, 24, v56
    v_add_lshl_u32 v32, v32, v56, 2
    v_lshl_add_u32 v33, v56, 4, s53
    v_cndmask_b32 v32, v33, v32, vcc
    v_add_u32 v51, v51, v32
    s_mov_b64 exec, s[70:71]
    ds_write_b32 v51, v19 offset:0
    s_mov_b64 exec, -1
    v_cmp_gt_u32 vcc, 31, v57
    v_min_u32 v57, 31, v57
    v_mul_u32_u24 v32, 43, v57
    v_cndmask_b32 v20, v59, v20, vcc
    v_lshrrev_b32 v32, 7, v32
    v_cmp_gt_u32 vcc, 24, v57
    v_add_lshl_u32 v32, v32, v57, 2
    v_lshl_add_u32 v33, v57, 4, s53
    v_cndmask_b32 v32, v33, v32, vcc
    v_add_u32 v52, v52, v32
    s_mov_b64 exec, s[72:73]
    ds_write_b32 v52, v20 offset:0
    s_mov_b64 exec, -1
    s_waitcnt lgkmcnt(0)
    s_barrier
    ds_read_b128 v[16:19], v61 offset:0
    ds_read_b32 v67, v67
    s_waitcnt lgkmcnt(1)
    v_mov_b32 v19, s48
    buffer_store_dwordx4 v[16:19], v64, s[32:35], 0 offen sc1
    s_waitcnt lgkmcnt(0)
    v_cmp_lt_u32 vcc, 23, v67
    s_cbranch_vccz L_noup
    ds_read_b128 v[28:31], v61 offset:8192
    s_waitcnt lgkmcnt(0)
    v_mov_b32 v31, s48
    s_mov_b64 exec, vcc
    buffer_store_dwordx4 v[28:31], v65, s[32:35], 0 offen sc1
    s_mov_b64 exec, -1
L_noup:
    s_cmp_ge_u32 s3, 2
    s_cbranch_scc1 L_nowf
    s_lshl1_add_u32 s44, s55, s3
    s_and_b32 s53, s44, 15
    s_lshl_b32 s53, s53, 13
    s_lshr_b32 s76, s44, 4
    s_lshl_b32 s76, s76, 6
    s_add_u32 s53, s53, s76
    v_lshrrev_b32 v60, 5, v1
    v_lshlrev_b32 v60, 12, v60
    v_and_b32 v61, 31, v1
    v_lshl_add_u32 v60, v61, 1, v60
    v_add_u32 v60, s53, v60
    buffer_load_ushort v32, v60, s[88:91], 0 offen offset:0
    buffer_load_ushort v33, v60, s[88:91], 0 offen offset:512
    buffer_load_ushort v34, v60, s[88:91], 0 offen offset:1024
    buffer_load_ushort v35, v60, s[88:91], 0 offen offset:1536
    buffer_load_ushort v36, v60, s[88:91], 0 offen offset:2048
    buffer_load_ushort v37, v60, s[88:91], 0 offen offset:2560
    buffer_load_ushort v38, v60, s[88:91], 0 offen offset:3072
    buffer_load_ushort v39, v60, s[88:91], 0 offen offset:3584
L_nowf:
    v_lshrrev_b32 v60, 5, v1
    v_bfe_u32 v61, v1, 2, 2
    v_bfe_u32 v62, v1, 4, 1
    v_and_b32 v63, 3, v1
    v_lshlrev_b32 v77, 12, v62
    v_lshl_add_u32 v77, v61, 9, v77
    v_lshl_add_u32 v77, v60, 5, v77
    v_lshl_add_u32 v77, v63, 3, v77
    s_mul_i32 s53, s2, 8320
    s_add_u32 s53, s53, 8388608
    v_lshl_add_u32 v70, v0, 4, s53
    s_lshl_b32 s53, s2, 13
    s_add_u32 s53, s53, 16777216
    v_lshl_add_u32 v71, v0, 4, s53
    v_mul_u32_u24 v73, 2500, v68
    v_mov_b64 v[80:81], 0
    v_mov_b64 v[82:83], 0
    v_mov_b64 v[84:85], 0
    v_mov_b64 v[86:87], 0
    v_mov_b64 v[88:89], 0
    v_mov_b64 v[90:91], 0
    v_mov_b64 v[92:93], 0
    v_mov_b64 v[94:95], 0
    v_mov_b64 v[96:97], 0
    v_mov_b64 v[98:99], 0
    v_mov_b64 v[100:101], 0
    v_mov_b64 v[102:103], 0
    v_mov_b64 v[104:105], 0
    v_mov_b64 v[106:107], 0
    v_mov_b64 v[108:109], 0
    v_mov_b64 v[110:111], 0
    v_mov_b64 v[112:113], 0
    v_mov_b64 v[114:115], 0
    v_mov_b64 v[116:117], 0
    v_mov_b64 v[118:119], 0
    v_mov_b64 v[120:121], 0
    v_mov_b64 v[122:123], 0
    v_mov_b64 v[124:125], 0
    v_mov_b64 v[126:127], 0
    v_mov_b64 v[128:129], 0
    v_mov_b64 v[130:131], 0
    v_mov_b64 v[132:133], 0
    v_mov_b64 v[134:135], 0
    v_mov_b64 v[136:137], 0
    v_mov_b64 v[138:139], 0
    v_mov_b64 v[140:141], 0
    v_mov_b64 v[142:143], 0
    v_mov_b64 v[144:145], 0
    v_mov_b64 v[146:147], 0
    v_mov_b64 v[148:149], 0
    v_mov_b64 v[150:151], 0
    v_mov_b64 v[152:153], 0
    v_mov_b64 v[154:155], 0
    s_mov_b64 s[6:7], -1
    s_mov_b32 s55, 0
    s_waitcnt vmcnt(0)
L_poll:
    s_mov_b64 exec, s[6:7]
    buffer_load_dwordx4 v[48:51], v70, s[32:35], 0 offen sc1
    s_mov_b64 exec, -1
    s_waitcnt vmcnt(0)
    v_cmp_ne_u32 s[6:7], s48, v51
    s_cmp_eq_u64 s[6:7], 0
    s_cbranch_scc1 L_got
    s_sleep 4
    s_add_u32 s55, s55, 1
    s_cmp_lt_u32 s55, 0x400000
    s_cbranch_scc1 L_poll
L_got:
    v_cmp_gt_u32 s[36:37], -2, v48
    v_cmp_gt_u32 s[38:39], -2, v49
    v_cmp_gt_u32 s[40:41], -2, v50
    v_mov_b32 v52, -1
    s_mov_b64 s[42:43], 0
    s_mov_b32 s53, 0x80808080
    s_and_b32 s6, s40, s53
    s_and_b32 s7, s41, s53
    s_cmp_eq_u64 s[6:7], 0
    s_cbranch_scc1 L_noext
    s_lshr_b64 s[6:7], s[6:7], 7
    s_mul_i32 s6, s6, 255
    s_mul_i32 s7, s7, 255
    v_mov_b32 v55, s48
L_poll2:
    s_mov_b64 exec, s[6:7]
    buffer_load_dwordx4 v[52:55], v71, s[32:35], 0 offen sc1
    s_mov_b64 exec, -1
    s_waitcnt vmcnt(0)
    v_cmp_ne_u32 vcc, s48, v55
    s_cbranch_vccz L_got2
    s_sleep 1
    s_add_u32 s55, s55, 1
    s_cmp_lt_u32 s55, 0x400000
    s_cbranch_scc1 L_poll2
L_got2:
    v_cmp_gt_u32 s[42:43], -2, v52
L_noext:
    v_cmp_eq_u32 vcc, -2, v52
    s_bcnt1_i32_b64 s64, s[36:37]
    s_bcnt1_i32_b64 s65, s[38:39]
    s_bcnt1_i32_b64 s66, s[40:41]
    s_bcnt1_i32_b64 s67, s[42:43]
    s_add_u32 s65, s65, s64
    s_add_u32 s66, s66, s65
    s_add_u32 s79, s67, s66
    v_mov_b32 v61, s79
    v_mov_b32 v60, 143552
    s_mov_b64 exec, 1
    ds_add_rtn_u32 v61, v60, v61
    s_mov_b64 exec, -1
    v_mbcnt_lo_u32_b32 v62, s36, 0
    v_mbcnt_hi_u32_b32 v62, s37, v62
    v_lshrrev_b32 v20, 20, v48
    v_add_u32 v20, v20, v73
    v_lshl_add_u32 v66, v62, 2, s49
    s_mov_b64 exec, s[36:37]
    ds_write_b32 v66, v20
    s_mov_b64 exec, -1
    v_lshlrev_b32 v24, 2, v48
    v_and_b32 v24, s82, v24
    v_and_b32 v16, 63, v48
    v_mbcnt_lo_u32_b32 v63, s38, 0
    v_mbcnt_hi_u32_b32 v63, s39, v63
    v_add_u32 v63, s64, v63
    v_lshrrev_b32 v21, 20, v49
    v_add_u32 v21, v21, v73
    v_lshl_add_u32 v66, v63, 2, s49
    s_mov_b64 exec, s[38:39]
    ds_write_b32 v66, v21
    s_mov_b64 exec, -1
    v_lshlrev_b32 v25, 2, v49
    v_and_b32 v25, s82, v25
    v_and_b32 v17, 63, v49
    v_mbcnt_lo_u32_b32 v64, s40, 0
    v_mbcnt_hi_u32_b32 v64, s41, v64
    v_add_u32 v64, s65, v64
    v_lshrrev_b32 v22, 20, v50
    v_add_u32 v22, v22, v73
    v_lshl_add_u32 v66, v64, 2, s49
    s_mov_b64 exec, s[40:41]
    ds_write_b32 v66, v22
    s_mov_b64 exec, -1
    v_lshlrev_b32 v26, 2, v50
    v_and_b32 v26, s82, v26
    v_and_b32 v18, 63, v50
    v_mbcnt_lo_u32_b32 v65, s42, 0
    v_mbcnt_hi_u32_b32 v65, s43, v65
    v_add_u32 v65, s66, v65
    v_lshrrev_b32 v23, 20, v52
    v_add_u32 v23, v23, v73
    v_lshl_add_u32 v66, v65, 2, s49
    s_mov_b64 exec, s[42:43]
    ds_write_b32 v66, v23
    s_mov_b64 exec, -1
    v_lshlrev_b32 v27, 2, v52
    v_and_b32 v27, s82, v27
    v_and_b32 v19, 63, v52
    v_lshl_or_b32 v14, v45, 16, v44
    v_lshl_or_b32 v15, v47, 16, v46
    v_mov_b64 v[156:157], 0
    v_mov_b64 v[158:159], 0
    s_cmp_ge_u32 s3, 2
    s_cbranch_scc1 L_1
    v_lshl_or_b32 v56, v33, 16, v32
    v_lshl_or_b32 v57, v35, 16, v34
    v_lshl_or_b32 v58, v37, 16, v36
    v_lshl_or_b32 v59, v39, 16, v38
    s_lshl_b32 s53, s54, 1
    s_add_u32 s53, s53, s44
    s_lshl2_add_u32 s83, s53, 4096
    s_lshl_b32 s53, s53, 10
    s_add_u32 s53, s53, 1048576
    v_lshl_add_u32 v60, v1, 4, s53
    buffer_store_dwordx4 v[56:59], v60, s[32:35], 0 offen sc1
L_1:
    s_mov_b32 s80, 79
    s_waitcnt lgkmcnt(0)
    v_readfirstlane_b32 s44, v61
    s_cbranch_vccnz L_defer
    s_add_u32 s53, s44, s79
    s_cmp_gt_u32 s53, 1024
    s_cbranch_scc1 L_defer
    v_add_u32 v62, s44, v62
    v_lshl_or_b32 v24, v62, 22, v24
    v_add_u32 v63, s44, v63
    v_lshl_or_b32 v25, v63, 22, v25
    v_add_u32 v64, s44, v64
    v_lshl_or_b32 v26, v64, 22, v26
    v_add_u32 v65, s44, v65
    v_lshl_or_b32 v27, v65, 22, v27
    s_branch L_have
L_defer:
    s_mov_b32 s80, 0
    s_mov_b32 s79, 0
    s_mov_b32 s44, 0
    s_mov_b64 s[36:37], 0
    s_mov_b64 s[38:39], 0
    s_mov_b64 s[40:41], 0
    s_mov_b64 s[42:43], 0
    v_mov_b32 v58, 1
    v_mov_b32 v59, 147984
    ds_write_b32 v59, v58
    s_branch L_have
L_scan:
    s_barrier
    s_mov_b32 s64, s63
    s_add_u32 s65, s63, 1024
    s_xor_b32 s47, s2, 1
L_sloop:
    s_cmp_ge_u32 s80, 79
    s_cbranch_scc1 L_scan_done
    s_mul_i32 s53, s3, 20000
    s_lshl_b32 s54, s80, 8
    s_add_u32 s55, s53, s54
    v_lshlrev_b32 v56, 2, v1
    v_add_u32 v56, s55, v56
    v_lshlrev_b32 v57, 2, v56
    buffer_load_dwordx4 v[60:63], v57, s[16:19], 0 offen
    s_waitcnt vmcnt(0)
    s_cmp_lg_u32 s80, 78
    s_cbranch_scc1 L_snotlast
    s_mov_b32 exec_lo, 0xffffff00
    v_mov_b32 v60, s47
    v_mov_b32 v61, s47
    v_mov_b32 v62, s47
    v_mov_b32 v63, s47
    s_mov_b64 exec, -1
L_snotlast:
    s_cmp_gt_u32 s52, 0
    s_cbranch_scc1 L_2
    v_cmp_eq_u32_sdwa vcc, v60, s2 src0_sel:BYTE_0 src1_sel:DWORD
    s_cbranch_vccz L_2
    s_bcnt1_i32_b64 s53, vcc
    s_lshl3_add_u32 s54, s53, s64
    s_mov_b32 s52, 0
    s_cmp_gt_u32 s54, s65
    s_cbranch_scc1 L_ovf
    v_mbcnt_lo_u32_b32 v58, vcc_lo, 0
    v_mbcnt_hi_u32_b32 v58, vcc_hi, v58
    v_lshl_add_u32 v58, v58, 3, s64
    v_add_u32 v59, 0, v56
    s_mov_b64 exec, vcc
    ds_write2_b32 v58, v60, v59 offset0:0 offset1:1
    s_mov_b64 exec, -1
    s_mov_b32 s64, s54
L_2:
    s_cmp_gt_u32 s52, 1
    s_cbranch_scc1 L_3
    v_cmp_eq_u32_sdwa vcc, v61, s2 src0_sel:BYTE_0 src1_sel:DWORD
    s_cbranch_vccz L_3
    s_bcnt1_i32_b64 s53, vcc
    s_lshl3_add_u32 s54, s53, s64
    s_mov_b32 s52, 1
    s_cmp_gt_u32 s54, s65
    s_cbranch_scc1 L_ovf
    v_mbcnt_lo_u32_b32 v58, vcc_lo, 0
    v_mbcnt_hi_u32_b32 v58, vcc_hi, v58
    v_lshl_add_u32 v58, v58, 3, s64
    v_add_u32 v59, 1, v56
    s_mov_b64 exec, vcc
    ds_write2_b32 v58, v61, v59 offset0:0 offset1:1
    s_mov_b64 exec, -1
    s_mov_b32 s64, s54
L_3:
    s_cmp_gt_u32 s52, 2
    s_cbranch_scc1 L_4
    v_cmp_eq_u32_sdwa vcc, v62, s2 src0_sel:BYTE_0 src1_sel:DWORD
    s_cbranch_vccz L_4
    s_bcnt1_i32_b64 s53, vcc
    s_lshl3_add_u32 s54, s53, s64
    s_mov_b32 s52, 2
    s_cmp_gt_u32 s54, s65
    s_cbranch_scc1 L_ovf
    v_mbcnt_lo_u32_b32 v58, vcc_lo, 0
    v_mbcnt_hi_u32_b32 v58, vcc_hi, v58
    v_lshl_add_u32 v58, v58, 3, s64
    v_add_u32 v59, 2, v56
    s_mov_b64 exec, vcc
    ds_write2_b32 v58, v62, v59 offset0:0 offset1:1
    s_mov_b64 exec, -1
    s_mov_b32 s64, s54
L_4:
    s_cmp_gt_u32 s52, 3
    s_cbranch_scc1 L_5
    v_cmp_eq_u32_sdwa vcc, v63, s2 src0_sel:BYTE_0 src1_sel:DWORD
    s_cbranch_vccz L_5
    s_bcnt1_i32_b64 s53, vcc
    s_lshl3_add_u32 s54, s53, s64
    s_mov_b32 s52, 3
    s_cmp_gt_u32 s54, s65
    s_cbranch_scc1 L_ovf
    v_mbcnt_lo_u32_b32 v58, vcc_lo, 0
    v_mbcnt_hi_u32_b32 v58, vcc_hi, v58
    v_lshl_add_u32 v58, v58, 3, s64
    v_add_u32 v59, 3, v56
    s_mov_b64 exec, vcc
    ds_write2_b32 v58, v63, v59 offset0:0 offset1:1
    s_mov_b64 exec, -1
    s_mov_b32 s64, s54
L_5:
    s_mov_b32 s52, 0
    s_add_u32 s80, s80, 1
    s_branch L_sloop
L_ovf:
    v_mov_b32 v58, 1
    v_mov_b32 v59, 147984
    ds_write_b32 v59, v58
L_scan_done:
    s_sub_u32 s79, s64, s63
    s_lshr_b32 s79, s79, 3
    s_lshl_b32 s44, s3, 7
    v_lshlrev_b32 v58, 3, v1
    v_add_u32 v58, s63, v58
    s_waitcnt lgkmcnt(0)
    ds_read_b32 v16, v58 offset:0
    ds_read_b32 v20, v58 offset:4
    s_sub_u32 s53, s79, 0
    v_cmp_gt_i32 s[36:37], s53, v1
    ds_read_b32 v17, v58 offset:512
    ds_read_b32 v21, v58 offset:516
    s_sub_u32 s53, s79, 64
    v_cmp_gt_i32 s[38:39], s53, v1
    s_mov_b64 s[40:41], 0
    v_mov_b32 v18, 0
    v_mov_b32 v26, 0
    s_mov_b64 s[42:43], 0
    v_mov_b32 v19, 0
    v_mov_b32 v27, 0
    v_lshl_add_u32 v58, v1, 2, s49
    v_add_u32 v59, s44, v1
    v_lshlrev_b32 v59, 22, v59
    s_waitcnt lgkmcnt(0)
    v_lshlrev_b32 v28, 2, v20
    buffer_load_dword v24, v28, s[12:15], 0 offen
    v_bfe_u32 v16, v16, 8, 6
    v_min_u32 v16, 47, v16
    ds_write_b32 v58, v20 offset:0
    v_lshlrev_b32 v29, 2, v21
    buffer_load_dword v25, v29, s[12:15], 0 offen
    v_bfe_u32 v17, v17, 8, 6
    v_min_u32 v17, 47, v17
    ds_write_b32 v58, v21 offset:256
    s_waitcnt vmcnt(0)
    v_and_b32 v24, 0x3fff, v24
    v_lshl_or_b32 v24, v24, 8, v59
    v_add_u32 v59, 268435456, v59
    v_and_b32 v25, 0x3fff, v25
    v_lshl_or_b32 v25, v25, 8, v59
    v_add_u32 v59, 268435456, v59
L_have:
    v_mov_b32 v58, 1
    s_mov_b32 s53, 139776
    s_mov_b32 s54, 143616
    v_bfe_u32 v28, v24, 8, 14
    v_mul_u32_u24 v28, 6711, v28
    v_lshrrev_b32 v28, 22, v28
    v_min_u32 v28, 15, v28
    v_lshl_add_u32 v28, v28, 2, s53
    v_lshl_add_u32 v28, v16, 6, v28
    v_lshl_add_u32 v16, v16, 2, s54
    s_mov_b64 exec, s[36:37]
    ds_add_rtn_u32 v32, v28, v58
    ds_add_u32 v16, v58
    s_mov_b64 exec, -1
    v_bfe_u32 v29, v25, 8, 14
    v_mul_u32_u24 v29, 6711, v29
    v_lshrrev_b32 v29, 22, v29
    v_min_u32 v29, 15, v29
    v_lshl_add_u32 v29, v29, 2, s53
    v_lshl_add_u32 v29, v17, 6, v29
    v_lshl_add_u32 v17, v17, 2, s54
    s_mov_b64 exec, s[38:39]
    ds_add_rtn_u32 v33, v29, v58
    ds_add_u32 v17, v58
    s_mov_b64 exec, -1
    v_bfe_u32 v30, v26, 8, 14
    v_mul_u32_u24 v30, 6711, v30
    v_lshrrev_b32 v30, 22, v30
    v_min_u32 v30, 15, v30
    v_lshl_add_u32 v30, v30, 2, s53
    v_lshl_add_u32 v30, v18, 6, v30
    v_lshl_add_u32 v18, v18, 2, s54
    s_mov_b64 exec, s[40:41]
    ds_add_rtn_u32 v34, v30, v58
    ds_add_u32 v18, v58
    s_mov_b64 exec, -1
    v_bfe_u32 v31, v27, 8, 14
    v_mul_u32_u24 v31, 6711, v31
    v_lshrrev_b32 v31, 22, v31
    v_min_u32 v31, 15, v31
    v_lshl_add_u32 v31, v31, 2, s53
    v_lshl_add_u32 v31, v19, 6, v31
    v_lshl_add_u32 v19, v19, 2, s54
    s_mov_b64 exec, s[42:43]
    ds_add_rtn_u32 v35, v31, v58
    ds_add_u32 v19, v58
    s_mov_b64 exec, -1
    v_lshrrev_b32 v36, 1, v1
    v_lshl_add_u32 v39, v36, 2, s49
    ds_read_b32 v40, v39 offset:0
    ds_read_b32 v41, v39 offset:128
    ds_read_b32 v42, v39 offset:256
    ds_read_b32 v43, v39 offset:384
    v_and_b32 v38, 1, v1
    v_lshlrev_b32 v37, 4, v38
    v_lshlrev_b32 v38, 2, v38
    s_mov_b32 s46, s79
    s_mov_b32 s45, s44
    v_lshl_add_u32 v56, v1, 2, s54
    v_mov_b32 v57, 147984
    s_waitcnt lgkmcnt(0)
    s_cmp_le_i32 s46, 0
    s_cbranch_scc1 L_6
    v_lshl_add_u32 v44, v40, 5, v37
    v_lshl_add_u32 v45, v40, 3, v38
    v_cmp_gt_i32 vcc, s46, v36
    s_lshl_b32 s76, s45, 5
    s_add_u32 m0, s76, 65536
    s_mov_b64 exec, vcc
    buffer_load_dwordx4 v44, s[24:27], 0 offen lds
    s_lshl3_add_u32 m0, s45, 98304
    s_add_u32 s45, s45, 32
    buffer_load_dword v45, s[20:23], 0 offen lds
    s_mov_b64 exec, -1
    s_sub_i32 s46, s46, 32
L_6:
    s_barrier
    ds_read_b32 v56, v56
    ds_read_b32 v57, v57
    s_cmp_le_i32 s46, 0
    s_cbranch_scc1 L_7
    v_lshl_add_u32 v44, v41, 5, v37
    v_lshl_add_u32 v45, v41, 3, v38
    v_cmp_gt_i32 vcc, s46, v36
    s_lshl_b32 s76, s45, 5
    s_add_u32 m0, s76, 65536
    s_mov_b64 exec, vcc
    buffer_load_dwordx4 v44, s[24:27], 0 offen lds
    s_lshl3_add_u32 m0, s45, 98304
    s_add_u32 s45, s45, 32
    buffer_load_dword v45, s[20:23], 0 offen lds
    s_mov_b64 exec, -1
    s_sub_i32 s46, s46, 32
L_7:
    s_waitcnt lgkmcnt(0)
    v_readfirstlane_b32 s78, v57
    s_cmp_lg_u32 s77, 0
    s_cbranch_scc1 L_assigned
    ds_read_b64_tr_b16 a[0:1], v77 offset:32768
    ds_read_b64_tr_b16 a[2:3], v77 offset:34816
    ds_read_b64_tr_b16 a[4:5], v77 offset:32832
    ds_read_b64_tr_b16 a[6:7], v77 offset:34880
    ds_read_b64_tr_b16 a[8:9], v77 offset:32896
    ds_read_b64_tr_b16 a[10:11], v77 offset:34944
    ds_read_b64_tr_b16 a[12:13], v77 offset:32960
    ds_read_b64_tr_b16 a[14:15], v77 offset:35008
    ds_read_b64_tr_b16 a[16:17], v77 offset:33024
    ds_read_b64_tr_b16 a[18:19], v77 offset:35072
    ds_read_b64_tr_b16 a[20:21], v77 offset:33088
    ds_read_b64_tr_b16 a[22:23], v77 offset:35136
    ds_read_b64_tr_b16 a[24:25], v77 offset:33152
    ds_read_b64_tr_b16 a[26:27], v77 offset:35200
    ds_read_b64_tr_b16 a[28:29], v77 offset:33216
    ds_read_b64_tr_b16 a[30:31], v77 offset:35264
    s_and_b32 s53, s2, 63
    s_or_b32 s53, s53, s3
    s_cbranch_scc1 L_8
    s_lshl_b32 s53, s2, 1
    v_mov_b32 v60, s53
    v_mov_b32 v61, s48
    s_mov_b64 exec, 1
    buffer_store_dword v61, v60, s[32:35], 0 offen sc1
    s_mov_b64 exec, -1
L_8:
    v_sub_u32 v57, 63, v1
    v_lshl_add_u32 v57, v56, 6, v57
    v_mov_b32 v59, 0
    v_readlane_b32 s84, v57, 0
    v_readlane_b32 s85, v57, 1
    v_readlane_b32 s86, v57, 2
    v_readlane_b32 s87, v57, 3
    v_readlane_b32 s88, v57, 4
    v_readlane_b32 s89, v57, 5
    v_readlane_b32 s90, v57, 6
    v_readlane_b32 s91, v57, 7
    v_readlane_b32 s92, v57, 8
    v_readlane_b32 s93, v57, 9
    v_readlane_b32 s94, v57, 10
    v_readlane_b32 s95, v57, 11
    v_readlane_b32 s96, v57, 12
    v_readlane_b32 s97, v57, 13
    v_readlane_b32 s98, v57, 14
    v_readlane_b32 s99, v57, 15
    v_cmp_gt_u32 vcc, s84, v57
    v_cmp_gt_u32 s[4:5], s85, v57
    v_cmp_gt_u32 s[6:7], s86, v57
    v_addc_co_u32 v59, vcc, 0, v59, vcc
    v_addc_co_u32 v59, s[4:5], 0, v59, s[4:5]
    v_addc_co_u32 v59, s[6:7], 0, v59, s[6:7]
    v_cmp_gt_u32 vcc, s87, v57
    v_cmp_gt_u32 s[4:5], s88, v57
    v_cmp_gt_u32 s[6:7], s89, v57
    v_addc_co_u32 v59, vcc, 0, v59, vcc
    v_addc_co_u32 v59, s[4:5], 0, v59, s[4:5]
    v_addc_co_u32 v59, s[6:7], 0, v59, s[6:7]
    v_cmp_gt_u32 vcc, s90, v57
    v_cmp_gt_u32 s[4:5], s91, v57
    v_cmp_gt_u32 s[6:7], s92, v57
    v_addc_co_u32 v59, vcc, 0, v59, vcc
    v_addc_co_u32 v59, s[4:5], 0, v59, s[4:5]
    v_addc_co_u32 v59, s[6:7], 0, v59, s[6:7]
    v_cmp_gt_u32 vcc, s93, v57
    v_cmp_gt_u32 s[4:5], s94, v57
    v_cmp_gt_u32 s[6:7], s95, v57
    v_addc_co_u32 v59, vcc, 0, v59, vcc
    v_addc_co_u32 v59, s[4:5], 0, v59, s[4:5]
    v_addc_co_u32 v59, s[6:7], 0, v59, s[6:7]
    v_cmp_gt_u32 vcc, s96, v57
    v_cmp_gt_u32 s[4:5], s97, v57
    v_cmp_gt_u32 s[6:7], s98, v57
    v_addc_co_u32 v59, vcc, 0, v59, vcc
    v_addc_co_u32 v59, s[4:5], 0, v59, s[4:5]
    v_addc_co_u32 v59, s[6:7], 0, v59, s[6:7]
    v_cmp_gt_u32 vcc, s99, v57
    s_nop 1
    v_addc_co_u32 v59, vcc, 0, v59, vcc
    v_readlane_b32 s84, v57, 16
    v_readlane_b32 s85, v57, 17
    v_readlane_b32 s86, v57, 18
    v_readlane_b32 s87, v57, 19
    v_readlane_b32 s88, v57, 20
    v_readlane_b32 s89, v57, 21
    v_readlane_b32 s90, v57, 22
    v_readlane_b32 s91, v57, 23
    v_readlane_b32 s92, v57, 24
    v_readlane_b32 s93, v57, 25
    v_readlane_b32 s94, v57, 26
    v_readlane_b32 s95, v57, 27
    v_readlane_b32 s96, v57, 28
    v_readlane_b32 s97, v57, 29
    v_readlane_b32 s98, v57, 30
    v_readlane_b32 s99, v57, 31
    v_cmp_gt_u32 vcc, s84, v57
    v_cmp_gt_u32 s[4:5], s85, v57
    v_cmp_gt_u32 s[6:7], s86, v57
    v_addc_co_u32 v59, vcc, 0, v59, vcc
    v_addc_co_u32 v59, s[4:5], 0, v59, s[4:5]
    v_addc_co_u32 v59, s[6:7], 0, v59, s[6:7]
    v_cmp_gt_u32 vcc, s87, v57
    v_cmp_gt_u32 s[4:5], s88, v57
    v_cmp_gt_u32 s[6:7], s89, v57
    v_addc_co_u32 v59, vcc, 0, v59, vcc
    v_addc_co_u32 v59, s[4:5], 0, v59, s[4:5]
    v_addc_co_u32 v59, s[6:7], 0, v59, s[6:7]
    v_cmp_gt_u32 vcc, s90, v57
    v_cmp_gt_u32 s[4:5], s91, v57
    v_cmp_gt_u32 s[6:7], s92, v57
    v_addc_co_u32 v59, vcc, 0, v59, vcc
    v_addc_co_u32 v59, s[4:5], 0, v59, s[4:5]
    v_addc_co_u32 v59, s[6:7], 0, v59, s[6:7]
    v_cmp_gt_u32 vcc, s93, v57
    v_cmp_gt_u32 s[4:5], s94, v57
    v_cmp_gt_u32 s[6:7], s95, v57
    v_addc_co_u32 v59, vcc, 0, v59, vcc
    v_addc_co_u32 v59, s[4:5], 0, v59, s[4:5]
    v_addc_co_u32 v59, s[6:7], 0, v59, s[6:7]
    v_cmp_gt_u32 vcc, s96, v57
    v_cmp_gt_u32 s[4:5], s97, v57
    v_cmp_gt_u32 s[6:7], s98, v57
    v_addc_co_u32 v59, vcc, 0, v59, vcc
    v_addc_co_u32 v59, s[4:5], 0, v59, s[4:5]
    v_addc_co_u32 v59, s[6:7], 0, v59, s[6:7]
    v_cmp_gt_u32 vcc, s99, v57
    s_nop 1
    v_addc_co_u32 v59, vcc, 0, v59, vcc
    v_readlane_b32 s84, v57, 32
    v_readlane_b32 s85, v57, 33
    v_readlane_b32 s86, v57, 34
    v_readlane_b32 s87, v57, 35
    v_readlane_b32 s88, v57, 36
    v_readlane_b32 s89, v57, 37
    v_readlane_b32 s90, v57, 38
    v_readlane_b32 s91, v57, 39
    v_cmp_gt_u32 vcc, s84, v57
    v_cmp_gt_u32 s[4:5], s85, v57
    v_cmp_gt_u32 s[6:7], s86, v57
    v_addc_co_u32 v59, vcc, 0, v59, vcc
    v_addc_co_u32 v59, s[4:5], 0, v59, s[4:5]
    v_addc_co_u32 v59, s[6:7], 0, v59, s[6:7]
    v_cmp_gt_u32 vcc, s87, v57
    v_cmp_gt_u32 s[4:5], s88, v57
    v_cmp_gt_u32 s[6:7], s89, v57
    v_addc_co_u32 v59, vcc, 0, v59, vcc
    v_addc_co_u32 v59, s[4:5], 0, v59, s[4:5]
    v_addc_co_u32 v59, s[6:7], 0, v59, s[6:7]
    v_cmp_gt_u32 vcc, s90, v57
    v_cmp_gt_u32 s[4:5], s91, v57
    s_nop 0
    v_addc_co_u32 v59, vcc, 0, v59, vcc
    v_addc_co_u32 v59, s[4:5], 0, v59, s[4:5]
    s_sub_u32 s53, 7, s3
    s_add_u32 s54, s3, 0
    v_cmp_eq_u32 vcc, s54, v59
    s_ff1_i32_b64 s56, vcc
    s_add_u32 s54, s53, 8
    v_cmp_eq_u32 vcc, s54, v59
    s_ff1_i32_b64 s57, vcc
    s_add_u32 s54, s3, 16
    v_cmp_eq_u32 vcc, s54, v59
    s_ff1_i32_b64 s58, vcc
    s_add_u32 s54, s53, 24
    v_cmp_eq_u32 vcc, s54, v59
    s_ff1_i32_b64 s59, vcc
    s_add_u32 s54, s3, 32
    v_cmp_eq_u32 vcc, s54, v59
    s_ff1_i32_b64 s60, vcc
L_assigned:
    v_and_b32 v61, 15, v1
    v_lshlrev_b32 v61, 2, v61
    v_add_u32 v61, 139776, v61
    s_lshl_b32 s84, s56, 6
    v_add_u32 v64, s84, v61
    ds_read_b32 v70, v64
    s_lshl_b32 s85, s57, 6
    v_add_u32 v65, s85, v61
    ds_read_b32 v71, v65
    s_lshl_b32 s86, s58, 6
    v_add_u32 v66, s86, v61
    ds_read_b32 v72, v66
    s_lshl_b32 s87, s59, 6
    v_add_u32 v67, s87, v61
    ds_read_b32 v73, v67
    s_lshl_b32 s88, s60, 6
    v_add_u32 v68, s88, v61
    ds_read_b32 v74, v68
    v_readlane_b32 s92, v56, s56
    v_readlane_b32 s93, v56, s57
    v_readlane_b32 s94, v56, s58
    v_readlane_b32 s95, v56, s59
    v_readlane_b32 s96, v56, s60
    s_mul_i32 s61, s3, 1040
    s_add_u32 s62, s92, s93
    s_add_u32 s62, s62, s94
    s_add_u32 s62, s62, s95
    s_add_u32 s62, s62, s96
    s_waitcnt lgkmcnt(0)
    v_add3_u32 v60, v70, v71, v72
    v_add3_u32 v60, v60, v73, v74
    v_mov_b32 v61, v60
    s_nop 1
    v_add_u32_dpp v61, v61, v61 row_shr:1 row_mask:0xf bank_mask:0xf bound_ctrl:1
    s_nop 1
    v_add_u32_dpp v61, v61, v61 row_shr:2 row_mask:0xf bank_mask:0xf bound_ctrl:1
    s_nop 1
    v_add_u32_dpp v61, v61, v61 row_shr:4 row_mask:0xf bank_mask:0xf bound_ctrl:1
    s_nop 1
    v_add_u32_dpp v61, v61, v61 row_shr:8 row_mask:0xf bank_mask:0xf bound_ctrl:1
    v_sub_u32 v61, v61, v60
    v_add_u32 v61, s61, v61
    v_lshl_add_u32 v75, v61, 8, 0
    ds_write_b32 v64, v75 offset:4096
    v_add_u32 v61, v61, v70
    v_lshl_add_u32 v76, v61, 8, 16
    ds_write_b32 v65, v76 offset:4096
    v_add_u32 v61, v61, v71
    v_lshl_add_u32 v77, v61, 8, 32
    ds_write_b32 v66, v77 offset:4096
    v_add_u32 v61, v61, v72
    v_lshl_add_u32 v78, v61, 8, 48
    ds_write_b32 v67, v78 offset:4096
    v_add_u32 v61, v61, v73
    v_lshl_add_u32 v79, v61, 8, 64
    ds_write_b32 v68, v79 offset:4096
    s_cmp_le_i32 s46, 0
    s_cbranch_scc1 L_9
    v_lshl_add_u32 v44, v42, 5, v37
    v_lshl_add_u32 v45, v42, 3, v38
    v_cmp_gt_i32 vcc, s46, v36
    s_lshl_b32 s76, s45, 5
    s_add_u32 m0, s76, 65536
    s_mov_b64 exec, vcc
    buffer_load_dwordx4 v44, s[24:27], 0 offen lds
    s_lshl3_add_u32 m0, s45, 98304
    s_add_u32 s45, s45, 32
    buffer_load_dword v45, s[20:23], 0 offen lds
    s_mov_b64 exec, -1
    s_sub_i32 s46, s46, 32
L_9:
    s_waitcnt lgkmcnt(0)
    s_barrier
    ds_read_b32 v16, v28 offset:4096
    ds_read_b32 v17, v29 offset:4096
    ds_read_b32 v18, v30 offset:4096
    ds_read_b32 v19, v31 offset:4096
    v_mov_b32 v60, 0
    v_mov_b32 v61, 0
    v_lshlrev_b32 v64, 3, v0
    v_add_u32 v64, 139776, v64
    ds_write_b64 v64, v[60:61]
    v_mov_b32 v64, 147984
    ds_write_b32 v64, v60
    s_mov_b32 s53, 106496
    s_movk_i32 s54, 255
    s_waitcnt lgkmcnt(2)
    v_lshrrev_b32 v28, 8, v16
    v_add_u32 v28, v28, v32
    v_and_or_b32 v16, v16, s54, v24
    v_lshl_add_u32 v28, v28, 2, s53
    s_mov_b64 exec, s[36:37]
    ds_write_b32 v28, v16
    s_mov_b64 exec, -1
    v_lshrrev_b32 v29, 8, v17
    v_add_u32 v29, v29, v33
    v_and_or_b32 v17, v17, s54, v25
    v_lshl_add_u32 v29, v29, 2, s53
    s_mov_b64 exec, s[38:39]
    ds_write_b32 v29, v17
    s_mov_b64 exec, -1
    v_lshrrev_b32 v30, 8, v18
    v_add_u32 v30, v30, v34
    v_and_or_b32 v18, v18, s54, v26
    v_lshl_add_u32 v30, v30, 2, s53
    s_mov_b64 exec, s[40:41]
    ds_write_b32 v30, v18
    s_mov_b64 exec, -1
    v_lshrrev_b32 v31, 8, v19
    v_add_u32 v31, v31, v35
    v_and_or_b32 v19, v19, s54, v27
    v_lshl_add_u32 v31, v31, 2, s53
    s_mov_b64 exec, s[42:43]
    ds_write_b32 v31, v19
    s_mov_b64 exec, -1
    s_cmp_le_i32 s46, 0
    s_cbranch_scc1 L_10
    v_lshl_add_u32 v44, v43, 5, v37
    v_lshl_add_u32 v45, v43, 3, v38
    v_cmp_gt_i32 vcc, s46, v36
    s_lshl_b32 s76, s45, 5
    s_add_u32 m0, s76, 65536
    s_mov_b64 exec, vcc
    buffer_load_dwordx4 v44, s[24:27], 0 offen lds
    s_lshl3_add_u32 m0, s45, 98304
    s_add_u32 s45, s45, 32
    buffer_load_dword v45, s[20:23], 0 offen lds
    s_mov_b64 exec, -1
    s_sub_i32 s46, s46, 32
L_10:
L_paymore:
    s_cmp_le_i32 s46, 0
    s_cbranch_scc1 L_paydone
    ds_read_b32 v40, v39 offset:512
    v_add_u32 v39, 128, v39
    s_waitcnt lgkmcnt(0)
    s_cmp_le_i32 s46, 0
    s_cbranch_scc1 L_11
    v_lshl_add_u32 v44, v40, 5, v37
    v_lshl_add_u32 v45, v40, 3, v38
    v_cmp_gt_i32 vcc, s46, v36
    s_lshl_b32 s76, s45, 5
    s_add_u32 m0, s76, 65536
    s_mov_b64 exec, vcc
    buffer_load_dwordx4 v44, s[24:27], 0 offen lds
    s_lshl3_add_u32 m0, s45, 98304
    s_add_u32 s45, s45, 32
    buffer_load_dword v45, s[20:23], 0 offen lds
    s_mov_b64 exec, -1
    s_sub_i32 s46, s46, 32
L_11:
    s_branch L_paymore
L_paydone:
    s_lshl_b32 s61, s61, 2
    s_add_u32 s61, s61, 106496
    s_and_b32 s54, s2, 192
    s_lshl_b32 s54, s54, 1
    s_lshl4_add_u32 s54, s3, s54
    s_lshl2_add_u32 s53, s54, 4096
    v_and_b32 v11, 15, v1
    v_lshl_add_u32 v11, v11, 2, s53
    s_xor_b32 s53, s48, 1
    v_mov_b32 v79, s53
    v_mov_b32 v13, s61
    v_and_b32 v62, 3, v1
    v_lshl_add_u32 v77, v62, 2, s61
    v_bfe_u32 v62, v1, 2, 2
    v_lshl_add_u32 v78, v62, 2, s61
    v_bfe_u32 v63, v1, 4, 1
    v_lshlrev_b32 v63, 4, v63
    v_add_u32 v63, 65536, v63
    v_mov_b32 v65, 98304
    v_mov_b32 v62, 147968
    v_cmp_ne_u32 vcc, 0, v7
    v_cmp_ne_u32 s[4:5], 0, v8
    v_cmp_ne_u32 s[6:7], 0, v10
    v_cndmask_b32 v74, v62, v63, vcc
    v_cndmask_b32 v75, v62, v63, s[4:5]
    v_cndmask_b32 v76, v62, v65, s[6:7]
    s_waitcnt lgkmcnt(0)
    s_barrier
    ds_read_b128 v[68:71], v13
    ds_read_b32 v72, v77
    ds_read_b32 v73, v78
    s_cmp_lt_u32 s62, 3
    s_cbranch_scc1 L_short
    s_waitcnt lgkmcnt(2)
    v_readfirstlane_b32 s64, v68
    v_readfirstlane_b32 s65, v69
    v_readfirstlane_b32 s66, v70
    v_readfirstlane_b32 s67, v71
    s_and_b32 s76, s64, s82
    s_add_u32 m0, s63, 0
    s_lshl_b32 s76, s76, 3
    buffer_load_dwordx4 v2, s[8:11], s76 offen lds
    buffer_load_dwordx4 v3, s[8:11], s76 offen offset:1024 lds
    s_and_b32 s76, s65, s82
    s_add_u32 m0, s63, 2048
    s_lshl_b32 s76, s76, 3
    buffer_load_dwordx4 v2, s[8:11], s76 offen lds
    buffer_load_dwordx4 v3, s[8:11], s76 offen offset:1024 lds
    s_and_b32 s76, s66, s82
    s_add_u32 m0, s63, 4096
    s_lshl_b32 s76, s76, 3
    buffer_load_dwordx4 v2, s[8:11], s76 offen lds
    buffer_load_dwordx4 v3, s[8:11], s76 offen offset:1024 lds
    s_waitcnt vmcnt(6)
    s_branch L_go
L_short:
    s_waitcnt vmcnt(0) lgkmcnt(0)
    v_readfirstlane_b32 s64, v68
    v_readfirstlane_b32 s65, v69
    v_readfirstlane_b32 s66, v70
    v_readfirstlane_b32 s67, v71
    s_cmp_le_u32 s62, 0
    s_cbranch_scc1 L_go
    s_and_b32 s76, s64, s82
    s_add_u32 m0, s63, 0
    s_lshl_b32 s76, s76, 3
    buffer_load_dwordx4 v2, s[8:11], s76 offen lds
    buffer_load_dwordx4 v3, s[8:11], s76 offen offset:1024 lds
    s_cmp_le_u32 s62, 1
    s_cbranch_scc1 L_go
    s_and_b32 s76, s65, s82
    s_add_u32 m0, s63, 2048
    s_lshl_b32 s76, s76, 3
    buffer_load_dwordx4 v2, s[8:11], s76 offen lds
    buffer_load_dwordx4 v3, s[8:11], s76 offen offset:1024 lds
L_go:
    s_cmp_ge_u32 s3, 2
    s_cbranch_scc1 L_12
    s_cmp_lg_u32 s77, 0
    s_cbranch_scc1 L_12
    v_mov_b32 v62, s83
    v_mov_b32 v63, s48
    s_mov_b64 exec, 1
    buffer_store_dword v63, v62, s[32:35], 0 offen sc1
    s_mov_b64 exec, -1
L_12:
    s_waitcnt lgkmcnt(0)
    v_lshrrev_b32 v72, 22, v72
    v_lshrrev_b32 v73, 22, v73
    v_mad_u32_u24 v5, v72, v7, v74
    v_mad_u32_u24 v6, v72, v8, v75
    v_mad_u32_u24 v9, v73, v10, v76
    s_barrier
    s_cmp_eq_u32 s62, 0
    s_cbranch_scc1 L_round_done
L_group:
    s_cmp_gt_u32 s62, 8
    s_cbranch_scc1 L_13
    buffer_load_dword v79, v11, s[32:35], 0 offen sc1
L_13:
    ds_read_b64 v[64:65], v9
    ds_read_b128 v[56:59], v5
    ds_read_b128 v[60:63], v6
    ds_read_b128 v[68:71], v13 offset:16
    ds_read_b32 v72, v77 offset:16
    ds_read_b32 v73, v78 offset:16
    v_add_u32 v13, 16, v13
    v_add_u32 v77, 16, v77
    v_add_u32 v78, 16, v78
    s_waitcnt lgkmcnt(0)
    v_mfma_f32_16x16x16_bf16 v[32:35], v[14:15], v[64:65], 0
    v_mfma_f32_16x16x32_bf16 v[16:19], v[56:59], a[0:3], 0
    v_mfma_f32_16x16x32_bf16 v[20:23], v[56:59], a[8:11], 0
    v_mfma_f32_16x16x32_bf16 v[24:27], v[56:59], a[16:19], 0
    v_mfma_f32_16x16x32_bf16 v[28:31], v[56:59], a[24:27], 0
    v_mfma_f32_16x16x32_bf16 v[16:19], v[60:63], a[4:7], v[16:19]
    v_mfma_f32_16x16x32_bf16 v[20:23], v[60:63], a[12:15], v[20:23]
    v_mfma_f32_16x16x32_bf16 v[24:27], v[60:63], a[20:23], v[24:27]
    v_mfma_f32_16x16x32_bf16 v[28:31], v[60:63], a[28:31], v[28:31]
    v_readfirstlane_b32 s68, v68
    v_readfirstlane_b32 s69, v69
    v_readfirstlane_b32 s70, v70
    v_readfirstlane_b32 s71, v71
    v_cvt_pk_bf16_f32 v64, v32, v33
    v_cvt_pk_bf16_f32 v65, v34, v35
    v_lshrrev_b32 v72, 22, v72
    v_lshrrev_b32 v73, 22, v73
    v_mad_u32_u24 v5, v72, v7, v74
    v_mad_u32_u24 v6, v72, v8, v75
    v_mad_u32_u24 v9, v73, v10, v76
    s_cmp_ge_u32 s62, 3
    s_cbranch_scc1 L_14
    s_waitcnt vmcnt(0)
L_14:
    s_waitcnt vmcnt(4)
    ds_read_b64_tr_b16 v[48:49], v4 offset:0
    ds_read_b64_tr_b16 v[50:51], v4 offset:256
    ds_read_b64_tr_b16 v[52:53], v4 offset:512
    ds_read_b64_tr_b16 v[54:55], v4 offset:768
    s_cmp_le_u32 s62, 3
    s_cbranch_scc1 L_15
    s_and_b32 s76, s67, s82
    s_add_u32 m0, s63, 6144
    s_lshl_b32 s76, s76, 3
    buffer_load_dwordx4 v2, s[8:11], s76 offen lds
    buffer_load_dwordx4 v3, s[8:11], s76 offen offset:1024 lds
L_15:
    s_waitcnt lgkmcnt(0)
    v_mfma_f32_4x4x4_16b_bf16 v[32:35], v[64:65], v[48:49], 0 cbsz:4 abid:0
    v_mfma_f32_4x4x4_16b_bf16 v[36:39], v[64:65], v[50:51], 0 cbsz:4 abid:0
    v_mfma_f32_4x4x4_16b_bf16 v[40:43], v[64:65], v[52:53], 0 cbsz:4 abid:0
    v_mfma_f32_4x4x4_16b_bf16 v[44:47], v[64:65], v[54:55], 0 cbsz:4 abid:0
    s_nop 0
    s_set_gpr_idx_on s64, gpr_idx(SRC2,DST)
    v_pk_fma_f32 v[80:81], v[32:33], v[16:17], v[80:81] op_sel:[0,0,0] op_sel_hi:[1,0,1]
    v_pk_fma_f32 v[82:83], v[34:35], v[16:17], v[82:83] op_sel:[0,0,0] op_sel_hi:[1,0,1]
    v_pk_fma_f32 v[84:85], v[36:37], v[20:21], v[84:85] op_sel:[0,0,0] op_sel_hi:[1,0,1]
    v_pk_fma_f32 v[86:87], v[38:39], v[20:21], v[86:87] op_sel:[0,0,0] op_sel_hi:[1,0,1]
    v_pk_fma_f32 v[88:89], v[40:41], v[24:25], v[88:89] op_sel:[0,0,0] op_sel_hi:[1,0,1]
    v_pk_fma_f32 v[90:91], v[42:43], v[24:25], v[90:91] op_sel:[0,0,0] op_sel_hi:[1,0,1]
    v_pk_fma_f32 v[92:93], v[44:45], v[28:29], v[92:93] op_sel:[0,0,0] op_sel_hi:[1,0,1]
    v_pk_fma_f32 v[94:95], v[46:47], v[28:29], v[94:95] op_sel:[0,0,0] op_sel_hi:[1,0,1]
    s_set_gpr_idx_off
    s_mov_b32 s64, s68
    s_sub_u32 s62, s62, 1
    s_cmp_eq_u32 s62, 0
    s_cbranch_scc1 L_round_done
    s_cmp_ge_u32 s62, 3
    s_cbranch_scc1 L_16
    s_waitcnt vmcnt(0)
L_16:
    s_waitcnt vmcnt(4)
    ds_read_b64_tr_b16 v[48:49], v4 offset:2048
    ds_read_b64_tr_b16 v[50:51], v4 offset:2304
    ds_read_b64_tr_b16 v[52:53], v4 offset:2560
    ds_read_b64_tr_b16 v[54:55], v4 offset:2816
    s_cmp_le_u32 s62, 3
    s_cbranch_scc1 L_17
    s_and_b32 s76, s68, s82
    s_add_u32 m0, s63, 0
    s_lshl_b32 s76, s76, 3
    buffer_load_dwordx4 v2, s[8:11], s76 offen lds
    buffer_load_dwordx4 v3, s[8:11], s76 offen offset:1024 lds
L_17:
    s_waitcnt lgkmcnt(0)
    v_mfma_f32_4x4x4_16b_bf16 v[32:35], v[64:65], v[48:49], 0 cbsz:4 abid:1
    v_mfma_f32_4x4x4_16b_bf16 v[36:39], v[64:65], v[50:51], 0 cbsz:4 abid:1
    v_mfma_f32_4x4x4_16b_bf16 v[40:43], v[64:65], v[52:53], 0 cbsz:4 abid:1
    v_mfma_f32_4x4x4_16b_bf16 v[44:47], v[64:65], v[54:55], 0 cbsz:4 abid:1
    s_nop 0
    s_set_gpr_idx_on s65, gpr_idx(SRC2,DST)
    v_pk_fma_f32 v[80:81], v[32:33], v[16:17], v[80:81] op_sel:[0,1,0] op_sel_hi:[1,1,1]
    v_pk_fma_f32 v[82:83], v[34:35], v[16:17], v[82:83] op_sel:[0,1,0] op_sel_hi:[1,1,1]
    v_pk_fma_f32 v[84:85], v[36:37], v[20:21], v[84:85] op_sel:[0,1,0] op_sel_hi:[1,1,1]
    v_pk_fma_f32 v[86:87], v[38:39], v[20:21], v[86:87] op_sel:[0,1,0] op_sel_hi:[1,1,1]
    v_pk_fma_f32 v[88:89], v[40:41], v[24:25], v[88:89] op_sel:[0,1,0] op_sel_hi:[1,1,1]
    v_pk_fma_f32 v[90:91], v[42:43], v[24:25], v[90:91] op_sel:[0,1,0] op_sel_hi:[1,1,1]
    v_pk_fma_f32 v[92:93], v[44:45], v[28:29], v[92:93] op_sel:[0,1,0] op_sel_hi:[1,1,1]
    v_pk_fma_f32 v[94:95], v[46:47], v[28:29], v[94:95] op_sel:[0,1,0] op_sel_hi:[1,1,1]
    s_set_gpr_idx_off
    s_mov_b32 s65, s69
    s_sub_u32 s62, s62, 1
    s_cmp_eq_u32 s62, 0
    s_cbranch_scc1 L_round_done
    s_cmp_ge_u32 s62, 3
    s_cbranch_scc1 L_18
    s_waitcnt vmcnt(0)
L_18:
    s_waitcnt vmcnt(4)
    ds_read_b64_tr_b16 v[48:49], v4 offset:4096
    ds_read_b64_tr_b16 v[50:51], v4 offset:4352
    ds_read_b64_tr_b16 v[52:53], v4 offset:4608
    ds_read_b64_tr_b16 v[54:55], v4 offset:4864
    s_cmp_le_u32 s62, 3
    s_cbranch_scc1 L_19
    s_and_b32 s76, s69, s82
    s_add_u32 m0, s63, 2048
    s_lshl_b32 s76, s76, 3
    buffer_load_dwordx4 v2, s[8:11], s76 offen lds
    buffer_load_dwordx4 v3, s[8:11], s76 offen offset:1024 lds
L_19:
    s_waitcnt lgkmcnt(0)
    v_mfma_f32_4x4x4_16b_bf16 v[32:35], v[64:65], v[48:49], 0 cbsz:4 abid:2
    v_mfma_f32_4x4x4_16b_bf16 v[36:39], v[64:65], v[50:51], 0 cbsz:4 abid:2
    v_mfma_f32_4x4x4_16b_bf16 v[40:43], v[64:65], v[52:53], 0 cbsz:4 abid:2
    v_mfma_f32_4x4x4_16b_bf16 v[44:47], v[64:65], v[54:55], 0 cbsz:4 abid:2
    s_nop 0
    s_set_gpr_idx_on s66, gpr_idx(SRC2,DST)
    v_pk_fma_f32 v[80:81], v[32:33], v[18:19], v[80:81] op_sel:[0,0,0] op_sel_hi:[1,0,1]
    v_pk_fma_f32 v[82:83], v[34:35], v[18:19], v[82:83] op_sel:[0,0,0] op_sel_hi:[1,0,1]
    v_pk_fma_f32 v[84:85], v[36:37], v[22:23], v[84:85] op_sel:[0,0,0] op_sel_hi:[1,0,1]
    v_pk_fma_f32 v[86:87], v[38:39], v[22:23], v[86:87] op_sel:[0,0,0] op_sel_hi:[1,0,1]
    v_pk_fma_f32 v[88:89], v[40:41], v[26:27], v[88:89] op_sel:[0,0,0] op_sel_hi:[1,0,1]
    v_pk_fma_f32 v[90:91], v[42:43], v[26:27], v[90:91] op_sel:[0,0,0] op_sel_hi:[1,0,1]
    v_pk_fma_f32 v[92:93], v[44:45], v[30:31], v[92:93] op_sel:[0,0,0] op_sel_hi:[1,0,1]
    v_pk_fma_f32 v[94:95], v[46:47], v[30:31], v[94:95] op_sel:[0,0,0] op_sel_hi:[1,0,1]
    s_set_gpr_idx_off
    s_mov_b32 s66, s70
    s_sub_u32 s62, s62, 1
    s_cmp_eq_u32 s62, 0
    s_cbranch_scc1 L_round_done
    s_cmp_ge_u32 s62, 3
    s_cbranch_scc1 L_20
    s_waitcnt vmcnt(0)
L_20:
    s_waitcnt vmcnt(4)
    ds_read_b64_tr_b16 v[48:49], v4 offset:6144
    ds_read_b64_tr_b16 v[50:51], v4 offset:6400
    ds_read_b64_tr_b16 v[52:53], v4 offset:6656
    ds_read_b64_tr_b16 v[54:55], v4 offset:6912
    s_cmp_le_u32 s62, 3
    s_cbranch_scc1 L_21
    s_and_b32 s76, s70, s82
    s_add_u32 m0, s63, 4096
    s_lshl_b32 s76, s76, 3
    buffer_load_dwordx4 v2, s[8:11], s76 offen lds
    buffer_load_dwordx4 v3, s[8:11], s76 offen offset:1024 lds
L_21:
    s_waitcnt lgkmcnt(0)
    v_mfma_f32_4x4x4_16b_bf16 v[32:35], v[64:65], v[48:49], 0 cbsz:4 abid:3
    v_mfma_f32_4x4x4_16b_bf16 v[36:39], v[64:65], v[50:51], 0 cbsz:4 abid:3
    v_mfma_f32_4x4x4_16b_bf16 v[40:43], v[64:65], v[52:53], 0 cbsz:4 abid:3
    v_mfma_f32_4x4x4_16b_bf16 v[44:47], v[64:65], v[54:55], 0 cbsz:4 abid:3
    s_nop 0
    s_set_gpr_idx_on s67, gpr_idx(SRC2,DST)
    v_pk_fma_f32 v[80:81], v[32:33], v[18:19], v[80:81] op_sel:[0,1,0] op_sel_hi:[1,1,1]
    v_pk_fma_f32 v[82:83], v[34:35], v[18:19], v[82:83] op_sel:[0,1,0] op_sel_hi:[1,1,1]
    v_pk_fma_f32 v[84:85], v[36:37], v[22:23], v[84:85] op_sel:[0,1,0] op_sel_hi:[1,1,1]
    v_pk_fma_f32 v[86:87], v[38:39], v[22:23], v[86:87] op_sel:[0,1,0] op_sel_hi:[1,1,1]
    v_pk_fma_f32 v[88:89], v[40:41], v[26:27], v[88:89] op_sel:[0,1,0] op_sel_hi:[1,1,1]
    v_pk_fma_f32 v[90:91], v[42:43], v[26:27], v[90:91] op_sel:[0,1,0] op_sel_hi:[1,1,1]
    v_pk_fma_f32 v[92:93], v[44:45], v[30:31], v[92:93] op_sel:[0,1,0] op_sel_hi:[1,1,1]
    v_pk_fma_f32 v[94:95], v[46:47], v[30:31], v[94:95] op_sel:[0,1,0] op_sel_hi:[1,1,1]
    s_set_gpr_idx_off
    s_mov_b32 s67, s71
    s_sub_u32 s62, s62, 1
    s_cmp_eq_u32 s62, 0
    s_cbranch_scc0 L_group
L_round_done:
    s_add_u32 s77, s77, 1
    s_cmp_lg_u32 s78, 0
    s_cbranch_scc1 L_scan
    s_and_b32 s54, s2, 192
    s_lshl_b32 s54, s54, 1
    s_lshl4_add_u32 s54, s3, s54
    s_lshl_b32 s53, s54, 10
    s_add_u32 s53, s53, 1048576
    v_lshl_add_u32 v18, v1, 4, s53
    s_mov_b32 s55, 0
L_pollw:
    s_waitcnt vmcnt(0)
    v_cmp_ne_u32 vcc, s48, v79
    s_cbranch_vccz L_gotw
    buffer_load_dword v79, v11, s[32:35], 0 offen sc1
    s_sleep 1
    s_add_u32 s55, s55, 1
    s_cmp_lt_u32 s55, 0x400000
    s_cbranch_scc1 L_pollw
L_gotw:
    buffer_load_dwordx4 a[32:35], v18, s[32:35], 0 offen offset:0 sc1
    buffer_load_dwordx4 a[36:39], v18, s[32:35], 0 offen offset:1024 sc1
    buffer_load_dwordx4 a[40:43], v18, s[32:35], 0 offen offset:2048 sc1
    buffer_load_dwordx4 a[44:47], v18, s[32:35], 0 offen offset:3072 sc1
    v_add_u32 v18, 4096, v18
    buffer_load_dwordx4 a[48:51], v18, s[32:35], 0 offen offset:0 sc1
    buffer_load_dwordx4 a[52:55], v18, s[32:35], 0 offen offset:1024 sc1
    buffer_load_dwordx4 a[56:59], v18, s[32:35], 0 offen offset:2048 sc1
    buffer_load_dwordx4 a[60:63], v18, s[32:35], 0 offen offset:3072 sc1
    v_add_u32 v18, 4096, v18
    buffer_load_dwordx4 a[64:67], v18, s[32:35], 0 offen offset:0 sc1
    buffer_load_dwordx4 a[68:71], v18, s[32:35], 0 offen offset:1024 sc1
    buffer_load_dwordx4 a[72:75], v18, s[32:35], 0 offen offset:2048 sc1
    buffer_load_dwordx4 a[76:79], v18, s[32:35], 0 offen offset:3072 sc1
    v_add_u32 v18, 4096, v18
    buffer_load_dwordx4 a[80:83], v18, s[32:35], 0 offen offset:0 sc1
    buffer_load_dwordx4 a[84:87], v18, s[32:35], 0 offen offset:1024 sc1
    buffer_load_dwordx4 a[88:91], v18, s[32:35], 0 offen offset:2048 sc1
    buffer_load_dwordx4 a[92:95], v18, s[32:35], 0 offen offset:3072 sc1
    v_add_u32 v18, 4096, v18
    v_mul_u32_u24 v16, 320, v1
    v_lshrrev_b32 v17, 2, v1
    v_lshl_add_u32 v16, v17, 3, v16
    s_lshl_b32 s53, s56, 3
    v_add_u32 v17, s53, v16
    s_lshl_b32 s53, s57, 3
    v_add_u32 v18, s53, v16
    s_lshl_b32 s53, s58, 3
    v_add_u32 v19, s53, v16
    s_lshl_b32 s53, s59, 3
    v_add_u32 v20, s53, v16
    s_lshl_b32 s53, s60, 3
    v_add_u32 v21, s53, v16
    v_cvt_pk_bf16_f32 v24, v80, v81
    v_cvt_pk_bf16_f32 v25, v82, v83
    v_cvt_pk_bf16_f32 v26, v84, v85
    v_cvt_pk_bf16_f32 v27, v86, v87
    v_cvt_pk_bf16_f32 v28, v88, v89
    v_cvt_pk_bf16_f32 v29, v90, v91
    v_cvt_pk_bf16_f32 v30, v92, v93
    v_cvt_pk_bf16_f32 v31, v94, v95
    v_cvt_pk_bf16_f32 v32, v96, v97
    v_cvt_pk_bf16_f32 v33, v98, v99
    v_cvt_pk_bf16_f32 v34, v100, v101
    v_cvt_pk_bf16_f32 v35, v102, v103
    v_cvt_pk_bf16_f32 v36, v104, v105
    v_cvt_pk_bf16_f32 v37, v106, v107
    v_cvt_pk_bf16_f32 v38, v108, v109
    v_cvt_pk_bf16_f32 v39, v110, v111
    v_cvt_pk_bf16_f32 v40, v112, v113
    v_cvt_pk_bf16_f32 v41, v114, v115
    v_cvt_pk_bf16_f32 v42, v116, v117
    v_cvt_pk_bf16_f32 v43, v118, v119
    v_cvt_pk_bf16_f32 v44, v120, v121
    v_cvt_pk_bf16_f32 v45, v122, v123
    v_cvt_pk_bf16_f32 v46, v124, v125
    v_cvt_pk_bf16_f32 v47, v126, v127
    v_cvt_pk_bf16_f32 v48, v128, v129
    v_cvt_pk_bf16_f32 v49, v130, v131
    v_cvt_pk_bf16_f32 v50, v132, v133
    v_cvt_pk_bf16_f32 v51, v134, v135
    v_cvt_pk_bf16_f32 v52, v136, v137
    v_cvt_pk_bf16_f32 v53, v138, v139
    v_cvt_pk_bf16_f32 v54, v140, v141
    v_cvt_pk_bf16_f32 v55, v142, v143
    v_cvt_pk_bf16_f32 v56, v144, v145
    v_cvt_pk_bf16_f32 v57, v146, v147
    v_cvt_pk_bf16_f32 v58, v148, v149
    v_cvt_pk_bf16_f32 v59, v150, v151
    v_cvt_pk_bf16_f32 v60, v152, v153
    v_cvt_pk_bf16_f32 v61, v154, v155
    v_cvt_pk_bf16_f32 v62, v156, v157
    v_cvt_pk_bf16_f32 v63, v158, v159
    v_lshrrev_b32 v70, 5, v1
    v_mul_u32_u24 v71, 2576, v70
    v_bfe_u32 v72, v1, 2, 2
    v_mul_u32_u24 v74, 320, v72
    v_bfe_u32 v73, v1, 4, 1
    v_lshl_add_u32 v71, v73, 5, v71
    v_and_b32 v73, 3, v1
    v_lshl_add_u32 v71, v73, 3, v71
    v_add_u32 v2, v71, v74
    v_add_u32 v3, 41216, v2
    s_mul_i32 s53, s3, 5120
    s_add_u32 s53, s53, 82432
    v_and_b32 v74, 31, v1
    v_mul_u32_u24 v74, 80, v74
    v_lshl_add_u32 v74, v70, 3, v74
    v_add_u32 v5, s53, v74
    v_lshrrev_b32 v74, 2, v1
    v_mul_u32_u24 v74, 80, v74
    v_lshl_add_u32 v74, v73, 4, v74
    v_add_u32 v6, s53, v74
    v_lshrrev_b32 v74, 4, v1
    v_lshlrev_b32 v74, 19, v74
    v_lshl_add_u32 v74, v72, 9, v74
    v_lshl_add_u32 v74, v73, 4, v74
    s_lshl_b32 s53, s2, 11
    s_lshl_b32 s54, s3, 6
    s_add_u32 s53, s53, s54
    v_add_u32 v4, s53, v74
    s_barrier
    ds_write_b64 v17, v[24:25] offset:0
    ds_write_b64 v17, v[26:27] offset:20608
    ds_write_b64 v17, v[28:29] offset:41216
    ds_write_b64 v17, v[30:31] offset:61824
    ds_write_b64 v18, v[32:33] offset:0
    ds_write_b64 v18, v[34:35] offset:20608
    ds_write_b64 v18, v[36:37] offset:41216
    ds_write_b64 v18, v[38:39] offset:61824
    ds_write_b64 v19, v[40:41] offset:0
    ds_write_b64 v19, v[42:43] offset:20608
    ds_write_b64 v19, v[44:45] offset:41216
    ds_write_b64 v19, v[46:47] offset:61824
    ds_write_b64 v20, v[48:49] offset:0
    ds_write_b64 v20, v[50:51] offset:20608
    ds_write_b64 v20, v[52:53] offset:41216
    ds_write_b64 v20, v[54:55] offset:61824
    ds_write_b64 v21, v[56:57] offset:0
    ds_write_b64 v21, v[58:59] offset:20608
    ds_write_b64 v21, v[60:61] offset:41216
    ds_write_b64 v21, v[62:63] offset:61824
    s_waitcnt lgkmcnt(0)
    s_barrier
    ds_read_b64_tr_b16 v[16:17], v2 offset:0
    ds_read_b64_tr_b16 v[18:19], v2 offset:1288
    ds_read_b64_tr_b16 v[20:21], v2 offset:5152
    ds_read_b64_tr_b16 v[22:23], v2 offset:6440
    ds_read_b64_tr_b16 v[24:25], v2 offset:10304
    ds_read_b64_tr_b16 v[26:27], v2 offset:11592
    ds_read_b64_tr_b16 v[28:29], v2 offset:15456
    ds_read_b64_tr_b16 v[30:31], v2 offset:16744
    ds_read_b64_tr_b16 v[32:33], v2 offset:20608
    ds_read_b64_tr_b16 v[34:35], v2 offset:21896
    ds_read_b64_tr_b16 v[36:37], v2 offset:25760
    ds_read_b64_tr_b16 v[38:39], v2 offset:27048
    s_waitcnt vmcnt(0)
    s_waitcnt lgkmcnt(10)
    v_mfma_f32_32x32x16_bf16 v[48:63], a[32:35], v[16:19], 0
    ds_read_b64_tr_b16 v[40:41], v2 offset:30912
    ds_read_b64_tr_b16 v[42:43], v2 offset:32200
    s_waitcnt lgkmcnt(10)
    v_mfma_f32_32x32x16_bf16 v[48:63], a[36:39], v[20:23], v[48:63]
    ds_read_b64_tr_b16 v[44:45], v2 offset:36064
    ds_read_b64_tr_b16 v[46:47], v2 offset:37352
    s_waitcnt lgkmcnt(10)
    v_mfma_f32_32x32x16_bf16 v[48:63], a[40:43], v[24:27], v[48:63]
    ds_read_b64_tr_b16 v[16:17], v3 offset:0
    ds_read_b64_tr_b16 v[18:19], v3 offset:1288
    s_waitcnt lgkmcnt(10)
    v_mfma_f32_32x32x16_bf16 v[48:63], a[44:47], v[28:31], v[48:63]
    ds_read_b64_tr_b16 v[20:21], v3 offset:5152
    ds_read_b64_tr_b16 v[22:23], v3 offset:6440
    s_waitcnt lgkmcnt(10)
    v_mfma_f32_32x32x16_bf16 v[48:63], a[48:51], v[32:35], v[48:63]
    ds_read_b64_tr_b16 v[24:25], v3 offset:10304
    ds_read_b64_tr_b16 v[26:27], v3 offset:11592
    s_waitcnt lgkmcnt(10)
    v_mfma_f32_32x32x16_bf16 v[48:63], a[52:55], v[36:39], v[48:63]
    ds_read_b64_tr_b16 v[28:29], v3 offset:15456
    ds_read_b64_tr_b16 v[30:31], v3 offset:16744
    s_waitcnt lgkmcnt(10)
    v_mfma_f32_32x32x16_bf16 v[48:63], a[56:59], v[40:43], v[48:63]
    ds_read_b64_tr_b16 v[32:33], v3 offset:20608
    ds_read_b64_tr_b16 v[34:35], v3 offset:21896
    s_waitcnt lgkmcnt(10)
    v_mfma_f32_32x32x16_bf16 v[48:63], a[60:63], v[44:47], v[48:63]
    ds_read_b64_tr_b16 v[36:37], v3 offset:25760
    ds_read_b64_tr_b16 v[38:39], v3 offset:27048
    s_waitcnt lgkmcnt(10)
    v_mfma_f32_32x32x16_bf16 v[48:63], a[64:67], v[16:19], v[48:63]
    ds_read_b64_tr_b16 v[40:41], v3 offset:30912
    ds_read_b64_tr_b16 v[42:43], v3 offset:32200
    s_waitcnt lgkmcnt(10)
    v_mfma_f32_32x32x16_bf16 v[48:63], a[68:71], v[20:23], v[48:63]
    ds_read_b64_tr_b16 v[44:45], v3 offset:36064
    ds_read_b64_tr_b16 v[46:47], v3 offset:37352
    s_waitcnt lgkmcnt(10)
    v_mfma_f32_32x32x16_bf16 v[48:63], a[72:75], v[24:27], v[48:63]
    ds_read_b64_tr_b16 v[16:17], v2 offset:64
    ds_read_b64_tr_b16 v[18:19], v2 offset:1352
    s_waitcnt lgkmcnt(10)
    v_mfma_f32_32x32x16_bf16 v[48:63], a[76:79], v[28:31], v[48:63]
    ds_read_b64_tr_b16 v[20:21], v2 offset:5216
    ds_read_b64_tr_b16 v[22:23], v2 offset:6504
    s_waitcnt lgkmcnt(10)
    v_mfma_f32_32x32x16_bf16 v[48:63], a[80:83], v[32:35], v[48:63]
    ds_read_b64_tr_b16 v[24:25], v2 offset:10368
    ds_read_b64_tr_b16 v[26:27], v2 offset:11656
    s_waitcnt lgkmcnt(10)
    v_mfma_f32_32x32x16_bf16 v[48:63], a[84:87], v[36:39], v[48:63]
    ds_read_b64_tr_b16 v[28:29], v2 offset:15520
    ds_read_b64_tr_b16 v[30:31], v2 offset:16808
    s_waitcnt lgkmcnt(10)
    v_mfma_f32_32x32x16_bf16 v[48:63], a[88:91], v[40:43], v[48:63]
    ds_read_b64_tr_b16 v[32:33], v2 offset:20672
    ds_read_b64_tr_b16 v[34:35], v2 offset:21960
    s_waitcnt lgkmcnt(10)
    v_mfma_f32_32x32x16_bf16 v[48:63], a[92:95], v[44:47], v[48:63]
    ds_read_b64_tr_b16 v[36:37], v2 offset:25824
    ds_read_b64_tr_b16 v[38:39], v2 offset:27112
    s_waitcnt lgkmcnt(10)
    v_mfma_f32_32x32x16_bf16 v[64:79], a[32:35], v[16:19], 0
    ds_read_b64_tr_b16 v[40:41], v2 offset:30976
    ds_read_b64_tr_b16 v[42:43], v2 offset:32264
    s_waitcnt lgkmcnt(10)
    v_mfma_f32_32x32x16_bf16 v[64:79], a[36:39], v[20:23], v[64:79]
    ds_read_b64_tr_b16 v[44:45], v2 offset:36128
    ds_read_b64_tr_b16 v[46:47], v2 offset:37416
    s_waitcnt lgkmcnt(10)
    v_mfma_f32_32x32x16_bf16 v[64:79], a[40:43], v[24:27], v[64:79]
    ds_read_b64_tr_b16 v[16:17], v3 offset:64
    ds_read_b64_tr_b16 v[18:19], v3 offset:1352
    s_waitcnt lgkmcnt(10)
    v_mfma_f32_32x32x16_bf16 v[64:79], a[44:47], v[28:31], v[64:79]
    ds_read_b64_tr_b16 v[20:21], v3 offset:5216
    ds_read_b64_tr_b16 v[22:23], v3 offset:6504
    v_cvt_pk_bf16_f32 v80, v48, v49
    v_cvt_pk_bf16_f32 v81, v50, v51
    ds_write_b64 v5, v[80:81] offset:0
    s_waitcnt lgkmcnt(10)
    v_mfma_f32_32x32x16_bf16 v[64:79], a[48:51], v[32:35], v[64:79]
    ds_read_b64_tr_b16 v[24:25], v3 offset:10368
    ds_read_b64_tr_b16 v[26:27], v3 offset:11656
    v_cvt_pk_bf16_f32 v82, v52, v53
    v_cvt_pk_bf16_f32 v83, v54, v55
    ds_write_b64 v5, v[82:83] offset:16
    s_waitcnt lgkmcnt(10)
    v_mfma_f32_32x32x16_bf16 v[64:79], a[52:55], v[36:39], v[64:79]
    ds_read_b64_tr_b16 v[28:29], v3 offset:15520
    ds_read_b64_tr_b16 v[30:31], v3 offset:16808
    v_cvt_pk_bf16_f32 v84, v56, v57
    v_cvt_pk_bf16_f32 v85, v58, v59
    ds_write_b64 v5, v[84:85] offset:32
    s_waitcnt lgkmcnt(10)
    v_mfma_f32_32x32x16_bf16 v[64:79], a[56:59], v[40:43], v[64:79]
    ds_read_b64_tr_b16 v[32:33], v3 offset:20672
    ds_read_b64_tr_b16 v[34:35], v3 offset:21960
    v_cvt_pk_bf16_f32 v86, v60, v61
    v_cvt_pk_bf16_f32 v87, v62, v63
    ds_write_b64 v5, v[86:87] offset:48
    s_waitcnt lgkmcnt(10)
    v_mfma_f32_32x32x16_bf16 v[64:79], a[60:63], v[44:47], v[64:79]
    ds_read_b64_tr_b16 v[36:37], v3 offset:25824
    ds_read_b64_tr_b16 v[38:39], v3 offset:27112
    ds_read_b128 v[96:99], v6 offset:0
    ds_read_b128 v[100:103], v6 offset:1280
    s_waitcnt lgkmcnt(10)
    v_mfma_f32_32x32x16_bf16 v[64:79], a[64:67], v[16:19], v[64:79]
    ds_read_b64_tr_b16 v[40:41], v3 offset:30976
    ds_read_b64_tr_b16 v[42:43], v3 offset:32264
    s_waitcnt lgkmcnt(10)
    v_mfma_f32_32x32x16_bf16 v[64:79], a[68:71], v[20:23], v[64:79]
    ds_read_b64_tr_b16 v[44:45], v3 offset:36128
    ds_read_b64_tr_b16 v[46:47], v3 offset:37416
    s_waitcnt lgkmcnt(10)
    v_mfma_f32_32x32x16_bf16 v[64:79], a[72:75], v[24:27], v[64:79]
    ds_read_b64_tr_b16 v[16:17], v2 offset:128
    ds_read_b64_tr_b16 v[18:19], v2 offset:1416
    s_waitcnt lgkmcnt(10)
    v_mfma_f32_32x32x16_bf16 v[64:79], a[76:79], v[28:31], v[64:79]
    ds_read_b64_tr_b16 v[20:21], v2 offset:5280
    ds_read_b64_tr_b16 v[22:23], v2 offset:6568
    s_waitcnt lgkmcnt(10)
    v_mfma_f32_32x32x16_bf16 v[64:79], a[80:83], v[32:35], v[64:79]
    ds_read_b64_tr_b16 v[24:25], v2 offset:10432
    ds_read_b64_tr_b16 v[26:27], v2 offset:11720
    s_waitcnt lgkmcnt(10)
    v_mfma_f32_32x32x16_bf16 v[64:79], a[84:87], v[36:39], v[64:79]
    ds_read_b64_tr_b16 v[28:29], v2 offset:15584
    ds_read_b64_tr_b16 v[30:31], v2 offset:16872
    s_waitcnt lgkmcnt(10)
    v_mfma_f32_32x32x16_bf16 v[64:79], a[88:91], v[40:43], v[64:79]
    ds_read_b64_tr_b16 v[32:33], v2 offset:20736
    ds_read_b64_tr_b16 v[34:35], v2 offset:22024
    buffer_store_dwordx4 v[96:99], v4, s[28:31], 0 offen sc1
    v_add_u32 v4, 2097152, v4
    buffer_store_dwordx4 v[100:103], v4, s[28:31], 0 offen sc1
    v_add_u32 v4, 2097152, v4
    s_waitcnt lgkmcnt(10)
    v_mfma_f32_32x32x16_bf16 v[64:79], a[92:95], v[44:47], v[64:79]
    ds_read_b64_tr_b16 v[36:37], v2 offset:25888
    ds_read_b64_tr_b16 v[38:39], v2 offset:27176
    s_waitcnt lgkmcnt(10)
    v_mfma_f32_32x32x16_bf16 v[112:127], a[32:35], v[16:19], 0
    ds_read_b64_tr_b16 v[40:41], v2 offset:31040
    ds_read_b64_tr_b16 v[42:43], v2 offset:32328
    s_waitcnt lgkmcnt(10)
    v_mfma_f32_32x32x16_bf16 v[112:127], a[36:39], v[20:23], v[112:127]
    ds_read_b64_tr_b16 v[44:45], v2 offset:36192
    ds_read_b64_tr_b16 v[46:47], v2 offset:37480
    s_waitcnt lgkmcnt(10)
    v_mfma_f32_32x32x16_bf16 v[112:127], a[40:43], v[24:27], v[112:127]
    ds_read_b64_tr_b16 v[16:17], v3 offset:128
    ds_read_b64_tr_b16 v[18:19], v3 offset:1416
    s_waitcnt lgkmcnt(10)
    v_mfma_f32_32x32x16_bf16 v[112:127], a[44:47], v[28:31], v[112:127]
    ds_read_b64_tr_b16 v[20:21], v3 offset:5280
    ds_read_b64_tr_b16 v[22:23], v3 offset:6568
    v_cvt_pk_bf16_f32 v88, v64, v65
    v_cvt_pk_bf16_f32 v89, v66, v67
    ds_write_b64 v5, v[88:89] offset:2560
    s_waitcnt lgkmcnt(10)
    v_mfma_f32_32x32x16_bf16 v[112:127], a[48:51], v[32:35], v[112:127]
    ds_read_b64_tr_b16 v[24:25], v3 offset:10432
    ds_read_b64_tr_b16 v[26:27], v3 offset:11720
    v_cvt_pk_bf16_f32 v90, v68, v69
    v_cvt_pk_bf16_f32 v91, v70, v71
    ds_write_b64 v5, v[90:91] offset:2576
    s_waitcnt lgkmcnt(10)
    v_mfma_f32_32x32x16_bf16 v[112:127], a[52:55], v[36:39], v[112:127]
    ds_read_b64_tr_b16 v[28:29], v3 offset:15584
    ds_read_b64_tr_b16 v[30:31], v3 offset:16872
    v_cvt_pk_bf16_f32 v92, v72, v73
    v_cvt_pk_bf16_f32 v93, v74, v75
    ds_write_b64 v5, v[92:93] offset:2592
    s_waitcnt lgkmcnt(10)
    v_mfma_f32_32x32x16_bf16 v[112:127], a[56:59], v[40:43], v[112:127]
    ds_read_b64_tr_b16 v[32:33], v3 offset:20736
    ds_read_b64_tr_b16 v[34:35], v3 offset:22024
    v_cvt_pk_bf16_f32 v94, v76, v77
    v_cvt_pk_bf16_f32 v95, v78, v79
    ds_write_b64 v5, v[94:95] offset:2608
    s_waitcnt lgkmcnt(10)
    v_mfma_f32_32x32x16_bf16 v[112:127], a[60:63], v[44:47], v[112:127]
    ds_read_b64_tr_b16 v[36:37], v3 offset:25888
    ds_read_b64_tr_b16 v[38:39], v3 offset:27176
    ds_read_b128 v[104:107], v6 offset:2560
    ds_read_b128 v[108:111], v6 offset:3840
    s_waitcnt lgkmcnt(10)
    v_mfma_f32_32x32x16_bf16 v[112:127], a[64:67], v[16:19], v[112:127]
    ds_read_b64_tr_b16 v[40:41], v3 offset:31040
    ds_read_b64_tr_b16 v[42:43], v3 offset:32328
    s_waitcnt lgkmcnt(10)
    v_mfma_f32_32x32x16_bf16 v[112:127], a[68:71], v[20:23], v[112:127]
    ds_read_b64_tr_b16 v[44:45], v3 offset:36192
    ds_read_b64_tr_b16 v[46:47], v3 offset:37480
    s_waitcnt lgkmcnt(10)
    v_mfma_f32_32x32x16_bf16 v[112:127], a[72:75], v[24:27], v[112:127]
    ds_read_b64_tr_b16 v[16:17], v2 offset:192
    ds_read_b64_tr_b16 v[18:19], v2 offset:1480
    s_waitcnt lgkmcnt(10)
    v_mfma_f32_32x32x16_bf16 v[112:127], a[76:79], v[28:31], v[112:127]
    ds_read_b64_tr_b16 v[20:21], v2 offset:5344
    ds_read_b64_tr_b16 v[22:23], v2 offset:6632
    s_waitcnt lgkmcnt(10)
    v_mfma_f32_32x32x16_bf16 v[112:127], a[80:83], v[32:35], v[112:127]
    ds_read_b64_tr_b16 v[24:25], v2 offset:10496
    ds_read_b64_tr_b16 v[26:27], v2 offset:11784
    s_waitcnt lgkmcnt(10)
    v_mfma_f32_32x32x16_bf16 v[112:127], a[84:87], v[36:39], v[112:127]
    ds_read_b64_tr_b16 v[28:29], v2 offset:15648
    ds_read_b64_tr_b16 v[30:31], v2 offset:16936
    s_waitcnt lgkmcnt(10)
    v_mfma_f32_32x32x16_bf16 v[112:127], a[88:91], v[40:43], v[112:127]
    ds_read_b64_tr_b16 v[32:33], v2 offset:20800
    ds_read_b64_tr_b16 v[34:35], v2 offset:22088
    buffer_store_dwordx4 v[104:107], v4, s[28:31], 0 offen sc1
    v_add_u32 v4, 2097152, v4
    buffer_store_dwordx4 v[108:111], v4, s[28:31], 0 offen sc1
    v_add_u32 v4, 2097152, v4
    s_waitcnt lgkmcnt(10)
    v_mfma_f32_32x32x16_bf16 v[112:127], a[92:95], v[44:47], v[112:127]
    ds_read_b64_tr_b16 v[36:37], v2 offset:25952
    ds_read_b64_tr_b16 v[38:39], v2 offset:27240
    s_waitcnt lgkmcnt(10)
    v_mfma_f32_32x32x16_bf16 v[128:143], a[32:35], v[16:19], 0
    ds_read_b64_tr_b16 v[40:41], v2 offset:31104
    ds_read_b64_tr_b16 v[42:43], v2 offset:32392
    s_waitcnt lgkmcnt(10)
    v_mfma_f32_32x32x16_bf16 v[128:143], a[36:39], v[20:23], v[128:143]
    ds_read_b64_tr_b16 v[44:45], v2 offset:36256
    ds_read_b64_tr_b16 v[46:47], v2 offset:37544
    s_waitcnt lgkmcnt(10)
    v_mfma_f32_32x32x16_bf16 v[128:143], a[40:43], v[24:27], v[128:143]
    ds_read_b64_tr_b16 v[16:17], v3 offset:192
    ds_read_b64_tr_b16 v[18:19], v3 offset:1480
    s_waitcnt lgkmcnt(10)
    v_mfma_f32_32x32x16_bf16 v[128:143], a[44:47], v[28:31], v[128:143]
    ds_read_b64_tr_b16 v[20:21], v3 offset:5344
    ds_read_b64_tr_b16 v[22:23], v3 offset:6632
    v_cvt_pk_bf16_f32 v80, v112, v113
    v_cvt_pk_bf16_f32 v81, v114, v115
    ds_write_b64 v5, v[80:81] offset:0
    s_waitcnt lgkmcnt(10)
    v_mfma_f32_32x32x16_bf16 v[128:143], a[48:51], v[32:35], v[128:143]
    ds_read_b64_tr_b16 v[24:25], v3 offset:10496
    ds_read_b64_tr_b16 v[26:27], v3 offset:11784
    v_cvt_pk_bf16_f32 v82, v116, v117
    v_cvt_pk_bf16_f32 v83, v118, v119
    ds_write_b64 v5, v[82:83] offset:16
    s_waitcnt lgkmcnt(10)
    v_mfma_f32_32x32x16_bf16 v[128:143], a[52:55], v[36:39], v[128:143]
    ds_read_b64_tr_b16 v[28:29], v3 offset:15648
    ds_read_b64_tr_b16 v[30:31], v3 offset:16936
    v_cvt_pk_bf16_f32 v84, v120, v121
    v_cvt_pk_bf16_f32 v85, v122, v123
    ds_write_b64 v5, v[84:85] offset:32
    s_waitcnt lgkmcnt(10)
    v_mfma_f32_32x32x16_bf16 v[128:143], a[56:59], v[40:43], v[128:143]
    ds_read_b64_tr_b16 v[32:33], v3 offset:20800
    ds_read_b64_tr_b16 v[34:35], v3 offset:22088
    v_cvt_pk_bf16_f32 v86, v124, v125
    v_cvt_pk_bf16_f32 v87, v126, v127
    ds_write_b64 v5, v[86:87] offset:48
    s_waitcnt lgkmcnt(10)
    v_mfma_f32_32x32x16_bf16 v[128:143], a[60:63], v[44:47], v[128:143]
    ds_read_b64_tr_b16 v[36:37], v3 offset:25952
    ds_read_b64_tr_b16 v[38:39], v3 offset:27240
    ds_read_b128 v[96:99], v6 offset:0
    ds_read_b128 v[100:103], v6 offset:1280
    s_waitcnt lgkmcnt(10)
    v_mfma_f32_32x32x16_bf16 v[128:143], a[64:67], v[16:19], v[128:143]
    ds_read_b64_tr_b16 v[40:41], v3 offset:31104
    ds_read_b64_tr_b16 v[42:43], v3 offset:32392
    s_waitcnt lgkmcnt(10)
    v_mfma_f32_32x32x16_bf16 v[128:143], a[68:71], v[20:23], v[128:143]
    ds_read_b64_tr_b16 v[44:45], v3 offset:36256
    ds_read_b64_tr_b16 v[46:47], v3 offset:37544
    s_waitcnt lgkmcnt(10)
    v_mfma_f32_32x32x16_bf16 v[128:143], a[72:75], v[24:27], v[128:143]
    ds_read_b64_tr_b16 v[16:17], v2 offset:256
    ds_read_b64_tr_b16 v[18:19], v2 offset:1544
    s_waitcnt lgkmcnt(10)
    v_mfma_f32_32x32x16_bf16 v[128:143], a[76:79], v[28:31], v[128:143]
    ds_read_b64_tr_b16 v[20:21], v2 offset:5408
    ds_read_b64_tr_b16 v[22:23], v2 offset:6696
    s_waitcnt lgkmcnt(10)
    v_mfma_f32_32x32x16_bf16 v[128:143], a[80:83], v[32:35], v[128:143]
    ds_read_b64_tr_b16 v[24:25], v2 offset:10560
    ds_read_b64_tr_b16 v[26:27], v2 offset:11848
    s_waitcnt lgkmcnt(10)
    v_mfma_f32_32x32x16_bf16 v[128:143], a[84:87], v[36:39], v[128:143]
    ds_read_b64_tr_b16 v[28:29], v2 offset:15712
    ds_read_b64_tr_b16 v[30:31], v2 offset:17000
    s_waitcnt lgkmcnt(10)
    v_mfma_f32_32x32x16_bf16 v[128:143], a[88:91], v[40:43], v[128:143]
    ds_read_b64_tr_b16 v[32:33], v2 offset:20864
    ds_read_b64_tr_b16 v[34:35], v2 offset:22152
    buffer_store_dwordx4 v[96:99], v4, s[28:31], 0 offen sc1
    v_add_u32 v4, 2097152, v4
    buffer_store_dwordx4 v[100:103], v4, s[28:31], 0 offen sc1
    v_add_u32 v4, 2097152, v4
    s_waitcnt lgkmcnt(10)
    v_mfma_f32_32x32x16_bf16 v[128:143], a[92:95], v[44:47], v[128:143]
    ds_read_b64_tr_b16 v[36:37], v2 offset:26016
    ds_read_b64_tr_b16 v[38:39], v2 offset:27304
    s_waitcnt lgkmcnt(10)
    v_mfma_f32_32x32x16_bf16 v[48:63], a[32:35], v[16:19], 0
    ds_read_b64_tr_b16 v[40:41], v2 offset:31168
    ds_read_b64_tr_b16 v[42:43], v2 offset:32456
    s_waitcnt lgkmcnt(10)
    v_mfma_f32_32x32x16_bf16 v[48:63], a[36:39], v[20:23], v[48:63]
    ds_read_b64_tr_b16 v[44:45], v2 offset:36320
    ds_read_b64_tr_b16 v[46:47], v2 offset:37608
    s_waitcnt lgkmcnt(10)
    v_mfma_f32_32x32x16_bf16 v[48:63], a[40:43], v[24:27], v[48:63]
    ds_read_b64_tr_b16 v[16:17], v3 offset:256
    ds_read_b64_tr_b16 v[18:19], v3 offset:1544
    s_waitcnt lgkmcnt(10)
    v_mfma_f32_32x32x16_bf16 v[48:63], a[44:47], v[28:31], v[48:63]
    ds_read_b64_tr_b16 v[20:21], v3 offset:5408
    ds_read_b64_tr_b16 v[22:23], v3 offset:6696
    v_cvt_pk_bf16_f32 v88, v128, v129
    v_cvt_pk_bf16_f32 v89, v130, v131
    ds_write_b64 v5, v[88:89] offset:2560
    s_waitcnt lgkmcnt(10)
    v_mfma_f32_32x32x16_bf16 v[48:63], a[48:51], v[32:35], v[48:63]
    ds_read_b64_tr_b16 v[24:25], v3 offset:10560
    ds_read_b64_tr_b16 v[26:27], v3 offset:11848
    v_cvt_pk_bf16_f32 v90, v132, v133
    v_cvt_pk_bf16_f32 v91, v134, v135
    ds_write_b64 v5, v[90:91] offset:2576
    s_waitcnt lgkmcnt(10)
    v_mfma_f32_32x32x16_bf16 v[48:63], a[52:55], v[36:39], v[48:63]
    ds_read_b64_tr_b16 v[28:29], v3 offset:15712
    ds_read_b64_tr_b16 v[30:31], v3 offset:17000
    v_cvt_pk_bf16_f32 v92, v136, v137
    v_cvt_pk_bf16_f32 v93, v138, v139
    ds_write_b64 v5, v[92:93] offset:2592
    s_waitcnt lgkmcnt(10)
    v_mfma_f32_32x32x16_bf16 v[48:63], a[56:59], v[40:43], v[48:63]
    ds_read_b64_tr_b16 v[32:33], v3 offset:20864
    ds_read_b64_tr_b16 v[34:35], v3 offset:22152
    v_cvt_pk_bf16_f32 v94, v140, v141
    v_cvt_pk_bf16_f32 v95, v142, v143
    ds_write_b64 v5, v[94:95] offset:2608
    s_waitcnt lgkmcnt(10)
    v_mfma_f32_32x32x16_bf16 v[48:63], a[60:63], v[44:47], v[48:63]
    ds_read_b64_tr_b16 v[36:37], v3 offset:26016
    ds_read_b64_tr_b16 v[38:39], v3 offset:27304
    ds_read_b128 v[104:107], v6 offset:2560
    ds_read_b128 v[108:111], v6 offset:3840
    s_waitcnt lgkmcnt(10)
    v_mfma_f32_32x32x16_bf16 v[48:63], a[64:67], v[16:19], v[48:63]
    ds_read_b64_tr_b16 v[40:41], v3 offset:31168
    ds_read_b64_tr_b16 v[42:43], v3 offset:32456
    s_waitcnt lgkmcnt(10)
    v_mfma_f32_32x32x16_bf16 v[48:63], a[68:71], v[20:23], v[48:63]
    ds_read_b64_tr_b16 v[44:45], v3 offset:36320
    ds_read_b64_tr_b16 v[46:47], v3 offset:37608
    s_waitcnt lgkmcnt(10)
    v_mfma_f32_32x32x16_bf16 v[48:63], a[72:75], v[24:27], v[48:63]
    s_waitcnt lgkmcnt(8)
    v_mfma_f32_32x32x16_bf16 v[48:63], a[76:79], v[28:31], v[48:63]
    s_waitcnt lgkmcnt(6)
    v_mfma_f32_32x32x16_bf16 v[48:63], a[80:83], v[32:35], v[48:63]
    s_waitcnt lgkmcnt(4)
    v_mfma_f32_32x32x16_bf16 v[48:63], a[84:87], v[36:39], v[48:63]
    s_waitcnt lgkmcnt(2)
    v_mfma_f32_32x32x16_bf16 v[48:63], a[88:91], v[40:43], v[48:63]
    buffer_store_dwordx4 v[104:107], v4, s[28:31], 0 offen sc1
    v_add_u32 v4, 2097152, v4
    buffer_store_dwordx4 v[108:111], v4, s[28:31], 0 offen sc1
    v_add_u32 v4, 2097152, v4
    s_waitcnt lgkmcnt(0)
    v_mfma_f32_32x32x16_bf16 v[48:63], a[92:95], v[44:47], v[48:63]
    s_waitcnt lgkmcnt(0)
    s_nop 11
    v_cvt_pk_bf16_f32 v80, v48, v49
    v_cvt_pk_bf16_f32 v81, v50, v51
    v_cvt_pk_bf16_f32 v82, v52, v53
    v_cvt_pk_bf16_f32 v83, v54, v55
    v_cvt_pk_bf16_f32 v84, v56, v57
    v_cvt_pk_bf16_f32 v85, v58, v59
    v_cvt_pk_bf16_f32 v86, v60, v61
    v_cvt_pk_bf16_f32 v87, v62, v63
    ds_write_b64 v5, v[80:81] offset:0
    ds_write_b64 v5, v[82:83] offset:16
    ds_write_b64 v5, v[84:85] offset:32
    ds_write_b64 v5, v[86:87] offset:48
    ds_read_b128 v[96:99], v6 offset:0
    ds_read_b128 v[100:103], v6 offset:1280
    s_waitcnt lgkmcnt(0)
    buffer_store_dwordx4 v[96:99], v4, s[28:31], 0 offen sc1
    v_add_u32 v4, 2097152, v4
    buffer_store_dwordx4 v[100:103], v4, s[28:31], 0 offen sc1
    v_add_u32 v4, 2097152, v4
L_end:
    s_endpgm
.section .rodata,"a"
.p2align 6
.amdhsa_kernel standalone__tensor_product_equiv_mace__graph_kernel
  .amdhsa_next_free_vgpr 256
  .amdhsa_next_free_sgpr 102
  .amdhsa_accum_offset 160
  .amdhsa_group_segment_fixed_size 0
  .amdhsa_kernarg_size 88
  .amdhsa_user_sgpr_count 2
  .amdhsa_user_sgpr_kernarg_segment_ptr 1
  .amdhsa_system_sgpr_workgroup_id_x 1
  .amdhsa_float_denorm_mode_32 3
.end_amdhsa_kernel
```

```asm
; @launch grid=(256,1,1) block=(512,1,1) lds=153600
.amdgcn_target "amdgcn-amd-amdhsa--gfx950"
.text
.globl standalone__tensor_product_equiv_mace__graph_kernel
.p2align 8
.type standalone__tensor_product_equiv_mace__graph_kernel,@function
standalone__tensor_product_equiv_mace__graph_kernel:
    s_cmp_ge_u32 s2, 256
    s_cbranch_scc1 L_end
    s_load_dwordx2 s[84:85], s[0:1], 80
    s_load_dwordx16 s[64:79], s[0:1], 0
    s_load_dwordx2 s[80:81], s[0:1], 64
    v_and_b32 v1, 63, v0
    v_lshrrev_b32 v60, 6, v0
    v_mov_b32 v12, 0
    v_readfirstlane_b32 s3, v60
    s_and_b32 s55, s2, 63
    s_and_b32 s54, s2, 192
    s_mul_i32 s53, s55, 10000
    v_lshlrev_b32 v63, 4, v0
    v_add_u32 v60, s53, v63
    s_add_u32 s53, s53, 8192
    v_lshl_add_u32 v61, v0, 2, s53
    s_lshl_b32 s53, s54, 1
    v_mov_b32 v62, s53
    s_waitcnt lgkmcnt(0)
    s_mov_b32 s16, s68
    s_mov_b32 s17, s69
    s_mov_b32 s18, 640000
    s_mov_b32 s19, 0x00020000
    buffer_load_dwordx4 v[16:19], v60, s[16:19], 0 offen
    buffer_load_dword v20, v61, s[16:19], 0 offen
    s_mov_b32 s12, s66
    s_mov_b32 s13, s67
    s_mov_b32 s14, 640000
    s_mov_b32 s15, 0x00020000
    buffer_load_dwordx4 v[24:27], v60, s[12:15], 0 offen
    buffer_load_dword v28, v61, s[12:15], 0 offen
    s_mov_b32 s32, s84
    s_mov_b32 s33, s85
    s_mov_b32 s34, 20971520
    s_mov_b32 s35, 0x00020000
    buffer_load_dword v42, v62, s[32:35], 0 offen sc1
    s_mov_b32 s20, s70
    s_mov_b32 s21, s71
    s_mov_b32 s22, 1280000
    s_mov_b32 s23, 0x00020000
    v_mov_b32 v72, -1
    v_mov_b32 v73, -1
    v_mov_b32 v74, -1
    v_mov_b32 v75, -1
    ds_write_b128 v63, v[72:75] offset:0
    ds_write_b128 v63, v[72:75] offset:8192
    v_mov_b32 v68, 0
    v_mov_b32 v69, 0
    v_lshlrev_b32 v60, 3, v0
    v_add_u32 v60, 111136, v60
    ds_write_b64 v60, v[68:69]
    v_min_u32 v60, 35, v1
    v_lshlrev_b32 v60, 3, v60
    v_add_u32 v60, 110848, v60
    ds_write_b64 v60, v[68:69]
    s_mov_b32 s8, s64
    s_mov_b32 s9, s65
    s_mov_b32 s10, 20480000
    s_mov_b32 s11, 0x00020000
    s_mov_b32 s24, s72
    s_mov_b32 s25, s73
    s_mov_b32 s26, 5120000
    s_mov_b32 s27, 0x00020000
    s_mov_b32 s28, s80
    s_mov_b32 s29, s81
    s_mov_b32 s30, 20480000
    s_mov_b32 s31, 0x00020000
    s_mov_b32 s96, s74
    s_mov_b32 s97, s75
    s_mov_b32 s98, 128
    s_mov_b32 s99, 0x00020000
    s_mov_b32 s92, s76
    s_mov_b32 s93, s77
    s_mov_b32 s94, 8192
    s_mov_b32 s95, 0x00020000
    s_mov_b32 s88, s78
    s_mov_b32 s89, s79
    s_mov_b32 s90, 131072
    s_mov_b32 s91, 0x00020000
    s_lshl_b32 s63, s3, 13
    s_mov_b32 s52, 0
    s_mov_b32 s77, 0
    s_mov_b32 s82, 0x3fff00
    s_mov_b32 s83, 20971520
    s_mov_b32 s81, 8
    s_lshl_b32 s49, s3, 10
    s_add_u32 s49, s49, 119328
    s_movk_i32 s53, 452
    v_cmp_gt_u32 s[50:51], s53, v0
    v_lshlrev_b32 v43, 22, v0
    v_lshlrev_b32 v59, 20, v0
    v_mov_b32 v58, 1
    s_waitcnt lgkmcnt(0)
    s_barrier
    v_and_b32 v60, 3, v1
    v_lshlrev_b32 v61, 5, v60
    v_lshrrev_b32 v66, 4, v1
    v_lshl_add_u32 v61, v66, 1, v61
    buffer_load_ushort v44, v61, s[96:99], 0 offen offset:0
    buffer_load_ushort v45, v61, s[96:99], 0 offen offset:8
    buffer_load_ushort v46, v61, s[96:99], 0 offen offset:16
    buffer_load_ushort v47, v61, s[96:99], 0 offen offset:24
    s_lshl_b32 s53, s3, 10
    s_add_u32 m0, s53, 32768
    v_lshlrev_b32 v64, 4, v1
    buffer_load_dwordx4 v64, s[92:95], s53 offen lds
    s_lshr_b32 s53, s2, 3
    s_lshl3_add_u32 s53, s53, s3
    s_lshl_b32 s53, s53, 10
    v_add_u32 v79, s53, v64
    buffer_load_dwordx4 v[156:159], v79, s[20:23], 0 offen
    v_add_u32 v79, 262144, v79
    buffer_load_dwordx4 v[156:159], v79, s[20:23], 0 offen
    v_add_u32 v79, 262144, v79
    v_and_b32 v61, 7, v1
    v_bfe_u32 v65, v1, 3, 1
    v_lshlrev_b32 v65, 9, v65
    v_lshl_add_u32 v65, v66, 7, v65
    v_lshl_add_u32 v2, v61, 4, v65
    v_xor_b32 v61, 4, v61
    v_lshl_add_u32 v3, v61, 4, v65
    v_bfe_u32 v60, v1, 2, 2
    v_bfe_u32 v62, v1, 1, 1
    v_lshl_add_u32 v62, v66, 1, v62
    v_lshrrev_b32 v63, 1, v60
    v_lshlrev_b32 v64, 2, v63
    v_xor_b32 v62, v62, v64
    v_and_b32 v64, 1, v60
    v_lshl_add_u32 v62, v64, 3, v62
    v_lshlrev_b32 v62, 4, v62
    v_lshl_add_u32 v62, v63, 10, v62
    v_and_b32 v64, 1, v1
    v_lshl_add_u32 v62, v64, 3, v62
    v_add_u32 v4, s63, v62
    v_lshrrev_b32 v61, 5, v1
    v_mov_b32 v63, 32
    v_cmp_eq_u32 vcc, v60, v61
    v_add_u32 v61, 2, v61
    v_and_b32 v64, 3, v1
    v_cndmask_b32 v7, 0, v63, vcc
    v_cmp_eq_u32 vcc, v60, v61
    v_cmp_eq_u32 s[4:5], v64, v66
    v_mov_b32 v65, 8
    v_cndmask_b32 v8, 0, v63, vcc
    v_cndmask_b32 v10, 0, v65, s[4:5]
    v_lshrrev_b32 v68, 3, v0
    v_and_b32 v69, 7, v0
    v_lshlrev_b32 v69, 4, v69
    v_add_u32 v61, s54, v68
    s_movk_i32 s46, 8320
    v_mad_u32_u24 v64, v61, s46, v69
    s_lshl_b32 s45, s55, 7
    s_add_u32 s53, s45, 8388608
    v_add_u32 v64, s53, v64
    v_lshl_add_u32 v65, v61, 13, v69
    s_add_u32 s53, s45, 16777216
    v_add_u32 v65, s53, v65
    v_lshlrev_b32 v61, 4, v0
    s_mov_b32 s53, 110880
    v_lshl_add_u32 v67, v68, 2, s53
    s_waitcnt vmcnt(10)
    v_and_b32 v48, 255, v16
    v_subrev_u32 v48, s54, v48
    v_cmp_gt_u32 s[64:65], 64, v48
    v_lshl_add_u32 v60, v48, 2, s53
    s_mov_b64 exec, s[64:65]
    ds_add_rtn_u32 v53, v60, v58
    s_mov_b64 exec, -1
    v_and_b32 v49, 255, v17
    v_subrev_u32 v49, s54, v49
    v_cmp_gt_u32 s[66:67], 64, v49
    v_lshl_add_u32 v60, v49, 2, s53
    s_mov_b64 exec, s[66:67]
    ds_add_rtn_u32 v54, v60, v58
    s_mov_b64 exec, -1
    v_and_b32 v50, 255, v18
    v_subrev_u32 v50, s54, v50
    v_cmp_gt_u32 s[68:69], 64, v50
    v_lshl_add_u32 v60, v50, 2, s53
    s_mov_b64 exec, s[68:69]
    ds_add_rtn_u32 v55, v60, v58
    s_mov_b64 exec, -1
    v_and_b32 v51, 255, v19
    v_subrev_u32 v51, s54, v51
    v_cmp_gt_u32 s[70:71], 64, v51
    v_lshl_add_u32 v60, v51, 2, s53
    s_mov_b64 exec, s[70:71]
    ds_add_rtn_u32 v56, v60, v58
    s_mov_b64 exec, -1
    v_and_b32 v52, 255, v20
    v_subrev_u32 v52, s54, v52
    v_cmp_gt_u32 s[72:73], 64, v52
    v_lshl_add_u32 v60, v52, 2, s53
    s_and_b64 s[72:73], s[72:73], s[50:51]
    s_mov_b64 exec, s[72:73]
    ds_add_rtn_u32 v57, v60, v58
    s_mov_b64 exec, -1
    s_waitcnt vmcnt(7)
    v_readfirstlane_b32 s48, v42
    buffer_load_dwordx4 v[156:159], v79, s[20:23], 0 offen
    v_add_u32 v79, 262144, v79
    buffer_load_dwordx4 v[156:159], v79, s[20:23], 0 offen
    v_add_u32 v79, 262144, v79
    buffer_load_dwordx4 v[156:159], v79, s[20:23], 0 offen
    v_add_u32 v79, 262144, v79
    v_bfe_u32 v16, v16, 8, 6
    v_min_u32 v16, 47, v16
    v_and_b32 v24, 0x3fff, v24
    v_lshl_or_b32 v16, v24, 6, v16
    v_add_u32 v24, 0, v43
    v_or_b32 v16, v16, v24
    v_lshlrev_b32 v48, 7, v48
    v_bfe_u32 v17, v17, 8, 6
    v_min_u32 v17, 47, v17
    v_and_b32 v25, 0x3fff, v25
    v_lshl_or_b32 v17, v25, 6, v17
    v_add_u32 v25, 1048576, v43
    v_or_b32 v17, v17, v25
    v_lshlrev_b32 v49, 7, v49
    v_bfe_u32 v18, v18, 8, 6
    v_min_u32 v18, 47, v18
    v_and_b32 v26, 0x3fff, v26
    v_lshl_or_b32 v18, v26, 6, v18
    v_add_u32 v26, 2097152, v43
    v_or_b32 v18, v18, v26
    v_lshlrev_b32 v50, 7, v50
    v_bfe_u32 v19, v19, 8, 6
    v_min_u32 v19, 47, v19
    v_and_b32 v27, 0x3fff, v27
    v_lshl_or_b32 v19, v27, 6, v19
    v_add_u32 v27, 3145728, v43
    v_or_b32 v19, v19, v27
    v_lshlrev_b32 v51, 7, v51
    v_bfe_u32 v20, v20, 8, 6
    v_min_u32 v20, 47, v20
    v_and_b32 v28, 0x3fff, v28
    v_lshl_or_b32 v20, v28, 6, v20
    v_add_u32 v28, 2147483648, v59
    v_or_b32 v20, v20, v28
    v_lshlrev_b32 v52, 7, v52
    v_mov_b32 v59, -2
    s_add_u32 s48, s48, 1
    s_movk_i32 s53, 7808
    s_waitcnt lgkmcnt(0)
    v_cmp_gt_u32 vcc, 31, v53
    v_min_u32 v53, 31, v53
    v_mul_u32_u24 v32, 43, v53
    v_cndmask_b32 v16, v59, v16, vcc
    v_lshrrev_b32 v32, 7, v32
    v_cmp_gt_u32 vcc, 24, v53
    v_add_lshl_u32 v32, v32, v53, 2
    v_lshl_add_u32 v33, v53, 4, s53
    v_cndmask_b32 v32, v33, v32, vcc
    v_add_u32 v48, v48, v32
    s_mov_b64 exec, s[64:65]
    ds_write_b32 v48, v16 offset:0
    s_mov_b64 exec, -1
    v_cmp_gt_u32 vcc, 31, v54
    v_min_u32 v54, 31, v54
    v_mul_u32_u24 v32, 43, v54
    v_cndmask_b32 v17, v59, v17, vcc
    v_lshrrev_b32 v32, 7, v32
    v_cmp_gt_u32 vcc, 24, v54
    v_add_lshl_u32 v32, v32, v54, 2
    v_lshl_add_u32 v33, v54, 4, s53
    v_cndmask_b32 v32, v33, v32, vcc
    v_add_u32 v49, v49, v32
    s_mov_b64 exec, s[66:67]
    ds_write_b32 v49, v17 offset:0
    s_mov_b64 exec, -1
    v_cmp_gt_u32 vcc, 31, v55
    v_min_u32 v55, 31, v55
    v_mul_u32_u24 v32, 43, v55
    v_cndmask_b32 v18, v59, v18, vcc
    v_lshrrev_b32 v32, 7, v32
    v_cmp_gt_u32 vcc, 24, v55
    v_add_lshl_u32 v32, v32, v55, 2
    v_lshl_add_u32 v33, v55, 4, s53
    v_cndmask_b32 v32, v33, v32, vcc
    v_add_u32 v50, v50, v32
    s_mov_b64 exec, s[68:69]
    ds_write_b32 v50, v18 offset:0
    s_mov_b64 exec, -1
    v_cmp_gt_u32 vcc, 31, v56
    v_min_u32 v56, 31, v56
    v_mul_u32_u24 v32, 43, v56
    v_cndmask_b32 v19, v59, v19, vcc
    v_lshrrev_b32 v32, 7, v32
    v_cmp_gt_u32 vcc, 24, v56
    v_add_lshl_u32 v32, v32, v56, 2
    v_lshl_add_u32 v33, v56, 4, s53
    v_cndmask_b32 v32, v33, v32, vcc
    v_add_u32 v51, v51, v32
    s_mov_b64 exec, s[70:71]
    ds_write_b32 v51, v19 offset:0
    s_mov_b64 exec, -1
    v_cmp_gt_u32 vcc, 31, v57
    v_min_u32 v57, 31, v57
    v_mul_u32_u24 v32, 43, v57
    v_cndmask_b32 v20, v59, v20, vcc
    v_lshrrev_b32 v32, 7, v32
    v_cmp_gt_u32 vcc, 24, v57
    v_add_lshl_u32 v32, v32, v57, 2
    v_lshl_add_u32 v33, v57, 4, s53
    v_cndmask_b32 v32, v33, v32, vcc
    v_add_u32 v52, v52, v32
    s_mov_b64 exec, s[72:73]
    ds_write_b32 v52, v20 offset:0
    s_mov_b64 exec, -1
    s_waitcnt lgkmcnt(0)
    s_barrier
    ds_read_b128 v[16:19], v61 offset:0
    ds_read_b32 v67, v67
    s_waitcnt lgkmcnt(1)
    v_mov_b32 v19, s48
    buffer_store_dwordx4 v[16:19], v64, s[32:35], 0 offen sc1
    s_waitcnt lgkmcnt(0)
    v_cmp_lt_u32 vcc, 23, v67
    s_cbranch_vccz L_noup
    ds_read_b128 v[28:31], v61 offset:8192
    s_waitcnt lgkmcnt(0)
    v_mov_b32 v31, s48
    s_mov_b64 exec, vcc
    buffer_store_dwordx4 v[28:31], v65, s[32:35], 0 offen sc1
    s_mov_b64 exec, -1
L_noup:
    s_cmp_ge_u32 s3, 2
    s_cbranch_scc1 L_nowf
    s_lshl1_add_u32 s44, s55, s3
    s_and_b32 s53, s44, 15
    s_lshl_b32 s53, s53, 13
    s_lshr_b32 s76, s44, 4
    s_lshl_b32 s76, s76, 6
    s_add_u32 s53, s53, s76
    v_lshrrev_b32 v60, 5, v1
    v_lshlrev_b32 v60, 12, v60
    v_and_b32 v61, 31, v1
    v_lshl_add_u32 v60, v61, 1, v60
    v_add_u32 v60, s53, v60
    buffer_load_ushort v32, v60, s[88:91], 0 offen offset:0
    buffer_load_ushort v33, v60, s[88:91], 0 offen offset:512
    buffer_load_ushort v34, v60, s[88:91], 0 offen offset:1024
    buffer_load_ushort v35, v60, s[88:91], 0 offen offset:1536
    buffer_load_ushort v36, v60, s[88:91], 0 offen offset:2048
    buffer_load_ushort v37, v60, s[88:91], 0 offen offset:2560
    buffer_load_ushort v38, v60, s[88:91], 0 offen offset:3072
    buffer_load_ushort v39, v60, s[88:91], 0 offen offset:3584
L_nowf:
    v_lshrrev_b32 v60, 5, v1
    v_bfe_u32 v61, v1, 2, 2
    v_bfe_u32 v62, v1, 4, 1
    v_and_b32 v63, 3, v1
    v_lshlrev_b32 v77, 12, v62
    v_lshl_add_u32 v77, v61, 9, v77
    v_lshl_add_u32 v77, v60, 5, v77
    v_lshl_add_u32 v77, v63, 3, v77
    s_mul_i32 s53, s2, 8320
    s_add_u32 s53, s53, 8388608
    v_lshl_add_u32 v70, v0, 4, s53
    s_lshl_b32 s53, s2, 13
    s_add_u32 s53, s53, 16777216
    v_lshl_add_u32 v71, v0, 4, s53
    v_mul_u32_u24 v73, 2500, v68
    v_mov_b64 v[80:81], 0
    v_mov_b64 v[82:83], 0
    v_mov_b64 v[84:85], 0
    v_mov_b64 v[86:87], 0
    v_mov_b64 v[88:89], 0
    v_mov_b64 v[90:91], 0
    v_mov_b64 v[92:93], 0
    v_mov_b64 v[94:95], 0
    v_mov_b64 v[96:97], 0
    v_mov_b64 v[98:99], 0
    v_mov_b64 v[100:101], 0
    v_mov_b64 v[102:103], 0
    v_mov_b64 v[104:105], 0
    v_mov_b64 v[106:107], 0
    v_mov_b64 v[108:109], 0
    v_mov_b64 v[110:111], 0
    v_mov_b64 v[112:113], 0
    v_mov_b64 v[114:115], 0
    v_mov_b64 v[116:117], 0
    v_mov_b64 v[118:119], 0
    v_mov_b64 v[120:121], 0
    v_mov_b64 v[122:123], 0
    v_mov_b64 v[124:125], 0
    v_mov_b64 v[126:127], 0
    v_mov_b64 v[128:129], 0
    v_mov_b64 v[130:131], 0
    v_mov_b64 v[132:133], 0
    v_mov_b64 v[134:135], 0
    v_mov_b64 v[136:137], 0
    v_mov_b64 v[138:139], 0
    v_mov_b64 v[140:141], 0
    v_mov_b64 v[142:143], 0
    v_mov_b64 v[144:145], 0
    v_mov_b64 v[146:147], 0
    v_mov_b64 v[148:149], 0
    v_mov_b64 v[150:151], 0
    v_mov_b64 v[152:153], 0
    v_mov_b64 v[154:155], 0
    s_mov_b64 s[6:7], -1
    s_mov_b32 s55, 0
    s_waitcnt vmcnt(0)
L_poll:
    s_mov_b64 exec, s[6:7]
    buffer_load_dwordx4 v[48:51], v70, s[32:35], 0 offen sc1
    s_mov_b64 exec, -1
    s_waitcnt vmcnt(0)
    v_cmp_ne_u32 s[6:7], s48, v51
    s_cmp_eq_u64 s[6:7], 0
    s_cbranch_scc1 L_got
    s_sleep 4
    s_add_u32 s55, s55, 1
    s_cmp_lt_u32 s55, 0x400000
    s_cbranch_scc1 L_poll
L_got:
    v_cmp_gt_u32 s[36:37], -2, v48
    v_cmp_gt_u32 s[38:39], -2, v49
    v_cmp_gt_u32 s[40:41], -2, v50
    v_mov_b32 v52, -1
    s_mov_b64 s[42:43], 0
    s_mov_b32 s53, 0x80808080
    s_and_b32 s6, s40, s53
    s_and_b32 s7, s41, s53
    s_cmp_eq_u64 s[6:7], 0
    s_cbranch_scc1 L_noext
    s_lshr_b64 s[6:7], s[6:7], 7
    s_mul_i32 s6, s6, 255
    s_mul_i32 s7, s7, 255
    v_mov_b32 v55, s48
L_poll2:
    s_mov_b64 exec, s[6:7]
    buffer_load_dwordx4 v[52:55], v71, s[32:35], 0 offen sc1
    s_mov_b64 exec, -1
    s_waitcnt vmcnt(0)
    v_cmp_ne_u32 vcc, s48, v55
    s_cbranch_vccz L_got2
    s_sleep 1
    s_add_u32 s55, s55, 1
    s_cmp_lt_u32 s55, 0x400000
    s_cbranch_scc1 L_poll2
L_got2:
    v_cmp_gt_u32 s[42:43], -2, v52
L_noext:
    v_cmp_eq_u32 vcc, -2, v52
    s_bcnt1_i32_b64 s64, s[36:37]
    s_bcnt1_i32_b64 s65, s[38:39]
    s_bcnt1_i32_b64 s66, s[40:41]
    s_bcnt1_i32_b64 s67, s[42:43]
    s_add_u32 s65, s65, s64
    s_add_u32 s66, s66, s65
    s_add_u32 s79, s67, s66
    v_mov_b32 v61, s79
    v_mov_b32 v60, 114912
    s_mov_b64 exec, 1
    ds_add_rtn_u32 v61, v60, v61
    s_mov_b64 exec, -1
    v_mbcnt_lo_u32_b32 v62, s36, 0
    v_mbcnt_hi_u32_b32 v62, s37, v62
    v_lshrrev_b32 v20, 20, v48
    v_add_u32 v20, v20, v73
    v_lshl_add_u32 v66, v62, 2, s49
    s_mov_b64 exec, s[36:37]
    ds_write_b32 v66, v20
    s_mov_b64 exec, -1
    v_lshlrev_b32 v24, 2, v48
    v_and_b32 v24, s82, v24
    v_and_b32 v16, 63, v48
    v_mbcnt_lo_u32_b32 v63, s38, 0
    v_mbcnt_hi_u32_b32 v63, s39, v63
    v_add_u32 v63, s64, v63
    v_lshrrev_b32 v21, 20, v49
    v_add_u32 v21, v21, v73
    v_lshl_add_u32 v66, v63, 2, s49
    s_mov_b64 exec, s[38:39]
    ds_write_b32 v66, v21
    s_mov_b64 exec, -1
    v_lshlrev_b32 v25, 2, v49
    v_and_b32 v25, s82, v25
    v_and_b32 v17, 63, v49
    v_mbcnt_lo_u32_b32 v64, s40, 0
    v_mbcnt_hi_u32_b32 v64, s41, v64
    v_add_u32 v64, s65, v64
    v_lshrrev_b32 v22, 20, v50
    v_add_u32 v22, v22, v73
    v_lshl_add_u32 v66, v64, 2, s49
    s_mov_b64 exec, s[40:41]
    ds_write_b32 v66, v22
    s_mov_b64 exec, -1
    v_lshlrev_b32 v26, 2, v50
    v_and_b32 v26, s82, v26
    v_and_b32 v18, 63, v50
    v_mbcnt_lo_u32_b32 v65, s42, 0
    v_mbcnt_hi_u32_b32 v65, s43, v65
    v_add_u32 v65, s66, v65
    v_lshrrev_b32 v23, 20, v52
    v_add_u32 v23, v23, v73
    v_lshl_add_u32 v66, v65, 2, s49
    s_mov_b64 exec, s[42:43]
    ds_write_b32 v66, v23
    s_mov_b64 exec, -1
    v_lshlrev_b32 v27, 2, v52
    v_and_b32 v27, s82, v27
    v_and_b32 v19, 63, v52
    v_lshl_or_b32 v14, v45, 16, v44
    v_lshl_or_b32 v15, v47, 16, v46
    v_mov_b64 v[156:157], 0
    v_mov_b64 v[158:159], 0
    s_cmp_ge_u32 s3, 2
    s_cbranch_scc1 L_1
    v_lshl_or_b32 v56, v33, 16, v32
    v_lshl_or_b32 v57, v35, 16, v34
    v_lshl_or_b32 v58, v37, 16, v36
    v_lshl_or_b32 v59, v39, 16, v38
    s_lshl_b32 s53, s54, 1
    s_add_u32 s53, s53, s44
    s_lshl2_add_u32 s83, s53, 4096
    s_lshl_b32 s53, s53, 10
    s_add_u32 s53, s53, 1048576
    v_lshl_add_u32 v60, v1, 4, s53
    buffer_store_dwordx4 v[56:59], v60, s[32:35], 0 offen sc1
L_1:
    s_mov_b32 s80, 79
    s_waitcnt lgkmcnt(0)
    v_readfirstlane_b32 s44, v61
    s_cbranch_vccnz L_defer
    s_add_u32 s53, s44, s79
    s_cmp_gt_u32 s53, 1024
    s_cbranch_scc1 L_defer
    v_add_u32 v62, s44, v62
    v_lshl_or_b32 v24, v62, 22, v24
    v_add_u32 v63, s44, v63
    v_lshl_or_b32 v25, v63, 22, v25
    v_add_u32 v64, s44, v64
    v_lshl_or_b32 v26, v64, 22, v26
    v_add_u32 v65, s44, v65
    v_lshl_or_b32 v27, v65, 22, v27
    s_branch L_have
L_defer:
    s_mov_b32 s80, 0
    s_mov_b32 s79, 0
    s_mov_b32 s44, 0
    s_mov_b64 s[36:37], 0
    s_mov_b64 s[38:39], 0
    s_mov_b64 s[40:41], 0
    s_mov_b64 s[42:43], 0
    v_mov_b32 v58, 1
    v_mov_b32 v59, 110864
    ds_write_b32 v59, v58
    s_branch L_have
L_scan:
    s_barrier
    s_mov_b32 s64, s63
    s_add_u32 s65, s63, 1024
    s_xor_b32 s47, s2, 1
L_sloop:
    s_cmp_ge_u32 s80, 79
    s_cbranch_scc1 L_scan_done
    s_mul_i32 s53, s3, 20000
    s_lshl_b32 s54, s80, 8
    s_add_u32 s55, s53, s54
    v_lshlrev_b32 v56, 2, v1
    v_add_u32 v56, s55, v56
    v_lshlrev_b32 v57, 2, v56
    buffer_load_dwordx4 v[60:63], v57, s[16:19], 0 offen
    s_waitcnt vmcnt(0)
    s_cmp_lg_u32 s80, 78
    s_cbranch_scc1 L_snotlast
    s_mov_b32 exec_lo, 0xffffff00
    v_mov_b32 v60, s47
    v_mov_b32 v61, s47
    v_mov_b32 v62, s47
    v_mov_b32 v63, s47
    s_mov_b64 exec, -1
L_snotlast:
    s_cmp_gt_u32 s52, 0
    s_cbranch_scc1 L_2
    v_cmp_eq_u32_sdwa vcc, v60, s2 src0_sel:BYTE_0 src1_sel:DWORD
    s_cbranch_vccz L_2
    s_bcnt1_i32_b64 s53, vcc
    s_lshl3_add_u32 s54, s53, s64
    s_mov_b32 s52, 0
    s_cmp_gt_u32 s54, s65
    s_cbranch_scc1 L_ovf
    v_mbcnt_lo_u32_b32 v58, vcc_lo, 0
    v_mbcnt_hi_u32_b32 v58, vcc_hi, v58
    v_lshl_add_u32 v58, v58, 3, s64
    v_add_u32 v59, 0, v56
    s_mov_b64 exec, vcc
    ds_write2_b32 v58, v60, v59 offset0:0 offset1:1
    s_mov_b64 exec, -1
    s_mov_b32 s64, s54
L_2:
    s_cmp_gt_u32 s52, 1
    s_cbranch_scc1 L_3
    v_cmp_eq_u32_sdwa vcc, v61, s2 src0_sel:BYTE_0 src1_sel:DWORD
    s_cbranch_vccz L_3
    s_bcnt1_i32_b64 s53, vcc
    s_lshl3_add_u32 s54, s53, s64
    s_mov_b32 s52, 1
    s_cmp_gt_u32 s54, s65
    s_cbranch_scc1 L_ovf
    v_mbcnt_lo_u32_b32 v58, vcc_lo, 0
    v_mbcnt_hi_u32_b32 v58, vcc_hi, v58
    v_lshl_add_u32 v58, v58, 3, s64
    v_add_u32 v59, 1, v56
    s_mov_b64 exec, vcc
    ds_write2_b32 v58, v61, v59 offset0:0 offset1:1
    s_mov_b64 exec, -1
    s_mov_b32 s64, s54
L_3:
    s_cmp_gt_u32 s52, 2
    s_cbranch_scc1 L_4
    v_cmp_eq_u32_sdwa vcc, v62, s2 src0_sel:BYTE_0 src1_sel:DWORD
    s_cbranch_vccz L_4
    s_bcnt1_i32_b64 s53, vcc
    s_lshl3_add_u32 s54, s53, s64
    s_mov_b32 s52, 2
    s_cmp_gt_u32 s54, s65
    s_cbranch_scc1 L_ovf
    v_mbcnt_lo_u32_b32 v58, vcc_lo, 0
    v_mbcnt_hi_u32_b32 v58, vcc_hi, v58
    v_lshl_add_u32 v58, v58, 3, s64
    v_add_u32 v59, 2, v56
    s_mov_b64 exec, vcc
    ds_write2_b32 v58, v62, v59 offset0:0 offset1:1
    s_mov_b64 exec, -1
    s_mov_b32 s64, s54
L_4:
    s_cmp_gt_u32 s52, 3
    s_cbranch_scc1 L_5
    v_cmp_eq_u32_sdwa vcc, v63, s2 src0_sel:BYTE_0 src1_sel:DWORD
    s_cbranch_vccz L_5
    s_bcnt1_i32_b64 s53, vcc
    s_lshl3_add_u32 s54, s53, s64
    s_mov_b32 s52, 3
    s_cmp_gt_u32 s54, s65
    s_cbranch_scc1 L_ovf
    v_mbcnt_lo_u32_b32 v58, vcc_lo, 0
    v_mbcnt_hi_u32_b32 v58, vcc_hi, v58
    v_lshl_add_u32 v58, v58, 3, s64
    v_add_u32 v59, 3, v56
    s_mov_b64 exec, vcc
    ds_write2_b32 v58, v63, v59 offset0:0 offset1:1
    s_mov_b64 exec, -1
    s_mov_b32 s64, s54
L_5:
    s_mov_b32 s52, 0
    s_add_u32 s80, s80, 1
    s_branch L_sloop
L_ovf:
    v_mov_b32 v58, 1
    v_mov_b32 v59, 110864
    ds_write_b32 v59, v58
L_scan_done:
    s_sub_u32 s79, s64, s63
    s_lshr_b32 s79, s79, 3
    s_lshl_b32 s44, s3, 7
    v_lshlrev_b32 v58, 3, v1
    v_add_u32 v58, s63, v58
    s_waitcnt lgkmcnt(0)
    ds_read_b32 v16, v58 offset:0
    ds_read_b32 v20, v58 offset:4
    s_sub_u32 s53, s79, 0
    v_cmp_gt_i32 s[36:37], s53, v1
    ds_read_b32 v17, v58 offset:512
    ds_read_b32 v21, v58 offset:516
    s_sub_u32 s53, s79, 64
    v_cmp_gt_i32 s[38:39], s53, v1
    s_mov_b64 s[40:41], 0
    v_mov_b32 v18, 0
    v_mov_b32 v26, 0
    s_mov_b64 s[42:43], 0
    v_mov_b32 v19, 0
    v_mov_b32 v27, 0
    v_lshl_add_u32 v58, v1, 2, s49
    v_add_u32 v59, s44, v1
    v_lshlrev_b32 v59, 22, v59
    s_waitcnt lgkmcnt(0)
    v_lshlrev_b32 v28, 2, v20
    buffer_load_dword v24, v28, s[12:15], 0 offen
    v_bfe_u32 v16, v16, 8, 6
    v_min_u32 v16, 47, v16
    ds_write_b32 v58, v20 offset:0
    v_lshlrev_b32 v29, 2, v21
    buffer_load_dword v25, v29, s[12:15], 0 offen
    v_bfe_u32 v17, v17, 8, 6
    v_min_u32 v17, 47, v17
    ds_write_b32 v58, v21 offset:256
    s_waitcnt vmcnt(0)
    v_and_b32 v24, 0x3fff, v24
    v_lshl_or_b32 v24, v24, 8, v59
    v_add_u32 v59, 268435456, v59
    v_and_b32 v25, 0x3fff, v25
    v_lshl_or_b32 v25, v25, 8, v59
    v_add_u32 v59, 268435456, v59
L_have:
    v_mov_b32 v58, 1
    s_mov_b32 s53, 111136
    s_mov_b32 s54, 114976
    v_bfe_u32 v28, v24, 8, 14
    v_mul_u32_u24 v28, 6711, v28
    v_lshrrev_b32 v28, 22, v28
    v_min_u32 v28, 15, v28
    v_lshl_add_u32 v28, v28, 2, s53
    v_lshl_add_u32 v28, v16, 6, v28
    v_lshl_add_u32 v16, v16, 2, s54
    s_mov_b64 exec, s[36:37]
    ds_add_rtn_u32 v32, v28, v58
    ds_add_u32 v16, v58
    s_mov_b64 exec, -1
    v_bfe_u32 v29, v25, 8, 14
    v_mul_u32_u24 v29, 6711, v29
    v_lshrrev_b32 v29, 22, v29
    v_min_u32 v29, 15, v29
    v_lshl_add_u32 v29, v29, 2, s53
    v_lshl_add_u32 v29, v17, 6, v29
    v_lshl_add_u32 v17, v17, 2, s54
    s_mov_b64 exec, s[38:39]
    ds_add_rtn_u32 v33, v29, v58
    ds_add_u32 v17, v58
    s_mov_b64 exec, -1
    v_bfe_u32 v30, v26, 8, 14
    v_mul_u32_u24 v30, 6711, v30
    v_lshrrev_b32 v30, 22, v30
    v_min_u32 v30, 15, v30
    v_lshl_add_u32 v30, v30, 2, s53
    v_lshl_add_u32 v30, v18, 6, v30
    v_lshl_add_u32 v18, v18, 2, s54
    s_mov_b64 exec, s[40:41]
    ds_add_rtn_u32 v34, v30, v58
    ds_add_u32 v18, v58
    s_mov_b64 exec, -1
    v_bfe_u32 v31, v27, 8, 14
    v_mul_u32_u24 v31, 6711, v31
    v_lshrrev_b32 v31, 22, v31
    v_min_u32 v31, 15, v31
    v_lshl_add_u32 v31, v31, 2, s53
    v_lshl_add_u32 v31, v19, 6, v31
    v_lshl_add_u32 v19, v19, 2, s54
    s_mov_b64 exec, s[42:43]
    ds_add_rtn_u32 v35, v31, v58
    ds_add_u32 v19, v58
    s_mov_b64 exec, -1
    v_lshrrev_b32 v36, 1, v1
    v_lshl_add_u32 v39, v36, 2, s49
    ds_read_b32 v40, v39 offset:0
    ds_read_b32 v41, v39 offset:128
    ds_read_b32 v42, v39 offset:256
    ds_read_b32 v43, v39 offset:384
    v_and_b32 v38, 1, v1
    v_lshlrev_b32 v37, 4, v38
    v_lshlrev_b32 v38, 2, v38
    s_mov_b32 s46, s79
    s_mov_b32 s45, s44
    v_lshl_add_u32 v56, v1, 2, s54
    v_mov_b32 v57, 110864
    s_waitcnt lgkmcnt(0)
    s_cmp_le_i32 s46, 0
    s_cbranch_scc1 L_6
    v_lshl_add_u32 v44, v40, 5, v37
    v_lshl_add_u32 v45, v40, 3, v38
    v_cmp_gt_i32 vcc, s46, v36
    s_lshl_b32 s76, s45, 5
    s_add_u32 m0, s76, 65536
    s_mov_b64 exec, vcc
    buffer_load_dwordx4 v44, s[24:27], 0 offen lds
    s_lshl3_add_u32 m0, s45, 98304
    s_add_u32 s45, s45, 32
    buffer_load_dword v45, s[20:23], 0 offen lds
    s_mov_b64 exec, -1
    s_sub_i32 s46, s46, 32
L_6:
    s_barrier
    ds_read_b32 v56, v56
    ds_read_b32 v57, v57
    s_cmp_le_i32 s46, 0
    s_cbranch_scc1 L_7
    v_lshl_add_u32 v44, v41, 5, v37
    v_lshl_add_u32 v45, v41, 3, v38
    v_cmp_gt_i32 vcc, s46, v36
    s_lshl_b32 s76, s45, 5
    s_add_u32 m0, s76, 65536
    s_mov_b64 exec, vcc
    buffer_load_dwordx4 v44, s[24:27], 0 offen lds
    s_lshl3_add_u32 m0, s45, 98304
    s_add_u32 s45, s45, 32
    buffer_load_dword v45, s[20:23], 0 offen lds
    s_mov_b64 exec, -1
    s_sub_i32 s46, s46, 32
L_7:
    s_waitcnt lgkmcnt(0)
    v_readfirstlane_b32 s78, v57
    s_cmp_lg_u32 s77, 0
    s_cbranch_scc1 L_assigned
    ds_read_b64_tr_b16 a[0:1], v77 offset:32768
    ds_read_b64_tr_b16 a[2:3], v77 offset:34816
    ds_read_b64_tr_b16 a[4:5], v77 offset:32832
    ds_read_b64_tr_b16 a[6:7], v77 offset:34880
    ds_read_b64_tr_b16 a[8:9], v77 offset:32896
    ds_read_b64_tr_b16 a[10:11], v77 offset:34944
    ds_read_b64_tr_b16 a[12:13], v77 offset:32960
    ds_read_b64_tr_b16 a[14:15], v77 offset:35008
    ds_read_b64_tr_b16 a[16:17], v77 offset:33024
    ds_read_b64_tr_b16 a[18:19], v77 offset:35072
    ds_read_b64_tr_b16 a[20:21], v77 offset:33088
    ds_read_b64_tr_b16 a[22:23], v77 offset:35136
    ds_read_b64_tr_b16 a[24:25], v77 offset:33152
    ds_read_b64_tr_b16 a[26:27], v77 offset:35200
    ds_read_b64_tr_b16 a[28:29], v77 offset:33216
    ds_read_b64_tr_b16 a[30:31], v77 offset:35264
    s_and_b32 s53, s2, 63
    s_or_b32 s53, s53, s3
    s_cbranch_scc1 L_8
    s_lshl_b32 s53, s2, 1
    v_mov_b32 v60, s53
    v_mov_b32 v61, s48
    s_mov_b64 exec, 1
    buffer_store_dword v61, v60, s[32:35], 0 offen sc1
    s_mov_b64 exec, -1
L_8:
    v_sub_u32 v57, 63, v1
    v_lshl_add_u32 v57, v56, 6, v57
    v_mov_b32 v59, 0
    v_readlane_b32 s84, v57, 0
    v_readlane_b32 s85, v57, 1
    v_readlane_b32 s86, v57, 2
    v_readlane_b32 s87, v57, 3
    v_readlane_b32 s88, v57, 4
    v_readlane_b32 s89, v57, 5
    v_readlane_b32 s90, v57, 6
    v_readlane_b32 s91, v57, 7
    v_readlane_b32 s92, v57, 8
    v_readlane_b32 s93, v57, 9
    v_readlane_b32 s94, v57, 10
    v_readlane_b32 s95, v57, 11
    v_readlane_b32 s96, v57, 12
    v_readlane_b32 s97, v57, 13
    v_readlane_b32 s98, v57, 14
    v_readlane_b32 s99, v57, 15
    v_cmp_gt_u32 vcc, s84, v57
    v_cmp_gt_u32 s[4:5], s85, v57
    v_cmp_gt_u32 s[6:7], s86, v57
    v_addc_co_u32 v59, vcc, 0, v59, vcc
    v_addc_co_u32 v59, s[4:5], 0, v59, s[4:5]
    v_addc_co_u32 v59, s[6:7], 0, v59, s[6:7]
    v_cmp_gt_u32 vcc, s87, v57
    v_cmp_gt_u32 s[4:5], s88, v57
    v_cmp_gt_u32 s[6:7], s89, v57
    v_addc_co_u32 v59, vcc, 0, v59, vcc
    v_addc_co_u32 v59, s[4:5], 0, v59, s[4:5]
    v_addc_co_u32 v59, s[6:7], 0, v59, s[6:7]
    v_cmp_gt_u32 vcc, s90, v57
    v_cmp_gt_u32 s[4:5], s91, v57
    v_cmp_gt_u32 s[6:7], s92, v57
    v_addc_co_u32 v59, vcc, 0, v59, vcc
    v_addc_co_u32 v59, s[4:5], 0, v59, s[4:5]
    v_addc_co_u32 v59, s[6:7], 0, v59, s[6:7]
    v_cmp_gt_u32 vcc, s93, v57
    v_cmp_gt_u32 s[4:5], s94, v57
    v_cmp_gt_u32 s[6:7], s95, v57
    v_addc_co_u32 v59, vcc, 0, v59, vcc
    v_addc_co_u32 v59, s[4:5], 0, v59, s[4:5]
    v_addc_co_u32 v59, s[6:7], 0, v59, s[6:7]
    v_cmp_gt_u32 vcc, s96, v57
    v_cmp_gt_u32 s[4:5], s97, v57
    v_cmp_gt_u32 s[6:7], s98, v57
    v_addc_co_u32 v59, vcc, 0, v59, vcc
    v_addc_co_u32 v59, s[4:5], 0, v59, s[4:5]
    v_addc_co_u32 v59, s[6:7], 0, v59, s[6:7]
    v_cmp_gt_u32 vcc, s99, v57
    s_nop 1
    v_addc_co_u32 v59, vcc, 0, v59, vcc
    v_readlane_b32 s84, v57, 16
    v_readlane_b32 s85, v57, 17
    v_readlane_b32 s86, v57, 18
    v_readlane_b32 s87, v57, 19
    v_readlane_b32 s88, v57, 20
    v_readlane_b32 s89, v57, 21
    v_readlane_b32 s90, v57, 22
    v_readlane_b32 s91, v57, 23
    v_readlane_b32 s92, v57, 24
    v_readlane_b32 s93, v57, 25
    v_readlane_b32 s94, v57, 26
    v_readlane_b32 s95, v57, 27
    v_readlane_b32 s96, v57, 28
    v_readlane_b32 s97, v57, 29
    v_readlane_b32 s98, v57, 30
    v_readlane_b32 s99, v57, 31
    v_cmp_gt_u32 vcc, s84, v57
    v_cmp_gt_u32 s[4:5], s85, v57
    v_cmp_gt_u32 s[6:7], s86, v57
    v_addc_co_u32 v59, vcc, 0, v59, vcc
    v_addc_co_u32 v59, s[4:5], 0, v59, s[4:5]
    v_addc_co_u32 v59, s[6:7], 0, v59, s[6:7]
    v_cmp_gt_u32 vcc, s87, v57
    v_cmp_gt_u32 s[4:5], s88, v57
    v_cmp_gt_u32 s[6:7], s89, v57
    v_addc_co_u32 v59, vcc, 0, v59, vcc
    v_addc_co_u32 v59, s[4:5], 0, v59, s[4:5]
    v_addc_co_u32 v59, s[6:7], 0, v59, s[6:7]
    v_cmp_gt_u32 vcc, s90, v57
    v_cmp_gt_u32 s[4:5], s91, v57
    v_cmp_gt_u32 s[6:7], s92, v57
    v_addc_co_u32 v59, vcc, 0, v59, vcc
    v_addc_co_u32 v59, s[4:5], 0, v59, s[4:5]
    v_addc_co_u32 v59, s[6:7], 0, v59, s[6:7]
    v_cmp_gt_u32 vcc, s93, v57
    v_cmp_gt_u32 s[4:5], s94, v57
    v_cmp_gt_u32 s[6:7], s95, v57
    v_addc_co_u32 v59, vcc, 0, v59, vcc
    v_addc_co_u32 v59, s[4:5], 0, v59, s[4:5]
    v_addc_co_u32 v59, s[6:7], 0, v59, s[6:7]
    v_cmp_gt_u32 vcc, s96, v57
    v_cmp_gt_u32 s[4:5], s97, v57
    v_cmp_gt_u32 s[6:7], s98, v57
    v_addc_co_u32 v59, vcc, 0, v59, vcc
    v_addc_co_u32 v59, s[4:5], 0, v59, s[4:5]
    v_addc_co_u32 v59, s[6:7], 0, v59, s[6:7]
    v_cmp_gt_u32 vcc, s99, v57
    s_nop 1
    v_addc_co_u32 v59, vcc, 0, v59, vcc
    v_readlane_b32 s84, v57, 32
    v_readlane_b32 s85, v57, 33
    v_readlane_b32 s86, v57, 34
    v_readlane_b32 s87, v57, 35
    v_readlane_b32 s88, v57, 36
    v_readlane_b32 s89, v57, 37
    v_readlane_b32 s90, v57, 38
    v_readlane_b32 s91, v57, 39
    v_cmp_gt_u32 vcc, s84, v57
    v_cmp_gt_u32 s[4:5], s85, v57
    v_cmp_gt_u32 s[6:7], s86, v57
    v_addc_co_u32 v59, vcc, 0, v59, vcc
    v_addc_co_u32 v59, s[4:5], 0, v59, s[4:5]
    v_addc_co_u32 v59, s[6:7], 0, v59, s[6:7]
    v_cmp_gt_u32 vcc, s87, v57
    v_cmp_gt_u32 s[4:5], s88, v57
    v_cmp_gt_u32 s[6:7], s89, v57
    v_addc_co_u32 v59, vcc, 0, v59, vcc
    v_addc_co_u32 v59, s[4:5], 0, v59, s[4:5]
    v_addc_co_u32 v59, s[6:7], 0, v59, s[6:7]
    v_cmp_gt_u32 vcc, s90, v57
    v_cmp_gt_u32 s[4:5], s91, v57
    s_nop 0
    v_addc_co_u32 v59, vcc, 0, v59, vcc
    v_addc_co_u32 v59, s[4:5], 0, v59, s[4:5]
    v_bfe_u32 v60, v59, 3, 1
    v_mul_u32_u24 v60, 7, v60
    v_and_b32 v61, 7, v59
    v_xor_b32 v11, v60, v61
    s_sub_u32 s53, 7, s3
    s_add_u32 s54, s3, 0
    v_cmp_eq_u32 vcc, s54, v59
    s_ff1_i32_b64 s56, vcc
    s_add_u32 s54, s53, 8
    v_cmp_eq_u32 vcc, s54, v59
    s_ff1_i32_b64 s57, vcc
    s_add_u32 s54, s3, 16
    v_cmp_eq_u32 vcc, s54, v59
    s_ff1_i32_b64 s58, vcc
    s_add_u32 s54, s53, 24
    v_cmp_eq_u32 vcc, s54, v59
    s_ff1_i32_b64 s59, vcc
    s_add_u32 s54, s3, 32
    v_cmp_eq_u32 vcc, s54, v59
    s_ff1_i32_b64 s60, vcc
L_assigned:
    v_cmp_gt_u32 vcc, s3, v11
    v_and_b32 v61, 15, v1
    v_lshlrev_b32 v61, 2, v61
    v_cndmask_b32 v60, 0, v56, vcc
    v_add_u32 v61, 111136, v61
    s_lshl_b32 s84, s56, 6
    v_add_u32 v64, s84, v61
    ds_read_b32 v70, v64
    s_lshl_b32 s85, s57, 6
    v_add_u32 v65, s85, v61
    ds_read_b32 v71, v65
    s_lshl_b32 s86, s58, 6
    v_add_u32 v66, s86, v61
    ds_read_b32 v72, v66
    s_lshl_b32 s87, s59, 6
    v_add_u32 v67, s87, v61
    ds_read_b32 v73, v67
    s_lshl_b32 s88, s60, 6
    v_add_u32 v68, s88, v61
    ds_read_b32 v74, v68
    v_add_u32_dpp v60, v60, v60 row_shr:1 row_mask:0xf bank_mask:0xf bound_ctrl:1
    v_readlane_b32 s92, v56, s56
    s_nop 0
    v_add_u32_dpp v60, v60, v60 row_shr:2 row_mask:0xf bank_mask:0xf bound_ctrl:1
    v_readlane_b32 s93, v56, s57
    s_nop 0
    v_add_u32_dpp v60, v60, v60 row_shr:4 row_mask:0xf bank_mask:0xf bound_ctrl:1
    v_readlane_b32 s94, v56, s58
    s_nop 0
    v_add_u32_dpp v60, v60, v60 row_shr:8 row_mask:0xf bank_mask:0xf bound_ctrl:1
    v_readlane_b32 s95, v56, s59
    s_nop 0
    v_readlane_b32 s96, v56, s60
    v_readlane_b32 s61, v60, 15
    v_readlane_b32 s53, v60, 31
    v_readlane_b32 s54, v60, 47
    s_add_u32 s62, s92, s93
    s_add_u32 s62, s62, s94
    s_add_u32 s62, s62, s95
    s_add_u32 s62, s62, s96
    s_add_u32 s61, s61, s53
    s_add_u32 s61, s61, s54
    s_add_u32 s61, s61, 3
    s_andn2_b32 s61, s61, 3
    s_lshl2_add_u32 s61, s3, s61
    s_waitcnt lgkmcnt(0)
    v_add3_u32 v60, v70, v71, v72
    v_add3_u32 v60, v60, v73, v74
    v_mov_b32 v61, v60
    s_nop 1
    v_add_u32_dpp v61, v61, v61 row_shr:1 row_mask:0xf bank_mask:0xf bound_ctrl:1
    s_nop 1
    v_add_u32_dpp v61, v61, v61 row_shr:2 row_mask:0xf bank_mask:0xf bound_ctrl:1
    s_nop 1
    v_add_u32_dpp v61, v61, v61 row_shr:4 row_mask:0xf bank_mask:0xf bound_ctrl:1
    s_nop 1
    v_add_u32_dpp v61, v61, v61 row_shr:8 row_mask:0xf bank_mask:0xf bound_ctrl:1
    v_sub_u32 v61, v61, v60
    v_add_u32 v61, s61, v61
    v_lshl_add_u32 v75, v61, 8, 0
    ds_write_b32 v64, v75 offset:4096
    v_add_u32 v61, v61, v70
    v_lshl_add_u32 v76, v61, 8, 16
    ds_write_b32 v65, v76 offset:4096
    v_add_u32 v61, v61, v71
    v_lshl_add_u32 v77, v61, 8, 32
    ds_write_b32 v66, v77 offset:4096
    v_add_u32 v61, v61, v72
    v_lshl_add_u32 v78, v61, 8, 48
    ds_write_b32 v67, v78 offset:4096
    v_add_u32 v61, v61, v73
    v_lshl_add_u32 v79, v61, 8, 64
    ds_write_b32 v68, v79 offset:4096
    s_cmp_le_i32 s46, 0
    s_cbranch_scc1 L_9
    v_lshl_add_u32 v44, v42, 5, v37
    v_lshl_add_u32 v45, v42, 3, v38
    v_cmp_gt_i32 vcc, s46, v36
    s_lshl_b32 s76, s45, 5
    s_add_u32 m0, s76, 65536
    s_mov_b64 exec, vcc
    buffer_load_dwordx4 v44, s[24:27], 0 offen lds
    s_lshl3_add_u32 m0, s45, 98304
    s_add_u32 s45, s45, 32
    buffer_load_dword v45, s[20:23], 0 offen lds
    s_mov_b64 exec, -1
    s_sub_i32 s46, s46, 32
L_9:
    s_waitcnt lgkmcnt(0)
    s_barrier
    ds_read_b32 v16, v28 offset:4096
    ds_read_b32 v17, v29 offset:4096
    ds_read_b32 v18, v30 offset:4096
    ds_read_b32 v19, v31 offset:4096
    v_mov_b32 v60, 0
    v_mov_b32 v61, 0
    v_lshlrev_b32 v64, 3, v0
    v_add_u32 v64, 111136, v64
    ds_write_b64 v64, v[60:61]
    v_mov_b32 v64, 110864
    ds_write_b32 v64, v60
    s_mov_b32 s53, 106496
    s_movk_i32 s54, 255
    s_waitcnt lgkmcnt(2)
    v_lshrrev_b32 v28, 8, v16
    v_add_u32 v28, v28, v32
    v_and_or_b32 v16, v16, s54, v24
    v_lshl_add_u32 v28, v28, 2, s53
    s_mov_b64 exec, s[36:37]
    ds_write_b32 v28, v16
    s_mov_b64 exec, -1
    v_lshrrev_b32 v29, 8, v17
    v_add_u32 v29, v29, v33
    v_and_or_b32 v17, v17, s54, v25
    v_lshl_add_u32 v29, v29, 2, s53
    s_mov_b64 exec, s[38:39]
    ds_write_b32 v29, v17
    s_mov_b64 exec, -1
    v_lshrrev_b32 v30, 8, v18
    v_add_u32 v30, v30, v34
    v_and_or_b32 v18, v18, s54, v26
    v_lshl_add_u32 v30, v30, 2, s53
    s_mov_b64 exec, s[40:41]
    ds_write_b32 v30, v18
    s_mov_b64 exec, -1
    v_lshrrev_b32 v31, 8, v19
    v_add_u32 v31, v31, v35
    v_and_or_b32 v19, v19, s54, v27
    v_lshl_add_u32 v31, v31, 2, s53
    s_mov_b64 exec, s[42:43]
    ds_write_b32 v31, v19
    s_mov_b64 exec, -1
    s_cmp_le_i32 s46, 0
    s_cbranch_scc1 L_10
    v_lshl_add_u32 v44, v43, 5, v37
    v_lshl_add_u32 v45, v43, 3, v38
    v_cmp_gt_i32 vcc, s46, v36
    s_lshl_b32 s76, s45, 5
    s_add_u32 m0, s76, 65536
    s_mov_b64 exec, vcc
    buffer_load_dwordx4 v44, s[24:27], 0 offen lds
    s_lshl3_add_u32 m0, s45, 98304
    s_add_u32 s45, s45, 32
    buffer_load_dword v45, s[20:23], 0 offen lds
    s_mov_b64 exec, -1
    s_sub_i32 s46, s46, 32
L_10:
L_paymore:
    s_cmp_le_i32 s46, 0
    s_cbranch_scc1 L_paydone
    ds_read_b32 v40, v39 offset:512
    v_add_u32 v39, 128, v39
    s_waitcnt lgkmcnt(0)
    s_cmp_le_i32 s46, 0
    s_cbranch_scc1 L_11
    v_lshl_add_u32 v44, v40, 5, v37
    v_lshl_add_u32 v45, v40, 3, v38
    v_cmp_gt_i32 vcc, s46, v36
    s_lshl_b32 s76, s45, 5
    s_add_u32 m0, s76, 65536
    s_mov_b64 exec, vcc
    buffer_load_dwordx4 v44, s[24:27], 0 offen lds
    s_lshl3_add_u32 m0, s45, 98304
    s_add_u32 s45, s45, 32
    buffer_load_dword v45, s[20:23], 0 offen lds
    s_mov_b64 exec, -1
    s_sub_i32 s46, s46, 32
L_11:
    s_branch L_paymore
L_paydone:
    s_lshl_b32 s61, s61, 2
    s_add_u32 s61, s61, 106496
    s_and_b32 s54, s2, 192
    s_lshl_b32 s54, s54, 1
    s_lshl4_add_u32 s54, s3, s54
    s_lshl2_add_u32 s53, s54, 4096
    v_and_b32 v66, 15, v1
    v_lshl_add_u32 v66, v66, 2, s53
    s_lshl_b32 s53, s54, 10
    s_add_u32 s53, s53, 1048576
    v_lshl_add_u32 v67, v1, 4, s53
    s_xor_b32 s53, s48, 1
    v_mov_b32 v79, s53
    v_mov_b32 v13, s61
    v_and_b32 v62, 3, v1
    v_lshl_add_u32 v77, v62, 2, s61
    v_bfe_u32 v62, v1, 2, 2
    v_lshl_add_u32 v78, v62, 2, s61
    v_bfe_u32 v63, v1, 4, 1
    v_lshlrev_b32 v63, 4, v63
    v_add_u32 v63, 65536, v63
    v_mov_b32 v65, 98304
    v_mov_b32 v62, 110848
    v_cmp_ne_u32 vcc, 0, v7
    v_cmp_ne_u32 s[4:5], 0, v8
    v_cmp_ne_u32 s[6:7], 0, v10
    v_cndmask_b32 v74, v62, v63, vcc
    v_cndmask_b32 v75, v62, v63, s[4:5]
    v_cndmask_b32 v76, v62, v65, s[6:7]
    s_waitcnt lgkmcnt(0)
    s_barrier
    ds_read_b128 v[68:71], v13
    ds_read_b32 v72, v77
    ds_read_b32 v73, v78
    s_cmp_lt_u32 s62, 3
    s_cbranch_scc1 L_short
    s_waitcnt lgkmcnt(2)
    v_readfirstlane_b32 s64, v68
    v_readfirstlane_b32 s65, v69
    v_readfirstlane_b32 s66, v70
    v_readfirstlane_b32 s67, v71
    s_and_b32 s76, s64, s82
    s_add_u32 m0, s63, 0
    s_lshl_b32 s76, s76, 3
    buffer_load_dwordx4 v2, s[8:11], s76 offen lds
    buffer_load_dwordx4 v3, s[8:11], s76 offen offset:1024 lds
    s_and_b32 s76, s65, s82
    s_add_u32 m0, s63, 2048
    s_lshl_b32 s76, s76, 3
    buffer_load_dwordx4 v2, s[8:11], s76 offen lds
    buffer_load_dwordx4 v3, s[8:11], s76 offen offset:1024 lds
    s_and_b32 s76, s66, s82
    s_add_u32 m0, s63, 4096
    s_lshl_b32 s76, s76, 3
    buffer_load_dwordx4 v2, s[8:11], s76 offen lds
    buffer_load_dwordx4 v3, s[8:11], s76 offen offset:1024 lds
    s_waitcnt vmcnt(6)
    s_branch L_go
L_short:
    s_waitcnt vmcnt(0) lgkmcnt(0)
    v_readfirstlane_b32 s64, v68
    v_readfirstlane_b32 s65, v69
    v_readfirstlane_b32 s66, v70
    v_readfirstlane_b32 s67, v71
    s_cmp_le_u32 s62, 0
    s_cbranch_scc1 L_go
    s_and_b32 s76, s64, s82
    s_add_u32 m0, s63, 0
    s_lshl_b32 s76, s76, 3
    buffer_load_dwordx4 v2, s[8:11], s76 offen lds
    buffer_load_dwordx4 v3, s[8:11], s76 offen offset:1024 lds
    s_cmp_le_u32 s62, 1
    s_cbranch_scc1 L_go
    s_and_b32 s76, s65, s82
    s_add_u32 m0, s63, 2048
    s_lshl_b32 s76, s76, 3
    buffer_load_dwordx4 v2, s[8:11], s76 offen lds
    buffer_load_dwordx4 v3, s[8:11], s76 offen offset:1024 lds
L_go:
    s_cmp_ge_u32 s3, 2
    s_cbranch_scc1 L_12
    s_cmp_lg_u32 s77, 0
    s_cbranch_scc1 L_12
    v_mov_b32 v62, s83
    v_mov_b32 v63, s48
    s_mov_b64 exec, 1
    buffer_store_dword v63, v62, s[32:35], 0 offen sc1
    s_mov_b64 exec, -1
L_12:
    s_waitcnt lgkmcnt(0)
    v_lshrrev_b32 v72, 22, v72
    v_lshrrev_b32 v73, 22, v73
    v_mad_u32_u24 v5, v72, v7, v74
    v_mad_u32_u24 v6, v72, v8, v75
    v_mad_u32_u24 v9, v73, v10, v76
    s_barrier
    s_cmp_eq_u32 s62, 0
    s_cbranch_scc1 L_round_done
L_group:
    s_cmp_le_u32 s62, s81
    s_cbranch_scc1 L_wstep
L_wback:
    ds_read_b64 v[64:65], v9
    ds_read_b128 v[56:59], v5
    ds_read_b128 v[60:63], v6
    ds_read_b128 v[68:71], v13 offset:16
    ds_read_b32 v72, v77 offset:16
    ds_read_b32 v73, v78 offset:16
    v_add_u32 v13, 16, v13
    v_add_u32 v77, 16, v77
    v_add_u32 v78, 16, v78
    s_waitcnt lgkmcnt(0)
    v_mfma_f32_16x16x16_bf16 v[32:35], v[14:15], v[64:65], 0
    v_mfma_f32_16x16x32_bf16 v[16:19], v[56:59], a[0:3], 0
    v_mfma_f32_16x16x32_bf16 v[20:23], v[56:59], a[8:11], 0
    v_mfma_f32_16x16x32_bf16 v[24:27], v[56:59], a[16:19], 0
    v_mfma_f32_16x16x32_bf16 v[28:31], v[56:59], a[24:27], 0
    v_mfma_f32_16x16x32_bf16 v[16:19], v[60:63], a[4:7], v[16:19]
    v_mfma_f32_16x16x32_bf16 v[20:23], v[60:63], a[12:15], v[20:23]
    v_mfma_f32_16x16x32_bf16 v[24:27], v[60:63], a[20:23], v[24:27]
    v_mfma_f32_16x16x32_bf16 v[28:31], v[60:63], a[28:31], v[28:31]
    v_readfirstlane_b32 s68, v68
    v_readfirstlane_b32 s69, v69
    v_readfirstlane_b32 s70, v70
    v_readfirstlane_b32 s71, v71
    v_cvt_pk_bf16_f32 v64, v32, v33
    v_cvt_pk_bf16_f32 v65, v34, v35
    v_lshrrev_b32 v72, 22, v72
    v_lshrrev_b32 v73, 22, v73
    v_mad_u32_u24 v5, v72, v7, v74
    v_mad_u32_u24 v6, v72, v8, v75
    v_mad_u32_u24 v9, v73, v10, v76
    s_cmp_ge_u32 s62, 3
    s_cbranch_scc1 L_13
    s_waitcnt vmcnt(0)
L_13:
    s_waitcnt vmcnt(4)
    ds_read_b64_tr_b16 v[48:49], v4 offset:0
    ds_read_b64_tr_b16 v[50:51], v4 offset:256
    ds_read_b64_tr_b16 v[52:53], v4 offset:512
    ds_read_b64_tr_b16 v[54:55], v4 offset:768
    s_cmp_le_u32 s62, 3
    s_cbranch_scc1 L_14
    s_and_b32 s76, s67, s82
    s_add_u32 m0, s63, 6144
    s_lshl_b32 s76, s76, 3
    buffer_load_dwordx4 v2, s[8:11], s76 offen lds
    buffer_load_dwordx4 v3, s[8:11], s76 offen offset:1024 lds
L_14:
    s_waitcnt lgkmcnt(0)
    v_mfma_f32_4x4x4_16b_bf16 v[32:35], v[64:65], v[48:49], 0 cbsz:4 abid:0
    v_mfma_f32_4x4x4_16b_bf16 v[36:39], v[64:65], v[50:51], 0 cbsz:4 abid:0
    v_mfma_f32_4x4x4_16b_bf16 v[40:43], v[64:65], v[52:53], 0 cbsz:4 abid:0
    v_mfma_f32_4x4x4_16b_bf16 v[44:47], v[64:65], v[54:55], 0 cbsz:4 abid:0
    s_nop 0
    s_set_gpr_idx_on s64, gpr_idx(SRC2,DST)
    v_pk_fma_f32 v[80:81], v[32:33], v[16:17], v[80:81] op_sel:[0,0,0] op_sel_hi:[1,0,1]
    v_pk_fma_f32 v[82:83], v[34:35], v[16:17], v[82:83] op_sel:[0,0,0] op_sel_hi:[1,0,1]
    v_pk_fma_f32 v[84:85], v[36:37], v[20:21], v[84:85] op_sel:[0,0,0] op_sel_hi:[1,0,1]
    v_pk_fma_f32 v[86:87], v[38:39], v[20:21], v[86:87] op_sel:[0,0,0] op_sel_hi:[1,0,1]
    v_pk_fma_f32 v[88:89], v[40:41], v[24:25], v[88:89] op_sel:[0,0,0] op_sel_hi:[1,0,1]
    v_pk_fma_f32 v[90:91], v[42:43], v[24:25], v[90:91] op_sel:[0,0,0] op_sel_hi:[1,0,1]
    v_pk_fma_f32 v[92:93], v[44:45], v[28:29], v[92:93] op_sel:[0,0,0] op_sel_hi:[1,0,1]
    v_pk_fma_f32 v[94:95], v[46:47], v[28:29], v[94:95] op_sel:[0,0,0] op_sel_hi:[1,0,1]
    s_set_gpr_idx_off
    s_mov_b32 s64, s68
    s_sub_u32 s62, s62, 1
    s_cmp_eq_u32 s62, 0
    s_cbranch_scc1 L_round_done
    s_cmp_ge_u32 s62, 3
    s_cbranch_scc1 L_15
    s_waitcnt vmcnt(0)
L_15:
    s_waitcnt vmcnt(4)
    ds_read_b64_tr_b16 v[48:49], v4 offset:2048
    ds_read_b64_tr_b16 v[50:51], v4 offset:2304
    ds_read_b64_tr_b16 v[52:53], v4 offset:2560
    ds_read_b64_tr_b16 v[54:55], v4 offset:2816
    s_cmp_le_u32 s62, 3
    s_cbranch_scc1 L_16
    s_and_b32 s76, s68, s82
    s_add_u32 m0, s63, 0
    s_lshl_b32 s76, s76, 3
    buffer_load_dwordx4 v2, s[8:11], s76 offen lds
    buffer_load_dwordx4 v3, s[8:11], s76 offen offset:1024 lds
L_16:
    s_waitcnt lgkmcnt(0)
    v_mfma_f32_4x4x4_16b_bf16 v[32:35], v[64:65], v[48:49], 0 cbsz:4 abid:1
    v_mfma_f32_4x4x4_16b_bf16 v[36:39], v[64:65], v[50:51], 0 cbsz:4 abid:1
    v_mfma_f32_4x4x4_16b_bf16 v[40:43], v[64:65], v[52:53], 0 cbsz:4 abid:1
    v_mfma_f32_4x4x4_16b_bf16 v[44:47], v[64:65], v[54:55], 0 cbsz:4 abid:1
    s_nop 0
    s_set_gpr_idx_on s65, gpr_idx(SRC2,DST)
    v_pk_fma_f32 v[80:81], v[32:33], v[16:17], v[80:81] op_sel:[0,1,0] op_sel_hi:[1,1,1]
    v_pk_fma_f32 v[82:83], v[34:35], v[16:17], v[82:83] op_sel:[0,1,0] op_sel_hi:[1,1,1]
    v_pk_fma_f32 v[84:85], v[36:37], v[20:21], v[84:85] op_sel:[0,1,0] op_sel_hi:[1,1,1]
    v_pk_fma_f32 v[86:87], v[38:39], v[20:21], v[86:87] op_sel:[0,1,0] op_sel_hi:[1,1,1]
    v_pk_fma_f32 v[88:89], v[40:41], v[24:25], v[88:89] op_sel:[0,1,0] op_sel_hi:[1,1,1]
    v_pk_fma_f32 v[90:91], v[42:43], v[24:25], v[90:91] op_sel:[0,1,0] op_sel_hi:[1,1,1]
    v_pk_fma_f32 v[92:93], v[44:45], v[28:29], v[92:93] op_sel:[0,1,0] op_sel_hi:[1,1,1]
    v_pk_fma_f32 v[94:95], v[46:47], v[28:29], v[94:95] op_sel:[0,1,0] op_sel_hi:[1,1,1]
    s_set_gpr_idx_off
    s_mov_b32 s65, s69
    s_sub_u32 s62, s62, 1
    s_cmp_eq_u32 s62, 0
    s_cbranch_scc1 L_round_done
    s_cmp_ge_u32 s62, 3
    s_cbranch_scc1 L_17
    s_waitcnt vmcnt(0)
L_17:
    s_waitcnt vmcnt(4)
    ds_read_b64_tr_b16 v[48:49], v4 offset:4096
    ds_read_b64_tr_b16 v[50:51], v4 offset:4352
    ds_read_b64_tr_b16 v[52:53], v4 offset:4608
    ds_read_b64_tr_b16 v[54:55], v4 offset:4864
    s_cmp_le_u32 s62, 3
    s_cbranch_scc1 L_18
    s_and_b32 s76, s69, s82
    s_add_u32 m0, s63, 2048
    s_lshl_b32 s76, s76, 3
    buffer_load_dwordx4 v2, s[8:11], s76 offen lds
    buffer_load_dwordx4 v3, s[8:11], s76 offen offset:1024 lds
L_18:
    s_waitcnt lgkmcnt(0)
    v_mfma_f32_4x4x4_16b_bf16 v[32:35], v[64:65], v[48:49], 0 cbsz:4 abid:2
    v_mfma_f32_4x4x4_16b_bf16 v[36:39], v[64:65], v[50:51], 0 cbsz:4 abid:2
    v_mfma_f32_4x4x4_16b_bf16 v[40:43], v[64:65], v[52:53], 0 cbsz:4 abid:2
    v_mfma_f32_4x4x4_16b_bf16 v[44:47], v[64:65], v[54:55], 0 cbsz:4 abid:2
    s_nop 0
    s_set_gpr_idx_on s66, gpr_idx(SRC2,DST)
    v_pk_fma_f32 v[80:81], v[32:33], v[18:19], v[80:81] op_sel:[0,0,0] op_sel_hi:[1,0,1]
    v_pk_fma_f32 v[82:83], v[34:35], v[18:19], v[82:83] op_sel:[0,0,0] op_sel_hi:[1,0,1]
    v_pk_fma_f32 v[84:85], v[36:37], v[22:23], v[84:85] op_sel:[0,0,0] op_sel_hi:[1,0,1]
    v_pk_fma_f32 v[86:87], v[38:39], v[22:23], v[86:87] op_sel:[0,0,0] op_sel_hi:[1,0,1]
    v_pk_fma_f32 v[88:89], v[40:41], v[26:27], v[88:89] op_sel:[0,0,0] op_sel_hi:[1,0,1]
    v_pk_fma_f32 v[90:91], v[42:43], v[26:27], v[90:91] op_sel:[0,0,0] op_sel_hi:[1,0,1]
    v_pk_fma_f32 v[92:93], v[44:45], v[30:31], v[92:93] op_sel:[0,0,0] op_sel_hi:[1,0,1]
    v_pk_fma_f32 v[94:95], v[46:47], v[30:31], v[94:95] op_sel:[0,0,0] op_sel_hi:[1,0,1]
    s_set_gpr_idx_off
    s_mov_b32 s66, s70
    s_sub_u32 s62, s62, 1
    s_cmp_eq_u32 s62, 0
    s_cbranch_scc1 L_round_done
    s_cmp_ge_u32 s62, 3
    s_cbranch_scc1 L_19
    s_waitcnt vmcnt(0)
L_19:
    s_waitcnt vmcnt(4)
    ds_read_b64_tr_b16 v[48:49], v4 offset:6144
    ds_read_b64_tr_b16 v[50:51], v4 offset:6400
    ds_read_b64_tr_b16 v[52:53], v4 offset:6656
    ds_read_b64_tr_b16 v[54:55], v4 offset:6912
    s_cmp_le_u32 s62, 3
    s_cbranch_scc1 L_20
    s_and_b32 s76, s70, s82
    s_add_u32 m0, s63, 4096
    s_lshl_b32 s76, s76, 3
    buffer_load_dwordx4 v2, s[8:11], s76 offen lds
    buffer_load_dwordx4 v3, s[8:11], s76 offen offset:1024 lds
L_20:
    s_waitcnt lgkmcnt(0)
    v_mfma_f32_4x4x4_16b_bf16 v[32:35], v[64:65], v[48:49], 0 cbsz:4 abid:3
    v_mfma_f32_4x4x4_16b_bf16 v[36:39], v[64:65], v[50:51], 0 cbsz:4 abid:3
    v_mfma_f32_4x4x4_16b_bf16 v[40:43], v[64:65], v[52:53], 0 cbsz:4 abid:3
    v_mfma_f32_4x4x4_16b_bf16 v[44:47], v[64:65], v[54:55], 0 cbsz:4 abid:3
    s_nop 0
    s_set_gpr_idx_on s67, gpr_idx(SRC2,DST)
    v_pk_fma_f32 v[80:81], v[32:33], v[18:19], v[80:81] op_sel:[0,1,0] op_sel_hi:[1,1,1]
    v_pk_fma_f32 v[82:83], v[34:35], v[18:19], v[82:83] op_sel:[0,1,0] op_sel_hi:[1,1,1]
    v_pk_fma_f32 v[84:85], v[36:37], v[22:23], v[84:85] op_sel:[0,1,0] op_sel_hi:[1,1,1]
    v_pk_fma_f32 v[86:87], v[38:39], v[22:23], v[86:87] op_sel:[0,1,0] op_sel_hi:[1,1,1]
    v_pk_fma_f32 v[88:89], v[40:41], v[26:27], v[88:89] op_sel:[0,1,0] op_sel_hi:[1,1,1]
    v_pk_fma_f32 v[90:91], v[42:43], v[26:27], v[90:91] op_sel:[0,1,0] op_sel_hi:[1,1,1]
    v_pk_fma_f32 v[92:93], v[44:45], v[30:31], v[92:93] op_sel:[0,1,0] op_sel_hi:[1,1,1]
    v_pk_fma_f32 v[94:95], v[46:47], v[30:31], v[94:95] op_sel:[0,1,0] op_sel_hi:[1,1,1]
    s_set_gpr_idx_off
    s_mov_b32 s67, s71
    s_sub_u32 s62, s62, 1
    s_cmp_eq_u32 s62, 0
    s_cbranch_scc0 L_group
L_round_done:
    s_add_u32 s77, s77, 1
    s_cmp_lg_u32 s78, 0
    s_cbranch_scc1 L_scan
    s_cmp_eq_u32 s81, 0
    s_cbranch_scc1 L_havew
    s_mov_b32 s55, 0
L_pollw:
    s_waitcnt vmcnt(0)
    v_cmp_ne_u32 vcc, s48, v79
    s_cbranch_vccz L_gotw
    buffer_load_dword v79, v66, s[32:35], 0 offen sc1
    s_sleep 1
    s_add_u32 s55, s55, 1
    s_cmp_lt_u32 s55, 0x400000
    s_cbranch_scc1 L_pollw
L_gotw:
    buffer_load_dwordx4 a[32:35], v67, s[32:35], 0 offen offset:0 sc1
    buffer_load_dwordx4 a[36:39], v67, s[32:35], 0 offen offset:1024 sc1
    buffer_load_dwordx4 a[40:43], v67, s[32:35], 0 offen offset:2048 sc1
    buffer_load_dwordx4 a[44:47], v67, s[32:35], 0 offen offset:3072 sc1
    v_add_u32 v67, 4096, v67
    buffer_load_dwordx4 a[48:51], v67, s[32:35], 0 offen offset:0 sc1
    buffer_load_dwordx4 a[52:55], v67, s[32:35], 0 offen offset:1024 sc1
    buffer_load_dwordx4 a[56:59], v67, s[32:35], 0 offen offset:2048 sc1
    buffer_load_dwordx4 a[60:63], v67, s[32:35], 0 offen offset:3072 sc1
    v_add_u32 v67, 4096, v67
    buffer_load_dwordx4 a[64:67], v67, s[32:35], 0 offen offset:0 sc1
    buffer_load_dwordx4 a[68:71], v67, s[32:35], 0 offen offset:1024 sc1
    buffer_load_dwordx4 a[72:75], v67, s[32:35], 0 offen offset:2048 sc1
    buffer_load_dwordx4 a[76:79], v67, s[32:35], 0 offen offset:3072 sc1
    v_add_u32 v67, 4096, v67
    buffer_load_dwordx4 a[80:83], v67, s[32:35], 0 offen offset:0 sc1
    buffer_load_dwordx4 a[84:87], v67, s[32:35], 0 offen offset:1024 sc1
    buffer_load_dwordx4 a[88:91], v67, s[32:35], 0 offen offset:2048 sc1
    buffer_load_dwordx4 a[92:95], v67, s[32:35], 0 offen offset:3072 sc1
    v_add_u32 v67, 4096, v67
    s_branch L_havew
L_wstep:
    v_cmp_ne_u32 vcc, s48, v79
    s_cbranch_vccz L_wgo
    buffer_load_dword v79, v66, s[32:35], 0 offen sc1
    s_branch L_wback
L_wgo:
    s_branch L_wback
L_havew:
    v_mul_u32_u24 v16, 320, v1
    v_lshrrev_b32 v17, 2, v1
    v_lshl_add_u32 v16, v17, 3, v16
    s_lshl_b32 s53, s56, 3
    v_add_u32 v72, s53, v16
    v_add_u32 v5, 111136, v72
    s_lshl_b32 s53, s57, 3
    v_add_u32 v73, s53, v16
    v_add_u32 v6, 111136, v73
    s_lshl_b32 s53, s58, 3
    v_add_u32 v74, s53, v16
    v_add_u32 v7, 111136, v74
    s_lshl_b32 s53, s59, 3
    v_add_u32 v75, s53, v16
    v_add_u32 v8, 111136, v75
    s_lshl_b32 s53, s60, 3
    v_add_u32 v76, s53, v16
    v_add_u32 v9, 111136, v76
    v_cvt_pk_bf16_f32 v32, v80, v81
    v_cvt_pk_bf16_f32 v33, v82, v83
    ds_write_b64 v5, v[32:33] offset:0
    v_cvt_pk_bf16_f32 v34, v96, v97
    v_cvt_pk_bf16_f32 v35, v98, v99
    ds_write_b64 v6, v[34:35] offset:0
    v_cvt_pk_bf16_f32 v36, v112, v113
    v_cvt_pk_bf16_f32 v37, v114, v115
    ds_write_b64 v7, v[36:37] offset:0
    v_cvt_pk_bf16_f32 v38, v128, v129
    v_cvt_pk_bf16_f32 v39, v130, v131
    ds_write_b64 v8, v[38:39] offset:0
    v_cvt_pk_bf16_f32 v40, v144, v145
    v_cvt_pk_bf16_f32 v41, v146, v147
    ds_write_b64 v9, v[40:41] offset:0
    v_cvt_pk_bf16_f32 v42, v84, v85
    v_cvt_pk_bf16_f32 v43, v86, v87
    ds_write_b64 v5, v[42:43] offset:20608
    v_cvt_pk_bf16_f32 v44, v100, v101
    v_cvt_pk_bf16_f32 v45, v102, v103
    ds_write_b64 v6, v[44:45] offset:20608
    v_cvt_pk_bf16_f32 v46, v116, v117
    v_cvt_pk_bf16_f32 v47, v118, v119
    ds_write_b64 v7, v[46:47] offset:20608
    v_cvt_pk_bf16_f32 v48, v132, v133
    v_cvt_pk_bf16_f32 v49, v134, v135
    ds_write_b64 v8, v[48:49] offset:20608
    v_cvt_pk_bf16_f32 v50, v148, v149
    v_cvt_pk_bf16_f32 v51, v150, v151
    ds_write_b64 v9, v[50:51] offset:20608
    v_cvt_pk_bf16_f32 v52, v88, v89
    v_cvt_pk_bf16_f32 v53, v90, v91
    v_cvt_pk_bf16_f32 v54, v104, v105
    v_cvt_pk_bf16_f32 v55, v106, v107
    v_cvt_pk_bf16_f32 v56, v120, v121
    v_cvt_pk_bf16_f32 v57, v122, v123
    v_cvt_pk_bf16_f32 v58, v136, v137
    v_cvt_pk_bf16_f32 v59, v138, v139
    v_cvt_pk_bf16_f32 v60, v152, v153
    v_cvt_pk_bf16_f32 v61, v154, v155
    v_cvt_pk_bf16_f32 v62, v92, v93
    v_cvt_pk_bf16_f32 v63, v94, v95
    v_cvt_pk_bf16_f32 v64, v108, v109
    v_cvt_pk_bf16_f32 v65, v110, v111
    v_cvt_pk_bf16_f32 v66, v124, v125
    v_cvt_pk_bf16_f32 v67, v126, v127
    v_cvt_pk_bf16_f32 v68, v140, v141
    v_cvt_pk_bf16_f32 v69, v142, v143
    v_cvt_pk_bf16_f32 v70, v156, v157
    v_cvt_pk_bf16_f32 v71, v158, v159
    v_lshrrev_b32 v20, 5, v1
    v_mul_u32_u24 v21, 2576, v20
    v_bfe_u32 v22, v1, 2, 2
    v_mul_u32_u24 v24, 320, v22
    v_bfe_u32 v23, v1, 4, 1
    v_lshl_add_u32 v21, v23, 5, v21
    v_and_b32 v23, 3, v1
    v_lshl_add_u32 v21, v23, 3, v21
    v_add_u32 v3, v21, v24
    v_add_u32 v2, 111136, v3
    s_mul_i32 s53, s3, 5120
    s_add_u32 s53, s53, 41216
    v_and_b32 v24, 31, v1
    v_mul_u32_u24 v24, 80, v24
    v_lshl_add_u32 v24, v20, 3, v24
    v_add_u32 v10, s53, v24
    v_lshrrev_b32 v24, 2, v1
    v_mul_u32_u24 v24, 80, v24
    v_lshl_add_u32 v24, v23, 4, v24
    v_add_u32 v11, s53, v24
    v_lshrrev_b32 v24, 4, v1
    v_lshlrev_b32 v24, 19, v24
    v_lshl_add_u32 v24, v22, 9, v24
    v_lshl_add_u32 v24, v23, 4, v24
    s_lshl_b32 s53, s2, 11
    s_lshl_b32 s54, s3, 6
    s_add_u32 s53, s53, s54
    v_add_u32 v4, s53, v24
    s_waitcnt lgkmcnt(0)
    s_barrier
    ds_read_b64_tr_b16 v[16:17], v2 offset:0
    ds_read_b64_tr_b16 v[18:19], v2 offset:1288
    ds_read_b64_tr_b16 v[20:21], v2 offset:5152
    ds_read_b64_tr_b16 v[22:23], v2 offset:6440
    ds_read_b64_tr_b16 v[24:25], v2 offset:10304
    ds_read_b64_tr_b16 v[26:27], v2 offset:11592
    ds_read_b64_tr_b16 v[28:29], v2 offset:15456
    ds_read_b64_tr_b16 v[30:31], v2 offset:16744
    ds_read_b64_tr_b16 v[32:33], v2 offset:20608
    ds_read_b64_tr_b16 v[34:35], v2 offset:21896
    ds_read_b64_tr_b16 v[36:37], v2 offset:25760
    ds_read_b64_tr_b16 v[38:39], v2 offset:27048
    s_waitcnt vmcnt(8)
    s_waitcnt lgkmcnt(10)
    v_mfma_f32_32x32x16_bf16 v[80:95], a[32:35], v[16:19], 0
    ds_read_b64_tr_b16 v[40:41], v2 offset:30912
    ds_read_b64_tr_b16 v[42:43], v2 offset:32200
    ds_write_b64 v72, v[52:53] offset:0
    ds_write_b64 v73, v[54:55] offset:0
    s_waitcnt lgkmcnt(10)
    v_mfma_f32_32x32x16_bf16 v[80:95], a[36:39], v[20:23], v[80:95]
    ds_read_b64_tr_b16 v[44:45], v2 offset:36064
    ds_read_b64_tr_b16 v[46:47], v2 offset:37352
    ds_write_b64 v74, v[56:57] offset:0
    ds_write_b64 v75, v[58:59] offset:0
    s_waitcnt lgkmcnt(10)
    v_mfma_f32_32x32x16_bf16 v[80:95], a[40:43], v[24:27], v[80:95]
    ds_read_b64_tr_b16 v[16:17], v2 offset:64
    ds_read_b64_tr_b16 v[18:19], v2 offset:1352
    ds_write_b64 v76, v[60:61] offset:0
    ds_write_b64 v72, v[62:63] offset:20608
    s_waitcnt lgkmcnt(10)
    v_mfma_f32_32x32x16_bf16 v[80:95], a[44:47], v[28:31], v[80:95]
    ds_read_b64_tr_b16 v[20:21], v2 offset:5216
    ds_read_b64_tr_b16 v[22:23], v2 offset:6504
    ds_write_b64 v73, v[64:65] offset:20608
    ds_write_b64 v74, v[66:67] offset:20608
    s_waitcnt lgkmcnt(10)
    v_mfma_f32_32x32x16_bf16 v[80:95], a[48:51], v[32:35], v[80:95]
    ds_read_b64_tr_b16 v[24:25], v2 offset:10368
    ds_read_b64_tr_b16 v[26:27], v2 offset:11656
    ds_write_b64 v75, v[68:69] offset:20608
    ds_write_b64 v76, v[70:71] offset:20608
    s_waitcnt lgkmcnt(10)
    v_mfma_f32_32x32x16_bf16 v[80:95], a[52:55], v[36:39], v[80:95]
    ds_read_b64_tr_b16 v[28:29], v2 offset:15520
    ds_read_b64_tr_b16 v[30:31], v2 offset:16808
    s_waitcnt lgkmcnt(10)
    v_mfma_f32_32x32x16_bf16 v[80:95], a[56:59], v[40:43], v[80:95]
    ds_read_b64_tr_b16 v[32:33], v2 offset:20672
    ds_read_b64_tr_b16 v[34:35], v2 offset:21960
    s_waitcnt lgkmcnt(10)
    v_mfma_f32_32x32x16_bf16 v[80:95], a[60:63], v[44:47], v[80:95]
    ds_read_b64_tr_b16 v[36:37], v2 offset:25824
    ds_read_b64_tr_b16 v[38:39], v2 offset:27112
    s_waitcnt lgkmcnt(10)
    v_mfma_f32_32x32x16_bf16 v[96:111], a[32:35], v[16:19], 0
    ds_read_b64_tr_b16 v[40:41], v2 offset:30976
    ds_read_b64_tr_b16 v[42:43], v2 offset:32264
    s_waitcnt lgkmcnt(10)
    v_mfma_f32_32x32x16_bf16 v[96:111], a[36:39], v[20:23], v[96:111]
    ds_read_b64_tr_b16 v[44:45], v2 offset:36128
    ds_read_b64_tr_b16 v[46:47], v2 offset:37416
    s_waitcnt lgkmcnt(10)
    v_mfma_f32_32x32x16_bf16 v[96:111], a[40:43], v[24:27], v[96:111]
    ds_read_b64_tr_b16 v[16:17], v2 offset:128
    ds_read_b64_tr_b16 v[18:19], v2 offset:1416
    s_waitcnt lgkmcnt(10)
    v_mfma_f32_32x32x16_bf16 v[96:111], a[44:47], v[28:31], v[96:111]
    ds_read_b64_tr_b16 v[20:21], v2 offset:5280
    ds_read_b64_tr_b16 v[22:23], v2 offset:6568
    s_waitcnt lgkmcnt(10)
    v_mfma_f32_32x32x16_bf16 v[96:111], a[48:51], v[32:35], v[96:111]
    ds_read_b64_tr_b16 v[24:25], v2 offset:10432
    ds_read_b64_tr_b16 v[26:27], v2 offset:11720
    s_waitcnt lgkmcnt(10)
    v_mfma_f32_32x32x16_bf16 v[96:111], a[52:55], v[36:39], v[96:111]
    ds_read_b64_tr_b16 v[28:29], v2 offset:15584
    ds_read_b64_tr_b16 v[30:31], v2 offset:16872
    s_waitcnt lgkmcnt(10)
    v_mfma_f32_32x32x16_bf16 v[96:111], a[56:59], v[40:43], v[96:111]
    ds_read_b64_tr_b16 v[32:33], v2 offset:20736
    ds_read_b64_tr_b16 v[34:35], v2 offset:22024
    s_waitcnt lgkmcnt(10)
    v_mfma_f32_32x32x16_bf16 v[96:111], a[60:63], v[44:47], v[96:111]
    ds_read_b64_tr_b16 v[36:37], v2 offset:25888
    ds_read_b64_tr_b16 v[38:39], v2 offset:27176
    s_waitcnt lgkmcnt(10)
    v_mfma_f32_32x32x16_bf16 v[112:127], a[32:35], v[16:19], 0
    ds_read_b64_tr_b16 v[40:41], v2 offset:31040
    ds_read_b64_tr_b16 v[42:43], v2 offset:32328
    s_waitcnt lgkmcnt(10)
    v_mfma_f32_32x32x16_bf16 v[112:127], a[36:39], v[20:23], v[112:127]
    ds_read_b64_tr_b16 v[44:45], v2 offset:36192
    ds_read_b64_tr_b16 v[46:47], v2 offset:37480
    s_barrier
    s_waitcnt lgkmcnt(10)
    v_mfma_f32_32x32x16_bf16 v[112:127], a[40:43], v[24:27], v[112:127]
    ds_read_b64_tr_b16 v[16:17], v3 offset:0
    ds_read_b64_tr_b16 v[18:19], v3 offset:1288
    s_waitcnt lgkmcnt(10)
    v_mfma_f32_32x32x16_bf16 v[112:127], a[44:47], v[28:31], v[112:127]
    ds_read_b64_tr_b16 v[20:21], v3 offset:5152
    ds_read_b64_tr_b16 v[22:23], v3 offset:6440
    s_waitcnt lgkmcnt(10)
    v_mfma_f32_32x32x16_bf16 v[112:127], a[48:51], v[32:35], v[112:127]
    ds_read_b64_tr_b16 v[24:25], v3 offset:10304
    ds_read_b64_tr_b16 v[26:27], v3 offset:11592
    s_waitcnt lgkmcnt(10)
    v_mfma_f32_32x32x16_bf16 v[112:127], a[52:55], v[36:39], v[112:127]
    ds_read_b64_tr_b16 v[28:29], v3 offset:15456
    ds_read_b64_tr_b16 v[30:31], v3 offset:16744
    s_waitcnt lgkmcnt(10)
    v_mfma_f32_32x32x16_bf16 v[112:127], a[56:59], v[40:43], v[112:127]
    ds_read_b64_tr_b16 v[32:33], v3 offset:20608
    ds_read_b64_tr_b16 v[34:35], v3 offset:21896
    s_waitcnt lgkmcnt(10)
    v_mfma_f32_32x32x16_bf16 v[112:127], a[60:63], v[44:47], v[112:127]
    ds_read_b64_tr_b16 v[36:37], v3 offset:25760
    ds_read_b64_tr_b16 v[38:39], v3 offset:27048
    s_waitcnt vmcnt(0)
    s_waitcnt lgkmcnt(10)
    v_mfma_f32_32x32x16_bf16 v[80:95], a[64:67], v[16:19], v[80:95]
    ds_read_b64_tr_b16 v[40:41], v3 offset:30912
    ds_read_b64_tr_b16 v[42:43], v3 offset:32200
    s_waitcnt lgkmcnt(10)
    v_mfma_f32_32x32x16_bf16 v[80:95], a[68:71], v[20:23], v[80:95]
    ds_read_b64_tr_b16 v[44:45], v3 offset:36064
    ds_read_b64_tr_b16 v[46:47], v3 offset:37352
    s_waitcnt lgkmcnt(10)
    v_mfma_f32_32x32x16_bf16 v[80:95], a[72:75], v[24:27], v[80:95]
    ds_read_b64_tr_b16 v[16:17], v3 offset:64
    ds_read_b64_tr_b16 v[18:19], v3 offset:1352
    s_waitcnt lgkmcnt(10)
    v_mfma_f32_32x32x16_bf16 v[80:95], a[76:79], v[28:31], v[80:95]
    ds_read_b64_tr_b16 v[20:21], v3 offset:5216
    ds_read_b64_tr_b16 v[22:23], v3 offset:6504
    s_waitcnt lgkmcnt(10)
    v_mfma_f32_32x32x16_bf16 v[80:95], a[80:83], v[32:35], v[80:95]
    ds_read_b64_tr_b16 v[24:25], v3 offset:10368
    ds_read_b64_tr_b16 v[26:27], v3 offset:11656
    s_waitcnt lgkmcnt(10)
    v_mfma_f32_32x32x16_bf16 v[80:95], a[84:87], v[36:39], v[80:95]
    ds_read_b64_tr_b16 v[28:29], v3 offset:15520
    ds_read_b64_tr_b16 v[30:31], v3 offset:16808
    s_waitcnt lgkmcnt(10)
    v_mfma_f32_32x32x16_bf16 v[80:95], a[88:91], v[40:43], v[80:95]
    ds_read_b64_tr_b16 v[32:33], v3 offset:20672
    ds_read_b64_tr_b16 v[34:35], v3 offset:21960
    s_waitcnt lgkmcnt(10)
    v_mfma_f32_32x32x16_bf16 v[80:95], a[92:95], v[44:47], v[80:95]
    ds_read_b64_tr_b16 v[36:37], v3 offset:25824
    ds_read_b64_tr_b16 v[38:39], v3 offset:27112
    s_waitcnt lgkmcnt(10)
    v_mfma_f32_32x32x16_bf16 v[96:111], a[64:67], v[16:19], v[96:111]
    ds_read_b64_tr_b16 v[40:41], v3 offset:30976
    ds_read_b64_tr_b16 v[42:43], v3 offset:32264
    s_waitcnt lgkmcnt(10)
    v_mfma_f32_32x32x16_bf16 v[96:111], a[68:71], v[20:23], v[96:111]
    ds_read_b64_tr_b16 v[44:45], v3 offset:36128
    ds_read_b64_tr_b16 v[46:47], v3 offset:37416
    s_waitcnt lgkmcnt(10)
    v_mfma_f32_32x32x16_bf16 v[96:111], a[72:75], v[24:27], v[96:111]
    ds_read_b64_tr_b16 v[16:17], v3 offset:128
    ds_read_b64_tr_b16 v[18:19], v3 offset:1416
    s_waitcnt lgkmcnt(10)
    v_mfma_f32_32x32x16_bf16 v[96:111], a[76:79], v[28:31], v[96:111]
    ds_read_b64_tr_b16 v[20:21], v3 offset:5280
    ds_read_b64_tr_b16 v[22:23], v3 offset:6568
    v_cvt_pk_bf16_f32 v80, v80, v81
    v_cvt_pk_bf16_f32 v81, v82, v83
    ds_write_b64 v10, v[80:81] offset:0
    s_waitcnt lgkmcnt(10)
    v_mfma_f32_32x32x16_bf16 v[96:111], a[80:83], v[32:35], v[96:111]
    ds_read_b64_tr_b16 v[24:25], v3 offset:10432
    ds_read_b64_tr_b16 v[26:27], v3 offset:11720
    v_cvt_pk_bf16_f32 v82, v84, v85
    v_cvt_pk_bf16_f32 v83, v86, v87
    ds_write_b64 v10, v[82:83] offset:16
    s_waitcnt lgkmcnt(10)
    v_mfma_f32_32x32x16_bf16 v[96:111], a[84:87], v[36:39], v[96:111]
    ds_read_b64_tr_b16 v[28:29], v3 offset:15584
    ds_read_b64_tr_b16 v[30:31], v3 offset:16872
    v_cvt_pk_bf16_f32 v84, v88, v89
    v_cvt_pk_bf16_f32 v85, v90, v91
    ds_write_b64 v10, v[84:85] offset:32
    s_waitcnt lgkmcnt(10)
    v_mfma_f32_32x32x16_bf16 v[96:111], a[88:91], v[40:43], v[96:111]
    ds_read_b64_tr_b16 v[32:33], v3 offset:20736
    ds_read_b64_tr_b16 v[34:35], v3 offset:22024
    v_cvt_pk_bf16_f32 v86, v92, v93
    v_cvt_pk_bf16_f32 v87, v94, v95
    ds_write_b64 v10, v[86:87] offset:48
    s_waitcnt lgkmcnt(10)
    v_mfma_f32_32x32x16_bf16 v[96:111], a[92:95], v[44:47], v[96:111]
    ds_read_b64_tr_b16 v[36:37], v3 offset:25888
    ds_read_b64_tr_b16 v[38:39], v3 offset:27176
    ds_read_b128 v[52:55], v11 offset:0
    ds_read_b128 v[56:59], v11 offset:1280
    s_waitcnt lgkmcnt(10)
    v_mfma_f32_32x32x16_bf16 v[112:127], a[64:67], v[16:19], v[112:127]
    ds_read_b64_tr_b16 v[40:41], v3 offset:31040
    ds_read_b64_tr_b16 v[42:43], v3 offset:32328
    s_waitcnt lgkmcnt(10)
    v_mfma_f32_32x32x16_bf16 v[112:127], a[68:71], v[20:23], v[112:127]
    ds_read_b64_tr_b16 v[44:45], v3 offset:36192
    ds_read_b64_tr_b16 v[46:47], v3 offset:37480
    s_waitcnt lgkmcnt(10)
    v_mfma_f32_32x32x16_bf16 v[112:127], a[72:75], v[24:27], v[112:127]
    ds_read_b64_tr_b16 v[16:17], v2 offset:192
    ds_read_b64_tr_b16 v[18:19], v2 offset:1480
    s_waitcnt lgkmcnt(10)
    v_mfma_f32_32x32x16_bf16 v[112:127], a[76:79], v[28:31], v[112:127]
    ds_read_b64_tr_b16 v[20:21], v2 offset:5344
    ds_read_b64_tr_b16 v[22:23], v2 offset:6632
    v_cvt_pk_bf16_f32 v96, v96, v97
    v_cvt_pk_bf16_f32 v97, v98, v99
    ds_write_b64 v10, v[96:97] offset:2560
    s_waitcnt lgkmcnt(10)
    v_mfma_f32_32x32x16_bf16 v[112:127], a[80:83], v[32:35], v[112:127]
    ds_read_b64_tr_b16 v[24:25], v2 offset:10496
    ds_read_b64_tr_b16 v[26:27], v2 offset:11784
    v_cvt_pk_bf16_f32 v98, v100, v101
    v_cvt_pk_bf16_f32 v99, v102, v103
    ds_write_b64 v10, v[98:99] offset:2576
    s_waitcnt lgkmcnt(10)
    v_mfma_f32_32x32x16_bf16 v[112:127], a[84:87], v[36:39], v[112:127]
    ds_read_b64_tr_b16 v[28:29], v2 offset:15648
    ds_read_b64_tr_b16 v[30:31], v2 offset:16936
    v_cvt_pk_bf16_f32 v100, v104, v105
    v_cvt_pk_bf16_f32 v101, v106, v107
    ds_write_b64 v10, v[100:101] offset:2592
    s_waitcnt lgkmcnt(10)
    v_mfma_f32_32x32x16_bf16 v[112:127], a[88:91], v[40:43], v[112:127]
    ds_read_b64_tr_b16 v[32:33], v2 offset:20800
    ds_read_b64_tr_b16 v[34:35], v2 offset:22088
    buffer_store_dwordx4 v[52:55], v4, s[28:31], 0 offen sc1
    v_add_u32 v4, 2097152, v4
    buffer_store_dwordx4 v[56:59], v4, s[28:31], 0 offen sc1
    v_add_u32 v4, 2097152, v4
    v_cvt_pk_bf16_f32 v102, v108, v109
    v_cvt_pk_bf16_f32 v103, v110, v111
    ds_write_b64 v10, v[102:103] offset:2608
    s_waitcnt lgkmcnt(10)
    v_mfma_f32_32x32x16_bf16 v[112:127], a[92:95], v[44:47], v[112:127]
    ds_read_b64_tr_b16 v[36:37], v2 offset:25952
    ds_read_b64_tr_b16 v[38:39], v2 offset:27240
    ds_read_b128 v[60:63], v11 offset:2560
    ds_read_b128 v[64:67], v11 offset:3840
    s_waitcnt lgkmcnt(10)
    v_mfma_f32_32x32x16_bf16 v[128:143], a[32:35], v[16:19], 0
    ds_read_b64_tr_b16 v[40:41], v2 offset:31104
    ds_read_b64_tr_b16 v[42:43], v2 offset:32392
    s_waitcnt lgkmcnt(10)
    v_mfma_f32_32x32x16_bf16 v[128:143], a[36:39], v[20:23], v[128:143]
    ds_read_b64_tr_b16 v[44:45], v2 offset:36256
    ds_read_b64_tr_b16 v[46:47], v2 offset:37544
    s_waitcnt lgkmcnt(10)
    v_mfma_f32_32x32x16_bf16 v[128:143], a[40:43], v[24:27], v[128:143]
    ds_read_b64_tr_b16 v[16:17], v3 offset:192
    ds_read_b64_tr_b16 v[18:19], v3 offset:1480
    s_waitcnt lgkmcnt(10)
    v_mfma_f32_32x32x16_bf16 v[128:143], a[44:47], v[28:31], v[128:143]
    ds_read_b64_tr_b16 v[20:21], v3 offset:5344
    ds_read_b64_tr_b16 v[22:23], v3 offset:6632
    v_cvt_pk_bf16_f32 v112, v112, v113
    v_cvt_pk_bf16_f32 v113, v114, v115
    ds_write_b64 v10, v[112:113] offset:0
    s_waitcnt lgkmcnt(10)
    v_mfma_f32_32x32x16_bf16 v[128:143], a[48:51], v[32:35], v[128:143]
    ds_read_b64_tr_b16 v[24:25], v3 offset:10496
    ds_read_b64_tr_b16 v[26:27], v3 offset:11784
    v_cvt_pk_bf16_f32 v114, v116, v117
    v_cvt_pk_bf16_f32 v115, v118, v119
    ds_write_b64 v10, v[114:115] offset:16
    s_waitcnt lgkmcnt(10)
    v_mfma_f32_32x32x16_bf16 v[128:143], a[52:55], v[36:39], v[128:143]
    ds_read_b64_tr_b16 v[28:29], v3 offset:15648
    ds_read_b64_tr_b16 v[30:31], v3 offset:16936
    v_cvt_pk_bf16_f32 v116, v120, v121
    v_cvt_pk_bf16_f32 v117, v122, v123
    ds_write_b64 v10, v[116:117] offset:32
    s_waitcnt lgkmcnt(10)
    v_mfma_f32_32x32x16_bf16 v[128:143], a[56:59], v[40:43], v[128:143]
    ds_read_b64_tr_b16 v[32:33], v3 offset:20800
    ds_read_b64_tr_b16 v[34:35], v3 offset:22088
    buffer_store_dwordx4 v[60:63], v4, s[28:31], 0 offen sc1
    v_add_u32 v4, 2097152, v4
    buffer_store_dwordx4 v[64:67], v4, s[28:31], 0 offen sc1
    v_add_u32 v4, 2097152, v4
    v_cvt_pk_bf16_f32 v118, v124, v125
    v_cvt_pk_bf16_f32 v119, v126, v127
    ds_write_b64 v10, v[118:119] offset:48
    s_waitcnt lgkmcnt(10)
    v_mfma_f32_32x32x16_bf16 v[128:143], a[60:63], v[44:47], v[128:143]
    ds_read_b64_tr_b16 v[36:37], v3 offset:25952
    ds_read_b64_tr_b16 v[38:39], v3 offset:27240
    ds_read_b128 v[52:55], v11 offset:0
    ds_read_b128 v[56:59], v11 offset:1280
    s_waitcnt lgkmcnt(10)
    v_mfma_f32_32x32x16_bf16 v[128:143], a[64:67], v[16:19], v[128:143]
    ds_read_b64_tr_b16 v[40:41], v3 offset:31104
    ds_read_b64_tr_b16 v[42:43], v3 offset:32392
    s_waitcnt lgkmcnt(10)
    v_mfma_f32_32x32x16_bf16 v[128:143], a[68:71], v[20:23], v[128:143]
    ds_read_b64_tr_b16 v[44:45], v3 offset:36256
    ds_read_b64_tr_b16 v[46:47], v3 offset:37544
    s_waitcnt lgkmcnt(10)
    v_mfma_f32_32x32x16_bf16 v[128:143], a[72:75], v[24:27], v[128:143]
    ds_read_b64_tr_b16 v[16:17], v2 offset:256
    ds_read_b64_tr_b16 v[18:19], v2 offset:1544
    s_waitcnt lgkmcnt(10)
    v_mfma_f32_32x32x16_bf16 v[128:143], a[76:79], v[28:31], v[128:143]
    ds_read_b64_tr_b16 v[20:21], v2 offset:5408
    ds_read_b64_tr_b16 v[22:23], v2 offset:6696
    s_waitcnt lgkmcnt(10)
    v_mfma_f32_32x32x16_bf16 v[128:143], a[80:83], v[32:35], v[128:143]
    ds_read_b64_tr_b16 v[24:25], v2 offset:10560
    ds_read_b64_tr_b16 v[26:27], v2 offset:11848
    s_waitcnt lgkmcnt(10)
    v_mfma_f32_32x32x16_bf16 v[128:143], a[84:87], v[36:39], v[128:143]
    ds_read_b64_tr_b16 v[28:29], v2 offset:15712
    ds_read_b64_tr_b16 v[30:31], v2 offset:17000
    s_waitcnt lgkmcnt(10)
    v_mfma_f32_32x32x16_bf16 v[128:143], a[88:91], v[40:43], v[128:143]
    ds_read_b64_tr_b16 v[32:33], v2 offset:20864
    ds_read_b64_tr_b16 v[34:35], v2 offset:22152
    buffer_store_dwordx4 v[52:55], v4, s[28:31], 0 offen sc1
    v_add_u32 v4, 2097152, v4
    buffer_store_dwordx4 v[56:59], v4, s[28:31], 0 offen sc1
    v_add_u32 v4, 2097152, v4
    s_waitcnt lgkmcnt(10)
    v_mfma_f32_32x32x16_bf16 v[128:143], a[92:95], v[44:47], v[128:143]
    ds_read_b64_tr_b16 v[36:37], v2 offset:26016
    ds_read_b64_tr_b16 v[38:39], v2 offset:27304
    s_waitcnt lgkmcnt(10)
    v_mfma_f32_32x32x16_bf16 v[144:159], a[32:35], v[16:19], 0
    ds_read_b64_tr_b16 v[40:41], v2 offset:31168
    ds_read_b64_tr_b16 v[42:43], v2 offset:32456
    s_waitcnt lgkmcnt(10)
    v_mfma_f32_32x32x16_bf16 v[144:159], a[36:39], v[20:23], v[144:159]
    ds_read_b64_tr_b16 v[44:45], v2 offset:36320
    ds_read_b64_tr_b16 v[46:47], v2 offset:37608
    s_waitcnt lgkmcnt(10)
    v_mfma_f32_32x32x16_bf16 v[144:159], a[40:43], v[24:27], v[144:159]
    ds_read_b64_tr_b16 v[16:17], v3 offset:256
    ds_read_b64_tr_b16 v[18:19], v3 offset:1544
    s_waitcnt lgkmcnt(10)
    v_mfma_f32_32x32x16_bf16 v[144:159], a[44:47], v[28:31], v[144:159]
    ds_read_b64_tr_b16 v[20:21], v3 offset:5408
    ds_read_b64_tr_b16 v[22:23], v3 offset:6696
    v_cvt_pk_bf16_f32 v128, v128, v129
    v_cvt_pk_bf16_f32 v129, v130, v131
    ds_write_b64 v10, v[128:129] offset:2560
    s_waitcnt lgkmcnt(10)
    v_mfma_f32_32x32x16_bf16 v[144:159], a[48:51], v[32:35], v[144:159]
    ds_read_b64_tr_b16 v[24:25], v3 offset:10560
    ds_read_b64_tr_b16 v[26:27], v3 offset:11848
    v_cvt_pk_bf16_f32 v130, v132, v133
    v_cvt_pk_bf16_f32 v131, v134, v135
    ds_write_b64 v10, v[130:131] offset:2576
    s_waitcnt lgkmcnt(10)
    v_mfma_f32_32x32x16_bf16 v[144:159], a[52:55], v[36:39], v[144:159]
    ds_read_b64_tr_b16 v[28:29], v3 offset:15712
    ds_read_b64_tr_b16 v[30:31], v3 offset:17000
    v_cvt_pk_bf16_f32 v132, v136, v137
    v_cvt_pk_bf16_f32 v133, v138, v139
    ds_write_b64 v10, v[132:133] offset:2592
    s_waitcnt lgkmcnt(10)
    v_mfma_f32_32x32x16_bf16 v[144:159], a[56:59], v[40:43], v[144:159]
    ds_read_b64_tr_b16 v[32:33], v3 offset:20864
    ds_read_b64_tr_b16 v[34:35], v3 offset:22152
    v_cvt_pk_bf16_f32 v134, v140, v141
    v_cvt_pk_bf16_f32 v135, v142, v143
    ds_write_b64 v10, v[134:135] offset:2608
    s_waitcnt lgkmcnt(10)
    v_mfma_f32_32x32x16_bf16 v[144:159], a[60:63], v[44:47], v[144:159]
    ds_read_b64_tr_b16 v[36:37], v3 offset:26016
    ds_read_b64_tr_b16 v[38:39], v3 offset:27304
    ds_read_b128 v[60:63], v11 offset:2560
    ds_read_b128 v[64:67], v11 offset:3840
    s_waitcnt lgkmcnt(10)
    v_mfma_f32_32x32x16_bf16 v[144:159], a[64:67], v[16:19], v[144:159]
    ds_read_b64_tr_b16 v[40:41], v3 offset:31168
    ds_read_b64_tr_b16 v[42:43], v3 offset:32456
    s_waitcnt lgkmcnt(10)
    v_mfma_f32_32x32x16_bf16 v[144:159], a[68:71], v[20:23], v[144:159]
    ds_read_b64_tr_b16 v[44:45], v3 offset:36320
    ds_read_b64_tr_b16 v[46:47], v3 offset:37608
    s_waitcnt lgkmcnt(10)
    v_mfma_f32_32x32x16_bf16 v[144:159], a[72:75], v[24:27], v[144:159]
    s_waitcnt lgkmcnt(8)
    v_mfma_f32_32x32x16_bf16 v[144:159], a[76:79], v[28:31], v[144:159]
    s_waitcnt lgkmcnt(6)
    v_mfma_f32_32x32x16_bf16 v[144:159], a[80:83], v[32:35], v[144:159]
    s_waitcnt lgkmcnt(4)
    v_mfma_f32_32x32x16_bf16 v[144:159], a[84:87], v[36:39], v[144:159]
    s_waitcnt lgkmcnt(2)
    v_mfma_f32_32x32x16_bf16 v[144:159], a[88:91], v[40:43], v[144:159]
    buffer_store_dwordx4 v[60:63], v4, s[28:31], 0 offen sc1
    v_add_u32 v4, 2097152, v4
    buffer_store_dwordx4 v[64:67], v4, s[28:31], 0 offen sc1
    v_add_u32 v4, 2097152, v4
    s_waitcnt lgkmcnt(0)
    v_mfma_f32_32x32x16_bf16 v[144:159], a[92:95], v[44:47], v[144:159]
    s_nop 11
    v_cvt_pk_bf16_f32 v144, v144, v145
    v_cvt_pk_bf16_f32 v145, v146, v147
    v_cvt_pk_bf16_f32 v146, v148, v149
    v_cvt_pk_bf16_f32 v147, v150, v151
    v_cvt_pk_bf16_f32 v148, v152, v153
    v_cvt_pk_bf16_f32 v149, v154, v155
    v_cvt_pk_bf16_f32 v150, v156, v157
    v_cvt_pk_bf16_f32 v151, v158, v159
    ds_write_b64 v10, v[144:145] offset:0
    ds_write_b64 v10, v[146:147] offset:16
    ds_write_b64 v10, v[148:149] offset:32
    ds_write_b64 v10, v[150:151] offset:48
    ds_read_b128 v[52:55], v11 offset:0
    ds_read_b128 v[56:59], v11 offset:1280
    s_waitcnt lgkmcnt(0)
    buffer_store_dwordx4 v[52:55], v4, s[28:31], 0 offen sc1
    v_add_u32 v4, 2097152, v4
    buffer_store_dwordx4 v[56:59], v4, s[28:31], 0 offen sc1
    v_add_u32 v4, 2097152, v4
L_end:
    s_endpgm
.section .rodata,"a"
.p2align 6
.amdhsa_kernel standalone__tensor_product_equiv_mace__graph_kernel
  .amdhsa_next_free_vgpr 256
  .amdhsa_next_free_sgpr 102
  .amdhsa_accum_offset 160
  .amdhsa_group_segment_fixed_size 0
  .amdhsa_kernarg_size 88
  .amdhsa_user_sgpr_count 2
  .amdhsa_user_sgpr_kernarg_segment_ptr 1
  .amdhsa_system_sgpr_workgroup_id_x 1
  .amdhsa_float_denorm_mode_32 3
.end_amdhsa_kernel
```

```asm
; @launch grid=(256,1,1) block=(512,1,1) lds=153600
.amdgcn_target "amdgcn-amd-amdhsa--gfx950"
.text
.globl standalone__tensor_product_equiv_mace__graph_kernel
.p2align 8
.type standalone__tensor_product_equiv_mace__graph_kernel,@function
standalone__tensor_product_equiv_mace__graph_kernel:
    s_cmp_ge_u32 s2, 256
    s_cbranch_scc1 L_end
    s_load_dwordx2 s[84:85], s[0:1], 80
    s_load_dwordx16 s[64:79], s[0:1], 0
    s_load_dwordx2 s[80:81], s[0:1], 64
    v_and_b32 v1, 63, v0
    v_lshrrev_b32 v60, 6, v0
    v_mov_b32 v12, 0
    v_readfirstlane_b32 s3, v60
    s_and_b32 s55, s2, 63
    s_and_b32 s54, s2, 192
    s_mul_i32 s53, s55, 10000
    v_lshlrev_b32 v63, 4, v0
    v_add_u32 v60, s53, v63
    s_add_u32 s53, s53, 8192
    v_lshl_add_u32 v61, v0, 2, s53
    s_lshl_b32 s53, s54, 1
    v_mov_b32 v62, s53
    s_waitcnt lgkmcnt(0)
    s_mov_b32 s16, s68
    s_mov_b32 s17, s69
    s_mov_b32 s18, 640000
    s_mov_b32 s19, 0x00020000
    buffer_load_dwordx4 v[16:19], v60, s[16:19], 0 offen
    buffer_load_dword v20, v61, s[16:19], 0 offen
    s_mov_b32 s12, s66
    s_mov_b32 s13, s67
    s_mov_b32 s14, 640000
    s_mov_b32 s15, 0x00020000
    buffer_load_dwordx4 v[24:27], v60, s[12:15], 0 offen
    buffer_load_dword v28, v61, s[12:15], 0 offen
    s_mov_b32 s32, s84
    s_mov_b32 s33, s85
    s_mov_b32 s34, 20971520
    s_mov_b32 s35, 0x00020000
    buffer_load_dword v42, v62, s[32:35], 0 offen sc1
    s_mov_b32 s20, s70
    s_mov_b32 s21, s71
    s_mov_b32 s22, 1280000
    s_mov_b32 s23, 0x00020000
    v_mov_b32 v72, -1
    v_mov_b32 v73, -1
    v_mov_b32 v74, -1
    v_mov_b32 v75, -1
    ds_write_b128 v63, v[72:75] offset:0
    ds_write_b128 v63, v[72:75] offset:8192
    v_mov_b32 v68, 0
    v_mov_b32 v69, 0
    v_lshlrev_b32 v60, 3, v0
    v_add_u32 v60, 111136, v60
    ds_write_b64 v60, v[68:69]
    v_min_u32 v60, 35, v1
    v_lshlrev_b32 v60, 3, v60
    v_add_u32 v60, 110848, v60
    ds_write_b64 v60, v[68:69]
    s_mov_b32 s8, s64
    s_mov_b32 s9, s65
    s_mov_b32 s10, 20480000
    s_mov_b32 s11, 0x00020000
    s_mov_b32 s24, s72
    s_mov_b32 s25, s73
    s_mov_b32 s26, 5120000
    s_mov_b32 s27, 0x00020000
    s_mov_b32 s28, s80
    s_mov_b32 s29, s81
    s_mov_b32 s30, 20480000
    s_mov_b32 s31, 0x00020000
    s_mov_b32 s96, s74
    s_mov_b32 s97, s75
    s_mov_b32 s98, 128
    s_mov_b32 s99, 0x00020000
    s_mov_b32 s92, s76
    s_mov_b32 s93, s77
    s_mov_b32 s94, 8192
    s_mov_b32 s95, 0x00020000
    s_mov_b32 s88, s78
    s_mov_b32 s89, s79
    s_mov_b32 s90, 131072
    s_mov_b32 s91, 0x00020000
    s_lshl_b32 s63, s3, 13
    s_mov_b32 s52, 0
    s_mov_b32 s77, 0
    s_mov_b32 s82, 0x3fff00
    s_mov_b32 s83, 20971520
    s_mov_b32 s81, 8
    s_lshl_b32 s49, s3, 10
    s_add_u32 s49, s49, 119328
    s_movk_i32 s53, 452
    v_cmp_gt_u32 s[50:51], s53, v0
    v_lshlrev_b32 v43, 22, v0
    v_lshlrev_b32 v59, 20, v0
    v_mov_b32 v58, 1
    s_waitcnt lgkmcnt(0)
    s_barrier
    v_and_b32 v60, 3, v1
    v_lshlrev_b32 v61, 5, v60
    v_lshrrev_b32 v66, 4, v1
    v_lshl_add_u32 v61, v66, 1, v61
    buffer_load_ushort v44, v61, s[96:99], 0 offen offset:0
    buffer_load_ushort v45, v61, s[96:99], 0 offen offset:8
    buffer_load_ushort v46, v61, s[96:99], 0 offen offset:16
    buffer_load_ushort v47, v61, s[96:99], 0 offen offset:24
    s_lshl_b32 s53, s3, 10
    s_add_u32 m0, s53, 32768
    v_lshlrev_b32 v64, 4, v1
    buffer_load_dwordx4 v64, s[92:95], s53 offen lds
    s_lshr_b32 s53, s2, 3
    s_lshl3_add_u32 s53, s53, s3
    s_lshl_b32 s53, s53, 10
    v_add_u32 v79, s53, v64
    buffer_load_dwordx4 v[156:159], v79, s[20:23], 0 offen
    v_add_u32 v79, 262144, v79
    buffer_load_dwordx4 v[156:159], v79, s[20:23], 0 offen
    v_add_u32 v79, 262144, v79
    v_and_b32 v61, 7, v1
    v_bfe_u32 v65, v1, 3, 1
    v_lshlrev_b32 v65, 9, v65
    v_lshl_add_u32 v65, v66, 7, v65
    v_lshl_add_u32 v2, v61, 4, v65
    v_xor_b32 v61, 4, v61
    v_lshl_add_u32 v3, v61, 4, v65
    v_bfe_u32 v60, v1, 2, 2
    v_bfe_u32 v62, v1, 1, 1
    v_lshl_add_u32 v62, v66, 1, v62
    v_lshrrev_b32 v63, 1, v60
    v_lshlrev_b32 v64, 2, v63
    v_xor_b32 v62, v62, v64
    v_and_b32 v64, 1, v60
    v_lshl_add_u32 v62, v64, 3, v62
    v_lshlrev_b32 v62, 4, v62
    v_lshl_add_u32 v62, v63, 10, v62
    v_and_b32 v64, 1, v1
    v_lshl_add_u32 v62, v64, 3, v62
    v_add_u32 v4, s63, v62
    v_lshrrev_b32 v61, 5, v1
    v_mov_b32 v63, 32
    v_cmp_eq_u32 vcc, v60, v61
    v_add_u32 v61, 2, v61
    v_and_b32 v64, 3, v1
    v_cndmask_b32 v7, 0, v63, vcc
    v_cmp_eq_u32 vcc, v60, v61
    v_cmp_eq_u32 s[4:5], v64, v66
    v_mov_b32 v65, 8
    v_cndmask_b32 v8, 0, v63, vcc
    v_cndmask_b32 v10, 0, v65, s[4:5]
    v_lshrrev_b32 v68, 3, v0
    v_and_b32 v69, 7, v0
    v_lshlrev_b32 v69, 4, v69
    v_add_u32 v61, s54, v68
    s_movk_i32 s46, 8320
    v_mad_u32_u24 v64, v61, s46, v69
    s_lshl_b32 s45, s55, 7
    s_add_u32 s53, s45, 8388608
    v_add_u32 v64, s53, v64
    v_lshl_add_u32 v65, v61, 13, v69
    s_add_u32 s53, s45, 16777216
    v_add_u32 v65, s53, v65
    v_lshlrev_b32 v61, 4, v0
    s_mov_b32 s53, 110880
    v_lshl_add_u32 v67, v68, 2, s53
    s_waitcnt vmcnt(10)
    v_and_b32 v48, 255, v16
    v_subrev_u32 v48, s54, v48
    v_cmp_gt_u32 s[64:65], 64, v48
    v_lshl_add_u32 v60, v48, 2, s53
    s_mov_b64 exec, s[64:65]
    ds_add_rtn_u32 v53, v60, v58
    s_mov_b64 exec, -1
    v_and_b32 v49, 255, v17
    v_subrev_u32 v49, s54, v49
    v_cmp_gt_u32 s[66:67], 64, v49
    v_lshl_add_u32 v60, v49, 2, s53
    s_mov_b64 exec, s[66:67]
    ds_add_rtn_u32 v54, v60, v58
    s_mov_b64 exec, -1
    v_and_b32 v50, 255, v18
    v_subrev_u32 v50, s54, v50
    v_cmp_gt_u32 s[68:69], 64, v50
    v_lshl_add_u32 v60, v50, 2, s53
    s_mov_b64 exec, s[68:69]
    ds_add_rtn_u32 v55, v60, v58
    s_mov_b64 exec, -1
    v_and_b32 v51, 255, v19
    v_subrev_u32 v51, s54, v51
    v_cmp_gt_u32 s[70:71], 64, v51
    v_lshl_add_u32 v60, v51, 2, s53
    s_mov_b64 exec, s[70:71]
    ds_add_rtn_u32 v56, v60, v58
    s_mov_b64 exec, -1
    v_and_b32 v52, 255, v20
    v_subrev_u32 v52, s54, v52
    v_cmp_gt_u32 s[72:73], 64, v52
    v_lshl_add_u32 v60, v52, 2, s53
    s_and_b64 s[72:73], s[72:73], s[50:51]
    s_mov_b64 exec, s[72:73]
    ds_add_rtn_u32 v57, v60, v58
    s_mov_b64 exec, -1
    s_waitcnt vmcnt(7)
    v_readfirstlane_b32 s48, v42
    buffer_load_dwordx4 v[156:159], v79, s[20:23], 0 offen
    v_add_u32 v79, 262144, v79
    buffer_load_dwordx4 v[156:159], v79, s[20:23], 0 offen
    v_add_u32 v79, 262144, v79
    buffer_load_dwordx4 v[156:159], v79, s[20:23], 0 offen
    v_add_u32 v79, 262144, v79
    v_bfe_u32 v16, v16, 8, 6
    v_min_u32 v16, 47, v16
    v_and_b32 v24, 0x3fff, v24
    v_lshl_or_b32 v16, v24, 6, v16
    v_add_u32 v24, 0, v43
    v_or_b32 v16, v16, v24
    v_lshlrev_b32 v48, 7, v48
    v_bfe_u32 v17, v17, 8, 6
    v_min_u32 v17, 47, v17
    v_and_b32 v25, 0x3fff, v25
    v_lshl_or_b32 v17, v25, 6, v17
    v_add_u32 v25, 1048576, v43
    v_or_b32 v17, v17, v25
    v_lshlrev_b32 v49, 7, v49
    v_bfe_u32 v18, v18, 8, 6
    v_min_u32 v18, 47, v18
    v_and_b32 v26, 0x3fff, v26
    v_lshl_or_b32 v18, v26, 6, v18
    v_add_u32 v26, 2097152, v43
    v_or_b32 v18, v18, v26
    v_lshlrev_b32 v50, 7, v50
    v_bfe_u32 v19, v19, 8, 6
    v_min_u32 v19, 47, v19
    v_and_b32 v27, 0x3fff, v27
    v_lshl_or_b32 v19, v27, 6, v19
    v_add_u32 v27, 3145728, v43
    v_or_b32 v19, v19, v27
    v_lshlrev_b32 v51, 7, v51
    v_bfe_u32 v20, v20, 8, 6
    v_min_u32 v20, 47, v20
    v_and_b32 v28, 0x3fff, v28
    v_lshl_or_b32 v20, v28, 6, v20
    v_add_u32 v28, 2147483648, v59
    v_or_b32 v20, v20, v28
    v_lshlrev_b32 v52, 7, v52
    v_mov_b32 v59, -2
    s_add_u32 s48, s48, 1
    s_movk_i32 s53, 7808
    s_waitcnt lgkmcnt(0)
    v_cmp_gt_u32 vcc, 31, v53
    v_min_u32 v53, 31, v53
    v_mul_u32_u24 v32, 43, v53
    v_cndmask_b32 v16, v59, v16, vcc
    v_lshrrev_b32 v32, 7, v32
    v_cmp_gt_u32 vcc, 24, v53
    v_add_lshl_u32 v32, v32, v53, 2
    v_lshl_add_u32 v33, v53, 4, s53
    v_cndmask_b32 v32, v33, v32, vcc
    v_add_u32 v48, v48, v32
    s_mov_b64 exec, s[64:65]
    ds_write_b32 v48, v16 offset:0
    s_mov_b64 exec, -1
    v_cmp_gt_u32 vcc, 31, v54
    v_min_u32 v54, 31, v54
    v_mul_u32_u24 v32, 43, v54
    v_cndmask_b32 v17, v59, v17, vcc
    v_lshrrev_b32 v32, 7, v32
    v_cmp_gt_u32 vcc, 24, v54
    v_add_lshl_u32 v32, v32, v54, 2
    v_lshl_add_u32 v33, v54, 4, s53
    v_cndmask_b32 v32, v33, v32, vcc
    v_add_u32 v49, v49, v32
    s_mov_b64 exec, s[66:67]
    ds_write_b32 v49, v17 offset:0
    s_mov_b64 exec, -1
    v_cmp_gt_u32 vcc, 31, v55
    v_min_u32 v55, 31, v55
    v_mul_u32_u24 v32, 43, v55
    v_cndmask_b32 v18, v59, v18, vcc
    v_lshrrev_b32 v32, 7, v32
    v_cmp_gt_u32 vcc, 24, v55
    v_add_lshl_u32 v32, v32, v55, 2
    v_lshl_add_u32 v33, v55, 4, s53
    v_cndmask_b32 v32, v33, v32, vcc
    v_add_u32 v50, v50, v32
    s_mov_b64 exec, s[68:69]
    ds_write_b32 v50, v18 offset:0
    s_mov_b64 exec, -1
    v_cmp_gt_u32 vcc, 31, v56
    v_min_u32 v56, 31, v56
    v_mul_u32_u24 v32, 43, v56
    v_cndmask_b32 v19, v59, v19, vcc
    v_lshrrev_b32 v32, 7, v32
    v_cmp_gt_u32 vcc, 24, v56
    v_add_lshl_u32 v32, v32, v56, 2
    v_lshl_add_u32 v33, v56, 4, s53
    v_cndmask_b32 v32, v33, v32, vcc
    v_add_u32 v51, v51, v32
    s_mov_b64 exec, s[70:71]
    ds_write_b32 v51, v19 offset:0
    s_mov_b64 exec, -1
    v_cmp_gt_u32 vcc, 31, v57
    v_min_u32 v57, 31, v57
    v_mul_u32_u24 v32, 43, v57
    v_cndmask_b32 v20, v59, v20, vcc
    v_lshrrev_b32 v32, 7, v32
    v_cmp_gt_u32 vcc, 24, v57
    v_add_lshl_u32 v32, v32, v57, 2
    v_lshl_add_u32 v33, v57, 4, s53
    v_cndmask_b32 v32, v33, v32, vcc
    v_add_u32 v52, v52, v32
    s_mov_b64 exec, s[72:73]
    ds_write_b32 v52, v20 offset:0
    s_mov_b64 exec, -1
    s_waitcnt lgkmcnt(0)
    s_barrier
    ds_read_b128 v[16:19], v61 offset:0
    ds_read_b32 v67, v67
    s_waitcnt lgkmcnt(1)
    v_mov_b32 v19, s48
    buffer_store_dwordx4 v[16:19], v64, s[32:35], 0 offen sc1
    s_waitcnt lgkmcnt(0)
    v_cmp_lt_u32 vcc, 23, v67
    s_cbranch_vccz L_noup
    ds_read_b128 v[28:31], v61 offset:8192
    s_waitcnt lgkmcnt(0)
    v_mov_b32 v31, s48
    s_mov_b64 exec, vcc
    buffer_store_dwordx4 v[28:31], v65, s[32:35], 0 offen sc1
    s_mov_b64 exec, -1
L_noup:
    s_cmp_ge_u32 s3, 2
    s_cbranch_scc1 L_nowf
    s_lshl1_add_u32 s44, s55, s3
    s_and_b32 s53, s44, 15
    s_lshl_b32 s53, s53, 13
    s_lshr_b32 s76, s44, 4
    s_lshl_b32 s76, s76, 6
    s_add_u32 s53, s53, s76
    v_lshrrev_b32 v60, 5, v1
    v_lshlrev_b32 v60, 12, v60
    v_and_b32 v61, 31, v1
    v_lshl_add_u32 v60, v61, 1, v60
    v_add_u32 v60, s53, v60
    buffer_load_ushort v32, v60, s[88:91], 0 offen offset:0
    buffer_load_ushort v33, v60, s[88:91], 0 offen offset:512
    buffer_load_ushort v34, v60, s[88:91], 0 offen offset:1024
    buffer_load_ushort v35, v60, s[88:91], 0 offen offset:1536
    buffer_load_ushort v36, v60, s[88:91], 0 offen offset:2048
    buffer_load_ushort v37, v60, s[88:91], 0 offen offset:2560
    buffer_load_ushort v38, v60, s[88:91], 0 offen offset:3072
    buffer_load_ushort v39, v60, s[88:91], 0 offen offset:3584
L_nowf:
    v_lshrrev_b32 v60, 5, v1
    v_bfe_u32 v61, v1, 2, 2
    v_bfe_u32 v62, v1, 4, 1
    v_and_b32 v63, 3, v1
    v_lshlrev_b32 v77, 12, v62
    v_lshl_add_u32 v77, v61, 9, v77
    v_lshl_add_u32 v77, v60, 5, v77
    v_lshl_add_u32 v77, v63, 3, v77
    s_mul_i32 s53, s2, 8320
    s_add_u32 s53, s53, 8388608
    v_lshl_add_u32 v70, v0, 4, s53
    s_lshl_b32 s53, s2, 13
    s_add_u32 s53, s53, 16777216
    v_lshl_add_u32 v71, v0, 4, s53
    v_mul_u32_u24 v73, 2500, v68
    v_mov_b64 v[80:81], 0
    v_mov_b64 v[82:83], 0
    v_mov_b64 v[84:85], 0
    v_mov_b64 v[86:87], 0
    v_mov_b64 v[88:89], 0
    v_mov_b64 v[90:91], 0
    v_mov_b64 v[92:93], 0
    v_mov_b64 v[94:95], 0
    v_mov_b64 v[96:97], 0
    v_mov_b64 v[98:99], 0
    v_mov_b64 v[100:101], 0
    v_mov_b64 v[102:103], 0
    v_mov_b64 v[104:105], 0
    v_mov_b64 v[106:107], 0
    v_mov_b64 v[108:109], 0
    v_mov_b64 v[110:111], 0
    v_mov_b64 v[112:113], 0
    v_mov_b64 v[114:115], 0
    v_mov_b64 v[116:117], 0
    v_mov_b64 v[118:119], 0
    v_mov_b64 v[120:121], 0
    v_mov_b64 v[122:123], 0
    v_mov_b64 v[124:125], 0
    v_mov_b64 v[126:127], 0
    v_mov_b64 v[128:129], 0
    v_mov_b64 v[130:131], 0
    v_mov_b64 v[132:133], 0
    v_mov_b64 v[134:135], 0
    v_mov_b64 v[136:137], 0
    v_mov_b64 v[138:139], 0
    v_mov_b64 v[140:141], 0
    v_mov_b64 v[142:143], 0
    v_mov_b64 v[144:145], 0
    v_mov_b64 v[146:147], 0
    v_mov_b64 v[148:149], 0
    v_mov_b64 v[150:151], 0
    v_mov_b64 v[152:153], 0
    v_mov_b64 v[154:155], 0
    s_mov_b64 s[6:7], -1
    s_mov_b32 s55, 0
    s_waitcnt vmcnt(0)
L_poll:
    s_mov_b64 exec, s[6:7]
    buffer_load_dwordx4 v[48:51], v70, s[32:35], 0 offen sc1
    s_mov_b64 exec, -1
    s_waitcnt vmcnt(0)
    v_cmp_ne_u32 s[6:7], s48, v51
    s_cmp_eq_u64 s[6:7], 0
    s_cbranch_scc1 L_got
    s_sleep 4
    s_add_u32 s55, s55, 1
    s_cmp_lt_u32 s55, 0x400000
    s_cbranch_scc1 L_poll
L_got:
    v_cmp_gt_u32 s[36:37], -2, v48
    v_cmp_gt_u32 s[38:39], -2, v49
    v_cmp_gt_u32 s[40:41], -2, v50
    v_mov_b32 v52, -1
    s_mov_b64 s[42:43], 0
    s_mov_b32 s53, 0x80808080
    s_and_b32 s6, s40, s53
    s_and_b32 s7, s41, s53
    s_cmp_eq_u64 s[6:7], 0
    s_cbranch_scc1 L_noext
    s_lshr_b64 s[6:7], s[6:7], 7
    s_mul_i32 s6, s6, 255
    s_mul_i32 s7, s7, 255
    v_mov_b32 v55, s48
L_poll2:
    s_mov_b64 exec, s[6:7]
    buffer_load_dwordx4 v[52:55], v71, s[32:35], 0 offen sc1
    s_mov_b64 exec, -1
    s_waitcnt vmcnt(0)
    v_cmp_ne_u32 vcc, s48, v55
    s_cbranch_vccz L_got2
    s_sleep 1
    s_add_u32 s55, s55, 1
    s_cmp_lt_u32 s55, 0x400000
    s_cbranch_scc1 L_poll2
L_got2:
    v_cmp_gt_u32 s[42:43], -2, v52
L_noext:
    v_cmp_eq_u32 vcc, -2, v52
    s_bcnt1_i32_b64 s64, s[36:37]
    s_bcnt1_i32_b64 s65, s[38:39]
    s_bcnt1_i32_b64 s66, s[40:41]
    s_bcnt1_i32_b64 s67, s[42:43]
    s_add_u32 s65, s65, s64
    s_add_u32 s66, s66, s65
    s_add_u32 s79, s67, s66
    v_mov_b32 v61, s79
    v_mov_b32 v60, 114912
    s_mov_b64 exec, 1
    ds_add_rtn_u32 v61, v60, v61
    s_mov_b64 exec, -1
    v_mbcnt_lo_u32_b32 v62, s36, 0
    v_mbcnt_hi_u32_b32 v62, s37, v62
    v_lshrrev_b32 v20, 20, v48
    v_add_u32 v20, v20, v73
    v_lshl_add_u32 v66, v62, 2, s49
    s_mov_b64 exec, s[36:37]
    ds_write_b32 v66, v20
    s_mov_b64 exec, -1
    v_lshlrev_b32 v24, 2, v48
    v_and_b32 v24, s82, v24
    v_and_b32 v16, 63, v48
    v_mbcnt_lo_u32_b32 v63, s38, 0
    v_mbcnt_hi_u32_b32 v63, s39, v63
    v_add_u32 v63, s64, v63
    v_lshrrev_b32 v21, 20, v49
    v_add_u32 v21, v21, v73
    v_lshl_add_u32 v66, v63, 2, s49
    s_mov_b64 exec, s[38:39]
    ds_write_b32 v66, v21
    s_mov_b64 exec, -1
    v_lshlrev_b32 v25, 2, v49
    v_and_b32 v25, s82, v25
    v_and_b32 v17, 63, v49
    v_mbcnt_lo_u32_b32 v64, s40, 0
    v_mbcnt_hi_u32_b32 v64, s41, v64
    v_add_u32 v64, s65, v64
    v_lshrrev_b32 v22, 20, v50
    v_add_u32 v22, v22, v73
    v_lshl_add_u32 v66, v64, 2, s49
    s_mov_b64 exec, s[40:41]
    ds_write_b32 v66, v22
    s_mov_b64 exec, -1
    v_lshlrev_b32 v26, 2, v50
    v_and_b32 v26, s82, v26
    v_and_b32 v18, 63, v50
    v_mbcnt_lo_u32_b32 v65, s42, 0
    v_mbcnt_hi_u32_b32 v65, s43, v65
    v_add_u32 v65, s66, v65
    v_lshrrev_b32 v23, 20, v52
    v_add_u32 v23, v23, v73
    v_lshl_add_u32 v66, v65, 2, s49
    s_mov_b64 exec, s[42:43]
    ds_write_b32 v66, v23
    s_mov_b64 exec, -1
    v_lshlrev_b32 v27, 2, v52
    v_and_b32 v27, s82, v27
    v_and_b32 v19, 63, v52
    v_lshl_or_b32 v14, v45, 16, v44
    v_lshl_or_b32 v15, v47, 16, v46
    v_mov_b64 v[156:157], 0
    v_mov_b64 v[158:159], 0
    s_cmp_ge_u32 s3, 2
    s_cbranch_scc1 L_1
    v_lshl_or_b32 v56, v33, 16, v32
    v_lshl_or_b32 v57, v35, 16, v34
    v_lshl_or_b32 v58, v37, 16, v36
    v_lshl_or_b32 v59, v39, 16, v38
    s_lshl_b32 s53, s54, 1
    s_add_u32 s53, s53, s44
    s_lshl2_add_u32 s83, s53, 4096
    s_lshl_b32 s53, s53, 10
    s_add_u32 s53, s53, 1048576
    v_lshl_add_u32 v60, v1, 4, s53
    buffer_store_dwordx4 v[56:59], v60, s[32:35], 0 offen sc1
L_1:
    s_mov_b32 s80, 79
    s_waitcnt lgkmcnt(0)
    v_readfirstlane_b32 s44, v61
    s_cbranch_vccnz L_defer
    s_add_u32 s53, s44, s79
    s_cmp_gt_u32 s53, 1024
    s_cbranch_scc1 L_defer
    v_add_u32 v62, s44, v62
    v_lshl_or_b32 v24, v62, 22, v24
    v_add_u32 v63, s44, v63
    v_lshl_or_b32 v25, v63, 22, v25
    v_add_u32 v64, s44, v64
    v_lshl_or_b32 v26, v64, 22, v26
    v_add_u32 v65, s44, v65
    v_lshl_or_b32 v27, v65, 22, v27
    s_branch L_have
L_defer:
    s_mov_b32 s80, 0
    s_mov_b32 s79, 0
    s_mov_b32 s44, 0
    s_mov_b64 s[36:37], 0
    s_mov_b64 s[38:39], 0
    s_mov_b64 s[40:41], 0
    s_mov_b64 s[42:43], 0
    v_mov_b32 v58, 1
    v_mov_b32 v59, 110864
    ds_write_b32 v59, v58
    s_branch L_have
L_scan:
    s_barrier
    s_mov_b32 s64, s63
    s_add_u32 s65, s63, 1024
    s_xor_b32 s47, s2, 1
L_sloop:
    s_cmp_ge_u32 s80, 79
    s_cbranch_scc1 L_scan_done
    s_mul_i32 s53, s3, 20000
    s_lshl_b32 s54, s80, 8
    s_add_u32 s55, s53, s54
    v_lshlrev_b32 v56, 2, v1
    v_add_u32 v56, s55, v56
    v_lshlrev_b32 v57, 2, v56
    buffer_load_dwordx4 v[60:63], v57, s[16:19], 0 offen
    s_waitcnt vmcnt(0)
    s_cmp_lg_u32 s80, 78
    s_cbranch_scc1 L_snotlast
    s_mov_b32 exec_lo, 0xffffff00
    v_mov_b32 v60, s47
    v_mov_b32 v61, s47
    v_mov_b32 v62, s47
    v_mov_b32 v63, s47
    s_mov_b64 exec, -1
L_snotlast:
    s_cmp_gt_u32 s52, 0
    s_cbranch_scc1 L_2
    v_cmp_eq_u32_sdwa vcc, v60, s2 src0_sel:BYTE_0 src1_sel:DWORD
    s_cbranch_vccz L_2
    s_bcnt1_i32_b64 s53, vcc
    s_lshl3_add_u32 s54, s53, s64
    s_mov_b32 s52, 0
    s_cmp_gt_u32 s54, s65
    s_cbranch_scc1 L_ovf
    v_mbcnt_lo_u32_b32 v58, vcc_lo, 0
    v_mbcnt_hi_u32_b32 v58, vcc_hi, v58
    v_lshl_add_u32 v58, v58, 3, s64
    v_add_u32 v59, 0, v56
    s_mov_b64 exec, vcc
    ds_write2_b32 v58, v60, v59 offset0:0 offset1:1
    s_mov_b64 exec, -1
    s_mov_b32 s64, s54
L_2:
    s_cmp_gt_u32 s52, 1
    s_cbranch_scc1 L_3
    v_cmp_eq_u32_sdwa vcc, v61, s2 src0_sel:BYTE_0 src1_sel:DWORD
    s_cbranch_vccz L_3
    s_bcnt1_i32_b64 s53, vcc
    s_lshl3_add_u32 s54, s53, s64
    s_mov_b32 s52, 1
    s_cmp_gt_u32 s54, s65
    s_cbranch_scc1 L_ovf
    v_mbcnt_lo_u32_b32 v58, vcc_lo, 0
    v_mbcnt_hi_u32_b32 v58, vcc_hi, v58
    v_lshl_add_u32 v58, v58, 3, s64
    v_add_u32 v59, 1, v56
    s_mov_b64 exec, vcc
    ds_write2_b32 v58, v61, v59 offset0:0 offset1:1
    s_mov_b64 exec, -1
    s_mov_b32 s64, s54
L_3:
    s_cmp_gt_u32 s52, 2
    s_cbranch_scc1 L_4
    v_cmp_eq_u32_sdwa vcc, v62, s2 src0_sel:BYTE_0 src1_sel:DWORD
    s_cbranch_vccz L_4
    s_bcnt1_i32_b64 s53, vcc
    s_lshl3_add_u32 s54, s53, s64
    s_mov_b32 s52, 2
    s_cmp_gt_u32 s54, s65
    s_cbranch_scc1 L_ovf
    v_mbcnt_lo_u32_b32 v58, vcc_lo, 0
    v_mbcnt_hi_u32_b32 v58, vcc_hi, v58
    v_lshl_add_u32 v58, v58, 3, s64
    v_add_u32 v59, 2, v56
    s_mov_b64 exec, vcc
    ds_write2_b32 v58, v62, v59 offset0:0 offset1:1
    s_mov_b64 exec, -1
    s_mov_b32 s64, s54
L_4:
    s_cmp_gt_u32 s52, 3
    s_cbranch_scc1 L_5
    v_cmp_eq_u32_sdwa vcc, v63, s2 src0_sel:BYTE_0 src1_sel:DWORD
    s_cbranch_vccz L_5
    s_bcnt1_i32_b64 s53, vcc
    s_lshl3_add_u32 s54, s53, s64
    s_mov_b32 s52, 3
    s_cmp_gt_u32 s54, s65
    s_cbranch_scc1 L_ovf
    v_mbcnt_lo_u32_b32 v58, vcc_lo, 0
    v_mbcnt_hi_u32_b32 v58, vcc_hi, v58
    v_lshl_add_u32 v58, v58, 3, s64
    v_add_u32 v59, 3, v56
    s_mov_b64 exec, vcc
    ds_write2_b32 v58, v63, v59 offset0:0 offset1:1
    s_mov_b64 exec, -1
    s_mov_b32 s64, s54
L_5:
    s_mov_b32 s52, 0
    s_add_u32 s80, s80, 1
    s_branch L_sloop
L_ovf:
    v_mov_b32 v58, 1
    v_mov_b32 v59, 110864
    ds_write_b32 v59, v58
L_scan_done:
    s_sub_u32 s79, s64, s63
    s_lshr_b32 s79, s79, 3
    s_lshl_b32 s44, s3, 7
    v_lshlrev_b32 v58, 3, v1
    v_add_u32 v58, s63, v58
    s_waitcnt lgkmcnt(0)
    ds_read_b32 v16, v58 offset:0
    ds_read_b32 v20, v58 offset:4
    s_sub_u32 s53, s79, 0
    v_cmp_gt_i32 s[36:37], s53, v1
    ds_read_b32 v17, v58 offset:512
    ds_read_b32 v21, v58 offset:516
    s_sub_u32 s53, s79, 64
    v_cmp_gt_i32 s[38:39], s53, v1
    s_mov_b64 s[40:41], 0
    v_mov_b32 v18, 0
    v_mov_b32 v26, 0
    s_mov_b64 s[42:43], 0
    v_mov_b32 v19, 0
    v_mov_b32 v27, 0
    v_lshl_add_u32 v58, v1, 2, s49
    v_add_u32 v59, s44, v1
    v_lshlrev_b32 v59, 22, v59
    s_waitcnt lgkmcnt(0)
    v_lshlrev_b32 v28, 2, v20
    buffer_load_dword v24, v28, s[12:15], 0 offen
    v_bfe_u32 v16, v16, 8, 6
    v_min_u32 v16, 47, v16
    ds_write_b32 v58, v20 offset:0
    v_lshlrev_b32 v29, 2, v21
    buffer_load_dword v25, v29, s[12:15], 0 offen
    v_bfe_u32 v17, v17, 8, 6
    v_min_u32 v17, 47, v17
    ds_write_b32 v58, v21 offset:256
    s_waitcnt vmcnt(0)
    v_and_b32 v24, 0x3fff, v24
    v_lshl_or_b32 v24, v24, 8, v59
    v_add_u32 v59, 268435456, v59
    v_and_b32 v25, 0x3fff, v25
    v_lshl_or_b32 v25, v25, 8, v59
    v_add_u32 v59, 268435456, v59
L_have:
    v_mov_b32 v58, 1
    s_mov_b32 s53, 111136
    s_mov_b32 s54, 114976
    v_bfe_u32 v28, v24, 8, 14
    v_mul_u32_u24 v28, 6711, v28
    v_lshrrev_b32 v28, 22, v28
    v_min_u32 v28, 15, v28
    v_lshl_add_u32 v28, v28, 2, s53
    v_lshl_add_u32 v28, v16, 6, v28
    v_lshl_add_u32 v16, v16, 2, s54
    s_mov_b64 exec, s[36:37]
    ds_add_rtn_u32 v32, v28, v58
    ds_add_u32 v16, v58
    s_mov_b64 exec, -1
    v_bfe_u32 v29, v25, 8, 14
    v_mul_u32_u24 v29, 6711, v29
    v_lshrrev_b32 v29, 22, v29
    v_min_u32 v29, 15, v29
    v_lshl_add_u32 v29, v29, 2, s53
    v_lshl_add_u32 v29, v17, 6, v29
    v_lshl_add_u32 v17, v17, 2, s54
    s_mov_b64 exec, s[38:39]
    ds_add_rtn_u32 v33, v29, v58
    ds_add_u32 v17, v58
    s_mov_b64 exec, -1
    v_bfe_u32 v30, v26, 8, 14
    v_mul_u32_u24 v30, 6711, v30
    v_lshrrev_b32 v30, 22, v30
    v_min_u32 v30, 15, v30
    v_lshl_add_u32 v30, v30, 2, s53
    v_lshl_add_u32 v30, v18, 6, v30
    v_lshl_add_u32 v18, v18, 2, s54
    s_mov_b64 exec, s[40:41]
    ds_add_rtn_u32 v34, v30, v58
    ds_add_u32 v18, v58
    s_mov_b64 exec, -1
    v_bfe_u32 v31, v27, 8, 14
    v_mul_u32_u24 v31, 6711, v31
    v_lshrrev_b32 v31, 22, v31
    v_min_u32 v31, 15, v31
    v_lshl_add_u32 v31, v31, 2, s53
    v_lshl_add_u32 v31, v19, 6, v31
    v_lshl_add_u32 v19, v19, 2, s54
    s_mov_b64 exec, s[42:43]
    ds_add_rtn_u32 v35, v31, v58
    ds_add_u32 v19, v58
    s_mov_b64 exec, -1
    v_lshrrev_b32 v36, 1, v1
    v_lshl_add_u32 v39, v36, 2, s49
    ds_read_b32 v40, v39 offset:0
    ds_read_b32 v41, v39 offset:128
    ds_read_b32 v42, v39 offset:256
    ds_read_b32 v43, v39 offset:384
    v_and_b32 v38, 1, v1
    v_lshlrev_b32 v37, 4, v38
    v_lshlrev_b32 v38, 2, v38
    s_mov_b32 s46, s79
    s_mov_b32 s45, s44
    v_lshl_add_u32 v56, v1, 2, s54
    v_mov_b32 v57, 110864
    s_waitcnt lgkmcnt(0)
    s_cmp_le_i32 s46, 0
    s_cbranch_scc1 L_6
    v_lshl_add_u32 v44, v40, 5, v37
    v_lshl_add_u32 v45, v40, 3, v38
    v_cmp_gt_i32 vcc, s46, v36
    s_lshl_b32 s76, s45, 5
    s_add_u32 m0, s76, 65536
    s_mov_b64 exec, vcc
    buffer_load_dwordx4 v44, s[24:27], 0 offen lds
    s_lshl3_add_u32 m0, s45, 98304
    s_add_u32 s45, s45, 32
    buffer_load_dword v45, s[20:23], 0 offen lds
    s_mov_b64 exec, -1
    s_sub_i32 s46, s46, 32
L_6:
    s_barrier
    ds_read_b32 v56, v56
    ds_read_b32 v57, v57
    s_cmp_le_i32 s46, 0
    s_cbranch_scc1 L_7
    v_lshl_add_u32 v44, v41, 5, v37
    v_lshl_add_u32 v45, v41, 3, v38
    v_cmp_gt_i32 vcc, s46, v36
    s_lshl_b32 s76, s45, 5
    s_add_u32 m0, s76, 65536
    s_mov_b64 exec, vcc
    buffer_load_dwordx4 v44, s[24:27], 0 offen lds
    s_lshl3_add_u32 m0, s45, 98304
    s_add_u32 s45, s45, 32
    buffer_load_dword v45, s[20:23], 0 offen lds
    s_mov_b64 exec, -1
    s_sub_i32 s46, s46, 32
L_7:
    s_waitcnt lgkmcnt(0)
    v_readfirstlane_b32 s78, v57
    s_cmp_lg_u32 s77, 0
    s_cbranch_scc1 L_assigned
    ds_read_b64_tr_b16 a[0:1], v77 offset:32768
    ds_read_b64_tr_b16 a[2:3], v77 offset:34816
    ds_read_b64_tr_b16 a[4:5], v77 offset:32832
    ds_read_b64_tr_b16 a[6:7], v77 offset:34880
    ds_read_b64_tr_b16 a[8:9], v77 offset:32896
    ds_read_b64_tr_b16 a[10:11], v77 offset:34944
    ds_read_b64_tr_b16 a[12:13], v77 offset:32960
    ds_read_b64_tr_b16 a[14:15], v77 offset:35008
    ds_read_b64_tr_b16 a[16:17], v77 offset:33024
    ds_read_b64_tr_b16 a[18:19], v77 offset:35072
    ds_read_b64_tr_b16 a[20:21], v77 offset:33088
    ds_read_b64_tr_b16 a[22:23], v77 offset:35136
    ds_read_b64_tr_b16 a[24:25], v77 offset:33152
    ds_read_b64_tr_b16 a[26:27], v77 offset:35200
    ds_read_b64_tr_b16 a[28:29], v77 offset:33216
    ds_read_b64_tr_b16 a[30:31], v77 offset:35264
    s_and_b32 s53, s2, 63
    s_or_b32 s53, s53, s3
    s_cbranch_scc1 L_8
    s_lshl_b32 s53, s2, 1
    v_mov_b32 v60, s53
    v_mov_b32 v61, s48
    s_mov_b64 exec, 1
    buffer_store_dword v61, v60, s[32:35], 0 offen sc1
    s_mov_b64 exec, -1
L_8:
    v_sub_u32 v57, 63, v1
    v_lshl_add_u32 v57, v56, 6, v57
    v_mov_b32 v59, 0
    v_readlane_b32 s84, v57, 0
    v_readlane_b32 s85, v57, 1
    v_readlane_b32 s86, v57, 2
    v_readlane_b32 s87, v57, 3
    v_readlane_b32 s88, v57, 4
    v_readlane_b32 s89, v57, 5
    v_readlane_b32 s90, v57, 6
    v_readlane_b32 s91, v57, 7
    v_readlane_b32 s92, v57, 8
    v_readlane_b32 s93, v57, 9
    v_readlane_b32 s94, v57, 10
    v_readlane_b32 s95, v57, 11
    v_readlane_b32 s96, v57, 12
    v_readlane_b32 s97, v57, 13
    v_readlane_b32 s98, v57, 14
    v_readlane_b32 s99, v57, 15
    v_cmp_gt_u32 vcc, s84, v57
    v_cmp_gt_u32 s[4:5], s85, v57
    v_cmp_gt_u32 s[6:7], s86, v57
    v_addc_co_u32 v59, vcc, 0, v59, vcc
    v_addc_co_u32 v59, s[4:5], 0, v59, s[4:5]
    v_addc_co_u32 v59, s[6:7], 0, v59, s[6:7]
    v_cmp_gt_u32 vcc, s87, v57
    v_cmp_gt_u32 s[4:5], s88, v57
    v_cmp_gt_u32 s[6:7], s89, v57
    v_addc_co_u32 v59, vcc, 0, v59, vcc
    v_addc_co_u32 v59, s[4:5], 0, v59, s[4:5]
    v_addc_co_u32 v59, s[6:7], 0, v59, s[6:7]
    v_cmp_gt_u32 vcc, s90, v57
    v_cmp_gt_u32 s[4:5], s91, v57
    v_cmp_gt_u32 s[6:7], s92, v57
    v_addc_co_u32 v59, vcc, 0, v59, vcc
    v_addc_co_u32 v59, s[4:5], 0, v59, s[4:5]
    v_addc_co_u32 v59, s[6:7], 0, v59, s[6:7]
    v_cmp_gt_u32 vcc, s93, v57
    v_cmp_gt_u32 s[4:5], s94, v57
    v_cmp_gt_u32 s[6:7], s95, v57
    v_addc_co_u32 v59, vcc, 0, v59, vcc
    v_addc_co_u32 v59, s[4:5], 0, v59, s[4:5]
    v_addc_co_u32 v59, s[6:7], 0, v59, s[6:7]
    v_cmp_gt_u32 vcc, s96, v57
    v_cmp_gt_u32 s[4:5], s97, v57
    v_cmp_gt_u32 s[6:7], s98, v57
    v_addc_co_u32 v59, vcc, 0, v59, vcc
    v_addc_co_u32 v59, s[4:5], 0, v59, s[4:5]
    v_addc_co_u32 v59, s[6:7], 0, v59, s[6:7]
    v_cmp_gt_u32 vcc, s99, v57
    s_nop 1
    v_addc_co_u32 v59, vcc, 0, v59, vcc
    v_readlane_b32 s84, v57, 16
    v_readlane_b32 s85, v57, 17
    v_readlane_b32 s86, v57, 18
    v_readlane_b32 s87, v57, 19
    v_readlane_b32 s88, v57, 20
    v_readlane_b32 s89, v57, 21
    v_readlane_b32 s90, v57, 22
    v_readlane_b32 s91, v57, 23
    v_readlane_b32 s92, v57, 24
    v_readlane_b32 s93, v57, 25
    v_readlane_b32 s94, v57, 26
    v_readlane_b32 s95, v57, 27
    v_readlane_b32 s96, v57, 28
    v_readlane_b32 s97, v57, 29
    v_readlane_b32 s98, v57, 30
    v_readlane_b32 s99, v57, 31
    v_cmp_gt_u32 vcc, s84, v57
    v_cmp_gt_u32 s[4:5], s85, v57
    v_cmp_gt_u32 s[6:7], s86, v57
    v_addc_co_u32 v59, vcc, 0, v59, vcc
    v_addc_co_u32 v59, s[4:5], 0, v59, s[4:5]
    v_addc_co_u32 v59, s[6:7], 0, v59, s[6:7]
    v_cmp_gt_u32 vcc, s87, v57
    v_cmp_gt_u32 s[4:5], s88, v57
    v_cmp_gt_u32 s[6:7], s89, v57
    v_addc_co_u32 v59, vcc, 0, v59, vcc
    v_addc_co_u32 v59, s[4:5], 0, v59, s[4:5]
    v_addc_co_u32 v59, s[6:7], 0, v59, s[6:7]
    v_cmp_gt_u32 vcc, s90, v57
    v_cmp_gt_u32 s[4:5], s91, v57
    v_cmp_gt_u32 s[6:7], s92, v57
    v_addc_co_u32 v59, vcc, 0, v59, vcc
    v_addc_co_u32 v59, s[4:5], 0, v59, s[4:5]
    v_addc_co_u32 v59, s[6:7], 0, v59, s[6:7]
    v_cmp_gt_u32 vcc, s93, v57
    v_cmp_gt_u32 s[4:5], s94, v57
    v_cmp_gt_u32 s[6:7], s95, v57
    v_addc_co_u32 v59, vcc, 0, v59, vcc
    v_addc_co_u32 v59, s[4:5], 0, v59, s[4:5]
    v_addc_co_u32 v59, s[6:7], 0, v59, s[6:7]
    v_cmp_gt_u32 vcc, s96, v57
    v_cmp_gt_u32 s[4:5], s97, v57
    v_cmp_gt_u32 s[6:7], s98, v57
    v_addc_co_u32 v59, vcc, 0, v59, vcc
    v_addc_co_u32 v59, s[4:5], 0, v59, s[4:5]
    v_addc_co_u32 v59, s[6:7], 0, v59, s[6:7]
    v_cmp_gt_u32 vcc, s99, v57
    s_nop 1
    v_addc_co_u32 v59, vcc, 0, v59, vcc
    v_readlane_b32 s84, v57, 32
    v_readlane_b32 s85, v57, 33
    v_readlane_b32 s86, v57, 34
    v_readlane_b32 s87, v57, 35
    v_readlane_b32 s88, v57, 36
    v_readlane_b32 s89, v57, 37
    v_readlane_b32 s90, v57, 38
    v_readlane_b32 s91, v57, 39
    v_cmp_gt_u32 vcc, s84, v57
    v_cmp_gt_u32 s[4:5], s85, v57
    v_cmp_gt_u32 s[6:7], s86, v57
    v_addc_co_u32 v59, vcc, 0, v59, vcc
    v_addc_co_u32 v59, s[4:5], 0, v59, s[4:5]
    v_addc_co_u32 v59, s[6:7], 0, v59, s[6:7]
    v_cmp_gt_u32 vcc, s87, v57
    v_cmp_gt_u32 s[4:5], s88, v57
    v_cmp_gt_u32 s[6:7], s89, v57
    v_addc_co_u32 v59, vcc, 0, v59, vcc
    v_addc_co_u32 v59, s[4:5], 0, v59, s[4:5]
    v_addc_co_u32 v59, s[6:7], 0, v59, s[6:7]
    v_cmp_gt_u32 vcc, s90, v57
    v_cmp_gt_u32 s[4:5], s91, v57
    s_nop 0
    v_addc_co_u32 v59, vcc, 0, v59, vcc
    v_addc_co_u32 v59, s[4:5], 0, v59, s[4:5]
    v_bfe_u32 v60, v59, 3, 1
    v_mul_u32_u24 v60, 7, v60
    v_and_b32 v61, 7, v59
    v_xor_b32 v11, v60, v61
    s_sub_u32 s53, 7, s3
    s_add_u32 s54, s3, 0
    v_cmp_eq_u32 vcc, s54, v59
    s_ff1_i32_b64 s56, vcc
    s_add_u32 s54, s53, 8
    v_cmp_eq_u32 vcc, s54, v59
    s_ff1_i32_b64 s57, vcc
    s_add_u32 s54, s3, 16
    v_cmp_eq_u32 vcc, s54, v59
    s_ff1_i32_b64 s58, vcc
    s_add_u32 s54, s53, 24
    v_cmp_eq_u32 vcc, s54, v59
    s_ff1_i32_b64 s59, vcc
    s_add_u32 s54, s3, 32
    v_cmp_eq_u32 vcc, s54, v59
    s_ff1_i32_b64 s60, vcc
L_assigned:
    v_cmp_gt_u32 vcc, s3, v11
    v_and_b32 v61, 15, v1
    v_lshlrev_b32 v61, 2, v61
    v_cndmask_b32 v60, 0, v56, vcc
    v_add_u32 v61, 111136, v61
    s_lshl_b32 s84, s56, 6
    v_add_u32 v64, s84, v61
    ds_read_b32 v70, v64
    s_lshl_b32 s85, s57, 6
    v_add_u32 v65, s85, v61
    ds_read_b32 v71, v65
    s_lshl_b32 s86, s58, 6
    v_add_u32 v66, s86, v61
    ds_read_b32 v72, v66
    s_lshl_b32 s87, s59, 6
    v_add_u32 v67, s87, v61
    ds_read_b32 v73, v67
    s_lshl_b32 s88, s60, 6
    v_add_u32 v68, s88, v61
    ds_read_b32 v74, v68
    v_add_u32_dpp v60, v60, v60 row_shr:1 row_mask:0xf bank_mask:0xf bound_ctrl:1
    v_readlane_b32 s92, v56, s56
    s_nop 0
    v_add_u32_dpp v60, v60, v60 row_shr:2 row_mask:0xf bank_mask:0xf bound_ctrl:1
    v_readlane_b32 s93, v56, s57
    s_nop 0
    v_add_u32_dpp v60, v60, v60 row_shr:4 row_mask:0xf bank_mask:0xf bound_ctrl:1
    v_readlane_b32 s94, v56, s58
    s_nop 0
    v_add_u32_dpp v60, v60, v60 row_shr:8 row_mask:0xf bank_mask:0xf bound_ctrl:1
    v_readlane_b32 s95, v56, s59
    s_nop 0
    v_readlane_b32 s96, v56, s60
    v_readlane_b32 s61, v60, 15
    v_readlane_b32 s53, v60, 31
    v_readlane_b32 s54, v60, 47
    s_add_u32 s62, s92, s93
    s_add_u32 s62, s62, s94
    s_add_u32 s62, s62, s95
    s_add_u32 s62, s62, s96
    s_add_u32 s61, s61, s53
    s_add_u32 s61, s61, s54
    s_add_u32 s61, s61, 3
    s_andn2_b32 s61, s61, 3
    s_lshl2_add_u32 s61, s3, s61
    s_waitcnt lgkmcnt(0)
    v_add3_u32 v60, v70, v71, v72
    v_add3_u32 v60, v60, v73, v74
    v_mov_b32 v61, v60
    s_nop 1
    v_add_u32_dpp v61, v61, v61 row_shr:1 row_mask:0xf bank_mask:0xf bound_ctrl:1
    s_nop 1
    v_add_u32_dpp v61, v61, v61 row_shr:2 row_mask:0xf bank_mask:0xf bound_ctrl:1
    s_nop 1
    v_add_u32_dpp v61, v61, v61 row_shr:4 row_mask:0xf bank_mask:0xf bound_ctrl:1
    s_nop 1
    v_add_u32_dpp v61, v61, v61 row_shr:8 row_mask:0xf bank_mask:0xf bound_ctrl:1
    v_sub_u32 v61, v61, v60
    v_add_u32 v61, s61, v61
    v_lshl_add_u32 v75, v61, 8, 0
    ds_write_b32 v64, v75 offset:4096
    v_add_u32 v61, v61, v70
    v_lshl_add_u32 v76, v61, 8, 16
    ds_write_b32 v65, v76 offset:4096
    v_add_u32 v61, v61, v71
    v_lshl_add_u32 v77, v61, 8, 32
    ds_write_b32 v66, v77 offset:4096
    v_add_u32 v61, v61, v72
    v_lshl_add_u32 v78, v61, 8, 48
    ds_write_b32 v67, v78 offset:4096
    v_add_u32 v61, v61, v73
    v_lshl_add_u32 v79, v61, 8, 64
    ds_write_b32 v68, v79 offset:4096
    s_cmp_le_i32 s46, 0
    s_cbranch_scc1 L_9
    v_lshl_add_u32 v44, v42, 5, v37
    v_lshl_add_u32 v45, v42, 3, v38
    v_cmp_gt_i32 vcc, s46, v36
    s_lshl_b32 s76, s45, 5
    s_add_u32 m0, s76, 65536
    s_mov_b64 exec, vcc
    buffer_load_dwordx4 v44, s[24:27], 0 offen lds
    s_lshl3_add_u32 m0, s45, 98304
    s_add_u32 s45, s45, 32
    buffer_load_dword v45, s[20:23], 0 offen lds
    s_mov_b64 exec, -1
    s_sub_i32 s46, s46, 32
L_9:
    s_waitcnt lgkmcnt(0)
    s_barrier
    ds_read_b32 v16, v28 offset:4096
    ds_read_b32 v17, v29 offset:4096
    ds_read_b32 v18, v30 offset:4096
    ds_read_b32 v19, v31 offset:4096
    v_mov_b32 v60, 0
    v_mov_b32 v61, 0
    v_lshlrev_b32 v64, 3, v0
    v_add_u32 v64, 111136, v64
    ds_write_b64 v64, v[60:61]
    v_mov_b32 v64, 110864
    ds_write_b32 v64, v60
    s_mov_b32 s53, 106496
    s_movk_i32 s54, 255
    s_waitcnt lgkmcnt(2)
    v_lshrrev_b32 v28, 8, v16
    v_add_u32 v28, v28, v32
    v_and_or_b32 v16, v16, s54, v24
    v_lshl_add_u32 v28, v28, 2, s53
    s_mov_b64 exec, s[36:37]
    ds_write_b32 v28, v16
    s_mov_b64 exec, -1
    v_lshrrev_b32 v29, 8, v17
    v_add_u32 v29, v29, v33
    v_and_or_b32 v17, v17, s54, v25
    v_lshl_add_u32 v29, v29, 2, s53
    s_mov_b64 exec, s[38:39]
    ds_write_b32 v29, v17
    s_mov_b64 exec, -1
    v_lshrrev_b32 v30, 8, v18
    v_add_u32 v30, v30, v34
    v_and_or_b32 v18, v18, s54, v26
    v_lshl_add_u32 v30, v30, 2, s53
    s_mov_b64 exec, s[40:41]
    ds_write_b32 v30, v18
    s_mov_b64 exec, -1
    v_lshrrev_b32 v31, 8, v19
    v_add_u32 v31, v31, v35
    v_and_or_b32 v19, v19, s54, v27
    v_lshl_add_u32 v31, v31, 2, s53
    s_mov_b64 exec, s[42:43]
    ds_write_b32 v31, v19
    s_mov_b64 exec, -1
    s_cmp_le_i32 s46, 0
    s_cbranch_scc1 L_10
    v_lshl_add_u32 v44, v43, 5, v37
    v_lshl_add_u32 v45, v43, 3, v38
    v_cmp_gt_i32 vcc, s46, v36
    s_lshl_b32 s76, s45, 5
    s_add_u32 m0, s76, 65536
    s_mov_b64 exec, vcc
    buffer_load_dwordx4 v44, s[24:27], 0 offen lds
    s_lshl3_add_u32 m0, s45, 98304
    s_add_u32 s45, s45, 32
    buffer_load_dword v45, s[20:23], 0 offen lds
    s_mov_b64 exec, -1
    s_sub_i32 s46, s46, 32
L_10:
L_paymore:
    s_cmp_le_i32 s46, 0
    s_cbranch_scc1 L_paydone
    ds_read_b32 v40, v39 offset:512
    v_add_u32 v39, 128, v39
    s_waitcnt lgkmcnt(0)
    s_cmp_le_i32 s46, 0
    s_cbranch_scc1 L_11
    v_lshl_add_u32 v44, v40, 5, v37
    v_lshl_add_u32 v45, v40, 3, v38
    v_cmp_gt_i32 vcc, s46, v36
    s_lshl_b32 s76, s45, 5
    s_add_u32 m0, s76, 65536
    s_mov_b64 exec, vcc
    buffer_load_dwordx4 v44, s[24:27], 0 offen lds
    s_lshl3_add_u32 m0, s45, 98304
    s_add_u32 s45, s45, 32
    buffer_load_dword v45, s[20:23], 0 offen lds
    s_mov_b64 exec, -1
    s_sub_i32 s46, s46, 32
L_11:
    s_branch L_paymore
L_paydone:
    s_lshl_b32 s61, s61, 2
    s_add_u32 s61, s61, 106496
    s_and_b32 s54, s2, 192
    s_lshl_b32 s54, s54, 1
    s_lshl4_add_u32 s54, s3, s54
    s_lshl2_add_u32 s53, s54, 4096
    v_and_b32 v66, 15, v1
    v_lshl_add_u32 v66, v66, 2, s53
    s_lshl_b32 s53, s54, 10
    s_add_u32 s53, s53, 1048576
    v_lshl_add_u32 v67, v1, 4, s53
    s_xor_b32 s53, s48, 1
    v_mov_b32 v79, s53
    v_mov_b32 v13, s61
    v_and_b32 v62, 3, v1
    v_lshl_add_u32 v77, v62, 2, s61
    v_bfe_u32 v62, v1, 2, 2
    v_lshl_add_u32 v78, v62, 2, s61
    v_bfe_u32 v63, v1, 4, 1
    v_lshlrev_b32 v63, 4, v63
    v_add_u32 v63, 65536, v63
    v_mov_b32 v65, 98304
    v_mov_b32 v62, 110848
    v_cmp_ne_u32 vcc, 0, v7
    v_cmp_ne_u32 s[4:5], 0, v8
    v_cmp_ne_u32 s[6:7], 0, v10
    v_cndmask_b32 v74, v62, v63, vcc
    v_cndmask_b32 v75, v62, v63, s[4:5]
    v_cndmask_b32 v76, v62, v65, s[6:7]
    s_waitcnt lgkmcnt(0)
    s_barrier
    ds_read_b128 v[68:71], v13
    ds_read_b32 v72, v77
    ds_read_b32 v73, v78
    s_cmp_lt_u32 s62, 3
    s_cbranch_scc1 L_short
    s_waitcnt lgkmcnt(2)
    v_readfirstlane_b32 s64, v68
    v_readfirstlane_b32 s65, v69
    v_readfirstlane_b32 s66, v70
    v_readfirstlane_b32 s67, v71
    s_and_b32 s76, s64, s82
    s_add_u32 m0, s63, 0
    s_lshl_b32 s76, s76, 3
    buffer_load_dwordx4 v2, s[8:11], s76 offen lds
    buffer_load_dwordx4 v3, s[8:11], s76 offen offset:1024 lds
    s_and_b32 s76, s65, s82
    s_add_u32 m0, s63, 2048
    s_lshl_b32 s76, s76, 3
    buffer_load_dwordx4 v2, s[8:11], s76 offen lds
    buffer_load_dwordx4 v3, s[8:11], s76 offen offset:1024 lds
    s_and_b32 s76, s66, s82
    s_add_u32 m0, s63, 4096
    s_lshl_b32 s76, s76, 3
    buffer_load_dwordx4 v2, s[8:11], s76 offen lds
    buffer_load_dwordx4 v3, s[8:11], s76 offen offset:1024 lds
    s_waitcnt vmcnt(6)
    s_branch L_go
L_short:
    s_waitcnt vmcnt(0) lgkmcnt(0)
    v_readfirstlane_b32 s64, v68
    v_readfirstlane_b32 s65, v69
    v_readfirstlane_b32 s66, v70
    v_readfirstlane_b32 s67, v71
    s_cmp_le_u32 s62, 0
    s_cbranch_scc1 L_go
    s_and_b32 s76, s64, s82
    s_add_u32 m0, s63, 0
    s_lshl_b32 s76, s76, 3
    buffer_load_dwordx4 v2, s[8:11], s76 offen lds
    buffer_load_dwordx4 v3, s[8:11], s76 offen offset:1024 lds
    s_cmp_le_u32 s62, 1
    s_cbranch_scc1 L_go
    s_and_b32 s76, s65, s82
    s_add_u32 m0, s63, 2048
    s_lshl_b32 s76, s76, 3
    buffer_load_dwordx4 v2, s[8:11], s76 offen lds
    buffer_load_dwordx4 v3, s[8:11], s76 offen offset:1024 lds
L_go:
    s_cmp_ge_u32 s3, 2
    s_cbranch_scc1 L_12
    s_cmp_lg_u32 s77, 0
    s_cbranch_scc1 L_12
    v_mov_b32 v62, s83
    v_mov_b32 v63, s48
    s_mov_b64 exec, 1
    buffer_store_dword v63, v62, s[32:35], 0 offen sc1
    s_mov_b64 exec, -1
L_12:
    s_waitcnt lgkmcnt(0)
    v_lshrrev_b32 v72, 22, v72
    v_lshrrev_b32 v73, 22, v73
    v_mad_u32_u24 v5, v72, v7, v74
    v_mad_u32_u24 v6, v72, v8, v75
    v_mad_u32_u24 v9, v73, v10, v76
    s_barrier
    s_cmp_eq_u32 s62, 0
    s_cbranch_scc1 L_round_done
L_group:
    s_cmp_le_u32 s62, s81
    s_cbranch_scc1 L_wstep
L_wback:
    ds_read_b64 v[64:65], v9
    ds_read_b128 v[56:59], v5
    ds_read_b128 v[60:63], v6
    ds_read_b128 v[68:71], v13 offset:16
    ds_read_b32 v72, v77 offset:16
    ds_read_b32 v73, v78 offset:16
    v_add_u32 v13, 16, v13
    v_add_u32 v77, 16, v77
    v_add_u32 v78, 16, v78
    s_waitcnt lgkmcnt(0)
    v_mfma_f32_16x16x16_bf16 v[32:35], v[14:15], v[64:65], 0
    v_mfma_f32_16x16x32_bf16 v[16:19], v[56:59], a[0:3], 0
    v_mfma_f32_16x16x32_bf16 v[20:23], v[56:59], a[8:11], 0
    v_mfma_f32_16x16x32_bf16 v[24:27], v[56:59], a[16:19], 0
    v_mfma_f32_16x16x32_bf16 v[28:31], v[56:59], a[24:27], 0
    v_mfma_f32_16x16x32_bf16 v[16:19], v[60:63], a[4:7], v[16:19]
    v_mfma_f32_16x16x32_bf16 v[20:23], v[60:63], a[12:15], v[20:23]
    v_mfma_f32_16x16x32_bf16 v[24:27], v[60:63], a[20:23], v[24:27]
    v_mfma_f32_16x16x32_bf16 v[28:31], v[60:63], a[28:31], v[28:31]
    v_readfirstlane_b32 s68, v68
    v_readfirstlane_b32 s69, v69
    v_readfirstlane_b32 s70, v70
    v_readfirstlane_b32 s71, v71
    v_cvt_pk_bf16_f32 v64, v32, v33
    v_cvt_pk_bf16_f32 v65, v34, v35
    v_lshrrev_b32 v72, 22, v72
    v_lshrrev_b32 v73, 22, v73
    v_mad_u32_u24 v5, v72, v7, v74
    v_mad_u32_u24 v6, v72, v8, v75
    v_mad_u32_u24 v9, v73, v10, v76
    s_cmp_ge_u32 s62, 3
    s_cbranch_scc1 L_13
    s_waitcnt vmcnt(0)
L_13:
    s_waitcnt vmcnt(4)
    ds_read_b64_tr_b16 v[48:49], v4 offset:0
    ds_read_b64_tr_b16 v[50:51], v4 offset:256
    ds_read_b64_tr_b16 v[52:53], v4 offset:512
    ds_read_b64_tr_b16 v[54:55], v4 offset:768
    s_cmp_le_u32 s62, 3
    s_cbranch_scc1 L_14
    s_and_b32 s76, s67, s82
    s_add_u32 m0, s63, 6144
    s_lshl_b32 s76, s76, 3
    buffer_load_dwordx4 v2, s[8:11], s76 offen lds
    buffer_load_dwordx4 v3, s[8:11], s76 offen offset:1024 lds
L_14:
    s_waitcnt lgkmcnt(0)
    v_mfma_f32_4x4x4_16b_bf16 v[32:35], v[64:65], v[48:49], 0 cbsz:4 abid:0
    v_mfma_f32_4x4x4_16b_bf16 v[36:39], v[64:65], v[50:51], 0 cbsz:4 abid:0
    v_mfma_f32_4x4x4_16b_bf16 v[40:43], v[64:65], v[52:53], 0 cbsz:4 abid:0
    v_mfma_f32_4x4x4_16b_bf16 v[44:47], v[64:65], v[54:55], 0 cbsz:4 abid:0
    s_nop 0
    s_set_gpr_idx_on s64, gpr_idx(SRC2,DST)
    v_pk_fma_f32 v[80:81], v[32:33], v[16:17], v[80:81] op_sel:[0,0,0] op_sel_hi:[1,0,1]
    v_pk_fma_f32 v[82:83], v[34:35], v[16:17], v[82:83] op_sel:[0,0,0] op_sel_hi:[1,0,1]
    v_pk_fma_f32 v[84:85], v[36:37], v[20:21], v[84:85] op_sel:[0,0,0] op_sel_hi:[1,0,1]
    v_pk_fma_f32 v[86:87], v[38:39], v[20:21], v[86:87] op_sel:[0,0,0] op_sel_hi:[1,0,1]
    v_pk_fma_f32 v[88:89], v[40:41], v[24:25], v[88:89] op_sel:[0,0,0] op_sel_hi:[1,0,1]
    v_pk_fma_f32 v[90:91], v[42:43], v[24:25], v[90:91] op_sel:[0,0,0] op_sel_hi:[1,0,1]
    v_pk_fma_f32 v[92:93], v[44:45], v[28:29], v[92:93] op_sel:[0,0,0] op_sel_hi:[1,0,1]
    v_pk_fma_f32 v[94:95], v[46:47], v[28:29], v[94:95] op_sel:[0,0,0] op_sel_hi:[1,0,1]
    s_set_gpr_idx_off
    s_mov_b32 s64, s68
    s_sub_u32 s62, s62, 1
    s_cmp_eq_u32 s62, 0
    s_cbranch_scc1 L_round_done
    s_cmp_ge_u32 s62, 3
    s_cbranch_scc1 L_15
    s_waitcnt vmcnt(0)
L_15:
    s_waitcnt vmcnt(4)
    ds_read_b64_tr_b16 v[48:49], v4 offset:2048
    ds_read_b64_tr_b16 v[50:51], v4 offset:2304
    ds_read_b64_tr_b16 v[52:53], v4 offset:2560
    ds_read_b64_tr_b16 v[54:55], v4 offset:2816
    s_cmp_le_u32 s62, 3
    s_cbranch_scc1 L_16
    s_and_b32 s76, s68, s82
    s_add_u32 m0, s63, 0
    s_lshl_b32 s76, s76, 3
    buffer_load_dwordx4 v2, s[8:11], s76 offen lds
    buffer_load_dwordx4 v3, s[8:11], s76 offen offset:1024 lds
L_16:
    s_waitcnt lgkmcnt(0)
    v_mfma_f32_4x4x4_16b_bf16 v[32:35], v[64:65], v[48:49], 0 cbsz:4 abid:1
    v_mfma_f32_4x4x4_16b_bf16 v[36:39], v[64:65], v[50:51], 0 cbsz:4 abid:1
    v_mfma_f32_4x4x4_16b_bf16 v[40:43], v[64:65], v[52:53], 0 cbsz:4 abid:1
    v_mfma_f32_4x4x4_16b_bf16 v[44:47], v[64:65], v[54:55], 0 cbsz:4 abid:1
    s_nop 0
    s_set_gpr_idx_on s65, gpr_idx(SRC2,DST)
    v_pk_fma_f32 v[80:81], v[32:33], v[16:17], v[80:81] op_sel:[0,1,0] op_sel_hi:[1,1,1]
    v_pk_fma_f32 v[82:83], v[34:35], v[16:17], v[82:83] op_sel:[0,1,0] op_sel_hi:[1,1,1]
    v_pk_fma_f32 v[84:85], v[36:37], v[20:21], v[84:85] op_sel:[0,1,0] op_sel_hi:[1,1,1]
    v_pk_fma_f32 v[86:87], v[38:39], v[20:21], v[86:87] op_sel:[0,1,0] op_sel_hi:[1,1,1]
    v_pk_fma_f32 v[88:89], v[40:41], v[24:25], v[88:89] op_sel:[0,1,0] op_sel_hi:[1,1,1]
    v_pk_fma_f32 v[90:91], v[42:43], v[24:25], v[90:91] op_sel:[0,1,0] op_sel_hi:[1,1,1]
    v_pk_fma_f32 v[92:93], v[44:45], v[28:29], v[92:93] op_sel:[0,1,0] op_sel_hi:[1,1,1]
    v_pk_fma_f32 v[94:95], v[46:47], v[28:29], v[94:95] op_sel:[0,1,0] op_sel_hi:[1,1,1]
    s_set_gpr_idx_off
    s_mov_b32 s65, s69
    s_sub_u32 s62, s62, 1
    s_cmp_eq_u32 s62, 0
    s_cbranch_scc1 L_round_done
    s_cmp_ge_u32 s62, 3
    s_cbranch_scc1 L_17
    s_waitcnt vmcnt(0)
L_17:
    s_waitcnt vmcnt(4)
    ds_read_b64_tr_b16 v[48:49], v4 offset:4096
    ds_read_b64_tr_b16 v[50:51], v4 offset:4352
    ds_read_b64_tr_b16 v[52:53], v4 offset:4608
    ds_read_b64_tr_b16 v[54:55], v4 offset:4864
    s_cmp_le_u32 s62, 3
    s_cbranch_scc1 L_18
    s_and_b32 s76, s69, s82
    s_add_u32 m0, s63, 2048
    s_lshl_b32 s76, s76, 3
    buffer_load_dwordx4 v2, s[8:11], s76 offen lds
    buffer_load_dwordx4 v3, s[8:11], s76 offen offset:1024 lds
L_18:
    s_waitcnt lgkmcnt(0)
    v_mfma_f32_4x4x4_16b_bf16 v[32:35], v[64:65], v[48:49], 0 cbsz:4 abid:2
    v_mfma_f32_4x4x4_16b_bf16 v[36:39], v[64:65], v[50:51], 0 cbsz:4 abid:2
    v_mfma_f32_4x4x4_16b_bf16 v[40:43], v[64:65], v[52:53], 0 cbsz:4 abid:2
    v_mfma_f32_4x4x4_16b_bf16 v[44:47], v[64:65], v[54:55], 0 cbsz:4 abid:2
    s_nop 0
    s_set_gpr_idx_on s66, gpr_idx(SRC2,DST)
    v_pk_fma_f32 v[80:81], v[32:33], v[18:19], v[80:81] op_sel:[0,0,0] op_sel_hi:[1,0,1]
    v_pk_fma_f32 v[82:83], v[34:35], v[18:19], v[82:83] op_sel:[0,0,0] op_sel_hi:[1,0,1]
    v_pk_fma_f32 v[84:85], v[36:37], v[22:23], v[84:85] op_sel:[0,0,0] op_sel_hi:[1,0,1]
    v_pk_fma_f32 v[86:87], v[38:39], v[22:23], v[86:87] op_sel:[0,0,0] op_sel_hi:[1,0,1]
    v_pk_fma_f32 v[88:89], v[40:41], v[26:27], v[88:89] op_sel:[0,0,0] op_sel_hi:[1,0,1]
    v_pk_fma_f32 v[90:91], v[42:43], v[26:27], v[90:91] op_sel:[0,0,0] op_sel_hi:[1,0,1]
    v_pk_fma_f32 v[92:93], v[44:45], v[30:31], v[92:93] op_sel:[0,0,0] op_sel_hi:[1,0,1]
    v_pk_fma_f32 v[94:95], v[46:47], v[30:31], v[94:95] op_sel:[0,0,0] op_sel_hi:[1,0,1]
    s_set_gpr_idx_off
    s_mov_b32 s66, s70
    s_sub_u32 s62, s62, 1
    s_cmp_eq_u32 s62, 0
    s_cbranch_scc1 L_round_done
    s_cmp_ge_u32 s62, 3
    s_cbranch_scc1 L_19
    s_waitcnt vmcnt(0)
L_19:
    s_waitcnt vmcnt(4)
    ds_read_b64_tr_b16 v[48:49], v4 offset:6144
    ds_read_b64_tr_b16 v[50:51], v4 offset:6400
    ds_read_b64_tr_b16 v[52:53], v4 offset:6656
    ds_read_b64_tr_b16 v[54:55], v4 offset:6912
    s_cmp_le_u32 s62, 3
    s_cbranch_scc1 L_20
    s_and_b32 s76, s70, s82
    s_add_u32 m0, s63, 4096
    s_lshl_b32 s76, s76, 3
    buffer_load_dwordx4 v2, s[8:11], s76 offen lds
    buffer_load_dwordx4 v3, s[8:11], s76 offen offset:1024 lds
L_20:
    s_waitcnt lgkmcnt(0)
    v_mfma_f32_4x4x4_16b_bf16 v[32:35], v[64:65], v[48:49], 0 cbsz:4 abid:3
    v_mfma_f32_4x4x4_16b_bf16 v[36:39], v[64:65], v[50:51], 0 cbsz:4 abid:3
    v_mfma_f32_4x4x4_16b_bf16 v[40:43], v[64:65], v[52:53], 0 cbsz:4 abid:3
    v_mfma_f32_4x4x4_16b_bf16 v[44:47], v[64:65], v[54:55], 0 cbsz:4 abid:3
    s_nop 0
    s_set_gpr_idx_on s67, gpr_idx(SRC2,DST)
    v_pk_fma_f32 v[80:81], v[32:33], v[18:19], v[80:81] op_sel:[0,1,0] op_sel_hi:[1,1,1]
    v_pk_fma_f32 v[82:83], v[34:35], v[18:19], v[82:83] op_sel:[0,1,0] op_sel_hi:[1,1,1]
    v_pk_fma_f32 v[84:85], v[36:37], v[22:23], v[84:85] op_sel:[0,1,0] op_sel_hi:[1,1,1]
    v_pk_fma_f32 v[86:87], v[38:39], v[22:23], v[86:87] op_sel:[0,1,0] op_sel_hi:[1,1,1]
    v_pk_fma_f32 v[88:89], v[40:41], v[26:27], v[88:89] op_sel:[0,1,0] op_sel_hi:[1,1,1]
    v_pk_fma_f32 v[90:91], v[42:43], v[26:27], v[90:91] op_sel:[0,1,0] op_sel_hi:[1,1,1]
    v_pk_fma_f32 v[92:93], v[44:45], v[30:31], v[92:93] op_sel:[0,1,0] op_sel_hi:[1,1,1]
    v_pk_fma_f32 v[94:95], v[46:47], v[30:31], v[94:95] op_sel:[0,1,0] op_sel_hi:[1,1,1]
    s_set_gpr_idx_off
    s_mov_b32 s67, s71
    s_sub_u32 s62, s62, 1
    s_cmp_eq_u32 s62, 0
    s_cbranch_scc0 L_group
L_round_done:
    s_add_u32 s77, s77, 1
    s_cmp_lg_u32 s78, 0
    s_cbranch_scc1 L_scan
    s_cmp_eq_u32 s81, 0
    s_cbranch_scc1 L_havew
    s_mov_b32 s55, 0
L_pollw:
    s_waitcnt vmcnt(0)
    v_cmp_ne_u32 vcc, s48, v79
    s_cbranch_vccz L_gotw
    buffer_load_dword v79, v66, s[32:35], 0 offen sc1
    s_sleep 1
    s_add_u32 s55, s55, 1
    s_cmp_lt_u32 s55, 0x400000
    s_cbranch_scc1 L_pollw
L_gotw:
    buffer_load_dwordx4 a[32:35], v67, s[32:35], 0 offen offset:0 sc1
    buffer_load_dwordx4 a[36:39], v67, s[32:35], 0 offen offset:1024 sc1
    buffer_load_dwordx4 a[40:43], v67, s[32:35], 0 offen offset:2048 sc1
    buffer_load_dwordx4 a[44:47], v67, s[32:35], 0 offen offset:3072 sc1
    v_add_u32 v67, 4096, v67
    buffer_load_dwordx4 a[48:51], v67, s[32:35], 0 offen offset:0 sc1
    buffer_load_dwordx4 a[52:55], v67, s[32:35], 0 offen offset:1024 sc1
    buffer_load_dwordx4 a[56:59], v67, s[32:35], 0 offen offset:2048 sc1
    buffer_load_dwordx4 a[60:63], v67, s[32:35], 0 offen offset:3072 sc1
    v_add_u32 v67, 4096, v67
    buffer_load_dwordx4 a[64:67], v67, s[32:35], 0 offen offset:0 sc1
    buffer_load_dwordx4 a[68:71], v67, s[32:35], 0 offen offset:1024 sc1
    buffer_load_dwordx4 a[72:75], v67, s[32:35], 0 offen offset:2048 sc1
    buffer_load_dwordx4 a[76:79], v67, s[32:35], 0 offen offset:3072 sc1
    v_add_u32 v67, 4096, v67
    buffer_load_dwordx4 a[80:83], v67, s[32:35], 0 offen offset:0 sc1
    buffer_load_dwordx4 a[84:87], v67, s[32:35], 0 offen offset:1024 sc1
    buffer_load_dwordx4 a[88:91], v67, s[32:35], 0 offen offset:2048 sc1
    buffer_load_dwordx4 a[92:95], v67, s[32:35], 0 offen offset:3072 sc1
    v_add_u32 v67, 4096, v67
    s_branch L_havew
L_wstep:
    v_cmp_ne_u32 vcc, s48, v79
    s_cbranch_vccz L_wgo
    buffer_load_dword v79, v66, s[32:35], 0 offen sc1
    s_branch L_wback
L_wgo:
    s_branch L_wback
L_havew:
    v_mul_u32_u24 v16, 320, v1
    v_lshrrev_b32 v17, 2, v1
    v_lshl_add_u32 v16, v17, 3, v16
    s_lshl_b32 s53, s56, 3
    v_add_u32 v72, s53, v16
    v_add_u32 v5, 111136, v72
    s_lshl_b32 s53, s57, 3
    v_add_u32 v73, s53, v16
    v_add_u32 v6, 111136, v73
    s_lshl_b32 s53, s58, 3
    v_add_u32 v74, s53, v16
    v_add_u32 v7, 111136, v74
    s_lshl_b32 s53, s59, 3
    v_add_u32 v75, s53, v16
    v_add_u32 v8, 111136, v75
    s_lshl_b32 s53, s60, 3
    v_add_u32 v76, s53, v16
    v_add_u32 v9, 111136, v76
    v_cvt_pk_bf16_f32 v32, v80, v81
    v_cvt_pk_bf16_f32 v33, v82, v83
    ds_write_b64 v5, v[32:33] offset:0
    v_cvt_pk_bf16_f32 v34, v96, v97
    v_cvt_pk_bf16_f32 v35, v98, v99
    ds_write_b64 v6, v[34:35] offset:0
    v_cvt_pk_bf16_f32 v36, v112, v113
    v_cvt_pk_bf16_f32 v37, v114, v115
    ds_write_b64 v7, v[36:37] offset:0
    v_cvt_pk_bf16_f32 v38, v128, v129
    v_cvt_pk_bf16_f32 v39, v130, v131
    ds_write_b64 v8, v[38:39] offset:0
    v_cvt_pk_bf16_f32 v40, v144, v145
    v_cvt_pk_bf16_f32 v41, v146, v147
    ds_write_b64 v9, v[40:41] offset:0
    v_cvt_pk_bf16_f32 v42, v84, v85
    v_cvt_pk_bf16_f32 v43, v86, v87
    ds_write_b64 v5, v[42:43] offset:20608
    v_cvt_pk_bf16_f32 v44, v100, v101
    v_cvt_pk_bf16_f32 v45, v102, v103
    ds_write_b64 v6, v[44:45] offset:20608
    v_cvt_pk_bf16_f32 v46, v116, v117
    v_cvt_pk_bf16_f32 v47, v118, v119
    ds_write_b64 v7, v[46:47] offset:20608
    v_cvt_pk_bf16_f32 v48, v132, v133
    v_cvt_pk_bf16_f32 v49, v134, v135
    ds_write_b64 v8, v[48:49] offset:20608
    v_cvt_pk_bf16_f32 v50, v148, v149
    v_cvt_pk_bf16_f32 v51, v150, v151
    ds_write_b64 v9, v[50:51] offset:20608
    v_cvt_pk_bf16_f32 v52, v88, v89
    v_cvt_pk_bf16_f32 v53, v90, v91
    v_cvt_pk_bf16_f32 v54, v104, v105
    v_cvt_pk_bf16_f32 v55, v106, v107
    v_cvt_pk_bf16_f32 v56, v120, v121
    v_cvt_pk_bf16_f32 v57, v122, v123
    v_cvt_pk_bf16_f32 v58, v136, v137
    v_cvt_pk_bf16_f32 v59, v138, v139
    v_cvt_pk_bf16_f32 v60, v152, v153
    v_cvt_pk_bf16_f32 v61, v154, v155
    v_cvt_pk_bf16_f32 v62, v92, v93
    v_cvt_pk_bf16_f32 v63, v94, v95
    v_cvt_pk_bf16_f32 v64, v108, v109
    v_cvt_pk_bf16_f32 v65, v110, v111
    v_cvt_pk_bf16_f32 v66, v124, v125
    v_cvt_pk_bf16_f32 v67, v126, v127
    v_cvt_pk_bf16_f32 v68, v140, v141
    v_cvt_pk_bf16_f32 v69, v142, v143
    v_cvt_pk_bf16_f32 v70, v156, v157
    v_cvt_pk_bf16_f32 v71, v158, v159
    v_lshrrev_b32 v20, 5, v1
    v_mul_u32_u24 v21, 2576, v20
    v_bfe_u32 v22, v1, 2, 2
    v_mul_u32_u24 v24, 320, v22
    v_bfe_u32 v23, v1, 4, 1
    v_lshl_add_u32 v21, v23, 5, v21
    v_and_b32 v23, 3, v1
    v_lshl_add_u32 v21, v23, 3, v21
    v_add_u32 v3, v21, v24
    v_add_u32 v2, 111136, v3
    s_mul_i32 s53, s3, 5120
    s_add_u32 s53, s53, 41472
    v_and_b32 v24, 31, v1
    v_mul_u32_u24 v24, 80, v24
    v_lshl_add_u32 v24, v20, 3, v24
    v_add_u32 v10, s53, v24
    v_lshrrev_b32 v24, 2, v1
    v_mul_u32_u24 v24, 80, v24
    v_lshl_add_u32 v24, v23, 4, v24
    v_add_u32 v11, s53, v24
    v_lshrrev_b32 v24, 4, v1
    v_lshlrev_b32 v24, 19, v24
    v_lshl_add_u32 v24, v22, 9, v24
    v_lshl_add_u32 v24, v23, 4, v24
    s_lshl_b32 s53, s2, 11
    s_lshl_b32 s54, s3, 6
    s_add_u32 s53, s53, s54
    v_add_u32 v4, s53, v24
    s_waitcnt lgkmcnt(0)
    s_barrier
    ds_read_b64_tr_b16 v[16:17], v2 offset:0
    ds_read_b64_tr_b16 v[18:19], v2 offset:1288
    ds_read_b64_tr_b16 v[20:21], v2 offset:5152
    ds_read_b64_tr_b16 v[22:23], v2 offset:6440
    ds_read_b64_tr_b16 v[24:25], v2 offset:10304
    ds_read_b64_tr_b16 v[26:27], v2 offset:11592
    ds_read_b64_tr_b16 v[28:29], v2 offset:15456
    ds_read_b64_tr_b16 v[30:31], v2 offset:16744
    ds_read_b64_tr_b16 v[32:33], v2 offset:20608
    ds_read_b64_tr_b16 v[34:35], v2 offset:21896
    s_waitcnt vmcnt(8)
    s_waitcnt lgkmcnt(8)
    v_mfma_f32_32x32x16_bf16 v[80:95], a[32:35], v[16:19], 0
    ds_read_b64_tr_b16 v[36:37], v2 offset:25760
    ds_read_b64_tr_b16 v[38:39], v2 offset:27048
    ds_write_b64 v72, v[52:53] offset:0
    s_waitcnt lgkmcnt(9)
    v_mfma_f32_32x32x16_bf16 v[80:95], a[36:39], v[20:23], v[80:95]
    ds_read_b64_tr_b16 v[40:41], v2 offset:30912
    ds_read_b64_tr_b16 v[42:43], v2 offset:32200
    ds_write_b64 v73, v[54:55] offset:0
    s_waitcnt lgkmcnt(10)
    v_mfma_f32_32x32x16_bf16 v[80:95], a[40:43], v[24:27], v[80:95]
    ds_read_b64_tr_b16 v[44:45], v2 offset:36064
    ds_read_b64_tr_b16 v[46:47], v2 offset:37352
    ds_write_b64 v74, v[56:57] offset:0
    s_waitcnt lgkmcnt(11)
    v_mfma_f32_32x32x16_bf16 v[80:95], a[44:47], v[28:31], v[80:95]
    ds_read_b64_tr_b16 v[16:17], v2 offset:64
    ds_read_b64_tr_b16 v[18:19], v2 offset:1352
    ds_write_b64 v75, v[58:59] offset:0
    s_waitcnt lgkmcnt(12)
    v_mfma_f32_32x32x16_bf16 v[80:95], a[48:51], v[32:35], v[80:95]
    ds_read_b64_tr_b16 v[20:21], v2 offset:5216
    ds_read_b64_tr_b16 v[22:23], v2 offset:6504
    ds_write_b64 v76, v[60:61] offset:0
    s_waitcnt lgkmcnt(13)
    v_mfma_f32_32x32x16_bf16 v[80:95], a[52:55], v[36:39], v[80:95]
    ds_read_b64_tr_b16 v[24:25], v2 offset:10368
    ds_read_b64_tr_b16 v[26:27], v2 offset:11656
    ds_write_b64 v72, v[62:63] offset:20608
    s_waitcnt lgkmcnt(13)
    v_mfma_f32_32x32x16_bf16 v[80:95], a[56:59], v[40:43], v[80:95]
    ds_read_b64_tr_b16 v[28:29], v2 offset:15520
    ds_read_b64_tr_b16 v[30:31], v2 offset:16808
    ds_write_b64 v73, v[64:65] offset:20608
    s_waitcnt lgkmcnt(13)
    v_mfma_f32_32x32x16_bf16 v[80:95], a[60:63], v[44:47], v[80:95]
    ds_read_b64_tr_b16 v[32:33], v2 offset:20672
    ds_read_b64_tr_b16 v[34:35], v2 offset:21960
    ds_write_b64 v74, v[66:67] offset:20608
    s_waitcnt lgkmcnt(13)
    v_mfma_f32_32x32x16_bf16 v[96:111], a[32:35], v[16:19], 0
    ds_read_b64_tr_b16 v[36:37], v2 offset:25824
    ds_read_b64_tr_b16 v[38:39], v2 offset:27112
    ds_write_b64 v75, v[68:69] offset:20608
    s_waitcnt lgkmcnt(13)
    v_mfma_f32_32x32x16_bf16 v[96:111], a[36:39], v[20:23], v[96:111]
    ds_read_b64_tr_b16 v[40:41], v2 offset:30976
    ds_read_b64_tr_b16 v[42:43], v2 offset:32264
    ds_write_b64 v76, v[70:71] offset:20608
    s_waitcnt lgkmcnt(13)
    v_mfma_f32_32x32x16_bf16 v[96:111], a[40:43], v[24:27], v[96:111]
    ds_read_b64_tr_b16 v[44:45], v2 offset:36128
    ds_read_b64_tr_b16 v[46:47], v2 offset:37416
    s_waitcnt lgkmcnt(12)
    v_mfma_f32_32x32x16_bf16 v[96:111], a[44:47], v[28:31], v[96:111]
    ds_read_b64_tr_b16 v[16:17], v2 offset:128
    ds_read_b64_tr_b16 v[18:19], v2 offset:1416
    s_waitcnt lgkmcnt(11)
    v_mfma_f32_32x32x16_bf16 v[96:111], a[48:51], v[32:35], v[96:111]
    ds_read_b64_tr_b16 v[20:21], v2 offset:5280
    ds_read_b64_tr_b16 v[22:23], v2 offset:6568
    s_waitcnt lgkmcnt(10)
    v_mfma_f32_32x32x16_bf16 v[96:111], a[52:55], v[36:39], v[96:111]
    ds_read_b64_tr_b16 v[24:25], v2 offset:10432
    ds_read_b64_tr_b16 v[26:27], v2 offset:11720
    s_waitcnt lgkmcnt(9)
    v_mfma_f32_32x32x16_bf16 v[96:111], a[56:59], v[40:43], v[96:111]
    ds_read_b64_tr_b16 v[28:29], v2 offset:15584
    ds_read_b64_tr_b16 v[30:31], v2 offset:16872
    s_waitcnt lgkmcnt(8)
    v_mfma_f32_32x32x16_bf16 v[96:111], a[60:63], v[44:47], v[96:111]
    ds_read_b64_tr_b16 v[32:33], v2 offset:20736
    ds_read_b64_tr_b16 v[34:35], v2 offset:22024
    s_waitcnt lgkmcnt(8)
    v_mfma_f32_32x32x16_bf16 v[112:127], a[32:35], v[16:19], 0
    ds_read_b64_tr_b16 v[36:37], v2 offset:25888
    ds_read_b64_tr_b16 v[38:39], v2 offset:27176
    s_waitcnt lgkmcnt(8)
    v_mfma_f32_32x32x16_bf16 v[112:127], a[36:39], v[20:23], v[112:127]
    ds_read_b64_tr_b16 v[40:41], v2 offset:31040
    ds_read_b64_tr_b16 v[42:43], v2 offset:32328
    s_waitcnt lgkmcnt(8)
    v_mfma_f32_32x32x16_bf16 v[112:127], a[40:43], v[24:27], v[112:127]
    ds_read_b64_tr_b16 v[44:45], v2 offset:36192
    ds_read_b64_tr_b16 v[46:47], v2 offset:37480
    s_barrier
    s_waitcnt lgkmcnt(8)
    v_mfma_f32_32x32x16_bf16 v[112:127], a[44:47], v[28:31], v[112:127]
    ds_read_b64_tr_b16 v[16:17], v3 offset:0
    ds_read_b64_tr_b16 v[18:19], v3 offset:1288
    s_waitcnt lgkmcnt(8)
    v_mfma_f32_32x32x16_bf16 v[112:127], a[48:51], v[32:35], v[112:127]
    ds_read_b64_tr_b16 v[20:21], v3 offset:5152
    ds_read_b64_tr_b16 v[22:23], v3 offset:6440
    s_waitcnt lgkmcnt(8)
    v_mfma_f32_32x32x16_bf16 v[112:127], a[52:55], v[36:39], v[112:127]
    ds_read_b64_tr_b16 v[24:25], v3 offset:10304
    ds_read_b64_tr_b16 v[26:27], v3 offset:11592
    s_waitcnt lgkmcnt(8)
    v_mfma_f32_32x32x16_bf16 v[112:127], a[56:59], v[40:43], v[112:127]
    ds_read_b64_tr_b16 v[28:29], v3 offset:15456
    ds_read_b64_tr_b16 v[30:31], v3 offset:16744
    s_waitcnt lgkmcnt(8)
    v_mfma_f32_32x32x16_bf16 v[112:127], a[60:63], v[44:47], v[112:127]
    ds_read_b64_tr_b16 v[32:33], v3 offset:20608
    ds_read_b64_tr_b16 v[34:35], v3 offset:21896
    s_waitcnt vmcnt(0)
    s_waitcnt lgkmcnt(8)
    v_mfma_f32_32x32x16_bf16 v[80:95], a[64:67], v[16:19], v[80:95]
    ds_read_b64_tr_b16 v[36:37], v3 offset:25760
    ds_read_b64_tr_b16 v[38:39], v3 offset:27048
    s_waitcnt lgkmcnt(8)
    v_mfma_f32_32x32x16_bf16 v[80:95], a[68:71], v[20:23], v[80:95]
    ds_read_b64_tr_b16 v[40:41], v3 offset:30912
    ds_read_b64_tr_b16 v[42:43], v3 offset:32200
    s_waitcnt lgkmcnt(8)
    v_mfma_f32_32x32x16_bf16 v[80:95], a[72:75], v[24:27], v[80:95]
    ds_read_b64_tr_b16 v[44:45], v3 offset:36064
    ds_read_b64_tr_b16 v[46:47], v3 offset:37352
    s_waitcnt lgkmcnt(8)
    v_mfma_f32_32x32x16_bf16 v[80:95], a[76:79], v[28:31], v[80:95]
    ds_read_b64_tr_b16 v[16:17], v3 offset:64
    ds_read_b64_tr_b16 v[18:19], v3 offset:1352
    s_waitcnt lgkmcnt(8)
    v_mfma_f32_32x32x16_bf16 v[80:95], a[80:83], v[32:35], v[80:95]
    ds_read_b64_tr_b16 v[20:21], v3 offset:5216
    ds_read_b64_tr_b16 v[22:23], v3 offset:6504
    s_waitcnt lgkmcnt(8)
    v_mfma_f32_32x32x16_bf16 v[80:95], a[84:87], v[36:39], v[80:95]
    ds_read_b64_tr_b16 v[24:25], v3 offset:10368
    ds_read_b64_tr_b16 v[26:27], v3 offset:11656
    s_waitcnt lgkmcnt(8)
    v_mfma_f32_32x32x16_bf16 v[80:95], a[88:91], v[40:43], v[80:95]
    ds_read_b64_tr_b16 v[28:29], v3 offset:15520
    ds_read_b64_tr_b16 v[30:31], v3 offset:16808
    s_waitcnt lgkmcnt(8)
    v_mfma_f32_32x32x16_bf16 v[80:95], a[92:95], v[44:47], v[80:95]
    ds_read_b64_tr_b16 v[32:33], v3 offset:20672
    ds_read_b64_tr_b16 v[34:35], v3 offset:21960
    s_waitcnt lgkmcnt(8)
    v_mfma_f32_32x32x16_bf16 v[96:111], a[64:67], v[16:19], v[96:111]
    ds_read_b64_tr_b16 v[36:37], v3 offset:25824
    ds_read_b64_tr_b16 v[38:39], v3 offset:27112
    s_waitcnt lgkmcnt(8)
    v_mfma_f32_32x32x16_bf16 v[96:111], a[68:71], v[20:23], v[96:111]
    ds_read_b64_tr_b16 v[40:41], v3 offset:30976
    ds_read_b64_tr_b16 v[42:43], v3 offset:32264
    s_waitcnt lgkmcnt(8)
    v_mfma_f32_32x32x16_bf16 v[96:111], a[72:75], v[24:27], v[96:111]
    ds_read_b64_tr_b16 v[44:45], v3 offset:36128
    ds_read_b64_tr_b16 v[46:47], v3 offset:37416
    s_waitcnt lgkmcnt(8)
    v_mfma_f32_32x32x16_bf16 v[96:111], a[76:79], v[28:31], v[96:111]
    ds_read_b64_tr_b16 v[16:17], v3 offset:128
    ds_read_b64_tr_b16 v[18:19], v3 offset:1416
    v_cvt_pk_bf16_f32 v80, v80, v81
    v_cvt_pk_bf16_f32 v81, v82, v83
    ds_write_b64 v10, v[80:81] offset:0
    s_waitcnt lgkmcnt(9)
    v_mfma_f32_32x32x16_bf16 v[96:111], a[80:83], v[32:35], v[96:111]
    ds_read_b64_tr_b16 v[20:21], v3 offset:5280
    ds_read_b64_tr_b16 v[22:23], v3 offset:6568
    v_cvt_pk_bf16_f32 v82, v84, v85
    v_cvt_pk_bf16_f32 v83, v86, v87
    ds_write_b64 v10, v[82:83] offset:16
    s_waitcnt lgkmcnt(10)
    v_mfma_f32_32x32x16_bf16 v[96:111], a[84:87], v[36:39], v[96:111]
    ds_read_b64_tr_b16 v[24:25], v3 offset:10432
    ds_read_b64_tr_b16 v[26:27], v3 offset:11720
    v_cvt_pk_bf16_f32 v84, v88, v89
    v_cvt_pk_bf16_f32 v85, v90, v91
    ds_write_b64 v10, v[84:85] offset:32
    s_waitcnt lgkmcnt(11)
    v_mfma_f32_32x32x16_bf16 v[96:111], a[88:91], v[40:43], v[96:111]
    ds_read_b64_tr_b16 v[28:29], v3 offset:15584
    ds_read_b64_tr_b16 v[30:31], v3 offset:16872
    v_cvt_pk_bf16_f32 v86, v92, v93
    v_cvt_pk_bf16_f32 v87, v94, v95
    ds_write_b64 v10, v[86:87] offset:48
    s_waitcnt lgkmcnt(12)
    v_mfma_f32_32x32x16_bf16 v[96:111], a[92:95], v[44:47], v[96:111]
    ds_read_b64_tr_b16 v[32:33], v3 offset:20736
    ds_read_b64_tr_b16 v[34:35], v3 offset:22024
    ds_read_b128 v[52:55], v11 offset:0
    s_waitcnt lgkmcnt(13)
    v_mfma_f32_32x32x16_bf16 v[112:127], a[64:67], v[16:19], v[112:127]
    ds_read_b64_tr_b16 v[36:37], v3 offset:25888
    ds_read_b64_tr_b16 v[38:39], v3 offset:27176
    ds_read_b128 v[56:59], v11 offset:1280
    s_waitcnt lgkmcnt(13)
    v_mfma_f32_32x32x16_bf16 v[112:127], a[68:71], v[20:23], v[112:127]
    ds_read_b64_tr_b16 v[40:41], v3 offset:31040
    ds_read_b64_tr_b16 v[42:43], v3 offset:32328
    s_waitcnt lgkmcnt(12)
    v_mfma_f32_32x32x16_bf16 v[112:127], a[72:75], v[24:27], v[112:127]
    ds_read_b64_tr_b16 v[44:45], v3 offset:36192
    ds_read_b64_tr_b16 v[46:47], v3 offset:37480
    s_waitcnt lgkmcnt(11)
    v_mfma_f32_32x32x16_bf16 v[112:127], a[76:79], v[28:31], v[112:127]
    ds_read_b64_tr_b16 v[16:17], v2 offset:192
    ds_read_b64_tr_b16 v[18:19], v2 offset:1480
    v_cvt_pk_bf16_f32 v96, v96, v97
    v_cvt_pk_bf16_f32 v97, v98, v99
    ds_write_b64 v10, v[96:97] offset:2560
    s_waitcnt lgkmcnt(11)
    v_mfma_f32_32x32x16_bf16 v[112:127], a[80:83], v[32:35], v[112:127]
    ds_read_b64_tr_b16 v[20:21], v2 offset:5344
    ds_read_b64_tr_b16 v[22:23], v2 offset:6632
    v_cvt_pk_bf16_f32 v98, v100, v101
    v_cvt_pk_bf16_f32 v99, v102, v103
    ds_write_b64 v10, v[98:99] offset:2576
    s_waitcnt lgkmcnt(11)
    v_mfma_f32_32x32x16_bf16 v[112:127], a[84:87], v[36:39], v[112:127]
    ds_read_b64_tr_b16 v[24:25], v2 offset:10496
    ds_read_b64_tr_b16 v[26:27], v2 offset:11784
    buffer_store_dwordx4 v[52:55], v4, s[28:31], 0 offen sc1
    v_add_u32 v4, 2097152, v4
    v_cvt_pk_bf16_f32 v100, v104, v105
    v_cvt_pk_bf16_f32 v101, v106, v107
    ds_write_b64 v10, v[100:101] offset:2592
    s_waitcnt lgkmcnt(11)
    v_mfma_f32_32x32x16_bf16 v[112:127], a[88:91], v[40:43], v[112:127]
    ds_read_b64_tr_b16 v[28:29], v2 offset:15648
    ds_read_b64_tr_b16 v[30:31], v2 offset:16936
    buffer_store_dwordx4 v[56:59], v4, s[28:31], 0 offen sc1
    v_add_u32 v4, 2097152, v4
    v_cvt_pk_bf16_f32 v102, v108, v109
    v_cvt_pk_bf16_f32 v103, v110, v111
    ds_write_b64 v10, v[102:103] offset:2608
    s_waitcnt lgkmcnt(12)
    v_mfma_f32_32x32x16_bf16 v[112:127], a[92:95], v[44:47], v[112:127]
    ds_read_b64_tr_b16 v[32:33], v2 offset:20800
    ds_read_b64_tr_b16 v[34:35], v2 offset:22088
    ds_read_b128 v[60:63], v11 offset:2560
    s_waitcnt lgkmcnt(13)
    v_mfma_f32_32x32x16_bf16 v[128:143], a[32:35], v[16:19], 0
    ds_read_b64_tr_b16 v[36:37], v2 offset:25952
    ds_read_b64_tr_b16 v[38:39], v2 offset:27240
    ds_read_b128 v[64:67], v11 offset:3840
    s_waitcnt lgkmcnt(13)
    v_mfma_f32_32x32x16_bf16 v[128:143], a[36:39], v[20:23], v[128:143]
    ds_read_b64_tr_b16 v[40:41], v2 offset:31104
    ds_read_b64_tr_b16 v[42:43], v2 offset:32392
    s_waitcnt lgkmcnt(12)
    v_mfma_f32_32x32x16_bf16 v[128:143], a[40:43], v[24:27], v[128:143]
    ds_read_b64_tr_b16 v[44:45], v2 offset:36256
    ds_read_b64_tr_b16 v[46:47], v2 offset:37544
    s_waitcnt lgkmcnt(11)
    v_mfma_f32_32x32x16_bf16 v[128:143], a[44:47], v[28:31], v[128:143]
    ds_read_b64_tr_b16 v[16:17], v3 offset:192
    ds_read_b64_tr_b16 v[18:19], v3 offset:1480
    v_cvt_pk_bf16_f32 v112, v112, v113
    v_cvt_pk_bf16_f32 v113, v114, v115
    ds_write_b64 v10, v[112:113] offset:0
    s_waitcnt lgkmcnt(11)
    v_mfma_f32_32x32x16_bf16 v[128:143], a[48:51], v[32:35], v[128:143]
    ds_read_b64_tr_b16 v[20:21], v3 offset:5344
    ds_read_b64_tr_b16 v[22:23], v3 offset:6632
    v_cvt_pk_bf16_f32 v114, v116, v117
    v_cvt_pk_bf16_f32 v115, v118, v119
    ds_write_b64 v10, v[114:115] offset:16
    s_waitcnt lgkmcnt(11)
    v_mfma_f32_32x32x16_bf16 v[128:143], a[52:55], v[36:39], v[128:143]
    ds_read_b64_tr_b16 v[24:25], v3 offset:10496
    ds_read_b64_tr_b16 v[26:27], v3 offset:11784
    buffer_store_dwordx4 v[60:63], v4, s[28:31], 0 offen sc1
    v_add_u32 v4, 2097152, v4
    v_cvt_pk_bf16_f32 v116, v120, v121
    v_cvt_pk_bf16_f32 v117, v122, v123
    ds_write_b64 v10, v[116:117] offset:32
    s_waitcnt lgkmcnt(11)
    v_mfma_f32_32x32x16_bf16 v[128:143], a[56:59], v[40:43], v[128:143]
    ds_read_b64_tr_b16 v[28:29], v3 offset:15648
    ds_read_b64_tr_b16 v[30:31], v3 offset:16936
    buffer_store_dwordx4 v[64:67], v4, s[28:31], 0 offen sc1
    v_add_u32 v4, 2097152, v4
    v_cvt_pk_bf16_f32 v118, v124, v125
    v_cvt_pk_bf16_f32 v119, v126, v127
    ds_write_b64 v10, v[118:119] offset:48
    s_waitcnt lgkmcnt(12)
    v_mfma_f32_32x32x16_bf16 v[128:143], a[60:63], v[44:47], v[128:143]
    ds_read_b64_tr_b16 v[32:33], v3 offset:20800
    ds_read_b64_tr_b16 v[34:35], v3 offset:22088
    ds_read_b128 v[52:55], v11 offset:0
    s_waitcnt lgkmcnt(13)
    v_mfma_f32_32x32x16_bf16 v[128:143], a[64:67], v[16:19], v[128:143]
    ds_read_b64_tr_b16 v[36:37], v3 offset:25952
    ds_read_b64_tr_b16 v[38:39], v3 offset:27240
    ds_read_b128 v[56:59], v11 offset:1280
    s_waitcnt lgkmcnt(13)
    v_mfma_f32_32x32x16_bf16 v[128:143], a[68:71], v[20:23], v[128:143]
    ds_read_b64_tr_b16 v[40:41], v3 offset:31104
    ds_read_b64_tr_b16 v[42:43], v3 offset:32392
    s_waitcnt lgkmcnt(12)
    v_mfma_f32_32x32x16_bf16 v[128:143], a[72:75], v[24:27], v[128:143]
    ds_read_b64_tr_b16 v[44:45], v3 offset:36256
    ds_read_b64_tr_b16 v[46:47], v3 offset:37544
    s_waitcnt lgkmcnt(11)
    v_mfma_f32_32x32x16_bf16 v[128:143], a[76:79], v[28:31], v[128:143]
    ds_read_b64_tr_b16 v[16:17], v2 offset:256
    ds_read_b64_tr_b16 v[18:19], v2 offset:1544
    s_waitcnt lgkmcnt(10)
    v_mfma_f32_32x32x16_bf16 v[128:143], a[80:83], v[32:35], v[128:143]
    ds_read_b64_tr_b16 v[20:21], v2 offset:5408
    ds_read_b64_tr_b16 v[22:23], v2 offset:6696
    s_waitcnt lgkmcnt(9)
    v_mfma_f32_32x32x16_bf16 v[128:143], a[84:87], v[36:39], v[128:143]
    ds_read_b64_tr_b16 v[24:25], v2 offset:10560
    ds_read_b64_tr_b16 v[26:27], v2 offset:11848
    buffer_store_dwordx4 v[52:55], v4, s[28:31], 0 offen sc1
    v_add_u32 v4, 2097152, v4
    s_waitcnt lgkmcnt(8)
    v_mfma_f32_32x32x16_bf16 v[128:143], a[88:91], v[40:43], v[128:143]
    ds_read_b64_tr_b16 v[28:29], v2 offset:15712
    ds_read_b64_tr_b16 v[30:31], v2 offset:17000
    buffer_store_dwordx4 v[56:59], v4, s[28:31], 0 offen sc1
    v_add_u32 v4, 2097152, v4
    s_waitcnt lgkmcnt(8)
    v_mfma_f32_32x32x16_bf16 v[128:143], a[92:95], v[44:47], v[128:143]
    ds_read_b64_tr_b16 v[32:33], v2 offset:20864
    ds_read_b64_tr_b16 v[34:35], v2 offset:22152
    s_waitcnt lgkmcnt(8)
    v_mfma_f32_32x32x16_bf16 v[144:159], a[32:35], v[16:19], 0
    ds_read_b64_tr_b16 v[36:37], v2 offset:26016
    ds_read_b64_tr_b16 v[38:39], v2 offset:27304
    s_waitcnt lgkmcnt(8)
    v_mfma_f32_32x32x16_bf16 v[144:159], a[36:39], v[20:23], v[144:159]
    ds_read_b64_tr_b16 v[40:41], v2 offset:31168
    ds_read_b64_tr_b16 v[42:43], v2 offset:32456
    s_waitcnt lgkmcnt(8)
    v_mfma_f32_32x32x16_bf16 v[144:159], a[40:43], v[24:27], v[144:159]
    ds_read_b64_tr_b16 v[44:45], v2 offset:36320
    ds_read_b64_tr_b16 v[46:47], v2 offset:37608
    s_waitcnt lgkmcnt(8)
    v_mfma_f32_32x32x16_bf16 v[144:159], a[44:47], v[28:31], v[144:159]
    ds_read_b64_tr_b16 v[16:17], v3 offset:256
    ds_read_b64_tr_b16 v[18:19], v3 offset:1544
    v_cvt_pk_bf16_f32 v128, v128, v129
    v_cvt_pk_bf16_f32 v129, v130, v131
    ds_write_b64 v10, v[128:129] offset:2560
    s_waitcnt lgkmcnt(9)
    v_mfma_f32_32x32x16_bf16 v[144:159], a[48:51], v[32:35], v[144:159]
    ds_read_b64_tr_b16 v[20:21], v3 offset:5408
    ds_read_b64_tr_b16 v[22:23], v3 offset:6696
    v_cvt_pk_bf16_f32 v130, v132, v133
    v_cvt_pk_bf16_f32 v131, v134, v135
    ds_write_b64 v10, v[130:131] offset:2576
    s_waitcnt lgkmcnt(10)
    v_mfma_f32_32x32x16_bf16 v[144:159], a[52:55], v[36:39], v[144:159]
    ds_read_b64_tr_b16 v[24:25], v3 offset:10560
    ds_read_b64_tr_b16 v[26:27], v3 offset:11848
    v_cvt_pk_bf16_f32 v132, v136, v137
    v_cvt_pk_bf16_f32 v133, v138, v139
    ds_write_b64 v10, v[132:133] offset:2592
    s_waitcnt lgkmcnt(11)
    v_mfma_f32_32x32x16_bf16 v[144:159], a[56:59], v[40:43], v[144:159]
    ds_read_b64_tr_b16 v[28:29], v3 offset:15712
    ds_read_b64_tr_b16 v[30:31], v3 offset:17000
    v_cvt_pk_bf16_f32 v134, v140, v141
    v_cvt_pk_bf16_f32 v135, v142, v143
    ds_write_b64 v10, v[134:135] offset:2608
    s_waitcnt lgkmcnt(12)
    v_mfma_f32_32x32x16_bf16 v[144:159], a[60:63], v[44:47], v[144:159]
    ds_read_b64_tr_b16 v[32:33], v3 offset:20864
    ds_read_b64_tr_b16 v[34:35], v3 offset:22152
    ds_read_b128 v[60:63], v11 offset:2560
    s_waitcnt lgkmcnt(13)
    v_mfma_f32_32x32x16_bf16 v[144:159], a[64:67], v[16:19], v[144:159]
    ds_read_b64_tr_b16 v[36:37], v3 offset:26016
    ds_read_b64_tr_b16 v[38:39], v3 offset:27304
    ds_read_b128 v[64:67], v11 offset:3840
    s_waitcnt lgkmcnt(13)
    v_mfma_f32_32x32x16_bf16 v[144:159], a[68:71], v[20:23], v[144:159]
    ds_read_b64_tr_b16 v[40:41], v3 offset:31168
    ds_read_b64_tr_b16 v[42:43], v3 offset:32456
    s_waitcnt lgkmcnt(12)
    v_mfma_f32_32x32x16_bf16 v[144:159], a[72:75], v[24:27], v[144:159]
    ds_read_b64_tr_b16 v[44:45], v3 offset:36320
    ds_read_b64_tr_b16 v[46:47], v3 offset:37608
    s_waitcnt lgkmcnt(11)
    v_mfma_f32_32x32x16_bf16 v[144:159], a[76:79], v[28:31], v[144:159]
    s_waitcnt lgkmcnt(8)
    v_mfma_f32_32x32x16_bf16 v[144:159], a[80:83], v[32:35], v[144:159]
    s_waitcnt lgkmcnt(5)
    v_mfma_f32_32x32x16_bf16 v[144:159], a[84:87], v[36:39], v[144:159]
    buffer_store_dwordx4 v[60:63], v4, s[28:31], 0 offen sc1
    v_add_u32 v4, 2097152, v4
    s_waitcnt lgkmcnt(2)
    v_mfma_f32_32x32x16_bf16 v[144:159], a[88:91], v[40:43], v[144:159]
    buffer_store_dwordx4 v[64:67], v4, s[28:31], 0 offen sc1
    v_add_u32 v4, 2097152, v4
    s_waitcnt lgkmcnt(0)
    v_mfma_f32_32x32x16_bf16 v[144:159], a[92:95], v[44:47], v[144:159]
    s_nop 11
    v_cvt_pk_bf16_f32 v144, v144, v145
    v_cvt_pk_bf16_f32 v145, v146, v147
    ds_write_b64 v10, v[144:145] offset:0
    v_cvt_pk_bf16_f32 v146, v148, v149
    v_cvt_pk_bf16_f32 v147, v150, v151
    ds_write_b64 v10, v[146:147] offset:16
    v_cvt_pk_bf16_f32 v148, v152, v153
    v_cvt_pk_bf16_f32 v149, v154, v155
    ds_write_b64 v10, v[148:149] offset:32
    v_cvt_pk_bf16_f32 v150, v156, v157
    v_cvt_pk_bf16_f32 v151, v158, v159
    ds_write_b64 v10, v[150:151] offset:48
    ds_read_b128 v[52:55], v11 offset:0
    ds_read_b128 v[56:59], v11 offset:1280
    s_waitcnt lgkmcnt(1)
    buffer_store_dwordx4 v[52:55], v4, s[28:31], 0 offen sc1
    v_add_u32 v4, 2097152, v4
    s_waitcnt lgkmcnt(0)
    buffer_store_dwordx4 v[56:59], v4, s[28:31], 0 offen sc1
    v_add_u32 v4, 2097152, v4
L_end:
    s_endpgm
.section .rodata,"a"
.p2align 6
.amdhsa_kernel standalone__tensor_product_equiv_mace__graph_kernel
  .amdhsa_next_free_vgpr 256
  .amdhsa_next_free_sgpr 102
  .amdhsa_accum_offset 160
  .amdhsa_group_segment_fixed_size 0
  .amdhsa_kernarg_size 88
  .amdhsa_user_sgpr_count 2
  .amdhsa_user_sgpr_kernarg_segment_ptr 1
  .amdhsa_system_sgpr_workgroup_id_x 1
  .amdhsa_float_denorm_mode_32 3
.end_amdhsa_kernel
```

```asm
; @launch grid=(256,1,1) block=(512,1,1) lds=153600
.amdgcn_target "amdgcn-amd-amdhsa--gfx950"
.text
.globl standalone__tensor_product_equiv_mace__graph_kernel
.p2align 8
.type standalone__tensor_product_equiv_mace__graph_kernel,@function
standalone__tensor_product_equiv_mace__graph_kernel:
    s_cmp_ge_u32 s2, 256
    s_cbranch_scc1 L_end
    s_load_dwordx2 s[84:85], s[0:1], 80
    s_load_dwordx16 s[64:79], s[0:1], 0
    s_load_dwordx2 s[80:81], s[0:1], 64
    v_and_b32 v1, 63, v0
    v_lshrrev_b32 v60, 6, v0
    v_mov_b32 v12, 0
    v_readfirstlane_b32 s3, v60
    s_and_b32 s55, s2, 63
    s_and_b32 s54, s2, 192
    s_mul_i32 s53, s55, 10000
    v_lshlrev_b32 v63, 4, v0
    v_add_u32 v60, s53, v63
    s_add_u32 s53, s53, 8192
    v_lshl_add_u32 v61, v0, 2, s53
    s_lshl_b32 s53, s54, 1
    v_mov_b32 v62, s53
    s_waitcnt lgkmcnt(0)
    s_mov_b32 s16, s68
    s_mov_b32 s17, s69
    s_mov_b32 s18, 640000
    s_mov_b32 s19, 0x00020000
    buffer_load_dwordx4 v[16:19], v60, s[16:19], 0 offen
    buffer_load_dword v20, v61, s[16:19], 0 offen
    s_mov_b32 s12, s66
    s_mov_b32 s13, s67
    s_mov_b32 s14, 640000
    s_mov_b32 s15, 0x00020000
    buffer_load_dwordx4 v[24:27], v60, s[12:15], 0 offen
    buffer_load_dword v28, v61, s[12:15], 0 offen
    s_mov_b32 s32, s84
    s_mov_b32 s33, s85
    s_mov_b32 s34, 20971520
    s_mov_b32 s35, 0x00020000
    buffer_load_dword v42, v62, s[32:35], 0 offen sc1
    s_mov_b32 s20, s70
    s_mov_b32 s21, s71
    s_mov_b32 s22, 1280000
    s_mov_b32 s23, 0x00020000
    v_mov_b32 v72, -1
    v_mov_b32 v73, -1
    v_mov_b32 v74, -1
    v_mov_b32 v75, -1
    ds_write_b128 v63, v[72:75] offset:0
    ds_write_b128 v63, v[72:75] offset:8192
    v_mov_b32 v68, 0
    v_mov_b32 v69, 0
    v_lshlrev_b32 v60, 3, v0
    v_add_u32 v60, 111136, v60
    ds_write_b64 v60, v[68:69]
    v_min_u32 v60, 35, v1
    v_lshlrev_b32 v60, 3, v60
    v_add_u32 v60, 110848, v60
    ds_write_b64 v60, v[68:69]
    s_mov_b32 s8, s64
    s_mov_b32 s9, s65
    s_mov_b32 s10, 20480000
    s_mov_b32 s11, 0x00020000
    s_mov_b32 s24, s72
    s_mov_b32 s25, s73
    s_mov_b32 s26, 5120000
    s_mov_b32 s27, 0x00020000
    s_mov_b32 s28, s80
    s_mov_b32 s29, s81
    s_mov_b32 s30, 20480000
    s_mov_b32 s31, 0x00020000
    s_mov_b32 s96, s74
    s_mov_b32 s97, s75
    s_mov_b32 s98, 128
    s_mov_b32 s99, 0x00020000
    s_mov_b32 s92, s76
    s_mov_b32 s93, s77
    s_mov_b32 s94, 8192
    s_mov_b32 s95, 0x00020000
    s_mov_b32 s88, s78
    s_mov_b32 s89, s79
    s_mov_b32 s90, 131072
    s_mov_b32 s91, 0x00020000
    s_lshl_b32 s63, s3, 13
    s_mov_b32 s52, 0
    s_mov_b32 s77, 0
    s_mov_b32 s82, 0x3fff00
    s_mov_b32 s83, 20971520
    s_mov_b32 s81, 8
    s_lshl_b32 s49, s3, 10
    s_add_u32 s49, s49, 119328
    s_movk_i32 s53, 452
    v_cmp_gt_u32 s[50:51], s53, v0
    v_lshlrev_b32 v43, 22, v0
    v_lshlrev_b32 v59, 20, v0
    v_mov_b32 v58, 1
    s_waitcnt lgkmcnt(0)
    s_barrier
    v_and_b32 v60, 3, v1
    v_lshlrev_b32 v61, 5, v60
    v_lshrrev_b32 v66, 4, v1
    v_lshl_add_u32 v61, v66, 1, v61
    buffer_load_ushort v44, v61, s[96:99], 0 offen offset:0
    buffer_load_ushort v45, v61, s[96:99], 0 offen offset:8
    buffer_load_ushort v46, v61, s[96:99], 0 offen offset:16
    buffer_load_ushort v47, v61, s[96:99], 0 offen offset:24
    s_lshl_b32 s53, s3, 10
    s_add_u32 m0, s53, 32768
    v_lshlrev_b32 v64, 4, v1
    buffer_load_dwordx4 v64, s[92:95], s53 offen lds
    s_lshr_b32 s53, s2, 3
    s_lshl3_add_u32 s53, s53, s3
    s_lshl_b32 s53, s53, 10
    v_add_u32 v79, s53, v64
    buffer_load_dwordx4 v[156:159], v79, s[20:23], 0 offen
    v_add_u32 v79, 262144, v79
    buffer_load_dwordx4 v[156:159], v79, s[20:23], 0 offen
    v_add_u32 v79, 262144, v79
    v_and_b32 v61, 7, v1
    v_bfe_u32 v65, v1, 3, 1
    v_lshlrev_b32 v65, 9, v65
    v_lshl_add_u32 v65, v66, 7, v65
    v_lshl_add_u32 v2, v61, 4, v65
    v_xor_b32 v61, 4, v61
    v_lshl_add_u32 v3, v61, 4, v65
    v_bfe_u32 v60, v1, 2, 2
    v_bfe_u32 v62, v1, 1, 1
    v_lshl_add_u32 v62, v66, 1, v62
    v_lshrrev_b32 v63, 1, v60
    v_lshlrev_b32 v64, 2, v63
    v_xor_b32 v62, v62, v64
    v_and_b32 v64, 1, v60
    v_lshl_add_u32 v62, v64, 3, v62
    v_lshlrev_b32 v62, 4, v62
    v_lshl_add_u32 v62, v63, 10, v62
    v_and_b32 v64, 1, v1
    v_lshl_add_u32 v62, v64, 3, v62
    v_add_u32 v4, s63, v62
    v_lshrrev_b32 v61, 5, v1
    v_mov_b32 v63, 32
    v_cmp_eq_u32 vcc, v60, v61
    v_add_u32 v61, 2, v61
    v_and_b32 v64, 3, v1
    v_cndmask_b32 v7, 0, v63, vcc
    v_cmp_eq_u32 vcc, v60, v61
    v_cmp_eq_u32 s[4:5], v64, v66
    v_mov_b32 v65, 8
    v_cndmask_b32 v8, 0, v63, vcc
    v_cndmask_b32 v10, 0, v65, s[4:5]
    v_lshrrev_b32 v68, 3, v0
    v_and_b32 v69, 7, v0
    v_lshlrev_b32 v69, 4, v69
    v_add_u32 v61, s54, v68
    s_movk_i32 s46, 8320
    v_mad_u32_u24 v64, v61, s46, v69
    s_lshl_b32 s45, s55, 7
    s_add_u32 s53, s45, 8388608
    v_add_u32 v64, s53, v64
    v_lshl_add_u32 v65, v61, 13, v69
    s_add_u32 s53, s45, 16777216
    v_add_u32 v65, s53, v65
    v_lshlrev_b32 v61, 4, v0
    s_mov_b32 s53, 110880
    v_lshl_add_u32 v67, v68, 2, s53
    s_waitcnt vmcnt(10)
    v_and_b32 v48, 255, v16
    v_subrev_u32 v48, s54, v48
    v_cmp_gt_u32 s[64:65], 64, v48
    v_lshl_add_u32 v60, v48, 2, s53
    s_mov_b64 exec, s[64:65]
    ds_add_rtn_u32 v53, v60, v58
    s_mov_b64 exec, -1
    v_and_b32 v49, 255, v17
    v_subrev_u32 v49, s54, v49
    v_cmp_gt_u32 s[66:67], 64, v49
    v_lshl_add_u32 v60, v49, 2, s53
    s_mov_b64 exec, s[66:67]
    ds_add_rtn_u32 v54, v60, v58
    s_mov_b64 exec, -1
    v_and_b32 v50, 255, v18
    v_subrev_u32 v50, s54, v50
    v_cmp_gt_u32 s[68:69], 64, v50
    v_lshl_add_u32 v60, v50, 2, s53
    s_mov_b64 exec, s[68:69]
    ds_add_rtn_u32 v55, v60, v58
    s_mov_b64 exec, -1
    v_and_b32 v51, 255, v19
    v_subrev_u32 v51, s54, v51
    v_cmp_gt_u32 s[70:71], 64, v51
    v_lshl_add_u32 v60, v51, 2, s53
    s_mov_b64 exec, s[70:71]
    ds_add_rtn_u32 v56, v60, v58
    s_mov_b64 exec, -1
    v_and_b32 v52, 255, v20
    v_subrev_u32 v52, s54, v52
    v_cmp_gt_u32 s[72:73], 64, v52
    v_lshl_add_u32 v60, v52, 2, s53
    s_and_b64 s[72:73], s[72:73], s[50:51]
    s_mov_b64 exec, s[72:73]
    ds_add_rtn_u32 v57, v60, v58
    s_mov_b64 exec, -1
    s_waitcnt vmcnt(7)
    v_readfirstlane_b32 s48, v42
    buffer_load_dwordx4 v[156:159], v79, s[20:23], 0 offen
    v_add_u32 v79, 262144, v79
    buffer_load_dwordx4 v[156:159], v79, s[20:23], 0 offen
    v_add_u32 v79, 262144, v79
    buffer_load_dwordx4 v[156:159], v79, s[20:23], 0 offen
    v_add_u32 v79, 262144, v79
    v_bfe_u32 v16, v16, 8, 6
    v_min_u32 v16, 47, v16
    v_min_u32 v24, 9999, v24
    v_lshl_or_b32 v16, v24, 6, v16
    v_add_u32 v24, 0, v43
    v_or_b32 v16, v16, v24
    v_lshlrev_b32 v48, 7, v48
    v_bfe_u32 v17, v17, 8, 6
    v_min_u32 v17, 47, v17
    v_min_u32 v25, 9999, v25
    v_lshl_or_b32 v17, v25, 6, v17
    v_add_u32 v25, 1048576, v43
    v_or_b32 v17, v17, v25
    v_lshlrev_b32 v49, 7, v49
    v_bfe_u32 v18, v18, 8, 6
    v_min_u32 v18, 47, v18
    v_min_u32 v26, 9999, v26
    v_lshl_or_b32 v18, v26, 6, v18
    v_add_u32 v26, 2097152, v43
    v_or_b32 v18, v18, v26
    v_lshlrev_b32 v50, 7, v50
    v_bfe_u32 v19, v19, 8, 6
    v_min_u32 v19, 47, v19
    v_min_u32 v27, 9999, v27
    v_lshl_or_b32 v19, v27, 6, v19
    v_add_u32 v27, 3145728, v43
    v_or_b32 v19, v19, v27
    v_lshlrev_b32 v51, 7, v51
    v_bfe_u32 v20, v20, 8, 6
    v_min_u32 v20, 47, v20
    v_min_u32 v28, 9999, v28
    v_lshl_or_b32 v20, v28, 6, v20
    v_add_u32 v28, 2147483648, v59
    v_or_b32 v20, v20, v28
    v_lshlrev_b32 v52, 7, v52
    v_mov_b32 v59, -2
    s_add_u32 s48, s48, 1
    s_movk_i32 s53, 7808
    s_waitcnt lgkmcnt(0)
    v_cmp_gt_u32 vcc, 31, v53
    v_min_u32 v53, 31, v53
    v_mul_u32_u24 v32, 43, v53
    v_cndmask_b32 v16, v59, v16, vcc
    v_lshrrev_b32 v32, 7, v32
    v_cmp_gt_u32 vcc, 24, v53
    v_add_lshl_u32 v32, v32, v53, 2
    v_lshl_add_u32 v33, v53, 4, s53
    v_cndmask_b32 v32, v33, v32, vcc
    v_add_u32 v48, v48, v32
    s_mov_b64 exec, s[64:65]
    ds_write_b32 v48, v16 offset:0
    s_mov_b64 exec, -1
    v_cmp_gt_u32 vcc, 31, v54
    v_min_u32 v54, 31, v54
    v_mul_u32_u24 v32, 43, v54
    v_cndmask_b32 v17, v59, v17, vcc
    v_lshrrev_b32 v32, 7, v32
    v_cmp_gt_u32 vcc, 24, v54
    v_add_lshl_u32 v32, v32, v54, 2
    v_lshl_add_u32 v33, v54, 4, s53
    v_cndmask_b32 v32, v33, v32, vcc
    v_add_u32 v49, v49, v32
    s_mov_b64 exec, s[66:67]
    ds_write_b32 v49, v17 offset:0
    s_mov_b64 exec, -1
    v_cmp_gt_u32 vcc, 31, v55
    v_min_u32 v55, 31, v55
    v_mul_u32_u24 v32, 43, v55
    v_cndmask_b32 v18, v59, v18, vcc
    v_lshrrev_b32 v32, 7, v32
    v_cmp_gt_u32 vcc, 24, v55
    v_add_lshl_u32 v32, v32, v55, 2
    v_lshl_add_u32 v33, v55, 4, s53
    v_cndmask_b32 v32, v33, v32, vcc
    v_add_u32 v50, v50, v32
    s_mov_b64 exec, s[68:69]
    ds_write_b32 v50, v18 offset:0
    s_mov_b64 exec, -1
    v_cmp_gt_u32 vcc, 31, v56
    v_min_u32 v56, 31, v56
    v_mul_u32_u24 v32, 43, v56
    v_cndmask_b32 v19, v59, v19, vcc
    v_lshrrev_b32 v32, 7, v32
    v_cmp_gt_u32 vcc, 24, v56
    v_add_lshl_u32 v32, v32, v56, 2
    v_lshl_add_u32 v33, v56, 4, s53
    v_cndmask_b32 v32, v33, v32, vcc
    v_add_u32 v51, v51, v32
    s_mov_b64 exec, s[70:71]
    ds_write_b32 v51, v19 offset:0
    s_mov_b64 exec, -1
    v_cmp_gt_u32 vcc, 31, v57
    v_min_u32 v57, 31, v57
    v_mul_u32_u24 v32, 43, v57
    v_cndmask_b32 v20, v59, v20, vcc
    v_lshrrev_b32 v32, 7, v32
    v_cmp_gt_u32 vcc, 24, v57
    v_add_lshl_u32 v32, v32, v57, 2
    v_lshl_add_u32 v33, v57, 4, s53
    v_cndmask_b32 v32, v33, v32, vcc
    v_add_u32 v52, v52, v32
    s_mov_b64 exec, s[72:73]
    ds_write_b32 v52, v20 offset:0
    s_mov_b64 exec, -1
    s_waitcnt lgkmcnt(0)
    s_barrier
    ds_read_b128 v[16:19], v61 offset:0
    ds_read_b32 v67, v67
    s_waitcnt lgkmcnt(1)
    v_mov_b32 v19, s48
    buffer_store_dwordx4 v[16:19], v64, s[32:35], 0 offen sc1
    s_waitcnt lgkmcnt(0)
    v_cmp_lt_u32 vcc, 23, v67
    s_cbranch_vccz L_noup
    ds_read_b128 v[28:31], v61 offset:8192
    s_waitcnt lgkmcnt(0)
    v_mov_b32 v31, s48
    s_mov_b64 exec, vcc
    buffer_store_dwordx4 v[28:31], v65, s[32:35], 0 offen sc1
    s_mov_b64 exec, -1
L_noup:
    s_cmp_ge_u32 s3, 2
    s_cbranch_scc1 L_nowf
    s_lshl1_add_u32 s44, s55, s3
    s_and_b32 s53, s44, 15
    s_lshl_b32 s53, s53, 13
    s_lshr_b32 s76, s44, 4
    s_lshl_b32 s76, s76, 6
    s_add_u32 s53, s53, s76
    v_lshrrev_b32 v60, 5, v1
    v_lshlrev_b32 v60, 12, v60
    v_and_b32 v61, 31, v1
    v_lshl_add_u32 v60, v61, 1, v60
    v_add_u32 v60, s53, v60
    buffer_load_ushort v32, v60, s[88:91], 0 offen offset:0
    buffer_load_ushort v33, v60, s[88:91], 0 offen offset:512
    buffer_load_ushort v34, v60, s[88:91], 0 offen offset:1024
    buffer_load_ushort v35, v60, s[88:91], 0 offen offset:1536
    buffer_load_ushort v36, v60, s[88:91], 0 offen offset:2048
    buffer_load_ushort v37, v60, s[88:91], 0 offen offset:2560
    buffer_load_ushort v38, v60, s[88:91], 0 offen offset:3072
    buffer_load_ushort v39, v60, s[88:91], 0 offen offset:3584
L_nowf:
    v_lshrrev_b32 v60, 5, v1
    v_bfe_u32 v61, v1, 2, 2
    v_bfe_u32 v62, v1, 4, 1
    v_and_b32 v63, 3, v1
    v_lshlrev_b32 v77, 12, v62
    v_lshl_add_u32 v77, v61, 9, v77
    v_lshl_add_u32 v77, v60, 5, v77
    v_lshl_add_u32 v77, v63, 3, v77
    s_mul_i32 s53, s2, 8320
    s_add_u32 s53, s53, 8388608
    v_lshl_add_u32 v70, v0, 4, s53
    s_lshl_b32 s53, s2, 13
    s_add_u32 s53, s53, 16777216
    v_lshl_add_u32 v71, v0, 4, s53
    v_mul_u32_u24 v73, 2500, v68
    v_mov_b64 v[80:81], 0
    v_mov_b64 v[82:83], 0
    v_mov_b64 v[84:85], 0
    v_mov_b64 v[86:87], 0
    v_mov_b64 v[88:89], 0
    v_mov_b64 v[90:91], 0
    v_mov_b64 v[92:93], 0
    v_mov_b64 v[94:95], 0
    v_mov_b64 v[96:97], 0
    v_mov_b64 v[98:99], 0
    v_mov_b64 v[100:101], 0
    v_mov_b64 v[102:103], 0
    v_mov_b64 v[104:105], 0
    v_mov_b64 v[106:107], 0
    v_mov_b64 v[108:109], 0
    v_mov_b64 v[110:111], 0
    v_mov_b64 v[112:113], 0
    v_mov_b64 v[114:115], 0
    v_mov_b64 v[116:117], 0
    v_mov_b64 v[118:119], 0
    v_mov_b64 v[120:121], 0
    v_mov_b64 v[122:123], 0
    v_mov_b64 v[124:125], 0
    v_mov_b64 v[126:127], 0
    v_mov_b64 v[128:129], 0
    v_mov_b64 v[130:131], 0
    v_mov_b64 v[132:133], 0
    v_mov_b64 v[134:135], 0
    v_mov_b64 v[136:137], 0
    v_mov_b64 v[138:139], 0
    v_mov_b64 v[140:141], 0
    v_mov_b64 v[142:143], 0
    v_mov_b64 v[144:145], 0
    v_mov_b64 v[146:147], 0
    v_mov_b64 v[148:149], 0
    v_mov_b64 v[150:151], 0
    v_mov_b64 v[152:153], 0
    v_mov_b64 v[154:155], 0
    s_mov_b64 s[6:7], -1
    s_mov_b32 s55, 0
    s_waitcnt vmcnt(0)
L_poll:
    s_mov_b64 exec, s[6:7]
    buffer_load_dwordx4 v[48:51], v70, s[32:35], 0 offen sc1
    s_mov_b64 exec, -1
    s_waitcnt vmcnt(0)
    v_cmp_ne_u32 s[6:7], s48, v51
    s_cmp_eq_u64 s[6:7], 0
    s_cbranch_scc1 L_got
    s_sleep 4
    s_add_u32 s55, s55, 1
    s_cmp_lt_u32 s55, 0x400000
    s_cbranch_scc1 L_poll
    s_endpgm
L_got:
    v_cmp_gt_u32 s[36:37], -2, v48
    v_cmp_gt_u32 s[38:39], -2, v49
    v_cmp_gt_u32 s[40:41], -2, v50
    v_mov_b32 v52, -1
    s_mov_b64 s[42:43], 0
    s_mov_b32 s53, 0x80808080
    s_and_b32 s6, s40, s53
    s_and_b32 s7, s41, s53
    s_cmp_eq_u64 s[6:7], 0
    s_cbranch_scc1 L_noext
    s_lshr_b64 s[6:7], s[6:7], 7
    s_mul_i32 s6, s6, 255
    s_mul_i32 s7, s7, 255
    v_mov_b32 v55, s48
L_poll2:
    s_mov_b64 exec, s[6:7]
    buffer_load_dwordx4 v[52:55], v71, s[32:35], 0 offen sc1
    s_mov_b64 exec, -1
    s_waitcnt vmcnt(0)
    v_cmp_ne_u32 vcc, s48, v55
    s_cbranch_vccz L_got2
    s_sleep 1
    s_add_u32 s55, s55, 1
    s_cmp_lt_u32 s55, 0x400000
    s_cbranch_scc1 L_poll2
    s_endpgm
L_got2:
    v_cmp_gt_u32 s[42:43], -2, v52
L_noext:
    v_cmp_eq_u32 vcc, -2, v52
    s_bcnt1_i32_b64 s64, s[36:37]
    s_bcnt1_i32_b64 s65, s[38:39]
    s_bcnt1_i32_b64 s66, s[40:41]
    s_bcnt1_i32_b64 s67, s[42:43]
    s_add_u32 s65, s65, s64
    s_add_u32 s66, s66, s65
    s_add_u32 s79, s67, s66
    v_mov_b32 v61, s79
    v_mov_b32 v60, 114912
    s_mov_b64 exec, 1
    ds_add_rtn_u32 v61, v60, v61
    s_mov_b64 exec, -1
    v_mbcnt_lo_u32_b32 v62, s36, 0
    v_mbcnt_hi_u32_b32 v62, s37, v62
    v_lshrrev_b32 v20, 20, v48
    v_add_u32 v20, v20, v73
    v_lshl_add_u32 v66, v62, 2, s49
    s_mov_b64 exec, s[36:37]
    ds_write_b32 v66, v20
    s_mov_b64 exec, -1
    v_lshlrev_b32 v24, 2, v48
    v_and_b32 v24, s82, v24
    v_and_b32 v16, 63, v48
    v_mbcnt_lo_u32_b32 v63, s38, 0
    v_mbcnt_hi_u32_b32 v63, s39, v63
    v_add_u32 v63, s64, v63
    v_lshrrev_b32 v21, 20, v49
    v_add_u32 v21, v21, v73
    v_lshl_add_u32 v66, v63, 2, s49
    s_mov_b64 exec, s[38:39]
    ds_write_b32 v66, v21
    s_mov_b64 exec, -1
    v_lshlrev_b32 v25, 2, v49
    v_and_b32 v25, s82, v25
    v_and_b32 v17, 63, v49
    v_mbcnt_lo_u32_b32 v64, s40, 0
    v_mbcnt_hi_u32_b32 v64, s41, v64
    v_add_u32 v64, s65, v64
    v_lshrrev_b32 v22, 20, v50
    v_add_u32 v22, v22, v73
    v_lshl_add_u32 v66, v64, 2, s49
    s_mov_b64 exec, s[40:41]
    ds_write_b32 v66, v22
    s_mov_b64 exec, -1
    v_lshlrev_b32 v26, 2, v50
    v_and_b32 v26, s82, v26
    v_and_b32 v18, 63, v50
    v_mbcnt_lo_u32_b32 v65, s42, 0
    v_mbcnt_hi_u32_b32 v65, s43, v65
    v_add_u32 v65, s66, v65
    v_lshrrev_b32 v23, 20, v52
    v_add_u32 v23, v23, v73
    v_lshl_add_u32 v66, v65, 2, s49
    s_mov_b64 exec, s[42:43]
    ds_write_b32 v66, v23
    s_mov_b64 exec, -1
    v_lshlrev_b32 v27, 2, v52
    v_and_b32 v27, s82, v27
    v_and_b32 v19, 63, v52
    v_lshl_or_b32 v14, v45, 16, v44
    v_lshl_or_b32 v15, v47, 16, v46
    v_mov_b64 v[156:157], 0
    v_mov_b64 v[158:159], 0
    s_cmp_ge_u32 s3, 2
    s_cbranch_scc1 L_1
    v_lshl_or_b32 v56, v33, 16, v32
    v_lshl_or_b32 v57, v35, 16, v34
    v_lshl_or_b32 v58, v37, 16, v36
    v_lshl_or_b32 v59, v39, 16, v38
    s_lshl_b32 s53, s54, 1
    s_add_u32 s53, s53, s44
    s_lshl2_add_u32 s83, s53, 4096
    s_lshl_b32 s53, s53, 10
    s_add_u32 s53, s53, 1048576
    v_lshl_add_u32 v60, v1, 4, s53
    buffer_store_dwordx4 v[56:59], v60, s[32:35], 0 offen sc1
L_1:
    s_mov_b32 s80, 79
    s_waitcnt lgkmcnt(0)
    v_readfirstlane_b32 s44, v61
    s_cbranch_vccnz L_defer
    s_add_u32 s53, s44, s79
    s_cmp_gt_u32 s53, 1024
    s_cbranch_scc1 L_defer
    v_add_u32 v62, s44, v62
    v_lshl_or_b32 v24, v62, 22, v24
    v_add_u32 v63, s44, v63
    v_lshl_or_b32 v25, v63, 22, v25
    v_add_u32 v64, s44, v64
    v_lshl_or_b32 v26, v64, 22, v26
    v_add_u32 v65, s44, v65
    v_lshl_or_b32 v27, v65, 22, v27
    s_branch L_have
L_defer:
    s_mov_b32 s80, 0
    s_mov_b32 s79, 0
    s_mov_b32 s44, 0
    s_mov_b64 s[36:37], 0
    s_mov_b64 s[38:39], 0
    s_mov_b64 s[40:41], 0
    s_mov_b64 s[42:43], 0
    v_mov_b32 v58, 1
    v_mov_b32 v59, 110864
    ds_write_b32 v59, v58
    s_branch L_have
L_scan:
    s_barrier
    s_mov_b32 s64, s63
    s_add_u32 s65, s63, 1024
    s_xor_b32 s47, s2, 1
L_sloop:
    s_cmp_ge_u32 s80, 79
    s_cbranch_scc1 L_scan_done
    s_mul_i32 s53, s3, 20000
    s_lshl_b32 s54, s80, 8
    s_add_u32 s55, s53, s54
    v_lshlrev_b32 v56, 2, v1
    v_add_u32 v56, s55, v56
    v_lshlrev_b32 v57, 2, v56
    buffer_load_dwordx4 v[60:63], v57, s[16:19], 0 offen
    s_waitcnt vmcnt(0)
    s_cmp_lg_u32 s80, 78
    s_cbranch_scc1 L_snotlast
    s_mov_b32 exec_lo, 0xffffff00
    v_mov_b32 v60, s47
    v_mov_b32 v61, s47
    v_mov_b32 v62, s47
    v_mov_b32 v63, s47
    s_mov_b64 exec, -1
L_snotlast:
    s_cmp_gt_u32 s52, 0
    s_cbranch_scc1 L_2
    v_cmp_eq_u32_sdwa vcc, v60, s2 src0_sel:BYTE_0 src1_sel:DWORD
    s_cbranch_vccz L_2
    s_bcnt1_i32_b64 s53, vcc
    s_lshl3_add_u32 s54, s53, s64
    s_mov_b32 s52, 0
    s_cmp_gt_u32 s54, s65
    s_cbranch_scc1 L_ovf
    v_mbcnt_lo_u32_b32 v58, vcc_lo, 0
    v_mbcnt_hi_u32_b32 v58, vcc_hi, v58
    v_lshl_add_u32 v58, v58, 3, s64
    v_add_u32 v59, 0, v56
    s_mov_b64 exec, vcc
    ds_write2_b32 v58, v60, v59 offset0:0 offset1:1
    s_mov_b64 exec, -1
    s_mov_b32 s64, s54
L_2:
    s_cmp_gt_u32 s52, 1
    s_cbranch_scc1 L_3
    v_cmp_eq_u32_sdwa vcc, v61, s2 src0_sel:BYTE_0 src1_sel:DWORD
    s_cbranch_vccz L_3
    s_bcnt1_i32_b64 s53, vcc
    s_lshl3_add_u32 s54, s53, s64
    s_mov_b32 s52, 1
    s_cmp_gt_u32 s54, s65
    s_cbranch_scc1 L_ovf
    v_mbcnt_lo_u32_b32 v58, vcc_lo, 0
    v_mbcnt_hi_u32_b32 v58, vcc_hi, v58
    v_lshl_add_u32 v58, v58, 3, s64
    v_add_u32 v59, 1, v56
    s_mov_b64 exec, vcc
    ds_write2_b32 v58, v61, v59 offset0:0 offset1:1
    s_mov_b64 exec, -1
    s_mov_b32 s64, s54
L_3:
    s_cmp_gt_u32 s52, 2
    s_cbranch_scc1 L_4
    v_cmp_eq_u32_sdwa vcc, v62, s2 src0_sel:BYTE_0 src1_sel:DWORD
    s_cbranch_vccz L_4
    s_bcnt1_i32_b64 s53, vcc
    s_lshl3_add_u32 s54, s53, s64
    s_mov_b32 s52, 2
    s_cmp_gt_u32 s54, s65
    s_cbranch_scc1 L_ovf
    v_mbcnt_lo_u32_b32 v58, vcc_lo, 0
    v_mbcnt_hi_u32_b32 v58, vcc_hi, v58
    v_lshl_add_u32 v58, v58, 3, s64
    v_add_u32 v59, 2, v56
    s_mov_b64 exec, vcc
    ds_write2_b32 v58, v62, v59 offset0:0 offset1:1
    s_mov_b64 exec, -1
    s_mov_b32 s64, s54
L_4:
    s_cmp_gt_u32 s52, 3
    s_cbranch_scc1 L_5
    v_cmp_eq_u32_sdwa vcc, v63, s2 src0_sel:BYTE_0 src1_sel:DWORD
    s_cbranch_vccz L_5
    s_bcnt1_i32_b64 s53, vcc
    s_lshl3_add_u32 s54, s53, s64
    s_mov_b32 s52, 3
    s_cmp_gt_u32 s54, s65
    s_cbranch_scc1 L_ovf
    v_mbcnt_lo_u32_b32 v58, vcc_lo, 0
    v_mbcnt_hi_u32_b32 v58, vcc_hi, v58
    v_lshl_add_u32 v58, v58, 3, s64
    v_add_u32 v59, 3, v56
    s_mov_b64 exec, vcc
    ds_write2_b32 v58, v63, v59 offset0:0 offset1:1
    s_mov_b64 exec, -1
    s_mov_b32 s64, s54
L_5:
    s_mov_b32 s52, 0
    s_add_u32 s80, s80, 1
    s_branch L_sloop
L_ovf:
    v_mov_b32 v58, 1
    v_mov_b32 v59, 110864
    ds_write_b32 v59, v58
L_scan_done:
    s_sub_u32 s79, s64, s63
    s_lshr_b32 s79, s79, 3
    s_lshl_b32 s44, s3, 7
    v_lshlrev_b32 v58, 3, v1
    v_add_u32 v58, s63, v58
    s_waitcnt lgkmcnt(0)
    ds_read_b32 v16, v58 offset:0
    ds_read_b32 v20, v58 offset:4
    s_sub_u32 s53, s79, 0
    v_cmp_gt_i32 s[36:37], s53, v1
    ds_read_b32 v17, v58 offset:512
    ds_read_b32 v21, v58 offset:516
    s_sub_u32 s53, s79, 64
    v_cmp_gt_i32 s[38:39], s53, v1
    s_mov_b64 s[40:41], 0
    v_mov_b32 v18, 0
    v_mov_b32 v26, 0
    s_mov_b64 s[42:43], 0
    v_mov_b32 v19, 0
    v_mov_b32 v27, 0
    v_lshl_add_u32 v58, v1, 2, s49
    v_add_u32 v59, s44, v1
    v_lshlrev_b32 v59, 22, v59
    s_waitcnt lgkmcnt(0)
    v_lshlrev_b32 v28, 2, v20
    buffer_load_dword v24, v28, s[12:15], 0 offen
    v_bfe_u32 v16, v16, 8, 6
    v_min_u32 v16, 47, v16
    ds_write_b32 v58, v20 offset:0
    v_lshlrev_b32 v29, 2, v21
    buffer_load_dword v25, v29, s[12:15], 0 offen
    v_bfe_u32 v17, v17, 8, 6
    v_min_u32 v17, 47, v17
    ds_write_b32 v58, v21 offset:256
    s_waitcnt vmcnt(0)
    v_min_u32 v24, 9999, v24
    v_lshl_or_b32 v24, v24, 8, v59
    v_add_u32 v59, 268435456, v59
    v_min_u32 v25, 9999, v25
    v_lshl_or_b32 v25, v25, 8, v59
    v_add_u32 v59, 268435456, v59
L_have:
    v_mov_b32 v58, 1
    s_mov_b32 s53, 111136
    s_mov_b32 s54, 114976
    v_bfe_u32 v28, v24, 8, 14
    v_mul_u32_u24 v28, 6711, v28
    v_lshrrev_b32 v28, 22, v28
    v_min_u32 v28, 15, v28
    v_lshl_add_u32 v28, v28, 2, s53
    v_lshl_add_u32 v28, v16, 6, v28
    v_lshl_add_u32 v16, v16, 2, s54
    s_mov_b64 exec, s[36:37]
    ds_add_rtn_u32 v32, v28, v58
    ds_add_u32 v16, v58
    s_mov_b64 exec, -1
    v_bfe_u32 v29, v25, 8, 14
    v_mul_u32_u24 v29, 6711, v29
    v_lshrrev_b32 v29, 22, v29
    v_min_u32 v29, 15, v29
    v_lshl_add_u32 v29, v29, 2, s53
    v_lshl_add_u32 v29, v17, 6, v29
    v_lshl_add_u32 v17, v17, 2, s54
    s_mov_b64 exec, s[38:39]
    ds_add_rtn_u32 v33, v29, v58
    ds_add_u32 v17, v58
    s_mov_b64 exec, -1
    v_bfe_u32 v30, v26, 8, 14
    v_mul_u32_u24 v30, 6711, v30
    v_lshrrev_b32 v30, 22, v30
    v_min_u32 v30, 15, v30
    v_lshl_add_u32 v30, v30, 2, s53
    v_lshl_add_u32 v30, v18, 6, v30
    v_lshl_add_u32 v18, v18, 2, s54
    s_mov_b64 exec, s[40:41]
    ds_add_rtn_u32 v34, v30, v58
    ds_add_u32 v18, v58
    s_mov_b64 exec, -1
    v_bfe_u32 v31, v27, 8, 14
    v_mul_u32_u24 v31, 6711, v31
    v_lshrrev_b32 v31, 22, v31
    v_min_u32 v31, 15, v31
    v_lshl_add_u32 v31, v31, 2, s53
    v_lshl_add_u32 v31, v19, 6, v31
    v_lshl_add_u32 v19, v19, 2, s54
    s_mov_b64 exec, s[42:43]
    ds_add_rtn_u32 v35, v31, v58
    ds_add_u32 v19, v58
    s_mov_b64 exec, -1
    v_lshrrev_b32 v36, 1, v1
    v_lshl_add_u32 v39, v36, 2, s49
    ds_read_b32 v40, v39 offset:0
    ds_read_b32 v41, v39 offset:128
    ds_read_b32 v42, v39 offset:256
    ds_read_b32 v43, v39 offset:384
    v_and_b32 v38, 1, v1
    v_lshlrev_b32 v37, 4, v38
    v_lshlrev_b32 v38, 2, v38
    s_mov_b32 s46, s79
    s_mov_b32 s45, s44
    v_lshl_add_u32 v56, v1, 2, s54
    v_mov_b32 v57, 110864
    s_waitcnt lgkmcnt(0)
    s_cmp_le_i32 s46, 0
    s_cbranch_scc1 L_6
    v_lshl_add_u32 v44, v40, 5, v37
    v_lshl_add_u32 v45, v40, 3, v38
    v_cmp_gt_i32 vcc, s46, v36
    s_lshl_b32 s76, s45, 5
    s_add_u32 m0, s76, 65536
    s_mov_b64 exec, vcc
    buffer_load_dwordx4 v44, s[24:27], 0 offen lds
    s_lshl3_add_u32 m0, s45, 98304
    s_add_u32 s45, s45, 32
    buffer_load_dword v45, s[20:23], 0 offen lds
    s_mov_b64 exec, -1
    s_sub_i32 s46, s46, 32
L_6:
    s_barrier
    ds_read_b32 v56, v56
    ds_read_b32 v57, v57
    s_cmp_le_i32 s46, 0
    s_cbranch_scc1 L_7
    v_lshl_add_u32 v44, v41, 5, v37
    v_lshl_add_u32 v45, v41, 3, v38
    v_cmp_gt_i32 vcc, s46, v36
    s_lshl_b32 s76, s45, 5
    s_add_u32 m0, s76, 65536
    s_mov_b64 exec, vcc
    buffer_load_dwordx4 v44, s[24:27], 0 offen lds
    s_lshl3_add_u32 m0, s45, 98304
    s_add_u32 s45, s45, 32
    buffer_load_dword v45, s[20:23], 0 offen lds
    s_mov_b64 exec, -1
    s_sub_i32 s46, s46, 32
L_7:
    s_waitcnt lgkmcnt(0)
    v_readfirstlane_b32 s78, v57
    s_cmp_lg_u32 s77, 0
    s_cbranch_scc1 L_assigned
    ds_read_b64_tr_b16 a[0:1], v77 offset:32768
    ds_read_b64_tr_b16 a[2:3], v77 offset:34816
    ds_read_b64_tr_b16 a[4:5], v77 offset:32832
    ds_read_b64_tr_b16 a[6:7], v77 offset:34880
    ds_read_b64_tr_b16 a[8:9], v77 offset:32896
    ds_read_b64_tr_b16 a[10:11], v77 offset:34944
    ds_read_b64_tr_b16 a[12:13], v77 offset:32960
    ds_read_b64_tr_b16 a[14:15], v77 offset:35008
    ds_read_b64_tr_b16 a[16:17], v77 offset:33024
    ds_read_b64_tr_b16 a[18:19], v77 offset:35072
    ds_read_b64_tr_b16 a[20:21], v77 offset:33088
    ds_read_b64_tr_b16 a[22:23], v77 offset:35136
    ds_read_b64_tr_b16 a[24:25], v77 offset:33152
    ds_read_b64_tr_b16 a[26:27], v77 offset:35200
    ds_read_b64_tr_b16 a[28:29], v77 offset:33216
    ds_read_b64_tr_b16 a[30:31], v77 offset:35264
    s_and_b32 s53, s2, 63
    s_or_b32 s53, s53, s3
    s_cbranch_scc1 L_8
    s_lshl_b32 s53, s2, 1
    v_mov_b32 v60, s53
    v_mov_b32 v61, s48
    s_mov_b64 exec, 1
    buffer_store_dword v61, v60, s[32:35], 0 offen sc1
    s_mov_b64 exec, -1
L_8:
    v_sub_u32 v57, 63, v1
    v_lshl_add_u32 v57, v56, 6, v57
    v_mov_b32 v59, 0
    v_readlane_b32 s84, v57, 0
    v_readlane_b32 s85, v57, 1
    v_readlane_b32 s86, v57, 2
    v_readlane_b32 s87, v57, 3
    v_readlane_b32 s88, v57, 4
    v_readlane_b32 s89, v57, 5
    v_readlane_b32 s90, v57, 6
    v_readlane_b32 s91, v57, 7
    v_readlane_b32 s92, v57, 8
    v_readlane_b32 s93, v57, 9
    v_readlane_b32 s94, v57, 10
    v_readlane_b32 s95, v57, 11
    v_readlane_b32 s96, v57, 12
    v_readlane_b32 s97, v57, 13
    v_readlane_b32 s98, v57, 14
    v_readlane_b32 s99, v57, 15
    v_cmp_gt_u32 vcc, s84, v57
    v_cmp_gt_u32 s[4:5], s85, v57
    v_cmp_gt_u32 s[6:7], s86, v57
    v_addc_co_u32 v59, vcc, 0, v59, vcc
    v_addc_co_u32 v59, s[4:5], 0, v59, s[4:5]
    v_addc_co_u32 v59, s[6:7], 0, v59, s[6:7]
    v_cmp_gt_u32 vcc, s87, v57
    v_cmp_gt_u32 s[4:5], s88, v57
    v_cmp_gt_u32 s[6:7], s89, v57
    v_addc_co_u32 v59, vcc, 0, v59, vcc
    v_addc_co_u32 v59, s[4:5], 0, v59, s[4:5]
    v_addc_co_u32 v59, s[6:7], 0, v59, s[6:7]
    v_cmp_gt_u32 vcc, s90, v57
    v_cmp_gt_u32 s[4:5], s91, v57
    v_cmp_gt_u32 s[6:7], s92, v57
    v_addc_co_u32 v59, vcc, 0, v59, vcc
    v_addc_co_u32 v59, s[4:5], 0, v59, s[4:5]
    v_addc_co_u32 v59, s[6:7], 0, v59, s[6:7]
    v_cmp_gt_u32 vcc, s93, v57
    v_cmp_gt_u32 s[4:5], s94, v57
    v_cmp_gt_u32 s[6:7], s95, v57
    v_addc_co_u32 v59, vcc, 0, v59, vcc
    v_addc_co_u32 v59, s[4:5], 0, v59, s[4:5]
    v_addc_co_u32 v59, s[6:7], 0, v59, s[6:7]
    v_cmp_gt_u32 vcc, s96, v57
    v_cmp_gt_u32 s[4:5], s97, v57
    v_cmp_gt_u32 s[6:7], s98, v57
    v_addc_co_u32 v59, vcc, 0, v59, vcc
    v_addc_co_u32 v59, s[4:5], 0, v59, s[4:5]
    v_addc_co_u32 v59, s[6:7], 0, v59, s[6:7]
    v_cmp_gt_u32 vcc, s99, v57
    s_nop 1
    v_addc_co_u32 v59, vcc, 0, v59, vcc
    v_readlane_b32 s84, v57, 16
    v_readlane_b32 s85, v57, 17
    v_readlane_b32 s86, v57, 18
    v_readlane_b32 s87, v57, 19
    v_readlane_b32 s88, v57, 20
    v_readlane_b32 s89, v57, 21
    v_readlane_b32 s90, v57, 22
    v_readlane_b32 s91, v57, 23
    v_readlane_b32 s92, v57, 24
    v_readlane_b32 s93, v57, 25
    v_readlane_b32 s94, v57, 26
    v_readlane_b32 s95, v57, 27
    v_readlane_b32 s96, v57, 28
    v_readlane_b32 s97, v57, 29
    v_readlane_b32 s98, v57, 30
    v_readlane_b32 s99, v57, 31
    v_cmp_gt_u32 vcc, s84, v57
    v_cmp_gt_u32 s[4:5], s85, v57
    v_cmp_gt_u32 s[6:7], s86, v57
    v_addc_co_u32 v59, vcc, 0, v59, vcc
    v_addc_co_u32 v59, s[4:5], 0, v59, s[4:5]
    v_addc_co_u32 v59, s[6:7], 0, v59, s[6:7]
    v_cmp_gt_u32 vcc, s87, v57
    v_cmp_gt_u32 s[4:5], s88, v57
    v_cmp_gt_u32 s[6:7], s89, v57
    v_addc_co_u32 v59, vcc, 0, v59, vcc
    v_addc_co_u32 v59, s[4:5], 0, v59, s[4:5]
    v_addc_co_u32 v59, s[6:7], 0, v59, s[6:7]
    v_cmp_gt_u32 vcc, s90, v57
    v_cmp_gt_u32 s[4:5], s91, v57
    v_cmp_gt_u32 s[6:7], s92, v57
    v_addc_co_u32 v59, vcc, 0, v59, vcc
    v_addc_co_u32 v59, s[4:5], 0, v59, s[4:5]
    v_addc_co_u32 v59, s[6:7], 0, v59, s[6:7]
    v_cmp_gt_u32 vcc, s93, v57
    v_cmp_gt_u32 s[4:5], s94, v57
    v_cmp_gt_u32 s[6:7], s95, v57
    v_addc_co_u32 v59, vcc, 0, v59, vcc
    v_addc_co_u32 v59, s[4:5], 0, v59, s[4:5]
    v_addc_co_u32 v59, s[6:7], 0, v59, s[6:7]
    v_cmp_gt_u32 vcc, s96, v57
    v_cmp_gt_u32 s[4:5], s97, v57
    v_cmp_gt_u32 s[6:7], s98, v57
    v_addc_co_u32 v59, vcc, 0, v59, vcc
    v_addc_co_u32 v59, s[4:5], 0, v59, s[4:5]
    v_addc_co_u32 v59, s[6:7], 0, v59, s[6:7]
    v_cmp_gt_u32 vcc, s99, v57
    s_nop 1
    v_addc_co_u32 v59, vcc, 0, v59, vcc
    v_readlane_b32 s84, v57, 32
    v_readlane_b32 s85, v57, 33
    v_readlane_b32 s86, v57, 34
    v_readlane_b32 s87, v57, 35
    v_readlane_b32 s88, v57, 36
    v_readlane_b32 s89, v57, 37
    v_readlane_b32 s90, v57, 38
    v_readlane_b32 s91, v57, 39
    v_cmp_gt_u32 vcc, s84, v57
    v_cmp_gt_u32 s[4:5], s85, v57
    v_cmp_gt_u32 s[6:7], s86, v57
    v_addc_co_u32 v59, vcc, 0, v59, vcc
    v_addc_co_u32 v59, s[4:5], 0, v59, s[4:5]
    v_addc_co_u32 v59, s[6:7], 0, v59, s[6:7]
    v_cmp_gt_u32 vcc, s87, v57
    v_cmp_gt_u32 s[4:5], s88, v57
    v_cmp_gt_u32 s[6:7], s89, v57
    v_addc_co_u32 v59, vcc, 0, v59, vcc
    v_addc_co_u32 v59, s[4:5], 0, v59, s[4:5]
    v_addc_co_u32 v59, s[6:7], 0, v59, s[6:7]
    v_cmp_gt_u32 vcc, s90, v57
    v_cmp_gt_u32 s[4:5], s91, v57
    s_nop 0
    v_addc_co_u32 v59, vcc, 0, v59, vcc
    v_addc_co_u32 v59, s[4:5], 0, v59, s[4:5]
    v_bfe_u32 v60, v59, 3, 1
    v_mul_u32_u24 v60, 7, v60
    v_and_b32 v61, 7, v59
    v_xor_b32 v11, v60, v61
    s_sub_u32 s53, 7, s3
    s_add_u32 s54, s3, 0
    v_cmp_eq_u32 vcc, s54, v59
    s_ff1_i32_b64 s56, vcc
    s_add_u32 s54, s53, 8
    v_cmp_eq_u32 vcc, s54, v59
    s_ff1_i32_b64 s57, vcc
    s_add_u32 s54, s3, 16
    v_cmp_eq_u32 vcc, s54, v59
    s_ff1_i32_b64 s58, vcc
    s_add_u32 s54, s53, 24
    v_cmp_eq_u32 vcc, s54, v59
    s_ff1_i32_b64 s59, vcc
    s_add_u32 s54, s3, 32
    v_cmp_eq_u32 vcc, s54, v59
    s_ff1_i32_b64 s60, vcc
L_assigned:
    v_cmp_gt_u32 vcc, s3, v11
    v_and_b32 v61, 15, v1
    v_lshlrev_b32 v61, 2, v61
    v_cndmask_b32 v60, 0, v56, vcc
    v_add_u32 v61, 111136, v61
    s_lshl_b32 s84, s56, 6
    v_add_u32 v64, s84, v61
    ds_read_b32 v70, v64
    s_lshl_b32 s85, s57, 6
    v_add_u32 v65, s85, v61
    ds_read_b32 v71, v65
    s_lshl_b32 s86, s58, 6
    v_add_u32 v66, s86, v61
    ds_read_b32 v72, v66
    s_lshl_b32 s87, s59, 6
    v_add_u32 v67, s87, v61
    ds_read_b32 v73, v67
    s_lshl_b32 s88, s60, 6
    v_add_u32 v68, s88, v61
    ds_read_b32 v74, v68
    v_add_u32_dpp v60, v60, v60 row_shr:1 row_mask:0xf bank_mask:0xf bound_ctrl:1
    v_readlane_b32 s92, v56, s56
    s_nop 0
    v_add_u32_dpp v60, v60, v60 row_shr:2 row_mask:0xf bank_mask:0xf bound_ctrl:1
    v_readlane_b32 s93, v56, s57
    s_nop 0
    v_add_u32_dpp v60, v60, v60 row_shr:4 row_mask:0xf bank_mask:0xf bound_ctrl:1
    v_readlane_b32 s94, v56, s58
    s_nop 0
    v_add_u32_dpp v60, v60, v60 row_shr:8 row_mask:0xf bank_mask:0xf bound_ctrl:1
    v_readlane_b32 s95, v56, s59
    s_nop 0
    v_readlane_b32 s96, v56, s60
    v_readlane_b32 s61, v60, 15
    v_readlane_b32 s53, v60, 31
    v_readlane_b32 s54, v60, 47
    s_add_u32 s62, s92, s93
    s_add_u32 s62, s62, s94
    s_add_u32 s62, s62, s95
    s_add_u32 s62, s62, s96
    s_add_u32 s61, s61, s53
    s_add_u32 s61, s61, s54
    s_add_u32 s61, s61, 3
    s_andn2_b32 s61, s61, 3
    s_lshl2_add_u32 s61, s3, s61
    s_waitcnt lgkmcnt(0)
    v_add3_u32 v60, v70, v71, v72
    v_add3_u32 v60, v60, v73, v74
    v_mov_b32 v61, v60
    s_nop 1
    v_add_u32_dpp v61, v61, v61 row_shr:1 row_mask:0xf bank_mask:0xf bound_ctrl:1
    s_nop 1
    v_add_u32_dpp v61, v61, v61 row_shr:2 row_mask:0xf bank_mask:0xf bound_ctrl:1
    s_nop 1
    v_add_u32_dpp v61, v61, v61 row_shr:4 row_mask:0xf bank_mask:0xf bound_ctrl:1
    s_nop 1
    v_add_u32_dpp v61, v61, v61 row_shr:8 row_mask:0xf bank_mask:0xf bound_ctrl:1
    v_sub_u32 v61, v61, v60
    v_add_u32 v61, s61, v61
    v_lshl_add_u32 v75, v61, 8, 0
    ds_write_b32 v64, v75 offset:4096
    v_add_u32 v61, v61, v70
    v_lshl_add_u32 v76, v61, 8, 16
    ds_write_b32 v65, v76 offset:4096
    v_add_u32 v61, v61, v71
    v_lshl_add_u32 v77, v61, 8, 32
    ds_write_b32 v66, v77 offset:4096
    v_add_u32 v61, v61, v72
    v_lshl_add_u32 v78, v61, 8, 48
    ds_write_b32 v67, v78 offset:4096
    v_add_u32 v61, v61, v73
    v_lshl_add_u32 v79, v61, 8, 64
    ds_write_b32 v68, v79 offset:4096
    s_cmp_le_i32 s46, 0
    s_cbranch_scc1 L_9
    v_lshl_add_u32 v44, v42, 5, v37
    v_lshl_add_u32 v45, v42, 3, v38
    v_cmp_gt_i32 vcc, s46, v36
    s_lshl_b32 s76, s45, 5
    s_add_u32 m0, s76, 65536
    s_mov_b64 exec, vcc
    buffer_load_dwordx4 v44, s[24:27], 0 offen lds
    s_lshl3_add_u32 m0, s45, 98304
    s_add_u32 s45, s45, 32
    buffer_load_dword v45, s[20:23], 0 offen lds
    s_mov_b64 exec, -1
    s_sub_i32 s46, s46, 32
L_9:
    s_waitcnt lgkmcnt(0)
    s_barrier
    ds_read_b32 v16, v28 offset:4096
    ds_read_b32 v17, v29 offset:4096
    ds_read_b32 v18, v30 offset:4096
    ds_read_b32 v19, v31 offset:4096
    v_mov_b32 v60, 0
    v_mov_b32 v61, 0
    v_lshlrev_b32 v64, 3, v0
    v_add_u32 v64, 111136, v64
    ds_write_b64 v64, v[60:61]
    v_mov_b32 v64, 110864
    ds_write_b32 v64, v60
    s_mov_b32 s53, 106496
    s_movk_i32 s54, 255
    s_waitcnt lgkmcnt(2)
    v_lshrrev_b32 v28, 8, v16
    v_add_u32 v28, v28, v32
    v_and_or_b32 v16, v16, s54, v24
    v_lshl_add_u32 v28, v28, 2, s53
    s_mov_b64 exec, s[36:37]
    ds_write_b32 v28, v16
    s_mov_b64 exec, -1
    v_lshrrev_b32 v29, 8, v17
    v_add_u32 v29, v29, v33
    v_and_or_b32 v17, v17, s54, v25
    v_lshl_add_u32 v29, v29, 2, s53
    s_mov_b64 exec, s[38:39]
    ds_write_b32 v29, v17
    s_mov_b64 exec, -1
    v_lshrrev_b32 v30, 8, v18
    v_add_u32 v30, v30, v34
    v_and_or_b32 v18, v18, s54, v26
    v_lshl_add_u32 v30, v30, 2, s53
    s_mov_b64 exec, s[40:41]
    ds_write_b32 v30, v18
    s_mov_b64 exec, -1
    v_lshrrev_b32 v31, 8, v19
    v_add_u32 v31, v31, v35
    v_and_or_b32 v19, v19, s54, v27
    v_lshl_add_u32 v31, v31, 2, s53
    s_mov_b64 exec, s[42:43]
    ds_write_b32 v31, v19
    s_mov_b64 exec, -1
    s_cmp_le_i32 s46, 0
    s_cbranch_scc1 L_10
    v_lshl_add_u32 v44, v43, 5, v37
    v_lshl_add_u32 v45, v43, 3, v38
    v_cmp_gt_i32 vcc, s46, v36
    s_lshl_b32 s76, s45, 5
    s_add_u32 m0, s76, 65536
    s_mov_b64 exec, vcc
    buffer_load_dwordx4 v44, s[24:27], 0 offen lds
    s_lshl3_add_u32 m0, s45, 98304
    s_add_u32 s45, s45, 32
    buffer_load_dword v45, s[20:23], 0 offen lds
    s_mov_b64 exec, -1
    s_sub_i32 s46, s46, 32
L_10:
L_paymore:
    s_cmp_le_i32 s46, 0
    s_cbranch_scc1 L_paydone
    ds_read_b32 v40, v39 offset:512
    v_add_u32 v39, 128, v39
    s_waitcnt lgkmcnt(0)
    s_cmp_le_i32 s46, 0
    s_cbranch_scc1 L_11
    v_lshl_add_u32 v44, v40, 5, v37
    v_lshl_add_u32 v45, v40, 3, v38
    v_cmp_gt_i32 vcc, s46, v36
    s_lshl_b32 s76, s45, 5
    s_add_u32 m0, s76, 65536
    s_mov_b64 exec, vcc
    buffer_load_dwordx4 v44, s[24:27], 0 offen lds
    s_lshl3_add_u32 m0, s45, 98304
    s_add_u32 s45, s45, 32
    buffer_load_dword v45, s[20:23], 0 offen lds
    s_mov_b64 exec, -1
    s_sub_i32 s46, s46, 32
L_11:
    s_branch L_paymore
L_paydone:
    s_lshl_b32 s61, s61, 2
    s_add_u32 s61, s61, 106496
    s_and_b32 s54, s2, 192
    s_lshl_b32 s54, s54, 1
    s_lshl4_add_u32 s54, s3, s54
    s_lshl2_add_u32 s53, s54, 4096
    v_and_b32 v66, 15, v1
    v_lshl_add_u32 v66, v66, 2, s53
    s_lshl_b32 s53, s54, 10
    s_add_u32 s53, s53, 1048576
    v_lshl_add_u32 v67, v1, 4, s53
    s_xor_b32 s53, s48, 1
    v_mov_b32 v79, s53
    v_mov_b32 v13, s61
    v_and_b32 v62, 3, v1
    v_lshl_add_u32 v77, v62, 2, s61
    v_bfe_u32 v62, v1, 2, 2
    v_lshl_add_u32 v78, v62, 2, s61
    v_bfe_u32 v63, v1, 4, 1
    v_lshlrev_b32 v63, 4, v63
    v_add_u32 v63, 65536, v63
    v_mov_b32 v65, 98304
    v_mov_b32 v62, 110848
    v_cmp_ne_u32 vcc, 0, v7
    v_cmp_ne_u32 s[4:5], 0, v8
    v_cmp_ne_u32 s[6:7], 0, v10
    v_cndmask_b32 v74, v62, v63, vcc
    v_cndmask_b32 v75, v62, v63, s[4:5]
    v_cndmask_b32 v76, v62, v65, s[6:7]
    s_waitcnt lgkmcnt(0)
    s_barrier
    ds_read_b128 v[68:71], v13
    ds_read_b32 v72, v77
    ds_read_b32 v73, v78
    s_cmp_lt_u32 s62, 3
    s_cbranch_scc1 L_short
    s_waitcnt lgkmcnt(2)
    v_readfirstlane_b32 s64, v68
    v_readfirstlane_b32 s65, v69
    v_readfirstlane_b32 s66, v70
    v_readfirstlane_b32 s67, v71
    s_and_b32 s76, s64, s82
    s_add_u32 m0, s63, 0
    s_lshl_b32 s76, s76, 3
    buffer_load_dwordx4 v2, s[8:11], s76 offen lds
    buffer_load_dwordx4 v3, s[8:11], s76 offen offset:1024 lds
    s_and_b32 s76, s65, s82
    s_add_u32 m0, s63, 2048
    s_lshl_b32 s76, s76, 3
    buffer_load_dwordx4 v2, s[8:11], s76 offen lds
    buffer_load_dwordx4 v3, s[8:11], s76 offen offset:1024 lds
    s_and_b32 s76, s66, s82
    s_add_u32 m0, s63, 4096
    s_lshl_b32 s76, s76, 3
    buffer_load_dwordx4 v2, s[8:11], s76 offen lds
    buffer_load_dwordx4 v3, s[8:11], s76 offen offset:1024 lds
    s_waitcnt vmcnt(6)
    s_branch L_go
L_short:
    s_waitcnt vmcnt(0) lgkmcnt(0)
    v_readfirstlane_b32 s64, v68
    v_readfirstlane_b32 s65, v69
    v_readfirstlane_b32 s66, v70
    v_readfirstlane_b32 s67, v71
    s_cmp_le_u32 s62, 0
    s_cbranch_scc1 L_go
    s_and_b32 s76, s64, s82
    s_add_u32 m0, s63, 0
    s_lshl_b32 s76, s76, 3
    buffer_load_dwordx4 v2, s[8:11], s76 offen lds
    buffer_load_dwordx4 v3, s[8:11], s76 offen offset:1024 lds
    s_cmp_le_u32 s62, 1
    s_cbranch_scc1 L_go
    s_and_b32 s76, s65, s82
    s_add_u32 m0, s63, 2048
    s_lshl_b32 s76, s76, 3
    buffer_load_dwordx4 v2, s[8:11], s76 offen lds
    buffer_load_dwordx4 v3, s[8:11], s76 offen offset:1024 lds
L_go:
    s_cmp_ge_u32 s3, 2
    s_cbranch_scc1 L_12
    s_cmp_lg_u32 s77, 0
    s_cbranch_scc1 L_12
    v_mov_b32 v62, s83
    v_mov_b32 v63, s48
    s_mov_b64 exec, 1
    buffer_store_dword v63, v62, s[32:35], 0 offen sc1
    s_mov_b64 exec, -1
L_12:
    s_waitcnt lgkmcnt(0)
    v_lshrrev_b32 v72, 22, v72
    v_lshrrev_b32 v73, 22, v73
    v_mad_u32_u24 v5, v72, v7, v74
    v_mad_u32_u24 v6, v72, v8, v75
    v_mad_u32_u24 v9, v73, v10, v76
    s_barrier
    s_cmp_eq_u32 s62, 0
    s_cbranch_scc1 L_round_done
L_group:
    s_cmp_le_u32 s62, s81
    s_cbranch_scc1 L_wstep
L_wback:
    ds_read_b64 v[64:65], v9
    ds_read_b128 v[56:59], v5
    ds_read_b128 v[60:63], v6
    ds_read_b128 v[68:71], v13 offset:16
    ds_read_b32 v72, v77 offset:16
    ds_read_b32 v73, v78 offset:16
    v_add_u32 v13, 16, v13
    v_add_u32 v77, 16, v77
    v_add_u32 v78, 16, v78
    s_waitcnt lgkmcnt(0)
    v_mfma_f32_16x16x16_bf16 v[32:35], v[14:15], v[64:65], 0
    v_mfma_f32_16x16x32_bf16 v[16:19], v[56:59], a[0:3], 0
    v_mfma_f32_16x16x32_bf16 v[20:23], v[56:59], a[8:11], 0
    v_mfma_f32_16x16x32_bf16 v[24:27], v[56:59], a[16:19], 0
    v_mfma_f32_16x16x32_bf16 v[28:31], v[56:59], a[24:27], 0
    v_mfma_f32_16x16x32_bf16 v[16:19], v[60:63], a[4:7], v[16:19]
    v_mfma_f32_16x16x32_bf16 v[20:23], v[60:63], a[12:15], v[20:23]
    v_mfma_f32_16x16x32_bf16 v[24:27], v[60:63], a[20:23], v[24:27]
    v_mfma_f32_16x16x32_bf16 v[28:31], v[60:63], a[28:31], v[28:31]
    v_readfirstlane_b32 s68, v68
    v_readfirstlane_b32 s69, v69
    v_readfirstlane_b32 s70, v70
    v_readfirstlane_b32 s71, v71
    v_cvt_pk_bf16_f32 v64, v32, v33
    v_cvt_pk_bf16_f32 v65, v34, v35
    v_lshrrev_b32 v72, 22, v72
    v_lshrrev_b32 v73, 22, v73
    v_mad_u32_u24 v5, v72, v7, v74
    v_mad_u32_u24 v6, v72, v8, v75
    v_mad_u32_u24 v9, v73, v10, v76
    s_cmp_ge_u32 s62, 3
    s_cbranch_scc1 L_13
    s_waitcnt vmcnt(0)
L_13:
    s_waitcnt vmcnt(4)
    ds_read_b64_tr_b16 v[48:49], v4 offset:0
    ds_read_b64_tr_b16 v[50:51], v4 offset:256
    ds_read_b64_tr_b16 v[52:53], v4 offset:512
    ds_read_b64_tr_b16 v[54:55], v4 offset:768
    s_cmp_le_u32 s62, 3
    s_cbranch_scc1 L_14
    s_and_b32 s76, s67, s82
    s_add_u32 m0, s63, 6144
    s_lshl_b32 s76, s76, 3
    buffer_load_dwordx4 v2, s[8:11], s76 offen lds
    buffer_load_dwordx4 v3, s[8:11], s76 offen offset:1024 lds
L_14:
    s_waitcnt lgkmcnt(0)
    v_mfma_f32_4x4x4_16b_bf16 v[32:35], v[64:65], v[48:49], 0 cbsz:4 abid:0
    v_mfma_f32_4x4x4_16b_bf16 v[36:39], v[64:65], v[50:51], 0 cbsz:4 abid:0
    v_mfma_f32_4x4x4_16b_bf16 v[40:43], v[64:65], v[52:53], 0 cbsz:4 abid:0
    v_mfma_f32_4x4x4_16b_bf16 v[44:47], v[64:65], v[54:55], 0 cbsz:4 abid:0
    s_nop 0
    s_set_gpr_idx_on s64, gpr_idx(SRC2,DST)
    v_pk_fma_f32 v[80:81], v[32:33], v[16:17], v[80:81] op_sel:[0,0,0] op_sel_hi:[1,0,1]
    v_pk_fma_f32 v[82:83], v[34:35], v[16:17], v[82:83] op_sel:[0,0,0] op_sel_hi:[1,0,1]
    v_pk_fma_f32 v[84:85], v[36:37], v[20:21], v[84:85] op_sel:[0,0,0] op_sel_hi:[1,0,1]
    v_pk_fma_f32 v[86:87], v[38:39], v[20:21], v[86:87] op_sel:[0,0,0] op_sel_hi:[1,0,1]
    v_pk_fma_f32 v[88:89], v[40:41], v[24:25], v[88:89] op_sel:[0,0,0] op_sel_hi:[1,0,1]
    v_pk_fma_f32 v[90:91], v[42:43], v[24:25], v[90:91] op_sel:[0,0,0] op_sel_hi:[1,0,1]
    v_pk_fma_f32 v[92:93], v[44:45], v[28:29], v[92:93] op_sel:[0,0,0] op_sel_hi:[1,0,1]
    v_pk_fma_f32 v[94:95], v[46:47], v[28:29], v[94:95] op_sel:[0,0,0] op_sel_hi:[1,0,1]
    s_set_gpr_idx_off
    s_mov_b32 s64, s68
    s_sub_u32 s62, s62, 1
    s_cmp_eq_u32 s62, 0
    s_cbranch_scc1 L_round_done
    s_cmp_ge_u32 s62, 3
    s_cbranch_scc1 L_15
    s_waitcnt vmcnt(0)
L_15:
    s_waitcnt vmcnt(4)
    ds_read_b64_tr_b16 v[48:49], v4 offset:2048
    ds_read_b64_tr_b16 v[50:51], v4 offset:2304
    ds_read_b64_tr_b16 v[52:53], v4 offset:2560
    ds_read_b64_tr_b16 v[54:55], v4 offset:2816
    s_cmp_le_u32 s62, 3
    s_cbranch_scc1 L_16
    s_and_b32 s76, s68, s82
    s_add_u32 m0, s63, 0
    s_lshl_b32 s76, s76, 3
    buffer_load_dwordx4 v2, s[8:11], s76 offen lds
    buffer_load_dwordx4 v3, s[8:11], s76 offen offset:1024 lds
L_16:
    s_waitcnt lgkmcnt(0)
    v_mfma_f32_4x4x4_16b_bf16 v[32:35], v[64:65], v[48:49], 0 cbsz:4 abid:1
    v_mfma_f32_4x4x4_16b_bf16 v[36:39], v[64:65], v[50:51], 0 cbsz:4 abid:1
    v_mfma_f32_4x4x4_16b_bf16 v[40:43], v[64:65], v[52:53], 0 cbsz:4 abid:1
    v_mfma_f32_4x4x4_16b_bf16 v[44:47], v[64:65], v[54:55], 0 cbsz:4 abid:1
    s_nop 0
    s_set_gpr_idx_on s65, gpr_idx(SRC2,DST)
    v_pk_fma_f32 v[80:81], v[32:33], v[16:17], v[80:81] op_sel:[0,1,0] op_sel_hi:[1,1,1]
    v_pk_fma_f32 v[82:83], v[34:35], v[16:17], v[82:83] op_sel:[0,1,0] op_sel_hi:[1,1,1]
    v_pk_fma_f32 v[84:85], v[36:37], v[20:21], v[84:85] op_sel:[0,1,0] op_sel_hi:[1,1,1]
    v_pk_fma_f32 v[86:87], v[38:39], v[20:21], v[86:87] op_sel:[0,1,0] op_sel_hi:[1,1,1]
    v_pk_fma_f32 v[88:89], v[40:41], v[24:25], v[88:89] op_sel:[0,1,0] op_sel_hi:[1,1,1]
    v_pk_fma_f32 v[90:91], v[42:43], v[24:25], v[90:91] op_sel:[0,1,0] op_sel_hi:[1,1,1]
    v_pk_fma_f32 v[92:93], v[44:45], v[28:29], v[92:93] op_sel:[0,1,0] op_sel_hi:[1,1,1]
    v_pk_fma_f32 v[94:95], v[46:47], v[28:29], v[94:95] op_sel:[0,1,0] op_sel_hi:[1,1,1]
    s_set_gpr_idx_off
    s_mov_b32 s65, s69
    s_sub_u32 s62, s62, 1
    s_cmp_eq_u32 s62, 0
    s_cbranch_scc1 L_round_done
    s_cmp_ge_u32 s62, 3
    s_cbranch_scc1 L_17
    s_waitcnt vmcnt(0)
L_17:
    s_waitcnt vmcnt(4)
    ds_read_b64_tr_b16 v[48:49], v4 offset:4096
    ds_read_b64_tr_b16 v[50:51], v4 offset:4352
    ds_read_b64_tr_b16 v[52:53], v4 offset:4608
    ds_read_b64_tr_b16 v[54:55], v4 offset:4864
    s_cmp_le_u32 s62, 3
    s_cbranch_scc1 L_18
    s_and_b32 s76, s69, s82
    s_add_u32 m0, s63, 2048
    s_lshl_b32 s76, s76, 3
    buffer_load_dwordx4 v2, s[8:11], s76 offen lds
    buffer_load_dwordx4 v3, s[8:11], s76 offen offset:1024 lds
L_18:
    s_waitcnt lgkmcnt(0)
    v_mfma_f32_4x4x4_16b_bf16 v[32:35], v[64:65], v[48:49], 0 cbsz:4 abid:2
    v_mfma_f32_4x4x4_16b_bf16 v[36:39], v[64:65], v[50:51], 0 cbsz:4 abid:2
    v_mfma_f32_4x4x4_16b_bf16 v[40:43], v[64:65], v[52:53], 0 cbsz:4 abid:2
    v_mfma_f32_4x4x4_16b_bf16 v[44:47], v[64:65], v[54:55], 0 cbsz:4 abid:2
    s_nop 0
    s_set_gpr_idx_on s66, gpr_idx(SRC2,DST)
    v_pk_fma_f32 v[80:81], v[32:33], v[18:19], v[80:81] op_sel:[0,0,0] op_sel_hi:[1,0,1]
    v_pk_fma_f32 v[82:83], v[34:35], v[18:19], v[82:83] op_sel:[0,0,0] op_sel_hi:[1,0,1]
    v_pk_fma_f32 v[84:85], v[36:37], v[22:23], v[84:85] op_sel:[0,0,0] op_sel_hi:[1,0,1]
    v_pk_fma_f32 v[86:87], v[38:39], v[22:23], v[86:87] op_sel:[0,0,0] op_sel_hi:[1,0,1]
    v_pk_fma_f32 v[88:89], v[40:41], v[26:27], v[88:89] op_sel:[0,0,0] op_sel_hi:[1,0,1]
    v_pk_fma_f32 v[90:91], v[42:43], v[26:27], v[90:91] op_sel:[0,0,0] op_sel_hi:[1,0,1]
    v_pk_fma_f32 v[92:93], v[44:45], v[30:31], v[92:93] op_sel:[0,0,0] op_sel_hi:[1,0,1]
    v_pk_fma_f32 v[94:95], v[46:47], v[30:31], v[94:95] op_sel:[0,0,0] op_sel_hi:[1,0,1]
    s_set_gpr_idx_off
    s_mov_b32 s66, s70
    s_sub_u32 s62, s62, 1
    s_cmp_eq_u32 s62, 0
    s_cbranch_scc1 L_round_done
    s_cmp_ge_u32 s62, 3
    s_cbranch_scc1 L_19
    s_waitcnt vmcnt(0)
L_19:
    s_waitcnt vmcnt(4)
    ds_read_b64_tr_b16 v[48:49], v4 offset:6144
    ds_read_b64_tr_b16 v[50:51], v4 offset:6400
    ds_read_b64_tr_b16 v[52:53], v4 offset:6656
    ds_read_b64_tr_b16 v[54:55], v4 offset:6912
    s_cmp_le_u32 s62, 3
    s_cbranch_scc1 L_20
    s_and_b32 s76, s70, s82
    s_add_u32 m0, s63, 4096
    s_lshl_b32 s76, s76, 3
    buffer_load_dwordx4 v2, s[8:11], s76 offen lds
    buffer_load_dwordx4 v3, s[8:11], s76 offen offset:1024 lds
L_20:
    s_waitcnt lgkmcnt(0)
    v_mfma_f32_4x4x4_16b_bf16 v[32:35], v[64:65], v[48:49], 0 cbsz:4 abid:3
    v_mfma_f32_4x4x4_16b_bf16 v[36:39], v[64:65], v[50:51], 0 cbsz:4 abid:3
    v_mfma_f32_4x4x4_16b_bf16 v[40:43], v[64:65], v[52:53], 0 cbsz:4 abid:3
    v_mfma_f32_4x4x4_16b_bf16 v[44:47], v[64:65], v[54:55], 0 cbsz:4 abid:3
    s_nop 0
    s_set_gpr_idx_on s67, gpr_idx(SRC2,DST)
    v_pk_fma_f32 v[80:81], v[32:33], v[18:19], v[80:81] op_sel:[0,1,0] op_sel_hi:[1,1,1]
    v_pk_fma_f32 v[82:83], v[34:35], v[18:19], v[82:83] op_sel:[0,1,0] op_sel_hi:[1,1,1]
    v_pk_fma_f32 v[84:85], v[36:37], v[22:23], v[84:85] op_sel:[0,1,0] op_sel_hi:[1,1,1]
    v_pk_fma_f32 v[86:87], v[38:39], v[22:23], v[86:87] op_sel:[0,1,0] op_sel_hi:[1,1,1]
    v_pk_fma_f32 v[88:89], v[40:41], v[26:27], v[88:89] op_sel:[0,1,0] op_sel_hi:[1,1,1]
    v_pk_fma_f32 v[90:91], v[42:43], v[26:27], v[90:91] op_sel:[0,1,0] op_sel_hi:[1,1,1]
    v_pk_fma_f32 v[92:93], v[44:45], v[30:31], v[92:93] op_sel:[0,1,0] op_sel_hi:[1,1,1]
    v_pk_fma_f32 v[94:95], v[46:47], v[30:31], v[94:95] op_sel:[0,1,0] op_sel_hi:[1,1,1]
    s_set_gpr_idx_off
    s_mov_b32 s67, s71
    s_sub_u32 s62, s62, 1
    s_cmp_eq_u32 s62, 0
    s_cbranch_scc0 L_group
L_round_done:
    s_add_u32 s77, s77, 1
    s_cmp_lg_u32 s78, 0
    s_cbranch_scc1 L_scan
    s_cmp_eq_u32 s81, 0
    s_cbranch_scc1 L_havew
    s_mov_b32 s55, 0
L_pollw:
    s_waitcnt vmcnt(0)
    v_cmp_ne_u32 vcc, s48, v79
    s_cbranch_vccz L_gotw
    buffer_load_dword v79, v66, s[32:35], 0 offen sc1
    s_sleep 1
    s_add_u32 s55, s55, 1
    s_cmp_lt_u32 s55, 0x400000
    s_cbranch_scc1 L_pollw
    s_endpgm
L_gotw:
    buffer_load_dwordx4 a[32:35], v67, s[32:35], 0 offen offset:0 sc1
    buffer_load_dwordx4 a[36:39], v67, s[32:35], 0 offen offset:1024 sc1
    buffer_load_dwordx4 a[40:43], v67, s[32:35], 0 offen offset:2048 sc1
    buffer_load_dwordx4 a[44:47], v67, s[32:35], 0 offen offset:3072 sc1
    v_add_u32 v67, 4096, v67
    buffer_load_dwordx4 a[48:51], v67, s[32:35], 0 offen offset:0 sc1
    buffer_load_dwordx4 a[52:55], v67, s[32:35], 0 offen offset:1024 sc1
    buffer_load_dwordx4 a[56:59], v67, s[32:35], 0 offen offset:2048 sc1
    buffer_load_dwordx4 a[60:63], v67, s[32:35], 0 offen offset:3072 sc1
    v_add_u32 v67, 4096, v67
    buffer_load_dwordx4 a[64:67], v67, s[32:35], 0 offen offset:0 sc1
    buffer_load_dwordx4 a[68:71], v67, s[32:35], 0 offen offset:1024 sc1
    buffer_load_dwordx4 a[72:75], v67, s[32:35], 0 offen offset:2048 sc1
    buffer_load_dwordx4 a[76:79], v67, s[32:35], 0 offen offset:3072 sc1
    v_add_u32 v67, 4096, v67
    buffer_load_dwordx4 a[80:83], v67, s[32:35], 0 offen offset:0 sc1
    buffer_load_dwordx4 a[84:87], v67, s[32:35], 0 offen offset:1024 sc1
    buffer_load_dwordx4 a[88:91], v67, s[32:35], 0 offen offset:2048 sc1
    buffer_load_dwordx4 a[92:95], v67, s[32:35], 0 offen offset:3072 sc1
    v_add_u32 v67, 4096, v67
    s_branch L_havew
L_wstep:
    v_cmp_ne_u32 vcc, s48, v79
    s_cbranch_vccz L_wgo
    buffer_load_dword v79, v66, s[32:35], 0 offen sc1
    s_branch L_wback
L_wgo:
    s_branch L_wback
L_havew:
    v_mul_u32_u24 v16, 320, v1
    v_lshrrev_b32 v17, 2, v1
    v_lshl_add_u32 v16, v17, 3, v16
    s_lshl_b32 s53, s56, 3
    v_add_u32 v72, s53, v16
    v_add_u32 v5, 111136, v72
    s_lshl_b32 s53, s57, 3
    v_add_u32 v73, s53, v16
    v_add_u32 v6, 111136, v73
    s_lshl_b32 s53, s58, 3
    v_add_u32 v74, s53, v16
    v_add_u32 v7, 111136, v74
    s_lshl_b32 s53, s59, 3
    v_add_u32 v75, s53, v16
    v_add_u32 v8, 111136, v75
    s_lshl_b32 s53, s60, 3
    v_add_u32 v76, s53, v16
    v_add_u32 v9, 111136, v76
    v_cvt_pk_bf16_f32 v32, v80, v81
    v_cvt_pk_bf16_f32 v33, v82, v83
    ds_write_b64 v5, v[32:33] offset:0
    v_cvt_pk_bf16_f32 v34, v96, v97
    v_cvt_pk_bf16_f32 v35, v98, v99
    ds_write_b64 v6, v[34:35] offset:0
    v_cvt_pk_bf16_f32 v36, v112, v113
    v_cvt_pk_bf16_f32 v37, v114, v115
    ds_write_b64 v7, v[36:37] offset:0
    v_cvt_pk_bf16_f32 v38, v128, v129
    v_cvt_pk_bf16_f32 v39, v130, v131
    ds_write_b64 v8, v[38:39] offset:0
    v_cvt_pk_bf16_f32 v40, v144, v145
    v_cvt_pk_bf16_f32 v41, v146, v147
    ds_write_b64 v9, v[40:41] offset:0
    v_cvt_pk_bf16_f32 v42, v84, v85
    v_cvt_pk_bf16_f32 v43, v86, v87
    ds_write_b64 v5, v[42:43] offset:20608
    v_cvt_pk_bf16_f32 v44, v100, v101
    v_cvt_pk_bf16_f32 v45, v102, v103
    ds_write_b64 v6, v[44:45] offset:20608
    v_cvt_pk_bf16_f32 v46, v116, v117
    v_cvt_pk_bf16_f32 v47, v118, v119
    ds_write_b64 v7, v[46:47] offset:20608
    v_cvt_pk_bf16_f32 v48, v132, v133
    v_cvt_pk_bf16_f32 v49, v134, v135
    ds_write_b64 v8, v[48:49] offset:20608
    v_cvt_pk_bf16_f32 v50, v148, v149
    v_cvt_pk_bf16_f32 v51, v150, v151
    ds_write_b64 v9, v[50:51] offset:20608
    v_cvt_pk_bf16_f32 v52, v88, v89
    v_cvt_pk_bf16_f32 v53, v90, v91
    v_cvt_pk_bf16_f32 v54, v104, v105
    v_cvt_pk_bf16_f32 v55, v106, v107
    v_cvt_pk_bf16_f32 v56, v120, v121
    v_cvt_pk_bf16_f32 v57, v122, v123
    v_cvt_pk_bf16_f32 v58, v136, v137
    v_cvt_pk_bf16_f32 v59, v138, v139
    v_cvt_pk_bf16_f32 v60, v152, v153
    v_cvt_pk_bf16_f32 v61, v154, v155
    v_cvt_pk_bf16_f32 v62, v92, v93
    v_cvt_pk_bf16_f32 v63, v94, v95
    v_cvt_pk_bf16_f32 v64, v108, v109
    v_cvt_pk_bf16_f32 v65, v110, v111
    v_cvt_pk_bf16_f32 v66, v124, v125
    v_cvt_pk_bf16_f32 v67, v126, v127
    v_cvt_pk_bf16_f32 v68, v140, v141
    v_cvt_pk_bf16_f32 v69, v142, v143
    v_cvt_pk_bf16_f32 v70, v156, v157
    v_cvt_pk_bf16_f32 v71, v158, v159
    v_lshrrev_b32 v20, 5, v1
    v_mul_u32_u24 v21, 2576, v20
    v_bfe_u32 v22, v1, 2, 2
    v_mul_u32_u24 v24, 320, v22
    v_bfe_u32 v23, v1, 4, 1
    v_lshl_add_u32 v21, v23, 5, v21
    v_and_b32 v23, 3, v1
    v_lshl_add_u32 v21, v23, 3, v21
    v_add_u32 v3, v21, v24
    v_add_u32 v2, 111136, v3
    s_mul_i32 s53, s3, 5120
    s_add_u32 s53, s53, 41472
    v_and_b32 v24, 31, v1
    v_mul_u32_u24 v24, 80, v24
    v_lshl_add_u32 v24, v20, 3, v24
    v_add_u32 v10, s53, v24
    v_lshrrev_b32 v24, 2, v1
    v_mul_u32_u24 v24, 80, v24
    v_lshl_add_u32 v24, v23, 4, v24
    v_add_u32 v11, s53, v24
    v_lshrrev_b32 v24, 4, v1
    v_lshlrev_b32 v24, 19, v24
    v_lshl_add_u32 v24, v22, 9, v24
    v_lshl_add_u32 v24, v23, 4, v24
    s_lshl_b32 s53, s2, 11
    s_lshl_b32 s54, s3, 6
    s_add_u32 s53, s53, s54
    v_add_u32 v4, s53, v24
    s_waitcnt lgkmcnt(0)
    s_barrier
    ds_read_b64_tr_b16 v[16:17], v2 offset:0
    ds_read_b64_tr_b16 v[18:19], v2 offset:1288
    ds_read_b64_tr_b16 v[20:21], v2 offset:5152
    ds_read_b64_tr_b16 v[22:23], v2 offset:6440
    ds_read_b64_tr_b16 v[24:25], v2 offset:10304
    ds_read_b64_tr_b16 v[26:27], v2 offset:11592
    ds_read_b64_tr_b16 v[28:29], v2 offset:15456
    ds_read_b64_tr_b16 v[30:31], v2 offset:16744
    ds_read_b64_tr_b16 v[32:33], v2 offset:20608
    ds_read_b64_tr_b16 v[34:35], v2 offset:21896
    s_waitcnt vmcnt(8)
    s_waitcnt lgkmcnt(8)
    v_mfma_f32_32x32x16_bf16 v[80:95], a[32:35], v[16:19], 0
    ds_read_b64_tr_b16 v[36:37], v2 offset:25760
    ds_read_b64_tr_b16 v[38:39], v2 offset:27048
    ds_write_b64 v72, v[52:53] offset:0
    s_waitcnt lgkmcnt(9)
    v_mfma_f32_32x32x16_bf16 v[80:95], a[36:39], v[20:23], v[80:95]
    ds_read_b64_tr_b16 v[40:41], v2 offset:30912
    ds_read_b64_tr_b16 v[42:43], v2 offset:32200
    ds_write_b64 v73, v[54:55] offset:0
    s_waitcnt lgkmcnt(10)
    v_mfma_f32_32x32x16_bf16 v[80:95], a[40:43], v[24:27], v[80:95]
    ds_read_b64_tr_b16 v[44:45], v2 offset:36064
    ds_read_b64_tr_b16 v[46:47], v2 offset:37352
    ds_write_b64 v74, v[56:57] offset:0
    s_waitcnt lgkmcnt(11)
    v_mfma_f32_32x32x16_bf16 v[80:95], a[44:47], v[28:31], v[80:95]
    ds_read_b64_tr_b16 v[16:17], v2 offset:64
    ds_read_b64_tr_b16 v[18:19], v2 offset:1352
    ds_write_b64 v75, v[58:59] offset:0
    s_waitcnt lgkmcnt(12)
    v_mfma_f32_32x32x16_bf16 v[80:95], a[48:51], v[32:35], v[80:95]
    ds_read_b64_tr_b16 v[20:21], v2 offset:5216
    ds_read_b64_tr_b16 v[22:23], v2 offset:6504
    ds_write_b64 v76, v[60:61] offset:0
    s_waitcnt lgkmcnt(13)
    v_mfma_f32_32x32x16_bf16 v[80:95], a[52:55], v[36:39], v[80:95]
    ds_read_b64_tr_b16 v[24:25], v2 offset:10368
    ds_read_b64_tr_b16 v[26:27], v2 offset:11656
    ds_write_b64 v72, v[62:63] offset:20608
    s_waitcnt lgkmcnt(13)
    v_mfma_f32_32x32x16_bf16 v[80:95], a[56:59], v[40:43], v[80:95]
    ds_read_b64_tr_b16 v[28:29], v2 offset:15520
    ds_read_b64_tr_b16 v[30:31], v2 offset:16808
    ds_write_b64 v73, v[64:65] offset:20608
    s_waitcnt lgkmcnt(13)
    v_mfma_f32_32x32x16_bf16 v[80:95], a[60:63], v[44:47], v[80:95]
    ds_read_b64_tr_b16 v[32:33], v2 offset:20672
    ds_read_b64_tr_b16 v[34:35], v2 offset:21960
    ds_write_b64 v74, v[66:67] offset:20608
    s_waitcnt lgkmcnt(13)
    v_mfma_f32_32x32x16_bf16 v[96:111], a[32:35], v[16:19], 0
    ds_read_b64_tr_b16 v[36:37], v2 offset:25824
    ds_read_b64_tr_b16 v[38:39], v2 offset:27112
    ds_write_b64 v75, v[68:69] offset:20608
    s_waitcnt lgkmcnt(13)
    v_mfma_f32_32x32x16_bf16 v[96:111], a[36:39], v[20:23], v[96:111]
    ds_read_b64_tr_b16 v[40:41], v2 offset:30976
    ds_read_b64_tr_b16 v[42:43], v2 offset:32264
    ds_write_b64 v76, v[70:71] offset:20608
    s_waitcnt lgkmcnt(13)
    v_mfma_f32_32x32x16_bf16 v[96:111], a[40:43], v[24:27], v[96:111]
    ds_read_b64_tr_b16 v[44:45], v2 offset:36128
    ds_read_b64_tr_b16 v[46:47], v2 offset:37416
    s_waitcnt lgkmcnt(12)
    v_mfma_f32_32x32x16_bf16 v[96:111], a[44:47], v[28:31], v[96:111]
    ds_read_b64_tr_b16 v[16:17], v2 offset:128
    ds_read_b64_tr_b16 v[18:19], v2 offset:1416
    s_waitcnt lgkmcnt(11)
    v_mfma_f32_32x32x16_bf16 v[96:111], a[48:51], v[32:35], v[96:111]
    ds_read_b64_tr_b16 v[20:21], v2 offset:5280
    ds_read_b64_tr_b16 v[22:23], v2 offset:6568
    s_waitcnt lgkmcnt(10)
    v_mfma_f32_32x32x16_bf16 v[96:111], a[52:55], v[36:39], v[96:111]
    ds_read_b64_tr_b16 v[24:25], v2 offset:10432
    ds_read_b64_tr_b16 v[26:27], v2 offset:11720
    s_waitcnt lgkmcnt(9)
    v_mfma_f32_32x32x16_bf16 v[96:111], a[56:59], v[40:43], v[96:111]
    ds_read_b64_tr_b16 v[28:29], v2 offset:15584
    ds_read_b64_tr_b16 v[30:31], v2 offset:16872
    s_waitcnt lgkmcnt(8)
    v_mfma_f32_32x32x16_bf16 v[96:111], a[60:63], v[44:47], v[96:111]
    ds_read_b64_tr_b16 v[32:33], v2 offset:20736
    ds_read_b64_tr_b16 v[34:35], v2 offset:22024
    s_waitcnt lgkmcnt(8)
    v_mfma_f32_32x32x16_bf16 v[112:127], a[32:35], v[16:19], 0
    ds_read_b64_tr_b16 v[36:37], v2 offset:25888
    ds_read_b64_tr_b16 v[38:39], v2 offset:27176
    s_waitcnt lgkmcnt(8)
    v_mfma_f32_32x32x16_bf16 v[112:127], a[36:39], v[20:23], v[112:127]
    ds_read_b64_tr_b16 v[40:41], v2 offset:31040
    ds_read_b64_tr_b16 v[42:43], v2 offset:32328
    s_waitcnt lgkmcnt(8)
    v_mfma_f32_32x32x16_bf16 v[112:127], a[40:43], v[24:27], v[112:127]
    ds_read_b64_tr_b16 v[44:45], v2 offset:36192
    ds_read_b64_tr_b16 v[46:47], v2 offset:37480
    s_barrier
    s_waitcnt lgkmcnt(8)
    v_mfma_f32_32x32x16_bf16 v[112:127], a[44:47], v[28:31], v[112:127]
    ds_read_b64_tr_b16 v[16:17], v3 offset:0
    ds_read_b64_tr_b16 v[18:19], v3 offset:1288
    s_waitcnt lgkmcnt(8)
    v_mfma_f32_32x32x16_bf16 v[112:127], a[48:51], v[32:35], v[112:127]
    ds_read_b64_tr_b16 v[20:21], v3 offset:5152
    ds_read_b64_tr_b16 v[22:23], v3 offset:6440
    s_waitcnt lgkmcnt(8)
    v_mfma_f32_32x32x16_bf16 v[112:127], a[52:55], v[36:39], v[112:127]
    ds_read_b64_tr_b16 v[24:25], v3 offset:10304
    ds_read_b64_tr_b16 v[26:27], v3 offset:11592
    s_waitcnt lgkmcnt(8)
    v_mfma_f32_32x32x16_bf16 v[112:127], a[56:59], v[40:43], v[112:127]
    ds_read_b64_tr_b16 v[28:29], v3 offset:15456
    ds_read_b64_tr_b16 v[30:31], v3 offset:16744
    s_waitcnt lgkmcnt(8)
    v_mfma_f32_32x32x16_bf16 v[112:127], a[60:63], v[44:47], v[112:127]
    ds_read_b64_tr_b16 v[32:33], v3 offset:20608
    ds_read_b64_tr_b16 v[34:35], v3 offset:21896
    s_waitcnt vmcnt(0)
    s_waitcnt lgkmcnt(8)
    v_mfma_f32_32x32x16_bf16 v[80:95], a[64:67], v[16:19], v[80:95]
    ds_read_b64_tr_b16 v[36:37], v3 offset:25760
    ds_read_b64_tr_b16 v[38:39], v3 offset:27048
    s_waitcnt lgkmcnt(8)
    v_mfma_f32_32x32x16_bf16 v[80:95], a[68:71], v[20:23], v[80:95]
    ds_read_b64_tr_b16 v[40:41], v3 offset:30912
    ds_read_b64_tr_b16 v[42:43], v3 offset:32200
    s_waitcnt lgkmcnt(8)
    v_mfma_f32_32x32x16_bf16 v[80:95], a[72:75], v[24:27], v[80:95]
    ds_read_b64_tr_b16 v[44:45], v3 offset:36064
    ds_read_b64_tr_b16 v[46:47], v3 offset:37352
    s_waitcnt lgkmcnt(8)
    v_mfma_f32_32x32x16_bf16 v[80:95], a[76:79], v[28:31], v[80:95]
    ds_read_b64_tr_b16 v[16:17], v3 offset:64
    ds_read_b64_tr_b16 v[18:19], v3 offset:1352
    s_waitcnt lgkmcnt(8)
    v_mfma_f32_32x32x16_bf16 v[80:95], a[80:83], v[32:35], v[80:95]
    ds_read_b64_tr_b16 v[20:21], v3 offset:5216
    ds_read_b64_tr_b16 v[22:23], v3 offset:6504
    s_waitcnt lgkmcnt(8)
    v_mfma_f32_32x32x16_bf16 v[80:95], a[84:87], v[36:39], v[80:95]
    ds_read_b64_tr_b16 v[24:25], v3 offset:10368
    ds_read_b64_tr_b16 v[26:27], v3 offset:11656
    s_waitcnt lgkmcnt(8)
    v_mfma_f32_32x32x16_bf16 v[80:95], a[88:91], v[40:43], v[80:95]
    ds_read_b64_tr_b16 v[28:29], v3 offset:15520
    ds_read_b64_tr_b16 v[30:31], v3 offset:16808
    s_waitcnt lgkmcnt(8)
    v_mfma_f32_32x32x16_bf16 v[80:95], a[92:95], v[44:47], v[80:95]
    ds_read_b64_tr_b16 v[32:33], v3 offset:20672
    ds_read_b64_tr_b16 v[34:35], v3 offset:21960
    s_waitcnt lgkmcnt(8)
    v_mfma_f32_32x32x16_bf16 v[96:111], a[64:67], v[16:19], v[96:111]
    ds_read_b64_tr_b16 v[36:37], v3 offset:25824
    ds_read_b64_tr_b16 v[38:39], v3 offset:27112
    s_waitcnt lgkmcnt(8)
    v_mfma_f32_32x32x16_bf16 v[96:111], a[68:71], v[20:23], v[96:111]
    ds_read_b64_tr_b16 v[40:41], v3 offset:30976
    ds_read_b64_tr_b16 v[42:43], v3 offset:32264
    s_waitcnt lgkmcnt(8)
    v_mfma_f32_32x32x16_bf16 v[96:111], a[72:75], v[24:27], v[96:111]
    ds_read_b64_tr_b16 v[44:45], v3 offset:36128
    ds_read_b64_tr_b16 v[46:47], v3 offset:37416
    s_waitcnt lgkmcnt(8)
    v_mfma_f32_32x32x16_bf16 v[96:111], a[76:79], v[28:31], v[96:111]
    ds_read_b64_tr_b16 v[16:17], v3 offset:128
    ds_read_b64_tr_b16 v[18:19], v3 offset:1416
    v_cvt_pk_bf16_f32 v80, v80, v81
    v_cvt_pk_bf16_f32 v81, v82, v83
    ds_write_b64 v10, v[80:81] offset:0
    s_waitcnt lgkmcnt(9)
    v_mfma_f32_32x32x16_bf16 v[96:111], a[80:83], v[32:35], v[96:111]
    ds_read_b64_tr_b16 v[20:21], v3 offset:5280
    ds_read_b64_tr_b16 v[22:23], v3 offset:6568
    v_cvt_pk_bf16_f32 v82, v84, v85
    v_cvt_pk_bf16_f32 v83, v86, v87
    ds_write_b64 v10, v[82:83] offset:16
    s_waitcnt lgkmcnt(10)
    v_mfma_f32_32x32x16_bf16 v[96:111], a[84:87], v[36:39], v[96:111]
    ds_read_b64_tr_b16 v[24:25], v3 offset:10432
    ds_read_b64_tr_b16 v[26:27], v3 offset:11720
    v_cvt_pk_bf16_f32 v84, v88, v89
    v_cvt_pk_bf16_f32 v85, v90, v91
    ds_write_b64 v10, v[84:85] offset:32
    s_waitcnt lgkmcnt(11)
    v_mfma_f32_32x32x16_bf16 v[96:111], a[88:91], v[40:43], v[96:111]
    ds_read_b64_tr_b16 v[28:29], v3 offset:15584
    ds_read_b64_tr_b16 v[30:31], v3 offset:16872
    v_cvt_pk_bf16_f32 v86, v92, v93
    v_cvt_pk_bf16_f32 v87, v94, v95
    ds_write_b64 v10, v[86:87] offset:48
    s_waitcnt lgkmcnt(12)
    v_mfma_f32_32x32x16_bf16 v[96:111], a[92:95], v[44:47], v[96:111]
    ds_read_b64_tr_b16 v[32:33], v3 offset:20736
    ds_read_b64_tr_b16 v[34:35], v3 offset:22024
    ds_read_b128 v[52:55], v11 offset:0
    s_waitcnt lgkmcnt(13)
    v_mfma_f32_32x32x16_bf16 v[112:127], a[64:67], v[16:19], v[112:127]
    ds_read_b64_tr_b16 v[36:37], v3 offset:25888
    ds_read_b64_tr_b16 v[38:39], v3 offset:27176
    ds_read_b128 v[56:59], v11 offset:1280
    s_waitcnt lgkmcnt(13)
    v_mfma_f32_32x32x16_bf16 v[112:127], a[68:71], v[20:23], v[112:127]
    ds_read_b64_tr_b16 v[40:41], v3 offset:31040
    ds_read_b64_tr_b16 v[42:43], v3 offset:32328
    s_waitcnt lgkmcnt(12)
    v_mfma_f32_32x32x16_bf16 v[112:127], a[72:75], v[24:27], v[112:127]
    ds_read_b64_tr_b16 v[44:45], v3 offset:36192
    ds_read_b64_tr_b16 v[46:47], v3 offset:37480
    s_waitcnt lgkmcnt(11)
    v_mfma_f32_32x32x16_bf16 v[112:127], a[76:79], v[28:31], v[112:127]
    ds_read_b64_tr_b16 v[16:17], v2 offset:192
    ds_read_b64_tr_b16 v[18:19], v2 offset:1480
    v_cvt_pk_bf16_f32 v96, v96, v97
    v_cvt_pk_bf16_f32 v97, v98, v99
    ds_write_b64 v10, v[96:97] offset:2560
    s_waitcnt lgkmcnt(11)
    v_mfma_f32_32x32x16_bf16 v[112:127], a[80:83], v[32:35], v[112:127]
    ds_read_b64_tr_b16 v[20:21], v2 offset:5344
    ds_read_b64_tr_b16 v[22:23], v2 offset:6632
    v_cvt_pk_bf16_f32 v98, v100, v101
    v_cvt_pk_bf16_f32 v99, v102, v103
    ds_write_b64 v10, v[98:99] offset:2576
    s_waitcnt lgkmcnt(11)
    v_mfma_f32_32x32x16_bf16 v[112:127], a[84:87], v[36:39], v[112:127]
    ds_read_b64_tr_b16 v[24:25], v2 offset:10496
    ds_read_b64_tr_b16 v[26:27], v2 offset:11784
    buffer_store_dwordx4 v[52:55], v4, s[28:31], 0 offen sc1
    v_add_u32 v4, 2097152, v4
    v_cvt_pk_bf16_f32 v100, v104, v105
    v_cvt_pk_bf16_f32 v101, v106, v107
    ds_write_b64 v10, v[100:101] offset:2592
    s_waitcnt lgkmcnt(11)
    v_mfma_f32_32x32x16_bf16 v[112:127], a[88:91], v[40:43], v[112:127]
    ds_read_b64_tr_b16 v[28:29], v2 offset:15648
    ds_read_b64_tr_b16 v[30:31], v2 offset:16936
    buffer_store_dwordx4 v[56:59], v4, s[28:31], 0 offen sc1
    v_add_u32 v4, 2097152, v4
    v_cvt_pk_bf16_f32 v102, v108, v109
    v_cvt_pk_bf16_f32 v103, v110, v111
    ds_write_b64 v10, v[102:103] offset:2608
    s_waitcnt lgkmcnt(12)
    v_mfma_f32_32x32x16_bf16 v[112:127], a[92:95], v[44:47], v[112:127]
    ds_read_b64_tr_b16 v[32:33], v2 offset:20800
    ds_read_b64_tr_b16 v[34:35], v2 offset:22088
    ds_read_b128 v[60:63], v11 offset:2560
    s_waitcnt lgkmcnt(13)
    v_mfma_f32_32x32x16_bf16 v[128:143], a[32:35], v[16:19], 0
    ds_read_b64_tr_b16 v[36:37], v2 offset:25952
    ds_read_b64_tr_b16 v[38:39], v2 offset:27240
    ds_read_b128 v[64:67], v11 offset:3840
    s_waitcnt lgkmcnt(13)
    v_mfma_f32_32x32x16_bf16 v[128:143], a[36:39], v[20:23], v[128:143]
    ds_read_b64_tr_b16 v[40:41], v2 offset:31104
    ds_read_b64_tr_b16 v[42:43], v2 offset:32392
    s_waitcnt lgkmcnt(12)
    v_mfma_f32_32x32x16_bf16 v[128:143], a[40:43], v[24:27], v[128:143]
    ds_read_b64_tr_b16 v[44:45], v2 offset:36256
    ds_read_b64_tr_b16 v[46:47], v2 offset:37544
    s_waitcnt lgkmcnt(11)
    v_mfma_f32_32x32x16_bf16 v[128:143], a[44:47], v[28:31], v[128:143]
    ds_read_b64_tr_b16 v[16:17], v3 offset:192
    ds_read_b64_tr_b16 v[18:19], v3 offset:1480
    v_cvt_pk_bf16_f32 v112, v112, v113
    v_cvt_pk_bf16_f32 v113, v114, v115
    ds_write_b64 v10, v[112:113] offset:0
    s_waitcnt lgkmcnt(11)
    v_mfma_f32_32x32x16_bf16 v[128:143], a[48:51], v[32:35], v[128:143]
    ds_read_b64_tr_b16 v[20:21], v3 offset:5344
    ds_read_b64_tr_b16 v[22:23], v3 offset:6632
    v_cvt_pk_bf16_f32 v114, v116, v117
    v_cvt_pk_bf16_f32 v115, v118, v119
    ds_write_b64 v10, v[114:115] offset:16
    s_waitcnt lgkmcnt(11)
    v_mfma_f32_32x32x16_bf16 v[128:143], a[52:55], v[36:39], v[128:143]
    ds_read_b64_tr_b16 v[24:25], v3 offset:10496
    ds_read_b64_tr_b16 v[26:27], v3 offset:11784
    buffer_store_dwordx4 v[60:63], v4, s[28:31], 0 offen sc1
    v_add_u32 v4, 2097152, v4
    v_cvt_pk_bf16_f32 v116, v120, v121
    v_cvt_pk_bf16_f32 v117, v122, v123
    ds_write_b64 v10, v[116:117] offset:32
    s_waitcnt lgkmcnt(11)
    v_mfma_f32_32x32x16_bf16 v[128:143], a[56:59], v[40:43], v[128:143]
    ds_read_b64_tr_b16 v[28:29], v3 offset:15648
    ds_read_b64_tr_b16 v[30:31], v3 offset:16936
    buffer_store_dwordx4 v[64:67], v4, s[28:31], 0 offen sc1
    v_add_u32 v4, 2097152, v4
    v_cvt_pk_bf16_f32 v118, v124, v125
    v_cvt_pk_bf16_f32 v119, v126, v127
    ds_write_b64 v10, v[118:119] offset:48
    s_waitcnt lgkmcnt(12)
    v_mfma_f32_32x32x16_bf16 v[128:143], a[60:63], v[44:47], v[128:143]
    ds_read_b64_tr_b16 v[32:33], v3 offset:20800
    ds_read_b64_tr_b16 v[34:35], v3 offset:22088
    ds_read_b128 v[52:55], v11 offset:0
    s_waitcnt lgkmcnt(13)
    v_mfma_f32_32x32x16_bf16 v[128:143], a[64:67], v[16:19], v[128:143]
    ds_read_b64_tr_b16 v[36:37], v3 offset:25952
    ds_read_b64_tr_b16 v[38:39], v3 offset:27240
    ds_read_b128 v[56:59], v11 offset:1280
    s_waitcnt lgkmcnt(13)
    v_mfma_f32_32x32x16_bf16 v[128:143], a[68:71], v[20:23], v[128:143]
    ds_read_b64_tr_b16 v[40:41], v3 offset:31104
    ds_read_b64_tr_b16 v[42:43], v3 offset:32392
    s_waitcnt lgkmcnt(12)
    v_mfma_f32_32x32x16_bf16 v[128:143], a[72:75], v[24:27], v[128:143]
    ds_read_b64_tr_b16 v[44:45], v3 offset:36256
    ds_read_b64_tr_b16 v[46:47], v3 offset:37544
    s_waitcnt lgkmcnt(11)
    v_mfma_f32_32x32x16_bf16 v[128:143], a[76:79], v[28:31], v[128:143]
    ds_read_b64_tr_b16 v[16:17], v2 offset:256
    ds_read_b64_tr_b16 v[18:19], v2 offset:1544
    s_waitcnt lgkmcnt(10)
    v_mfma_f32_32x32x16_bf16 v[128:143], a[80:83], v[32:35], v[128:143]
    ds_read_b64_tr_b16 v[20:21], v2 offset:5408
    ds_read_b64_tr_b16 v[22:23], v2 offset:6696
    s_waitcnt lgkmcnt(9)
    v_mfma_f32_32x32x16_bf16 v[128:143], a[84:87], v[36:39], v[128:143]
    ds_read_b64_tr_b16 v[24:25], v2 offset:10560
    ds_read_b64_tr_b16 v[26:27], v2 offset:11848
    buffer_store_dwordx4 v[52:55], v4, s[28:31], 0 offen sc1
    v_add_u32 v4, 2097152, v4
    s_waitcnt lgkmcnt(8)
    v_mfma_f32_32x32x16_bf16 v[128:143], a[88:91], v[40:43], v[128:143]
    ds_read_b64_tr_b16 v[28:29], v2 offset:15712
    ds_read_b64_tr_b16 v[30:31], v2 offset:17000
    buffer_store_dwordx4 v[56:59], v4, s[28:31], 0 offen sc1
    v_add_u32 v4, 2097152, v4
    s_waitcnt lgkmcnt(8)
    v_mfma_f32_32x32x16_bf16 v[128:143], a[92:95], v[44:47], v[128:143]
    ds_read_b64_tr_b16 v[32:33], v2 offset:20864
    ds_read_b64_tr_b16 v[34:35], v2 offset:22152
    s_waitcnt lgkmcnt(8)
    v_mfma_f32_32x32x16_bf16 v[144:159], a[32:35], v[16:19], 0
    ds_read_b64_tr_b16 v[36:37], v2 offset:26016
    ds_read_b64_tr_b16 v[38:39], v2 offset:27304
    s_waitcnt lgkmcnt(8)
    v_mfma_f32_32x32x16_bf16 v[144:159], a[36:39], v[20:23], v[144:159]
    ds_read_b64_tr_b16 v[40:41], v2 offset:31168
    ds_read_b64_tr_b16 v[42:43], v2 offset:32456
    s_waitcnt lgkmcnt(8)
    v_mfma_f32_32x32x16_bf16 v[144:159], a[40:43], v[24:27], v[144:159]
    ds_read_b64_tr_b16 v[44:45], v2 offset:36320
    ds_read_b64_tr_b16 v[46:47], v2 offset:37608
    s_waitcnt lgkmcnt(8)
    v_mfma_f32_32x32x16_bf16 v[144:159], a[44:47], v[28:31], v[144:159]
    ds_read_b64_tr_b16 v[16:17], v3 offset:256
    ds_read_b64_tr_b16 v[18:19], v3 offset:1544
    v_cvt_pk_bf16_f32 v128, v128, v129
    v_cvt_pk_bf16_f32 v129, v130, v131
    ds_write_b64 v10, v[128:129] offset:2560
    s_waitcnt lgkmcnt(9)
    v_mfma_f32_32x32x16_bf16 v[144:159], a[48:51], v[32:35], v[144:159]
    ds_read_b64_tr_b16 v[20:21], v3 offset:5408
    ds_read_b64_tr_b16 v[22:23], v3 offset:6696
    v_cvt_pk_bf16_f32 v130, v132, v133
    v_cvt_pk_bf16_f32 v131, v134, v135
    ds_write_b64 v10, v[130:131] offset:2576
    s_waitcnt lgkmcnt(10)
    v_mfma_f32_32x32x16_bf16 v[144:159], a[52:55], v[36:39], v[144:159]
    ds_read_b64_tr_b16 v[24:25], v3 offset:10560
    ds_read_b64_tr_b16 v[26:27], v3 offset:11848
    v_cvt_pk_bf16_f32 v132, v136, v137
    v_cvt_pk_bf16_f32 v133, v138, v139
    ds_write_b64 v10, v[132:133] offset:2592
    s_waitcnt lgkmcnt(11)
    v_mfma_f32_32x32x16_bf16 v[144:159], a[56:59], v[40:43], v[144:159]
    ds_read_b64_tr_b16 v[28:29], v3 offset:15712
    ds_read_b64_tr_b16 v[30:31], v3 offset:17000
    v_cvt_pk_bf16_f32 v134, v140, v141
    v_cvt_pk_bf16_f32 v135, v142, v143
    ds_write_b64 v10, v[134:135] offset:2608
    s_waitcnt lgkmcnt(12)
    v_mfma_f32_32x32x16_bf16 v[144:159], a[60:63], v[44:47], v[144:159]
    ds_read_b64_tr_b16 v[32:33], v3 offset:20864
    ds_read_b64_tr_b16 v[34:35], v3 offset:22152
    ds_read_b128 v[60:63], v11 offset:2560
    s_waitcnt lgkmcnt(13)
    v_mfma_f32_32x32x16_bf16 v[144:159], a[64:67], v[16:19], v[144:159]
    ds_read_b64_tr_b16 v[36:37], v3 offset:26016
    ds_read_b64_tr_b16 v[38:39], v3 offset:27304
    ds_read_b128 v[64:67], v11 offset:3840
    s_waitcnt lgkmcnt(13)
    v_mfma_f32_32x32x16_bf16 v[144:159], a[68:71], v[20:23], v[144:159]
    ds_read_b64_tr_b16 v[40:41], v3 offset:31168
    ds_read_b64_tr_b16 v[42:43], v3 offset:32456
    s_waitcnt lgkmcnt(12)
    v_mfma_f32_32x32x16_bf16 v[144:159], a[72:75], v[24:27], v[144:159]
    ds_read_b64_tr_b16 v[44:45], v3 offset:36320
    ds_read_b64_tr_b16 v[46:47], v3 offset:37608
    s_waitcnt lgkmcnt(11)
    v_mfma_f32_32x32x16_bf16 v[144:159], a[76:79], v[28:31], v[144:159]
    s_waitcnt lgkmcnt(8)
    v_mfma_f32_32x32x16_bf16 v[144:159], a[80:83], v[32:35], v[144:159]
    s_waitcnt lgkmcnt(5)
    v_mfma_f32_32x32x16_bf16 v[144:159], a[84:87], v[36:39], v[144:159]
    buffer_store_dwordx4 v[60:63], v4, s[28:31], 0 offen sc1
    v_add_u32 v4, 2097152, v4
    s_waitcnt lgkmcnt(2)
    v_mfma_f32_32x32x16_bf16 v[144:159], a[88:91], v[40:43], v[144:159]
    buffer_store_dwordx4 v[64:67], v4, s[28:31], 0 offen sc1
    v_add_u32 v4, 2097152, v4
    s_waitcnt lgkmcnt(0)
    v_mfma_f32_32x32x16_bf16 v[144:159], a[92:95], v[44:47], v[144:159]
    s_nop 11
    v_cvt_pk_bf16_f32 v144, v144, v145
    v_cvt_pk_bf16_f32 v145, v146, v147
    ds_write_b64 v10, v[144:145] offset:0
    v_cvt_pk_bf16_f32 v146, v148, v149
    v_cvt_pk_bf16_f32 v147, v150, v151
    ds_write_b64 v10, v[146:147] offset:16
    v_cvt_pk_bf16_f32 v148, v152, v153
    v_cvt_pk_bf16_f32 v149, v154, v155
    ds_write_b64 v10, v[148:149] offset:32
    v_cvt_pk_bf16_f32 v150, v156, v157
    v_cvt_pk_bf16_f32 v151, v158, v159
    ds_write_b64 v10, v[150:151] offset:48
    ds_read_b128 v[52:55], v11 offset:0
    ds_read_b128 v[56:59], v11 offset:1280
    s_waitcnt lgkmcnt(1)
    buffer_store_dwordx4 v[52:55], v4, s[28:31], 0 offen sc1
    v_add_u32 v4, 2097152, v4
    s_waitcnt lgkmcnt(0)
    buffer_store_dwordx4 v[56:59], v4, s[28:31], 0 offen sc1
    v_add_u32 v4, 2097152, v4
L_end:
    s_endpgm
.section .rodata,"a"
.p2align 6
.amdhsa_kernel standalone__tensor_product_equiv_mace__graph_kernel
  .amdhsa_next_free_vgpr 256
  .amdhsa_next_free_sgpr 102
  .amdhsa_accum_offset 160
  .amdhsa_group_segment_fixed_size 0
  .amdhsa_kernarg_size 88
  .amdhsa_user_sgpr_count 2
  .amdhsa_user_sgpr_kernarg_segment_ptr 1
  .amdhsa_system_sgpr_workgroup_id_x 1
  .amdhsa_float_denorm_mode_32 3
.end_amdhsa_kernel
```

```asm
; @launch grid=(256,1,1) block=(512,1,1) lds=153600
.amdgcn_target "amdgcn-amd-amdhsa--gfx950"
.text
.globl standalone__tensor_product_equiv_mace__graph_kernel
.p2align 8
.type standalone__tensor_product_equiv_mace__graph_kernel,@function
standalone__tensor_product_equiv_mace__graph_kernel:
    s_cmp_ge_u32 s2, 256
    s_cbranch_scc1 L_end
    s_load_dwordx2 s[84:85], s[0:1], 80
    s_load_dwordx16 s[64:79], s[0:1], 0
    s_load_dwordx2 s[80:81], s[0:1], 64
    v_and_b32 v1, 63, v0
    v_lshrrev_b32 v60, 6, v0
    v_mov_b32 v12, 0
    v_readfirstlane_b32 s3, v60
    s_and_b32 s55, s2, 63
    s_and_b32 s54, s2, 192
    s_mul_i32 s53, s55, 10000
    v_lshlrev_b32 v63, 4, v0
    v_add_u32 v60, s53, v63
    s_add_u32 s53, s53, 8192
    v_lshl_add_u32 v61, v0, 2, s53
    s_lshl_b32 s53, s54, 1
    v_mov_b32 v62, s53
    s_waitcnt lgkmcnt(0)
    s_mov_b32 s16, s68
    s_mov_b32 s17, s69
    s_mov_b32 s18, 640000
    s_mov_b32 s19, 0x00020000
    buffer_load_dwordx4 v[16:19], v60, s[16:19], 0 offen
    buffer_load_dword v20, v61, s[16:19], 0 offen
    s_mov_b32 s12, s66
    s_mov_b32 s13, s67
    s_mov_b32 s14, 640000
    s_mov_b32 s15, 0x00020000
    buffer_load_dwordx4 v[24:27], v60, s[12:15], 0 offen
    buffer_load_dword v28, v61, s[12:15], 0 offen
    s_mov_b32 s32, s84
    s_mov_b32 s33, s85
    s_mov_b32 s34, 20971520
    s_mov_b32 s35, 0x00020000
    buffer_load_dword v42, v62, s[32:35], 0 offen sc1
    s_mov_b32 s20, s70
    s_mov_b32 s21, s71
    s_mov_b32 s22, 1280000
    s_mov_b32 s23, 0x00020000
    v_mov_b32 v72, -1
    v_mov_b32 v73, -1
    v_mov_b32 v74, -1
    v_mov_b32 v75, -1
    ds_write_b128 v63, v[72:75] offset:0
    ds_write_b128 v63, v[72:75] offset:8192
    v_mov_b32 v68, 0
    v_mov_b32 v69, 0
    v_lshlrev_b32 v60, 3, v0
    v_add_u32 v60, 111136, v60
    ds_write_b64 v60, v[68:69]
    v_min_u32 v60, 35, v1
    v_lshlrev_b32 v60, 3, v60
    v_add_u32 v60, 110848, v60
    ds_write_b64 v60, v[68:69]
    s_mov_b32 s8, s64
    s_mov_b32 s9, s65
    s_mov_b32 s10, 20480000
    s_mov_b32 s11, 0x00020000
    s_mov_b32 s24, s72
    s_mov_b32 s25, s73
    s_mov_b32 s26, 5120000
    s_mov_b32 s27, 0x00020000
    s_mov_b32 s28, s80
    s_mov_b32 s29, s81
    s_mov_b32 s30, 20480000
    s_mov_b32 s31, 0x00020000
    s_mov_b32 s96, s74
    s_mov_b32 s97, s75
    s_mov_b32 s98, 128
    s_mov_b32 s99, 0x00020000
    s_mov_b32 s92, s76
    s_mov_b32 s93, s77
    s_mov_b32 s94, 8192
    s_mov_b32 s95, 0x00020000
    s_mov_b32 s88, s78
    s_mov_b32 s89, s79
    s_mov_b32 s90, 131072
    s_mov_b32 s91, 0x00020000
    s_lshl_b32 s63, s3, 13
    s_mov_b32 s52, 0
    s_mov_b32 s77, 0
    s_mov_b32 s82, 0x3fff00
    s_mov_b32 s83, 20971520
    s_mov_b32 s81, 8
    s_lshl_b32 s49, s3, 10
    s_add_u32 s49, s49, 119328
    s_movk_i32 s53, 452
    v_cmp_gt_u32 s[50:51], s53, v0
    v_lshlrev_b32 v43, 22, v0
    v_lshlrev_b32 v59, 20, v0
    v_mov_b32 v58, 1
    s_waitcnt lgkmcnt(0)
    s_barrier
    v_and_b32 v60, 3, v1
    v_lshlrev_b32 v61, 5, v60
    v_lshrrev_b32 v66, 4, v1
    v_lshl_add_u32 v61, v66, 1, v61
    buffer_load_ushort v44, v61, s[96:99], 0 offen offset:0
    buffer_load_ushort v45, v61, s[96:99], 0 offen offset:8
    buffer_load_ushort v46, v61, s[96:99], 0 offen offset:16
    buffer_load_ushort v47, v61, s[96:99], 0 offen offset:24
    s_lshl_b32 s53, s3, 10
    s_add_u32 m0, s53, 32768
    v_bfe_u32 v62, v1, 1, 2
    v_bfe_u32 v64, v1, 3, 1
    v_lshl_add_u32 v62, v64, 3, v62
    v_bfe_u32 v64, v1, 4, 1
    v_lshl_add_u32 v62, v64, 2, v62
    v_lshlrev_b32 v62, 9, v62
    v_lshrrev_b32 v64, 5, v1
    v_lshl_add_u32 v62, v64, 5, v62
    v_and_b32 v64, 1, v1
    v_lshl_add_u32 v62, v64, 4, v62
    s_lshl_b32 s53, s3, 6
    buffer_load_dwordx4 v62, s[92:95], s53 offen lds
    v_lshlrev_b32 v64, 4, v1
    s_lshr_b32 s53, s2, 3
    s_lshl3_add_u32 s53, s53, s3
    s_lshl_b32 s53, s53, 10
    v_add_u32 v79, s53, v64
    buffer_load_dwordx4 v[156:159], v79, s[20:23], 0 offen
    v_add_u32 v79, 262144, v79
    buffer_load_dwordx4 v[156:159], v79, s[20:23], 0 offen
    v_add_u32 v79, 262144, v79
    v_and_b32 v61, 7, v1
    v_bfe_u32 v65, v1, 3, 1
    v_lshlrev_b32 v65, 9, v65
    v_lshl_add_u32 v65, v66, 7, v65
    v_lshl_add_u32 v2, v61, 4, v65
    v_xor_b32 v61, 4, v61
    v_lshl_add_u32 v3, v61, 4, v65
    v_bfe_u32 v60, v1, 2, 2
    v_bfe_u32 v62, v1, 1, 1
    v_lshl_add_u32 v62, v66, 1, v62
    v_lshrrev_b32 v63, 1, v60
    v_lshlrev_b32 v64, 2, v63
    v_xor_b32 v62, v62, v64
    v_and_b32 v64, 1, v60
    v_lshl_add_u32 v62, v64, 3, v62
    v_lshlrev_b32 v62, 4, v62
    v_lshl_add_u32 v62, v63, 10, v62
    v_and_b32 v64, 1, v1
    v_lshl_add_u32 v62, v64, 3, v62
    v_add_u32 v4, s63, v62
    v_lshrrev_b32 v61, 5, v1
    v_mov_b32 v63, 32
    v_cmp_eq_u32 vcc, v60, v61
    v_add_u32 v61, 2, v61
    v_and_b32 v64, 3, v1
    v_cndmask_b32 v7, 0, v63, vcc
    v_cmp_eq_u32 vcc, v60, v61
    v_cmp_eq_u32 s[4:5], v64, v66
    v_mov_b32 v65, 8
    v_cndmask_b32 v8, 0, v63, vcc
    v_cndmask_b32 v10, 0, v65, s[4:5]
    v_lshrrev_b32 v68, 3, v0
    v_and_b32 v69, 7, v0
    v_lshlrev_b32 v69, 4, v69
    v_add_u32 v61, s54, v68
    s_movk_i32 s46, 8320
    v_mad_u32_u24 v64, v61, s46, v69
    s_lshl_b32 s45, s55, 7
    s_add_u32 s53, s45, 8388608
    v_add_u32 v64, s53, v64
    v_lshl_add_u32 v65, v61, 13, v69
    s_add_u32 s53, s45, 16777216
    v_add_u32 v65, s53, v65
    v_lshlrev_b32 v61, 4, v0
    s_mov_b32 s53, 110880
    v_lshl_add_u32 v67, v68, 2, s53
    s_waitcnt vmcnt(10)
    v_and_b32 v48, 255, v16
    v_subrev_u32 v48, s54, v48
    v_cmp_gt_u32 s[64:65], 64, v48
    v_lshl_add_u32 v60, v48, 2, s53
    s_mov_b64 exec, s[64:65]
    ds_add_rtn_u32 v53, v60, v58
    s_mov_b64 exec, -1
    v_and_b32 v49, 255, v17
    v_subrev_u32 v49, s54, v49
    v_cmp_gt_u32 s[66:67], 64, v49
    v_lshl_add_u32 v60, v49, 2, s53
    s_mov_b64 exec, s[66:67]
    ds_add_rtn_u32 v54, v60, v58
    s_mov_b64 exec, -1
    v_and_b32 v50, 255, v18
    v_subrev_u32 v50, s54, v50
    v_cmp_gt_u32 s[68:69], 64, v50
    v_lshl_add_u32 v60, v50, 2, s53
    s_mov_b64 exec, s[68:69]
    ds_add_rtn_u32 v55, v60, v58
    s_mov_b64 exec, -1
    v_and_b32 v51, 255, v19
    v_subrev_u32 v51, s54, v51
    v_cmp_gt_u32 s[70:71], 64, v51
    v_lshl_add_u32 v60, v51, 2, s53
    s_mov_b64 exec, s[70:71]
    ds_add_rtn_u32 v56, v60, v58
    s_mov_b64 exec, -1
    v_and_b32 v52, 255, v20
    v_subrev_u32 v52, s54, v52
    v_cmp_gt_u32 s[72:73], 64, v52
    v_lshl_add_u32 v60, v52, 2, s53
    s_and_b64 s[72:73], s[72:73], s[50:51]
    s_mov_b64 exec, s[72:73]
    ds_add_rtn_u32 v57, v60, v58
    s_mov_b64 exec, -1
    s_waitcnt vmcnt(7)
    v_readfirstlane_b32 s48, v42
    buffer_load_dwordx4 v[156:159], v79, s[20:23], 0 offen
    v_add_u32 v79, 262144, v79
    buffer_load_dwordx4 v[156:159], v79, s[20:23], 0 offen
    v_add_u32 v79, 262144, v79
    buffer_load_dwordx4 v[156:159], v79, s[20:23], 0 offen
    v_add_u32 v79, 262144, v79
    v_bfe_u32 v16, v16, 8, 6
    v_min_u32 v16, 47, v16
    v_min_u32 v24, 9999, v24
    v_lshl_or_b32 v16, v24, 6, v16
    v_add_u32 v24, 0, v43
    v_or_b32 v16, v16, v24
    v_lshlrev_b32 v48, 7, v48
    v_bfe_u32 v17, v17, 8, 6
    v_min_u32 v17, 47, v17
    v_min_u32 v25, 9999, v25
    v_lshl_or_b32 v17, v25, 6, v17
    v_add_u32 v25, 1048576, v43
    v_or_b32 v17, v17, v25
    v_lshlrev_b32 v49, 7, v49
    v_bfe_u32 v18, v18, 8, 6
    v_min_u32 v18, 47, v18
    v_min_u32 v26, 9999, v26
    v_lshl_or_b32 v18, v26, 6, v18
    v_add_u32 v26, 2097152, v43
    v_or_b32 v18, v18, v26
    v_lshlrev_b32 v50, 7, v50
    v_bfe_u32 v19, v19, 8, 6
    v_min_u32 v19, 47, v19
    v_min_u32 v27, 9999, v27
    v_lshl_or_b32 v19, v27, 6, v19
    v_add_u32 v27, 3145728, v43
    v_or_b32 v19, v19, v27
    v_lshlrev_b32 v51, 7, v51
    v_bfe_u32 v20, v20, 8, 6
    v_min_u32 v20, 47, v20
    v_min_u32 v28, 9999, v28
    v_lshl_or_b32 v20, v28, 6, v20
    v_add_u32 v28, 2147483648, v59
    v_or_b32 v20, v20, v28
    v_lshlrev_b32 v52, 7, v52
    v_mov_b32 v59, -2
    s_add_u32 s48, s48, 1
    s_movk_i32 s53, 7808
    s_waitcnt lgkmcnt(0)
    v_cmp_gt_u32 vcc, 31, v53
    v_min_u32 v53, 31, v53
    v_mul_u32_u24 v32, 43, v53
    v_cndmask_b32 v16, v59, v16, vcc
    v_lshrrev_b32 v32, 7, v32
    v_cmp_gt_u32 vcc, 24, v53
    v_add_lshl_u32 v32, v32, v53, 2
    v_lshl_add_u32 v33, v53, 4, s53
    v_cndmask_b32 v32, v33, v32, vcc
    v_add_u32 v48, v48, v32
    s_mov_b64 exec, s[64:65]
    ds_write_b32 v48, v16 offset:0
    s_mov_b64 exec, -1
    v_cmp_gt_u32 vcc, 31, v54
    v_min_u32 v54, 31, v54
    v_mul_u32_u24 v32, 43, v54
    v_cndmask_b32 v17, v59, v17, vcc
    v_lshrrev_b32 v32, 7, v32
    v_cmp_gt_u32 vcc, 24, v54
    v_add_lshl_u32 v32, v32, v54, 2
    v_lshl_add_u32 v33, v54, 4, s53
    v_cndmask_b32 v32, v33, v32, vcc
    v_add_u32 v49, v49, v32
    s_mov_b64 exec, s[66:67]
    ds_write_b32 v49, v17 offset:0
    s_mov_b64 exec, -1
    v_cmp_gt_u32 vcc, 31, v55
    v_min_u32 v55, 31, v55
    v_mul_u32_u24 v32, 43, v55
    v_cndmask_b32 v18, v59, v18, vcc
    v_lshrrev_b32 v32, 7, v32
    v_cmp_gt_u32 vcc, 24, v55
    v_add_lshl_u32 v32, v32, v55, 2
    v_lshl_add_u32 v33, v55, 4, s53
    v_cndmask_b32 v32, v33, v32, vcc
    v_add_u32 v50, v50, v32
    s_mov_b64 exec, s[68:69]
    ds_write_b32 v50, v18 offset:0
    s_mov_b64 exec, -1
    v_cmp_gt_u32 vcc, 31, v56
    v_min_u32 v56, 31, v56
    v_mul_u32_u24 v32, 43, v56
    v_cndmask_b32 v19, v59, v19, vcc
    v_lshrrev_b32 v32, 7, v32
    v_cmp_gt_u32 vcc, 24, v56
    v_add_lshl_u32 v32, v32, v56, 2
    v_lshl_add_u32 v33, v56, 4, s53
    v_cndmask_b32 v32, v33, v32, vcc
    v_add_u32 v51, v51, v32
    s_mov_b64 exec, s[70:71]
    ds_write_b32 v51, v19 offset:0
    s_mov_b64 exec, -1
    v_cmp_gt_u32 vcc, 31, v57
    v_min_u32 v57, 31, v57
    v_mul_u32_u24 v32, 43, v57
    v_cndmask_b32 v20, v59, v20, vcc
    v_lshrrev_b32 v32, 7, v32
    v_cmp_gt_u32 vcc, 24, v57
    v_add_lshl_u32 v32, v32, v57, 2
    v_lshl_add_u32 v33, v57, 4, s53
    v_cndmask_b32 v32, v33, v32, vcc
    v_add_u32 v52, v52, v32
    s_mov_b64 exec, s[72:73]
    ds_write_b32 v52, v20 offset:0
    s_mov_b64 exec, -1
    s_waitcnt lgkmcnt(0)
    s_barrier
    ds_read_b128 v[16:19], v61 offset:0
    ds_read_b32 v67, v67
    s_waitcnt lgkmcnt(1)
    v_mov_b32 v19, s48
    buffer_store_dwordx4 v[16:19], v64, s[32:35], 0 offen sc1
    s_waitcnt lgkmcnt(0)
    v_cmp_lt_u32 vcc, 23, v67
    s_cbranch_vccz L_noup
    ds_read_b128 v[28:31], v61 offset:8192
    s_waitcnt lgkmcnt(0)
    v_mov_b32 v31, s48
    s_mov_b64 exec, vcc
    buffer_store_dwordx4 v[28:31], v65, s[32:35], 0 offen sc1
    s_mov_b64 exec, -1
L_noup:
    s_cmp_ge_u32 s3, 2
    s_cbranch_scc1 L_nowf
    s_lshl1_add_u32 s44, s55, s3
    s_and_b32 s53, s44, 15
    s_lshl_b32 s53, s53, 13
    s_lshr_b32 s76, s44, 4
    s_lshl_b32 s76, s76, 6
    s_add_u32 s53, s53, s76
    v_lshrrev_b32 v60, 5, v1
    v_lshlrev_b32 v60, 12, v60
    v_and_b32 v61, 31, v1
    v_lshl_add_u32 v60, v61, 1, v60
    v_add_u32 v60, s53, v60
    buffer_load_ushort v32, v60, s[88:91], 0 offen offset:0
    buffer_load_ushort v33, v60, s[88:91], 0 offen offset:512
    buffer_load_ushort v34, v60, s[88:91], 0 offen offset:1024
    buffer_load_ushort v35, v60, s[88:91], 0 offen offset:1536
    buffer_load_ushort v36, v60, s[88:91], 0 offen offset:2048
    buffer_load_ushort v37, v60, s[88:91], 0 offen offset:2560
    buffer_load_ushort v38, v60, s[88:91], 0 offen offset:3072
    buffer_load_ushort v39, v60, s[88:91], 0 offen offset:3584
L_nowf:
    v_lshrrev_b32 v60, 5, v1
    v_bfe_u32 v61, v1, 2, 2
    v_bfe_u32 v62, v1, 4, 1
    v_and_b32 v63, 3, v1
    v_lshlrev_b32 v77, 7, v62
    v_lshl_add_u32 v77, v61, 5, v77
    v_lshl_add_u32 v77, v60, 9, v77
    v_lshl_add_u32 v77, v63, 3, v77
    s_mul_i32 s53, s2, 8320
    s_add_u32 s53, s53, 8388608
    v_lshl_add_u32 v70, v0, 4, s53
    s_lshl_b32 s53, s2, 13
    s_add_u32 s53, s53, 16777216
    v_lshl_add_u32 v71, v0, 4, s53
    v_mul_u32_u24 v73, 2500, v68
    v_mov_b64 v[80:81], 0
    v_mov_b64 v[82:83], 0
    v_mov_b64 v[84:85], 0
    v_mov_b64 v[86:87], 0
    v_mov_b64 v[88:89], 0
    v_mov_b64 v[90:91], 0
    v_mov_b64 v[92:93], 0
    v_mov_b64 v[94:95], 0
    v_mov_b64 v[96:97], 0
    v_mov_b64 v[98:99], 0
    v_mov_b64 v[100:101], 0
    v_mov_b64 v[102:103], 0
    v_mov_b64 v[104:105], 0
    v_mov_b64 v[106:107], 0
    v_mov_b64 v[108:109], 0
    v_mov_b64 v[110:111], 0
    v_mov_b64 v[112:113], 0
    v_mov_b64 v[114:115], 0
    v_mov_b64 v[116:117], 0
    v_mov_b64 v[118:119], 0
    v_mov_b64 v[120:121], 0
    v_mov_b64 v[122:123], 0
    v_mov_b64 v[124:125], 0
    v_mov_b64 v[126:127], 0
    v_mov_b64 v[128:129], 0
    v_mov_b64 v[130:131], 0
    v_mov_b64 v[132:133], 0
    v_mov_b64 v[134:135], 0
    v_mov_b64 v[136:137], 0
    v_mov_b64 v[138:139], 0
    v_mov_b64 v[140:141], 0
    v_mov_b64 v[142:143], 0
    v_mov_b64 v[144:145], 0
    v_mov_b64 v[146:147], 0
    v_mov_b64 v[148:149], 0
    v_mov_b64 v[150:151], 0
    v_mov_b64 v[152:153], 0
    v_mov_b64 v[154:155], 0
    s_mov_b64 s[6:7], -1
    s_mov_b32 s55, 0
    s_waitcnt vmcnt(0)
L_poll:
    s_mov_b64 exec, s[6:7]
    buffer_load_dwordx4 v[48:51], v70, s[32:35], 0 offen sc1
    s_mov_b64 exec, -1
    s_waitcnt vmcnt(0)
    v_cmp_ne_u32 s[6:7], s48, v51
    s_cmp_eq_u64 s[6:7], 0
    s_cbranch_scc1 L_got
    s_sleep 4
    s_add_u32 s55, s55, 1
    s_cmp_lt_u32 s55, 0x400000
    s_cbranch_scc1 L_poll
    s_endpgm
L_got:
    v_cmp_gt_u32 s[36:37], -2, v48
    v_cmp_gt_u32 s[38:39], -2, v49
    v_cmp_gt_u32 s[40:41], -2, v50
    v_mov_b32 v52, -1
    s_mov_b64 s[42:43], 0
    s_mov_b32 s53, 0x80808080
    s_and_b32 s6, s40, s53
    s_and_b32 s7, s41, s53
    s_cmp_eq_u64 s[6:7], 0
    s_cbranch_scc1 L_noext
    s_lshr_b64 s[6:7], s[6:7], 7
    s_mul_i32 s6, s6, 255
    s_mul_i32 s7, s7, 255
    v_mov_b32 v55, s48
L_poll2:
    s_mov_b64 exec, s[6:7]
    buffer_load_dwordx4 v[52:55], v71, s[32:35], 0 offen sc1
    s_mov_b64 exec, -1
    s_waitcnt vmcnt(0)
    v_cmp_ne_u32 vcc, s48, v55
    s_cbranch_vccz L_got2
    s_sleep 1
    s_add_u32 s55, s55, 1
    s_cmp_lt_u32 s55, 0x400000
    s_cbranch_scc1 L_poll2
    s_endpgm
L_got2:
    v_cmp_gt_u32 s[42:43], -2, v52
L_noext:
    v_cmp_eq_u32 vcc, -2, v52
    s_bcnt1_i32_b64 s64, s[36:37]
    s_bcnt1_i32_b64 s65, s[38:39]
    s_bcnt1_i32_b64 s66, s[40:41]
    s_bcnt1_i32_b64 s67, s[42:43]
    s_add_u32 s65, s65, s64
    s_add_u32 s66, s66, s65
    s_add_u32 s79, s67, s66
    v_mov_b32 v61, s79
    v_mov_b32 v60, 114912
    s_mov_b64 exec, 1
    ds_add_rtn_u32 v61, v60, v61
    s_mov_b64 exec, -1
    v_mbcnt_lo_u32_b32 v62, s36, 0
    v_mbcnt_hi_u32_b32 v62, s37, v62
    v_lshrrev_b32 v20, 20, v48
    v_add_u32 v20, v20, v73
    v_lshl_add_u32 v66, v62, 2, s49
    s_mov_b64 exec, s[36:37]
    ds_write_b32 v66, v20
    s_mov_b64 exec, -1
    v_lshlrev_b32 v24, 2, v48
    v_and_b32 v24, s82, v24
    v_and_b32 v16, 63, v48
    v_mbcnt_lo_u32_b32 v63, s38, 0
    v_mbcnt_hi_u32_b32 v63, s39, v63
    v_add_u32 v63, s64, v63
    v_lshrrev_b32 v21, 20, v49
    v_add_u32 v21, v21, v73
    v_lshl_add_u32 v66, v63, 2, s49
    s_mov_b64 exec, s[38:39]
    ds_write_b32 v66, v21
    s_mov_b64 exec, -1
    v_lshlrev_b32 v25, 2, v49
    v_and_b32 v25, s82, v25
    v_and_b32 v17, 63, v49
    v_mbcnt_lo_u32_b32 v64, s40, 0
    v_mbcnt_hi_u32_b32 v64, s41, v64
    v_add_u32 v64, s65, v64
    v_lshrrev_b32 v22, 20, v50
    v_add_u32 v22, v22, v73
    v_lshl_add_u32 v66, v64, 2, s49
    s_mov_b64 exec, s[40:41]
    ds_write_b32 v66, v22
    s_mov_b64 exec, -1
    v_lshlrev_b32 v26, 2, v50
    v_and_b32 v26, s82, v26
    v_and_b32 v18, 63, v50
    v_mbcnt_lo_u32_b32 v65, s42, 0
    v_mbcnt_hi_u32_b32 v65, s43, v65
    v_add_u32 v65, s66, v65
    v_lshrrev_b32 v23, 20, v52
    v_add_u32 v23, v23, v73
    v_lshl_add_u32 v66, v65, 2, s49
    s_mov_b64 exec, s[42:43]
    ds_write_b32 v66, v23
    s_mov_b64 exec, -1
    v_lshlrev_b32 v27, 2, v52
    v_and_b32 v27, s82, v27
    v_and_b32 v19, 63, v52
    v_lshl_or_b32 v14, v45, 16, v44
    v_lshl_or_b32 v15, v47, 16, v46
    v_mov_b64 v[156:157], 0
    v_mov_b64 v[158:159], 0
    s_cmp_ge_u32 s3, 2
    s_cbranch_scc1 L_1
    v_lshl_or_b32 v56, v33, 16, v32
    v_lshl_or_b32 v57, v35, 16, v34
    v_lshl_or_b32 v58, v37, 16, v36
    v_lshl_or_b32 v59, v39, 16, v38
    s_lshl_b32 s53, s54, 1
    s_add_u32 s53, s53, s44
    s_lshl2_add_u32 s83, s53, 4096
    s_lshl_b32 s53, s53, 10
    s_add_u32 s53, s53, 1048576
    v_lshl_add_u32 v60, v1, 4, s53
    buffer_store_dwordx4 v[56:59], v60, s[32:35], 0 offen sc1
L_1:
    s_mov_b32 s80, 79
    s_waitcnt lgkmcnt(0)
    v_readfirstlane_b32 s44, v61
    s_cbranch_vccnz L_defer
    s_add_u32 s53, s44, s79
    s_cmp_gt_u32 s53, 1024
    s_cbranch_scc1 L_defer
    v_add_u32 v62, s44, v62
    v_lshl_or_b32 v24, v62, 22, v24
    v_add_u32 v63, s44, v63
    v_lshl_or_b32 v25, v63, 22, v25
    v_add_u32 v64, s44, v64
    v_lshl_or_b32 v26, v64, 22, v26
    v_add_u32 v65, s44, v65
    v_lshl_or_b32 v27, v65, 22, v27
    s_branch L_have
L_defer:
    s_mov_b32 s80, 0
    s_mov_b32 s79, 0
    s_mov_b32 s44, 0
    s_mov_b64 s[36:37], 0
    s_mov_b64 s[38:39], 0
    s_mov_b64 s[40:41], 0
    s_mov_b64 s[42:43], 0
    v_mov_b32 v58, 1
    v_mov_b32 v59, 110864
    ds_write_b32 v59, v58
    s_branch L_have
L_scan:
    s_barrier
    s_mov_b32 s64, s63
    s_add_u32 s65, s63, 1024
    s_xor_b32 s47, s2, 1
L_sloop:
    s_cmp_ge_u32 s80, 79
    s_cbranch_scc1 L_scan_done
    s_mul_i32 s53, s3, 20000
    s_lshl_b32 s54, s80, 8
    s_add_u32 s55, s53, s54
    v_lshlrev_b32 v56, 2, v1
    v_add_u32 v56, s55, v56
    v_lshlrev_b32 v57, 2, v56
    buffer_load_dwordx4 v[60:63], v57, s[16:19], 0 offen
    s_waitcnt vmcnt(0)
    s_cmp_lg_u32 s80, 78
    s_cbranch_scc1 L_snotlast
    s_mov_b32 exec_lo, 0xffffff00
    v_mov_b32 v60, s47
    v_mov_b32 v61, s47
    v_mov_b32 v62, s47
    v_mov_b32 v63, s47
    s_mov_b64 exec, -1
L_snotlast:
    s_cmp_gt_u32 s52, 0
    s_cbranch_scc1 L_2
    v_cmp_eq_u32_sdwa vcc, v60, s2 src0_sel:BYTE_0 src1_sel:DWORD
    s_cbranch_vccz L_2
    s_bcnt1_i32_b64 s53, vcc
    s_lshl3_add_u32 s54, s53, s64
    s_mov_b32 s52, 0
    s_cmp_gt_u32 s54, s65
    s_cbranch_scc1 L_ovf
    v_mbcnt_lo_u32_b32 v58, vcc_lo, 0
    v_mbcnt_hi_u32_b32 v58, vcc_hi, v58
    v_lshl_add_u32 v58, v58, 3, s64
    v_add_u32 v59, 0, v56
    s_mov_b64 exec, vcc
    ds_write2_b32 v58, v60, v59 offset0:0 offset1:1
    s_mov_b64 exec, -1
    s_mov_b32 s64, s54
L_2:
    s_cmp_gt_u32 s52, 1
    s_cbranch_scc1 L_3
    v_cmp_eq_u32_sdwa vcc, v61, s2 src0_sel:BYTE_0 src1_sel:DWORD
    s_cbranch_vccz L_3
    s_bcnt1_i32_b64 s53, vcc
    s_lshl3_add_u32 s54, s53, s64
    s_mov_b32 s52, 1
    s_cmp_gt_u32 s54, s65
    s_cbranch_scc1 L_ovf
    v_mbcnt_lo_u32_b32 v58, vcc_lo, 0
    v_mbcnt_hi_u32_b32 v58, vcc_hi, v58
    v_lshl_add_u32 v58, v58, 3, s64
    v_add_u32 v59, 1, v56
    s_mov_b64 exec, vcc
    ds_write2_b32 v58, v61, v59 offset0:0 offset1:1
    s_mov_b64 exec, -1
    s_mov_b32 s64, s54
L_3:
    s_cmp_gt_u32 s52, 2
    s_cbranch_scc1 L_4
    v_cmp_eq_u32_sdwa vcc, v62, s2 src0_sel:BYTE_0 src1_sel:DWORD
    s_cbranch_vccz L_4
    s_bcnt1_i32_b64 s53, vcc
    s_lshl3_add_u32 s54, s53, s64
    s_mov_b32 s52, 2
    s_cmp_gt_u32 s54, s65
    s_cbranch_scc1 L_ovf
    v_mbcnt_lo_u32_b32 v58, vcc_lo, 0
    v_mbcnt_hi_u32_b32 v58, vcc_hi, v58
    v_lshl_add_u32 v58, v58, 3, s64
    v_add_u32 v59, 2, v56
    s_mov_b64 exec, vcc
    ds_write2_b32 v58, v62, v59 offset0:0 offset1:1
    s_mov_b64 exec, -1
    s_mov_b32 s64, s54
L_4:
    s_cmp_gt_u32 s52, 3
    s_cbranch_scc1 L_5
    v_cmp_eq_u32_sdwa vcc, v63, s2 src0_sel:BYTE_0 src1_sel:DWORD
    s_cbranch_vccz L_5
    s_bcnt1_i32_b64 s53, vcc
    s_lshl3_add_u32 s54, s53, s64
    s_mov_b32 s52, 3
    s_cmp_gt_u32 s54, s65
    s_cbranch_scc1 L_ovf
    v_mbcnt_lo_u32_b32 v58, vcc_lo, 0
    v_mbcnt_hi_u32_b32 v58, vcc_hi, v58
    v_lshl_add_u32 v58, v58, 3, s64
    v_add_u32 v59, 3, v56
    s_mov_b64 exec, vcc
    ds_write2_b32 v58, v63, v59 offset0:0 offset1:1
    s_mov_b64 exec, -1
    s_mov_b32 s64, s54
L_5:
    s_mov_b32 s52, 0
    s_add_u32 s80, s80, 1
    s_branch L_sloop
L_ovf:
    v_mov_b32 v58, 1
    v_mov_b32 v59, 110864
    ds_write_b32 v59, v58
L_scan_done:
    s_sub_u32 s79, s64, s63
    s_lshr_b32 s79, s79, 3
    s_lshl_b32 s44, s3, 7
    v_lshlrev_b32 v58, 3, v1
    v_add_u32 v58, s63, v58
    s_waitcnt lgkmcnt(0)
    ds_read_b32 v16, v58 offset:0
    ds_read_b32 v20, v58 offset:4
    s_sub_u32 s53, s79, 0
    v_cmp_gt_i32 s[36:37], s53, v1
    ds_read_b32 v17, v58 offset:512
    ds_read_b32 v21, v58 offset:516
    s_sub_u32 s53, s79, 64
    v_cmp_gt_i32 s[38:39], s53, v1
    s_mov_b64 s[40:41], 0
    v_mov_b32 v18, 0
    v_mov_b32 v26, 0
    s_mov_b64 s[42:43], 0
    v_mov_b32 v19, 0
    v_mov_b32 v27, 0
    v_lshl_add_u32 v58, v1, 2, s49
    v_add_u32 v59, s44, v1
    v_lshlrev_b32 v59, 22, v59
    s_waitcnt lgkmcnt(0)
    v_lshlrev_b32 v28, 2, v20
    buffer_load_dword v24, v28, s[12:15], 0 offen
    v_bfe_u32 v16, v16, 8, 6
    v_min_u32 v16, 47, v16
    ds_write_b32 v58, v20 offset:0
    v_lshlrev_b32 v29, 2, v21
    buffer_load_dword v25, v29, s[12:15], 0 offen
    v_bfe_u32 v17, v17, 8, 6
    v_min_u32 v17, 47, v17
    ds_write_b32 v58, v21 offset:256
    s_waitcnt vmcnt(0)
    v_min_u32 v24, 9999, v24
    v_lshl_or_b32 v24, v24, 8, v59
    v_add_u32 v59, 268435456, v59
    v_min_u32 v25, 9999, v25
    v_lshl_or_b32 v25, v25, 8, v59
    v_add_u32 v59, 268435456, v59
L_have:
    v_mov_b32 v58, 1
    s_mov_b32 s53, 111136
    s_mov_b32 s54, 114976
    v_bfe_u32 v28, v24, 8, 14
    v_mul_u32_u24 v28, 6711, v28
    v_lshrrev_b32 v28, 22, v28
    v_min_u32 v28, 15, v28
    v_lshl_add_u32 v28, v28, 2, s53
    v_lshl_add_u32 v28, v16, 6, v28
    v_lshl_add_u32 v16, v16, 2, s54
    s_mov_b64 exec, s[36:37]
    ds_add_rtn_u32 v32, v28, v58
    ds_add_u32 v16, v58
    s_mov_b64 exec, -1
    v_bfe_u32 v29, v25, 8, 14
    v_mul_u32_u24 v29, 6711, v29
    v_lshrrev_b32 v29, 22, v29
    v_min_u32 v29, 15, v29
    v_lshl_add_u32 v29, v29, 2, s53
    v_lshl_add_u32 v29, v17, 6, v29
    v_lshl_add_u32 v17, v17, 2, s54
    s_mov_b64 exec, s[38:39]
    ds_add_rtn_u32 v33, v29, v58
    ds_add_u32 v17, v58
    s_mov_b64 exec, -1
    v_bfe_u32 v30, v26, 8, 14
    v_mul_u32_u24 v30, 6711, v30
    v_lshrrev_b32 v30, 22, v30
    v_min_u32 v30, 15, v30
    v_lshl_add_u32 v30, v30, 2, s53
    v_lshl_add_u32 v30, v18, 6, v30
    v_lshl_add_u32 v18, v18, 2, s54
    s_mov_b64 exec, s[40:41]
    ds_add_rtn_u32 v34, v30, v58
    ds_add_u32 v18, v58
    s_mov_b64 exec, -1
    v_bfe_u32 v31, v27, 8, 14
    v_mul_u32_u24 v31, 6711, v31
    v_lshrrev_b32 v31, 22, v31
    v_min_u32 v31, 15, v31
    v_lshl_add_u32 v31, v31, 2, s53
    v_lshl_add_u32 v31, v19, 6, v31
    v_lshl_add_u32 v19, v19, 2, s54
    s_mov_b64 exec, s[42:43]
    ds_add_rtn_u32 v35, v31, v58
    ds_add_u32 v19, v58
    s_mov_b64 exec, -1
    v_lshrrev_b32 v36, 1, v1
    v_lshl_add_u32 v39, v36, 2, s49
    ds_read_b32 v40, v39 offset:0
    ds_read_b32 v41, v39 offset:128
    ds_read_b32 v42, v39 offset:256
    ds_read_b32 v43, v39 offset:384
    v_and_b32 v38, 1, v1
    v_lshlrev_b32 v37, 4, v38
    v_lshlrev_b32 v38, 2, v38
    s_mov_b32 s46, s79
    s_mov_b32 s45, s44
    v_lshl_add_u32 v56, v1, 2, s54
    v_mov_b32 v57, 110864
    s_waitcnt lgkmcnt(0)
    s_cmp_le_i32 s46, 0
    s_cbranch_scc1 L_6
    v_lshl_add_u32 v44, v40, 5, v37
    v_lshl_add_u32 v45, v40, 3, v38
    v_cmp_gt_i32 vcc, s46, v36
    s_lshl_b32 s76, s45, 5
    s_add_u32 m0, s76, 65536
    s_mov_b64 exec, vcc
    buffer_load_dwordx4 v44, s[24:27], 0 offen lds
    s_lshl3_add_u32 m0, s45, 98304
    s_add_u32 s45, s45, 32
    buffer_load_dword v45, s[20:23], 0 offen lds
    s_mov_b64 exec, -1
    s_sub_i32 s46, s46, 32
L_6:
    s_barrier
    ds_read_b32 v56, v56
    ds_read_b32 v57, v57
    s_cmp_le_i32 s46, 0
    s_cbranch_scc1 L_7
    v_lshl_add_u32 v44, v41, 5, v37
    v_lshl_add_u32 v45, v41, 3, v38
    v_cmp_gt_i32 vcc, s46, v36
    s_lshl_b32 s76, s45, 5
    s_add_u32 m0, s76, 65536
    s_mov_b64 exec, vcc
    buffer_load_dwordx4 v44, s[24:27], 0 offen lds
    s_lshl3_add_u32 m0, s45, 98304
    s_add_u32 s45, s45, 32
    buffer_load_dword v45, s[20:23], 0 offen lds
    s_mov_b64 exec, -1
    s_sub_i32 s46, s46, 32
L_7:
    s_waitcnt lgkmcnt(0)
    v_readfirstlane_b32 s78, v57
    s_cmp_lg_u32 s77, 0
    s_cbranch_scc1 L_assigned
    ds_read_b64_tr_b16 a[0:1], v77 offset:32768
    ds_read_b64_tr_b16 a[2:3], v77 offset:33024
    ds_read_b64_tr_b16 a[4:5], v77 offset:33792
    ds_read_b64_tr_b16 a[6:7], v77 offset:34048
    ds_read_b64_tr_b16 a[8:9], v77 offset:34816
    ds_read_b64_tr_b16 a[10:11], v77 offset:35072
    ds_read_b64_tr_b16 a[12:13], v77 offset:35840
    ds_read_b64_tr_b16 a[14:15], v77 offset:36096
    ds_read_b64_tr_b16 a[16:17], v77 offset:36864
    ds_read_b64_tr_b16 a[18:19], v77 offset:37120
    ds_read_b64_tr_b16 a[20:21], v77 offset:37888
    ds_read_b64_tr_b16 a[22:23], v77 offset:38144
    ds_read_b64_tr_b16 a[24:25], v77 offset:38912
    ds_read_b64_tr_b16 a[26:27], v77 offset:39168
    ds_read_b64_tr_b16 a[28:29], v77 offset:39936
    ds_read_b64_tr_b16 a[30:31], v77 offset:40192
    s_and_b32 s53, s2, 63
    s_or_b32 s53, s53, s3
    s_cbranch_scc1 L_8
    s_lshl_b32 s53, s2, 1
    v_mov_b32 v60, s53
    v_mov_b32 v61, s48
    s_mov_b64 exec, 1
    buffer_store_dword v61, v60, s[32:35], 0 offen sc1
    s_mov_b64 exec, -1
L_8:
    v_sub_u32 v57, 63, v1
    v_lshl_add_u32 v57, v56, 6, v57
    v_mov_b32 v59, 0
    v_readlane_b32 s84, v57, 0
    v_readlane_b32 s85, v57, 1
    v_readlane_b32 s86, v57, 2
    v_readlane_b32 s87, v57, 3
    v_readlane_b32 s88, v57, 4
    v_readlane_b32 s89, v57, 5
    v_readlane_b32 s90, v57, 6
    v_readlane_b32 s91, v57, 7
    v_readlane_b32 s92, v57, 8
    v_readlane_b32 s93, v57, 9
    v_readlane_b32 s94, v57, 10
    v_readlane_b32 s95, v57, 11
    v_readlane_b32 s96, v57, 12
    v_readlane_b32 s97, v57, 13
    v_readlane_b32 s98, v57, 14
    v_readlane_b32 s99, v57, 15
    v_cmp_gt_u32 vcc, s84, v57
    v_cmp_gt_u32 s[4:5], s85, v57
    v_cmp_gt_u32 s[6:7], s86, v57
    v_addc_co_u32 v59, vcc, 0, v59, vcc
    v_addc_co_u32 v59, s[4:5], 0, v59, s[4:5]
    v_addc_co_u32 v59, s[6:7], 0, v59, s[6:7]
    v_cmp_gt_u32 vcc, s87, v57
    v_cmp_gt_u32 s[4:5], s88, v57
    v_cmp_gt_u32 s[6:7], s89, v57
    v_addc_co_u32 v59, vcc, 0, v59, vcc
    v_addc_co_u32 v59, s[4:5], 0, v59, s[4:5]
    v_addc_co_u32 v59, s[6:7], 0, v59, s[6:7]
    v_cmp_gt_u32 vcc, s90, v57
    v_cmp_gt_u32 s[4:5], s91, v57
    v_cmp_gt_u32 s[6:7], s92, v57
    v_addc_co_u32 v59, vcc, 0, v59, vcc
    v_addc_co_u32 v59, s[4:5], 0, v59, s[4:5]
    v_addc_co_u32 v59, s[6:7], 0, v59, s[6:7]
    v_cmp_gt_u32 vcc, s93, v57
    v_cmp_gt_u32 s[4:5], s94, v57
    v_cmp_gt_u32 s[6:7], s95, v57
    v_addc_co_u32 v59, vcc, 0, v59, vcc
    v_addc_co_u32 v59, s[4:5], 0, v59, s[4:5]
    v_addc_co_u32 v59, s[6:7], 0, v59, s[6:7]
    v_cmp_gt_u32 vcc, s96, v57
    v_cmp_gt_u32 s[4:5], s97, v57
    v_cmp_gt_u32 s[6:7], s98, v57
    v_addc_co_u32 v59, vcc, 0, v59, vcc
    v_addc_co_u32 v59, s[4:5], 0, v59, s[4:5]
    v_addc_co_u32 v59, s[6:7], 0, v59, s[6:7]
    v_cmp_gt_u32 vcc, s99, v57
    s_nop 1
    v_addc_co_u32 v59, vcc, 0, v59, vcc
    v_readlane_b32 s84, v57, 16
    v_readlane_b32 s85, v57, 17
    v_readlane_b32 s86, v57, 18
    v_readlane_b32 s87, v57, 19
    v_readlane_b32 s88, v57, 20
    v_readlane_b32 s89, v57, 21
    v_readlane_b32 s90, v57, 22
    v_readlane_b32 s91, v57, 23
    v_readlane_b32 s92, v57, 24
    v_readlane_b32 s93, v57, 25
    v_readlane_b32 s94, v57, 26
    v_readlane_b32 s95, v57, 27
    v_readlane_b32 s96, v57, 28
    v_readlane_b32 s97, v57, 29
    v_readlane_b32 s98, v57, 30
    v_readlane_b32 s99, v57, 31
    v_cmp_gt_u32 vcc, s84, v57
    v_cmp_gt_u32 s[4:5], s85, v57
    v_cmp_gt_u32 s[6:7], s86, v57
    v_addc_co_u32 v59, vcc, 0, v59, vcc
    v_addc_co_u32 v59, s[4:5], 0, v59, s[4:5]
    v_addc_co_u32 v59, s[6:7], 0, v59, s[6:7]
    v_cmp_gt_u32 vcc, s87, v57
    v_cmp_gt_u32 s[4:5], s88, v57
    v_cmp_gt_u32 s[6:7], s89, v57
    v_addc_co_u32 v59, vcc, 0, v59, vcc
    v_addc_co_u32 v59, s[4:5], 0, v59, s[4:5]
    v_addc_co_u32 v59, s[6:7], 0, v59, s[6:7]
    v_cmp_gt_u32 vcc, s90, v57
    v_cmp_gt_u32 s[4:5], s91, v57
    v_cmp_gt_u32 s[6:7], s92, v57
    v_addc_co_u32 v59, vcc, 0, v59, vcc
    v_addc_co_u32 v59, s[4:5], 0, v59, s[4:5]
    v_addc_co_u32 v59, s[6:7], 0, v59, s[6:7]
    v_cmp_gt_u32 vcc, s93, v57
    v_cmp_gt_u32 s[4:5], s94, v57
    v_cmp_gt_u32 s[6:7], s95, v57
    v_addc_co_u32 v59, vcc, 0, v59, vcc
    v_addc_co_u32 v59, s[4:5], 0, v59, s[4:5]
    v_addc_co_u32 v59, s[6:7], 0, v59, s[6:7]
    v_cmp_gt_u32 vcc, s96, v57
    v_cmp_gt_u32 s[4:5], s97, v57
    v_cmp_gt_u32 s[6:7], s98, v57
    v_addc_co_u32 v59, vcc, 0, v59, vcc
    v_addc_co_u32 v59, s[4:5], 0, v59, s[4:5]
    v_addc_co_u32 v59, s[6:7], 0, v59, s[6:7]
    v_cmp_gt_u32 vcc, s99, v57
    s_nop 1
    v_addc_co_u32 v59, vcc, 0, v59, vcc
    v_readlane_b32 s84, v57, 32
    v_readlane_b32 s85, v57, 33
    v_readlane_b32 s86, v57, 34
    v_readlane_b32 s87, v57, 35
    v_readlane_b32 s88, v57, 36
    v_readlane_b32 s89, v57, 37
    v_readlane_b32 s90, v57, 38
    v_readlane_b32 s91, v57, 39
    v_cmp_gt_u32 vcc, s84, v57
    v_cmp_gt_u32 s[4:5], s85, v57
    v_cmp_gt_u32 s[6:7], s86, v57
    v_addc_co_u32 v59, vcc, 0, v59, vcc
    v_addc_co_u32 v59, s[4:5], 0, v59, s[4:5]
    v_addc_co_u32 v59, s[6:7], 0, v59, s[6:7]
    v_cmp_gt_u32 vcc, s87, v57
    v_cmp_gt_u32 s[4:5], s88, v57
    v_cmp_gt_u32 s[6:7], s89, v57
    v_addc_co_u32 v59, vcc, 0, v59, vcc
    v_addc_co_u32 v59, s[4:5], 0, v59, s[4:5]
    v_addc_co_u32 v59, s[6:7], 0, v59, s[6:7]
    v_cmp_gt_u32 vcc, s90, v57
    v_cmp_gt_u32 s[4:5], s91, v57
    s_nop 0
    v_addc_co_u32 v59, vcc, 0, v59, vcc
    v_addc_co_u32 v59, s[4:5], 0, v59, s[4:5]
    v_bfe_u32 v60, v59, 3, 1
    v_mul_u32_u24 v60, 7, v60
    v_and_b32 v61, 7, v59
    v_xor_b32 v11, v60, v61
    s_sub_u32 s53, 7, s3
    s_add_u32 s54, s3, 0
    v_cmp_eq_u32 vcc, s54, v59
    s_ff1_i32_b64 s56, vcc
    s_add_u32 s54, s53, 8
    v_cmp_eq_u32 vcc, s54, v59
    s_ff1_i32_b64 s57, vcc
    s_add_u32 s54, s3, 16
    v_cmp_eq_u32 vcc, s54, v59
    s_ff1_i32_b64 s58, vcc
    s_add_u32 s54, s53, 24
    v_cmp_eq_u32 vcc, s54, v59
    s_ff1_i32_b64 s59, vcc
    s_add_u32 s54, s3, 32
    v_cmp_eq_u32 vcc, s54, v59
    s_ff1_i32_b64 s60, vcc
L_assigned:
    v_cmp_gt_u32 vcc, s3, v11
    v_and_b32 v61, 15, v1
    v_lshlrev_b32 v61, 2, v61
    v_cndmask_b32 v60, 0, v56, vcc
    v_add_u32 v61, 111136, v61
    s_lshl_b32 s84, s56, 6
    v_add_u32 v64, s84, v61
    ds_read_b32 v70, v64
    s_lshl_b32 s85, s57, 6
    v_add_u32 v65, s85, v61
    ds_read_b32 v71, v65
    s_lshl_b32 s86, s58, 6
    v_add_u32 v66, s86, v61
    ds_read_b32 v72, v66
    s_lshl_b32 s87, s59, 6
    v_add_u32 v67, s87, v61
    ds_read_b32 v73, v67
    s_lshl_b32 s88, s60, 6
    v_add_u32 v68, s88, v61
    ds_read_b32 v74, v68
    v_add_u32_dpp v60, v60, v60 row_shr:1 row_mask:0xf bank_mask:0xf bound_ctrl:1
    v_readlane_b32 s92, v56, s56
    s_nop 0
    v_add_u32_dpp v60, v60, v60 row_shr:2 row_mask:0xf bank_mask:0xf bound_ctrl:1
    v_readlane_b32 s93, v56, s57
    s_nop 0
    v_add_u32_dpp v60, v60, v60 row_shr:4 row_mask:0xf bank_mask:0xf bound_ctrl:1
    v_readlane_b32 s94, v56, s58
    s_nop 0
    v_add_u32_dpp v60, v60, v60 row_shr:8 row_mask:0xf bank_mask:0xf bound_ctrl:1
    v_readlane_b32 s95, v56, s59
    s_nop 0
    v_readlane_b32 s96, v56, s60
    v_readlane_b32 s61, v60, 15
    v_readlane_b32 s53, v60, 31
    v_readlane_b32 s54, v60, 47
    s_add_u32 s62, s92, s93
    s_add_u32 s62, s62, s94
    s_add_u32 s62, s62, s95
    s_add_u32 s62, s62, s96
    s_add_u32 s61, s61, s53
    s_add_u32 s61, s61, s54
    s_add_u32 s61, s61, 3
    s_andn2_b32 s61, s61, 3
    s_lshl2_add_u32 s61, s3, s61
    s_waitcnt lgkmcnt(0)
    v_add3_u32 v60, v70, v71, v72
    v_add3_u32 v60, v60, v73, v74
    v_mov_b32 v61, v60
    s_nop 1
    v_add_u32_dpp v61, v61, v61 row_shr:1 row_mask:0xf bank_mask:0xf bound_ctrl:1
    s_nop 1
    v_add_u32_dpp v61, v61, v61 row_shr:2 row_mask:0xf bank_mask:0xf bound_ctrl:1
    s_nop 1
    v_add_u32_dpp v61, v61, v61 row_shr:4 row_mask:0xf bank_mask:0xf bound_ctrl:1
    s_nop 1
    v_add_u32_dpp v61, v61, v61 row_shr:8 row_mask:0xf bank_mask:0xf bound_ctrl:1
    v_sub_u32 v61, v61, v60
    v_add_u32 v61, s61, v61
    v_lshl_add_u32 v75, v61, 8, 0
    ds_write_b32 v64, v75 offset:4096
    v_add_u32 v61, v61, v70
    v_lshl_add_u32 v76, v61, 8, 16
    ds_write_b32 v65, v76 offset:4096
    v_add_u32 v61, v61, v71
    v_lshl_add_u32 v77, v61, 8, 32
    ds_write_b32 v66, v77 offset:4096
    v_add_u32 v61, v61, v72
    v_lshl_add_u32 v78, v61, 8, 48
    ds_write_b32 v67, v78 offset:4096
    v_add_u32 v61, v61, v73
    v_lshl_add_u32 v79, v61, 8, 64
    ds_write_b32 v68, v79 offset:4096
    s_cmp_le_i32 s46, 0
    s_cbranch_scc1 L_9
    v_lshl_add_u32 v44, v42, 5, v37
    v_lshl_add_u32 v45, v42, 3, v38
    v_cmp_gt_i32 vcc, s46, v36
    s_lshl_b32 s76, s45, 5
    s_add_u32 m0, s76, 65536
    s_mov_b64 exec, vcc
    buffer_load_dwordx4 v44, s[24:27], 0 offen lds
    s_lshl3_add_u32 m0, s45, 98304
    s_add_u32 s45, s45, 32
    buffer_load_dword v45, s[20:23], 0 offen lds
    s_mov_b64 exec, -1
    s_sub_i32 s46, s46, 32
L_9:
    s_waitcnt lgkmcnt(0)
    s_barrier
    ds_read_b32 v16, v28 offset:4096
    ds_read_b32 v17, v29 offset:4096
    ds_read_b32 v18, v30 offset:4096
    ds_read_b32 v19, v31 offset:4096
    v_mov_b32 v60, 0
    v_mov_b32 v61, 0
    v_lshlrev_b32 v64, 3, v0
    v_add_u32 v64, 111136, v64
    ds_write_b64 v64, v[60:61]
    v_mov_b32 v64, 110864
    ds_write_b32 v64, v60
    s_mov_b32 s53, 106496
    s_movk_i32 s54, 255
    s_waitcnt lgkmcnt(2)
    v_lshrrev_b32 v28, 8, v16
    v_add_u32 v28, v28, v32
    v_and_or_b32 v16, v16, s54, v24
    v_lshl_add_u32 v28, v28, 2, s53
    s_mov_b64 exec, s[36:37]
    ds_write_b32 v28, v16
    s_mov_b64 exec, -1
    v_lshrrev_b32 v29, 8, v17
    v_add_u32 v29, v29, v33
    v_and_or_b32 v17, v17, s54, v25
    v_lshl_add_u32 v29, v29, 2, s53
    s_mov_b64 exec, s[38:39]
    ds_write_b32 v29, v17
    s_mov_b64 exec, -1
    v_lshrrev_b32 v30, 8, v18
    v_add_u32 v30, v30, v34
    v_and_or_b32 v18, v18, s54, v26
    v_lshl_add_u32 v30, v30, 2, s53
    s_mov_b64 exec, s[40:41]
    ds_write_b32 v30, v18
    s_mov_b64 exec, -1
    v_lshrrev_b32 v31, 8, v19
    v_add_u32 v31, v31, v35
    v_and_or_b32 v19, v19, s54, v27
    v_lshl_add_u32 v31, v31, 2, s53
    s_mov_b64 exec, s[42:43]
    ds_write_b32 v31, v19
    s_mov_b64 exec, -1
    s_cmp_le_i32 s46, 0
    s_cbranch_scc1 L_10
    v_lshl_add_u32 v44, v43, 5, v37
    v_lshl_add_u32 v45, v43, 3, v38
    v_cmp_gt_i32 vcc, s46, v36
    s_lshl_b32 s76, s45, 5
    s_add_u32 m0, s76, 65536
    s_mov_b64 exec, vcc
    buffer_load_dwordx4 v44, s[24:27], 0 offen lds
    s_lshl3_add_u32 m0, s45, 98304
    s_add_u32 s45, s45, 32
    buffer_load_dword v45, s[20:23], 0 offen lds
    s_mov_b64 exec, -1
    s_sub_i32 s46, s46, 32
L_10:
L_paymore:
    s_cmp_le_i32 s46, 0
    s_cbranch_scc1 L_paydone
    ds_read_b32 v40, v39 offset:512
    v_add_u32 v39, 128, v39
    s_waitcnt lgkmcnt(0)
    s_cmp_le_i32 s46, 0
    s_cbranch_scc1 L_11
    v_lshl_add_u32 v44, v40, 5, v37
    v_lshl_add_u32 v45, v40, 3, v38
    v_cmp_gt_i32 vcc, s46, v36
    s_lshl_b32 s76, s45, 5
    s_add_u32 m0, s76, 65536
    s_mov_b64 exec, vcc
    buffer_load_dwordx4 v44, s[24:27], 0 offen lds
    s_lshl3_add_u32 m0, s45, 98304
    s_add_u32 s45, s45, 32
    buffer_load_dword v45, s[20:23], 0 offen lds
    s_mov_b64 exec, -1
    s_sub_i32 s46, s46, 32
L_11:
    s_branch L_paymore
L_paydone:
    s_lshl_b32 s61, s61, 2
    s_add_u32 s61, s61, 106496
    s_and_b32 s54, s2, 192
    s_lshl_b32 s54, s54, 1
    s_lshl4_add_u32 s54, s3, s54
    s_lshl2_add_u32 s53, s54, 4096
    v_and_b32 v66, 15, v1
    v_lshl_add_u32 v66, v66, 2, s53
    s_lshl_b32 s53, s54, 10
    s_add_u32 s53, s53, 1048576
    v_lshl_add_u32 v67, v1, 4, s53
    s_xor_b32 s53, s48, 1
    v_mov_b32 v79, s53
    v_mov_b32 v13, s61
    v_and_b32 v62, 3, v1
    v_lshl_add_u32 v77, v62, 2, s61
    v_bfe_u32 v62, v1, 2, 2
    v_lshl_add_u32 v78, v62, 2, s61
    v_bfe_u32 v63, v1, 4, 1
    v_lshlrev_b32 v63, 4, v63
    v_add_u32 v63, 65536, v63
    v_mov_b32 v65, 98304
    v_mov_b32 v62, 110848
    v_cmp_ne_u32 vcc, 0, v7
    v_cmp_ne_u32 s[4:5], 0, v8
    v_cmp_ne_u32 s[6:7], 0, v10
    v_cndmask_b32 v74, v62, v63, vcc
    v_cndmask_b32 v75, v62, v63, s[4:5]
    v_cndmask_b32 v76, v62, v65, s[6:7]
    s_waitcnt lgkmcnt(0)
    s_barrier
    ds_read_b128 v[68:71], v13
    ds_read_b32 v72, v77
    ds_read_b32 v73, v78
    s_cmp_lt_u32 s62, 3
    s_cbranch_scc1 L_short
    s_waitcnt lgkmcnt(2)
    v_readfirstlane_b32 s64, v68
    v_readfirstlane_b32 s65, v69
    v_readfirstlane_b32 s66, v70
    v_readfirstlane_b32 s67, v71
    s_and_b32 s76, s64, s82
    s_add_u32 m0, s63, 0
    s_lshl_b32 s76, s76, 3
    buffer_load_dwordx4 v2, s[8:11], s76 offen lds
    buffer_load_dwordx4 v3, s[8:11], s76 offen offset:1024 lds
    s_and_b32 s76, s65, s82
    s_add_u32 m0, s63, 2048
    s_lshl_b32 s76, s76, 3
    buffer_load_dwordx4 v2, s[8:11], s76 offen lds
    buffer_load_dwordx4 v3, s[8:11], s76 offen offset:1024 lds
    s_and_b32 s76, s66, s82
    s_add_u32 m0, s63, 4096
    s_lshl_b32 s76, s76, 3
    buffer_load_dwordx4 v2, s[8:11], s76 offen lds
    buffer_load_dwordx4 v3, s[8:11], s76 offen offset:1024 lds
    s_waitcnt vmcnt(6)
    s_branch L_go
L_short:
    s_waitcnt vmcnt(0) lgkmcnt(0)
    v_readfirstlane_b32 s64, v68
    v_readfirstlane_b32 s65, v69
    v_readfirstlane_b32 s66, v70
    v_readfirstlane_b32 s67, v71
    s_cmp_le_u32 s62, 0
    s_cbranch_scc1 L_go
    s_and_b32 s76, s64, s82
    s_add_u32 m0, s63, 0
    s_lshl_b32 s76, s76, 3
    buffer_load_dwordx4 v2, s[8:11], s76 offen lds
    buffer_load_dwordx4 v3, s[8:11], s76 offen offset:1024 lds
    s_cmp_le_u32 s62, 1
    s_cbranch_scc1 L_go
    s_and_b32 s76, s65, s82
    s_add_u32 m0, s63, 2048
    s_lshl_b32 s76, s76, 3
    buffer_load_dwordx4 v2, s[8:11], s76 offen lds
    buffer_load_dwordx4 v3, s[8:11], s76 offen offset:1024 lds
L_go:
    s_cmp_ge_u32 s3, 2
    s_cbranch_scc1 L_12
    s_cmp_lg_u32 s77, 0
    s_cbranch_scc1 L_12
    v_mov_b32 v62, s83
    v_mov_b32 v63, s48
    s_mov_b64 exec, 1
    buffer_store_dword v63, v62, s[32:35], 0 offen sc1
    s_mov_b64 exec, -1
L_12:
    s_waitcnt lgkmcnt(0)
    v_lshrrev_b32 v72, 22, v72
    v_lshrrev_b32 v73, 22, v73
    v_mad_u32_u24 v5, v72, v7, v74
    v_mad_u32_u24 v6, v72, v8, v75
    v_mad_u32_u24 v9, v73, v10, v76
    s_barrier
    s_cmp_eq_u32 s62, 0
    s_cbranch_scc1 L_round_done
L_group:
    s_cmp_le_u32 s62, s81
    s_cbranch_scc1 L_wstep
L_wback:
    ds_read_b64 v[64:65], v9
    ds_read_b128 v[56:59], v5
    ds_read_b128 v[60:63], v6
    ds_read_b128 v[68:71], v13 offset:16
    ds_read_b32 v72, v77 offset:16
    ds_read_b32 v73, v78 offset:16
    v_add_u32 v13, 16, v13
    v_add_u32 v77, 16, v77
    v_add_u32 v78, 16, v78
    s_waitcnt lgkmcnt(0)
    v_mfma_f32_16x16x16_bf16 v[32:35], v[14:15], v[64:65], 0
    v_mfma_f32_16x16x32_bf16 v[16:19], v[56:59], a[0:3], 0
    v_mfma_f32_16x16x32_bf16 v[20:23], v[56:59], a[8:11], 0
    v_mfma_f32_16x16x32_bf16 v[24:27], v[56:59], a[16:19], 0
    v_mfma_f32_16x16x32_bf16 v[28:31], v[56:59], a[24:27], 0
    v_mfma_f32_16x16x32_bf16 v[16:19], v[60:63], a[4:7], v[16:19]
    v_mfma_f32_16x16x32_bf16 v[20:23], v[60:63], a[12:15], v[20:23]
    v_mfma_f32_16x16x32_bf16 v[24:27], v[60:63], a[20:23], v[24:27]
    v_mfma_f32_16x16x32_bf16 v[28:31], v[60:63], a[28:31], v[28:31]
    v_readfirstlane_b32 s68, v68
    v_readfirstlane_b32 s69, v69
    v_readfirstlane_b32 s70, v70
    v_readfirstlane_b32 s71, v71
    v_cvt_pk_bf16_f32 v64, v32, v33
    v_cvt_pk_bf16_f32 v65, v34, v35
    v_lshrrev_b32 v72, 22, v72
    v_lshrrev_b32 v73, 22, v73
    v_mad_u32_u24 v5, v72, v7, v74
    v_mad_u32_u24 v6, v72, v8, v75
    v_mad_u32_u24 v9, v73, v10, v76
    s_cmp_ge_u32 s62, 3
    s_cbranch_scc1 L_13
    s_waitcnt vmcnt(0)
L_13:
    s_waitcnt vmcnt(4)
    ds_read_b64_tr_b16 v[48:49], v4 offset:0
    ds_read_b64_tr_b16 v[50:51], v4 offset:256
    ds_read_b64_tr_b16 v[52:53], v4 offset:512
    ds_read_b64_tr_b16 v[54:55], v4 offset:768
    s_cmp_le_u32 s62, 3
    s_cbranch_scc1 L_14
    s_and_b32 s76, s67, s82
    s_add_u32 m0, s63, 6144
    s_lshl_b32 s76, s76, 3
    buffer_load_dwordx4 v2, s[8:11], s76 offen lds
    buffer_load_dwordx4 v3, s[8:11], s76 offen offset:1024 lds
L_14:
    s_waitcnt lgkmcnt(0)
    v_mfma_f32_4x4x4_16b_bf16 v[32:35], v[64:65], v[48:49], 0 cbsz:4 abid:0
    v_mfma_f32_4x4x4_16b_bf16 v[36:39], v[64:65], v[50:51], 0 cbsz:4 abid:0
    v_mfma_f32_4x4x4_16b_bf16 v[40:43], v[64:65], v[52:53], 0 cbsz:4 abid:0
    v_mfma_f32_4x4x4_16b_bf16 v[44:47], v[64:65], v[54:55], 0 cbsz:4 abid:0
    s_nop 0
    s_set_gpr_idx_on s64, gpr_idx(SRC2,DST)
    v_pk_fma_f32 v[80:81], v[32:33], v[16:17], v[80:81] op_sel:[0,0,0] op_sel_hi:[1,0,1]
    v_pk_fma_f32 v[82:83], v[34:35], v[16:17], v[82:83] op_sel:[0,0,0] op_sel_hi:[1,0,1]
    v_pk_fma_f32 v[84:85], v[36:37], v[20:21], v[84:85] op_sel:[0,0,0] op_sel_hi:[1,0,1]
    v_pk_fma_f32 v[86:87], v[38:39], v[20:21], v[86:87] op_sel:[0,0,0] op_sel_hi:[1,0,1]
    v_pk_fma_f32 v[88:89], v[40:41], v[24:25], v[88:89] op_sel:[0,0,0] op_sel_hi:[1,0,1]
    v_pk_fma_f32 v[90:91], v[42:43], v[24:25], v[90:91] op_sel:[0,0,0] op_sel_hi:[1,0,1]
    v_pk_fma_f32 v[92:93], v[44:45], v[28:29], v[92:93] op_sel:[0,0,0] op_sel_hi:[1,0,1]
    v_pk_fma_f32 v[94:95], v[46:47], v[28:29], v[94:95] op_sel:[0,0,0] op_sel_hi:[1,0,1]
    s_set_gpr_idx_off
    s_mov_b32 s64, s68
    s_sub_u32 s62, s62, 1
    s_cmp_eq_u32 s62, 0
    s_cbranch_scc1 L_round_done
    s_cmp_ge_u32 s62, 3
    s_cbranch_scc1 L_15
    s_waitcnt vmcnt(0)
L_15:
    s_waitcnt vmcnt(4)
    ds_read_b64_tr_b16 v[48:49], v4 offset:2048
    ds_read_b64_tr_b16 v[50:51], v4 offset:2304
    ds_read_b64_tr_b16 v[52:53], v4 offset:2560
    ds_read_b64_tr_b16 v[54:55], v4 offset:2816
    s_cmp_le_u32 s62, 3
    s_cbranch_scc1 L_16
    s_and_b32 s76, s68, s82
    s_add_u32 m0, s63, 0
    s_lshl_b32 s76, s76, 3
    buffer_load_dwordx4 v2, s[8:11], s76 offen lds
    buffer_load_dwordx4 v3, s[8:11], s76 offen offset:1024 lds
L_16:
    s_waitcnt lgkmcnt(0)
    v_mfma_f32_4x4x4_16b_bf16 v[32:35], v[64:65], v[48:49], 0 cbsz:4 abid:1
    v_mfma_f32_4x4x4_16b_bf16 v[36:39], v[64:65], v[50:51], 0 cbsz:4 abid:1
    v_mfma_f32_4x4x4_16b_bf16 v[40:43], v[64:65], v[52:53], 0 cbsz:4 abid:1
    v_mfma_f32_4x4x4_16b_bf16 v[44:47], v[64:65], v[54:55], 0 cbsz:4 abid:1
    s_nop 0
    s_set_gpr_idx_on s65, gpr_idx(SRC2,DST)
    v_pk_fma_f32 v[80:81], v[32:33], v[16:17], v[80:81] op_sel:[0,1,0] op_sel_hi:[1,1,1]
    v_pk_fma_f32 v[82:83], v[34:35], v[16:17], v[82:83] op_sel:[0,1,0] op_sel_hi:[1,1,1]
    v_pk_fma_f32 v[84:85], v[36:37], v[20:21], v[84:85] op_sel:[0,1,0] op_sel_hi:[1,1,1]
    v_pk_fma_f32 v[86:87], v[38:39], v[20:21], v[86:87] op_sel:[0,1,0] op_sel_hi:[1,1,1]
    v_pk_fma_f32 v[88:89], v[40:41], v[24:25], v[88:89] op_sel:[0,1,0] op_sel_hi:[1,1,1]
    v_pk_fma_f32 v[90:91], v[42:43], v[24:25], v[90:91] op_sel:[0,1,0] op_sel_hi:[1,1,1]
    v_pk_fma_f32 v[92:93], v[44:45], v[28:29], v[92:93] op_sel:[0,1,0] op_sel_hi:[1,1,1]
    v_pk_fma_f32 v[94:95], v[46:47], v[28:29], v[94:95] op_sel:[0,1,0] op_sel_hi:[1,1,1]
    s_set_gpr_idx_off
    s_mov_b32 s65, s69
    s_sub_u32 s62, s62, 1
    s_cmp_eq_u32 s62, 0
    s_cbranch_scc1 L_round_done
    s_cmp_ge_u32 s62, 3
    s_cbranch_scc1 L_17
    s_waitcnt vmcnt(0)
L_17:
    s_waitcnt vmcnt(4)
    ds_read_b64_tr_b16 v[48:49], v4 offset:4096
    ds_read_b64_tr_b16 v[50:51], v4 offset:4352
    ds_read_b64_tr_b16 v[52:53], v4 offset:4608
    ds_read_b64_tr_b16 v[54:55], v4 offset:4864
    s_cmp_le_u32 s62, 3
    s_cbranch_scc1 L_18
    s_and_b32 s76, s69, s82
    s_add_u32 m0, s63, 2048
    s_lshl_b32 s76, s76, 3
    buffer_load_dwordx4 v2, s[8:11], s76 offen lds
    buffer_load_dwordx4 v3, s[8:11], s76 offen offset:1024 lds
L_18:
    s_waitcnt lgkmcnt(0)
    v_mfma_f32_4x4x4_16b_bf16 v[32:35], v[64:65], v[48:49], 0 cbsz:4 abid:2
    v_mfma_f32_4x4x4_16b_bf16 v[36:39], v[64:65], v[50:51], 0 cbsz:4 abid:2
    v_mfma_f32_4x4x4_16b_bf16 v[40:43], v[64:65], v[52:53], 0 cbsz:4 abid:2
    v_mfma_f32_4x4x4_16b_bf16 v[44:47], v[64:65], v[54:55], 0 cbsz:4 abid:2
    s_nop 0
    s_set_gpr_idx_on s66, gpr_idx(SRC2,DST)
    v_pk_fma_f32 v[80:81], v[32:33], v[18:19], v[80:81] op_sel:[0,0,0] op_sel_hi:[1,0,1]
    v_pk_fma_f32 v[82:83], v[34:35], v[18:19], v[82:83] op_sel:[0,0,0] op_sel_hi:[1,0,1]
    v_pk_fma_f32 v[84:85], v[36:37], v[22:23], v[84:85] op_sel:[0,0,0] op_sel_hi:[1,0,1]
    v_pk_fma_f32 v[86:87], v[38:39], v[22:23], v[86:87] op_sel:[0,0,0] op_sel_hi:[1,0,1]
    v_pk_fma_f32 v[88:89], v[40:41], v[26:27], v[88:89] op_sel:[0,0,0] op_sel_hi:[1,0,1]
    v_pk_fma_f32 v[90:91], v[42:43], v[26:27], v[90:91] op_sel:[0,0,0] op_sel_hi:[1,0,1]
    v_pk_fma_f32 v[92:93], v[44:45], v[30:31], v[92:93] op_sel:[0,0,0] op_sel_hi:[1,0,1]
    v_pk_fma_f32 v[94:95], v[46:47], v[30:31], v[94:95] op_sel:[0,0,0] op_sel_hi:[1,0,1]
    s_set_gpr_idx_off
    s_mov_b32 s66, s70
    s_sub_u32 s62, s62, 1
    s_cmp_eq_u32 s62, 0
    s_cbranch_scc1 L_round_done
    s_cmp_ge_u32 s62, 3
    s_cbranch_scc1 L_19
    s_waitcnt vmcnt(0)
L_19:
    s_waitcnt vmcnt(4)
    ds_read_b64_tr_b16 v[48:49], v4 offset:6144
    ds_read_b64_tr_b16 v[50:51], v4 offset:6400
    ds_read_b64_tr_b16 v[52:53], v4 offset:6656
    ds_read_b64_tr_b16 v[54:55], v4 offset:6912
    s_cmp_le_u32 s62, 3
    s_cbranch_scc1 L_20
    s_and_b32 s76, s70, s82
    s_add_u32 m0, s63, 4096
    s_lshl_b32 s76, s76, 3
    buffer_load_dwordx4 v2, s[8:11], s76 offen lds
    buffer_load_dwordx4 v3, s[8:11], s76 offen offset:1024 lds
L_20:
    s_waitcnt lgkmcnt(0)
    v_mfma_f32_4x4x4_16b_bf16 v[32:35], v[64:65], v[48:49], 0 cbsz:4 abid:3
    v_mfma_f32_4x4x4_16b_bf16 v[36:39], v[64:65], v[50:51], 0 cbsz:4 abid:3
    v_mfma_f32_4x4x4_16b_bf16 v[40:43], v[64:65], v[52:53], 0 cbsz:4 abid:3
    v_mfma_f32_4x4x4_16b_bf16 v[44:47], v[64:65], v[54:55], 0 cbsz:4 abid:3
    s_nop 0
    s_set_gpr_idx_on s67, gpr_idx(SRC2,DST)
    v_pk_fma_f32 v[80:81], v[32:33], v[18:19], v[80:81] op_sel:[0,1,0] op_sel_hi:[1,1,1]
    v_pk_fma_f32 v[82:83], v[34:35], v[18:19], v[82:83] op_sel:[0,1,0] op_sel_hi:[1,1,1]
    v_pk_fma_f32 v[84:85], v[36:37], v[22:23], v[84:85] op_sel:[0,1,0] op_sel_hi:[1,1,1]
    v_pk_fma_f32 v[86:87], v[38:39], v[22:23], v[86:87] op_sel:[0,1,0] op_sel_hi:[1,1,1]
    v_pk_fma_f32 v[88:89], v[40:41], v[26:27], v[88:89] op_sel:[0,1,0] op_sel_hi:[1,1,1]
    v_pk_fma_f32 v[90:91], v[42:43], v[26:27], v[90:91] op_sel:[0,1,0] op_sel_hi:[1,1,1]
    v_pk_fma_f32 v[92:93], v[44:45], v[30:31], v[92:93] op_sel:[0,1,0] op_sel_hi:[1,1,1]
    v_pk_fma_f32 v[94:95], v[46:47], v[30:31], v[94:95] op_sel:[0,1,0] op_sel_hi:[1,1,1]
    s_set_gpr_idx_off
    s_mov_b32 s67, s71
    s_sub_u32 s62, s62, 1
    s_cmp_eq_u32 s62, 0
    s_cbranch_scc0 L_group
L_round_done:
    s_add_u32 s77, s77, 1
    s_cmp_lg_u32 s78, 0
    s_cbranch_scc1 L_scan
    s_cmp_eq_u32 s81, 0
    s_cbranch_scc1 L_havew
    s_mov_b32 s55, 0
L_pollw:
    s_waitcnt vmcnt(0)
    v_cmp_ne_u32 vcc, s48, v79
    s_cbranch_vccz L_gotw
    buffer_load_dword v79, v66, s[32:35], 0 offen sc1
    s_sleep 1
    s_add_u32 s55, s55, 1
    s_cmp_lt_u32 s55, 0x400000
    s_cbranch_scc1 L_pollw
    s_endpgm
L_gotw:
    buffer_load_dwordx4 a[32:35], v67, s[32:35], 0 offen offset:0 sc1
    buffer_load_dwordx4 a[36:39], v67, s[32:35], 0 offen offset:1024 sc1
    buffer_load_dwordx4 a[40:43], v67, s[32:35], 0 offen offset:2048 sc1
    buffer_load_dwordx4 a[44:47], v67, s[32:35], 0 offen offset:3072 sc1
    v_add_u32 v67, 4096, v67
    buffer_load_dwordx4 a[48:51], v67, s[32:35], 0 offen offset:0 sc1
    buffer_load_dwordx4 a[52:55], v67, s[32:35], 0 offen offset:1024 sc1
    buffer_load_dwordx4 a[56:59], v67, s[32:35], 0 offen offset:2048 sc1
    buffer_load_dwordx4 a[60:63], v67, s[32:35], 0 offen offset:3072 sc1
    v_add_u32 v67, 4096, v67
    buffer_load_dwordx4 a[64:67], v67, s[32:35], 0 offen offset:0 sc1
    buffer_load_dwordx4 a[68:71], v67, s[32:35], 0 offen offset:1024 sc1
    buffer_load_dwordx4 a[72:75], v67, s[32:35], 0 offen offset:2048 sc1
    buffer_load_dwordx4 a[76:79], v67, s[32:35], 0 offen offset:3072 sc1
    v_add_u32 v67, 4096, v67
    buffer_load_dwordx4 a[80:83], v67, s[32:35], 0 offen offset:0 sc1
    buffer_load_dwordx4 a[84:87], v67, s[32:35], 0 offen offset:1024 sc1
    buffer_load_dwordx4 a[88:91], v67, s[32:35], 0 offen offset:2048 sc1
    buffer_load_dwordx4 a[92:95], v67, s[32:35], 0 offen offset:3072 sc1
    v_add_u32 v67, 4096, v67
    s_branch L_havew
L_wstep:
    v_cmp_ne_u32 vcc, s48, v79
    s_cbranch_vccz L_wgo
    buffer_load_dword v79, v66, s[32:35], 0 offen sc1
    s_branch L_wback
L_wgo:
    s_branch L_wback
L_havew:
    v_mul_u32_u24 v16, 320, v1
    v_lshrrev_b32 v17, 2, v1
    v_lshl_add_u32 v16, v17, 3, v16
    s_lshl_b32 s53, s56, 3
    v_add_u32 v72, s53, v16
    v_add_u32 v5, 111136, v72
    s_lshl_b32 s53, s57, 3
    v_add_u32 v73, s53, v16
    v_add_u32 v6, 111136, v73
    s_lshl_b32 s53, s58, 3
    v_add_u32 v74, s53, v16
    v_add_u32 v7, 111136, v74
    s_lshl_b32 s53, s59, 3
    v_add_u32 v75, s53, v16
    v_add_u32 v8, 111136, v75
    s_lshl_b32 s53, s60, 3
    v_add_u32 v76, s53, v16
    v_add_u32 v9, 111136, v76
    v_cvt_pk_bf16_f32 v32, v80, v81
    v_cvt_pk_bf16_f32 v33, v82, v83
    ds_write_b64 v5, v[32:33] offset:0
    v_cvt_pk_bf16_f32 v34, v96, v97
    v_cvt_pk_bf16_f32 v35, v98, v99
    ds_write_b64 v6, v[34:35] offset:0
    v_cvt_pk_bf16_f32 v36, v112, v113
    v_cvt_pk_bf16_f32 v37, v114, v115
    ds_write_b64 v7, v[36:37] offset:0
    v_cvt_pk_bf16_f32 v38, v128, v129
    v_cvt_pk_bf16_f32 v39, v130, v131
    ds_write_b64 v8, v[38:39] offset:0
    v_cvt_pk_bf16_f32 v40, v144, v145
    v_cvt_pk_bf16_f32 v41, v146, v147
    ds_write_b64 v9, v[40:41] offset:0
    v_cvt_pk_bf16_f32 v42, v84, v85
    v_cvt_pk_bf16_f32 v43, v86, v87
    ds_write_b64 v5, v[42:43] offset:20608
    v_cvt_pk_bf16_f32 v44, v100, v101
    v_cvt_pk_bf16_f32 v45, v102, v103
    ds_write_b64 v6, v[44:45] offset:20608
    v_cvt_pk_bf16_f32 v46, v116, v117
    v_cvt_pk_bf16_f32 v47, v118, v119
    ds_write_b64 v7, v[46:47] offset:20608
    v_cvt_pk_bf16_f32 v48, v132, v133
    v_cvt_pk_bf16_f32 v49, v134, v135
    ds_write_b64 v8, v[48:49] offset:20608
    v_cvt_pk_bf16_f32 v50, v148, v149
    v_cvt_pk_bf16_f32 v51, v150, v151
    ds_write_b64 v9, v[50:51] offset:20608
    v_cvt_pk_bf16_f32 v52, v88, v89
    v_cvt_pk_bf16_f32 v53, v90, v91
    v_cvt_pk_bf16_f32 v54, v104, v105
    v_cvt_pk_bf16_f32 v55, v106, v107
    v_cvt_pk_bf16_f32 v56, v120, v121
    v_cvt_pk_bf16_f32 v57, v122, v123
    v_cvt_pk_bf16_f32 v58, v136, v137
    v_cvt_pk_bf16_f32 v59, v138, v139
    v_cvt_pk_bf16_f32 v60, v152, v153
    v_cvt_pk_bf16_f32 v61, v154, v155
    v_cvt_pk_bf16_f32 v62, v92, v93
    v_cvt_pk_bf16_f32 v63, v94, v95
    v_cvt_pk_bf16_f32 v64, v108, v109
    v_cvt_pk_bf16_f32 v65, v110, v111
    v_cvt_pk_bf16_f32 v66, v124, v125
    v_cvt_pk_bf16_f32 v67, v126, v127
    v_cvt_pk_bf16_f32 v68, v140, v141
    v_cvt_pk_bf16_f32 v69, v142, v143
    v_cvt_pk_bf16_f32 v70, v156, v157
    v_cvt_pk_bf16_f32 v71, v158, v159
    v_lshrrev_b32 v20, 5, v1
    v_mul_u32_u24 v21, 2576, v20
    v_bfe_u32 v22, v1, 2, 2
    v_mul_u32_u24 v24, 320, v22
    v_bfe_u32 v23, v1, 4, 1
    v_lshl_add_u32 v21, v23, 5, v21
    v_and_b32 v23, 3, v1
    v_lshl_add_u32 v21, v23, 3, v21
    v_add_u32 v3, v21, v24
    v_add_u32 v2, 111136, v3
    s_mul_i32 s53, s3, 5120
    s_add_u32 s53, s53, 41472
    v_and_b32 v24, 31, v1
    v_mul_u32_u24 v24, 80, v24
    v_lshl_add_u32 v24, v20, 3, v24
    v_add_u32 v10, s53, v24
    v_lshrrev_b32 v24, 2, v1
    v_mul_u32_u24 v24, 80, v24
    v_lshl_add_u32 v24, v23, 4, v24
    v_add_u32 v11, s53, v24
    v_lshrrev_b32 v24, 4, v1
    v_lshlrev_b32 v24, 19, v24
    v_lshl_add_u32 v24, v22, 9, v24
    v_lshl_add_u32 v24, v23, 4, v24
    s_lshl_b32 s53, s2, 11
    s_lshl_b32 s54, s3, 6
    s_add_u32 s53, s53, s54
    v_add_u32 v4, s53, v24
    s_waitcnt lgkmcnt(0)
    s_barrier
    ds_read_b64_tr_b16 v[16:17], v2 offset:0
    ds_read_b64_tr_b16 v[18:19], v2 offset:1288
    ds_read_b64_tr_b16 v[20:21], v2 offset:5152
    ds_read_b64_tr_b16 v[22:23], v2 offset:6440
    ds_read_b64_tr_b16 v[24:25], v2 offset:10304
    ds_read_b64_tr_b16 v[26:27], v2 offset:11592
    ds_read_b64_tr_b16 v[28:29], v2 offset:15456
    ds_read_b64_tr_b16 v[30:31], v2 offset:16744
    ds_read_b64_tr_b16 v[32:33], v2 offset:20608
    ds_read_b64_tr_b16 v[34:35], v2 offset:21896
    s_waitcnt vmcnt(8)
    s_waitcnt lgkmcnt(8)
    v_mfma_f32_32x32x16_bf16 v[80:95], a[32:35], v[16:19], 0
    ds_read_b64_tr_b16 v[36:37], v2 offset:25760
    ds_read_b64_tr_b16 v[38:39], v2 offset:27048
    ds_write_b64 v72, v[52:53] offset:0
    s_waitcnt lgkmcnt(9)
    v_mfma_f32_32x32x16_bf16 v[80:95], a[36:39], v[20:23], v[80:95]
    ds_read_b64_tr_b16 v[40:41], v2 offset:30912
    ds_read_b64_tr_b16 v[42:43], v2 offset:32200
    ds_write_b64 v73, v[54:55] offset:0
    s_waitcnt lgkmcnt(10)
    v_mfma_f32_32x32x16_bf16 v[80:95], a[40:43], v[24:27], v[80:95]
    ds_read_b64_tr_b16 v[44:45], v2 offset:36064
    ds_read_b64_tr_b16 v[46:47], v2 offset:37352
    ds_write_b64 v74, v[56:57] offset:0
    s_waitcnt lgkmcnt(11)
    v_mfma_f32_32x32x16_bf16 v[80:95], a[44:47], v[28:31], v[80:95]
    ds_read_b64_tr_b16 v[16:17], v2 offset:64
    ds_read_b64_tr_b16 v[18:19], v2 offset:1352
    ds_write_b64 v75, v[58:59] offset:0
    s_waitcnt lgkmcnt(12)
    v_mfma_f32_32x32x16_bf16 v[80:95], a[48:51], v[32:35], v[80:95]
    ds_read_b64_tr_b16 v[20:21], v2 offset:5216
    ds_read_b64_tr_b16 v[22:23], v2 offset:6504
    ds_write_b64 v76, v[60:61] offset:0
    s_waitcnt lgkmcnt(13)
    v_mfma_f32_32x32x16_bf16 v[80:95], a[52:55], v[36:39], v[80:95]
    ds_read_b64_tr_b16 v[24:25], v2 offset:10368
    ds_read_b64_tr_b16 v[26:27], v2 offset:11656
    ds_write_b64 v72, v[62:63] offset:20608
    s_waitcnt lgkmcnt(13)
    v_mfma_f32_32x32x16_bf16 v[80:95], a[56:59], v[40:43], v[80:95]
    ds_read_b64_tr_b16 v[28:29], v2 offset:15520
    ds_read_b64_tr_b16 v[30:31], v2 offset:16808
    ds_write_b64 v73, v[64:65] offset:20608
    s_waitcnt lgkmcnt(13)
    v_mfma_f32_32x32x16_bf16 v[80:95], a[60:63], v[44:47], v[80:95]
    ds_read_b64_tr_b16 v[32:33], v2 offset:20672
    ds_read_b64_tr_b16 v[34:35], v2 offset:21960
    ds_write_b64 v74, v[66:67] offset:20608
    s_waitcnt lgkmcnt(13)
    v_mfma_f32_32x32x16_bf16 v[96:111], a[32:35], v[16:19], 0
    ds_read_b64_tr_b16 v[36:37], v2 offset:25824
    ds_read_b64_tr_b16 v[38:39], v2 offset:27112
    ds_write_b64 v75, v[68:69] offset:20608
    s_waitcnt lgkmcnt(13)
    v_mfma_f32_32x32x16_bf16 v[96:111], a[36:39], v[20:23], v[96:111]
    ds_read_b64_tr_b16 v[40:41], v2 offset:30976
    ds_read_b64_tr_b16 v[42:43], v2 offset:32264
    ds_write_b64 v76, v[70:71] offset:20608
    s_waitcnt lgkmcnt(13)
    v_mfma_f32_32x32x16_bf16 v[96:111], a[40:43], v[24:27], v[96:111]
    ds_read_b64_tr_b16 v[44:45], v2 offset:36128
    ds_read_b64_tr_b16 v[46:47], v2 offset:37416
    s_waitcnt lgkmcnt(12)
    v_mfma_f32_32x32x16_bf16 v[96:111], a[44:47], v[28:31], v[96:111]
    ds_read_b64_tr_b16 v[16:17], v2 offset:128
    ds_read_b64_tr_b16 v[18:19], v2 offset:1416
    s_waitcnt lgkmcnt(11)
    v_mfma_f32_32x32x16_bf16 v[96:111], a[48:51], v[32:35], v[96:111]
    ds_read_b64_tr_b16 v[20:21], v2 offset:5280
    ds_read_b64_tr_b16 v[22:23], v2 offset:6568
    s_waitcnt lgkmcnt(10)
    v_mfma_f32_32x32x16_bf16 v[96:111], a[52:55], v[36:39], v[96:111]
    ds_read_b64_tr_b16 v[24:25], v2 offset:10432
    ds_read_b64_tr_b16 v[26:27], v2 offset:11720
    s_waitcnt lgkmcnt(9)
    v_mfma_f32_32x32x16_bf16 v[96:111], a[56:59], v[40:43], v[96:111]
    ds_read_b64_tr_b16 v[28:29], v2 offset:15584
    ds_read_b64_tr_b16 v[30:31], v2 offset:16872
    s_waitcnt lgkmcnt(8)
    v_mfma_f32_32x32x16_bf16 v[96:111], a[60:63], v[44:47], v[96:111]
    ds_read_b64_tr_b16 v[32:33], v2 offset:20736
    ds_read_b64_tr_b16 v[34:35], v2 offset:22024
    s_waitcnt lgkmcnt(8)
    v_mfma_f32_32x32x16_bf16 v[112:127], a[32:35], v[16:19], 0
    ds_read_b64_tr_b16 v[36:37], v2 offset:25888
    ds_read_b64_tr_b16 v[38:39], v2 offset:27176
    s_waitcnt lgkmcnt(8)
    v_mfma_f32_32x32x16_bf16 v[112:127], a[36:39], v[20:23], v[112:127]
    ds_read_b64_tr_b16 v[40:41], v2 offset:31040
    ds_read_b64_tr_b16 v[42:43], v2 offset:32328
    s_waitcnt lgkmcnt(8)
    v_mfma_f32_32x32x16_bf16 v[112:127], a[40:43], v[24:27], v[112:127]
    ds_read_b64_tr_b16 v[44:45], v2 offset:36192
    ds_read_b64_tr_b16 v[46:47], v2 offset:37480
    s_barrier
    s_waitcnt lgkmcnt(8)
    v_mfma_f32_32x32x16_bf16 v[112:127], a[44:47], v[28:31], v[112:127]
    ds_read_b64_tr_b16 v[16:17], v3 offset:0
    ds_read_b64_tr_b16 v[18:19], v3 offset:1288
    s_waitcnt lgkmcnt(8)
    v_mfma_f32_32x32x16_bf16 v[112:127], a[48:51], v[32:35], v[112:127]
    ds_read_b64_tr_b16 v[20:21], v3 offset:5152
    ds_read_b64_tr_b16 v[22:23], v3 offset:6440
    s_waitcnt lgkmcnt(8)
    v_mfma_f32_32x32x16_bf16 v[112:127], a[52:55], v[36:39], v[112:127]
    ds_read_b64_tr_b16 v[24:25], v3 offset:10304
    ds_read_b64_tr_b16 v[26:27], v3 offset:11592
    s_waitcnt lgkmcnt(8)
    v_mfma_f32_32x32x16_bf16 v[112:127], a[56:59], v[40:43], v[112:127]
    ds_read_b64_tr_b16 v[28:29], v3 offset:15456
    ds_read_b64_tr_b16 v[30:31], v3 offset:16744
    s_waitcnt lgkmcnt(8)
    v_mfma_f32_32x32x16_bf16 v[112:127], a[60:63], v[44:47], v[112:127]
    ds_read_b64_tr_b16 v[32:33], v3 offset:20608
    ds_read_b64_tr_b16 v[34:35], v3 offset:21896
    s_waitcnt vmcnt(0)
    s_waitcnt lgkmcnt(8)
    v_mfma_f32_32x32x16_bf16 v[80:95], a[64:67], v[16:19], v[80:95]
    ds_read_b64_tr_b16 v[36:37], v3 offset:25760
    ds_read_b64_tr_b16 v[38:39], v3 offset:27048
    s_waitcnt lgkmcnt(8)
    v_mfma_f32_32x32x16_bf16 v[80:95], a[68:71], v[20:23], v[80:95]
    ds_read_b64_tr_b16 v[40:41], v3 offset:30912
    ds_read_b64_tr_b16 v[42:43], v3 offset:32200
    s_waitcnt lgkmcnt(8)
    v_mfma_f32_32x32x16_bf16 v[80:95], a[72:75], v[24:27], v[80:95]
    ds_read_b64_tr_b16 v[44:45], v3 offset:36064
    ds_read_b64_tr_b16 v[46:47], v3 offset:37352
    s_waitcnt lgkmcnt(8)
    v_mfma_f32_32x32x16_bf16 v[80:95], a[76:79], v[28:31], v[80:95]
    ds_read_b64_tr_b16 v[16:17], v3 offset:64
    ds_read_b64_tr_b16 v[18:19], v3 offset:1352
    s_waitcnt lgkmcnt(8)
    v_mfma_f32_32x32x16_bf16 v[80:95], a[80:83], v[32:35], v[80:95]
    ds_read_b64_tr_b16 v[20:21], v3 offset:5216
    ds_read_b64_tr_b16 v[22:23], v3 offset:6504
    s_waitcnt lgkmcnt(8)
    v_mfma_f32_32x32x16_bf16 v[80:95], a[84:87], v[36:39], v[80:95]
    ds_read_b64_tr_b16 v[24:25], v3 offset:10368
    ds_read_b64_tr_b16 v[26:27], v3 offset:11656
    s_waitcnt lgkmcnt(8)
    v_mfma_f32_32x32x16_bf16 v[80:95], a[88:91], v[40:43], v[80:95]
    ds_read_b64_tr_b16 v[28:29], v3 offset:15520
    ds_read_b64_tr_b16 v[30:31], v3 offset:16808
    s_waitcnt lgkmcnt(8)
    v_mfma_f32_32x32x16_bf16 v[80:95], a[92:95], v[44:47], v[80:95]
    ds_read_b64_tr_b16 v[32:33], v3 offset:20672
    ds_read_b64_tr_b16 v[34:35], v3 offset:21960
    s_waitcnt lgkmcnt(8)
    v_mfma_f32_32x32x16_bf16 v[96:111], a[64:67], v[16:19], v[96:111]
    ds_read_b64_tr_b16 v[36:37], v3 offset:25824
    ds_read_b64_tr_b16 v[38:39], v3 offset:27112
    s_waitcnt lgkmcnt(8)
    v_mfma_f32_32x32x16_bf16 v[96:111], a[68:71], v[20:23], v[96:111]
    ds_read_b64_tr_b16 v[40:41], v3 offset:30976
    ds_read_b64_tr_b16 v[42:43], v3 offset:32264
    s_waitcnt lgkmcnt(8)
    v_mfma_f32_32x32x16_bf16 v[96:111], a[72:75], v[24:27], v[96:111]
    ds_read_b64_tr_b16 v[44:45], v3 offset:36128
    ds_read_b64_tr_b16 v[46:47], v3 offset:37416
    s_waitcnt lgkmcnt(8)
    v_mfma_f32_32x32x16_bf16 v[96:111], a[76:79], v[28:31], v[96:111]
    ds_read_b64_tr_b16 v[16:17], v3 offset:128
    ds_read_b64_tr_b16 v[18:19], v3 offset:1416
    v_cvt_pk_bf16_f32 v80, v80, v81
    v_cvt_pk_bf16_f32 v81, v82, v83
    ds_write_b64 v10, v[80:81] offset:0
    s_waitcnt lgkmcnt(9)
    v_mfma_f32_32x32x16_bf16 v[96:111], a[80:83], v[32:35], v[96:111]
    ds_read_b64_tr_b16 v[20:21], v3 offset:5280
    ds_read_b64_tr_b16 v[22:23], v3 offset:6568
    v_cvt_pk_bf16_f32 v82, v84, v85
    v_cvt_pk_bf16_f32 v83, v86, v87
    ds_write_b64 v10, v[82:83] offset:16
    s_waitcnt lgkmcnt(10)
    v_mfma_f32_32x32x16_bf16 v[96:111], a[84:87], v[36:39], v[96:111]
    ds_read_b64_tr_b16 v[24:25], v3 offset:10432
    ds_read_b64_tr_b16 v[26:27], v3 offset:11720
    v_cvt_pk_bf16_f32 v84, v88, v89
    v_cvt_pk_bf16_f32 v85, v90, v91
    ds_write_b64 v10, v[84:85] offset:32
    s_waitcnt lgkmcnt(11)
    v_mfma_f32_32x32x16_bf16 v[96:111], a[88:91], v[40:43], v[96:111]
    ds_read_b64_tr_b16 v[28:29], v3 offset:15584
    ds_read_b64_tr_b16 v[30:31], v3 offset:16872
    v_cvt_pk_bf16_f32 v86, v92, v93
    v_cvt_pk_bf16_f32 v87, v94, v95
    ds_write_b64 v10, v[86:87] offset:48
    s_waitcnt lgkmcnt(12)
    v_mfma_f32_32x32x16_bf16 v[96:111], a[92:95], v[44:47], v[96:111]
    ds_read_b64_tr_b16 v[32:33], v3 offset:20736
    ds_read_b64_tr_b16 v[34:35], v3 offset:22024
    ds_read_b128 v[52:55], v11 offset:0
    s_waitcnt lgkmcnt(13)
    v_mfma_f32_32x32x16_bf16 v[112:127], a[64:67], v[16:19], v[112:127]
    ds_read_b64_tr_b16 v[36:37], v3 offset:25888
    ds_read_b64_tr_b16 v[38:39], v3 offset:27176
    ds_read_b128 v[56:59], v11 offset:1280
    s_waitcnt lgkmcnt(13)
    v_mfma_f32_32x32x16_bf16 v[112:127], a[68:71], v[20:23], v[112:127]
    ds_read_b64_tr_b16 v[40:41], v3 offset:31040
    ds_read_b64_tr_b16 v[42:43], v3 offset:32328
    s_waitcnt lgkmcnt(12)
    v_mfma_f32_32x32x16_bf16 v[112:127], a[72:75], v[24:27], v[112:127]
    ds_read_b64_tr_b16 v[44:45], v3 offset:36192
    ds_read_b64_tr_b16 v[46:47], v3 offset:37480
    s_waitcnt lgkmcnt(11)
    v_mfma_f32_32x32x16_bf16 v[112:127], a[76:79], v[28:31], v[112:127]
    ds_read_b64_tr_b16 v[16:17], v2 offset:192
    ds_read_b64_tr_b16 v[18:19], v2 offset:1480
    v_cvt_pk_bf16_f32 v96, v96, v97
    v_cvt_pk_bf16_f32 v97, v98, v99
    ds_write_b64 v10, v[96:97] offset:2560
    s_waitcnt lgkmcnt(11)
    v_mfma_f32_32x32x16_bf16 v[112:127], a[80:83], v[32:35], v[112:127]
    ds_read_b64_tr_b16 v[20:21], v2 offset:5344
    ds_read_b64_tr_b16 v[22:23], v2 offset:6632
    v_cvt_pk_bf16_f32 v98, v100, v101
    v_cvt_pk_bf16_f32 v99, v102, v103
    ds_write_b64 v10, v[98:99] offset:2576
    s_waitcnt lgkmcnt(11)
    v_mfma_f32_32x32x16_bf16 v[112:127], a[84:87], v[36:39], v[112:127]
    ds_read_b64_tr_b16 v[24:25], v2 offset:10496
    ds_read_b64_tr_b16 v[26:27], v2 offset:11784
    buffer_store_dwordx4 v[52:55], v4, s[28:31], 0 offen sc1
    v_add_u32 v4, 2097152, v4
    v_cvt_pk_bf16_f32 v100, v104, v105
    v_cvt_pk_bf16_f32 v101, v106, v107
    ds_write_b64 v10, v[100:101] offset:2592
    s_waitcnt lgkmcnt(11)
    v_mfma_f32_32x32x16_bf16 v[112:127], a[88:91], v[40:43], v[112:127]
    ds_read_b64_tr_b16 v[28:29], v2 offset:15648
    ds_read_b64_tr_b16 v[30:31], v2 offset:16936
    buffer_store_dwordx4 v[56:59], v4, s[28:31], 0 offen sc1
    v_add_u32 v4, 2097152, v4
    v_cvt_pk_bf16_f32 v102, v108, v109
    v_cvt_pk_bf16_f32 v103, v110, v111
    ds_write_b64 v10, v[102:103] offset:2608
    s_waitcnt lgkmcnt(12)
    v_mfma_f32_32x32x16_bf16 v[112:127], a[92:95], v[44:47], v[112:127]
    ds_read_b64_tr_b16 v[32:33], v2 offset:20800
    ds_read_b64_tr_b16 v[34:35], v2 offset:22088
    ds_read_b128 v[60:63], v11 offset:2560
    s_waitcnt lgkmcnt(13)
    v_mfma_f32_32x32x16_bf16 v[128:143], a[32:35], v[16:19], 0
    ds_read_b64_tr_b16 v[36:37], v2 offset:25952
    ds_read_b64_tr_b16 v[38:39], v2 offset:27240
    ds_read_b128 v[64:67], v11 offset:3840
    s_waitcnt lgkmcnt(13)
    v_mfma_f32_32x32x16_bf16 v[128:143], a[36:39], v[20:23], v[128:143]
    ds_read_b64_tr_b16 v[40:41], v2 offset:31104
    ds_read_b64_tr_b16 v[42:43], v2 offset:32392
    s_waitcnt lgkmcnt(12)
    v_mfma_f32_32x32x16_bf16 v[128:143], a[40:43], v[24:27], v[128:143]
    ds_read_b64_tr_b16 v[44:45], v2 offset:36256
    ds_read_b64_tr_b16 v[46:47], v2 offset:37544
    s_waitcnt lgkmcnt(11)
    v_mfma_f32_32x32x16_bf16 v[128:143], a[44:47], v[28:31], v[128:143]
    ds_read_b64_tr_b16 v[16:17], v3 offset:192
    ds_read_b64_tr_b16 v[18:19], v3 offset:1480
    v_cvt_pk_bf16_f32 v112, v112, v113
    v_cvt_pk_bf16_f32 v113, v114, v115
    ds_write_b64 v10, v[112:113] offset:0
    s_waitcnt lgkmcnt(11)
    v_mfma_f32_32x32x16_bf16 v[128:143], a[48:51], v[32:35], v[128:143]
    ds_read_b64_tr_b16 v[20:21], v3 offset:5344
    ds_read_b64_tr_b16 v[22:23], v3 offset:6632
    v_cvt_pk_bf16_f32 v114, v116, v117
    v_cvt_pk_bf16_f32 v115, v118, v119
    ds_write_b64 v10, v[114:115] offset:16
    s_waitcnt lgkmcnt(11)
    v_mfma_f32_32x32x16_bf16 v[128:143], a[52:55], v[36:39], v[128:143]
    ds_read_b64_tr_b16 v[24:25], v3 offset:10496
    ds_read_b64_tr_b16 v[26:27], v3 offset:11784
    buffer_store_dwordx4 v[60:63], v4, s[28:31], 0 offen sc1
    v_add_u32 v4, 2097152, v4
    v_cvt_pk_bf16_f32 v116, v120, v121
    v_cvt_pk_bf16_f32 v117, v122, v123
    ds_write_b64 v10, v[116:117] offset:32
    s_waitcnt lgkmcnt(11)
    v_mfma_f32_32x32x16_bf16 v[128:143], a[56:59], v[40:43], v[128:143]
    ds_read_b64_tr_b16 v[28:29], v3 offset:15648
    ds_read_b64_tr_b16 v[30:31], v3 offset:16936
    buffer_store_dwordx4 v[64:67], v4, s[28:31], 0 offen sc1
    v_add_u32 v4, 2097152, v4
    v_cvt_pk_bf16_f32 v118, v124, v125
    v_cvt_pk_bf16_f32 v119, v126, v127
    ds_write_b64 v10, v[118:119] offset:48
    s_waitcnt lgkmcnt(12)
    v_mfma_f32_32x32x16_bf16 v[128:143], a[60:63], v[44:47], v[128:143]
    ds_read_b64_tr_b16 v[32:33], v3 offset:20800
    ds_read_b64_tr_b16 v[34:35], v3 offset:22088
    ds_read_b128 v[52:55], v11 offset:0
    s_waitcnt lgkmcnt(13)
    v_mfma_f32_32x32x16_bf16 v[128:143], a[64:67], v[16:19], v[128:143]
    ds_read_b64_tr_b16 v[36:37], v3 offset:25952
    ds_read_b64_tr_b16 v[38:39], v3 offset:27240
    ds_read_b128 v[56:59], v11 offset:1280
    s_waitcnt lgkmcnt(13)
    v_mfma_f32_32x32x16_bf16 v[128:143], a[68:71], v[20:23], v[128:143]
    ds_read_b64_tr_b16 v[40:41], v3 offset:31104
    ds_read_b64_tr_b16 v[42:43], v3 offset:32392
    s_waitcnt lgkmcnt(12)
    v_mfma_f32_32x32x16_bf16 v[128:143], a[72:75], v[24:27], v[128:143]
    ds_read_b64_tr_b16 v[44:45], v3 offset:36256
    ds_read_b64_tr_b16 v[46:47], v3 offset:37544
    s_waitcnt lgkmcnt(11)
    v_mfma_f32_32x32x16_bf16 v[128:143], a[76:79], v[28:31], v[128:143]
    ds_read_b64_tr_b16 v[16:17], v2 offset:256
    ds_read_b64_tr_b16 v[18:19], v2 offset:1544
    s_waitcnt lgkmcnt(10)
    v_mfma_f32_32x32x16_bf16 v[128:143], a[80:83], v[32:35], v[128:143]
    ds_read_b64_tr_b16 v[20:21], v2 offset:5408
    ds_read_b64_tr_b16 v[22:23], v2 offset:6696
    s_waitcnt lgkmcnt(9)
    v_mfma_f32_32x32x16_bf16 v[128:143], a[84:87], v[36:39], v[128:143]
    ds_read_b64_tr_b16 v[24:25], v2 offset:10560
    ds_read_b64_tr_b16 v[26:27], v2 offset:11848
    buffer_store_dwordx4 v[52:55], v4, s[28:31], 0 offen sc1
    v_add_u32 v4, 2097152, v4
    s_waitcnt lgkmcnt(8)
    v_mfma_f32_32x32x16_bf16 v[128:143], a[88:91], v[40:43], v[128:143]
    ds_read_b64_tr_b16 v[28:29], v2 offset:15712
    ds_read_b64_tr_b16 v[30:31], v2 offset:17000
    buffer_store_dwordx4 v[56:59], v4, s[28:31], 0 offen sc1
    v_add_u32 v4, 2097152, v4
    s_waitcnt lgkmcnt(8)
    v_mfma_f32_32x32x16_bf16 v[128:143], a[92:95], v[44:47], v[128:143]
    ds_read_b64_tr_b16 v[32:33], v2 offset:20864
    ds_read_b64_tr_b16 v[34:35], v2 offset:22152
    s_waitcnt lgkmcnt(8)
    v_mfma_f32_32x32x16_bf16 v[144:159], a[32:35], v[16:19], 0
    ds_read_b64_tr_b16 v[36:37], v2 offset:26016
    ds_read_b64_tr_b16 v[38:39], v2 offset:27304
    s_waitcnt lgkmcnt(8)
    v_mfma_f32_32x32x16_bf16 v[144:159], a[36:39], v[20:23], v[144:159]
    ds_read_b64_tr_b16 v[40:41], v2 offset:31168
    ds_read_b64_tr_b16 v[42:43], v2 offset:32456
    s_waitcnt lgkmcnt(8)
    v_mfma_f32_32x32x16_bf16 v[144:159], a[40:43], v[24:27], v[144:159]
    ds_read_b64_tr_b16 v[44:45], v2 offset:36320
    ds_read_b64_tr_b16 v[46:47], v2 offset:37608
    s_waitcnt lgkmcnt(8)
    v_mfma_f32_32x32x16_bf16 v[144:159], a[44:47], v[28:31], v[144:159]
    ds_read_b64_tr_b16 v[16:17], v3 offset:256
    ds_read_b64_tr_b16 v[18:19], v3 offset:1544
    v_cvt_pk_bf16_f32 v128, v128, v129
    v_cvt_pk_bf16_f32 v129, v130, v131
    ds_write_b64 v10, v[128:129] offset:2560
    s_waitcnt lgkmcnt(9)
    v_mfma_f32_32x32x16_bf16 v[144:159], a[48:51], v[32:35], v[144:159]
    ds_read_b64_tr_b16 v[20:21], v3 offset:5408
    ds_read_b64_tr_b16 v[22:23], v3 offset:6696
    v_cvt_pk_bf16_f32 v130, v132, v133
    v_cvt_pk_bf16_f32 v131, v134, v135
    ds_write_b64 v10, v[130:131] offset:2576
    s_waitcnt lgkmcnt(10)
    v_mfma_f32_32x32x16_bf16 v[144:159], a[52:55], v[36:39], v[144:159]
    ds_read_b64_tr_b16 v[24:25], v3 offset:10560
    ds_read_b64_tr_b16 v[26:27], v3 offset:11848
    v_cvt_pk_bf16_f32 v132, v136, v137
    v_cvt_pk_bf16_f32 v133, v138, v139
    ds_write_b64 v10, v[132:133] offset:2592
    s_waitcnt lgkmcnt(11)
    v_mfma_f32_32x32x16_bf16 v[144:159], a[56:59], v[40:43], v[144:159]
    ds_read_b64_tr_b16 v[28:29], v3 offset:15712
    ds_read_b64_tr_b16 v[30:31], v3 offset:17000
    v_cvt_pk_bf16_f32 v134, v140, v141
    v_cvt_pk_bf16_f32 v135, v142, v143
    ds_write_b64 v10, v[134:135] offset:2608
    s_waitcnt lgkmcnt(12)
    v_mfma_f32_32x32x16_bf16 v[144:159], a[60:63], v[44:47], v[144:159]
    ds_read_b64_tr_b16 v[32:33], v3 offset:20864
    ds_read_b64_tr_b16 v[34:35], v3 offset:22152
    ds_read_b128 v[60:63], v11 offset:2560
    s_waitcnt lgkmcnt(13)
    v_mfma_f32_32x32x16_bf16 v[144:159], a[64:67], v[16:19], v[144:159]
    ds_read_b64_tr_b16 v[36:37], v3 offset:26016
    ds_read_b64_tr_b16 v[38:39], v3 offset:27304
    ds_read_b128 v[64:67], v11 offset:3840
    s_waitcnt lgkmcnt(13)
    v_mfma_f32_32x32x16_bf16 v[144:159], a[68:71], v[20:23], v[144:159]
    ds_read_b64_tr_b16 v[40:41], v3 offset:31168
    ds_read_b64_tr_b16 v[42:43], v3 offset:32456
    s_waitcnt lgkmcnt(12)
    v_mfma_f32_32x32x16_bf16 v[144:159], a[72:75], v[24:27], v[144:159]
    ds_read_b64_tr_b16 v[44:45], v3 offset:36320
    ds_read_b64_tr_b16 v[46:47], v3 offset:37608
    s_waitcnt lgkmcnt(11)
    v_mfma_f32_32x32x16_bf16 v[144:159], a[76:79], v[28:31], v[144:159]
    s_waitcnt lgkmcnt(8)
    v_mfma_f32_32x32x16_bf16 v[144:159], a[80:83], v[32:35], v[144:159]
    s_waitcnt lgkmcnt(5)
    v_mfma_f32_32x32x16_bf16 v[144:159], a[84:87], v[36:39], v[144:159]
    buffer_store_dwordx4 v[60:63], v4, s[28:31], 0 offen sc1
    v_add_u32 v4, 2097152, v4
    s_waitcnt lgkmcnt(2)
    v_mfma_f32_32x32x16_bf16 v[144:159], a[88:91], v[40:43], v[144:159]
    buffer_store_dwordx4 v[64:67], v4, s[28:31], 0 offen sc1
    v_add_u32 v4, 2097152, v4
    s_waitcnt lgkmcnt(0)
    v_mfma_f32_32x32x16_bf16 v[144:159], a[92:95], v[44:47], v[144:159]
    s_nop 11
    v_cvt_pk_bf16_f32 v144, v144, v145
    v_cvt_pk_bf16_f32 v145, v146, v147
    ds_write_b64 v10, v[144:145] offset:0
    v_cvt_pk_bf16_f32 v146, v148, v149
    v_cvt_pk_bf16_f32 v147, v150, v151
    ds_write_b64 v10, v[146:147] offset:16
    v_cvt_pk_bf16_f32 v148, v152, v153
    v_cvt_pk_bf16_f32 v149, v154, v155
    ds_write_b64 v10, v[148:149] offset:32
    v_cvt_pk_bf16_f32 v150, v156, v157
    v_cvt_pk_bf16_f32 v151, v158, v159
    ds_write_b64 v10, v[150:151] offset:48
    ds_read_b128 v[52:55], v11 offset:0
    ds_read_b128 v[56:59], v11 offset:1280
    s_waitcnt lgkmcnt(1)
    buffer_store_dwordx4 v[52:55], v4, s[28:31], 0 offen sc1
    v_add_u32 v4, 2097152, v4
    s_waitcnt lgkmcnt(0)
    buffer_store_dwordx4 v[56:59], v4, s[28:31], 0 offen sc1
    v_add_u32 v4, 2097152, v4
L_end:
    s_endpgm
.section .rodata,"a"
.p2align 6
.amdhsa_kernel standalone__tensor_product_equiv_mace__graph_kernel
  .amdhsa_next_free_vgpr 256
  .amdhsa_next_free_sgpr 102
  .amdhsa_accum_offset 160
  .amdhsa_group_segment_fixed_size 0
  .amdhsa_kernarg_size 88
  .amdhsa_user_sgpr_count 2
  .amdhsa_user_sgpr_kernarg_segment_ptr 1
  .amdhsa_system_sgpr_workgroup_id_x 1
  .amdhsa_float_denorm_mode_32 3
.end_amdhsa_kernel
```

```asm
; @launch grid=(256,1,1) block=(512,1,1) lds=153600
.amdgcn_target "amdgcn-amd-amdhsa--gfx950"
.text
.globl standalone__tensor_product_equiv_mace__graph_kernel
.p2align 8
.type standalone__tensor_product_equiv_mace__graph_kernel,@function
standalone__tensor_product_equiv_mace__graph_kernel:
    s_cmp_ge_u32 s2, 256
    s_cbranch_scc1 L_end
    s_load_dwordx2 s[84:85], s[0:1], 80
    s_load_dwordx16 s[64:79], s[0:1], 0
    s_load_dwordx2 s[80:81], s[0:1], 64
    v_and_b32 v1, 63, v0
    v_lshrrev_b32 v60, 6, v0
    v_mov_b32 v12, 0
    v_readfirstlane_b32 s3, v60
    s_and_b32 s55, s2, 63
    s_and_b32 s54, s2, 192
    s_mul_i32 s53, s55, 10000
    v_lshlrev_b32 v63, 4, v0
    v_add_u32 v60, s53, v63
    s_add_u32 s53, s53, 8192
    v_lshl_add_u32 v61, v0, 2, s53
    s_lshl_b32 s53, s54, 1
    v_mov_b32 v62, s53
    s_waitcnt lgkmcnt(0)
    s_mov_b32 s16, s68
    s_mov_b32 s17, s69
    s_mov_b32 s18, 640000
    s_mov_b32 s19, 0x00020000
    buffer_load_dwordx4 v[16:19], v60, s[16:19], 0 offen
    buffer_load_dword v20, v61, s[16:19], 0 offen
    s_mov_b32 s12, s66
    s_mov_b32 s13, s67
    s_mov_b32 s14, 640000
    s_mov_b32 s15, 0x00020000
    buffer_load_dwordx4 v[24:27], v60, s[12:15], 0 offen
    buffer_load_dword v28, v61, s[12:15], 0 offen
    s_mov_b32 s32, s84
    s_mov_b32 s33, s85
    s_mov_b32 s34, 20971520
    s_mov_b32 s35, 0x00020000
    buffer_load_dword v42, v62, s[32:35], 0 offen sc1
    s_mov_b32 s20, s70
    s_mov_b32 s21, s71
    s_mov_b32 s22, 1280000
    s_mov_b32 s23, 0x00020000
    v_mov_b32 v72, -1
    v_mov_b32 v73, -1
    v_mov_b32 v74, -1
    v_mov_b32 v75, -1
    ds_write_b128 v63, v[72:75] offset:0
    ds_write_b128 v63, v[72:75] offset:8192
    v_mov_b32 v68, 0
    v_mov_b32 v69, 0
    v_lshlrev_b32 v60, 3, v0
    v_add_u32 v60, 111136, v60
    ds_write_b64 v60, v[68:69]
    v_min_u32 v60, 35, v1
    v_lshlrev_b32 v60, 3, v60
    v_add_u32 v60, 110848, v60
    ds_write_b64 v60, v[68:69]
    s_mov_b32 s8, s64
    s_mov_b32 s9, s65
    s_mov_b32 s10, 20480000
    s_mov_b32 s11, 0x00020000
    s_mov_b32 s24, s72
    s_mov_b32 s25, s73
    s_mov_b32 s26, 5120000
    s_mov_b32 s27, 0x00020000
    s_mov_b32 s28, s80
    s_mov_b32 s29, s81
    s_mov_b32 s30, 20480000
    s_mov_b32 s31, 0x00020000
    s_mov_b32 s96, s74
    s_mov_b32 s97, s75
    s_mov_b32 s98, 128
    s_mov_b32 s99, 0x00020000
    s_mov_b32 s92, s76
    s_mov_b32 s93, s77
    s_mov_b32 s94, 8192
    s_mov_b32 s95, 0x00020000
    s_mov_b32 s88, s78
    s_mov_b32 s89, s79
    s_mov_b32 s90, 131072
    s_mov_b32 s91, 0x00020000
    s_lshl_b32 s63, s3, 13
    s_mov_b32 s52, 0
    s_mov_b32 s77, 0
    s_mov_b32 s82, 0x3fff00
    s_mov_b32 s83, 20971520
    s_mov_b32 s81, 8
    s_lshl_b32 s49, s3, 10
    s_add_u32 s49, s49, 119328
    s_movk_i32 s53, 452
    v_cmp_gt_u32 s[50:51], s53, v0
    v_lshlrev_b32 v43, 22, v0
    v_lshlrev_b32 v59, 20, v0
    v_mov_b32 v58, 1
    s_waitcnt lgkmcnt(0)
    s_barrier
    v_and_b32 v60, 3, v1
    v_lshlrev_b32 v61, 5, v60
    v_lshrrev_b32 v66, 4, v1
    v_lshl_add_u32 v61, v66, 1, v61
    buffer_load_ushort v44, v61, s[96:99], 0 offen offset:0
    buffer_load_ushort v45, v61, s[96:99], 0 offen offset:8
    buffer_load_ushort v46, v61, s[96:99], 0 offen offset:16
    buffer_load_ushort v47, v61, s[96:99], 0 offen offset:24
    s_lshl_b32 s53, s3, 10
    s_add_u32 m0, s53, 32768
    v_bfe_u32 v62, v1, 1, 2
    v_bfe_u32 v64, v1, 3, 1
    v_lshl_add_u32 v62, v64, 3, v62
    v_bfe_u32 v64, v1, 4, 1
    v_lshl_add_u32 v62, v64, 2, v62
    v_lshlrev_b32 v62, 9, v62
    v_lshrrev_b32 v64, 5, v1
    v_lshl_add_u32 v62, v64, 5, v62
    v_and_b32 v64, 1, v1
    v_lshl_add_u32 v62, v64, 4, v62
    s_lshl_b32 s53, s3, 6
    buffer_load_dwordx4 v62, s[92:95], s53 offen lds
    v_lshlrev_b32 v64, 4, v1
    s_lshr_b32 s53, s2, 3
    s_lshl3_add_u32 s53, s53, s3
    s_lshl_b32 s53, s53, 10
    v_add_u32 v79, s53, v64
    buffer_load_dwordx4 v[156:159], v79, s[20:23], 0 offen
    v_add_u32 v79, 262144, v79
    buffer_load_dwordx4 v[156:159], v79, s[20:23], 0 offen
    v_add_u32 v79, 262144, v79
    v_and_b32 v61, 7, v1
    v_bfe_u32 v65, v1, 3, 1
    v_lshlrev_b32 v65, 9, v65
    v_lshl_add_u32 v65, v66, 7, v65
    v_lshl_add_u32 v2, v61, 4, v65
    v_xor_b32 v61, 4, v61
    v_lshl_add_u32 v3, v61, 4, v65
    v_bfe_u32 v60, v1, 2, 2
    v_bfe_u32 v62, v1, 1, 1
    v_lshl_add_u32 v62, v66, 1, v62
    v_lshrrev_b32 v63, 1, v60
    v_lshlrev_b32 v64, 2, v63
    v_xor_b32 v62, v62, v64
    v_and_b32 v64, 1, v60
    v_lshl_add_u32 v62, v64, 3, v62
    v_lshlrev_b32 v62, 4, v62
    v_lshl_add_u32 v62, v63, 10, v62
    v_and_b32 v64, 1, v1
    v_lshl_add_u32 v62, v64, 3, v62
    v_add_u32 v4, s63, v62
    v_lshrrev_b32 v61, 5, v1
    v_mov_b32 v63, 32
    v_cmp_eq_u32 vcc, v60, v61
    v_add_u32 v61, 2, v61
    v_and_b32 v64, 3, v1
    v_cndmask_b32 v7, 0, v63, vcc
    v_cmp_eq_u32 vcc, v60, v61
    v_cmp_eq_u32 s[4:5], v64, v66
    v_mov_b32 v65, 8
    v_cndmask_b32 v8, 0, v63, vcc
    v_cndmask_b32 v10, 0, v65, s[4:5]
    v_lshrrev_b32 v68, 3, v0
    v_and_b32 v69, 7, v0
    v_lshlrev_b32 v69, 4, v69
    v_add_u32 v61, s54, v68
    s_movk_i32 s46, 8320
    v_mad_u32_u24 v64, v61, s46, v69
    s_lshl_b32 s45, s55, 7
    s_add_u32 s53, s45, 8388608
    v_add_u32 v64, s53, v64
    v_lshl_add_u32 v65, v61, 13, v69
    s_add_u32 s53, s45, 16777216
    v_add_u32 v65, s53, v65
    v_lshlrev_b32 v61, 4, v0
    s_mov_b32 s53, 110880
    v_lshl_add_u32 v67, v68, 2, s53
    s_waitcnt vmcnt(10)
    v_and_b32 v48, 255, v16
    v_subrev_u32 v48, s54, v48
    v_cmp_gt_u32 s[64:65], 64, v48
    v_lshl_add_u32 v60, v48, 2, s53
    s_mov_b64 exec, s[64:65]
    ds_add_rtn_u32 v53, v60, v58
    s_mov_b64 exec, -1
    v_and_b32 v49, 255, v17
    v_subrev_u32 v49, s54, v49
    v_cmp_gt_u32 s[66:67], 64, v49
    v_lshl_add_u32 v60, v49, 2, s53
    s_mov_b64 exec, s[66:67]
    ds_add_rtn_u32 v54, v60, v58
    s_mov_b64 exec, -1
    v_and_b32 v50, 255, v18
    v_subrev_u32 v50, s54, v50
    v_cmp_gt_u32 s[68:69], 64, v50
    v_lshl_add_u32 v60, v50, 2, s53
    s_mov_b64 exec, s[68:69]
    ds_add_rtn_u32 v55, v60, v58
    s_mov_b64 exec, -1
    v_and_b32 v51, 255, v19
    v_subrev_u32 v51, s54, v51
    v_cmp_gt_u32 s[70:71], 64, v51
    v_lshl_add_u32 v60, v51, 2, s53
    s_mov_b64 exec, s[70:71]
    ds_add_rtn_u32 v56, v60, v58
    s_mov_b64 exec, -1
    v_and_b32 v52, 255, v20
    v_subrev_u32 v52, s54, v52
    v_cmp_gt_u32 s[72:73], 64, v52
    v_lshl_add_u32 v60, v52, 2, s53
    s_and_b64 s[72:73], s[72:73], s[50:51]
    s_mov_b64 exec, s[72:73]
    ds_add_rtn_u32 v57, v60, v58
    s_mov_b64 exec, -1
    s_waitcnt vmcnt(7)
    v_readfirstlane_b32 s48, v42
    buffer_load_dwordx4 v[156:159], v79, s[20:23], 0 offen
    v_add_u32 v79, 262144, v79
    buffer_load_dwordx4 v[156:159], v79, s[20:23], 0 offen
    v_add_u32 v79, 262144, v79
    buffer_load_dwordx4 v[156:159], v79, s[20:23], 0 offen
    v_add_u32 v79, 262144, v79
    v_bfe_u32 v16, v16, 8, 6
    v_min_u32 v16, 47, v16
    v_min_u32 v24, 9999, v24
    v_lshl_or_b32 v16, v24, 6, v16
    v_add_u32 v24, 0, v43
    v_or_b32 v16, v16, v24
    v_lshlrev_b32 v48, 7, v48
    v_bfe_u32 v17, v17, 8, 6
    v_min_u32 v17, 47, v17
    v_min_u32 v25, 9999, v25
    v_lshl_or_b32 v17, v25, 6, v17
    v_add_u32 v25, 1048576, v43
    v_or_b32 v17, v17, v25
    v_lshlrev_b32 v49, 7, v49
    v_bfe_u32 v18, v18, 8, 6
    v_min_u32 v18, 47, v18
    v_min_u32 v26, 9999, v26
    v_lshl_or_b32 v18, v26, 6, v18
    v_add_u32 v26, 2097152, v43
    v_or_b32 v18, v18, v26
    v_lshlrev_b32 v50, 7, v50
    v_bfe_u32 v19, v19, 8, 6
    v_min_u32 v19, 47, v19
    v_min_u32 v27, 9999, v27
    v_lshl_or_b32 v19, v27, 6, v19
    v_add_u32 v27, 3145728, v43
    v_or_b32 v19, v19, v27
    v_lshlrev_b32 v51, 7, v51
    v_bfe_u32 v20, v20, 8, 6
    v_min_u32 v20, 47, v20
    v_min_u32 v28, 9999, v28
    v_lshl_or_b32 v20, v28, 6, v20
    v_add_u32 v28, 2147483648, v59
    v_or_b32 v20, v20, v28
    v_lshlrev_b32 v52, 7, v52
    v_mov_b32 v59, -2
    s_add_u32 s48, s48, 1
    s_movk_i32 s53, 7808
    s_waitcnt lgkmcnt(0)
    v_cmp_gt_u32 vcc, 31, v53
    v_min_u32 v53, 31, v53
    v_mul_u32_u24 v32, 43, v53
    v_cndmask_b32 v16, v59, v16, vcc
    v_lshrrev_b32 v32, 7, v32
    v_cmp_gt_u32 vcc, 24, v53
    v_add_lshl_u32 v32, v32, v53, 2
    v_lshl_add_u32 v33, v53, 4, s53
    v_cndmask_b32 v32, v33, v32, vcc
    v_add_u32 v48, v48, v32
    s_mov_b64 exec, s[64:65]
    ds_write_b32 v48, v16 offset:0
    s_mov_b64 exec, -1
    v_cmp_gt_u32 vcc, 31, v54
    v_min_u32 v54, 31, v54
    v_mul_u32_u24 v32, 43, v54
    v_cndmask_b32 v17, v59, v17, vcc
    v_lshrrev_b32 v32, 7, v32
    v_cmp_gt_u32 vcc, 24, v54
    v_add_lshl_u32 v32, v32, v54, 2
    v_lshl_add_u32 v33, v54, 4, s53
    v_cndmask_b32 v32, v33, v32, vcc
    v_add_u32 v49, v49, v32
    s_mov_b64 exec, s[66:67]
    ds_write_b32 v49, v17 offset:0
    s_mov_b64 exec, -1
    v_cmp_gt_u32 vcc, 31, v55
    v_min_u32 v55, 31, v55
    v_mul_u32_u24 v32, 43, v55
    v_cndmask_b32 v18, v59, v18, vcc
    v_lshrrev_b32 v32, 7, v32
    v_cmp_gt_u32 vcc, 24, v55
    v_add_lshl_u32 v32, v32, v55, 2
    v_lshl_add_u32 v33, v55, 4, s53
    v_cndmask_b32 v32, v33, v32, vcc
    v_add_u32 v50, v50, v32
    s_mov_b64 exec, s[68:69]
    ds_write_b32 v50, v18 offset:0
    s_mov_b64 exec, -1
    v_cmp_gt_u32 vcc, 31, v56
    v_min_u32 v56, 31, v56
    v_mul_u32_u24 v32, 43, v56
    v_cndmask_b32 v19, v59, v19, vcc
    v_lshrrev_b32 v32, 7, v32
    v_cmp_gt_u32 vcc, 24, v56
    v_add_lshl_u32 v32, v32, v56, 2
    v_lshl_add_u32 v33, v56, 4, s53
    v_cndmask_b32 v32, v33, v32, vcc
    v_add_u32 v51, v51, v32
    s_mov_b64 exec, s[70:71]
    ds_write_b32 v51, v19 offset:0
    s_mov_b64 exec, -1
    v_cmp_gt_u32 vcc, 31, v57
    v_min_u32 v57, 31, v57
    v_mul_u32_u24 v32, 43, v57
    v_cndmask_b32 v20, v59, v20, vcc
    v_lshrrev_b32 v32, 7, v32
    v_cmp_gt_u32 vcc, 24, v57
    v_add_lshl_u32 v32, v32, v57, 2
    v_lshl_add_u32 v33, v57, 4, s53
    v_cndmask_b32 v32, v33, v32, vcc
    v_add_u32 v52, v52, v32
    s_mov_b64 exec, s[72:73]
    ds_write_b32 v52, v20 offset:0
    s_mov_b64 exec, -1
    s_waitcnt lgkmcnt(0)
    s_barrier
    ds_read_b128 v[16:19], v61 offset:0
    ds_read_b32 v67, v67
    s_waitcnt lgkmcnt(1)
    v_mov_b32 v19, s48
    buffer_store_dwordx4 v[16:19], v64, s[32:35], 0 offen sc1
    s_waitcnt lgkmcnt(0)
    v_cmp_lt_u32 vcc, 23, v67
    s_cbranch_vccz L_noup
    ds_read_b128 v[28:31], v61 offset:8192
    s_waitcnt lgkmcnt(0)
    v_mov_b32 v31, s48
    s_mov_b64 exec, vcc
    buffer_store_dwordx4 v[28:31], v65, s[32:35], 0 offen sc1
    s_mov_b64 exec, -1
L_noup:
    s_cmp_ge_u32 s3, 2
    s_cbranch_scc1 L_nowf
    s_lshl1_add_u32 s44, s55, s3
    s_and_b32 s53, s44, 15
    s_lshl_b32 s53, s53, 13
    s_lshr_b32 s76, s44, 4
    s_lshl_b32 s76, s76, 6
    s_add_u32 s53, s53, s76
    v_lshrrev_b32 v60, 5, v1
    v_lshlrev_b32 v60, 12, v60
    v_and_b32 v61, 31, v1
    v_lshl_add_u32 v60, v61, 1, v60
    v_add_u32 v60, s53, v60
    buffer_load_ushort v32, v60, s[88:91], 0 offen offset:0
    buffer_load_ushort v33, v60, s[88:91], 0 offen offset:512
    buffer_load_ushort v34, v60, s[88:91], 0 offen offset:1024
    buffer_load_ushort v35, v60, s[88:91], 0 offen offset:1536
    buffer_load_ushort v36, v60, s[88:91], 0 offen offset:2048
    buffer_load_ushort v37, v60, s[88:91], 0 offen offset:2560
    buffer_load_ushort v38, v60, s[88:91], 0 offen offset:3072
    buffer_load_ushort v39, v60, s[88:91], 0 offen offset:3584
L_nowf:
    v_lshrrev_b32 v60, 5, v1
    v_bfe_u32 v61, v1, 2, 2
    v_bfe_u32 v62, v1, 4, 1
    v_and_b32 v63, 3, v1
    v_lshlrev_b32 v77, 7, v62
    v_lshl_add_u32 v77, v61, 5, v77
    v_lshl_add_u32 v77, v60, 9, v77
    v_lshl_add_u32 v77, v63, 3, v77
    s_mul_i32 s53, s2, 8320
    s_add_u32 s53, s53, 8388608
    v_lshl_add_u32 v70, v0, 4, s53
    s_lshl_b32 s53, s2, 13
    s_add_u32 s53, s53, 16777216
    v_lshl_add_u32 v71, v0, 4, s53
    v_mul_u32_u24 v73, 2500, v68
    s_cmp_ge_u32 s2, 16
    s_cbranch_scc1 L_2
    s_mov_b32 s100, 662282944
    s_mov_b32 s74, 0
    s_mov_b32 s75, 0
    s_cmp_eq_u32 s3, 1
    s_cmov_b32 s100, 577856449
    s_cmov_b32 s74, 1140852737
    s_cmov_b32 s75, 128
    s_cmp_eq_u32 s3, 2
    s_cmov_b32 s100, 543503171
    s_cmov_b32 s74, 1413515267
    s_cmov_b32 s75, 132
    s_cmp_eq_u32 s3, 3
    s_cmov_b32 s100, 612176386
    s_cmov_b32 s74, 1447602187
    s_cmov_b32 s75, 133
    s_cmp_eq_u32 s3, 4
    s_cmov_b32 s100, 561324933
    s_cmov_b32 s74, 3595217167
    s_cmov_b32 s75, 149
    s_cmp_eq_u32 s3, 5
    s_cmov_b32 s100, 594367236
    s_cmov_b32 s74, 4132366639
    s_cmov_b32 s75, 151
    s_cmp_eq_u32 s3, 6
    s_cmov_b32 s100, 626868807
    s_cmov_b32 s74, 4268685631
    s_cmov_b32 s75, 159
    s_cmp_eq_u32 s3, 7
    s_cmov_b32 s100, 643891846
    s_cmov_b32 s74, 4278123455
    s_cmov_b32 s75, 191
    s_branch L_1
L_2:
    s_mov_b32 s100, 645498048
    s_mov_b32 s74, 0
    s_mov_b32 s75, 0
    s_cmp_eq_u32 s3, 1
    s_cmov_b32 s100, 561844995
    s_cmov_b32 s74, 1091043329
    s_cmov_b32 s75, 64
    s_cmp_eq_u32 s3, 2
    s_cmov_b32 s100, 594862662
    s_cmov_b32 s74, 3238662153
    s_cmov_b32 s75, 66
    s_cmp_eq_u32 s3, 3
    s_cmov_b32 s100, 543769412
    s_cmov_b32 s74, 3775550025
    s_cmov_b32 s75, 74
    s_cmp_eq_u32 s3, 4
    s_cmov_b32 s100, 611415042
    s_cmov_b32 s74, 3843715673
    s_cmov_b32 s75, 75
    s_cmp_eq_u32 s3, 5
    s_cmov_b32 s100, 577590213
    s_cmov_b32 s74, 4120605277
    s_cmov_b32 s75, 91
    s_cmp_eq_u32 s3, 6
    s_cmov_b32 s100, 627385031
    s_cmov_b32 s74, 4256952957
    s_cmov_b32 s75, 95
    s_cmp_eq_u32 s3, 7
    s_cmov_b32 s100, 660120065
    s_cmov_b32 s74, 4290771709
    s_cmov_b32 s75, 127
L_1:
    v_mov_b64 v[80:81], 0
    v_mov_b64 v[82:83], 0
    v_mov_b64 v[84:85], 0
    v_mov_b64 v[86:87], 0
    v_mov_b64 v[88:89], 0
    v_mov_b64 v[90:91], 0
    v_mov_b64 v[92:93], 0
    v_mov_b64 v[94:95], 0
    v_mov_b64 v[96:97], 0
    v_mov_b64 v[98:99], 0
    v_mov_b64 v[100:101], 0
    v_mov_b64 v[102:103], 0
    v_mov_b64 v[104:105], 0
    v_mov_b64 v[106:107], 0
    v_mov_b64 v[108:109], 0
    v_mov_b64 v[110:111], 0
    v_mov_b64 v[112:113], 0
    v_mov_b64 v[114:115], 0
    v_mov_b64 v[116:117], 0
    v_mov_b64 v[118:119], 0
    v_mov_b64 v[120:121], 0
    v_mov_b64 v[122:123], 0
    v_mov_b64 v[124:125], 0
    v_mov_b64 v[126:127], 0
    v_mov_b64 v[128:129], 0
    v_mov_b64 v[130:131], 0
    v_mov_b64 v[132:133], 0
    v_mov_b64 v[134:135], 0
    v_mov_b64 v[136:137], 0
    v_mov_b64 v[138:139], 0
    v_mov_b64 v[140:141], 0
    v_mov_b64 v[142:143], 0
    v_mov_b64 v[144:145], 0
    v_mov_b64 v[146:147], 0
    v_mov_b64 v[148:149], 0
    v_mov_b64 v[150:151], 0
    v_mov_b64 v[152:153], 0
    v_mov_b64 v[154:155], 0
    s_mov_b64 s[6:7], -1
    s_mov_b32 s55, 0
    s_waitcnt vmcnt(0)
L_poll:
    s_mov_b64 exec, s[6:7]
    buffer_load_dwordx4 v[48:51], v70, s[32:35], 0 offen sc1
    s_mov_b64 exec, -1
    s_waitcnt vmcnt(0)
    v_cmp_ne_u32 s[6:7], s48, v51
    s_cmp_eq_u64 s[6:7], 0
    s_cbranch_scc1 L_got
    s_sleep 4
    s_add_u32 s55, s55, 1
    s_cmp_lt_u32 s55, 0x400000
    s_cbranch_scc1 L_poll
    s_endpgm
L_got:
    v_cmp_gt_u32 s[36:37], -2, v48
    v_cmp_gt_u32 s[38:39], -2, v49
    v_cmp_gt_u32 s[40:41], -2, v50
    v_mov_b32 v52, -1
    s_mov_b64 s[42:43], 0
    s_mov_b32 s53, 0x80808080
    s_and_b32 s6, s40, s53
    s_and_b32 s7, s41, s53
    s_cmp_eq_u64 s[6:7], 0
    s_cbranch_scc1 L_noext
    s_lshr_b64 s[6:7], s[6:7], 7
    s_mul_i32 s6, s6, 255
    s_mul_i32 s7, s7, 255
    v_mov_b32 v55, s48
L_poll2:
    s_mov_b64 exec, s[6:7]
    buffer_load_dwordx4 v[52:55], v71, s[32:35], 0 offen sc1
    s_mov_b64 exec, -1
    s_waitcnt vmcnt(0)
    v_cmp_ne_u32 vcc, s48, v55
    s_cbranch_vccz L_got2
    s_sleep 1
    s_add_u32 s55, s55, 1
    s_cmp_lt_u32 s55, 0x400000
    s_cbranch_scc1 L_poll2
    s_endpgm
L_got2:
    v_cmp_gt_u32 s[42:43], -2, v52
L_noext:
    v_cmp_eq_u32 vcc, -2, v52
    s_bcnt1_i32_b64 s64, s[36:37]
    s_bcnt1_i32_b64 s65, s[38:39]
    s_bcnt1_i32_b64 s66, s[40:41]
    s_bcnt1_i32_b64 s67, s[42:43]
    s_add_u32 s65, s65, s64
    s_add_u32 s66, s66, s65
    s_add_u32 s79, s67, s66
    v_mov_b32 v61, s79
    v_mov_b32 v60, 114912
    s_mov_b64 exec, 1
    ds_add_rtn_u32 v61, v60, v61
    s_mov_b64 exec, -1
    v_mbcnt_lo_u32_b32 v62, s36, 0
    v_mbcnt_hi_u32_b32 v62, s37, v62
    v_lshrrev_b32 v20, 20, v48
    v_add_u32 v20, v20, v73
    v_lshl_add_u32 v66, v62, 2, s49
    s_mov_b64 exec, s[36:37]
    ds_write_b32 v66, v20
    s_mov_b64 exec, -1
    v_lshlrev_b32 v24, 2, v48
    v_and_b32 v24, s82, v24
    v_and_b32 v16, 63, v48
    v_mbcnt_lo_u32_b32 v63, s38, 0
    v_mbcnt_hi_u32_b32 v63, s39, v63
    v_add_u32 v63, s64, v63
    v_lshrrev_b32 v21, 20, v49
    v_add_u32 v21, v21, v73
    v_lshl_add_u32 v66, v63, 2, s49
    s_mov_b64 exec, s[38:39]
    ds_write_b32 v66, v21
    s_mov_b64 exec, -1
    v_lshlrev_b32 v25, 2, v49
    v_and_b32 v25, s82, v25
    v_and_b32 v17, 63, v49
    v_mbcnt_lo_u32_b32 v64, s40, 0
    v_mbcnt_hi_u32_b32 v64, s41, v64
    v_add_u32 v64, s65, v64
    v_lshrrev_b32 v22, 20, v50
    v_add_u32 v22, v22, v73
    v_lshl_add_u32 v66, v64, 2, s49
    s_mov_b64 exec, s[40:41]
    ds_write_b32 v66, v22
    s_mov_b64 exec, -1
    v_lshlrev_b32 v26, 2, v50
    v_and_b32 v26, s82, v26
    v_and_b32 v18, 63, v50
    v_mbcnt_lo_u32_b32 v65, s42, 0
    v_mbcnt_hi_u32_b32 v65, s43, v65
    v_add_u32 v65, s66, v65
    v_lshrrev_b32 v23, 20, v52
    v_add_u32 v23, v23, v73
    v_lshl_add_u32 v66, v65, 2, s49
    s_mov_b64 exec, s[42:43]
    ds_write_b32 v66, v23
    s_mov_b64 exec, -1
    v_lshlrev_b32 v27, 2, v52
    v_and_b32 v27, s82, v27
    v_and_b32 v19, 63, v52
    v_lshl_or_b32 v14, v45, 16, v44
    v_lshl_or_b32 v15, v47, 16, v46
    v_mov_b64 v[156:157], 0
    v_mov_b64 v[158:159], 0
    s_cmp_ge_u32 s3, 2
    s_cbranch_scc1 L_4
    v_lshl_or_b32 v56, v33, 16, v32
    v_lshl_or_b32 v57, v35, 16, v34
    v_lshl_or_b32 v58, v37, 16, v36
    v_lshl_or_b32 v59, v39, 16, v38
    s_lshl_b32 s53, s54, 1
    s_add_u32 s53, s53, s44
    s_lshl2_add_u32 s83, s53, 4096
    s_lshl_b32 s53, s53, 10
    s_add_u32 s53, s53, 1048576
    v_lshl_add_u32 v60, v1, 4, s53
    buffer_store_dwordx4 v[56:59], v60, s[32:35], 0 offen sc1
L_4:
    s_mov_b32 s80, 79
    s_waitcnt lgkmcnt(0)
    v_readfirstlane_b32 s44, v61
    s_cbranch_vccnz L_defer
    s_add_u32 s53, s44, s79
    s_cmp_gt_u32 s53, 1024
    s_cbranch_scc1 L_defer
    v_add_u32 v62, s44, v62
    v_lshl_or_b32 v24, v62, 22, v24
    v_add_u32 v63, s44, v63
    v_lshl_or_b32 v25, v63, 22, v25
    v_add_u32 v64, s44, v64
    v_lshl_or_b32 v26, v64, 22, v26
    v_add_u32 v65, s44, v65
    v_lshl_or_b32 v27, v65, 22, v27
    s_branch L_have
L_defer:
    s_mov_b32 s80, 0
    s_mov_b32 s79, 0
    s_mov_b32 s44, 0
    s_mov_b64 s[36:37], 0
    s_mov_b64 s[38:39], 0
    s_mov_b64 s[40:41], 0
    s_mov_b64 s[42:43], 0
    v_mov_b32 v58, 1
    v_mov_b32 v59, 110864
    ds_write_b32 v59, v58
    s_branch L_have
L_scan:
    s_barrier
    s_mov_b32 s64, s63
    s_add_u32 s65, s63, 1024
    s_xor_b32 s47, s2, 1
L_sloop:
    s_cmp_ge_u32 s80, 79
    s_cbranch_scc1 L_scan_done
    s_mul_i32 s53, s3, 20000
    s_lshl_b32 s54, s80, 8
    s_add_u32 s55, s53, s54
    v_lshlrev_b32 v56, 2, v1
    v_add_u32 v56, s55, v56
    v_lshlrev_b32 v57, 2, v56
    buffer_load_dwordx4 v[60:63], v57, s[16:19], 0 offen
    s_waitcnt vmcnt(0)
    s_cmp_lg_u32 s80, 78
    s_cbranch_scc1 L_snotlast
    s_mov_b32 exec_lo, 0xffffff00
    v_mov_b32 v60, s47
    v_mov_b32 v61, s47
    v_mov_b32 v62, s47
    v_mov_b32 v63, s47
    s_mov_b64 exec, -1
L_snotlast:
    s_cmp_gt_u32 s52, 0
    s_cbranch_scc1 L_5
    v_cmp_eq_u32_sdwa vcc, v60, s2 src0_sel:BYTE_0 src1_sel:DWORD
    s_cbranch_vccz L_5
    s_bcnt1_i32_b64 s53, vcc
    s_lshl3_add_u32 s54, s53, s64
    s_mov_b32 s52, 0
    s_cmp_gt_u32 s54, s65
    s_cbranch_scc1 L_ovf
    v_mbcnt_lo_u32_b32 v58, vcc_lo, 0
    v_mbcnt_hi_u32_b32 v58, vcc_hi, v58
    v_lshl_add_u32 v58, v58, 3, s64
    v_add_u32 v59, 0, v56
    s_mov_b64 exec, vcc
    ds_write2_b32 v58, v60, v59 offset0:0 offset1:1
    s_mov_b64 exec, -1
    s_mov_b32 s64, s54
L_5:
    s_cmp_gt_u32 s52, 1
    s_cbranch_scc1 L_6
    v_cmp_eq_u32_sdwa vcc, v61, s2 src0_sel:BYTE_0 src1_sel:DWORD
    s_cbranch_vccz L_6
    s_bcnt1_i32_b64 s53, vcc
    s_lshl3_add_u32 s54, s53, s64
    s_mov_b32 s52, 1
    s_cmp_gt_u32 s54, s65
    s_cbranch_scc1 L_ovf
    v_mbcnt_lo_u32_b32 v58, vcc_lo, 0
    v_mbcnt_hi_u32_b32 v58, vcc_hi, v58
    v_lshl_add_u32 v58, v58, 3, s64
    v_add_u32 v59, 1, v56
    s_mov_b64 exec, vcc
    ds_write2_b32 v58, v61, v59 offset0:0 offset1:1
    s_mov_b64 exec, -1
    s_mov_b32 s64, s54
L_6:
    s_cmp_gt_u32 s52, 2
    s_cbranch_scc1 L_7
    v_cmp_eq_u32_sdwa vcc, v62, s2 src0_sel:BYTE_0 src1_sel:DWORD
    s_cbranch_vccz L_7
    s_bcnt1_i32_b64 s53, vcc
    s_lshl3_add_u32 s54, s53, s64
    s_mov_b32 s52, 2
    s_cmp_gt_u32 s54, s65
    s_cbranch_scc1 L_ovf
    v_mbcnt_lo_u32_b32 v58, vcc_lo, 0
    v_mbcnt_hi_u32_b32 v58, vcc_hi, v58
    v_lshl_add_u32 v58, v58, 3, s64
    v_add_u32 v59, 2, v56
    s_mov_b64 exec, vcc
    ds_write2_b32 v58, v62, v59 offset0:0 offset1:1
    s_mov_b64 exec, -1
    s_mov_b32 s64, s54
L_7:
    s_cmp_gt_u32 s52, 3
    s_cbranch_scc1 L_8
    v_cmp_eq_u32_sdwa vcc, v63, s2 src0_sel:BYTE_0 src1_sel:DWORD
    s_cbranch_vccz L_8
    s_bcnt1_i32_b64 s53, vcc
    s_lshl3_add_u32 s54, s53, s64
    s_mov_b32 s52, 3
    s_cmp_gt_u32 s54, s65
    s_cbranch_scc1 L_ovf
    v_mbcnt_lo_u32_b32 v58, vcc_lo, 0
    v_mbcnt_hi_u32_b32 v58, vcc_hi, v58
    v_lshl_add_u32 v58, v58, 3, s64
    v_add_u32 v59, 3, v56
    s_mov_b64 exec, vcc
    ds_write2_b32 v58, v63, v59 offset0:0 offset1:1
    s_mov_b64 exec, -1
    s_mov_b32 s64, s54
L_8:
    s_mov_b32 s52, 0
    s_add_u32 s80, s80, 1
    s_branch L_sloop
L_ovf:
    v_mov_b32 v58, 1
    v_mov_b32 v59, 110864
    ds_write_b32 v59, v58
L_scan_done:
    s_sub_u32 s79, s64, s63
    s_lshr_b32 s79, s79, 3
    s_lshl_b32 s44, s3, 7
    v_lshlrev_b32 v58, 3, v1
    v_add_u32 v58, s63, v58
    s_waitcnt lgkmcnt(0)
    ds_read_b32 v16, v58 offset:0
    ds_read_b32 v20, v58 offset:4
    s_sub_u32 s53, s79, 0
    v_cmp_gt_i32 s[36:37], s53, v1
    ds_read_b32 v17, v58 offset:512
    ds_read_b32 v21, v58 offset:516
    s_sub_u32 s53, s79, 64
    v_cmp_gt_i32 s[38:39], s53, v1
    s_mov_b64 s[40:41], 0
    v_mov_b32 v18, 0
    v_mov_b32 v26, 0
    s_mov_b64 s[42:43], 0
    v_mov_b32 v19, 0
    v_mov_b32 v27, 0
    v_lshl_add_u32 v58, v1, 2, s49
    v_add_u32 v59, s44, v1
    v_lshlrev_b32 v59, 22, v59
    s_waitcnt lgkmcnt(0)
    v_lshlrev_b32 v28, 2, v20
    buffer_load_dword v24, v28, s[12:15], 0 offen
    v_bfe_u32 v16, v16, 8, 6
    v_min_u32 v16, 47, v16
    ds_write_b32 v58, v20 offset:0
    v_lshlrev_b32 v29, 2, v21
    buffer_load_dword v25, v29, s[12:15], 0 offen
    v_bfe_u32 v17, v17, 8, 6
    v_min_u32 v17, 47, v17
    ds_write_b32 v58, v21 offset:256
    s_waitcnt vmcnt(0)
    v_min_u32 v24, 9999, v24
    v_lshl_or_b32 v24, v24, 8, v59
    v_add_u32 v59, 268435456, v59
    v_min_u32 v25, 9999, v25
    v_lshl_or_b32 v25, v25, 8, v59
    v_add_u32 v59, 268435456, v59
L_have:
    v_mov_b32 v58, 1
    s_mov_b32 s53, 111136
    s_mov_b32 s54, 114976
    v_bfe_u32 v28, v24, 8, 14
    v_mul_u32_u24 v28, 6711, v28
    v_lshrrev_b32 v28, 22, v28
    v_min_u32 v28, 15, v28
    v_lshl_add_u32 v28, v28, 2, s53
    v_lshl_add_u32 v28, v16, 6, v28
    v_lshl_add_u32 v16, v16, 2, s54
    s_mov_b64 exec, s[36:37]
    ds_add_rtn_u32 v32, v28, v58
    ds_add_u32 v16, v58
    s_mov_b64 exec, -1
    v_bfe_u32 v29, v25, 8, 14
    v_mul_u32_u24 v29, 6711, v29
    v_lshrrev_b32 v29, 22, v29
    v_min_u32 v29, 15, v29
    v_lshl_add_u32 v29, v29, 2, s53
    v_lshl_add_u32 v29, v17, 6, v29
    v_lshl_add_u32 v17, v17, 2, s54
    s_mov_b64 exec, s[38:39]
    ds_add_rtn_u32 v33, v29, v58
    ds_add_u32 v17, v58
    s_mov_b64 exec, -1
    v_bfe_u32 v30, v26, 8, 14
    v_mul_u32_u24 v30, 6711, v30
    v_lshrrev_b32 v30, 22, v30
    v_min_u32 v30, 15, v30
    v_lshl_add_u32 v30, v30, 2, s53
    v_lshl_add_u32 v30, v18, 6, v30
    v_lshl_add_u32 v18, v18, 2, s54
    s_mov_b64 exec, s[40:41]
    ds_add_rtn_u32 v34, v30, v58
    ds_add_u32 v18, v58
    s_mov_b64 exec, -1
    v_bfe_u32 v31, v27, 8, 14
    v_mul_u32_u24 v31, 6711, v31
    v_lshrrev_b32 v31, 22, v31
    v_min_u32 v31, 15, v31
    v_lshl_add_u32 v31, v31, 2, s53
    v_lshl_add_u32 v31, v19, 6, v31
    v_lshl_add_u32 v19, v19, 2, s54
    s_mov_b64 exec, s[42:43]
    ds_add_rtn_u32 v35, v31, v58
    ds_add_u32 v19, v58
    s_mov_b64 exec, -1
    v_lshrrev_b32 v36, 1, v1
    v_lshl_add_u32 v39, v36, 2, s49
    ds_read_b32 v40, v39 offset:0
    ds_read_b32 v41, v39 offset:128
    ds_read_b32 v42, v39 offset:256
    ds_read_b32 v43, v39 offset:384
    v_and_b32 v38, 1, v1
    v_lshlrev_b32 v37, 4, v38
    v_lshlrev_b32 v38, 2, v38
    s_mov_b32 s46, s79
    s_mov_b32 s45, s44
    v_lshl_add_u32 v56, v1, 2, s54
    v_mov_b32 v57, 110864
    s_waitcnt lgkmcnt(0)
    s_cmp_le_i32 s46, 0
    s_cbranch_scc1 L_9
    v_lshl_add_u32 v44, v40, 5, v37
    v_lshl_add_u32 v45, v40, 3, v38
    v_cmp_gt_i32 vcc, s46, v36
    s_lshl_b32 s76, s45, 5
    s_add_u32 m0, s76, 65536
    s_mov_b64 exec, vcc
    buffer_load_dwordx4 v44, s[24:27], 0 offen lds
    s_lshl3_add_u32 m0, s45, 98304
    s_add_u32 s45, s45, 32
    buffer_load_dword v45, s[20:23], 0 offen lds
    s_mov_b64 exec, -1
    s_sub_i32 s46, s46, 32
L_9:
    s_barrier
    ds_read_b32 v56, v56
    ds_read_b32 v57, v57
    s_cmp_le_i32 s46, 0
    s_cbranch_scc1 L_10
    v_lshl_add_u32 v44, v41, 5, v37
    v_lshl_add_u32 v45, v41, 3, v38
    v_cmp_gt_i32 vcc, s46, v36
    s_lshl_b32 s76, s45, 5
    s_add_u32 m0, s76, 65536
    s_mov_b64 exec, vcc
    buffer_load_dwordx4 v44, s[24:27], 0 offen lds
    s_lshl3_add_u32 m0, s45, 98304
    s_add_u32 s45, s45, 32
    buffer_load_dword v45, s[20:23], 0 offen lds
    s_mov_b64 exec, -1
    s_sub_i32 s46, s46, 32
L_10:
    s_waitcnt lgkmcnt(0)
    v_readfirstlane_b32 s78, v57
    s_cmp_lg_u32 s77, 0
    s_cbranch_scc1 L_assigned
    ds_read_b64_tr_b16 a[0:1], v77 offset:32768
    ds_read_b64_tr_b16 a[2:3], v77 offset:33024
    ds_read_b64_tr_b16 a[4:5], v77 offset:33792
    ds_read_b64_tr_b16 a[6:7], v77 offset:34048
    ds_read_b64_tr_b16 a[8:9], v77 offset:34816
    ds_read_b64_tr_b16 a[10:11], v77 offset:35072
    ds_read_b64_tr_b16 a[12:13], v77 offset:35840
    ds_read_b64_tr_b16 a[14:15], v77 offset:36096
    ds_read_b64_tr_b16 a[16:17], v77 offset:36864
    ds_read_b64_tr_b16 a[18:19], v77 offset:37120
    ds_read_b64_tr_b16 a[20:21], v77 offset:37888
    ds_read_b64_tr_b16 a[22:23], v77 offset:38144
    ds_read_b64_tr_b16 a[24:25], v77 offset:38912
    ds_read_b64_tr_b16 a[26:27], v77 offset:39168
    ds_read_b64_tr_b16 a[28:29], v77 offset:39936
    ds_read_b64_tr_b16 a[30:31], v77 offset:40192
    s_and_b32 s53, s2, 63
    s_or_b32 s53, s53, s3
    s_cbranch_scc1 L_11
    s_lshl_b32 s53, s2, 1
    v_mov_b32 v60, s53
    v_mov_b32 v61, s48
    s_mov_b64 exec, 1
    buffer_store_dword v61, v60, s[32:35], 0 offen sc1
    s_mov_b64 exec, -1
L_11:
    v_sub_u32 v57, 63, v1
    v_lshl_add_u32 v57, v56, 6, v57
    v_mov_b32 v59, 0
    v_readlane_b32 s84, v57, 0
    v_readlane_b32 s85, v57, 1
    v_readlane_b32 s86, v57, 2
    v_readlane_b32 s87, v57, 3
    v_readlane_b32 s88, v57, 4
    v_readlane_b32 s89, v57, 5
    v_readlane_b32 s90, v57, 6
    v_readlane_b32 s91, v57, 7
    v_readlane_b32 s92, v57, 8
    v_readlane_b32 s93, v57, 9
    v_readlane_b32 s94, v57, 10
    v_readlane_b32 s95, v57, 11
    v_readlane_b32 s96, v57, 12
    v_readlane_b32 s97, v57, 13
    v_readlane_b32 s98, v57, 14
    v_readlane_b32 s99, v57, 15
    v_cmp_gt_u32 vcc, s84, v57
    v_cmp_gt_u32 s[4:5], s85, v57
    v_cmp_gt_u32 s[6:7], s86, v57
    v_addc_co_u32 v59, vcc, 0, v59, vcc
    v_addc_co_u32 v59, s[4:5], 0, v59, s[4:5]
    v_addc_co_u32 v59, s[6:7], 0, v59, s[6:7]
    v_cmp_gt_u32 vcc, s87, v57
    v_cmp_gt_u32 s[4:5], s88, v57
    v_cmp_gt_u32 s[6:7], s89, v57
    v_addc_co_u32 v59, vcc, 0, v59, vcc
    v_addc_co_u32 v59, s[4:5], 0, v59, s[4:5]
    v_addc_co_u32 v59, s[6:7], 0, v59, s[6:7]
    v_cmp_gt_u32 vcc, s90, v57
    v_cmp_gt_u32 s[4:5], s91, v57
    v_cmp_gt_u32 s[6:7], s92, v57
    v_addc_co_u32 v59, vcc, 0, v59, vcc
    v_addc_co_u32 v59, s[4:5], 0, v59, s[4:5]
    v_addc_co_u32 v59, s[6:7], 0, v59, s[6:7]
    v_cmp_gt_u32 vcc, s93, v57
    v_cmp_gt_u32 s[4:5], s94, v57
    v_cmp_gt_u32 s[6:7], s95, v57
    v_addc_co_u32 v59, vcc, 0, v59, vcc
    v_addc_co_u32 v59, s[4:5], 0, v59, s[4:5]
    v_addc_co_u32 v59, s[6:7], 0, v59, s[6:7]
    v_cmp_gt_u32 vcc, s96, v57
    v_cmp_gt_u32 s[4:5], s97, v57
    v_cmp_gt_u32 s[6:7], s98, v57
    v_addc_co_u32 v59, vcc, 0, v59, vcc
    v_addc_co_u32 v59, s[4:5], 0, v59, s[4:5]
    v_addc_co_u32 v59, s[6:7], 0, v59, s[6:7]
    v_cmp_gt_u32 vcc, s99, v57
    s_nop 1
    v_addc_co_u32 v59, vcc, 0, v59, vcc
    v_readlane_b32 s84, v57, 16
    v_readlane_b32 s85, v57, 17
    v_readlane_b32 s86, v57, 18
    v_readlane_b32 s87, v57, 19
    v_readlane_b32 s88, v57, 20
    v_readlane_b32 s89, v57, 21
    v_readlane_b32 s90, v57, 22
    v_readlane_b32 s91, v57, 23
    v_readlane_b32 s92, v57, 24
    v_readlane_b32 s93, v57, 25
    v_readlane_b32 s94, v57, 26
    v_readlane_b32 s95, v57, 27
    v_readlane_b32 s96, v57, 28
    v_readlane_b32 s97, v57, 29
    v_readlane_b32 s98, v57, 30
    v_readlane_b32 s99, v57, 31
    v_cmp_gt_u32 vcc, s84, v57
    v_cmp_gt_u32 s[4:5], s85, v57
    v_cmp_gt_u32 s[6:7], s86, v57
    v_addc_co_u32 v59, vcc, 0, v59, vcc
    v_addc_co_u32 v59, s[4:5], 0, v59, s[4:5]
    v_addc_co_u32 v59, s[6:7], 0, v59, s[6:7]
    v_cmp_gt_u32 vcc, s87, v57
    v_cmp_gt_u32 s[4:5], s88, v57
    v_cmp_gt_u32 s[6:7], s89, v57
    v_addc_co_u32 v59, vcc, 0, v59, vcc
    v_addc_co_u32 v59, s[4:5], 0, v59, s[4:5]
    v_addc_co_u32 v59, s[6:7], 0, v59, s[6:7]
    v_cmp_gt_u32 vcc, s90, v57
    v_cmp_gt_u32 s[4:5], s91, v57
    v_cmp_gt_u32 s[6:7], s92, v57
    v_addc_co_u32 v59, vcc, 0, v59, vcc
    v_addc_co_u32 v59, s[4:5], 0, v59, s[4:5]
    v_addc_co_u32 v59, s[6:7], 0, v59, s[6:7]
    v_cmp_gt_u32 vcc, s93, v57
    v_cmp_gt_u32 s[4:5], s94, v57
    v_cmp_gt_u32 s[6:7], s95, v57
    v_addc_co_u32 v59, vcc, 0, v59, vcc
    v_addc_co_u32 v59, s[4:5], 0, v59, s[4:5]
    v_addc_co_u32 v59, s[6:7], 0, v59, s[6:7]
    v_cmp_gt_u32 vcc, s96, v57
    v_cmp_gt_u32 s[4:5], s97, v57
    v_cmp_gt_u32 s[6:7], s98, v57
    v_addc_co_u32 v59, vcc, 0, v59, vcc
    v_addc_co_u32 v59, s[4:5], 0, v59, s[4:5]
    v_addc_co_u32 v59, s[6:7], 0, v59, s[6:7]
    v_cmp_gt_u32 vcc, s99, v57
    s_nop 1
    v_addc_co_u32 v59, vcc, 0, v59, vcc
    v_readlane_b32 s84, v57, 32
    v_readlane_b32 s85, v57, 33
    v_readlane_b32 s86, v57, 34
    v_readlane_b32 s87, v57, 35
    v_readlane_b32 s88, v57, 36
    v_readlane_b32 s89, v57, 37
    v_readlane_b32 s90, v57, 38
    v_readlane_b32 s91, v57, 39
    v_cmp_gt_u32 vcc, s84, v57
    v_cmp_gt_u32 s[4:5], s85, v57
    v_cmp_gt_u32 s[6:7], s86, v57
    v_addc_co_u32 v59, vcc, 0, v59, vcc
    v_addc_co_u32 v59, s[4:5], 0, v59, s[4:5]
    v_addc_co_u32 v59, s[6:7], 0, v59, s[6:7]
    v_cmp_gt_u32 vcc, s87, v57
    v_cmp_gt_u32 s[4:5], s88, v57
    v_cmp_gt_u32 s[6:7], s89, v57
    v_addc_co_u32 v59, vcc, 0, v59, vcc
    v_addc_co_u32 v59, s[4:5], 0, v59, s[4:5]
    v_addc_co_u32 v59, s[6:7], 0, v59, s[6:7]
    v_cmp_gt_u32 vcc, s90, v57
    v_cmp_gt_u32 s[4:5], s91, v57
    s_nop 0
    v_addc_co_u32 v59, vcc, 0, v59, vcc
    v_addc_co_u32 v59, s[4:5], 0, v59, s[4:5]
    v_lshrrev_b64 v[60:61], v59, s[74:75]
    v_and_b32 v11, 1, v60
    s_bfe_u32 s54, s100, 393216
    v_cmp_eq_u32 vcc, s54, v59
    s_ff1_i32_b64 s56, vcc
    s_bfe_u32 s54, s100, 393222
    v_cmp_eq_u32 vcc, s54, v59
    s_ff1_i32_b64 s57, vcc
    s_bfe_u32 s54, s100, 393228
    v_cmp_eq_u32 vcc, s54, v59
    s_ff1_i32_b64 s58, vcc
    s_bfe_u32 s54, s100, 393234
    v_cmp_eq_u32 vcc, s54, v59
    s_ff1_i32_b64 s59, vcc
    s_bfe_u32 s54, s100, 393240
    v_cmp_eq_u32 vcc, s54, v59
    s_ff1_i32_b64 s60, vcc
L_assigned:
    v_mul_u32_u24 v60, v56, v11
    v_and_b32 v61, 15, v1
    v_lshlrev_b32 v61, 2, v61
    v_add_u32 v61, 111136, v61
    s_lshl_b32 s84, s56, 6
    v_add_u32 v64, s84, v61
    ds_read_b32 v70, v64
    s_lshl_b32 s85, s57, 6
    v_add_u32 v65, s85, v61
    ds_read_b32 v71, v65
    s_lshl_b32 s86, s58, 6
    v_add_u32 v66, s86, v61
    ds_read_b32 v72, v66
    s_lshl_b32 s87, s59, 6
    v_add_u32 v67, s87, v61
    ds_read_b32 v73, v67
    s_lshl_b32 s88, s60, 6
    v_add_u32 v68, s88, v61
    ds_read_b32 v74, v68
    v_add_u32_dpp v60, v60, v60 row_shr:1 row_mask:0xf bank_mask:0xf bound_ctrl:1
    v_readlane_b32 s92, v56, s56
    s_nop 0
    v_add_u32_dpp v60, v60, v60 row_shr:2 row_mask:0xf bank_mask:0xf bound_ctrl:1
    v_readlane_b32 s93, v56, s57
    s_nop 0
    v_add_u32_dpp v60, v60, v60 row_shr:4 row_mask:0xf bank_mask:0xf bound_ctrl:1
    v_readlane_b32 s94, v56, s58
    s_nop 0
    v_add_u32_dpp v60, v60, v60 row_shr:8 row_mask:0xf bank_mask:0xf bound_ctrl:1
    v_readlane_b32 s95, v56, s59
    s_nop 0
    v_readlane_b32 s96, v56, s60
    v_readlane_b32 s61, v60, 15
    v_readlane_b32 s53, v60, 31
    v_readlane_b32 s54, v60, 47
    s_add_u32 s62, s92, s93
    s_add_u32 s62, s62, s94
    s_add_u32 s62, s62, s95
    s_add_u32 s62, s62, s96
    s_add_u32 s61, s61, s53
    s_add_u32 s61, s61, s54
    s_add_u32 s61, s61, 3
    s_andn2_b32 s61, s61, 3
    s_lshl2_add_u32 s61, s3, s61
    s_waitcnt lgkmcnt(0)
    v_add3_u32 v60, v70, v71, v72
    v_add3_u32 v60, v60, v73, v74
    v_mov_b32 v61, v60
    s_nop 1
    v_add_u32_dpp v61, v61, v61 row_shr:1 row_mask:0xf bank_mask:0xf bound_ctrl:1
    s_nop 1
    v_add_u32_dpp v61, v61, v61 row_shr:2 row_mask:0xf bank_mask:0xf bound_ctrl:1
    s_nop 1
    v_add_u32_dpp v61, v61, v61 row_shr:4 row_mask:0xf bank_mask:0xf bound_ctrl:1
    s_nop 1
    v_add_u32_dpp v61, v61, v61 row_shr:8 row_mask:0xf bank_mask:0xf bound_ctrl:1
    v_sub_u32 v61, v61, v60
    v_add_u32 v61, s61, v61
    v_lshl_add_u32 v75, v61, 8, 0
    ds_write_b32 v64, v75 offset:4096
    v_add_u32 v61, v61, v70
    v_lshl_add_u32 v76, v61, 8, 16
    ds_write_b32 v65, v76 offset:4096
    v_add_u32 v61, v61, v71
    v_lshl_add_u32 v77, v61, 8, 32
    ds_write_b32 v66, v77 offset:4096
    v_add_u32 v61, v61, v72
    v_lshl_add_u32 v78, v61, 8, 48
    ds_write_b32 v67, v78 offset:4096
    v_add_u32 v61, v61, v73
    v_lshl_add_u32 v79, v61, 8, 64
    ds_write_b32 v68, v79 offset:4096
    s_cmp_le_i32 s46, 0
    s_cbranch_scc1 L_12
    v_lshl_add_u32 v44, v42, 5, v37
    v_lshl_add_u32 v45, v42, 3, v38
    v_cmp_gt_i32 vcc, s46, v36
    s_lshl_b32 s76, s45, 5
    s_add_u32 m0, s76, 65536
    s_mov_b64 exec, vcc
    buffer_load_dwordx4 v44, s[24:27], 0 offen lds
    s_lshl3_add_u32 m0, s45, 98304
    s_add_u32 s45, s45, 32
    buffer_load_dword v45, s[20:23], 0 offen lds
    s_mov_b64 exec, -1
    s_sub_i32 s46, s46, 32
L_12:
    s_waitcnt lgkmcnt(0)
    s_barrier
    ds_read_b32 v16, v28 offset:4096
    ds_read_b32 v17, v29 offset:4096
    ds_read_b32 v18, v30 offset:4096
    ds_read_b32 v19, v31 offset:4096
    v_mov_b32 v60, 0
    v_mov_b32 v61, 0
    v_lshlrev_b32 v64, 3, v0
    v_add_u32 v64, 111136, v64
    ds_write_b64 v64, v[60:61]
    v_mov_b32 v64, 110864
    ds_write_b32 v64, v60
    s_mov_b32 s53, 106496
    s_movk_i32 s54, 255
    s_waitcnt lgkmcnt(2)
    v_lshrrev_b32 v28, 8, v16
    v_add_u32 v28, v28, v32
    v_and_or_b32 v16, v16, s54, v24
    v_lshl_add_u32 v28, v28, 2, s53
    s_mov_b64 exec, s[36:37]
    ds_write_b32 v28, v16
    s_mov_b64 exec, -1
    v_lshrrev_b32 v29, 8, v17
    v_add_u32 v29, v29, v33
    v_and_or_b32 v17, v17, s54, v25
    v_lshl_add_u32 v29, v29, 2, s53
    s_mov_b64 exec, s[38:39]
    ds_write_b32 v29, v17
    s_mov_b64 exec, -1
    v_lshrrev_b32 v30, 8, v18
    v_add_u32 v30, v30, v34
    v_and_or_b32 v18, v18, s54, v26
    v_lshl_add_u32 v30, v30, 2, s53
    s_mov_b64 exec, s[40:41]
    ds_write_b32 v30, v18
    s_mov_b64 exec, -1
    v_lshrrev_b32 v31, 8, v19
    v_add_u32 v31, v31, v35
    v_and_or_b32 v19, v19, s54, v27
    v_lshl_add_u32 v31, v31, 2, s53
    s_mov_b64 exec, s[42:43]
    ds_write_b32 v31, v19
    s_mov_b64 exec, -1
    s_cmp_le_i32 s46, 0
    s_cbranch_scc1 L_13
    v_lshl_add_u32 v44, v43, 5, v37
    v_lshl_add_u32 v45, v43, 3, v38
    v_cmp_gt_i32 vcc, s46, v36
    s_lshl_b32 s76, s45, 5
    s_add_u32 m0, s76, 65536
    s_mov_b64 exec, vcc
    buffer_load_dwordx4 v44, s[24:27], 0 offen lds
    s_lshl3_add_u32 m0, s45, 98304
    s_add_u32 s45, s45, 32
    buffer_load_dword v45, s[20:23], 0 offen lds
    s_mov_b64 exec, -1
    s_sub_i32 s46, s46, 32
L_13:
L_paymore:
    s_cmp_le_i32 s46, 0
    s_cbranch_scc1 L_paydone
    ds_read_b32 v40, v39 offset:512
    v_add_u32 v39, 128, v39
    s_waitcnt lgkmcnt(0)
    s_cmp_le_i32 s46, 0
    s_cbranch_scc1 L_14
    v_lshl_add_u32 v44, v40, 5, v37
    v_lshl_add_u32 v45, v40, 3, v38
    v_cmp_gt_i32 vcc, s46, v36
    s_lshl_b32 s76, s45, 5
    s_add_u32 m0, s76, 65536
    s_mov_b64 exec, vcc
    buffer_load_dwordx4 v44, s[24:27], 0 offen lds
    s_lshl3_add_u32 m0, s45, 98304
    s_add_u32 s45, s45, 32
    buffer_load_dword v45, s[20:23], 0 offen lds
    s_mov_b64 exec, -1
    s_sub_i32 s46, s46, 32
L_14:
    s_branch L_paymore
L_paydone:
    s_lshl_b32 s61, s61, 2
    s_add_u32 s61, s61, 106496
    s_and_b32 s54, s2, 192
    s_lshl_b32 s54, s54, 1
    s_lshl4_add_u32 s54, s3, s54
    s_lshl2_add_u32 s53, s54, 4096
    v_and_b32 v66, 15, v1
    v_lshl_add_u32 v66, v66, 2, s53
    s_lshl_b32 s53, s54, 10
    s_add_u32 s53, s53, 1048576
    v_lshl_add_u32 v67, v1, 4, s53
    s_xor_b32 s53, s48, 1
    v_mov_b32 v79, s53
    v_mov_b32 v13, s61
    v_and_b32 v62, 3, v1
    v_lshl_add_u32 v77, v62, 2, s61
    v_bfe_u32 v62, v1, 2, 2
    v_lshl_add_u32 v78, v62, 2, s61
    v_bfe_u32 v63, v1, 4, 1
    v_lshlrev_b32 v63, 4, v63
    v_add_u32 v63, 65536, v63
    v_mov_b32 v65, 98304
    v_mov_b32 v62, 110848
    v_cmp_ne_u32 vcc, 0, v7
    v_cmp_ne_u32 s[4:5], 0, v8
    v_cmp_ne_u32 s[6:7], 0, v10
    v_cndmask_b32 v74, v62, v63, vcc
    v_cndmask_b32 v75, v62, v63, s[4:5]
    v_cndmask_b32 v76, v62, v65, s[6:7]
    s_waitcnt lgkmcnt(0)
    s_barrier
    ds_read_b128 v[68:71], v13
    ds_read_b32 v72, v77
    ds_read_b32 v73, v78
    s_cmp_lt_u32 s62, 3
    s_cbranch_scc1 L_short
    s_waitcnt lgkmcnt(2)
    v_readfirstlane_b32 s64, v68
    v_readfirstlane_b32 s65, v69
    v_readfirstlane_b32 s66, v70
    v_readfirstlane_b32 s67, v71
    s_and_b32 s76, s64, s82
    s_add_u32 m0, s63, 0
    s_lshl_b32 s76, s76, 3
    buffer_load_dwordx4 v2, s[8:11], s76 offen lds
    buffer_load_dwordx4 v3, s[8:11], s76 offen offset:1024 lds
    s_and_b32 s76, s65, s82
    s_add_u32 m0, s63, 2048
    s_lshl_b32 s76, s76, 3
    buffer_load_dwordx4 v2, s[8:11], s76 offen lds
    buffer_load_dwordx4 v3, s[8:11], s76 offen offset:1024 lds
    s_and_b32 s76, s66, s82
    s_add_u32 m0, s63, 4096
    s_lshl_b32 s76, s76, 3
    buffer_load_dwordx4 v2, s[8:11], s76 offen lds
    buffer_load_dwordx4 v3, s[8:11], s76 offen offset:1024 lds
    s_waitcnt vmcnt(6)
    s_branch L_go
L_short:
    s_waitcnt vmcnt(0) lgkmcnt(0)
    v_readfirstlane_b32 s64, v68
    v_readfirstlane_b32 s65, v69
    v_readfirstlane_b32 s66, v70
    v_readfirstlane_b32 s67, v71
    s_cmp_le_u32 s62, 0
    s_cbranch_scc1 L_go
    s_and_b32 s76, s64, s82
    s_add_u32 m0, s63, 0
    s_lshl_b32 s76, s76, 3
    buffer_load_dwordx4 v2, s[8:11], s76 offen lds
    buffer_load_dwordx4 v3, s[8:11], s76 offen offset:1024 lds
    s_cmp_le_u32 s62, 1
    s_cbranch_scc1 L_go
    s_and_b32 s76, s65, s82
    s_add_u32 m0, s63, 2048
    s_lshl_b32 s76, s76, 3
    buffer_load_dwordx4 v2, s[8:11], s76 offen lds
    buffer_load_dwordx4 v3, s[8:11], s76 offen offset:1024 lds
L_go:
    s_cmp_ge_u32 s3, 2
    s_cbranch_scc1 L_15
    s_cmp_lg_u32 s77, 0
    s_cbranch_scc1 L_15
    v_mov_b32 v62, s83
    v_mov_b32 v63, s48
    s_mov_b64 exec, 1
    buffer_store_dword v63, v62, s[32:35], 0 offen sc1
    s_mov_b64 exec, -1
L_15:
    s_waitcnt lgkmcnt(0)
    v_lshrrev_b32 v72, 22, v72
    v_lshrrev_b32 v73, 22, v73
    v_mad_u32_u24 v5, v72, v7, v74
    v_mad_u32_u24 v6, v72, v8, v75
    v_mad_u32_u24 v9, v73, v10, v76
    s_barrier
    s_cmp_eq_u32 s62, 0
    s_cbranch_scc1 L_round_done
L_group:
    s_cmp_le_u32 s62, s81
    s_cbranch_scc1 L_wstep
L_wback:
    ds_read_b64 v[64:65], v9
    ds_read_b128 v[56:59], v5
    ds_read_b128 v[60:63], v6
    ds_read_b128 v[68:71], v13 offset:16
    ds_read_b32 v72, v77 offset:16
    ds_read_b32 v73, v78 offset:16
    v_add_u32 v13, 16, v13
    v_add_u32 v77, 16, v77
    v_add_u32 v78, 16, v78
    s_waitcnt lgkmcnt(0)
    v_mfma_f32_16x16x16_bf16 v[32:35], v[14:15], v[64:65], 0
    v_mfma_f32_16x16x32_bf16 v[16:19], v[56:59], a[0:3], 0
    v_mfma_f32_16x16x32_bf16 v[20:23], v[56:59], a[8:11], 0
    v_mfma_f32_16x16x32_bf16 v[24:27], v[56:59], a[16:19], 0
    v_mfma_f32_16x16x32_bf16 v[28:31], v[56:59], a[24:27], 0
    v_mfma_f32_16x16x32_bf16 v[16:19], v[60:63], a[4:7], v[16:19]
    v_mfma_f32_16x16x32_bf16 v[20:23], v[60:63], a[12:15], v[20:23]
    v_mfma_f32_16x16x32_bf16 v[24:27], v[60:63], a[20:23], v[24:27]
    v_mfma_f32_16x16x32_bf16 v[28:31], v[60:63], a[28:31], v[28:31]
    v_readfirstlane_b32 s68, v68
    v_readfirstlane_b32 s69, v69
    v_readfirstlane_b32 s70, v70
    v_readfirstlane_b32 s71, v71
    v_cvt_pk_bf16_f32 v64, v32, v33
    v_cvt_pk_bf16_f32 v65, v34, v35
    v_lshrrev_b32 v72, 22, v72
    v_lshrrev_b32 v73, 22, v73
    v_mad_u32_u24 v5, v72, v7, v74
    v_mad_u32_u24 v6, v72, v8, v75
    v_mad_u32_u24 v9, v73, v10, v76
    s_cmp_ge_u32 s62, 3
    s_cbranch_scc1 L_16
    s_waitcnt vmcnt(0)
L_16:
    s_waitcnt vmcnt(4)
    ds_read_b64_tr_b16 v[48:49], v4 offset:0
    ds_read_b64_tr_b16 v[50:51], v4 offset:256
    ds_read_b64_tr_b16 v[52:53], v4 offset:512
    ds_read_b64_tr_b16 v[54:55], v4 offset:768
    s_cmp_le_u32 s62, 3
    s_cbranch_scc1 L_17
    s_and_b32 s76, s67, s82
    s_add_u32 m0, s63, 6144
    s_lshl_b32 s76, s76, 3
    buffer_load_dwordx4 v2, s[8:11], s76 offen lds
    buffer_load_dwordx4 v3, s[8:11], s76 offen offset:1024 lds
L_17:
    s_waitcnt lgkmcnt(0)
    v_mfma_f32_4x4x4_16b_bf16 v[32:35], v[64:65], v[48:49], 0 cbsz:4 abid:0
    v_mfma_f32_4x4x4_16b_bf16 v[36:39], v[64:65], v[50:51], 0 cbsz:4 abid:0
    v_mfma_f32_4x4x4_16b_bf16 v[40:43], v[64:65], v[52:53], 0 cbsz:4 abid:0
    v_mfma_f32_4x4x4_16b_bf16 v[44:47], v[64:65], v[54:55], 0 cbsz:4 abid:0
    s_nop 0
    s_set_gpr_idx_on s64, gpr_idx(SRC2,DST)
    v_pk_fma_f32 v[80:81], v[32:33], v[16:17], v[80:81] op_sel:[0,0,0] op_sel_hi:[1,0,1]
    v_pk_fma_f32 v[82:83], v[34:35], v[16:17], v[82:83] op_sel:[0,0,0] op_sel_hi:[1,0,1]
    v_pk_fma_f32 v[84:85], v[36:37], v[20:21], v[84:85] op_sel:[0,0,0] op_sel_hi:[1,0,1]
    v_pk_fma_f32 v[86:87], v[38:39], v[20:21], v[86:87] op_sel:[0,0,0] op_sel_hi:[1,0,1]
    v_pk_fma_f32 v[88:89], v[40:41], v[24:25], v[88:89] op_sel:[0,0,0] op_sel_hi:[1,0,1]
    v_pk_fma_f32 v[90:91], v[42:43], v[24:25], v[90:91] op_sel:[0,0,0] op_sel_hi:[1,0,1]
    v_pk_fma_f32 v[92:93], v[44:45], v[28:29], v[92:93] op_sel:[0,0,0] op_sel_hi:[1,0,1]
    v_pk_fma_f32 v[94:95], v[46:47], v[28:29], v[94:95] op_sel:[0,0,0] op_sel_hi:[1,0,1]
    s_set_gpr_idx_off
    s_mov_b32 s64, s68
    s_sub_u32 s62, s62, 1
    s_cmp_eq_u32 s62, 0
    s_cbranch_scc1 L_round_done
    s_cmp_ge_u32 s62, 3
    s_cbranch_scc1 L_18
    s_waitcnt vmcnt(0)
L_18:
    s_waitcnt vmcnt(4)
    ds_read_b64_tr_b16 v[48:49], v4 offset:2048
    ds_read_b64_tr_b16 v[50:51], v4 offset:2304
    ds_read_b64_tr_b16 v[52:53], v4 offset:2560
    ds_read_b64_tr_b16 v[54:55], v4 offset:2816
    s_cmp_le_u32 s62, 3
    s_cbranch_scc1 L_19
    s_and_b32 s76, s68, s82
    s_add_u32 m0, s63, 0
    s_lshl_b32 s76, s76, 3
    buffer_load_dwordx4 v2, s[8:11], s76 offen lds
    buffer_load_dwordx4 v3, s[8:11], s76 offen offset:1024 lds
L_19:
    s_waitcnt lgkmcnt(0)
    v_mfma_f32_4x4x4_16b_bf16 v[32:35], v[64:65], v[48:49], 0 cbsz:4 abid:1
    v_mfma_f32_4x4x4_16b_bf16 v[36:39], v[64:65], v[50:51], 0 cbsz:4 abid:1
    v_mfma_f32_4x4x4_16b_bf16 v[40:43], v[64:65], v[52:53], 0 cbsz:4 abid:1
    v_mfma_f32_4x4x4_16b_bf16 v[44:47], v[64:65], v[54:55], 0 cbsz:4 abid:1
    s_nop 0
    s_set_gpr_idx_on s65, gpr_idx(SRC2,DST)
    v_pk_fma_f32 v[80:81], v[32:33], v[16:17], v[80:81] op_sel:[0,1,0] op_sel_hi:[1,1,1]
    v_pk_fma_f32 v[82:83], v[34:35], v[16:17], v[82:83] op_sel:[0,1,0] op_sel_hi:[1,1,1]
    v_pk_fma_f32 v[84:85], v[36:37], v[20:21], v[84:85] op_sel:[0,1,0] op_sel_hi:[1,1,1]
    v_pk_fma_f32 v[86:87], v[38:39], v[20:21], v[86:87] op_sel:[0,1,0] op_sel_hi:[1,1,1]
    v_pk_fma_f32 v[88:89], v[40:41], v[24:25], v[88:89] op_sel:[0,1,0] op_sel_hi:[1,1,1]
    v_pk_fma_f32 v[90:91], v[42:43], v[24:25], v[90:91] op_sel:[0,1,0] op_sel_hi:[1,1,1]
    v_pk_fma_f32 v[92:93], v[44:45], v[28:29], v[92:93] op_sel:[0,1,0] op_sel_hi:[1,1,1]
    v_pk_fma_f32 v[94:95], v[46:47], v[28:29], v[94:95] op_sel:[0,1,0] op_sel_hi:[1,1,1]
    s_set_gpr_idx_off
    s_mov_b32 s65, s69
    s_sub_u32 s62, s62, 1
    s_cmp_eq_u32 s62, 0
    s_cbranch_scc1 L_round_done
    s_cmp_ge_u32 s62, 3
    s_cbranch_scc1 L_20
    s_waitcnt vmcnt(0)
L_20:
    s_waitcnt vmcnt(4)
    ds_read_b64_tr_b16 v[48:49], v4 offset:4096
    ds_read_b64_tr_b16 v[50:51], v4 offset:4352
    ds_read_b64_tr_b16 v[52:53], v4 offset:4608
    ds_read_b64_tr_b16 v[54:55], v4 offset:4864
    s_cmp_le_u32 s62, 3
    s_cbranch_scc1 L_21
    s_and_b32 s76, s69, s82
    s_add_u32 m0, s63, 2048
    s_lshl_b32 s76, s76, 3
    buffer_load_dwordx4 v2, s[8:11], s76 offen lds
    buffer_load_dwordx4 v3, s[8:11], s76 offen offset:1024 lds
L_21:
    s_waitcnt lgkmcnt(0)
    v_mfma_f32_4x4x4_16b_bf16 v[32:35], v[64:65], v[48:49], 0 cbsz:4 abid:2
    v_mfma_f32_4x4x4_16b_bf16 v[36:39], v[64:65], v[50:51], 0 cbsz:4 abid:2
    v_mfma_f32_4x4x4_16b_bf16 v[40:43], v[64:65], v[52:53], 0 cbsz:4 abid:2
    v_mfma_f32_4x4x4_16b_bf16 v[44:47], v[64:65], v[54:55], 0 cbsz:4 abid:2
    s_nop 0
    s_set_gpr_idx_on s66, gpr_idx(SRC2,DST)
    v_pk_fma_f32 v[80:81], v[32:33], v[18:19], v[80:81] op_sel:[0,0,0] op_sel_hi:[1,0,1]
    v_pk_fma_f32 v[82:83], v[34:35], v[18:19], v[82:83] op_sel:[0,0,0] op_sel_hi:[1,0,1]
    v_pk_fma_f32 v[84:85], v[36:37], v[22:23], v[84:85] op_sel:[0,0,0] op_sel_hi:[1,0,1]
    v_pk_fma_f32 v[86:87], v[38:39], v[22:23], v[86:87] op_sel:[0,0,0] op_sel_hi:[1,0,1]
    v_pk_fma_f32 v[88:89], v[40:41], v[26:27], v[88:89] op_sel:[0,0,0] op_sel_hi:[1,0,1]
    v_pk_fma_f32 v[90:91], v[42:43], v[26:27], v[90:91] op_sel:[0,0,0] op_sel_hi:[1,0,1]
    v_pk_fma_f32 v[92:93], v[44:45], v[30:31], v[92:93] op_sel:[0,0,0] op_sel_hi:[1,0,1]
    v_pk_fma_f32 v[94:95], v[46:47], v[30:31], v[94:95] op_sel:[0,0,0] op_sel_hi:[1,0,1]
    s_set_gpr_idx_off
    s_mov_b32 s66, s70
    s_sub_u32 s62, s62, 1
    s_cmp_eq_u32 s62, 0
    s_cbranch_scc1 L_round_done
    s_cmp_ge_u32 s62, 3
    s_cbranch_scc1 L_22
    s_waitcnt vmcnt(0)
L_22:
    s_waitcnt vmcnt(4)
    ds_read_b64_tr_b16 v[48:49], v4 offset:6144
    ds_read_b64_tr_b16 v[50:51], v4 offset:6400
    ds_read_b64_tr_b16 v[52:53], v4 offset:6656
    ds_read_b64_tr_b16 v[54:55], v4 offset:6912
    s_cmp_le_u32 s62, 3
    s_cbranch_scc1 L_23
    s_and_b32 s76, s70, s82
    s_add_u32 m0, s63, 4096
    s_lshl_b32 s76, s76, 3
    buffer_load_dwordx4 v2, s[8:11], s76 offen lds
    buffer_load_dwordx4 v3, s[8:11], s76 offen offset:1024 lds
L_23:
    s_waitcnt lgkmcnt(0)
    v_mfma_f32_4x4x4_16b_bf16 v[32:35], v[64:65], v[48:49], 0 cbsz:4 abid:3
    v_mfma_f32_4x4x4_16b_bf16 v[36:39], v[64:65], v[50:51], 0 cbsz:4 abid:3
    v_mfma_f32_4x4x4_16b_bf16 v[40:43], v[64:65], v[52:53], 0 cbsz:4 abid:3
    v_mfma_f32_4x4x4_16b_bf16 v[44:47], v[64:65], v[54:55], 0 cbsz:4 abid:3
    s_nop 0
    s_set_gpr_idx_on s67, gpr_idx(SRC2,DST)
    v_pk_fma_f32 v[80:81], v[32:33], v[18:19], v[80:81] op_sel:[0,1,0] op_sel_hi:[1,1,1]
    v_pk_fma_f32 v[82:83], v[34:35], v[18:19], v[82:83] op_sel:[0,1,0] op_sel_hi:[1,1,1]
    v_pk_fma_f32 v[84:85], v[36:37], v[22:23], v[84:85] op_sel:[0,1,0] op_sel_hi:[1,1,1]
    v_pk_fma_f32 v[86:87], v[38:39], v[22:23], v[86:87] op_sel:[0,1,0] op_sel_hi:[1,1,1]
    v_pk_fma_f32 v[88:89], v[40:41], v[26:27], v[88:89] op_sel:[0,1,0] op_sel_hi:[1,1,1]
    v_pk_fma_f32 v[90:91], v[42:43], v[26:27], v[90:91] op_sel:[0,1,0] op_sel_hi:[1,1,1]
    v_pk_fma_f32 v[92:93], v[44:45], v[30:31], v[92:93] op_sel:[0,1,0] op_sel_hi:[1,1,1]
    v_pk_fma_f32 v[94:95], v[46:47], v[30:31], v[94:95] op_sel:[0,1,0] op_sel_hi:[1,1,1]
    s_set_gpr_idx_off
    s_mov_b32 s67, s71
    s_sub_u32 s62, s62, 1
    s_cmp_eq_u32 s62, 0
    s_cbranch_scc0 L_group
L_round_done:
    s_add_u32 s77, s77, 1
    s_cmp_lg_u32 s78, 0
    s_cbranch_scc1 L_scan
    s_cmp_eq_u32 s81, 0
    s_cbranch_scc1 L_havew
    s_mov_b32 s55, 0
L_pollw:
    s_waitcnt vmcnt(0)
    v_cmp_ne_u32 vcc, s48, v79
    s_cbranch_vccz L_gotw
    buffer_load_dword v79, v66, s[32:35], 0 offen sc1
    s_sleep 1
    s_add_u32 s55, s55, 1
    s_cmp_lt_u32 s55, 0x400000
    s_cbranch_scc1 L_pollw
    s_endpgm
L_gotw:
    buffer_load_dwordx4 a[32:35], v67, s[32:35], 0 offen offset:0 sc1
    buffer_load_dwordx4 a[36:39], v67, s[32:35], 0 offen offset:1024 sc1
    buffer_load_dwordx4 a[40:43], v67, s[32:35], 0 offen offset:2048 sc1
    buffer_load_dwordx4 a[44:47], v67, s[32:35], 0 offen offset:3072 sc1
    v_add_u32 v67, 4096, v67
    buffer_load_dwordx4 a[48:51], v67, s[32:35], 0 offen offset:0 sc1
    buffer_load_dwordx4 a[52:55], v67, s[32:35], 0 offen offset:1024 sc1
    buffer_load_dwordx4 a[56:59], v67, s[32:35], 0 offen offset:2048 sc1
    buffer_load_dwordx4 a[60:63], v67, s[32:35], 0 offen offset:3072 sc1
    v_add_u32 v67, 4096, v67
    buffer_load_dwordx4 a[64:67], v67, s[32:35], 0 offen offset:0 sc1
    buffer_load_dwordx4 a[68:71], v67, s[32:35], 0 offen offset:1024 sc1
    buffer_load_dwordx4 a[72:75], v67, s[32:35], 0 offen offset:2048 sc1
    buffer_load_dwordx4 a[76:79], v67, s[32:35], 0 offen offset:3072 sc1
    v_add_u32 v67, 4096, v67
    buffer_load_dwordx4 a[80:83], v67, s[32:35], 0 offen offset:0 sc1
    buffer_load_dwordx4 a[84:87], v67, s[32:35], 0 offen offset:1024 sc1
    buffer_load_dwordx4 a[88:91], v67, s[32:35], 0 offen offset:2048 sc1
    buffer_load_dwordx4 a[92:95], v67, s[32:35], 0 offen offset:3072 sc1
    v_add_u32 v67, 4096, v67
    s_branch L_havew
L_wstep:
    v_cmp_ne_u32 vcc, s48, v79
    s_cbranch_vccz L_wgo
    buffer_load_dword v79, v66, s[32:35], 0 offen sc1
    s_branch L_wback
L_wgo:
    s_branch L_wback
L_havew:
    v_mul_u32_u24 v16, 320, v1
    v_lshrrev_b32 v17, 2, v1
    v_lshl_add_u32 v16, v17, 3, v16
    s_lshl_b32 s53, s56, 3
    v_add_u32 v72, s53, v16
    v_add_u32 v5, 111136, v72
    s_lshl_b32 s53, s57, 3
    v_add_u32 v73, s53, v16
    v_add_u32 v6, 111136, v73
    s_lshl_b32 s53, s58, 3
    v_add_u32 v74, s53, v16
    v_add_u32 v7, 111136, v74
    s_lshl_b32 s53, s59, 3
    v_add_u32 v75, s53, v16
    v_add_u32 v8, 111136, v75
    s_lshl_b32 s53, s60, 3
    v_add_u32 v76, s53, v16
    v_add_u32 v9, 111136, v76
    v_cvt_pk_bf16_f32 v32, v80, v81
    v_cvt_pk_bf16_f32 v33, v82, v83
    ds_write_b64 v5, v[32:33] offset:0
    v_cvt_pk_bf16_f32 v34, v96, v97
    v_cvt_pk_bf16_f32 v35, v98, v99
    ds_write_b64 v6, v[34:35] offset:0
    v_cvt_pk_bf16_f32 v36, v112, v113
    v_cvt_pk_bf16_f32 v37, v114, v115
    ds_write_b64 v7, v[36:37] offset:0
    v_cvt_pk_bf16_f32 v38, v128, v129
    v_cvt_pk_bf16_f32 v39, v130, v131
    ds_write_b64 v8, v[38:39] offset:0
    v_cvt_pk_bf16_f32 v40, v144, v145
    v_cvt_pk_bf16_f32 v41, v146, v147
    ds_write_b64 v9, v[40:41] offset:0
    v_cvt_pk_bf16_f32 v42, v84, v85
    v_cvt_pk_bf16_f32 v43, v86, v87
    ds_write_b64 v5, v[42:43] offset:20608
    v_cvt_pk_bf16_f32 v44, v100, v101
    v_cvt_pk_bf16_f32 v45, v102, v103
    ds_write_b64 v6, v[44:45] offset:20608
    v_cvt_pk_bf16_f32 v46, v116, v117
    v_cvt_pk_bf16_f32 v47, v118, v119
    ds_write_b64 v7, v[46:47] offset:20608
    v_cvt_pk_bf16_f32 v48, v132, v133
    v_cvt_pk_bf16_f32 v49, v134, v135
    ds_write_b64 v8, v[48:49] offset:20608
    v_cvt_pk_bf16_f32 v50, v148, v149
    v_cvt_pk_bf16_f32 v51, v150, v151
    ds_write_b64 v9, v[50:51] offset:20608
    v_cvt_pk_bf16_f32 v52, v88, v89
    v_cvt_pk_bf16_f32 v53, v90, v91
    v_cvt_pk_bf16_f32 v54, v104, v105
    v_cvt_pk_bf16_f32 v55, v106, v107
    v_cvt_pk_bf16_f32 v56, v120, v121
    v_cvt_pk_bf16_f32 v57, v122, v123
    v_cvt_pk_bf16_f32 v58, v136, v137
    v_cvt_pk_bf16_f32 v59, v138, v139
    v_cvt_pk_bf16_f32 v60, v152, v153
    v_cvt_pk_bf16_f32 v61, v154, v155
    v_cvt_pk_bf16_f32 v62, v92, v93
    v_cvt_pk_bf16_f32 v63, v94, v95
    v_cvt_pk_bf16_f32 v64, v108, v109
    v_cvt_pk_bf16_f32 v65, v110, v111
    v_cvt_pk_bf16_f32 v66, v124, v125
    v_cvt_pk_bf16_f32 v67, v126, v127
    v_cvt_pk_bf16_f32 v68, v140, v141
    v_cvt_pk_bf16_f32 v69, v142, v143
    v_cvt_pk_bf16_f32 v70, v156, v157
    v_cvt_pk_bf16_f32 v71, v158, v159
    v_lshrrev_b32 v20, 5, v1
    v_mul_u32_u24 v21, 2576, v20
    v_bfe_u32 v22, v1, 2, 2
    v_mul_u32_u24 v24, 320, v22
    v_bfe_u32 v23, v1, 4, 1
    v_lshl_add_u32 v21, v23, 5, v21
    v_and_b32 v23, 3, v1
    v_lshl_add_u32 v21, v23, 3, v21
    v_add_u32 v3, v21, v24
    v_add_u32 v2, 111136, v3
    s_mul_i32 s53, s3, 5120
    s_add_u32 s53, s53, 41472
    v_and_b32 v24, 31, v1
    v_mul_u32_u24 v24, 80, v24
    v_lshl_add_u32 v24, v20, 3, v24
    v_add_u32 v10, s53, v24
    v_lshrrev_b32 v24, 2, v1
    v_mul_u32_u24 v24, 80, v24
    v_lshl_add_u32 v24, v23, 4, v24
    v_add_u32 v11, s53, v24
    v_lshrrev_b32 v24, 4, v1
    v_lshlrev_b32 v24, 19, v24
    v_lshl_add_u32 v24, v22, 9, v24
    v_lshl_add_u32 v24, v23, 4, v24
    s_lshl_b32 s53, s2, 11
    s_lshl_b32 s54, s3, 6
    s_add_u32 s53, s53, s54
    v_add_u32 v4, s53, v24
    s_waitcnt lgkmcnt(0)
    s_barrier
    ds_read_b64_tr_b16 v[16:17], v2 offset:0
    ds_read_b64_tr_b16 v[18:19], v2 offset:1288
    ds_read_b64_tr_b16 v[20:21], v2 offset:5152
    ds_read_b64_tr_b16 v[22:23], v2 offset:6440
    ds_read_b64_tr_b16 v[24:25], v2 offset:10304
    ds_read_b64_tr_b16 v[26:27], v2 offset:11592
    ds_read_b64_tr_b16 v[28:29], v2 offset:15456
    ds_read_b64_tr_b16 v[30:31], v2 offset:16744
    ds_read_b64_tr_b16 v[32:33], v2 offset:20608
    ds_read_b64_tr_b16 v[34:35], v2 offset:21896
    s_waitcnt vmcnt(8)
    s_waitcnt lgkmcnt(8)
    v_mfma_f32_32x32x16_bf16 v[80:95], a[32:35], v[16:19], 0
    ds_read_b64_tr_b16 v[36:37], v2 offset:25760
    ds_read_b64_tr_b16 v[38:39], v2 offset:27048
    ds_write_b64 v72, v[52:53] offset:0
    s_waitcnt lgkmcnt(9)
    v_mfma_f32_32x32x16_bf16 v[80:95], a[36:39], v[20:23], v[80:95]
    ds_read_b64_tr_b16 v[40:41], v2 offset:30912
    ds_read_b64_tr_b16 v[42:43], v2 offset:32200
    ds_write_b64 v73, v[54:55] offset:0
    s_waitcnt lgkmcnt(10)
    v_mfma_f32_32x32x16_bf16 v[80:95], a[40:43], v[24:27], v[80:95]
    ds_read_b64_tr_b16 v[44:45], v2 offset:36064
    ds_read_b64_tr_b16 v[46:47], v2 offset:37352
    ds_write_b64 v74, v[56:57] offset:0
    s_waitcnt lgkmcnt(11)
    v_mfma_f32_32x32x16_bf16 v[80:95], a[44:47], v[28:31], v[80:95]
    ds_read_b64_tr_b16 v[16:17], v2 offset:64
    ds_read_b64_tr_b16 v[18:19], v2 offset:1352
    ds_write_b64 v75, v[58:59] offset:0
    s_waitcnt lgkmcnt(12)
    v_mfma_f32_32x32x16_bf16 v[80:95], a[48:51], v[32:35], v[80:95]
    ds_read_b64_tr_b16 v[20:21], v2 offset:5216
    ds_read_b64_tr_b16 v[22:23], v2 offset:6504
    ds_write_b64 v76, v[60:61] offset:0
    s_waitcnt lgkmcnt(13)
    v_mfma_f32_32x32x16_bf16 v[80:95], a[52:55], v[36:39], v[80:95]
    ds_read_b64_tr_b16 v[24:25], v2 offset:10368
    ds_read_b64_tr_b16 v[26:27], v2 offset:11656
    ds_write_b64 v72, v[62:63] offset:20608
    s_waitcnt lgkmcnt(13)
    v_mfma_f32_32x32x16_bf16 v[80:95], a[56:59], v[40:43], v[80:95]
    ds_read_b64_tr_b16 v[28:29], v2 offset:15520
    ds_read_b64_tr_b16 v[30:31], v2 offset:16808
    ds_write_b64 v73, v[64:65] offset:20608
    s_waitcnt lgkmcnt(13)
    v_mfma_f32_32x32x16_bf16 v[80:95], a[60:63], v[44:47], v[80:95]
    ds_read_b64_tr_b16 v[32:33], v2 offset:20672
    ds_read_b64_tr_b16 v[34:35], v2 offset:21960
    ds_write_b64 v74, v[66:67] offset:20608
    s_waitcnt lgkmcnt(13)
    v_mfma_f32_32x32x16_bf16 v[96:111], a[32:35], v[16:19], 0
    ds_read_b64_tr_b16 v[36:37], v2 offset:25824
    ds_read_b64_tr_b16 v[38:39], v2 offset:27112
    ds_write_b64 v75, v[68:69] offset:20608
    s_waitcnt lgkmcnt(13)
    v_mfma_f32_32x32x16_bf16 v[96:111], a[36:39], v[20:23], v[96:111]
    ds_read_b64_tr_b16 v[40:41], v2 offset:30976
    ds_read_b64_tr_b16 v[42:43], v2 offset:32264
    ds_write_b64 v76, v[70:71] offset:20608
    s_waitcnt lgkmcnt(13)
    v_mfma_f32_32x32x16_bf16 v[96:111], a[40:43], v[24:27], v[96:111]
    ds_read_b64_tr_b16 v[44:45], v2 offset:36128
    ds_read_b64_tr_b16 v[46:47], v2 offset:37416
    s_waitcnt lgkmcnt(12)
    v_mfma_f32_32x32x16_bf16 v[96:111], a[44:47], v[28:31], v[96:111]
    ds_read_b64_tr_b16 v[16:17], v2 offset:128
    ds_read_b64_tr_b16 v[18:19], v2 offset:1416
    s_waitcnt lgkmcnt(11)
    v_mfma_f32_32x32x16_bf16 v[96:111], a[48:51], v[32:35], v[96:111]
    ds_read_b64_tr_b16 v[20:21], v2 offset:5280
    ds_read_b64_tr_b16 v[22:23], v2 offset:6568
    s_waitcnt lgkmcnt(10)
    v_mfma_f32_32x32x16_bf16 v[96:111], a[52:55], v[36:39], v[96:111]
    ds_read_b64_tr_b16 v[24:25], v2 offset:10432
    ds_read_b64_tr_b16 v[26:27], v2 offset:11720
    s_waitcnt lgkmcnt(9)
    v_mfma_f32_32x32x16_bf16 v[96:111], a[56:59], v[40:43], v[96:111]
    ds_read_b64_tr_b16 v[28:29], v2 offset:15584
    ds_read_b64_tr_b16 v[30:31], v2 offset:16872
    s_waitcnt lgkmcnt(8)
    v_mfma_f32_32x32x16_bf16 v[96:111], a[60:63], v[44:47], v[96:111]
    ds_read_b64_tr_b16 v[32:33], v2 offset:20736
    ds_read_b64_tr_b16 v[34:35], v2 offset:22024
    s_waitcnt lgkmcnt(8)
    v_mfma_f32_32x32x16_bf16 v[112:127], a[32:35], v[16:19], 0
    ds_read_b64_tr_b16 v[36:37], v2 offset:25888
    ds_read_b64_tr_b16 v[38:39], v2 offset:27176
    s_waitcnt lgkmcnt(8)
    v_mfma_f32_32x32x16_bf16 v[112:127], a[36:39], v[20:23], v[112:127]
    ds_read_b64_tr_b16 v[40:41], v2 offset:31040
    ds_read_b64_tr_b16 v[42:43], v2 offset:32328
    s_waitcnt lgkmcnt(8)
    v_mfma_f32_32x32x16_bf16 v[112:127], a[40:43], v[24:27], v[112:127]
    ds_read_b64_tr_b16 v[44:45], v2 offset:36192
    ds_read_b64_tr_b16 v[46:47], v2 offset:37480
    s_barrier
    s_waitcnt lgkmcnt(8)
    v_mfma_f32_32x32x16_bf16 v[112:127], a[44:47], v[28:31], v[112:127]
    ds_read_b64_tr_b16 v[16:17], v3 offset:0
    ds_read_b64_tr_b16 v[18:19], v3 offset:1288
    s_waitcnt lgkmcnt(8)
    v_mfma_f32_32x32x16_bf16 v[112:127], a[48:51], v[32:35], v[112:127]
    ds_read_b64_tr_b16 v[20:21], v3 offset:5152
    ds_read_b64_tr_b16 v[22:23], v3 offset:6440
    s_waitcnt lgkmcnt(8)
    v_mfma_f32_32x32x16_bf16 v[112:127], a[52:55], v[36:39], v[112:127]
    ds_read_b64_tr_b16 v[24:25], v3 offset:10304
    ds_read_b64_tr_b16 v[26:27], v3 offset:11592
    s_waitcnt lgkmcnt(8)
    v_mfma_f32_32x32x16_bf16 v[112:127], a[56:59], v[40:43], v[112:127]
    ds_read_b64_tr_b16 v[28:29], v3 offset:15456
    ds_read_b64_tr_b16 v[30:31], v3 offset:16744
    s_waitcnt lgkmcnt(8)
    v_mfma_f32_32x32x16_bf16 v[112:127], a[60:63], v[44:47], v[112:127]
    ds_read_b64_tr_b16 v[32:33], v3 offset:20608
    ds_read_b64_tr_b16 v[34:35], v3 offset:21896
    s_waitcnt vmcnt(0)
    s_waitcnt lgkmcnt(8)
    v_mfma_f32_32x32x16_bf16 v[80:95], a[64:67], v[16:19], v[80:95]
    ds_read_b64_tr_b16 v[36:37], v3 offset:25760
    ds_read_b64_tr_b16 v[38:39], v3 offset:27048
    s_waitcnt lgkmcnt(8)
    v_mfma_f32_32x32x16_bf16 v[80:95], a[68:71], v[20:23], v[80:95]
    ds_read_b64_tr_b16 v[40:41], v3 offset:30912
    ds_read_b64_tr_b16 v[42:43], v3 offset:32200
    s_waitcnt lgkmcnt(8)
    v_mfma_f32_32x32x16_bf16 v[80:95], a[72:75], v[24:27], v[80:95]
    ds_read_b64_tr_b16 v[44:45], v3 offset:36064
    ds_read_b64_tr_b16 v[46:47], v3 offset:37352
    s_waitcnt lgkmcnt(8)
    v_mfma_f32_32x32x16_bf16 v[80:95], a[76:79], v[28:31], v[80:95]
    ds_read_b64_tr_b16 v[16:17], v3 offset:64
    ds_read_b64_tr_b16 v[18:19], v3 offset:1352
    s_waitcnt lgkmcnt(8)
    v_mfma_f32_32x32x16_bf16 v[80:95], a[80:83], v[32:35], v[80:95]
    ds_read_b64_tr_b16 v[20:21], v3 offset:5216
    ds_read_b64_tr_b16 v[22:23], v3 offset:6504
    s_waitcnt lgkmcnt(8)
    v_mfma_f32_32x32x16_bf16 v[80:95], a[84:87], v[36:39], v[80:95]
    ds_read_b64_tr_b16 v[24:25], v3 offset:10368
    ds_read_b64_tr_b16 v[26:27], v3 offset:11656
    s_waitcnt lgkmcnt(8)
    v_mfma_f32_32x32x16_bf16 v[80:95], a[88:91], v[40:43], v[80:95]
    ds_read_b64_tr_b16 v[28:29], v3 offset:15520
    ds_read_b64_tr_b16 v[30:31], v3 offset:16808
    s_waitcnt lgkmcnt(8)
    v_mfma_f32_32x32x16_bf16 v[80:95], a[92:95], v[44:47], v[80:95]
    ds_read_b64_tr_b16 v[32:33], v3 offset:20672
    ds_read_b64_tr_b16 v[34:35], v3 offset:21960
    s_waitcnt lgkmcnt(8)
    v_mfma_f32_32x32x16_bf16 v[96:111], a[64:67], v[16:19], v[96:111]
    ds_read_b64_tr_b16 v[36:37], v3 offset:25824
    ds_read_b64_tr_b16 v[38:39], v3 offset:27112
    s_waitcnt lgkmcnt(8)
    v_mfma_f32_32x32x16_bf16 v[96:111], a[68:71], v[20:23], v[96:111]
    ds_read_b64_tr_b16 v[40:41], v3 offset:30976
    ds_read_b64_tr_b16 v[42:43], v3 offset:32264
    s_waitcnt lgkmcnt(8)
    v_mfma_f32_32x32x16_bf16 v[96:111], a[72:75], v[24:27], v[96:111]
    ds_read_b64_tr_b16 v[44:45], v3 offset:36128
    ds_read_b64_tr_b16 v[46:47], v3 offset:37416
    s_waitcnt lgkmcnt(8)
    v_mfma_f32_32x32x16_bf16 v[96:111], a[76:79], v[28:31], v[96:111]
    ds_read_b64_tr_b16 v[16:17], v3 offset:128
    ds_read_b64_tr_b16 v[18:19], v3 offset:1416
    v_cvt_pk_bf16_f32 v80, v80, v81
    v_cvt_pk_bf16_f32 v81, v82, v83
    ds_write_b64 v10, v[80:81] offset:0
    s_waitcnt lgkmcnt(9)
    v_mfma_f32_32x32x16_bf16 v[96:111], a[80:83], v[32:35], v[96:111]
    ds_read_b64_tr_b16 v[20:21], v3 offset:5280
    ds_read_b64_tr_b16 v[22:23], v3 offset:6568
    v_cvt_pk_bf16_f32 v82, v84, v85
    v_cvt_pk_bf16_f32 v83, v86, v87
    ds_write_b64 v10, v[82:83] offset:16
    s_waitcnt lgkmcnt(10)
    v_mfma_f32_32x32x16_bf16 v[96:111], a[84:87], v[36:39], v[96:111]
    ds_read_b64_tr_b16 v[24:25], v3 offset:10432
    ds_read_b64_tr_b16 v[26:27], v3 offset:11720
    v_cvt_pk_bf16_f32 v84, v88, v89
    v_cvt_pk_bf16_f32 v85, v90, v91
    ds_write_b64 v10, v[84:85] offset:32
    s_waitcnt lgkmcnt(11)
    v_mfma_f32_32x32x16_bf16 v[96:111], a[88:91], v[40:43], v[96:111]
    ds_read_b64_tr_b16 v[28:29], v3 offset:15584
    ds_read_b64_tr_b16 v[30:31], v3 offset:16872
    v_cvt_pk_bf16_f32 v86, v92, v93
    v_cvt_pk_bf16_f32 v87, v94, v95
    ds_write_b64 v10, v[86:87] offset:48
    s_waitcnt lgkmcnt(12)
    v_mfma_f32_32x32x16_bf16 v[96:111], a[92:95], v[44:47], v[96:111]
    ds_read_b64_tr_b16 v[32:33], v3 offset:20736
    ds_read_b64_tr_b16 v[34:35], v3 offset:22024
    ds_read_b128 v[52:55], v11 offset:0
    s_waitcnt lgkmcnt(13)
    v_mfma_f32_32x32x16_bf16 v[112:127], a[64:67], v[16:19], v[112:127]
    ds_read_b64_tr_b16 v[36:37], v3 offset:25888
    ds_read_b64_tr_b16 v[38:39], v3 offset:27176
    ds_read_b128 v[56:59], v11 offset:1280
    s_waitcnt lgkmcnt(13)
    v_mfma_f32_32x32x16_bf16 v[112:127], a[68:71], v[20:23], v[112:127]
    ds_read_b64_tr_b16 v[40:41], v3 offset:31040
    ds_read_b64_tr_b16 v[42:43], v3 offset:32328
    s_waitcnt lgkmcnt(12)
    v_mfma_f32_32x32x16_bf16 v[112:127], a[72:75], v[24:27], v[112:127]
    ds_read_b64_tr_b16 v[44:45], v3 offset:36192
    ds_read_b64_tr_b16 v[46:47], v3 offset:37480
    s_waitcnt lgkmcnt(11)
    v_mfma_f32_32x32x16_bf16 v[112:127], a[76:79], v[28:31], v[112:127]
    ds_read_b64_tr_b16 v[16:17], v2 offset:192
    ds_read_b64_tr_b16 v[18:19], v2 offset:1480
    v_cvt_pk_bf16_f32 v96, v96, v97
    v_cvt_pk_bf16_f32 v97, v98, v99
    ds_write_b64 v10, v[96:97] offset:2560
    s_waitcnt lgkmcnt(11)
    v_mfma_f32_32x32x16_bf16 v[112:127], a[80:83], v[32:35], v[112:127]
    ds_read_b64_tr_b16 v[20:21], v2 offset:5344
    ds_read_b64_tr_b16 v[22:23], v2 offset:6632
    v_cvt_pk_bf16_f32 v98, v100, v101
    v_cvt_pk_bf16_f32 v99, v102, v103
    ds_write_b64 v10, v[98:99] offset:2576
    s_waitcnt lgkmcnt(11)
    v_mfma_f32_32x32x16_bf16 v[112:127], a[84:87], v[36:39], v[112:127]
    ds_read_b64_tr_b16 v[24:25], v2 offset:10496
    ds_read_b64_tr_b16 v[26:27], v2 offset:11784
    buffer_store_dwordx4 v[52:55], v4, s[28:31], 0 offen sc1
    v_add_u32 v4, 2097152, v4
    v_cvt_pk_bf16_f32 v100, v104, v105
    v_cvt_pk_bf16_f32 v101, v106, v107
    ds_write_b64 v10, v[100:101] offset:2592
    s_waitcnt lgkmcnt(11)
    v_mfma_f32_32x32x16_bf16 v[112:127], a[88:91], v[40:43], v[112:127]
    ds_read_b64_tr_b16 v[28:29], v2 offset:15648
    ds_read_b64_tr_b16 v[30:31], v2 offset:16936
    buffer_store_dwordx4 v[56:59], v4, s[28:31], 0 offen sc1
    v_add_u32 v4, 2097152, v4
    v_cvt_pk_bf16_f32 v102, v108, v109
    v_cvt_pk_bf16_f32 v103, v110, v111
    ds_write_b64 v10, v[102:103] offset:2608
    s_waitcnt lgkmcnt(12)
    v_mfma_f32_32x32x16_bf16 v[112:127], a[92:95], v[44:47], v[112:127]
    ds_read_b64_tr_b16 v[32:33], v2 offset:20800
    ds_read_b64_tr_b16 v[34:35], v2 offset:22088
    ds_read_b128 v[60:63], v11 offset:2560
    s_waitcnt lgkmcnt(13)
    v_mfma_f32_32x32x16_bf16 v[128:143], a[32:35], v[16:19], 0
    ds_read_b64_tr_b16 v[36:37], v2 offset:25952
    ds_read_b64_tr_b16 v[38:39], v2 offset:27240
    ds_read_b128 v[64:67], v11 offset:3840
    s_waitcnt lgkmcnt(13)
    v_mfma_f32_32x32x16_bf16 v[128:143], a[36:39], v[20:23], v[128:143]
    ds_read_b64_tr_b16 v[40:41], v2 offset:31104
    ds_read_b64_tr_b16 v[42:43], v2 offset:32392
    s_waitcnt lgkmcnt(12)
    v_mfma_f32_32x32x16_bf16 v[128:143], a[40:43], v[24:27], v[128:143]
    ds_read_b64_tr_b16 v[44:45], v2 offset:36256
    ds_read_b64_tr_b16 v[46:47], v2 offset:37544
    s_waitcnt lgkmcnt(11)
    v_mfma_f32_32x32x16_bf16 v[128:143], a[44:47], v[28:31], v[128:143]
    ds_read_b64_tr_b16 v[16:17], v3 offset:192
    ds_read_b64_tr_b16 v[18:19], v3 offset:1480
    v_cvt_pk_bf16_f32 v112, v112, v113
    v_cvt_pk_bf16_f32 v113, v114, v115
    ds_write_b64 v10, v[112:113] offset:0
    s_waitcnt lgkmcnt(11)
    v_mfma_f32_32x32x16_bf16 v[128:143], a[48:51], v[32:35], v[128:143]
    ds_read_b64_tr_b16 v[20:21], v3 offset:5344
    ds_read_b64_tr_b16 v[22:23], v3 offset:6632
    v_cvt_pk_bf16_f32 v114, v116, v117
    v_cvt_pk_bf16_f32 v115, v118, v119
    ds_write_b64 v10, v[114:115] offset:16
    s_waitcnt lgkmcnt(11)
    v_mfma_f32_32x32x16_bf16 v[128:143], a[52:55], v[36:39], v[128:143]
    ds_read_b64_tr_b16 v[24:25], v3 offset:10496
    ds_read_b64_tr_b16 v[26:27], v3 offset:11784
    buffer_store_dwordx4 v[60:63], v4, s[28:31], 0 offen sc1
    v_add_u32 v4, 2097152, v4
    v_cvt_pk_bf16_f32 v116, v120, v121
    v_cvt_pk_bf16_f32 v117, v122, v123
    ds_write_b64 v10, v[116:117] offset:32
    s_waitcnt lgkmcnt(11)
    v_mfma_f32_32x32x16_bf16 v[128:143], a[56:59], v[40:43], v[128:143]
    ds_read_b64_tr_b16 v[28:29], v3 offset:15648
    ds_read_b64_tr_b16 v[30:31], v3 offset:16936
    buffer_store_dwordx4 v[64:67], v4, s[28:31], 0 offen sc1
    v_add_u32 v4, 2097152, v4
    v_cvt_pk_bf16_f32 v118, v124, v125
    v_cvt_pk_bf16_f32 v119, v126, v127
    ds_write_b64 v10, v[118:119] offset:48
    s_waitcnt lgkmcnt(12)
    v_mfma_f32_32x32x16_bf16 v[128:143], a[60:63], v[44:47], v[128:143]
    ds_read_b64_tr_b16 v[32:33], v3 offset:20800
    ds_read_b64_tr_b16 v[34:35], v3 offset:22088
    ds_read_b128 v[52:55], v11 offset:0
    s_waitcnt lgkmcnt(13)
    v_mfma_f32_32x32x16_bf16 v[128:143], a[64:67], v[16:19], v[128:143]
    ds_read_b64_tr_b16 v[36:37], v3 offset:25952
    ds_read_b64_tr_b16 v[38:39], v3 offset:27240
    ds_read_b128 v[56:59], v11 offset:1280
    s_waitcnt lgkmcnt(13)
    v_mfma_f32_32x32x16_bf16 v[128:143], a[68:71], v[20:23], v[128:143]
    ds_read_b64_tr_b16 v[40:41], v3 offset:31104
    ds_read_b64_tr_b16 v[42:43], v3 offset:32392
    s_waitcnt lgkmcnt(12)
    v_mfma_f32_32x32x16_bf16 v[128:143], a[72:75], v[24:27], v[128:143]
    ds_read_b64_tr_b16 v[44:45], v3 offset:36256
    ds_read_b64_tr_b16 v[46:47], v3 offset:37544
    s_waitcnt lgkmcnt(11)
    v_mfma_f32_32x32x16_bf16 v[128:143], a[76:79], v[28:31], v[128:143]
    ds_read_b64_tr_b16 v[16:17], v2 offset:256
    ds_read_b64_tr_b16 v[18:19], v2 offset:1544
    s_waitcnt lgkmcnt(10)
    v_mfma_f32_32x32x16_bf16 v[128:143], a[80:83], v[32:35], v[128:143]
    ds_read_b64_tr_b16 v[20:21], v2 offset:5408
    ds_read_b64_tr_b16 v[22:23], v2 offset:6696
    s_waitcnt lgkmcnt(9)
    v_mfma_f32_32x32x16_bf16 v[128:143], a[84:87], v[36:39], v[128:143]
    ds_read_b64_tr_b16 v[24:25], v2 offset:10560
    ds_read_b64_tr_b16 v[26:27], v2 offset:11848
    buffer_store_dwordx4 v[52:55], v4, s[28:31], 0 offen sc1
    v_add_u32 v4, 2097152, v4
    s_waitcnt lgkmcnt(8)
    v_mfma_f32_32x32x16_bf16 v[128:143], a[88:91], v[40:43], v[128:143]
    ds_read_b64_tr_b16 v[28:29], v2 offset:15712
    ds_read_b64_tr_b16 v[30:31], v2 offset:17000
    buffer_store_dwordx4 v[56:59], v4, s[28:31], 0 offen sc1
    v_add_u32 v4, 2097152, v4
    s_waitcnt lgkmcnt(8)
    v_mfma_f32_32x32x16_bf16 v[128:143], a[92:95], v[44:47], v[128:143]
    ds_read_b64_tr_b16 v[32:33], v2 offset:20864
    ds_read_b64_tr_b16 v[34:35], v2 offset:22152
    s_waitcnt lgkmcnt(8)
    v_mfma_f32_32x32x16_bf16 v[144:159], a[32:35], v[16:19], 0
    ds_read_b64_tr_b16 v[36:37], v2 offset:26016
    ds_read_b64_tr_b16 v[38:39], v2 offset:27304
    s_waitcnt lgkmcnt(8)
    v_mfma_f32_32x32x16_bf16 v[144:159], a[36:39], v[20:23], v[144:159]
    ds_read_b64_tr_b16 v[40:41], v2 offset:31168
    ds_read_b64_tr_b16 v[42:43], v2 offset:32456
    s_waitcnt lgkmcnt(8)
    v_mfma_f32_32x32x16_bf16 v[144:159], a[40:43], v[24:27], v[144:159]
    ds_read_b64_tr_b16 v[44:45], v2 offset:36320
    ds_read_b64_tr_b16 v[46:47], v2 offset:37608
    s_waitcnt lgkmcnt(8)
    v_mfma_f32_32x32x16_bf16 v[144:159], a[44:47], v[28:31], v[144:159]
    ds_read_b64_tr_b16 v[16:17], v3 offset:256
    ds_read_b64_tr_b16 v[18:19], v3 offset:1544
    v_cvt_pk_bf16_f32 v128, v128, v129
    v_cvt_pk_bf16_f32 v129, v130, v131
    ds_write_b64 v10, v[128:129] offset:2560
    s_waitcnt lgkmcnt(9)
    v_mfma_f32_32x32x16_bf16 v[144:159], a[48:51], v[32:35], v[144:159]
    ds_read_b64_tr_b16 v[20:21], v3 offset:5408
    ds_read_b64_tr_b16 v[22:23], v3 offset:6696
    v_cvt_pk_bf16_f32 v130, v132, v133
    v_cvt_pk_bf16_f32 v131, v134, v135
    ds_write_b64 v10, v[130:131] offset:2576
    s_waitcnt lgkmcnt(10)
    v_mfma_f32_32x32x16_bf16 v[144:159], a[52:55], v[36:39], v[144:159]
    ds_read_b64_tr_b16 v[24:25], v3 offset:10560
    ds_read_b64_tr_b16 v[26:27], v3 offset:11848
    v_cvt_pk_bf16_f32 v132, v136, v137
    v_cvt_pk_bf16_f32 v133, v138, v139
    ds_write_b64 v10, v[132:133] offset:2592
    s_waitcnt lgkmcnt(11)
    v_mfma_f32_32x32x16_bf16 v[144:159], a[56:59], v[40:43], v[144:159]
    ds_read_b64_tr_b16 v[28:29], v3 offset:15712
    ds_read_b64_tr_b16 v[30:31], v3 offset:17000
    v_cvt_pk_bf16_f32 v134, v140, v141
    v_cvt_pk_bf16_f32 v135, v142, v143
    ds_write_b64 v10, v[134:135] offset:2608
    s_waitcnt lgkmcnt(12)
    v_mfma_f32_32x32x16_bf16 v[144:159], a[60:63], v[44:47], v[144:159]
    ds_read_b64_tr_b16 v[32:33], v3 offset:20864
    ds_read_b64_tr_b16 v[34:35], v3 offset:22152
    ds_read_b128 v[60:63], v11 offset:2560
    s_waitcnt lgkmcnt(13)
    v_mfma_f32_32x32x16_bf16 v[144:159], a[64:67], v[16:19], v[144:159]
    ds_read_b64_tr_b16 v[36:37], v3 offset:26016
    ds_read_b64_tr_b16 v[38:39], v3 offset:27304
    ds_read_b128 v[64:67], v11 offset:3840
    s_waitcnt lgkmcnt(13)
    v_mfma_f32_32x32x16_bf16 v[144:159], a[68:71], v[20:23], v[144:159]
    ds_read_b64_tr_b16 v[40:41], v3 offset:31168
    ds_read_b64_tr_b16 v[42:43], v3 offset:32456
    s_waitcnt lgkmcnt(12)
    v_mfma_f32_32x32x16_bf16 v[144:159], a[72:75], v[24:27], v[144:159]
    ds_read_b64_tr_b16 v[44:45], v3 offset:36320
    ds_read_b64_tr_b16 v[46:47], v3 offset:37608
    s_waitcnt lgkmcnt(11)
    v_mfma_f32_32x32x16_bf16 v[144:159], a[76:79], v[28:31], v[144:159]
    s_waitcnt lgkmcnt(8)
    v_mfma_f32_32x32x16_bf16 v[144:159], a[80:83], v[32:35], v[144:159]
    s_waitcnt lgkmcnt(5)
    v_mfma_f32_32x32x16_bf16 v[144:159], a[84:87], v[36:39], v[144:159]
    buffer_store_dwordx4 v[60:63], v4, s[28:31], 0 offen sc1
    v_add_u32 v4, 2097152, v4
    s_waitcnt lgkmcnt(2)
    v_mfma_f32_32x32x16_bf16 v[144:159], a[88:91], v[40:43], v[144:159]
    buffer_store_dwordx4 v[64:67], v4, s[28:31], 0 offen sc1
    v_add_u32 v4, 2097152, v4
    s_waitcnt lgkmcnt(0)
    v_mfma_f32_32x32x16_bf16 v[144:159], a[92:95], v[44:47], v[144:159]
    s_nop 11
    v_cvt_pk_bf16_f32 v144, v144, v145
    v_cvt_pk_bf16_f32 v145, v146, v147
    ds_write_b64 v10, v[144:145] offset:0
    v_cvt_pk_bf16_f32 v146, v148, v149
    v_cvt_pk_bf16_f32 v147, v150, v151
    ds_write_b64 v10, v[146:147] offset:16
    v_cvt_pk_bf16_f32 v148, v152, v153
    v_cvt_pk_bf16_f32 v149, v154, v155
    ds_write_b64 v10, v[148:149] offset:32
    v_cvt_pk_bf16_f32 v150, v156, v157
    v_cvt_pk_bf16_f32 v151, v158, v159
    ds_write_b64 v10, v[150:151] offset:48
    ds_read_b128 v[52:55], v11 offset:0
    ds_read_b128 v[56:59], v11 offset:1280
    s_waitcnt lgkmcnt(1)
    buffer_store_dwordx4 v[52:55], v4, s[28:31], 0 offen sc1
    v_add_u32 v4, 2097152, v4
    s_waitcnt lgkmcnt(0)
    buffer_store_dwordx4 v[56:59], v4, s[28:31], 0 offen sc1
    v_add_u32 v4, 2097152, v4
L_end:
    s_endpgm
.section .rodata,"a"
.p2align 6
.amdhsa_kernel standalone__tensor_product_equiv_mace__graph_kernel
  .amdhsa_next_free_vgpr 256
  .amdhsa_next_free_sgpr 102
  .amdhsa_accum_offset 160
  .amdhsa_group_segment_fixed_size 0
  .amdhsa_kernarg_size 88
  .amdhsa_user_sgpr_count 2
  .amdhsa_user_sgpr_kernarg_segment_ptr 1
  .amdhsa_system_sgpr_workgroup_id_x 1
  .amdhsa_float_denorm_mode_32 3
.end_amdhsa_kernel
```

```asm
; @launch grid=(256,1,1) block=(512,1,1) lds=153600
.amdgcn_target "amdgcn-amd-amdhsa--gfx950"
.text
.globl standalone__tensor_product_equiv_mace__graph_kernel
.p2align 8
.type standalone__tensor_product_equiv_mace__graph_kernel,@function
standalone__tensor_product_equiv_mace__graph_kernel:
    s_cmp_ge_u32 s2, 256
    s_cbranch_scc1 L_end
    s_load_dwordx2 s[84:85], s[0:1], 80
    s_load_dwordx16 s[64:79], s[0:1], 0
    s_load_dwordx2 s[80:81], s[0:1], 64
    v_and_b32 v1, 63, v0
    v_lshrrev_b32 v60, 6, v0
    v_mov_b32 v12, 0
    v_readfirstlane_b32 s3, v60
    s_and_b32 s55, s2, 63
    s_and_b32 s54, s2, 192
    s_mul_i32 s53, s55, 10000
    v_lshlrev_b32 v63, 4, v0
    v_add_u32 v60, s53, v63
    s_add_u32 s53, s53, 8192
    v_lshl_add_u32 v61, v0, 2, s53
    s_lshl_b32 s53, s54, 1
    v_mov_b32 v62, s53
    s_waitcnt lgkmcnt(0)
    s_mov_b32 s16, s68
    s_mov_b32 s17, s69
    s_mov_b32 s18, 640000
    s_mov_b32 s19, 0x00020000
    buffer_load_dwordx4 v[16:19], v60, s[16:19], 0 offen
    buffer_load_dword v20, v61, s[16:19], 0 offen
    s_mov_b32 s12, s66
    s_mov_b32 s13, s67
    s_mov_b32 s14, 640000
    s_mov_b32 s15, 0x00020000
    buffer_load_dwordx4 v[24:27], v60, s[12:15], 0 offen
    buffer_load_dword v28, v61, s[12:15], 0 offen
    s_mov_b32 s32, s84
    s_mov_b32 s33, s85
    s_mov_b32 s34, 20971520
    s_mov_b32 s35, 0x00020000
    buffer_load_dword v42, v62, s[32:35], 0 offen sc1
    s_mov_b32 s20, s70
    s_mov_b32 s21, s71
    s_mov_b32 s22, 1280000
    s_mov_b32 s23, 0x00020000
    v_mov_b32 v72, -1
    v_mov_b32 v73, -1
    v_mov_b32 v74, -1
    v_mov_b32 v75, -1
    ds_write_b128 v63, v[72:75] offset:0
    ds_write_b128 v63, v[72:75] offset:8192
    v_mov_b32 v68, 0
    v_mov_b32 v69, 0
    v_lshlrev_b32 v60, 3, v0
    v_add_u32 v60, 111136, v60
    ds_write_b64 v60, v[68:69]
    v_min_u32 v60, 35, v1
    v_lshlrev_b32 v60, 3, v60
    v_add_u32 v60, 110848, v60
    ds_write_b64 v60, v[68:69]
    s_mov_b32 s8, s64
    s_mov_b32 s9, s65
    s_mov_b32 s10, 20480000
    s_mov_b32 s11, 0x00020000
    s_mov_b32 s24, s72
    s_mov_b32 s25, s73
    s_mov_b32 s26, 5120000
    s_mov_b32 s27, 0x00020000
    s_mov_b32 s28, s80
    s_mov_b32 s29, s81
    s_mov_b32 s30, 20480000
    s_mov_b32 s31, 0x00020000
    s_mov_b32 s96, s74
    s_mov_b32 s97, s75
    s_mov_b32 s98, 128
    s_mov_b32 s99, 0x00020000
    s_mov_b32 s92, s76
    s_mov_b32 s93, s77
    s_mov_b32 s94, 8192
    s_mov_b32 s95, 0x00020000
    s_mov_b32 s88, s78
    s_mov_b32 s89, s79
    s_mov_b32 s90, 131072
    s_mov_b32 s91, 0x00020000
    s_lshl_b32 s63, s3, 13
    s_mov_b32 s52, 0
    s_mov_b32 s77, 0
    s_mov_b32 s82, 0x3fff00
    s_mov_b32 s83, 20971520
    s_mov_b32 s81, 8
    s_lshl_b32 s49, s3, 10
    s_add_u32 s49, s49, 119328
    s_movk_i32 s53, 452
    v_cmp_gt_u32 s[50:51], s53, v0
    v_lshlrev_b32 v43, 22, v0
    v_lshlrev_b32 v59, 20, v0
    v_mov_b32 v58, 1
    s_waitcnt lgkmcnt(0)
    s_barrier
    v_and_b32 v60, 3, v1
    v_lshlrev_b32 v61, 5, v60
    v_lshrrev_b32 v66, 4, v1
    v_lshl_add_u32 v61, v66, 1, v61
    buffer_load_ushort v44, v61, s[96:99], 0 offen offset:0
    buffer_load_ushort v45, v61, s[96:99], 0 offen offset:8
    buffer_load_ushort v46, v61, s[96:99], 0 offen offset:16
    buffer_load_ushort v47, v61, s[96:99], 0 offen offset:24
    s_lshl_b32 s53, s3, 10
    s_add_u32 m0, s53, 32768
    v_bfe_u32 v62, v1, 1, 2
    v_bfe_u32 v64, v1, 3, 1
    v_lshl_add_u32 v62, v64, 3, v62
    v_bfe_u32 v64, v1, 4, 1
    v_lshl_add_u32 v62, v64, 2, v62
    v_lshlrev_b32 v62, 9, v62
    v_lshrrev_b32 v64, 5, v1
    v_lshl_add_u32 v62, v64, 5, v62
    v_and_b32 v64, 1, v1
    v_lshl_add_u32 v62, v64, 4, v62
    s_lshl_b32 s53, s3, 6
    buffer_load_dwordx4 v62, s[92:95], s53 offen lds
    v_lshlrev_b32 v64, 4, v1
    s_lshr_b32 s53, s2, 3
    s_lshl3_add_u32 s53, s53, s3
    s_lshl_b32 s53, s53, 10
    v_add_u32 v79, s53, v64
    buffer_load_dwordx4 v[156:159], v79, s[20:23], 0 offen
    v_add_u32 v79, 262144, v79
    buffer_load_dwordx4 v[156:159], v79, s[20:23], 0 offen
    v_add_u32 v79, 262144, v79
    v_and_b32 v61, 7, v1
    v_bfe_u32 v65, v1, 3, 1
    v_lshlrev_b32 v65, 9, v65
    v_lshl_add_u32 v65, v66, 7, v65
    v_lshl_add_u32 v2, v61, 4, v65
    v_xor_b32 v61, 4, v61
    v_lshl_add_u32 v3, v61, 4, v65
    v_bfe_u32 v60, v1, 2, 2
    v_bfe_u32 v62, v1, 1, 1
    v_lshl_add_u32 v62, v66, 1, v62
    v_lshrrev_b32 v63, 1, v60
    v_lshlrev_b32 v64, 2, v63
    v_xor_b32 v62, v62, v64
    v_and_b32 v64, 1, v60
    v_lshl_add_u32 v62, v64, 3, v62
    v_lshlrev_b32 v62, 4, v62
    v_lshl_add_u32 v62, v63, 10, v62
    v_and_b32 v64, 1, v1
    v_lshl_add_u32 v62, v64, 3, v62
    v_add_u32 v4, s63, v62
    v_lshrrev_b32 v61, 5, v1
    v_mov_b32 v63, 32
    v_cmp_eq_u32 vcc, v60, v61
    v_add_u32 v61, 2, v61
    v_and_b32 v64, 3, v1
    v_cndmask_b32 v7, 0, v63, vcc
    v_cmp_eq_u32 vcc, v60, v61
    v_cmp_eq_u32 s[4:5], v64, v66
    v_mov_b32 v65, 8
    v_cndmask_b32 v8, 0, v63, vcc
    v_cndmask_b32 v10, 0, v65, s[4:5]
    v_lshrrev_b32 v68, 3, v0
    v_and_b32 v69, 7, v0
    v_lshlrev_b32 v69, 4, v69
    v_add_u32 v61, s54, v68
    s_movk_i32 s46, 8320
    v_mad_u32_u24 v64, v61, s46, v69
    s_lshl_b32 s45, s55, 7
    s_add_u32 s53, s45, 8388608
    v_add_u32 v64, s53, v64
    v_lshl_add_u32 v65, v61, 13, v69
    s_add_u32 s53, s45, 16777216
    v_add_u32 v65, s53, v65
    v_lshlrev_b32 v61, 4, v0
    s_mov_b32 s53, 110880
    v_lshl_add_u32 v67, v68, 2, s53
    s_waitcnt vmcnt(10)
    v_and_b32 v48, 255, v16
    v_subrev_u32 v48, s54, v48
    v_cmp_gt_u32 s[64:65], 64, v48
    v_lshl_add_u32 v60, v48, 2, s53
    s_mov_b64 exec, s[64:65]
    ds_add_rtn_u32 v53, v60, v58
    s_mov_b64 exec, -1
    v_and_b32 v49, 255, v17
    v_subrev_u32 v49, s54, v49
    v_cmp_gt_u32 s[66:67], 64, v49
    v_lshl_add_u32 v60, v49, 2, s53
    s_mov_b64 exec, s[66:67]
    ds_add_rtn_u32 v54, v60, v58
    s_mov_b64 exec, -1
    v_and_b32 v50, 255, v18
    v_subrev_u32 v50, s54, v50
    v_cmp_gt_u32 s[68:69], 64, v50
    v_lshl_add_u32 v60, v50, 2, s53
    s_mov_b64 exec, s[68:69]
    ds_add_rtn_u32 v55, v60, v58
    s_mov_b64 exec, -1
    v_and_b32 v51, 255, v19
    v_subrev_u32 v51, s54, v51
    v_cmp_gt_u32 s[70:71], 64, v51
    v_lshl_add_u32 v60, v51, 2, s53
    s_mov_b64 exec, s[70:71]
    ds_add_rtn_u32 v56, v60, v58
    s_mov_b64 exec, -1
    v_and_b32 v52, 255, v20
    v_subrev_u32 v52, s54, v52
    v_cmp_gt_u32 s[72:73], 64, v52
    v_lshl_add_u32 v60, v52, 2, s53
    s_and_b64 s[72:73], s[72:73], s[50:51]
    s_mov_b64 exec, s[72:73]
    ds_add_rtn_u32 v57, v60, v58
    s_mov_b64 exec, -1
    s_waitcnt vmcnt(7)
    v_readfirstlane_b32 s48, v42
    buffer_load_dwordx4 v[156:159], v79, s[20:23], 0 offen
    v_add_u32 v79, 262144, v79
    buffer_load_dwordx4 v[156:159], v79, s[20:23], 0 offen
    v_add_u32 v79, 262144, v79
    buffer_load_dwordx4 v[156:159], v79, s[20:23], 0 offen
    v_add_u32 v79, 262144, v79
    v_bfe_u32 v16, v16, 8, 6
    v_min_u32 v16, 47, v16
    v_min_u32 v24, 9999, v24
    v_lshl_or_b32 v16, v24, 6, v16
    v_add_u32 v24, 0, v43
    v_or_b32 v16, v16, v24
    v_lshlrev_b32 v48, 7, v48
    v_bfe_u32 v17, v17, 8, 6
    v_min_u32 v17, 47, v17
    v_min_u32 v25, 9999, v25
    v_lshl_or_b32 v17, v25, 6, v17
    v_add_u32 v25, 1048576, v43
    v_or_b32 v17, v17, v25
    v_lshlrev_b32 v49, 7, v49
    v_bfe_u32 v18, v18, 8, 6
    v_min_u32 v18, 47, v18
    v_min_u32 v26, 9999, v26
    v_lshl_or_b32 v18, v26, 6, v18
    v_add_u32 v26, 2097152, v43
    v_or_b32 v18, v18, v26
    v_lshlrev_b32 v50, 7, v50
    v_bfe_u32 v19, v19, 8, 6
    v_min_u32 v19, 47, v19
    v_min_u32 v27, 9999, v27
    v_lshl_or_b32 v19, v27, 6, v19
    v_add_u32 v27, 3145728, v43
    v_or_b32 v19, v19, v27
    v_lshlrev_b32 v51, 7, v51
    v_bfe_u32 v20, v20, 8, 6
    v_min_u32 v20, 47, v20
    v_min_u32 v28, 9999, v28
    v_lshl_or_b32 v20, v28, 6, v20
    v_add_u32 v28, 2147483648, v59
    v_or_b32 v20, v20, v28
    v_lshlrev_b32 v52, 7, v52
    v_mov_b32 v59, -2
    s_add_u32 s48, s48, 1
    s_movk_i32 s53, 7808
    s_waitcnt lgkmcnt(0)
    v_cmp_gt_u32 vcc, 31, v53
    v_min_u32 v53, 31, v53
    v_mul_u32_u24 v32, 43, v53
    v_cndmask_b32 v16, v59, v16, vcc
    v_lshrrev_b32 v32, 7, v32
    v_cmp_gt_u32 vcc, 24, v53
    v_add_lshl_u32 v32, v32, v53, 2
    v_lshl_add_u32 v33, v53, 4, s53
    v_cndmask_b32 v32, v33, v32, vcc
    v_add_u32 v48, v48, v32
    s_mov_b64 exec, s[64:65]
    ds_write_b32 v48, v16 offset:0
    s_mov_b64 exec, -1
    v_cmp_gt_u32 vcc, 31, v54
    v_min_u32 v54, 31, v54
    v_mul_u32_u24 v32, 43, v54
    v_cndmask_b32 v17, v59, v17, vcc
    v_lshrrev_b32 v32, 7, v32
    v_cmp_gt_u32 vcc, 24, v54
    v_add_lshl_u32 v32, v32, v54, 2
    v_lshl_add_u32 v33, v54, 4, s53
    v_cndmask_b32 v32, v33, v32, vcc
    v_add_u32 v49, v49, v32
    s_mov_b64 exec, s[66:67]
    ds_write_b32 v49, v17 offset:0
    s_mov_b64 exec, -1
    v_cmp_gt_u32 vcc, 31, v55
    v_min_u32 v55, 31, v55
    v_mul_u32_u24 v32, 43, v55
    v_cndmask_b32 v18, v59, v18, vcc
    v_lshrrev_b32 v32, 7, v32
    v_cmp_gt_u32 vcc, 24, v55
    v_add_lshl_u32 v32, v32, v55, 2
    v_lshl_add_u32 v33, v55, 4, s53
    v_cndmask_b32 v32, v33, v32, vcc
    v_add_u32 v50, v50, v32
    s_mov_b64 exec, s[68:69]
    ds_write_b32 v50, v18 offset:0
    s_mov_b64 exec, -1
    v_cmp_gt_u32 vcc, 31, v56
    v_min_u32 v56, 31, v56
    v_mul_u32_u24 v32, 43, v56
    v_cndmask_b32 v19, v59, v19, vcc
    v_lshrrev_b32 v32, 7, v32
    v_cmp_gt_u32 vcc, 24, v56
    v_add_lshl_u32 v32, v32, v56, 2
    v_lshl_add_u32 v33, v56, 4, s53
    v_cndmask_b32 v32, v33, v32, vcc
    v_add_u32 v51, v51, v32
    s_mov_b64 exec, s[70:71]
    ds_write_b32 v51, v19 offset:0
    s_mov_b64 exec, -1
    v_cmp_gt_u32 vcc, 31, v57
    v_min_u32 v57, 31, v57
    v_mul_u32_u24 v32, 43, v57
    v_cndmask_b32 v20, v59, v20, vcc
    v_lshrrev_b32 v32, 7, v32
    v_cmp_gt_u32 vcc, 24, v57
    v_add_lshl_u32 v32, v32, v57, 2
    v_lshl_add_u32 v33, v57, 4, s53
    v_cndmask_b32 v32, v33, v32, vcc
    v_add_u32 v52, v52, v32
    s_mov_b64 exec, s[72:73]
    ds_write_b32 v52, v20 offset:0
    s_mov_b64 exec, -1
    s_waitcnt lgkmcnt(0)
    s_barrier
    ds_read_b128 v[16:19], v61 offset:0
    ds_read_b32 v67, v67
    s_waitcnt lgkmcnt(1)
    v_mov_b32 v19, s48
    buffer_store_dwordx4 v[16:19], v64, s[32:35], 0 offen sc1
    s_waitcnt lgkmcnt(0)
    v_cmp_lt_u32 vcc, 23, v67
    s_cbranch_vccz L_noup
    ds_read_b128 v[28:31], v61 offset:8192
    s_waitcnt lgkmcnt(0)
    v_mov_b32 v31, s48
    s_mov_b64 exec, vcc
    buffer_store_dwordx4 v[28:31], v65, s[32:35], 0 offen sc1
    s_mov_b64 exec, -1
L_noup:
    s_cmp_ge_u32 s3, 2
    s_cbranch_scc1 L_nowf
    s_lshl1_add_u32 s44, s55, s3
    s_and_b32 s53, s44, 15
    s_lshl_b32 s53, s53, 13
    s_lshr_b32 s76, s44, 4
    s_lshl_b32 s76, s76, 6
    s_add_u32 s53, s53, s76
    v_lshrrev_b32 v60, 5, v1
    v_lshlrev_b32 v60, 12, v60
    v_and_b32 v61, 31, v1
    v_lshl_add_u32 v60, v61, 1, v60
    v_add_u32 v60, s53, v60
    buffer_load_ushort v32, v60, s[88:91], 0 offen offset:0
    buffer_load_ushort v33, v60, s[88:91], 0 offen offset:512
    buffer_load_ushort v34, v60, s[88:91], 0 offen offset:1024
    buffer_load_ushort v35, v60, s[88:91], 0 offen offset:1536
    buffer_load_ushort v36, v60, s[88:91], 0 offen offset:2048
    buffer_load_ushort v37, v60, s[88:91], 0 offen offset:2560
    buffer_load_ushort v38, v60, s[88:91], 0 offen offset:3072
    buffer_load_ushort v39, v60, s[88:91], 0 offen offset:3584
L_nowf:
    v_lshrrev_b32 v60, 5, v1
    v_bfe_u32 v61, v1, 2, 2
    v_bfe_u32 v62, v1, 4, 1
    v_and_b32 v63, 3, v1
    v_lshlrev_b32 v77, 7, v62
    v_lshl_add_u32 v77, v61, 5, v77
    v_lshl_add_u32 v77, v60, 9, v77
    v_lshl_add_u32 v77, v63, 3, v77
    s_mul_i32 s53, s2, 8320
    s_add_u32 s53, s53, 8388608
    v_lshl_add_u32 v70, v0, 4, s53
    s_lshl_b32 s53, s2, 13
    s_add_u32 s53, s53, 16777216
    v_lshl_add_u32 v71, v0, 4, s53
    v_mul_u32_u24 v73, 2500, v68
    s_cmp_ge_u32 s2, 16
    s_cbranch_scc1 L_2
    s_mov_b32 s100, 662282944
    s_mov_b32 s74, 0
    s_mov_b32 s75, 0
    s_cmp_eq_u32 s3, 1
    s_cmov_b32 s100, 577856449
    s_cmov_b32 s74, 1140852737
    s_cmov_b32 s75, 128
    s_cmp_eq_u32 s3, 2
    s_cmov_b32 s100, 543503171
    s_cmov_b32 s74, 1413515267
    s_cmov_b32 s75, 132
    s_cmp_eq_u32 s3, 3
    s_cmov_b32 s100, 612176386
    s_cmov_b32 s74, 1447602187
    s_cmov_b32 s75, 133
    s_cmp_eq_u32 s3, 4
    s_cmov_b32 s100, 561324933
    s_cmov_b32 s74, 3595217167
    s_cmov_b32 s75, 149
    s_cmp_eq_u32 s3, 5
    s_cmov_b32 s100, 594367236
    s_cmov_b32 s74, 4132366639
    s_cmov_b32 s75, 151
    s_cmp_eq_u32 s3, 6
    s_cmov_b32 s100, 626868807
    s_cmov_b32 s74, 4268685631
    s_cmov_b32 s75, 159
    s_cmp_eq_u32 s3, 7
    s_cmov_b32 s100, 643891846
    s_cmov_b32 s74, 4278123455
    s_cmov_b32 s75, 191
    s_branch L_1
L_2:
    s_mov_b32 s100, 645498048
    s_mov_b32 s74, 0
    s_mov_b32 s75, 0
    s_cmp_eq_u32 s3, 1
    s_cmov_b32 s100, 561844995
    s_cmov_b32 s74, 1091043329
    s_cmov_b32 s75, 64
    s_cmp_eq_u32 s3, 2
    s_cmov_b32 s100, 594862662
    s_cmov_b32 s74, 3238662153
    s_cmov_b32 s75, 66
    s_cmp_eq_u32 s3, 3
    s_cmov_b32 s100, 543769412
    s_cmov_b32 s74, 3775550025
    s_cmov_b32 s75, 74
    s_cmp_eq_u32 s3, 4
    s_cmov_b32 s100, 611415042
    s_cmov_b32 s74, 3843715673
    s_cmov_b32 s75, 75
    s_cmp_eq_u32 s3, 5
    s_cmov_b32 s100, 577590213
    s_cmov_b32 s74, 4120605277
    s_cmov_b32 s75, 91
    s_cmp_eq_u32 s3, 6
    s_cmov_b32 s100, 627385031
    s_cmov_b32 s74, 4256952957
    s_cmov_b32 s75, 95
    s_cmp_eq_u32 s3, 7
    s_cmov_b32 s100, 660120065
    s_cmov_b32 s74, 4290771709
    s_cmov_b32 s75, 127
L_1:
    v_mov_b64 v[80:81], 0
    v_mov_b64 v[82:83], 0
    v_mov_b64 v[84:85], 0
    v_mov_b64 v[86:87], 0
    v_mov_b64 v[88:89], 0
    v_mov_b64 v[90:91], 0
    v_mov_b64 v[92:93], 0
    v_mov_b64 v[94:95], 0
    v_mov_b64 v[96:97], 0
    v_mov_b64 v[98:99], 0
    v_mov_b64 v[100:101], 0
    v_mov_b64 v[102:103], 0
    v_mov_b64 v[104:105], 0
    v_mov_b64 v[106:107], 0
    v_mov_b64 v[108:109], 0
    v_mov_b64 v[110:111], 0
    v_mov_b64 v[112:113], 0
    v_mov_b64 v[114:115], 0
    v_mov_b64 v[116:117], 0
    v_mov_b64 v[118:119], 0
    v_mov_b64 v[120:121], 0
    v_mov_b64 v[122:123], 0
    v_mov_b64 v[124:125], 0
    v_mov_b64 v[126:127], 0
    v_mov_b64 v[128:129], 0
    v_mov_b64 v[130:131], 0
    v_mov_b64 v[132:133], 0
    v_mov_b64 v[134:135], 0
    v_mov_b64 v[136:137], 0
    v_mov_b64 v[138:139], 0
    v_mov_b64 v[140:141], 0
    v_mov_b64 v[142:143], 0
    v_mov_b64 v[144:145], 0
    v_mov_b64 v[146:147], 0
    v_mov_b64 v[148:149], 0
    v_mov_b64 v[150:151], 0
    v_mov_b64 v[152:153], 0
    v_mov_b64 v[154:155], 0
    s_mov_b64 s[6:7], -1
    s_mov_b32 s55, 0
    s_waitcnt vmcnt(0)
L_poll:
    s_mov_b64 exec, s[6:7]
    buffer_load_dwordx4 v[48:51], v70, s[32:35], 0 offen sc1
    s_mov_b64 exec, -1
    s_waitcnt vmcnt(0)
    v_cmp_ne_u32 s[6:7], s48, v51
    s_cmp_eq_u64 s[6:7], 0
    s_cbranch_scc1 L_got
    s_sleep 4
    s_add_u32 s55, s55, 1
    s_cmp_lt_u32 s55, 0x400000
    s_cbranch_scc1 L_poll
    s_endpgm
L_got:
    v_cmp_gt_u32 s[36:37], -2, v48
    v_cmp_gt_u32 s[38:39], -2, v49
    v_cmp_gt_u32 s[40:41], -2, v50
    v_mov_b32 v52, -1
    s_mov_b64 s[42:43], 0
    s_mov_b32 s53, 0x80808080
    s_and_b32 s6, s40, s53
    s_and_b32 s7, s41, s53
    s_cmp_eq_u64 s[6:7], 0
    s_cbranch_scc1 L_noext
    s_lshr_b64 s[6:7], s[6:7], 7
    s_mul_i32 s6, s6, 255
    s_mul_i32 s7, s7, 255
    v_mov_b32 v55, s48
L_poll2:
    s_mov_b64 exec, s[6:7]
    buffer_load_dwordx4 v[52:55], v71, s[32:35], 0 offen sc1
    s_mov_b64 exec, -1
    s_waitcnt vmcnt(0)
    v_cmp_ne_u32 vcc, s48, v55
    s_cbranch_vccz L_got2
    s_sleep 1
    s_add_u32 s55, s55, 1
    s_cmp_lt_u32 s55, 0x400000
    s_cbranch_scc1 L_poll2
    s_endpgm
L_got2:
    v_cmp_gt_u32 s[42:43], -2, v52
L_noext:
    v_cmp_eq_u32 vcc, -2, v52
    s_bcnt1_i32_b64 s64, s[36:37]
    s_bcnt1_i32_b64 s65, s[38:39]
    s_bcnt1_i32_b64 s66, s[40:41]
    s_bcnt1_i32_b64 s67, s[42:43]
    s_add_u32 s65, s65, s64
    s_add_u32 s66, s66, s65
    s_add_u32 s79, s67, s66
    v_mov_b32 v61, s79
    v_mov_b32 v60, 114912
    s_mov_b64 exec, 1
    ds_add_rtn_u32 v61, v60, v61
    s_mov_b64 exec, -1
    v_mbcnt_lo_u32_b32 v62, s36, 0
    v_mbcnt_hi_u32_b32 v62, s37, v62
    v_lshrrev_b32 v20, 20, v48
    v_add_u32 v20, v20, v73
    v_lshl_add_u32 v66, v62, 2, s49
    s_mov_b64 exec, s[36:37]
    ds_write_b32 v66, v20
    s_mov_b64 exec, -1
    v_lshlrev_b32 v24, 2, v48
    v_and_b32 v24, s82, v24
    v_and_b32 v16, 63, v48
    v_mbcnt_lo_u32_b32 v63, s38, 0
    v_mbcnt_hi_u32_b32 v63, s39, v63
    v_add_u32 v63, s64, v63
    v_lshrrev_b32 v21, 20, v49
    v_add_u32 v21, v21, v73
    v_lshl_add_u32 v66, v63, 2, s49
    s_mov_b64 exec, s[38:39]
    ds_write_b32 v66, v21
    s_mov_b64 exec, -1
    v_lshlrev_b32 v25, 2, v49
    v_and_b32 v25, s82, v25
    v_and_b32 v17, 63, v49
    v_mbcnt_lo_u32_b32 v64, s40, 0
    v_mbcnt_hi_u32_b32 v64, s41, v64
    v_add_u32 v64, s65, v64
    v_lshrrev_b32 v22, 20, v50
    v_add_u32 v22, v22, v73
    v_lshl_add_u32 v66, v64, 2, s49
    s_mov_b64 exec, s[40:41]
    ds_write_b32 v66, v22
    s_mov_b64 exec, -1
    v_lshlrev_b32 v26, 2, v50
    v_and_b32 v26, s82, v26
    v_and_b32 v18, 63, v50
    v_mbcnt_lo_u32_b32 v65, s42, 0
    v_mbcnt_hi_u32_b32 v65, s43, v65
    v_add_u32 v65, s66, v65
    v_lshrrev_b32 v23, 20, v52
    v_add_u32 v23, v23, v73
    v_lshl_add_u32 v66, v65, 2, s49
    s_mov_b64 exec, s[42:43]
    ds_write_b32 v66, v23
    s_mov_b64 exec, -1
    v_lshlrev_b32 v27, 2, v52
    v_and_b32 v27, s82, v27
    v_and_b32 v19, 63, v52
    v_lshl_or_b32 v14, v45, 16, v44
    v_lshl_or_b32 v15, v47, 16, v46
    v_mov_b64 v[156:157], 0
    v_mov_b64 v[158:159], 0
    s_cmp_ge_u32 s3, 2
    s_cbranch_scc1 L_4
    v_lshl_or_b32 v56, v33, 16, v32
    v_lshl_or_b32 v57, v35, 16, v34
    v_lshl_or_b32 v58, v37, 16, v36
    v_lshl_or_b32 v59, v39, 16, v38
    s_lshl_b32 s53, s54, 1
    s_add_u32 s53, s53, s44
    s_lshl2_add_u32 s83, s53, 4096
    s_lshl_b32 s53, s53, 10
    s_add_u32 s53, s53, 1048576
    v_lshl_add_u32 v60, v1, 4, s53
    buffer_store_dwordx4 v[56:59], v60, s[32:35], 0 offen sc1
L_4:
    s_mov_b32 s80, 79
    s_waitcnt lgkmcnt(0)
    v_readfirstlane_b32 s44, v61
    s_cbranch_vccnz L_defer
    s_add_u32 s53, s44, s79
    s_cmp_gt_u32 s53, 1024
    s_cbranch_scc1 L_defer
    v_add_u32 v62, s44, v62
    v_lshl_or_b32 v24, v62, 22, v24
    v_add_u32 v63, s44, v63
    v_lshl_or_b32 v25, v63, 22, v25
    v_add_u32 v64, s44, v64
    v_lshl_or_b32 v26, v64, 22, v26
    v_add_u32 v65, s44, v65
    v_lshl_or_b32 v27, v65, 22, v27
    s_branch L_have
L_defer:
    s_mov_b32 s80, 0
    s_mov_b32 s79, 0
    s_mov_b32 s44, 0
    s_mov_b64 s[36:37], 0
    s_mov_b64 s[38:39], 0
    s_mov_b64 s[40:41], 0
    s_mov_b64 s[42:43], 0
    v_mov_b32 v58, 1
    v_mov_b32 v59, 110864
    ds_write_b32 v59, v58
    s_branch L_have
L_scan:
    s_barrier
    s_mov_b32 s64, s63
    s_add_u32 s65, s63, 1024
    s_xor_b32 s47, s2, 1
L_sloop:
    s_cmp_ge_u32 s80, 79
    s_cbranch_scc1 L_scan_done
    s_mul_i32 s53, s3, 20000
    s_lshl_b32 s54, s80, 8
    s_add_u32 s55, s53, s54
    v_lshlrev_b32 v56, 2, v1
    v_add_u32 v56, s55, v56
    v_lshlrev_b32 v57, 2, v56
    buffer_load_dwordx4 v[60:63], v57, s[16:19], 0 offen
    s_waitcnt vmcnt(0)
    s_cmp_lg_u32 s80, 78
    s_cbranch_scc1 L_snotlast
    s_mov_b32 exec_lo, 0xffffff00
    v_mov_b32 v60, s47
    v_mov_b32 v61, s47
    v_mov_b32 v62, s47
    v_mov_b32 v63, s47
    s_mov_b64 exec, -1
L_snotlast:
    s_cmp_gt_u32 s52, 0
    s_cbranch_scc1 L_5
    v_cmp_eq_u32_sdwa vcc, v60, s2 src0_sel:BYTE_0 src1_sel:DWORD
    s_cbranch_vccz L_5
    s_bcnt1_i32_b64 s53, vcc
    s_lshl3_add_u32 s54, s53, s64
    s_mov_b32 s52, 0
    s_cmp_gt_u32 s54, s65
    s_cbranch_scc1 L_ovf
    v_mbcnt_lo_u32_b32 v58, vcc_lo, 0
    v_mbcnt_hi_u32_b32 v58, vcc_hi, v58
    v_lshl_add_u32 v58, v58, 3, s64
    v_add_u32 v59, 0, v56
    s_mov_b64 exec, vcc
    ds_write2_b32 v58, v60, v59 offset0:0 offset1:1
    s_mov_b64 exec, -1
    s_mov_b32 s64, s54
L_5:
    s_cmp_gt_u32 s52, 1
    s_cbranch_scc1 L_6
    v_cmp_eq_u32_sdwa vcc, v61, s2 src0_sel:BYTE_0 src1_sel:DWORD
    s_cbranch_vccz L_6
    s_bcnt1_i32_b64 s53, vcc
    s_lshl3_add_u32 s54, s53, s64
    s_mov_b32 s52, 1
    s_cmp_gt_u32 s54, s65
    s_cbranch_scc1 L_ovf
    v_mbcnt_lo_u32_b32 v58, vcc_lo, 0
    v_mbcnt_hi_u32_b32 v58, vcc_hi, v58
    v_lshl_add_u32 v58, v58, 3, s64
    v_add_u32 v59, 1, v56
    s_mov_b64 exec, vcc
    ds_write2_b32 v58, v61, v59 offset0:0 offset1:1
    s_mov_b64 exec, -1
    s_mov_b32 s64, s54
L_6:
    s_cmp_gt_u32 s52, 2
    s_cbranch_scc1 L_7
    v_cmp_eq_u32_sdwa vcc, v62, s2 src0_sel:BYTE_0 src1_sel:DWORD
    s_cbranch_vccz L_7
    s_bcnt1_i32_b64 s53, vcc
    s_lshl3_add_u32 s54, s53, s64
    s_mov_b32 s52, 2
    s_cmp_gt_u32 s54, s65
    s_cbranch_scc1 L_ovf
    v_mbcnt_lo_u32_b32 v58, vcc_lo, 0
    v_mbcnt_hi_u32_b32 v58, vcc_hi, v58
    v_lshl_add_u32 v58, v58, 3, s64
    v_add_u32 v59, 2, v56
    s_mov_b64 exec, vcc
    ds_write2_b32 v58, v62, v59 offset0:0 offset1:1
    s_mov_b64 exec, -1
    s_mov_b32 s64, s54
L_7:
    s_cmp_gt_u32 s52, 3
    s_cbranch_scc1 L_8
    v_cmp_eq_u32_sdwa vcc, v63, s2 src0_sel:BYTE_0 src1_sel:DWORD
    s_cbranch_vccz L_8
    s_bcnt1_i32_b64 s53, vcc
    s_lshl3_add_u32 s54, s53, s64
    s_mov_b32 s52, 3
    s_cmp_gt_u32 s54, s65
    s_cbranch_scc1 L_ovf
    v_mbcnt_lo_u32_b32 v58, vcc_lo, 0
    v_mbcnt_hi_u32_b32 v58, vcc_hi, v58
    v_lshl_add_u32 v58, v58, 3, s64
    v_add_u32 v59, 3, v56
    s_mov_b64 exec, vcc
    ds_write2_b32 v58, v63, v59 offset0:0 offset1:1
    s_mov_b64 exec, -1
    s_mov_b32 s64, s54
L_8:
    s_mov_b32 s52, 0
    s_add_u32 s80, s80, 1
    s_branch L_sloop
L_ovf:
    v_mov_b32 v58, 1
    v_mov_b32 v59, 110864
    ds_write_b32 v59, v58
L_scan_done:
    s_sub_u32 s79, s64, s63
    s_lshr_b32 s79, s79, 3
    s_lshl_b32 s44, s3, 7
    v_lshlrev_b32 v58, 3, v1
    v_add_u32 v58, s63, v58
    s_waitcnt lgkmcnt(0)
    ds_read_b32 v16, v58 offset:0
    ds_read_b32 v20, v58 offset:4
    s_sub_u32 s53, s79, 0
    v_cmp_gt_i32 s[36:37], s53, v1
    ds_read_b32 v17, v58 offset:512
    ds_read_b32 v21, v58 offset:516
    s_sub_u32 s53, s79, 64
    v_cmp_gt_i32 s[38:39], s53, v1
    s_mov_b64 s[40:41], 0
    v_mov_b32 v18, 0
    v_mov_b32 v26, 0
    s_mov_b64 s[42:43], 0
    v_mov_b32 v19, 0
    v_mov_b32 v27, 0
    v_lshl_add_u32 v58, v1, 2, s49
    v_add_u32 v59, s44, v1
    v_lshlrev_b32 v59, 22, v59
    s_waitcnt lgkmcnt(0)
    v_lshlrev_b32 v28, 2, v20
    buffer_load_dword v24, v28, s[12:15], 0 offen
    v_bfe_u32 v16, v16, 8, 6
    v_min_u32 v16, 47, v16
    ds_write_b32 v58, v20 offset:0
    v_lshlrev_b32 v29, 2, v21
    buffer_load_dword v25, v29, s[12:15], 0 offen
    v_bfe_u32 v17, v17, 8, 6
    v_min_u32 v17, 47, v17
    ds_write_b32 v58, v21 offset:256
    s_waitcnt vmcnt(0)
    v_min_u32 v24, 9999, v24
    v_lshl_or_b32 v24, v24, 8, v59
    v_add_u32 v59, 268435456, v59
    v_min_u32 v25, 9999, v25
    v_lshl_or_b32 v25, v25, 8, v59
    v_add_u32 v59, 268435456, v59
L_have:
    v_mov_b32 v58, 1
    s_mov_b32 s53, 111136
    s_mov_b32 s54, 114976
    v_bfe_u32 v28, v24, 8, 14
    v_mul_u32_u24 v28, 6711, v28
    v_lshrrev_b32 v28, 22, v28
    v_min_u32 v28, 15, v28
    v_lshl_add_u32 v28, v28, 2, s53
    v_lshl_add_u32 v28, v16, 6, v28
    v_lshl_add_u32 v16, v16, 2, s54
    s_mov_b64 exec, s[36:37]
    ds_add_rtn_u32 v32, v28, v58
    ds_add_u32 v16, v58
    s_mov_b64 exec, -1
    v_bfe_u32 v29, v25, 8, 14
    v_mul_u32_u24 v29, 6711, v29
    v_lshrrev_b32 v29, 22, v29
    v_min_u32 v29, 15, v29
    v_lshl_add_u32 v29, v29, 2, s53
    v_lshl_add_u32 v29, v17, 6, v29
    v_lshl_add_u32 v17, v17, 2, s54
    s_mov_b64 exec, s[38:39]
    ds_add_rtn_u32 v33, v29, v58
    ds_add_u32 v17, v58
    s_mov_b64 exec, -1
    v_bfe_u32 v30, v26, 8, 14
    v_mul_u32_u24 v30, 6711, v30
    v_lshrrev_b32 v30, 22, v30
    v_min_u32 v30, 15, v30
    v_lshl_add_u32 v30, v30, 2, s53
    v_lshl_add_u32 v30, v18, 6, v30
    v_lshl_add_u32 v18, v18, 2, s54
    s_mov_b64 exec, s[40:41]
    ds_add_rtn_u32 v34, v30, v58
    ds_add_u32 v18, v58
    s_mov_b64 exec, -1
    v_bfe_u32 v31, v27, 8, 14
    v_mul_u32_u24 v31, 6711, v31
    v_lshrrev_b32 v31, 22, v31
    v_min_u32 v31, 15, v31
    v_lshl_add_u32 v31, v31, 2, s53
    v_lshl_add_u32 v31, v19, 6, v31
    v_lshl_add_u32 v19, v19, 2, s54
    s_mov_b64 exec, s[42:43]
    ds_add_rtn_u32 v35, v31, v58
    ds_add_u32 v19, v58
    s_mov_b64 exec, -1
    v_lshrrev_b32 v36, 1, v1
    v_lshl_add_u32 v39, v36, 2, s49
    ds_read_b32 v40, v39 offset:0
    ds_read_b32 v41, v39 offset:128
    ds_read_b32 v42, v39 offset:256
    ds_read_b32 v43, v39 offset:384
    v_and_b32 v38, 1, v1
    v_lshlrev_b32 v37, 4, v38
    v_lshlrev_b32 v38, 2, v38
    s_mov_b32 s46, s79
    s_mov_b32 s45, s44
    v_lshl_add_u32 v56, v1, 2, s54
    v_mov_b32 v57, 110864
    s_waitcnt lgkmcnt(0)
    s_cmp_le_i32 s46, 0
    s_cbranch_scc1 L_9
    v_lshl_add_u32 v44, v40, 5, v37
    v_lshl_add_u32 v45, v40, 3, v38
    v_cmp_gt_i32 vcc, s46, v36
    s_lshl_b32 s76, s45, 5
    s_add_u32 m0, s76, 65536
    s_mov_b64 exec, vcc
    buffer_load_dwordx4 v44, s[24:27], 0 offen lds
    s_lshl3_add_u32 m0, s45, 98304
    s_add_u32 s45, s45, 32
    buffer_load_dword v45, s[20:23], 0 offen lds
    s_mov_b64 exec, -1
    s_sub_i32 s46, s46, 32
L_9:
    s_barrier
    ds_read_b32 v56, v56
    ds_read_b32 v57, v57
    s_cmp_le_i32 s46, 0
    s_cbranch_scc1 L_10
    v_lshl_add_u32 v44, v41, 5, v37
    v_lshl_add_u32 v45, v41, 3, v38
    v_cmp_gt_i32 vcc, s46, v36
    s_lshl_b32 s76, s45, 5
    s_add_u32 m0, s76, 65536
    s_mov_b64 exec, vcc
    buffer_load_dwordx4 v44, s[24:27], 0 offen lds
    s_lshl3_add_u32 m0, s45, 98304
    s_add_u32 s45, s45, 32
    buffer_load_dword v45, s[20:23], 0 offen lds
    s_mov_b64 exec, -1
    s_sub_i32 s46, s46, 32
L_10:
    s_waitcnt lgkmcnt(0)
    v_readfirstlane_b32 s78, v57
    s_cmp_lg_u32 s77, 0
    s_cbranch_scc1 L_assigned
    ds_read_b64_tr_b16 a[0:1], v77 offset:32768
    ds_read_b64_tr_b16 a[2:3], v77 offset:33024
    ds_read_b64_tr_b16 a[4:5], v77 offset:33792
    ds_read_b64_tr_b16 a[6:7], v77 offset:34048
    ds_read_b64_tr_b16 a[8:9], v77 offset:34816
    ds_read_b64_tr_b16 a[10:11], v77 offset:35072
    ds_read_b64_tr_b16 a[12:13], v77 offset:35840
    ds_read_b64_tr_b16 a[14:15], v77 offset:36096
    ds_read_b64_tr_b16 a[16:17], v77 offset:36864
    ds_read_b64_tr_b16 a[18:19], v77 offset:37120
    ds_read_b64_tr_b16 a[20:21], v77 offset:37888
    ds_read_b64_tr_b16 a[22:23], v77 offset:38144
    ds_read_b64_tr_b16 a[24:25], v77 offset:38912
    ds_read_b64_tr_b16 a[26:27], v77 offset:39168
    ds_read_b64_tr_b16 a[28:29], v77 offset:39936
    ds_read_b64_tr_b16 a[30:31], v77 offset:40192
    s_and_b32 s53, s2, 63
    s_or_b32 s53, s53, s3
    s_cbranch_scc1 L_11
    s_lshl_b32 s53, s2, 1
    v_mov_b32 v60, s53
    v_mov_b32 v61, s48
    s_mov_b64 exec, 1
    buffer_store_dword v61, v60, s[32:35], 0 offen sc1
    s_mov_b64 exec, -1
L_11:
    v_sub_u32 v57, 63, v1
    v_lshl_add_u32 v57, v56, 6, v57
    v_mov_b32 v59, 0
    v_readlane_b32 s84, v57, 0
    v_readlane_b32 s85, v57, 1
    v_readlane_b32 s86, v57, 2
    v_readlane_b32 s87, v57, 3
    v_readlane_b32 s88, v57, 4
    v_readlane_b32 s89, v57, 5
    v_readlane_b32 s90, v57, 6
    v_readlane_b32 s91, v57, 7
    v_readlane_b32 s92, v57, 8
    v_readlane_b32 s93, v57, 9
    v_readlane_b32 s94, v57, 10
    v_readlane_b32 s95, v57, 11
    v_readlane_b32 s96, v57, 12
    v_readlane_b32 s97, v57, 13
    v_readlane_b32 s98, v57, 14
    v_readlane_b32 s99, v57, 15
    v_cmp_gt_u32 vcc, s84, v57
    v_cmp_gt_u32 s[4:5], s85, v57
    v_cmp_gt_u32 s[6:7], s86, v57
    v_addc_co_u32 v59, vcc, 0, v59, vcc
    v_addc_co_u32 v59, s[4:5], 0, v59, s[4:5]
    v_addc_co_u32 v59, s[6:7], 0, v59, s[6:7]
    v_cmp_gt_u32 vcc, s87, v57
    v_cmp_gt_u32 s[4:5], s88, v57
    v_cmp_gt_u32 s[6:7], s89, v57
    v_addc_co_u32 v59, vcc, 0, v59, vcc
    v_addc_co_u32 v59, s[4:5], 0, v59, s[4:5]
    v_addc_co_u32 v59, s[6:7], 0, v59, s[6:7]
    v_cmp_gt_u32 vcc, s90, v57
    v_cmp_gt_u32 s[4:5], s91, v57
    v_cmp_gt_u32 s[6:7], s92, v57
    v_addc_co_u32 v59, vcc, 0, v59, vcc
    v_addc_co_u32 v59, s[4:5], 0, v59, s[4:5]
    v_addc_co_u32 v59, s[6:7], 0, v59, s[6:7]
    v_cmp_gt_u32 vcc, s93, v57
    v_cmp_gt_u32 s[4:5], s94, v57
    v_cmp_gt_u32 s[6:7], s95, v57
    v_addc_co_u32 v59, vcc, 0, v59, vcc
    v_addc_co_u32 v59, s[4:5], 0, v59, s[4:5]
    v_addc_co_u32 v59, s[6:7], 0, v59, s[6:7]
    v_cmp_gt_u32 vcc, s96, v57
    v_cmp_gt_u32 s[4:5], s97, v57
    v_cmp_gt_u32 s[6:7], s98, v57
    v_addc_co_u32 v59, vcc, 0, v59, vcc
    v_addc_co_u32 v59, s[4:5], 0, v59, s[4:5]
    v_addc_co_u32 v59, s[6:7], 0, v59, s[6:7]
    v_cmp_gt_u32 vcc, s99, v57
    s_nop 1
    v_addc_co_u32 v59, vcc, 0, v59, vcc
    v_readlane_b32 s84, v57, 16
    v_readlane_b32 s85, v57, 17
    v_readlane_b32 s86, v57, 18
    v_readlane_b32 s87, v57, 19
    v_readlane_b32 s88, v57, 20
    v_readlane_b32 s89, v57, 21
    v_readlane_b32 s90, v57, 22
    v_readlane_b32 s91, v57, 23
    v_readlane_b32 s92, v57, 24
    v_readlane_b32 s93, v57, 25
    v_readlane_b32 s94, v57, 26
    v_readlane_b32 s95, v57, 27
    v_readlane_b32 s96, v57, 28
    v_readlane_b32 s97, v57, 29
    v_readlane_b32 s98, v57, 30
    v_readlane_b32 s99, v57, 31
    v_cmp_gt_u32 vcc, s84, v57
    v_cmp_gt_u32 s[4:5], s85, v57
    v_cmp_gt_u32 s[6:7], s86, v57
    v_addc_co_u32 v59, vcc, 0, v59, vcc
    v_addc_co_u32 v59, s[4:5], 0, v59, s[4:5]
    v_addc_co_u32 v59, s[6:7], 0, v59, s[6:7]
    v_cmp_gt_u32 vcc, s87, v57
    v_cmp_gt_u32 s[4:5], s88, v57
    v_cmp_gt_u32 s[6:7], s89, v57
    v_addc_co_u32 v59, vcc, 0, v59, vcc
    v_addc_co_u32 v59, s[4:5], 0, v59, s[4:5]
    v_addc_co_u32 v59, s[6:7], 0, v59, s[6:7]
    v_cmp_gt_u32 vcc, s90, v57
    v_cmp_gt_u32 s[4:5], s91, v57
    v_cmp_gt_u32 s[6:7], s92, v57
    v_addc_co_u32 v59, vcc, 0, v59, vcc
    v_addc_co_u32 v59, s[4:5], 0, v59, s[4:5]
    v_addc_co_u32 v59, s[6:7], 0, v59, s[6:7]
    v_cmp_gt_u32 vcc, s93, v57
    v_cmp_gt_u32 s[4:5], s94, v57
    v_cmp_gt_u32 s[6:7], s95, v57
    v_addc_co_u32 v59, vcc, 0, v59, vcc
    v_addc_co_u32 v59, s[4:5], 0, v59, s[4:5]
    v_addc_co_u32 v59, s[6:7], 0, v59, s[6:7]
    v_cmp_gt_u32 vcc, s96, v57
    v_cmp_gt_u32 s[4:5], s97, v57
    v_cmp_gt_u32 s[6:7], s98, v57
    v_addc_co_u32 v59, vcc, 0, v59, vcc
    v_addc_co_u32 v59, s[4:5], 0, v59, s[4:5]
    v_addc_co_u32 v59, s[6:7], 0, v59, s[6:7]
    v_cmp_gt_u32 vcc, s99, v57
    s_nop 1
    v_addc_co_u32 v59, vcc, 0, v59, vcc
    v_readlane_b32 s84, v57, 32
    v_readlane_b32 s85, v57, 33
    v_readlane_b32 s86, v57, 34
    v_readlane_b32 s87, v57, 35
    v_readlane_b32 s88, v57, 36
    v_readlane_b32 s89, v57, 37
    v_readlane_b32 s90, v57, 38
    v_readlane_b32 s91, v57, 39
    v_cmp_gt_u32 vcc, s84, v57
    v_cmp_gt_u32 s[4:5], s85, v57
    v_cmp_gt_u32 s[6:7], s86, v57
    v_addc_co_u32 v59, vcc, 0, v59, vcc
    v_addc_co_u32 v59, s[4:5], 0, v59, s[4:5]
    v_addc_co_u32 v59, s[6:7], 0, v59, s[6:7]
    v_cmp_gt_u32 vcc, s87, v57
    v_cmp_gt_u32 s[4:5], s88, v57
    v_cmp_gt_u32 s[6:7], s89, v57
    v_addc_co_u32 v59, vcc, 0, v59, vcc
    v_addc_co_u32 v59, s[4:5], 0, v59, s[4:5]
    v_addc_co_u32 v59, s[6:7], 0, v59, s[6:7]
    v_cmp_gt_u32 vcc, s90, v57
    v_cmp_gt_u32 s[4:5], s91, v57
    s_nop 0
    v_addc_co_u32 v59, vcc, 0, v59, vcc
    v_addc_co_u32 v59, s[4:5], 0, v59, s[4:5]
    v_lshrrev_b64 v[60:61], v59, s[74:75]
    v_and_b32 v11, 1, v60
    s_bfe_u32 s54, s100, 393216
    v_cmp_eq_u32 vcc, s54, v59
    s_ff1_i32_b64 s56, vcc
    s_bfe_u32 s54, s100, 393222
    v_cmp_eq_u32 vcc, s54, v59
    s_ff1_i32_b64 s57, vcc
    s_bfe_u32 s54, s100, 393228
    v_cmp_eq_u32 vcc, s54, v59
    s_ff1_i32_b64 s58, vcc
    s_bfe_u32 s54, s100, 393234
    v_cmp_eq_u32 vcc, s54, v59
    s_ff1_i32_b64 s59, vcc
    s_bfe_u32 s54, s100, 393240
    v_cmp_eq_u32 vcc, s54, v59
    s_ff1_i32_b64 s60, vcc
L_assigned:
    v_mul_u32_u24 v60, v56, v11
    v_and_b32 v61, 15, v1
    v_lshlrev_b32 v61, 2, v61
    v_add_u32 v61, 111136, v61
    s_lshl_b32 s84, s56, 6
    v_add_u32 v64, s84, v61
    ds_read_b32 v70, v64
    s_lshl_b32 s85, s57, 6
    v_add_u32 v65, s85, v61
    ds_read_b32 v71, v65
    s_lshl_b32 s86, s58, 6
    v_add_u32 v66, s86, v61
    ds_read_b32 v72, v66
    s_lshl_b32 s87, s59, 6
    v_add_u32 v67, s87, v61
    ds_read_b32 v73, v67
    s_lshl_b32 s88, s60, 6
    v_add_u32 v68, s88, v61
    ds_read_b32 v74, v68
    v_add_u32_dpp v60, v60, v60 row_shr:1 row_mask:0xf bank_mask:0xf bound_ctrl:1
    v_readlane_b32 s92, v56, s56
    s_nop 0
    v_add_u32_dpp v60, v60, v60 row_shr:2 row_mask:0xf bank_mask:0xf bound_ctrl:1
    v_readlane_b32 s93, v56, s57
    s_nop 0
    v_add_u32_dpp v60, v60, v60 row_shr:4 row_mask:0xf bank_mask:0xf bound_ctrl:1
    v_readlane_b32 s94, v56, s58
    s_nop 0
    v_add_u32_dpp v60, v60, v60 row_shr:8 row_mask:0xf bank_mask:0xf bound_ctrl:1
    v_readlane_b32 s95, v56, s59
    s_nop 0
    v_readlane_b32 s96, v56, s60
    v_readlane_b32 s61, v60, 15
    v_readlane_b32 s53, v60, 31
    v_readlane_b32 s54, v60, 47
    s_add_u32 s62, s92, s93
    s_add_u32 s62, s62, s94
    s_add_u32 s62, s62, s95
    s_add_u32 s62, s62, s96
    s_add_u32 s61, s61, s53
    s_add_u32 s61, s61, s54
    s_add_u32 s61, s61, 3
    s_andn2_b32 s61, s61, 3
    s_lshl2_add_u32 s61, s3, s61
    s_waitcnt lgkmcnt(0)
    v_add3_u32 v60, v70, v71, v72
    v_add3_u32 v60, v60, v73, v74
    v_mov_b32 v61, v60
    s_nop 1
    v_add_u32_dpp v61, v61, v61 row_shr:1 row_mask:0xf bank_mask:0xf bound_ctrl:1
    s_nop 1
    v_add_u32_dpp v61, v61, v61 row_shr:2 row_mask:0xf bank_mask:0xf bound_ctrl:1
    s_nop 1
    v_add_u32_dpp v61, v61, v61 row_shr:4 row_mask:0xf bank_mask:0xf bound_ctrl:1
    s_nop 1
    v_add_u32_dpp v61, v61, v61 row_shr:8 row_mask:0xf bank_mask:0xf bound_ctrl:1
    v_sub_u32 v61, v61, v60
    v_add_u32 v61, s61, v61
    v_lshl_add_u32 v75, v61, 8, 0
    ds_write_b32 v64, v75 offset:4096
    v_add_u32 v61, v61, v70
    v_lshl_add_u32 v76, v61, 8, 16
    ds_write_b32 v65, v76 offset:4096
    v_add_u32 v61, v61, v71
    v_lshl_add_u32 v77, v61, 8, 32
    ds_write_b32 v66, v77 offset:4096
    v_add_u32 v61, v61, v72
    v_lshl_add_u32 v78, v61, 8, 48
    ds_write_b32 v67, v78 offset:4096
    v_add_u32 v61, v61, v73
    v_lshl_add_u32 v79, v61, 8, 64
    ds_write_b32 v68, v79 offset:4096
    s_cmp_le_i32 s46, 0
    s_cbranch_scc1 L_12
    v_lshl_add_u32 v44, v42, 5, v37
    v_lshl_add_u32 v45, v42, 3, v38
    v_cmp_gt_i32 vcc, s46, v36
    s_lshl_b32 s76, s45, 5
    s_add_u32 m0, s76, 65536
    s_mov_b64 exec, vcc
    buffer_load_dwordx4 v44, s[24:27], 0 offen lds
    s_lshl3_add_u32 m0, s45, 98304
    s_add_u32 s45, s45, 32
    buffer_load_dword v45, s[20:23], 0 offen lds
    s_mov_b64 exec, -1
    s_sub_i32 s46, s46, 32
L_12:
    s_waitcnt lgkmcnt(0)
    s_barrier
    ds_read_b32 v16, v28 offset:4096
    ds_read_b32 v17, v29 offset:4096
    ds_read_b32 v18, v30 offset:4096
    ds_read_b32 v19, v31 offset:4096
    v_mov_b32 v60, 0
    v_mov_b32 v61, 0
    v_lshlrev_b32 v64, 3, v0
    v_add_u32 v64, 111136, v64
    ds_write_b64 v64, v[60:61]
    v_mov_b32 v64, 110864
    ds_write_b32 v64, v60
    s_mov_b32 s53, 106496
    s_movk_i32 s54, 255
    s_waitcnt lgkmcnt(2)
    v_lshrrev_b32 v28, 8, v16
    v_add_u32 v28, v28, v32
    v_and_or_b32 v16, v16, s54, v24
    v_lshl_add_u32 v28, v28, 2, s53
    s_mov_b64 exec, s[36:37]
    ds_write_b32 v28, v16
    s_mov_b64 exec, -1
    v_lshrrev_b32 v29, 8, v17
    v_add_u32 v29, v29, v33
    v_and_or_b32 v17, v17, s54, v25
    v_lshl_add_u32 v29, v29, 2, s53
    s_mov_b64 exec, s[38:39]
    ds_write_b32 v29, v17
    s_mov_b64 exec, -1
    v_lshrrev_b32 v30, 8, v18
    v_add_u32 v30, v30, v34
    v_and_or_b32 v18, v18, s54, v26
    v_lshl_add_u32 v30, v30, 2, s53
    s_mov_b64 exec, s[40:41]
    ds_write_b32 v30, v18
    s_mov_b64 exec, -1
    v_lshrrev_b32 v31, 8, v19
    v_add_u32 v31, v31, v35
    v_and_or_b32 v19, v19, s54, v27
    v_lshl_add_u32 v31, v31, 2, s53
    s_mov_b64 exec, s[42:43]
    ds_write_b32 v31, v19
    s_mov_b64 exec, -1
    s_cmp_le_i32 s46, 0
    s_cbranch_scc1 L_13
    v_lshl_add_u32 v44, v43, 5, v37
    v_lshl_add_u32 v45, v43, 3, v38
    v_cmp_gt_i32 vcc, s46, v36
    s_lshl_b32 s76, s45, 5
    s_add_u32 m0, s76, 65536
    s_mov_b64 exec, vcc
    buffer_load_dwordx4 v44, s[24:27], 0 offen lds
    s_lshl3_add_u32 m0, s45, 98304
    s_add_u32 s45, s45, 32
    buffer_load_dword v45, s[20:23], 0 offen lds
    s_mov_b64 exec, -1
    s_sub_i32 s46, s46, 32
L_13:
L_paymore:
    s_cmp_le_i32 s46, 0
    s_cbranch_scc1 L_paydone
    ds_read_b32 v40, v39 offset:512
    v_add_u32 v39, 128, v39
    s_waitcnt lgkmcnt(0)
    s_cmp_le_i32 s46, 0
    s_cbranch_scc1 L_14
    v_lshl_add_u32 v44, v40, 5, v37
    v_lshl_add_u32 v45, v40, 3, v38
    v_cmp_gt_i32 vcc, s46, v36
    s_lshl_b32 s76, s45, 5
    s_add_u32 m0, s76, 65536
    s_mov_b64 exec, vcc
    buffer_load_dwordx4 v44, s[24:27], 0 offen lds
    s_lshl3_add_u32 m0, s45, 98304
    s_add_u32 s45, s45, 32
    buffer_load_dword v45, s[20:23], 0 offen lds
    s_mov_b64 exec, -1
    s_sub_i32 s46, s46, 32
L_14:
    s_branch L_paymore
L_paydone:
    s_lshl_b32 s61, s61, 2
    s_add_u32 s61, s61, 106496
    s_and_b32 s54, s2, 192
    s_lshl_b32 s54, s54, 1
    s_lshl4_add_u32 s54, s3, s54
    s_lshl2_add_u32 s53, s54, 4096
    v_and_b32 v66, 15, v1
    v_lshl_add_u32 v66, v66, 2, s53
    s_lshl_b32 s53, s54, 10
    s_add_u32 s53, s53, 1048576
    v_lshl_add_u32 v67, v1, 4, s53
    s_xor_b32 s53, s48, 1
    v_mov_b32 v79, s53
    v_mov_b32 v13, s61
    v_and_b32 v62, 3, v1
    v_lshl_add_u32 v77, v62, 2, s61
    v_bfe_u32 v62, v1, 2, 2
    v_lshl_add_u32 v78, v62, 2, s61
    v_bfe_u32 v63, v1, 4, 1
    v_lshlrev_b32 v63, 4, v63
    v_add_u32 v63, 65536, v63
    v_mov_b32 v65, 98304
    v_mov_b32 v62, 110848
    v_cmp_ne_u32 vcc, 0, v7
    v_cmp_ne_u32 s[4:5], 0, v8
    v_cmp_ne_u32 s[6:7], 0, v10
    v_cndmask_b32 v74, v62, v63, vcc
    v_cndmask_b32 v75, v62, v63, s[4:5]
    v_cndmask_b32 v76, v62, v65, s[6:7]
    s_waitcnt lgkmcnt(0)
    s_barrier
    ds_read_b128 v[68:71], v13
    ds_read_b32 v72, v77
    ds_read_b32 v73, v78
    s_cmp_lt_u32 s62, 3
    s_cbranch_scc1 L_short
    s_waitcnt lgkmcnt(2)
    v_readfirstlane_b32 s64, v68
    v_readfirstlane_b32 s65, v69
    v_readfirstlane_b32 s66, v70
    v_readfirstlane_b32 s67, v71
    s_and_b32 s76, s64, s82
    s_add_u32 m0, s63, 0
    s_lshl_b32 s76, s76, 3
    buffer_load_dwordx4 v2, s[8:11], s76 offen lds
    buffer_load_dwordx4 v3, s[8:11], s76 offen offset:1024 lds
    s_and_b32 s76, s65, s82
    s_add_u32 m0, s63, 2048
    s_lshl_b32 s76, s76, 3
    buffer_load_dwordx4 v2, s[8:11], s76 offen lds
    buffer_load_dwordx4 v3, s[8:11], s76 offen offset:1024 lds
    s_and_b32 s76, s66, s82
    s_add_u32 m0, s63, 4096
    s_lshl_b32 s76, s76, 3
    buffer_load_dwordx4 v2, s[8:11], s76 offen lds
    buffer_load_dwordx4 v3, s[8:11], s76 offen offset:1024 lds
    s_waitcnt vmcnt(6)
    s_branch L_go
L_short:
    s_waitcnt vmcnt(0) lgkmcnt(0)
    v_readfirstlane_b32 s64, v68
    v_readfirstlane_b32 s65, v69
    v_readfirstlane_b32 s66, v70
    v_readfirstlane_b32 s67, v71
    s_cmp_le_u32 s62, 0
    s_cbranch_scc1 L_go
    s_and_b32 s76, s64, s82
    s_add_u32 m0, s63, 0
    s_lshl_b32 s76, s76, 3
    buffer_load_dwordx4 v2, s[8:11], s76 offen lds
    buffer_load_dwordx4 v3, s[8:11], s76 offen offset:1024 lds
    s_cmp_le_u32 s62, 1
    s_cbranch_scc1 L_go
    s_and_b32 s76, s65, s82
    s_add_u32 m0, s63, 2048
    s_lshl_b32 s76, s76, 3
    buffer_load_dwordx4 v2, s[8:11], s76 offen lds
    buffer_load_dwordx4 v3, s[8:11], s76 offen offset:1024 lds
L_go:
    s_cmp_ge_u32 s3, 2
    s_cbranch_scc1 L_15
    s_cmp_lg_u32 s77, 0
    s_cbranch_scc1 L_15
    v_mov_b32 v62, s83
    v_mov_b32 v63, s48
    s_mov_b64 exec, 1
    buffer_store_dword v63, v62, s[32:35], 0 offen sc1
    s_mov_b64 exec, -1
L_15:
    s_waitcnt lgkmcnt(0)
    v_lshrrev_b32 v72, 22, v72
    v_lshrrev_b32 v73, 22, v73
    v_mad_u32_u24 v5, v72, v7, v74
    v_mad_u32_u24 v6, v72, v8, v75
    v_mad_u32_u24 v9, v73, v10, v76
    s_barrier
    s_cmp_eq_u32 s62, 0
    s_cbranch_scc1 L_round_done
L_group:
    s_cmp_le_u32 s62, s81
    s_cbranch_scc1 L_wstep
L_wback:
    ds_read_b64 v[64:65], v9
    ds_read_b128 v[56:59], v5
    ds_read_b128 v[60:63], v6
    ds_read_b128 v[68:71], v13 offset:16
    ds_read_b32 v72, v77 offset:16
    ds_read_b32 v73, v78 offset:16
    v_add_u32 v13, 16, v13
    v_add_u32 v77, 16, v77
    v_add_u32 v78, 16, v78
    s_waitcnt lgkmcnt(0)
    v_mfma_f32_16x16x16_bf16 v[32:35], v[14:15], v[64:65], 0
    v_mfma_f32_16x16x32_bf16 v[16:19], v[56:59], a[0:3], 0
    v_mfma_f32_16x16x32_bf16 v[20:23], v[56:59], a[8:11], 0
    v_mfma_f32_16x16x32_bf16 v[24:27], v[56:59], a[16:19], 0
    v_mfma_f32_16x16x32_bf16 v[28:31], v[56:59], a[24:27], 0
    v_mfma_f32_16x16x32_bf16 v[16:19], v[60:63], a[4:7], v[16:19]
    v_mfma_f32_16x16x32_bf16 v[20:23], v[60:63], a[12:15], v[20:23]
    v_mfma_f32_16x16x32_bf16 v[24:27], v[60:63], a[20:23], v[24:27]
    v_mfma_f32_16x16x32_bf16 v[28:31], v[60:63], a[28:31], v[28:31]
    v_readfirstlane_b32 s68, v68
    v_readfirstlane_b32 s69, v69
    v_readfirstlane_b32 s70, v70
    v_readfirstlane_b32 s71, v71
    v_cvt_pk_bf16_f32 v64, v32, v33
    v_cvt_pk_bf16_f32 v65, v34, v35
    v_lshrrev_b32 v72, 22, v72
    v_lshrrev_b32 v73, 22, v73
    v_mad_u32_u24 v5, v72, v7, v74
    v_mad_u32_u24 v6, v72, v8, v75
    v_mad_u32_u24 v9, v73, v10, v76
    s_cmp_ge_u32 s62, 3
    s_cbranch_scc1 L_16
    s_waitcnt vmcnt(0)
L_16:
    s_waitcnt vmcnt(4)
    ds_read_b64_tr_b16 v[48:49], v4 offset:0
    ds_read_b64_tr_b16 v[50:51], v4 offset:256
    ds_read_b64_tr_b16 v[52:53], v4 offset:512
    ds_read_b64_tr_b16 v[54:55], v4 offset:768
    s_cmp_le_u32 s62, 3
    s_cbranch_scc1 L_17
    s_and_b32 s76, s67, s82
    s_add_u32 m0, s63, 6144
    s_lshl_b32 s76, s76, 3
    buffer_load_dwordx4 v2, s[8:11], s76 offen lds
    buffer_load_dwordx4 v3, s[8:11], s76 offen offset:1024 lds
L_17:
    s_waitcnt lgkmcnt(0)
    v_mfma_f32_4x4x4_16b_bf16 v[32:35], v[64:65], v[48:49], 0 cbsz:4 abid:0
    v_mfma_f32_4x4x4_16b_bf16 v[36:39], v[64:65], v[50:51], 0 cbsz:4 abid:0
    v_mfma_f32_4x4x4_16b_bf16 v[40:43], v[64:65], v[52:53], 0 cbsz:4 abid:0
    v_mfma_f32_4x4x4_16b_bf16 v[44:47], v[64:65], v[54:55], 0 cbsz:4 abid:0
    s_nop 0
    s_set_gpr_idx_on s64, gpr_idx(SRC2,DST)
    v_pk_fma_f32 v[80:81], v[32:33], v[16:17], v[80:81] op_sel:[0,0,0] op_sel_hi:[1,0,1]
    v_pk_fma_f32 v[82:83], v[34:35], v[16:17], v[82:83] op_sel:[0,0,0] op_sel_hi:[1,0,1]
    v_pk_fma_f32 v[84:85], v[36:37], v[20:21], v[84:85] op_sel:[0,0,0] op_sel_hi:[1,0,1]
    v_pk_fma_f32 v[86:87], v[38:39], v[20:21], v[86:87] op_sel:[0,0,0] op_sel_hi:[1,0,1]
    v_pk_fma_f32 v[88:89], v[40:41], v[24:25], v[88:89] op_sel:[0,0,0] op_sel_hi:[1,0,1]
    v_pk_fma_f32 v[90:91], v[42:43], v[24:25], v[90:91] op_sel:[0,0,0] op_sel_hi:[1,0,1]
    v_pk_fma_f32 v[92:93], v[44:45], v[28:29], v[92:93] op_sel:[0,0,0] op_sel_hi:[1,0,1]
    v_pk_fma_f32 v[94:95], v[46:47], v[28:29], v[94:95] op_sel:[0,0,0] op_sel_hi:[1,0,1]
    s_set_gpr_idx_off
    s_mov_b32 s64, s68
    s_sub_u32 s62, s62, 1
    s_cmp_eq_u32 s62, 0
    s_cbranch_scc1 L_round_done
    s_cmp_ge_u32 s62, 3
    s_cbranch_scc1 L_18
    s_waitcnt vmcnt(0)
L_18:
    s_waitcnt vmcnt(4)
    ds_read_b64_tr_b16 v[48:49], v4 offset:2048
    ds_read_b64_tr_b16 v[50:51], v4 offset:2304
    ds_read_b64_tr_b16 v[52:53], v4 offset:2560
    ds_read_b64_tr_b16 v[54:55], v4 offset:2816
    s_cmp_le_u32 s62, 3
    s_cbranch_scc1 L_19
    s_and_b32 s76, s68, s82
    s_add_u32 m0, s63, 0
    s_lshl_b32 s76, s76, 3
    buffer_load_dwordx4 v2, s[8:11], s76 offen lds
    buffer_load_dwordx4 v3, s[8:11], s76 offen offset:1024 lds
L_19:
    s_waitcnt lgkmcnt(0)
    v_mfma_f32_4x4x4_16b_bf16 v[32:35], v[64:65], v[48:49], 0 cbsz:4 abid:1
    v_mfma_f32_4x4x4_16b_bf16 v[36:39], v[64:65], v[50:51], 0 cbsz:4 abid:1
    v_mfma_f32_4x4x4_16b_bf16 v[40:43], v[64:65], v[52:53], 0 cbsz:4 abid:1
    v_mfma_f32_4x4x4_16b_bf16 v[44:47], v[64:65], v[54:55], 0 cbsz:4 abid:1
    s_nop 0
    s_set_gpr_idx_on s65, gpr_idx(SRC2,DST)
    v_pk_fma_f32 v[80:81], v[32:33], v[16:17], v[80:81] op_sel:[0,1,0] op_sel_hi:[1,1,1]
    v_pk_fma_f32 v[82:83], v[34:35], v[16:17], v[82:83] op_sel:[0,1,0] op_sel_hi:[1,1,1]
    v_pk_fma_f32 v[84:85], v[36:37], v[20:21], v[84:85] op_sel:[0,1,0] op_sel_hi:[1,1,1]
    v_pk_fma_f32 v[86:87], v[38:39], v[20:21], v[86:87] op_sel:[0,1,0] op_sel_hi:[1,1,1]
    v_pk_fma_f32 v[88:89], v[40:41], v[24:25], v[88:89] op_sel:[0,1,0] op_sel_hi:[1,1,1]
    v_pk_fma_f32 v[90:91], v[42:43], v[24:25], v[90:91] op_sel:[0,1,0] op_sel_hi:[1,1,1]
    v_pk_fma_f32 v[92:93], v[44:45], v[28:29], v[92:93] op_sel:[0,1,0] op_sel_hi:[1,1,1]
    v_pk_fma_f32 v[94:95], v[46:47], v[28:29], v[94:95] op_sel:[0,1,0] op_sel_hi:[1,1,1]
    s_set_gpr_idx_off
    s_mov_b32 s65, s69
    s_sub_u32 s62, s62, 1
    s_cmp_eq_u32 s62, 0
    s_cbranch_scc1 L_round_done
    s_cmp_ge_u32 s62, 3
    s_cbranch_scc1 L_20
    s_waitcnt vmcnt(0)
L_20:
    s_waitcnt vmcnt(4)
    ds_read_b64_tr_b16 v[48:49], v4 offset:4096
    ds_read_b64_tr_b16 v[50:51], v4 offset:4352
    ds_read_b64_tr_b16 v[52:53], v4 offset:4608
    ds_read_b64_tr_b16 v[54:55], v4 offset:4864
    s_cmp_le_u32 s62, 3
    s_cbranch_scc1 L_21
    s_and_b32 s76, s69, s82
    s_add_u32 m0, s63, 2048
    s_lshl_b32 s76, s76, 3
    buffer_load_dwordx4 v2, s[8:11], s76 offen lds
    buffer_load_dwordx4 v3, s[8:11], s76 offen offset:1024 lds
L_21:
    s_waitcnt lgkmcnt(0)
    v_mfma_f32_4x4x4_16b_bf16 v[32:35], v[64:65], v[48:49], 0 cbsz:4 abid:2
    v_mfma_f32_4x4x4_16b_bf16 v[36:39], v[64:65], v[50:51], 0 cbsz:4 abid:2
    v_mfma_f32_4x4x4_16b_bf16 v[40:43], v[64:65], v[52:53], 0 cbsz:4 abid:2
    v_mfma_f32_4x4x4_16b_bf16 v[44:47], v[64:65], v[54:55], 0 cbsz:4 abid:2
    s_nop 0
    s_set_gpr_idx_on s66, gpr_idx(SRC2,DST)
    v_pk_fma_f32 v[80:81], v[32:33], v[18:19], v[80:81] op_sel:[0,0,0] op_sel_hi:[1,0,1]
    v_pk_fma_f32 v[82:83], v[34:35], v[18:19], v[82:83] op_sel:[0,0,0] op_sel_hi:[1,0,1]
    v_pk_fma_f32 v[84:85], v[36:37], v[22:23], v[84:85] op_sel:[0,0,0] op_sel_hi:[1,0,1]
    v_pk_fma_f32 v[86:87], v[38:39], v[22:23], v[86:87] op_sel:[0,0,0] op_sel_hi:[1,0,1]
    v_pk_fma_f32 v[88:89], v[40:41], v[26:27], v[88:89] op_sel:[0,0,0] op_sel_hi:[1,0,1]
    v_pk_fma_f32 v[90:91], v[42:43], v[26:27], v[90:91] op_sel:[0,0,0] op_sel_hi:[1,0,1]
    v_pk_fma_f32 v[92:93], v[44:45], v[30:31], v[92:93] op_sel:[0,0,0] op_sel_hi:[1,0,1]
    v_pk_fma_f32 v[94:95], v[46:47], v[30:31], v[94:95] op_sel:[0,0,0] op_sel_hi:[1,0,1]
    s_set_gpr_idx_off
    s_mov_b32 s66, s70
    s_sub_u32 s62, s62, 1
    s_cmp_eq_u32 s62, 0
    s_cbranch_scc1 L_round_done
    s_cmp_ge_u32 s62, 3
    s_cbranch_scc1 L_22
    s_waitcnt vmcnt(0)
L_22:
    s_waitcnt vmcnt(4)
    ds_read_b64_tr_b16 v[48:49], v4 offset:6144
    ds_read_b64_tr_b16 v[50:51], v4 offset:6400
    ds_read_b64_tr_b16 v[52:53], v4 offset:6656
    ds_read_b64_tr_b16 v[54:55], v4 offset:6912
    s_cmp_le_u32 s62, 3
    s_cbranch_scc1 L_23
    s_and_b32 s76, s70, s82
    s_add_u32 m0, s63, 4096
    s_lshl_b32 s76, s76, 3
    buffer_load_dwordx4 v2, s[8:11], s76 offen lds
    buffer_load_dwordx4 v3, s[8:11], s76 offen offset:1024 lds
L_23:
    s_waitcnt lgkmcnt(0)
    v_mfma_f32_4x4x4_16b_bf16 v[32:35], v[64:65], v[48:49], 0 cbsz:4 abid:3
    v_mfma_f32_4x4x4_16b_bf16 v[36:39], v[64:65], v[50:51], 0 cbsz:4 abid:3
    v_mfma_f32_4x4x4_16b_bf16 v[40:43], v[64:65], v[52:53], 0 cbsz:4 abid:3
    v_mfma_f32_4x4x4_16b_bf16 v[44:47], v[64:65], v[54:55], 0 cbsz:4 abid:3
    s_nop 0
    s_set_gpr_idx_on s67, gpr_idx(SRC2,DST)
    v_pk_fma_f32 v[80:81], v[32:33], v[18:19], v[80:81] op_sel:[0,1,0] op_sel_hi:[1,1,1]
    v_pk_fma_f32 v[82:83], v[34:35], v[18:19], v[82:83] op_sel:[0,1,0] op_sel_hi:[1,1,1]
    v_pk_fma_f32 v[84:85], v[36:37], v[22:23], v[84:85] op_sel:[0,1,0] op_sel_hi:[1,1,1]
    v_pk_fma_f32 v[86:87], v[38:39], v[22:23], v[86:87] op_sel:[0,1,0] op_sel_hi:[1,1,1]
    v_pk_fma_f32 v[88:89], v[40:41], v[26:27], v[88:89] op_sel:[0,1,0] op_sel_hi:[1,1,1]
    v_pk_fma_f32 v[90:91], v[42:43], v[26:27], v[90:91] op_sel:[0,1,0] op_sel_hi:[1,1,1]
    v_pk_fma_f32 v[92:93], v[44:45], v[30:31], v[92:93] op_sel:[0,1,0] op_sel_hi:[1,1,1]
    v_pk_fma_f32 v[94:95], v[46:47], v[30:31], v[94:95] op_sel:[0,1,0] op_sel_hi:[1,1,1]
    s_set_gpr_idx_off
    s_mov_b32 s67, s71
    s_sub_u32 s62, s62, 1
    s_cmp_eq_u32 s62, 0
    s_cbranch_scc0 L_group
L_round_done:
    s_add_u32 s77, s77, 1
    s_cmp_lg_u32 s78, 0
    s_cbranch_scc1 L_scan
    s_cmp_eq_u32 s81, 0
    s_cbranch_scc1 L_havew
    s_mov_b32 s55, 0
L_pollw:
    s_waitcnt vmcnt(0)
    v_cmp_ne_u32 vcc, s48, v79
    s_cbranch_vccz L_gotw
    buffer_load_dword v79, v66, s[32:35], 0 offen sc1
    s_sleep 1
    s_add_u32 s55, s55, 1
    s_cmp_lt_u32 s55, 0x400000
    s_cbranch_scc1 L_pollw
    s_endpgm
L_gotw:
    buffer_load_dwordx4 a[32:35], v67, s[32:35], 0 offen offset:0 sc1
    buffer_load_dwordx4 a[36:39], v67, s[32:35], 0 offen offset:1024 sc1
    buffer_load_dwordx4 a[40:43], v67, s[32:35], 0 offen offset:2048 sc1
    buffer_load_dwordx4 a[44:47], v67, s[32:35], 0 offen offset:3072 sc1
    v_add_u32 v67, 4096, v67
    buffer_load_dwordx4 a[48:51], v67, s[32:35], 0 offen offset:0 sc1
    buffer_load_dwordx4 a[52:55], v67, s[32:35], 0 offen offset:1024 sc1
    buffer_load_dwordx4 a[56:59], v67, s[32:35], 0 offen offset:2048 sc1
    buffer_load_dwordx4 a[60:63], v67, s[32:35], 0 offen offset:3072 sc1
    v_add_u32 v67, 4096, v67
    buffer_load_dwordx4 a[64:67], v67, s[32:35], 0 offen offset:0 sc1
    buffer_load_dwordx4 a[68:71], v67, s[32:35], 0 offen offset:1024 sc1
    buffer_load_dwordx4 a[72:75], v67, s[32:35], 0 offen offset:2048 sc1
    buffer_load_dwordx4 a[76:79], v67, s[32:35], 0 offen offset:3072 sc1
    v_add_u32 v67, 4096, v67
    buffer_load_dwordx4 a[80:83], v67, s[32:35], 0 offen offset:0 sc1
    buffer_load_dwordx4 a[84:87], v67, s[32:35], 0 offen offset:1024 sc1
    buffer_load_dwordx4 a[88:91], v67, s[32:35], 0 offen offset:2048 sc1
    buffer_load_dwordx4 a[92:95], v67, s[32:35], 0 offen offset:3072 sc1
    v_add_u32 v67, 4096, v67
    s_branch L_havew
L_wstep:
    v_cmp_ne_u32 vcc, s48, v79
    s_cbranch_vccz L_wgo
    buffer_load_dword v79, v66, s[32:35], 0 offen sc1
    s_branch L_wback
L_wgo:
    s_branch L_wback
L_havew:
    v_mov_b32 v13, v67
    v_mul_u32_u24 v16, 320, v1
    v_lshrrev_b32 v17, 2, v1
    v_lshl_add_u32 v16, v17, 3, v16
    s_lshl_b32 s53, s56, 3
    v_add_u32 v72, s53, v16
    v_add_u32 v5, 111136, v72
    s_lshl_b32 s53, s57, 3
    v_add_u32 v73, s53, v16
    v_add_u32 v6, 111136, v73
    s_lshl_b32 s53, s58, 3
    v_add_u32 v74, s53, v16
    v_add_u32 v7, 111136, v74
    s_lshl_b32 s53, s59, 3
    v_add_u32 v75, s53, v16
    v_add_u32 v8, 111136, v75
    s_lshl_b32 s53, s60, 3
    v_add_u32 v76, s53, v16
    v_add_u32 v9, 111136, v76
    v_cvt_pk_bf16_f32 v32, v80, v81
    v_cvt_pk_bf16_f32 v33, v82, v83
    ds_write_b64 v5, v[32:33] offset:0
    v_cvt_pk_bf16_f32 v34, v96, v97
    v_cvt_pk_bf16_f32 v35, v98, v99
    ds_write_b64 v6, v[34:35] offset:0
    v_cvt_pk_bf16_f32 v36, v112, v113
    v_cvt_pk_bf16_f32 v37, v114, v115
    ds_write_b64 v7, v[36:37] offset:0
    v_cvt_pk_bf16_f32 v38, v128, v129
    v_cvt_pk_bf16_f32 v39, v130, v131
    ds_write_b64 v8, v[38:39] offset:0
    v_cvt_pk_bf16_f32 v40, v144, v145
    v_cvt_pk_bf16_f32 v41, v146, v147
    ds_write_b64 v9, v[40:41] offset:0
    v_cvt_pk_bf16_f32 v42, v84, v85
    v_cvt_pk_bf16_f32 v43, v86, v87
    ds_write_b64 v5, v[42:43] offset:20608
    v_cvt_pk_bf16_f32 v44, v100, v101
    v_cvt_pk_bf16_f32 v45, v102, v103
    ds_write_b64 v6, v[44:45] offset:20608
    v_cvt_pk_bf16_f32 v46, v116, v117
    v_cvt_pk_bf16_f32 v47, v118, v119
    ds_write_b64 v7, v[46:47] offset:20608
    v_cvt_pk_bf16_f32 v48, v132, v133
    v_cvt_pk_bf16_f32 v49, v134, v135
    ds_write_b64 v8, v[48:49] offset:20608
    v_cvt_pk_bf16_f32 v50, v148, v149
    v_cvt_pk_bf16_f32 v51, v150, v151
    ds_write_b64 v9, v[50:51] offset:20608
    v_cvt_pk_bf16_f32 v52, v88, v89
    v_cvt_pk_bf16_f32 v53, v90, v91
    v_cvt_pk_bf16_f32 v54, v104, v105
    v_cvt_pk_bf16_f32 v55, v106, v107
    v_cvt_pk_bf16_f32 v56, v120, v121
    v_cvt_pk_bf16_f32 v57, v122, v123
    v_cvt_pk_bf16_f32 v58, v136, v137
    v_cvt_pk_bf16_f32 v59, v138, v139
    v_cvt_pk_bf16_f32 v60, v152, v153
    v_cvt_pk_bf16_f32 v61, v154, v155
    v_cvt_pk_bf16_f32 v62, v92, v93
    v_cvt_pk_bf16_f32 v63, v94, v95
    v_cvt_pk_bf16_f32 v64, v108, v109
    v_cvt_pk_bf16_f32 v65, v110, v111
    v_cvt_pk_bf16_f32 v66, v124, v125
    v_cvt_pk_bf16_f32 v67, v126, v127
    v_cvt_pk_bf16_f32 v68, v140, v141
    v_cvt_pk_bf16_f32 v69, v142, v143
    v_cvt_pk_bf16_f32 v70, v156, v157
    v_cvt_pk_bf16_f32 v71, v158, v159
    v_lshrrev_b32 v20, 5, v1
    v_mul_u32_u24 v21, 2576, v20
    v_bfe_u32 v22, v1, 2, 2
    v_mul_u32_u24 v24, 320, v22
    v_bfe_u32 v23, v1, 4, 1
    v_lshl_add_u32 v21, v23, 5, v21
    v_and_b32 v23, 3, v1
    v_lshl_add_u32 v21, v23, 3, v21
    v_add_u32 v3, v21, v24
    v_add_u32 v2, 111136, v3
    s_lshl_b32 s53, s3, 12
    s_add_u32 s53, s53, 41472
    v_and_b32 v24, 31, v1
    v_lshlrev_b32 v24, 6, v24
    v_lshl_add_u32 v24, v20, 3, v24
    v_bfe_u32 v25, v1, 1, 2
    v_lshl_add_u32 v24, v25, 4, v24
    v_add_u32 v5, s53, v24
    v_xor_b32 v6, 16, v5
    v_xor_b32 v7, 32, v5
    v_xor_b32 v8, 48, v5
    v_bfe_u32 v25, v1, 3, 2
    v_xor_b32 v25, v25, v23
    v_lshrrev_b32 v24, 2, v1
    v_lshlrev_b32 v24, 6, v24
    v_lshl_add_u32 v24, v25, 4, v24
    v_add_u32 v11, s53, v24
    v_lshrrev_b32 v24, 4, v1
    v_lshlrev_b32 v24, 19, v24
    v_lshl_add_u32 v24, v22, 9, v24
    v_lshl_add_u32 v24, v23, 4, v24
    s_lshl_b32 s53, s2, 11
    s_lshl_b32 s54, s3, 6
    s_add_u32 s53, s53, s54
    v_add_u32 v4, s53, v24
    s_waitcnt lgkmcnt(0)
    s_barrier
    ds_read_b64_tr_b16 v[16:17], v2 offset:0
    ds_read_b64_tr_b16 v[18:19], v2 offset:1288
    ds_read_b64_tr_b16 v[20:21], v2 offset:5152
    ds_read_b64_tr_b16 v[22:23], v2 offset:6440
    ds_read_b64_tr_b16 v[24:25], v2 offset:10304
    ds_read_b64_tr_b16 v[26:27], v2 offset:11592
    ds_read_b64_tr_b16 v[28:29], v2 offset:15456
    ds_read_b64_tr_b16 v[30:31], v2 offset:16744
    ds_read_b64_tr_b16 v[32:33], v2 offset:20608
    ds_read_b64_tr_b16 v[34:35], v2 offset:21896
    s_waitcnt vmcnt(8)
    s_waitcnt lgkmcnt(8)
    v_mfma_f32_32x32x16_bf16 v[80:95], a[32:35], v[16:19], 0
    ds_read_b64_tr_b16 v[36:37], v2 offset:25760
    ds_read_b64_tr_b16 v[38:39], v2 offset:27048
    ds_write_b64 v72, v[52:53] offset:0
    s_waitcnt lgkmcnt(9)
    v_mfma_f32_32x32x16_bf16 v[80:95], a[36:39], v[20:23], v[80:95]
    ds_read_b64_tr_b16 v[40:41], v2 offset:30912
    ds_read_b64_tr_b16 v[42:43], v2 offset:32200
    ds_write_b64 v73, v[54:55] offset:0
    s_waitcnt lgkmcnt(10)
    v_mfma_f32_32x32x16_bf16 v[80:95], a[40:43], v[24:27], v[80:95]
    ds_read_b64_tr_b16 v[44:45], v2 offset:36064
    ds_read_b64_tr_b16 v[46:47], v2 offset:37352
    ds_write_b64 v74, v[56:57] offset:0
    s_waitcnt lgkmcnt(11)
    v_mfma_f32_32x32x16_bf16 v[80:95], a[44:47], v[28:31], v[80:95]
    ds_read_b64_tr_b16 v[16:17], v2 offset:64
    ds_read_b64_tr_b16 v[18:19], v2 offset:1352
    ds_write_b64 v75, v[58:59] offset:0
    s_waitcnt lgkmcnt(12)
    v_mfma_f32_32x32x16_bf16 v[80:95], a[48:51], v[32:35], v[80:95]
    ds_read_b64_tr_b16 v[20:21], v2 offset:5216
    ds_read_b64_tr_b16 v[22:23], v2 offset:6504
    ds_write_b64 v76, v[60:61] offset:0
    s_waitcnt lgkmcnt(13)
    v_mfma_f32_32x32x16_bf16 v[80:95], a[52:55], v[36:39], v[80:95]
    ds_read_b64_tr_b16 v[24:25], v2 offset:10368
    ds_read_b64_tr_b16 v[26:27], v2 offset:11656
    ds_write_b64 v72, v[62:63] offset:20608
    s_waitcnt lgkmcnt(13)
    v_mfma_f32_32x32x16_bf16 v[80:95], a[56:59], v[40:43], v[80:95]
    ds_read_b64_tr_b16 v[28:29], v2 offset:15520
    ds_read_b64_tr_b16 v[30:31], v2 offset:16808
    ds_write_b64 v73, v[64:65] offset:20608
    s_waitcnt lgkmcnt(13)
    v_mfma_f32_32x32x16_bf16 v[80:95], a[60:63], v[44:47], v[80:95]
    ds_read_b64_tr_b16 v[32:33], v2 offset:20672
    ds_read_b64_tr_b16 v[34:35], v2 offset:21960
    ds_write_b64 v74, v[66:67] offset:20608
    s_waitcnt lgkmcnt(13)
    v_mfma_f32_32x32x16_bf16 v[96:111], a[32:35], v[16:19], 0
    ds_read_b64_tr_b16 v[36:37], v2 offset:25824
    ds_read_b64_tr_b16 v[38:39], v2 offset:27112
    ds_write_b64 v75, v[68:69] offset:20608
    s_waitcnt lgkmcnt(13)
    v_mfma_f32_32x32x16_bf16 v[96:111], a[36:39], v[20:23], v[96:111]
    ds_read_b64_tr_b16 v[40:41], v2 offset:30976
    ds_read_b64_tr_b16 v[42:43], v2 offset:32264
    ds_write_b64 v76, v[70:71] offset:20608
    s_waitcnt lgkmcnt(13)
    v_mfma_f32_32x32x16_bf16 v[96:111], a[40:43], v[24:27], v[96:111]
    ds_read_b64_tr_b16 v[44:45], v2 offset:36128
    ds_read_b64_tr_b16 v[46:47], v2 offset:37416
    s_waitcnt lgkmcnt(12)
    v_mfma_f32_32x32x16_bf16 v[96:111], a[44:47], v[28:31], v[96:111]
    ds_read_b64_tr_b16 v[16:17], v2 offset:128
    ds_read_b64_tr_b16 v[18:19], v2 offset:1416
    s_waitcnt lgkmcnt(11)
    v_mfma_f32_32x32x16_bf16 v[96:111], a[48:51], v[32:35], v[96:111]
    ds_read_b64_tr_b16 v[20:21], v2 offset:5280
    ds_read_b64_tr_b16 v[22:23], v2 offset:6568
    s_waitcnt lgkmcnt(10)
    v_mfma_f32_32x32x16_bf16 v[96:111], a[52:55], v[36:39], v[96:111]
    ds_read_b64_tr_b16 v[24:25], v2 offset:10432
    ds_read_b64_tr_b16 v[26:27], v2 offset:11720
    s_waitcnt lgkmcnt(9)
    v_mfma_f32_32x32x16_bf16 v[96:111], a[56:59], v[40:43], v[96:111]
    ds_read_b64_tr_b16 v[28:29], v2 offset:15584
    ds_read_b64_tr_b16 v[30:31], v2 offset:16872
    s_waitcnt lgkmcnt(8)
    v_mfma_f32_32x32x16_bf16 v[96:111], a[60:63], v[44:47], v[96:111]
    ds_read_b64_tr_b16 v[32:33], v2 offset:20736
    ds_read_b64_tr_b16 v[34:35], v2 offset:22024
    s_waitcnt lgkmcnt(8)
    v_mfma_f32_32x32x16_bf16 v[112:127], a[32:35], v[16:19], 0
    ds_read_b64_tr_b16 v[36:37], v2 offset:25888
    ds_read_b64_tr_b16 v[38:39], v2 offset:27176
    s_waitcnt lgkmcnt(8)
    v_mfma_f32_32x32x16_bf16 v[112:127], a[36:39], v[20:23], v[112:127]
    ds_read_b64_tr_b16 v[40:41], v2 offset:31040
    ds_read_b64_tr_b16 v[42:43], v2 offset:32328
    s_waitcnt lgkmcnt(8)
    v_mfma_f32_32x32x16_bf16 v[112:127], a[40:43], v[24:27], v[112:127]
    ds_read_b64_tr_b16 v[44:45], v2 offset:36192
    ds_read_b64_tr_b16 v[46:47], v2 offset:37480
    s_barrier
    s_waitcnt lgkmcnt(8)
    v_mfma_f32_32x32x16_bf16 v[112:127], a[44:47], v[28:31], v[112:127]
    ds_read_b64_tr_b16 v[16:17], v3 offset:0
    ds_read_b64_tr_b16 v[18:19], v3 offset:1288
    s_waitcnt lgkmcnt(8)
    v_mfma_f32_32x32x16_bf16 v[112:127], a[48:51], v[32:35], v[112:127]
    ds_read_b64_tr_b16 v[20:21], v3 offset:5152
    ds_read_b64_tr_b16 v[22:23], v3 offset:6440
    s_waitcnt lgkmcnt(8)
    v_mfma_f32_32x32x16_bf16 v[112:127], a[52:55], v[36:39], v[112:127]
    ds_read_b64_tr_b16 v[24:25], v3 offset:10304
    ds_read_b64_tr_b16 v[26:27], v3 offset:11592
    s_waitcnt lgkmcnt(8)
    v_mfma_f32_32x32x16_bf16 v[112:127], a[56:59], v[40:43], v[112:127]
    ds_read_b64_tr_b16 v[28:29], v3 offset:15456
    ds_read_b64_tr_b16 v[30:31], v3 offset:16744
    s_waitcnt lgkmcnt(8)
    v_mfma_f32_32x32x16_bf16 v[112:127], a[60:63], v[44:47], v[112:127]
    ds_read_b64_tr_b16 v[32:33], v3 offset:20608
    ds_read_b64_tr_b16 v[34:35], v3 offset:21896
    s_waitcnt vmcnt(0)
    s_waitcnt lgkmcnt(8)
    v_mfma_f32_32x32x16_bf16 v[80:95], a[64:67], v[16:19], v[80:95]
    ds_read_b64_tr_b16 v[36:37], v3 offset:25760
    ds_read_b64_tr_b16 v[38:39], v3 offset:27048
    s_waitcnt lgkmcnt(8)
    v_mfma_f32_32x32x16_bf16 v[80:95], a[68:71], v[20:23], v[80:95]
    ds_read_b64_tr_b16 v[40:41], v3 offset:30912
    ds_read_b64_tr_b16 v[42:43], v3 offset:32200
    s_waitcnt lgkmcnt(8)
    v_mfma_f32_32x32x16_bf16 v[80:95], a[72:75], v[24:27], v[80:95]
    ds_read_b64_tr_b16 v[44:45], v3 offset:36064
    ds_read_b64_tr_b16 v[46:47], v3 offset:37352
    s_waitcnt lgkmcnt(8)
    v_mfma_f32_32x32x16_bf16 v[80:95], a[76:79], v[28:31], v[80:95]
    ds_read_b64_tr_b16 v[16:17], v3 offset:64
    ds_read_b64_tr_b16 v[18:19], v3 offset:1352
    s_waitcnt lgkmcnt(8)
    v_mfma_f32_32x32x16_bf16 v[80:95], a[80:83], v[32:35], v[80:95]
    ds_read_b64_tr_b16 v[20:21], v3 offset:5216
    ds_read_b64_tr_b16 v[22:23], v3 offset:6504
    s_waitcnt lgkmcnt(8)
    v_mfma_f32_32x32x16_bf16 v[80:95], a[84:87], v[36:39], v[80:95]
    ds_read_b64_tr_b16 v[24:25], v3 offset:10368
    ds_read_b64_tr_b16 v[26:27], v3 offset:11656
    s_waitcnt lgkmcnt(8)
    v_mfma_f32_32x32x16_bf16 v[80:95], a[88:91], v[40:43], v[80:95]
    ds_read_b64_tr_b16 v[28:29], v3 offset:15520
    ds_read_b64_tr_b16 v[30:31], v3 offset:16808
    s_waitcnt lgkmcnt(8)
    v_mfma_f32_32x32x16_bf16 v[80:95], a[92:95], v[44:47], v[80:95]
    ds_read_b64_tr_b16 v[32:33], v3 offset:20672
    ds_read_b64_tr_b16 v[34:35], v3 offset:21960
    s_waitcnt lgkmcnt(8)
    v_mfma_f32_32x32x16_bf16 v[96:111], a[64:67], v[16:19], v[96:111]
    ds_read_b64_tr_b16 v[36:37], v3 offset:25824
    ds_read_b64_tr_b16 v[38:39], v3 offset:27112
    s_waitcnt lgkmcnt(8)
    v_mfma_f32_32x32x16_bf16 v[96:111], a[68:71], v[20:23], v[96:111]
    ds_read_b64_tr_b16 v[40:41], v3 offset:30976
    ds_read_b64_tr_b16 v[42:43], v3 offset:32264
    s_waitcnt lgkmcnt(8)
    v_mfma_f32_32x32x16_bf16 v[96:111], a[72:75], v[24:27], v[96:111]
    ds_read_b64_tr_b16 v[44:45], v3 offset:36128
    ds_read_b64_tr_b16 v[46:47], v3 offset:37416
    s_waitcnt lgkmcnt(8)
    v_mfma_f32_32x32x16_bf16 v[96:111], a[76:79], v[28:31], v[96:111]
    ds_read_b64_tr_b16 v[16:17], v3 offset:128
    ds_read_b64_tr_b16 v[18:19], v3 offset:1416
    v_cvt_pk_bf16_f32 v80, v80, v81
    v_cvt_pk_bf16_f32 v81, v82, v83
    ds_write_b64 v5, v[80:81] offset:0
    s_waitcnt lgkmcnt(9)
    v_mfma_f32_32x32x16_bf16 v[96:111], a[80:83], v[32:35], v[96:111]
    ds_read_b64_tr_b16 v[20:21], v3 offset:5280
    ds_read_b64_tr_b16 v[22:23], v3 offset:6568
    v_cvt_pk_bf16_f32 v82, v84, v85
    v_cvt_pk_bf16_f32 v83, v86, v87
    ds_write_b64 v6, v[82:83] offset:0
    s_waitcnt lgkmcnt(10)
    v_mfma_f32_32x32x16_bf16 v[96:111], a[84:87], v[36:39], v[96:111]
    ds_read_b64_tr_b16 v[24:25], v3 offset:10432
    ds_read_b64_tr_b16 v[26:27], v3 offset:11720
    v_cvt_pk_bf16_f32 v84, v88, v89
    v_cvt_pk_bf16_f32 v85, v90, v91
    ds_write_b64 v7, v[84:85] offset:0
    s_waitcnt lgkmcnt(11)
    v_mfma_f32_32x32x16_bf16 v[96:111], a[88:91], v[40:43], v[96:111]
    ds_read_b64_tr_b16 v[28:29], v3 offset:15584
    ds_read_b64_tr_b16 v[30:31], v3 offset:16872
    v_cvt_pk_bf16_f32 v86, v92, v93
    v_cvt_pk_bf16_f32 v87, v94, v95
    ds_write_b64 v8, v[86:87] offset:0
    s_waitcnt lgkmcnt(12)
    v_mfma_f32_32x32x16_bf16 v[96:111], a[92:95], v[44:47], v[96:111]
    ds_read_b64_tr_b16 v[32:33], v3 offset:20736
    ds_read_b64_tr_b16 v[34:35], v3 offset:22024
    ds_read_b128 v[52:55], v11 offset:0
    s_waitcnt lgkmcnt(13)
    v_mfma_f32_32x32x16_bf16 v[112:127], a[64:67], v[16:19], v[112:127]
    ds_read_b64_tr_b16 v[36:37], v3 offset:25888
    ds_read_b64_tr_b16 v[38:39], v3 offset:27176
    ds_read_b128 v[56:59], v11 offset:1024
    s_waitcnt lgkmcnt(13)
    v_mfma_f32_32x32x16_bf16 v[112:127], a[68:71], v[20:23], v[112:127]
    ds_read_b64_tr_b16 v[40:41], v3 offset:31040
    ds_read_b64_tr_b16 v[42:43], v3 offset:32328
    s_waitcnt lgkmcnt(12)
    v_mfma_f32_32x32x16_bf16 v[112:127], a[72:75], v[24:27], v[112:127]
    ds_read_b64_tr_b16 v[44:45], v3 offset:36192
    ds_read_b64_tr_b16 v[46:47], v3 offset:37480
    s_waitcnt lgkmcnt(11)
    v_mfma_f32_32x32x16_bf16 v[112:127], a[76:79], v[28:31], v[112:127]
    ds_read_b64_tr_b16 v[16:17], v2 offset:192
    ds_read_b64_tr_b16 v[18:19], v2 offset:1480
    v_cvt_pk_bf16_f32 v96, v96, v97
    v_cvt_pk_bf16_f32 v97, v98, v99
    ds_write_b64 v5, v[96:97] offset:2048
    s_waitcnt lgkmcnt(11)
    v_mfma_f32_32x32x16_bf16 v[112:127], a[80:83], v[32:35], v[112:127]
    ds_read_b64_tr_b16 v[20:21], v2 offset:5344
    ds_read_b64_tr_b16 v[22:23], v2 offset:6632
    v_cvt_pk_bf16_f32 v98, v100, v101
    v_cvt_pk_bf16_f32 v99, v102, v103
    ds_write_b64 v6, v[98:99] offset:2048
    s_waitcnt lgkmcnt(11)
    v_mfma_f32_32x32x16_bf16 v[112:127], a[84:87], v[36:39], v[112:127]
    ds_read_b64_tr_b16 v[24:25], v2 offset:10496
    ds_read_b64_tr_b16 v[26:27], v2 offset:11784
    buffer_store_dwordx4 v[52:55], v4, s[28:31], 0 offen sc1
    v_add_u32 v4, 2097152, v4
    v_cvt_pk_bf16_f32 v100, v104, v105
    v_cvt_pk_bf16_f32 v101, v106, v107
    ds_write_b64 v7, v[100:101] offset:2048
    s_waitcnt lgkmcnt(11)
    v_mfma_f32_32x32x16_bf16 v[112:127], a[88:91], v[40:43], v[112:127]
    ds_read_b64_tr_b16 v[28:29], v2 offset:15648
    ds_read_b64_tr_b16 v[30:31], v2 offset:16936
    buffer_store_dwordx4 v[56:59], v4, s[28:31], 0 offen sc1
    v_add_u32 v4, 2097152, v4
    v_cvt_pk_bf16_f32 v102, v108, v109
    v_cvt_pk_bf16_f32 v103, v110, v111
    ds_write_b64 v8, v[102:103] offset:2048
    s_waitcnt lgkmcnt(12)
    v_mfma_f32_32x32x16_bf16 v[112:127], a[92:95], v[44:47], v[112:127]
    ds_read_b64_tr_b16 v[32:33], v2 offset:20800
    ds_read_b64_tr_b16 v[34:35], v2 offset:22088
    ds_read_b128 v[60:63], v11 offset:2048
    s_waitcnt lgkmcnt(13)
    v_mfma_f32_32x32x16_bf16 v[128:143], a[32:35], v[16:19], 0
    ds_read_b64_tr_b16 v[36:37], v2 offset:25952
    ds_read_b64_tr_b16 v[38:39], v2 offset:27240
    ds_read_b128 v[64:67], v11 offset:3072
    s_waitcnt lgkmcnt(13)
    v_mfma_f32_32x32x16_bf16 v[128:143], a[36:39], v[20:23], v[128:143]
    ds_read_b64_tr_b16 v[40:41], v2 offset:31104
    ds_read_b64_tr_b16 v[42:43], v2 offset:32392
    s_waitcnt lgkmcnt(12)
    v_mfma_f32_32x32x16_bf16 v[128:143], a[40:43], v[24:27], v[128:143]
    ds_read_b64_tr_b16 v[44:45], v2 offset:36256
    ds_read_b64_tr_b16 v[46:47], v2 offset:37544
    s_waitcnt lgkmcnt(11)
    v_mfma_f32_32x32x16_bf16 v[128:143], a[44:47], v[28:31], v[128:143]
    ds_read_b64_tr_b16 v[16:17], v3 offset:192
    ds_read_b64_tr_b16 v[18:19], v3 offset:1480
    v_cvt_pk_bf16_f32 v112, v112, v113
    v_cvt_pk_bf16_f32 v113, v114, v115
    ds_write_b64 v5, v[112:113] offset:0
    s_waitcnt lgkmcnt(11)
    v_mfma_f32_32x32x16_bf16 v[128:143], a[48:51], v[32:35], v[128:143]
    ds_read_b64_tr_b16 v[20:21], v3 offset:5344
    ds_read_b64_tr_b16 v[22:23], v3 offset:6632
    v_cvt_pk_bf16_f32 v114, v116, v117
    v_cvt_pk_bf16_f32 v115, v118, v119
    ds_write_b64 v6, v[114:115] offset:0
    s_waitcnt lgkmcnt(11)
    v_mfma_f32_32x32x16_bf16 v[128:143], a[52:55], v[36:39], v[128:143]
    ds_read_b64_tr_b16 v[24:25], v3 offset:10496
    ds_read_b64_tr_b16 v[26:27], v3 offset:11784
    buffer_store_dwordx4 v[60:63], v4, s[28:31], 0 offen sc1
    v_add_u32 v4, 2097152, v4
    v_cvt_pk_bf16_f32 v116, v120, v121
    v_cvt_pk_bf16_f32 v117, v122, v123
    ds_write_b64 v7, v[116:117] offset:0
    s_waitcnt lgkmcnt(11)
    v_mfma_f32_32x32x16_bf16 v[128:143], a[56:59], v[40:43], v[128:143]
    ds_read_b64_tr_b16 v[28:29], v3 offset:15648
    ds_read_b64_tr_b16 v[30:31], v3 offset:16936
    buffer_store_dwordx4 v[64:67], v4, s[28:31], 0 offen sc1
    v_add_u32 v4, 2097152, v4
    v_cvt_pk_bf16_f32 v118, v124, v125
    v_cvt_pk_bf16_f32 v119, v126, v127
    ds_write_b64 v8, v[118:119] offset:0
    s_waitcnt lgkmcnt(12)
    v_mfma_f32_32x32x16_bf16 v[128:143], a[60:63], v[44:47], v[128:143]
    ds_read_b64_tr_b16 v[32:33], v3 offset:20800
    ds_read_b64_tr_b16 v[34:35], v3 offset:22088
    ds_read_b128 v[52:55], v11 offset:0
    s_waitcnt lgkmcnt(13)
    v_mfma_f32_32x32x16_bf16 v[128:143], a[64:67], v[16:19], v[128:143]
    ds_read_b64_tr_b16 v[36:37], v3 offset:25952
    ds_read_b64_tr_b16 v[38:39], v3 offset:27240
    ds_read_b128 v[56:59], v11 offset:1024
    s_waitcnt lgkmcnt(13)
    v_mfma_f32_32x32x16_bf16 v[128:143], a[68:71], v[20:23], v[128:143]
    ds_read_b64_tr_b16 v[40:41], v3 offset:31104
    ds_read_b64_tr_b16 v[42:43], v3 offset:32392
    s_waitcnt lgkmcnt(12)
    v_mfma_f32_32x32x16_bf16 v[128:143], a[72:75], v[24:27], v[128:143]
    ds_read_b64_tr_b16 v[44:45], v3 offset:36256
    ds_read_b64_tr_b16 v[46:47], v3 offset:37544
    s_waitcnt lgkmcnt(11)
    v_mfma_f32_32x32x16_bf16 v[128:143], a[76:79], v[28:31], v[128:143]
    ds_read_b64_tr_b16 v[16:17], v2 offset:256
    ds_read_b64_tr_b16 v[18:19], v2 offset:1544
    s_waitcnt lgkmcnt(10)
    v_mfma_f32_32x32x16_bf16 v[128:143], a[80:83], v[32:35], v[128:143]
    ds_read_b64_tr_b16 v[20:21], v2 offset:5408
    ds_read_b64_tr_b16 v[22:23], v2 offset:6696
    s_waitcnt lgkmcnt(9)
    v_mfma_f32_32x32x16_bf16 v[128:143], a[84:87], v[36:39], v[128:143]
    ds_read_b64_tr_b16 v[24:25], v2 offset:10560
    ds_read_b64_tr_b16 v[26:27], v2 offset:11848
    buffer_store_dwordx4 v[52:55], v4, s[28:31], 0 offen sc1
    v_add_u32 v4, 2097152, v4
    s_waitcnt lgkmcnt(8)
    v_mfma_f32_32x32x16_bf16 v[128:143], a[88:91], v[40:43], v[128:143]
    ds_read_b64_tr_b16 v[28:29], v2 offset:15712
    ds_read_b64_tr_b16 v[30:31], v2 offset:17000
    buffer_store_dwordx4 v[56:59], v4, s[28:31], 0 offen sc1
    v_add_u32 v4, 2097152, v4
    s_waitcnt lgkmcnt(8)
    v_mfma_f32_32x32x16_bf16 v[128:143], a[92:95], v[44:47], v[128:143]
    ds_read_b64_tr_b16 v[32:33], v2 offset:20864
    ds_read_b64_tr_b16 v[34:35], v2 offset:22152
    s_waitcnt lgkmcnt(8)
    v_mfma_f32_32x32x16_bf16 v[144:159], a[32:35], v[16:19], 0
    ds_read_b64_tr_b16 v[36:37], v2 offset:26016
    ds_read_b64_tr_b16 v[38:39], v2 offset:27304
    s_waitcnt lgkmcnt(8)
    v_mfma_f32_32x32x16_bf16 v[144:159], a[36:39], v[20:23], v[144:159]
    ds_read_b64_tr_b16 v[40:41], v2 offset:31168
    ds_read_b64_tr_b16 v[42:43], v2 offset:32456
    s_waitcnt lgkmcnt(8)
    v_mfma_f32_32x32x16_bf16 v[144:159], a[40:43], v[24:27], v[144:159]
    ds_read_b64_tr_b16 v[44:45], v2 offset:36320
    ds_read_b64_tr_b16 v[46:47], v2 offset:37608
    s_waitcnt lgkmcnt(8)
    v_mfma_f32_32x32x16_bf16 v[144:159], a[44:47], v[28:31], v[144:159]
    ds_read_b64_tr_b16 v[16:17], v3 offset:256
    ds_read_b64_tr_b16 v[18:19], v3 offset:1544
    v_cvt_pk_bf16_f32 v128, v128, v129
    v_cvt_pk_bf16_f32 v129, v130, v131
    ds_write_b64 v5, v[128:129] offset:2048
    s_waitcnt lgkmcnt(9)
    v_mfma_f32_32x32x16_bf16 v[144:159], a[48:51], v[32:35], v[144:159]
    ds_read_b64_tr_b16 v[20:21], v3 offset:5408
    ds_read_b64_tr_b16 v[22:23], v3 offset:6696
    v_cvt_pk_bf16_f32 v130, v132, v133
    v_cvt_pk_bf16_f32 v131, v134, v135
    ds_write_b64 v6, v[130:131] offset:2048
    s_waitcnt lgkmcnt(10)
    v_mfma_f32_32x32x16_bf16 v[144:159], a[52:55], v[36:39], v[144:159]
    ds_read_b64_tr_b16 v[24:25], v3 offset:10560
    ds_read_b64_tr_b16 v[26:27], v3 offset:11848
    v_cvt_pk_bf16_f32 v132, v136, v137
    v_cvt_pk_bf16_f32 v133, v138, v139
    ds_write_b64 v7, v[132:133] offset:2048
    s_waitcnt lgkmcnt(11)
    v_mfma_f32_32x32x16_bf16 v[144:159], a[56:59], v[40:43], v[144:159]
    ds_read_b64_tr_b16 v[28:29], v3 offset:15712
    ds_read_b64_tr_b16 v[30:31], v3 offset:17000
    v_cvt_pk_bf16_f32 v134, v140, v141
    v_cvt_pk_bf16_f32 v135, v142, v143
    ds_write_b64 v8, v[134:135] offset:2048
    s_waitcnt lgkmcnt(12)
    v_mfma_f32_32x32x16_bf16 v[144:159], a[60:63], v[44:47], v[144:159]
    ds_read_b64_tr_b16 v[32:33], v3 offset:20864
    ds_read_b64_tr_b16 v[34:35], v3 offset:22152
    ds_read_b128 v[60:63], v11 offset:2048
    s_waitcnt lgkmcnt(13)
    v_mfma_f32_32x32x16_bf16 v[144:159], a[64:67], v[16:19], v[144:159]
    ds_read_b64_tr_b16 v[36:37], v3 offset:26016
    ds_read_b64_tr_b16 v[38:39], v3 offset:27304
    ds_read_b128 v[64:67], v11 offset:3072
    s_waitcnt lgkmcnt(13)
    v_mfma_f32_32x32x16_bf16 v[144:159], a[68:71], v[20:23], v[144:159]
    ds_read_b64_tr_b16 v[40:41], v3 offset:31168
    ds_read_b64_tr_b16 v[42:43], v3 offset:32456
    s_waitcnt lgkmcnt(12)
    v_mfma_f32_32x32x16_bf16 v[144:159], a[72:75], v[24:27], v[144:159]
    ds_read_b64_tr_b16 v[44:45], v3 offset:36320
    ds_read_b64_tr_b16 v[46:47], v3 offset:37608
    s_waitcnt lgkmcnt(11)
    v_mfma_f32_32x32x16_bf16 v[144:159], a[76:79], v[28:31], v[144:159]
    s_waitcnt lgkmcnt(8)
    v_mfma_f32_32x32x16_bf16 v[144:159], a[80:83], v[32:35], v[144:159]
    s_waitcnt lgkmcnt(5)
    v_mfma_f32_32x32x16_bf16 v[144:159], a[84:87], v[36:39], v[144:159]
    buffer_store_dwordx4 v[60:63], v4, s[28:31], 0 offen sc1
    v_add_u32 v4, 2097152, v4
    s_waitcnt lgkmcnt(2)
    v_mfma_f32_32x32x16_bf16 v[144:159], a[88:91], v[40:43], v[144:159]
    buffer_store_dwordx4 v[64:67], v4, s[28:31], 0 offen sc1
    v_add_u32 v4, 2097152, v4
    s_waitcnt lgkmcnt(0)
    v_mfma_f32_32x32x16_bf16 v[144:159], a[92:95], v[44:47], v[144:159]
    s_nop 11
    v_cvt_pk_bf16_f32 v144, v144, v145
    v_cvt_pk_bf16_f32 v145, v146, v147
    ds_write_b64 v5, v[144:145] offset:0
    v_cvt_pk_bf16_f32 v146, v148, v149
    v_cvt_pk_bf16_f32 v147, v150, v151
    ds_write_b64 v6, v[146:147] offset:0
    v_cvt_pk_bf16_f32 v148, v152, v153
    v_cvt_pk_bf16_f32 v149, v154, v155
    ds_write_b64 v7, v[148:149] offset:0
    v_cvt_pk_bf16_f32 v150, v156, v157
    v_cvt_pk_bf16_f32 v151, v158, v159
    ds_write_b64 v8, v[150:151] offset:0
    ds_read_b128 v[52:55], v11 offset:0
    ds_read_b128 v[56:59], v11 offset:1024
    s_waitcnt lgkmcnt(1)
    buffer_store_dwordx4 v[52:55], v4, s[28:31], 0 offen sc1
    v_add_u32 v4, 2097152, v4
    s_waitcnt lgkmcnt(0)
    buffer_store_dwordx4 v[56:59], v4, s[28:31], 0 offen sc1
    v_add_u32 v4, 2097152, v4
L_end:
    s_endpgm
.section .rodata,"a"
.p2align 6
.amdhsa_kernel standalone__tensor_product_equiv_mace__graph_kernel
  .amdhsa_next_free_vgpr 256
  .amdhsa_next_free_sgpr 102
  .amdhsa_accum_offset 160
  .amdhsa_group_segment_fixed_size 0
  .amdhsa_kernarg_size 88
  .amdhsa_user_sgpr_count 2
  .amdhsa_user_sgpr_kernarg_segment_ptr 1
  .amdhsa_system_sgpr_workgroup_id_x 1
  .amdhsa_float_denorm_mode_32 3
.end_amdhsa_kernel
```
